```python
import torch

def _softmax(x, axis=-1):
    return torch.softmax(x, dim=axis)
def _gelu(x):
    return torch.nn.functional.gelu(x, approximate="tanh")
def _silu(x):
    return torch.nn.functional.silu(x)
def _sigmoid(x):
    return torch.sigmoid(x)
def _layernorm(x, axis=-1, eps=1e-5):
    m = x.mean(dim=axis, keepdim=True)
    v = x.var(dim=axis, keepdim=True, unbiased=False)
    return (x - m) / torch.sqrt(v + eps)
def _scatter_add(tgt, idx, src, axis=0):
    return tgt.clone().index_add_(axis, idx, src)
def _segment_sum(src, seg, n):
    out = torch.zeros((n,) + src.shape[1:], dtype=src.dtype)
    return out.index_add_(0, seg, src)
def _pad(x, pw):
    flat = tuple(v for pair in reversed(pw) for v in pair)
    return torch.nn.functional.pad(x, flat)

kernel_name = 'standalone__modern_conv_block_convnext__vision'

def setup_inputs():

    _w = (lambda a: (lambda t: t.to(torch.bfloat16) if t.is_floating_point() else t)(torch.as_tensor(a)))
    H = W = 512
    C = 96
    K = 3
    return {
        "x": _w((lambda *s: torch.randn(*s, dtype=torch.bfloat16) * 0.05)(1, H, W, C)),
        "dw": _w((lambda *s: torch.randn(*s, dtype=torch.bfloat16) * 0.05)(K, K, C)),
        "w1": _w((lambda *s: torch.randn(*s, dtype=torch.bfloat16) * 0.05)(C, 4 * C)),
        "b1": _w((lambda *s: torch.randn(*s, dtype=torch.bfloat16) * 0.2)(4 * C)),
        "w2": _w((lambda *s: torch.randn(*s, dtype=torch.bfloat16) * 0.05)(4 * C, C)),
        "b2": _w((lambda *s: torch.randn(*s, dtype=torch.bfloat16) * 0.2)(C)),
        "gamma": _w((lambda *s: torch.randn(*s, dtype=torch.bfloat16) * 0.05)(C)),
    }

def reference(x, dw, w1, b1, w2, b2, gamma):
    B, H, W, C = x.shape
    K = dw.shape[0]
    pad = K // 2
    xp = _pad(x, ((0,0),(pad,pad),(pad,pad),(0,0)))
    out = torch.zeros_like(x)
    for i in range(K):
        for j in range(K):
            out = out + xp[:, i:i+H, j:j+W, :] * dw[i, j][None, None, None, :]
    h = _layernorm(out, axis=-1)
    h = torch.einsum('bhwc,ce->bhwe', h, w1) + b1
    h = _gelu(h)
    h = torch.einsum('bhwe,ec->bhwc', h, w2) + b2
    return x + gamma[None, None, None, :] * h
```

```asm
; @launch grid=(256,1,1) block=(256,1,1) lds=163840
.amdgcn_target "amdgcn-amd-amdhsa--gfx950"
.text
.globl standalone__modern_conv_block_convnext__vision_kernel
.p2align 8
.type standalone__modern_conv_block_convnext__vision_kernel,@function
standalone__modern_conv_block_convnext__vision_kernel:
  s_cmp_ge_u32 s2, 0x100
  s_cbranch_scc1 L_end
  s_load_dwordx16 s[36:51], s[0:1], 0
  v_mov_b32 v16, v0
  v_and_b32 v17, 63, v0
  v_lshrrev_b32 v18, 6, v0
  v_lshlrev_b32 v19, 4, v17
  v_readfirstlane_b32 s27, v18
  s_lshr_b32 s54, s2, 4
  s_lshl_b32 s54, s54, 5
  s_and_b32 s53, s2, 15
  s_lshl_b32 s53, s53, 5
  s_lshl_b32 s32, s27, 3
  s_add_u32 s53, s53, s32
  s_min_u32 s57, s27, 2
  s_mul_i32 s58, s27, 0x1040
  s_mul_i32 s59, s27, 0x4800
  v_and_b32 v20, 7, v17
  v_bfe_u32 v21, v17, 3, 1
  v_bfe_u32 v22, v17, 4, 1
  v_lshrrev_b32 v23, 5, v17
  v_bfe_u32 v24, v17, 2, 1
  v_and_b32 v25, 3, v17
  v_lshrrev_b32 v26, 4, v17
  s_cmp_eq_u32 s53, 0
  s_cselect_b32 s35, 12, 0
  s_cmp_eq_u32 s53, 0x1f8
  s_cselect_b32 s55, 12, 0
  s_add_u32 s55, s55, s35
  s_sub_u32 s55, 0x78, s55
  s_mul_i32 s56, s53, 0xc0
  s_add_u32 s56, s56, 0xf40
  v_mov_b32 v27, 0x80000000
  v_mov_b32 v28, v17
  v_mov_b32 v29, 0
  v_lshl_add_u32 v29, v28, 4, v29
  v_add_u32 v29, s56, v29
  v_subrev_u32 v28, s35, v28
  v_cmp_gt_u32 vcc, s55, v28
  s_nop 1
  v_cndmask_b32 v6, v27, v29, vcc
  v_add_u32 v28, 64, v17
  v_subrev_u32 v30, 57, v17
  v_cmp_le_u32 vcc, 57, v17
  v_mov_b32 v29, 0x17c00
  s_nop 0
  v_cndmask_b32 v28, v28, v30, vcc
  v_mov_b32 v30, 0xfffffc00
  v_cndmask_b32 v29, v30, v29, vcc
  v_lshl_add_u32 v29, v28, 4, v29
  v_add_u32 v29, s56, v29
  v_subrev_u32 v28, s35, v28
  v_cmp_gt_u32 vcc, s55, v28
  s_nop 1
  v_cndmask_b32 v7, v27, v29, vcc
  v_add_u32 v28, 7, v17
  v_mov_b32 v29, 0x17800
  v_lshl_add_u32 v29, v28, 4, v29
  v_add_u32 v29, s56, v29
  v_subrev_u32 v28, s35, v28
  v_cmp_gt_u32 vcc, s55, v28
  s_nop 1
  v_cndmask_b32 v8, v27, v29, vcc
  v_add_u32 v28, 0x47, v17
  v_mov_b32 v29, 0x17400
  v_lshl_add_u32 v29, v28, 4, v29
  v_add_u32 v29, s56, v29
  v_subrev_u32 v28, s35, v28
  v_cmp_gt_u32 vcc, s55, v28
  s_nop 1
  v_cndmask_b32 v9, v27, v29, vcc
  s_waitcnt lgkmcnt(0)
  s_mov_b32 s4, s36
  s_mov_b32 s5, s37
  s_mov_b32 s6, 0x3000000
  s_mov_b32 s7, 0x20000
  s_mov_b32 s60, s38
  s_mov_b32 s61, s39
  s_mov_b32 s62, 0x6c0
  s_mov_b32 s63, 0x20000
  s_mov_b32 s64, s40
  s_mov_b32 s65, s41
  s_mov_b32 s66, 0x12000
  s_mov_b32 s67, 0x20000
  s_mov_b32 s68, s42
  s_mov_b32 s69, s43
  s_mov_b32 s70, 0x300
  s_mov_b32 s71, 0x20000
  s_mov_b32 s72, s44
  s_mov_b32 s73, s45
  s_mov_b32 s74, 0x12000
  s_mov_b32 s75, 0x20000
  s_mov_b32 s76, s46
  s_mov_b32 s77, s47
  s_mov_b32 s78, 0xc0
  s_mov_b32 s79, 0x20000
  s_mov_b32 s80, s48
  s_mov_b32 s81, s49
  s_mov_b32 s82, 0xc0
  s_mov_b32 s83, 0x20000
  s_mov_b32 s8, s50
  s_mov_b32 s9, s51
  s_mov_b32 s10, 0x3000000
  s_mov_b32 s11, 0x20000
  s_add_u32 s32, s59, 0
  s_add_u32 m0, s32, 0x16000
  s_nop 0
  buffer_load_dwordx4 v19, s[72:75], s32 offen lds
  buffer_load_dwordx4 v19, s[72:75], s32 offen offset:1024 lds
  buffer_load_dwordx4 v19, s[72:75], s32 offen offset:2048 lds
  buffer_load_dwordx4 v19, s[72:75], s32 offen offset:3072 lds
  s_add_u32 s32, s59, 0x1000
  s_add_u32 m0, s32, 0x16000
  s_nop 0
  buffer_load_dwordx4 v19, s[72:75], s32 offen lds
  buffer_load_dwordx4 v19, s[72:75], s32 offen offset:1024 lds
  buffer_load_dwordx4 v19, s[72:75], s32 offen offset:2048 lds
  buffer_load_dwordx4 v19, s[72:75], s32 offen offset:3072 lds
  s_add_u32 s32, s59, 0x2000
  s_add_u32 m0, s32, 0x16000
  s_nop 0
  buffer_load_dwordx4 v19, s[72:75], s32 offen lds
  buffer_load_dwordx4 v19, s[72:75], s32 offen offset:1024 lds
  buffer_load_dwordx4 v19, s[72:75], s32 offen offset:2048 lds
  buffer_load_dwordx4 v19, s[72:75], s32 offen offset:3072 lds
  s_add_u32 s32, s59, 0x3000
  s_add_u32 m0, s32, 0x16000
  s_nop 0
  buffer_load_dwordx4 v19, s[72:75], s32 offen lds
  buffer_load_dwordx4 v19, s[72:75], s32 offen offset:1024 lds
  buffer_load_dwordx4 v19, s[72:75], s32 offen offset:2048 lds
  buffer_load_dwordx4 v19, s[72:75], s32 offen offset:3072 lds
  s_add_u32 s32, s59, 0x4000
  s_add_u32 m0, s32, 0x16000
  s_nop 0
  buffer_load_dwordx4 v19, s[72:75], s32 offen lds
  buffer_load_dwordx4 v19, s[72:75], s32 offen offset:1024 lds
  v_lshlrev_b32 v31, 4, v22
  v_lshl_add_u32 v31, v24, 3, v31
  v_lshl_add_u32 v31, v21, 2, v31
  v_add_u32 v31, v31, v25
  v_lshlrev_b32 v31, 1, v31
  buffer_load_ushort v32, v31, s[80:83], 0 offen
  buffer_load_ushort v33, v31, s[80:83], 0 offen offset:64
  buffer_load_ushort v34, v31, s[80:83], 0 offen offset:128
  s_lshl_b32 s32, s57, 6
  buffer_load_ushort v35, v31, s[80:83], s32 offen
  buffer_load_ushort v36, v31, s[76:79], s32 offen
  v_lshlrev_b32 v37, 2, v17
  s_lshl_b32 s33, s57, 8
  buffer_load_dword v38, v37, s[68:71], s33 offen
  v_lshlrev_b32 v39, 1, v16
  buffer_load_ushort v40, v39, s[60:63], 0 offen
  buffer_load_ushort v41, v39, s[60:63], 0 offen offset:576
  buffer_load_ushort v42, v39, s[60:63], 0 offen offset:1152
  v_and_b32 v44, 31, v17
  v_lshlrev_b32 v45, 1, v44
  s_mul_i32 s34, s57, 0x240
  buffer_load_ushort v43, v45, s[60:63], s34 offen offset:512
  s_mul_i32 s32, s54, 0x18000
  s_add_u32 s33, s32, 0xfffe7000
  v_add_u32 v28, s33, v6
  buffer_load_dwordx4 v[112:115], v28, s[4:7], 0 offen
  s_add_u32 s33, s32, 0xfffe7400
  v_add_u32 v28, s33, v7
  buffer_load_dwordx4 v[116:119], v28, s[4:7], 0 offen
  s_add_u32 s33, s32, 0xfffe7800
  v_add_u32 v28, s33, v8
  buffer_load_dwordx4 v[120:123], v28, s[4:7], 0 offen
  s_add_u32 s33, s32, 0xfffe7c00
  v_add_u32 v28, s33, v9
  buffer_load_dwordx4 v[124:127], v28, s[4:7], 0 offen
  s_add_u32 s33, s32, 0x17000
  buffer_load_dwordx4 v[128:131], v6, s[4:7], s33 offen
  buffer_load_dwordx4 v[132:135], v7, s[4:7], s33 offen offset:1024
  buffer_load_dwordx4 v[136:139], v8, s[4:7], s33 offen offset:2048
  buffer_load_dwordx4 v[140:143], v9, s[4:7], s33 offen offset:3072
  s_add_u32 s33, s32, 0x47000
  buffer_load_dwordx4 v[144:147], v6, s[4:7], s33 offen
  buffer_load_dwordx4 v[148:151], v7, s[4:7], s33 offen offset:1024
  buffer_load_dwordx4 v[152:155], v8, s[4:7], s33 offen offset:2048
  buffer_load_dwordx4 v[156:159], v9, s[4:7], s33 offen offset:3072
  s_add_u32 s29, s32, 0x77000
  s_add_u32 s52, s32, 0xa7000
  v_lshlrev_b32 v46, 2, v22
  v_xor_b32 v46, v46, v20
  v_lshlrev_b32 v46, 4, v46
  v_lshrrev_b32 v47, 3, v17
  v_mov_b32 v29, 0x300
  v_mad_u32_u24 v46, v47, v29, v46
  s_mul_i32 s35, s27, 0xc00
  s_add_u32 s33, s59, 0
  s_add_u32 m0, s35, 0
  s_nop 0
  buffer_load_dwordx4 v46, s[64:67], s33 offen lds
  s_add_u32 s33, s59, 0x1800
  s_add_u32 m0, s35, 0x400
  s_nop 0
  buffer_load_dwordx4 v46, s[64:67], s33 offen lds
  s_add_u32 s33, s59, 0x3000
  s_add_u32 m0, s35, 0x800
  s_nop 0
  buffer_load_dwordx4 v46, s[64:67], s33 offen lds
  s_add_u32 s33, s59, 0x80
  s_add_u32 m0, s35, 0x3000
  s_nop 0
  buffer_load_dwordx4 v46, s[64:67], s33 offen lds
  s_add_u32 s33, s59, 0x1880
  s_add_u32 m0, s35, 0x3400
  s_nop 0
  buffer_load_dwordx4 v46, s[64:67], s33 offen lds
  s_add_u32 s33, s59, 0x3080
  s_add_u32 m0, s35, 0x3800
  s_nop 0
  buffer_load_dwordx4 v46, s[64:67], s33 offen lds
  s_add_u32 s33, s59, 0x100
  s_add_u32 m0, s35, 0x6000
  s_nop 0
  buffer_load_dwordx4 v46, s[64:67], s33 offen lds
  s_add_u32 s33, s59, 0x1900
  s_add_u32 m0, s35, 0x6400
  s_nop 0
  buffer_load_dwordx4 v46, s[64:67], s33 offen lds
  s_add_u32 s33, s59, 0x3100
  s_add_u32 m0, s35, 0x6800
  s_nop 0
  buffer_load_dwordx4 v46, s[64:67], s33 offen lds
  s_add_u32 s33, s59, 0x180
  s_add_u32 m0, s35, 0x9000
  s_nop 0
  buffer_load_dwordx4 v46, s[64:67], s33 offen lds
  s_add_u32 s33, s59, 0x1980
  s_add_u32 m0, s35, 0x9400
  s_nop 0
  buffer_load_dwordx4 v46, s[64:67], s33 offen lds
  s_add_u32 s33, s59, 0x3180
  s_add_u32 m0, s35, 0x9800
  s_nop 0
  buffer_load_dwordx4 v46, s[64:67], s33 offen lds
  s_add_u32 s33, s59, 0x200
  s_add_u32 m0, s35, 0xc000
  s_nop 0
  buffer_load_dwordx4 v46, s[64:67], s33 offen lds
  s_add_u32 s33, s59, 0x1a00
  s_add_u32 m0, s35, 0xc400
  s_nop 0
  buffer_load_dwordx4 v46, s[64:67], s33 offen lds
  s_add_u32 s33, s59, 0x3200
  s_add_u32 m0, s35, 0xc800
  s_nop 0
  buffer_load_dwordx4 v46, s[64:67], s33 offen lds
  s_add_u32 s33, s59, 0x280
  s_add_u32 m0, s35, 0xf000
  s_nop 0
  buffer_load_dwordx4 v46, s[64:67], s33 offen lds
  s_add_u32 s33, s59, 0x1a80
  s_add_u32 m0, s35, 0xf400
  s_nop 0
  buffer_load_dwordx4 v46, s[64:67], s33 offen lds
  s_add_u32 s33, s59, 0x3280
  s_add_u32 m0, s35, 0xf800
  s_nop 0
  buffer_load_dwordx4 v46, s[64:67], s33 offen lds
  s_mov_b32 s20, 0x409d30fc
  s_mov_b32 s21, 0x409d30fc
  s_mov_b32 s22, 0x3eeff558
  s_mov_b32 s23, 0x3eeff558
  s_mov_b32 s24, 0x3c2aaaab
  s_mov_b32 s25, 0x3727c5ac
  v_lshl_add_u32 v49, v21, 1, v26
  v_lshrrev_b32 v28, 1, v49
  v_mov_b32 v29, 0x4100
  v_mul_u32_u24 v48, v28, v29
  v_and_b32 v28, 1, v28
  v_lshl_add_u32 v48, v28, 5, v48
  v_and_b32 v28, 1, v49
  v_mov_b32 v29, 0x790
  v_mad_u32_u24 v48, v28, v29, v48
  v_mov_b32 v29, 0xc0
  v_mad_u32_u24 v48, v20, v29, v48
  v_add_u32 v4, s58, v48
  v_lshl_add_u32 v50, v21, 1, v22
  v_add_u32 v49, 1, v50
  v_lshlrev_b32 v51, 4, v23
  v_add_u32 v52, 0xc0, v51
  v_lshrrev_b32 v28, 1, v49
  v_mov_b32 v29, 0x4100
  v_mul_u32_u24 v48, v28, v29
  v_and_b32 v28, 1, v28
  v_lshl_add_u32 v48, v28, 5, v48
  v_and_b32 v28, 1, v49
  v_mov_b32 v29, 0x790
  v_mad_u32_u24 v48, v28, v29, v48
  v_mov_b32 v29, 0xc0
  v_mad_u32_u24 v48, v20, v29, v48
  v_add_u32 v48, v48, v52
  v_add_u32 v5, s58, v48
  v_mov_b32 v29, 0x18000
  v_mad_u32_u24 v10, v50, v29, v51
  v_add_u32 v28, s53, v20
  v_mov_b32 v29, 0xc0
  v_mad_u32_u24 v10, v28, v29, v10
  v_add_u32 v2, 0x15840, v51
  v_sub_u32 v28, v26, v24
  v_lshl_add_u32 v29, v21, 2, v25
  v_lshl_add_u32 v29, v28, 3, v29
  v_cmp_gt_u32 vcc, 3, v28
  v_mov_b32 v30, 24
  s_nop 0
  v_cndmask_b32 v29, v30, v29, vcc
  v_lshlrev_b32 v29, 4, v29
  v_add_u32 v3, 0x12000, v29
  v_lshlrev_b32 v28, 2, v22
  v_lshl_add_u32 v28, v21, 1, v28
  v_bfe_u32 v29, v17, 1, 1
  v_add_u32 v28, v28, v29
  v_and_b32 v29, 1, v17
  v_lshlrev_b32 v29, 4, v29
  v_mov_b32 v53, v29
  v_mov_b32 v30, 0x3f80
  v_lshlrev_b32 v29, v29, v30
  v_cmp_eq_u32 vcc, v24, v23
  s_nop 1
  v_cndmask_b32 v29, 0, v29, vcc
  v_cmp_eq_u32 vcc, 0, v28
  s_nop 1
  v_cndmask_b32 v240, 0, v29, vcc
  v_cmp_eq_u32 vcc, 1, v28
  s_nop 1
  v_cndmask_b32 v241, 0, v29, vcc
  v_cmp_eq_u32 vcc, 2, v28
  s_nop 1
  v_cndmask_b32 v242, 0, v29, vcc
  v_cmp_eq_u32 vcc, 3, v28
  s_nop 1
  v_cndmask_b32 v243, 0, v29, vcc
  v_cmp_eq_u32 vcc, 4, v28
  s_nop 1
  v_cndmask_b32 v244, 0, v29, vcc
  v_cmp_eq_u32 vcc, 5, v28
  s_nop 1
  v_cndmask_b32 v245, 0, v29, vcc
  v_cmp_eq_u32 vcc, 6, v28
  s_nop 1
  v_cndmask_b32 v246, 0, v29, vcc
  v_cmp_eq_u32 vcc, 7, v28
  s_nop 1
  v_cndmask_b32 v247, 0, v29, vcc
  v_mov_b32 v30, 0xffff
  v_lshlrev_b32 v30, v53, v30
  v_bfe_u32 v28, v17, 1, 2
  v_cmp_eq_u32 vcc, 0, v28
  s_nop 1
  v_cndmask_b32 v192, 0, v30, vcc
  v_mov_b32 v200, 0
  v_cmp_eq_u32 vcc, 1, v28
  s_nop 1
  v_cndmask_b32 v193, 0, v30, vcc
  v_mov_b32 v201, 0
  v_cmp_eq_u32 vcc, 2, v28
  s_nop 1
  v_cndmask_b32 v194, 0, v30, vcc
  v_mov_b32 v202, 0
  v_cmp_eq_u32 vcc, 3, v28
  s_nop 1
  v_cndmask_b32 v195, 0, v30, vcc
  v_mov_b32 v203, 0
  v_mov_b32 v29, 0x190
  v_min_u32 v28, 35, v17
  v_mul_u32_u24 v28, v28, v29
  v_add_u32 v28, 0x12180, v28
  ds_write_b128 v28, v[200:203]
  v_lshrrev_b32 v54, 3, v16
  v_mul_u32_u24 v54, v54, v29
  v_lshl_add_u32 v54, v20, 4, v54
  v_add_u32 v54, 0x12000, v54
  v_lshrrev_b32 v55, 3, v44
  v_mul_u32_u24 v55, v55, v29
  v_lshl_add_u32 v55, v20, 4, v55
  s_lshl_b32 s32, s57, 7
  s_add_u32 s32, s32, 0x15200
  v_add_u32 v55, s32, v55
  s_waitcnt vmcnt(33)
  v_lshl_or_b32 v40, v40, 16, v40
  v_and_b32 v196, v192, v40
  v_and_b32 v197, v193, v40
  v_and_b32 v198, v194, v40
  v_and_b32 v199, v195, v40
  ds_write_b128 v54, v[196:199]
  s_waitcnt vmcnt(32)
  v_lshl_or_b32 v41, v41, 16, v41
  v_and_b32 v204, v192, v41
  v_and_b32 v205, v193, v41
  v_and_b32 v206, v194, v41
  v_and_b32 v207, v195, v41
  ds_write_b128 v54, v[204:207] offset:128
  s_waitcnt vmcnt(31)
  v_lshl_or_b32 v42, v42, 16, v42
  v_and_b32 v208, v192, v42
  v_and_b32 v209, v193, v42
  v_and_b32 v210, v194, v42
  v_and_b32 v211, v195, v42
  ds_write_b128 v54, v[208:211] offset:256
  s_waitcnt vmcnt(30)
  v_lshl_or_b32 v43, v43, 16, v43
  v_and_b32 v212, v192, v43
  v_and_b32 v213, v193, v43
  v_and_b32 v214, v194, v43
  v_and_b32 v215, v195, v43
  ds_write_b128 v55, v[212:215]
  v_lshlrev_b32 v216, 16, v38
  v_and_b32 v217, 0xffff0000, v38
  v_pk_mul_f32 v[216:217], v[216:217], s[22:23]
  s_lshl_b32 s32, s57, 9
  s_add_u32 s32, s32, 0x15840
  v_lshlrev_b32 v28, 3, v17
  v_add_u32 v28, s32, v28
  ds_write_b64 v28, v[216:217]
  v_lshlrev_b32 v35, 16, v35
  v_lshlrev_b32 v36, 16, v36
  v_mul_f32 v35, v35, v36
  s_lshl_b32 s32, s57, 7
  s_add_u32 s32, s32, 0x15e40
  v_lshlrev_b32 v28, 2, v44
  v_add_u32 v28, s32, v28
  ds_write_b32 v28, v35
  v_lshlrev_b32 v218, 16, v32
  v_lshlrev_b32 v220, 16, v33
  v_lshlrev_b32 v222, 16, v34
  v_bfe_u32 v56, v17, 2, 2
  v_lshl_add_u32 v57, v23, 2, v56
  v_mov_b32 v29, 0xc0
  v_mul_u32_u24 v58, v57, v29
  v_lshl_add_u32 v58, v22, 5, v58
  v_and_b32 v28, 1, v17
  v_lshl_add_u32 v58, v28, 4, v58
  v_bfe_u32 v28, v17, 1, 1
  v_lshl_add_u32 v58, v28, 3, v58
  s_add_u32 s32, s59, 0x16000
  v_add_u32 v58, s32, v58
  v_add_u32 v59, s32, v19
  ds_read_b64_tr_b16 v[64:65], v58
  ds_read_b64_tr_b16 v[66:67], v58 offset:1536
  ds_read_b64_tr_b16 v[68:69], v58 offset:64
  ds_read_b64_tr_b16 v[70:71], v58 offset:1600
  ds_read_b64_tr_b16 v[72:73], v58 offset:128
  ds_read_b64_tr_b16 v[74:75], v58 offset:1664
  ds_read_b64_tr_b16 v[76:77], v58 offset:3072
  ds_read_b64_tr_b16 v[78:79], v58 offset:4608
  ds_read_b64_tr_b16 v[80:81], v58 offset:3136
  ds_read_b64_tr_b16 v[82:83], v58 offset:4672
  ds_read_b64_tr_b16 v[84:85], v58 offset:3200
  ds_read_b64_tr_b16 v[86:87], v58 offset:4736
  ds_read_b64_tr_b16 v[88:89], v58 offset:6144
  ds_read_b64_tr_b16 v[90:91], v58 offset:7680
  ds_read_b64_tr_b16 v[92:93], v58 offset:6208
  ds_read_b64_tr_b16 v[94:95], v58 offset:7744
  ds_read_b64_tr_b16 v[96:97], v58 offset:6272
  ds_read_b64_tr_b16 v[98:99], v58 offset:7808
  ds_read_b64_tr_b16 v[100:101], v58 offset:9216
  ds_read_b64_tr_b16 v[102:103], v58 offset:10752
  ds_read_b64_tr_b16 v[104:105], v58 offset:9280
  ds_read_b64_tr_b16 v[106:107], v58 offset:10816
  ds_read_b64_tr_b16 v[108:109], v58 offset:9344
  ds_read_b64_tr_b16 v[110:111], v58 offset:10880
  ds_read_b64_tr_b16 v[160:161], v58 offset:12288
  ds_read_b64_tr_b16 v[162:163], v58 offset:13824
  ds_read_b64_tr_b16 v[164:165], v58 offset:12352
  ds_read_b64_tr_b16 v[166:167], v58 offset:13888
  ds_read_b64_tr_b16 v[168:169], v58 offset:12416
  ds_read_b64_tr_b16 v[170:171], v58 offset:13952
  ds_read_b64_tr_b16 v[172:173], v58 offset:15360
  ds_read_b64_tr_b16 v[174:175], v58 offset:16896
  ds_read_b64_tr_b16 v[176:177], v58 offset:15424
  ds_read_b64_tr_b16 v[178:179], v58 offset:16960
  ds_read_b64_tr_b16 v[180:181], v58 offset:15488
  ds_read_b64_tr_b16 v[182:183], v58 offset:17024
  s_waitcnt lgkmcnt(15)
  v_lshlrev_b32 v224, 16, v64
  v_and_b32 v225, 0xffff0000, v64
  v_lshlrev_b32 v226, 16, v65
  v_and_b32 v227, 0xffff0000, v65
  v_lshlrev_b32 v228, 16, v66
  v_and_b32 v229, 0xffff0000, v66
  v_lshlrev_b32 v230, 16, v67
  v_and_b32 v231, 0xffff0000, v67
  v_pk_mul_f32 v[224:225], v[224:225], v[218:219] op_sel_hi:[1,0]
  v_pk_mul_f32 v[226:227], v[226:227], v[218:219] op_sel_hi:[1,0]
  v_pk_mul_f32 v[228:229], v[228:229], v[218:219] op_sel_hi:[1,0]
  v_pk_mul_f32 v[230:231], v[230:231], v[218:219] op_sel_hi:[1,0]
  v_cvt_pk_bf16_f32 v64, v224, v225
  v_cvt_pk_bf16_f32 v65, v226, v227
  v_cvt_pk_bf16_f32 v66, v228, v229
  v_cvt_pk_bf16_f32 v67, v230, v231
  ds_write_b128 v59, v[64:67]
  v_lshlrev_b32 v232, 16, v68
  v_and_b32 v233, 0xffff0000, v68
  v_lshlrev_b32 v234, 16, v69
  v_and_b32 v235, 0xffff0000, v69
  v_lshlrev_b32 v236, 16, v70
  v_and_b32 v237, 0xffff0000, v70
  v_lshlrev_b32 v238, 16, v71
  v_and_b32 v239, 0xffff0000, v71
  v_pk_mul_f32 v[232:233], v[232:233], v[220:221] op_sel_hi:[1,0]
  v_pk_mul_f32 v[234:235], v[234:235], v[220:221] op_sel_hi:[1,0]
  v_pk_mul_f32 v[236:237], v[236:237], v[220:221] op_sel_hi:[1,0]
  v_pk_mul_f32 v[238:239], v[238:239], v[220:221] op_sel_hi:[1,0]
  v_cvt_pk_bf16_f32 v68, v232, v233
  v_cvt_pk_bf16_f32 v69, v234, v235
  v_cvt_pk_bf16_f32 v70, v236, v237
  v_cvt_pk_bf16_f32 v71, v238, v239
  ds_write_b128 v59, v[68:71] offset:1024
  v_lshlrev_b32 v224, 16, v72
  v_and_b32 v225, 0xffff0000, v72
  v_lshlrev_b32 v226, 16, v73
  v_and_b32 v227, 0xffff0000, v73
  v_lshlrev_b32 v228, 16, v74
  v_and_b32 v229, 0xffff0000, v74
  v_lshlrev_b32 v230, 16, v75
  v_and_b32 v231, 0xffff0000, v75
  v_pk_mul_f32 v[224:225], v[224:225], v[222:223] op_sel_hi:[1,0]
  v_pk_mul_f32 v[226:227], v[226:227], v[222:223] op_sel_hi:[1,0]
  v_pk_mul_f32 v[228:229], v[228:229], v[222:223] op_sel_hi:[1,0]
  v_pk_mul_f32 v[230:231], v[230:231], v[222:223] op_sel_hi:[1,0]
  v_cvt_pk_bf16_f32 v72, v224, v225
  v_cvt_pk_bf16_f32 v73, v226, v227
  v_cvt_pk_bf16_f32 v74, v228, v229
  v_cvt_pk_bf16_f32 v75, v230, v231
  ds_write_b128 v59, v[72:75] offset:2048
  v_lshlrev_b32 v232, 16, v76
  v_and_b32 v233, 0xffff0000, v76
  v_lshlrev_b32 v234, 16, v77
  v_and_b32 v235, 0xffff0000, v77
  v_lshlrev_b32 v236, 16, v78
  v_and_b32 v237, 0xffff0000, v78
  v_lshlrev_b32 v238, 16, v79
  v_and_b32 v239, 0xffff0000, v79
  v_pk_mul_f32 v[232:233], v[232:233], v[218:219] op_sel_hi:[1,0]
  v_pk_mul_f32 v[234:235], v[234:235], v[218:219] op_sel_hi:[1,0]
  v_pk_mul_f32 v[236:237], v[236:237], v[218:219] op_sel_hi:[1,0]
  v_pk_mul_f32 v[238:239], v[238:239], v[218:219] op_sel_hi:[1,0]
  v_cvt_pk_bf16_f32 v76, v232, v233
  v_cvt_pk_bf16_f32 v77, v234, v235
  v_cvt_pk_bf16_f32 v78, v236, v237
  v_cvt_pk_bf16_f32 v79, v238, v239
  ds_write_b128 v59, v[76:79] offset:3072
  v_lshlrev_b32 v224, 16, v80
  v_and_b32 v225, 0xffff0000, v80
  v_lshlrev_b32 v226, 16, v81
  v_and_b32 v227, 0xffff0000, v81
  v_lshlrev_b32 v228, 16, v82
  v_and_b32 v229, 0xffff0000, v82
  v_lshlrev_b32 v230, 16, v83
  v_and_b32 v231, 0xffff0000, v83
  v_pk_mul_f32 v[224:225], v[224:225], v[220:221] op_sel_hi:[1,0]
  v_pk_mul_f32 v[226:227], v[226:227], v[220:221] op_sel_hi:[1,0]
  v_pk_mul_f32 v[228:229], v[228:229], v[220:221] op_sel_hi:[1,0]
  v_pk_mul_f32 v[230:231], v[230:231], v[220:221] op_sel_hi:[1,0]
  v_cvt_pk_bf16_f32 v80, v224, v225
  v_cvt_pk_bf16_f32 v81, v226, v227
  v_cvt_pk_bf16_f32 v82, v228, v229
  v_cvt_pk_bf16_f32 v83, v230, v231
  ds_write_b128 v59, v[80:83] offset:4096
  v_lshlrev_b32 v232, 16, v84
  v_and_b32 v233, 0xffff0000, v84
  v_lshlrev_b32 v234, 16, v85
  v_and_b32 v235, 0xffff0000, v85
  v_lshlrev_b32 v236, 16, v86
  v_and_b32 v237, 0xffff0000, v86
  v_lshlrev_b32 v238, 16, v87
  v_and_b32 v239, 0xffff0000, v87
  v_pk_mul_f32 v[232:233], v[232:233], v[222:223] op_sel_hi:[1,0]
  v_pk_mul_f32 v[234:235], v[234:235], v[222:223] op_sel_hi:[1,0]
  v_pk_mul_f32 v[236:237], v[236:237], v[222:223] op_sel_hi:[1,0]
  v_pk_mul_f32 v[238:239], v[238:239], v[222:223] op_sel_hi:[1,0]
  v_cvt_pk_bf16_f32 v84, v232, v233
  v_cvt_pk_bf16_f32 v85, v234, v235
  v_cvt_pk_bf16_f32 v86, v236, v237
  v_cvt_pk_bf16_f32 v87, v238, v239
  ds_write_b128 v59, v[84:87] offset:5120
  s_waitcnt lgkmcnt(15)
  v_lshlrev_b32 v224, 16, v88
  v_and_b32 v225, 0xffff0000, v88
  v_lshlrev_b32 v226, 16, v89
  v_and_b32 v227, 0xffff0000, v89
  v_lshlrev_b32 v228, 16, v90
  v_and_b32 v229, 0xffff0000, v90
  v_lshlrev_b32 v230, 16, v91
  v_and_b32 v231, 0xffff0000, v91
  v_pk_mul_f32 v[224:225], v[224:225], v[218:219] op_sel_hi:[1,0]
  v_pk_mul_f32 v[226:227], v[226:227], v[218:219] op_sel_hi:[1,0]
  v_pk_mul_f32 v[228:229], v[228:229], v[218:219] op_sel_hi:[1,0]
  v_pk_mul_f32 v[230:231], v[230:231], v[218:219] op_sel_hi:[1,0]
  v_cvt_pk_bf16_f32 v88, v224, v225
  v_cvt_pk_bf16_f32 v89, v226, v227
  v_cvt_pk_bf16_f32 v90, v228, v229
  v_cvt_pk_bf16_f32 v91, v230, v231
  ds_write_b128 v59, v[88:91] offset:6144
  v_lshlrev_b32 v232, 16, v92
  v_and_b32 v233, 0xffff0000, v92
  v_lshlrev_b32 v234, 16, v93
  v_and_b32 v235, 0xffff0000, v93
  v_lshlrev_b32 v236, 16, v94
  v_and_b32 v237, 0xffff0000, v94
  v_lshlrev_b32 v238, 16, v95
  v_and_b32 v239, 0xffff0000, v95
  v_pk_mul_f32 v[232:233], v[232:233], v[220:221] op_sel_hi:[1,0]
  v_pk_mul_f32 v[234:235], v[234:235], v[220:221] op_sel_hi:[1,0]
  v_pk_mul_f32 v[236:237], v[236:237], v[220:221] op_sel_hi:[1,0]
  v_pk_mul_f32 v[238:239], v[238:239], v[220:221] op_sel_hi:[1,0]
  v_cvt_pk_bf16_f32 v92, v232, v233
  v_cvt_pk_bf16_f32 v93, v234, v235
  v_cvt_pk_bf16_f32 v94, v236, v237
  v_cvt_pk_bf16_f32 v95, v238, v239
  ds_write_b128 v59, v[92:95] offset:7168
  v_lshlrev_b32 v224, 16, v96
  v_and_b32 v225, 0xffff0000, v96
  v_lshlrev_b32 v226, 16, v97
  v_and_b32 v227, 0xffff0000, v97
  v_lshlrev_b32 v228, 16, v98
  v_and_b32 v229, 0xffff0000, v98
  v_lshlrev_b32 v230, 16, v99
  v_and_b32 v231, 0xffff0000, v99
  v_pk_mul_f32 v[224:225], v[224:225], v[222:223] op_sel_hi:[1,0]
  v_pk_mul_f32 v[226:227], v[226:227], v[222:223] op_sel_hi:[1,0]
  v_pk_mul_f32 v[228:229], v[228:229], v[222:223] op_sel_hi:[1,0]
  v_pk_mul_f32 v[230:231], v[230:231], v[222:223] op_sel_hi:[1,0]
  v_cvt_pk_bf16_f32 v96, v224, v225
  v_cvt_pk_bf16_f32 v97, v226, v227
  v_cvt_pk_bf16_f32 v98, v228, v229
  v_cvt_pk_bf16_f32 v99, v230, v231
  ds_write_b128 v59, v[96:99] offset:8192
  v_lshlrev_b32 v232, 16, v100
  v_and_b32 v233, 0xffff0000, v100
  v_lshlrev_b32 v234, 16, v101
  v_and_b32 v235, 0xffff0000, v101
  v_lshlrev_b32 v236, 16, v102
  v_and_b32 v237, 0xffff0000, v102
  v_lshlrev_b32 v238, 16, v103
  v_and_b32 v239, 0xffff0000, v103
  v_pk_mul_f32 v[232:233], v[232:233], v[218:219] op_sel_hi:[1,0]
  v_pk_mul_f32 v[234:235], v[234:235], v[218:219] op_sel_hi:[1,0]
  v_pk_mul_f32 v[236:237], v[236:237], v[218:219] op_sel_hi:[1,0]
  v_pk_mul_f32 v[238:239], v[238:239], v[218:219] op_sel_hi:[1,0]
  v_cvt_pk_bf16_f32 v100, v232, v233
  v_cvt_pk_bf16_f32 v101, v234, v235
  v_cvt_pk_bf16_f32 v102, v236, v237
  v_cvt_pk_bf16_f32 v103, v238, v239
  ds_write_b128 v59, v[100:103] offset:9216
  v_lshlrev_b32 v224, 16, v104
  v_and_b32 v225, 0xffff0000, v104
  v_lshlrev_b32 v226, 16, v105
  v_and_b32 v227, 0xffff0000, v105
  v_lshlrev_b32 v228, 16, v106
  v_and_b32 v229, 0xffff0000, v106
  v_lshlrev_b32 v230, 16, v107
  v_and_b32 v231, 0xffff0000, v107
  v_pk_mul_f32 v[224:225], v[224:225], v[220:221] op_sel_hi:[1,0]
  v_pk_mul_f32 v[226:227], v[226:227], v[220:221] op_sel_hi:[1,0]
  v_pk_mul_f32 v[228:229], v[228:229], v[220:221] op_sel_hi:[1,0]
  v_pk_mul_f32 v[230:231], v[230:231], v[220:221] op_sel_hi:[1,0]
  v_cvt_pk_bf16_f32 v104, v224, v225
  v_cvt_pk_bf16_f32 v105, v226, v227
  v_cvt_pk_bf16_f32 v106, v228, v229
  v_cvt_pk_bf16_f32 v107, v230, v231
  ds_write_b128 v59, v[104:107] offset:10240
  v_lshlrev_b32 v232, 16, v108
  v_and_b32 v233, 0xffff0000, v108
  v_lshlrev_b32 v234, 16, v109
  v_and_b32 v235, 0xffff0000, v109
  v_lshlrev_b32 v236, 16, v110
  v_and_b32 v237, 0xffff0000, v110
  v_lshlrev_b32 v238, 16, v111
  v_and_b32 v239, 0xffff0000, v111
  v_pk_mul_f32 v[232:233], v[232:233], v[222:223] op_sel_hi:[1,0]
  v_pk_mul_f32 v[234:235], v[234:235], v[222:223] op_sel_hi:[1,0]
  v_pk_mul_f32 v[236:237], v[236:237], v[222:223] op_sel_hi:[1,0]
  v_pk_mul_f32 v[238:239], v[238:239], v[222:223] op_sel_hi:[1,0]
  v_cvt_pk_bf16_f32 v108, v232, v233
  v_cvt_pk_bf16_f32 v109, v234, v235
  v_cvt_pk_bf16_f32 v110, v236, v237
  v_cvt_pk_bf16_f32 v111, v238, v239
  ds_write_b128 v59, v[108:111] offset:11264
  s_waitcnt lgkmcnt(12)
  v_lshlrev_b32 v224, 16, v160
  v_and_b32 v225, 0xffff0000, v160
  v_lshlrev_b32 v226, 16, v161
  v_and_b32 v227, 0xffff0000, v161
  v_lshlrev_b32 v228, 16, v162
  v_and_b32 v229, 0xffff0000, v162
  v_lshlrev_b32 v230, 16, v163
  v_and_b32 v231, 0xffff0000, v163
  v_pk_mul_f32 v[224:225], v[224:225], v[218:219] op_sel_hi:[1,0]
  v_pk_mul_f32 v[226:227], v[226:227], v[218:219] op_sel_hi:[1,0]
  v_pk_mul_f32 v[228:229], v[228:229], v[218:219] op_sel_hi:[1,0]
  v_pk_mul_f32 v[230:231], v[230:231], v[218:219] op_sel_hi:[1,0]
  v_cvt_pk_bf16_f32 v160, v224, v225
  v_cvt_pk_bf16_f32 v161, v226, v227
  v_cvt_pk_bf16_f32 v162, v228, v229
  v_cvt_pk_bf16_f32 v163, v230, v231
  ds_write_b128 v59, v[160:163] offset:12288
  v_lshlrev_b32 v232, 16, v164
  v_and_b32 v233, 0xffff0000, v164
  v_lshlrev_b32 v234, 16, v165
  v_and_b32 v235, 0xffff0000, v165
  v_lshlrev_b32 v236, 16, v166
  v_and_b32 v237, 0xffff0000, v166
  v_lshlrev_b32 v238, 16, v167
  v_and_b32 v239, 0xffff0000, v167
  v_pk_mul_f32 v[232:233], v[232:233], v[220:221] op_sel_hi:[1,0]
  v_pk_mul_f32 v[234:235], v[234:235], v[220:221] op_sel_hi:[1,0]
  v_pk_mul_f32 v[236:237], v[236:237], v[220:221] op_sel_hi:[1,0]
  v_pk_mul_f32 v[238:239], v[238:239], v[220:221] op_sel_hi:[1,0]
  v_cvt_pk_bf16_f32 v164, v232, v233
  v_cvt_pk_bf16_f32 v165, v234, v235
  v_cvt_pk_bf16_f32 v166, v236, v237
  v_cvt_pk_bf16_f32 v167, v238, v239
  ds_write_b128 v59, v[164:167] offset:13312
  v_lshlrev_b32 v224, 16, v168
  v_and_b32 v225, 0xffff0000, v168
  v_lshlrev_b32 v226, 16, v169
  v_and_b32 v227, 0xffff0000, v169
  v_lshlrev_b32 v228, 16, v170
  v_and_b32 v229, 0xffff0000, v170
  v_lshlrev_b32 v230, 16, v171
  v_and_b32 v231, 0xffff0000, v171
  v_pk_mul_f32 v[224:225], v[224:225], v[222:223] op_sel_hi:[1,0]
  v_pk_mul_f32 v[226:227], v[226:227], v[222:223] op_sel_hi:[1,0]
  v_pk_mul_f32 v[228:229], v[228:229], v[222:223] op_sel_hi:[1,0]
  v_pk_mul_f32 v[230:231], v[230:231], v[222:223] op_sel_hi:[1,0]
  v_cvt_pk_bf16_f32 v168, v224, v225
  v_cvt_pk_bf16_f32 v169, v226, v227
  v_cvt_pk_bf16_f32 v170, v228, v229
  v_cvt_pk_bf16_f32 v171, v230, v231
  ds_write_b128 v59, v[168:171] offset:14336
  v_lshlrev_b32 v232, 16, v172
  v_and_b32 v233, 0xffff0000, v172
  v_lshlrev_b32 v234, 16, v173
  v_and_b32 v235, 0xffff0000, v173
  v_lshlrev_b32 v236, 16, v174
  v_and_b32 v237, 0xffff0000, v174
  v_lshlrev_b32 v238, 16, v175
  v_and_b32 v239, 0xffff0000, v175
  v_pk_mul_f32 v[232:233], v[232:233], v[218:219] op_sel_hi:[1,0]
  v_pk_mul_f32 v[234:235], v[234:235], v[218:219] op_sel_hi:[1,0]
  v_pk_mul_f32 v[236:237], v[236:237], v[218:219] op_sel_hi:[1,0]
  v_pk_mul_f32 v[238:239], v[238:239], v[218:219] op_sel_hi:[1,0]
  v_cvt_pk_bf16_f32 v172, v232, v233
  v_cvt_pk_bf16_f32 v173, v234, v235
  v_cvt_pk_bf16_f32 v174, v236, v237
  v_cvt_pk_bf16_f32 v175, v238, v239
  ds_write_b128 v59, v[172:175] offset:15360
  v_lshlrev_b32 v224, 16, v176
  v_and_b32 v225, 0xffff0000, v176
  v_lshlrev_b32 v226, 16, v177
  v_and_b32 v227, 0xffff0000, v177
  v_lshlrev_b32 v228, 16, v178
  v_and_b32 v229, 0xffff0000, v178
  v_lshlrev_b32 v230, 16, v179
  v_and_b32 v231, 0xffff0000, v179
  v_pk_mul_f32 v[224:225], v[224:225], v[220:221] op_sel_hi:[1,0]
  v_pk_mul_f32 v[226:227], v[226:227], v[220:221] op_sel_hi:[1,0]
  v_pk_mul_f32 v[228:229], v[228:229], v[220:221] op_sel_hi:[1,0]
  v_pk_mul_f32 v[230:231], v[230:231], v[220:221] op_sel_hi:[1,0]
  v_cvt_pk_bf16_f32 v176, v224, v225
  v_cvt_pk_bf16_f32 v177, v226, v227
  v_cvt_pk_bf16_f32 v178, v228, v229
  v_cvt_pk_bf16_f32 v179, v230, v231
  ds_write_b128 v59, v[176:179] offset:16384
  v_lshlrev_b32 v232, 16, v180
  v_and_b32 v233, 0xffff0000, v180
  v_lshlrev_b32 v234, 16, v181
  v_and_b32 v235, 0xffff0000, v181
  v_lshlrev_b32 v236, 16, v182
  v_and_b32 v237, 0xffff0000, v182
  v_lshlrev_b32 v238, 16, v183
  v_and_b32 v239, 0xffff0000, v183
  v_pk_mul_f32 v[232:233], v[232:233], v[222:223] op_sel_hi:[1,0]
  v_pk_mul_f32 v[234:235], v[234:235], v[222:223] op_sel_hi:[1,0]
  v_pk_mul_f32 v[236:237], v[236:237], v[222:223] op_sel_hi:[1,0]
  v_pk_mul_f32 v[238:239], v[238:239], v[222:223] op_sel_hi:[1,0]
  v_cvt_pk_bf16_f32 v180, v232, v233
  v_cvt_pk_bf16_f32 v181, v234, v235
  v_cvt_pk_bf16_f32 v182, v236, v237
  v_cvt_pk_bf16_f32 v183, v238, v239
  ds_write_b128 v59, v[180:183] offset:17408
  v_lshlrev_b32 v60, 7, v57
  v_lshl_add_u32 v60, v22, 5, v60
  v_lshl_add_u32 v60, v25, 3, v60
  v_lshl_add_u32 v60, v21, 6, v60
  v_xor_b32 v61, 64, v60
  v_add_u32 v62, 0x9000, v60
  v_add_u32 v63, 0x9000, v61
  s_mul_i32 s32, s27, 0x3000
  v_add_u32 v184, s32, v60
  v_add_u32 v185, s32, v61
  s_waitcnt vmcnt(0)
  s_waitcnt lgkmcnt(0)
  s_barrier
  ds_read_b64_tr_b16 v[192:193], v184 offset:34816
  ds_read_b64_tr_b16 v[194:195], v184 offset:35840
  ds_read_b64_tr_b16 v[196:197], v185 offset:34816
  ds_read_b64_tr_b16 v[198:199], v185 offset:35840
  ds_read_b64_tr_b16 a[0:1], v60
  ds_read_b64_tr_b16 a[2:3], v60 offset:1024
  ds_read_b64_tr_b16 a[4:5], v60 offset:2048
  ds_read_b64_tr_b16 a[6:7], v60 offset:3072
  ds_read_b64_tr_b16 a[8:9], v60 offset:4096
  ds_read_b64_tr_b16 a[10:11], v60 offset:5120
  ds_read_b64_tr_b16 a[12:13], v60 offset:6144
  ds_read_b64_tr_b16 a[14:15], v60 offset:7168
  ds_read_b64_tr_b16 a[16:17], v60 offset:8192
  ds_read_b64_tr_b16 a[18:19], v60 offset:9216
  ds_read_b64_tr_b16 a[20:21], v60 offset:10240
  ds_read_b64_tr_b16 a[22:23], v60 offset:11264
  ds_read_b64_tr_b16 a[24:25], v61
  ds_read_b64_tr_b16 a[26:27], v61 offset:1024
  ds_read_b64_tr_b16 a[28:29], v61 offset:2048
  ds_read_b64_tr_b16 a[30:31], v61 offset:3072
  ds_read_b64_tr_b16 a[32:33], v61 offset:4096
  ds_read_b64_tr_b16 a[34:35], v61 offset:5120
  ds_read_b64_tr_b16 a[36:37], v61 offset:6144
  ds_read_b64_tr_b16 a[38:39], v61 offset:7168
  ds_read_b64_tr_b16 a[40:41], v61 offset:8192
  ds_read_b64_tr_b16 a[42:43], v61 offset:9216
  ds_read_b64_tr_b16 a[44:45], v61 offset:10240
  ds_read_b64_tr_b16 a[46:47], v61 offset:11264
  ds_read_b64_tr_b16 a[48:49], v60 offset:12288
  ds_read_b64_tr_b16 a[50:51], v60 offset:13312
  ds_read_b64_tr_b16 a[52:53], v60 offset:14336
  ds_read_b64_tr_b16 a[54:55], v60 offset:15360
  ds_read_b64_tr_b16 a[56:57], v60 offset:16384
  ds_read_b64_tr_b16 a[58:59], v60 offset:17408
  ds_read_b64_tr_b16 a[60:61], v60 offset:18432
  ds_read_b64_tr_b16 a[62:63], v60 offset:19456
  ds_read_b64_tr_b16 a[64:65], v60 offset:20480
  ds_read_b64_tr_b16 a[66:67], v60 offset:21504
  ds_read_b64_tr_b16 a[68:69], v60 offset:22528
  ds_read_b64_tr_b16 a[70:71], v60 offset:23552
  ds_read_b64_tr_b16 a[72:73], v61 offset:12288
  ds_read_b64_tr_b16 a[74:75], v61 offset:13312
  ds_read_b64_tr_b16 a[76:77], v61 offset:14336
  ds_read_b64_tr_b16 a[78:79], v61 offset:15360
  ds_read_b64_tr_b16 a[80:81], v61 offset:16384
  ds_read_b64_tr_b16 a[82:83], v61 offset:17408
  ds_read_b64_tr_b16 a[84:85], v61 offset:18432
  ds_read_b64_tr_b16 a[86:87], v61 offset:19456
  ds_read_b64_tr_b16 a[88:89], v61 offset:20480
  ds_read_b64_tr_b16 a[90:91], v61 offset:21504
  ds_read_b64_tr_b16 a[92:93], v61 offset:22528
  ds_read_b64_tr_b16 a[94:95], v61 offset:23552
  ds_read_b64_tr_b16 a[96:97], v60 offset:24576
  ds_read_b64_tr_b16 a[98:99], v60 offset:25600
  ds_read_b64_tr_b16 a[100:101], v60 offset:26624
  ds_read_b64_tr_b16 a[102:103], v60 offset:27648
  ds_read_b64_tr_b16 a[104:105], v60 offset:28672
  ds_read_b64_tr_b16 a[106:107], v60 offset:29696
  ds_read_b64_tr_b16 a[108:109], v60 offset:30720
  ds_read_b64_tr_b16 a[110:111], v60 offset:31744
  ds_read_b64_tr_b16 a[112:113], v60 offset:32768
  ds_read_b64_tr_b16 a[114:115], v60 offset:33792
  ds_read_b64_tr_b16 a[116:117], v61 offset:24576
  ds_read_b64_tr_b16 a[118:119], v61 offset:25600
  ds_read_b64_tr_b16 a[120:121], v61 offset:26624
  ds_read_b64_tr_b16 a[122:123], v61 offset:27648
  ds_read_b64_tr_b16 a[124:125], v61 offset:28672
  ds_read_b64_tr_b16 a[126:127], v61 offset:29696
  ds_read_b64_tr_b16 a[128:129], v61 offset:30720
  ds_read_b64_tr_b16 a[130:131], v61 offset:31744
  ds_read_b64_tr_b16 a[132:133], v61 offset:32768
  ds_read_b64_tr_b16 a[134:135], v61 offset:33792
  ds_read_b64_tr_b16 a[136:137], v62
  ds_read_b64_tr_b16 a[138:139], v62 offset:1024
  ds_read_b64_tr_b16 a[140:141], v62 offset:2048
  ds_read_b64_tr_b16 a[142:143], v62 offset:3072
  ds_read_b64_tr_b16 a[144:145], v62 offset:4096
  ds_read_b64_tr_b16 a[146:147], v62 offset:5120
  ds_read_b64_tr_b16 a[148:149], v62 offset:6144
  ds_read_b64_tr_b16 a[150:151], v62 offset:7168
  ds_read_b64_tr_b16 a[152:153], v62 offset:8192
  ds_read_b64_tr_b16 a[154:155], v62 offset:9216
  ds_read_b64_tr_b16 a[156:157], v63
  ds_read_b64_tr_b16 a[158:159], v63 offset:1024
  ds_read_b64_tr_b16 a[160:161], v63 offset:2048
  ds_read_b64_tr_b16 a[162:163], v63 offset:3072
  ds_read_b64_tr_b16 a[164:165], v63 offset:4096
  ds_read_b64_tr_b16 a[166:167], v63 offset:5120
  ds_read_b64_tr_b16 a[168:169], v63 offset:6144
  ds_read_b64_tr_b16 a[170:171], v63 offset:7168
  ds_read_b64_tr_b16 a[172:173], v63 offset:8192
  ds_read_b64_tr_b16 a[174:175], v63 offset:9216
  ds_read_b64_tr_b16 a[176:177], v62 offset:12288
  ds_read_b64_tr_b16 a[178:179], v62 offset:13312
  ds_read_b64_tr_b16 a[180:181], v62 offset:14336
  ds_read_b64_tr_b16 a[182:183], v62 offset:15360
  ds_read_b64_tr_b16 a[184:185], v62 offset:16384
  ds_read_b64_tr_b16 a[186:187], v62 offset:17408
  ds_read_b64_tr_b16 a[188:189], v62 offset:18432
  ds_read_b64_tr_b16 a[190:191], v62 offset:19456
  ds_read_b64_tr_b16 a[192:193], v62 offset:20480
  ds_read_b64_tr_b16 a[194:195], v62 offset:21504
  ds_read_b64_tr_b16 a[196:197], v63 offset:12288
  ds_read_b64_tr_b16 a[198:199], v63 offset:13312
  ds_read_b64_tr_b16 a[200:201], v63 offset:14336
  ds_read_b64_tr_b16 a[202:203], v63 offset:15360
  ds_read_b64_tr_b16 a[204:205], v63 offset:16384
  ds_read_b64_tr_b16 a[206:207], v63 offset:17408
  ds_read_b64_tr_b16 a[208:209], v63 offset:18432
  ds_read_b64_tr_b16 a[210:211], v63 offset:19456
  ds_read_b64_tr_b16 a[212:213], v63 offset:20480
  ds_read_b64_tr_b16 a[214:215], v63 offset:21504
  ds_read_b64_tr_b16 a[216:217], v62 offset:24576
  ds_read_b64_tr_b16 a[218:219], v62 offset:25600
  ds_read_b64_tr_b16 a[220:221], v62 offset:26624
  ds_read_b64_tr_b16 a[222:223], v62 offset:27648
  ds_read_b64_tr_b16 a[224:225], v62 offset:28672
  ds_read_b64_tr_b16 a[226:227], v62 offset:29696
  ds_read_b64_tr_b16 a[228:229], v62 offset:30720
  ds_read_b64_tr_b16 a[230:231], v62 offset:31744
  ds_read_b64_tr_b16 a[232:233], v62 offset:32768
  ds_read_b64_tr_b16 a[234:235], v62 offset:33792
  ds_read_b64_tr_b16 a[236:237], v63 offset:24576
  ds_read_b64_tr_b16 a[238:239], v63 offset:25600
  ds_read_b64_tr_b16 a[240:241], v63 offset:26624
  ds_read_b64_tr_b16 a[242:243], v63 offset:27648
  ds_read_b64_tr_b16 a[244:245], v63 offset:28672
  ds_read_b64_tr_b16 a[246:247], v63 offset:29696
  ds_read_b64_tr_b16 a[248:249], v63 offset:30720
  ds_read_b64_tr_b16 a[250:251], v63 offset:31744
  ds_read_b64_tr_b16 a[252:253], v63 offset:32768
  ds_read_b64_tr_b16 a[254:255], v63 offset:33792
  v_add_u32 v0, 0xc300, v19
  v_add_u32 v1, 0x18000, v19
  s_lshl_b32 s32, s27, 11
  v_add_u32 v186, s32, v0
  v_add_u32 v187, s58, v19
  s_waitcnt lgkmcnt(0)
  s_barrier
  ds_write_b128 v186, v[192:195]
  ds_write_b128 v186, v[196:199] offset:1024
  ds_write_b128 v187, v[112:115]
  ds_write_b128 v187, v[116:119] offset:1024
  ds_write_b128 v187, v[120:123] offset:2048
  ds_write_b128 v187, v[124:127] offset:3072
  ds_write_b128 v187, v[128:131] offset:16672
  ds_write_b128 v187, v[132:135] offset:17696
  ds_write_b128 v187, v[136:139] offset:18720
  ds_write_b128 v187, v[140:143] offset:19744
  ds_write_b128 v187, v[144:147] offset:33280
  ds_write_b128 v187, v[148:151] offset:34304
  ds_write_b128 v187, v[152:155] offset:35328
  ds_write_b128 v187, v[156:159] offset:36352
  s_add_u32 s30, s58, 32
  s_add_u32 s31, s58, 0x4100
  s_add_u32 s33, s58, 0x8200
  s_mul_i32 s34, s54, 0x18000
  s_mov_b32 s28, 0x80000000
  ds_read_b128 v[216:219], v3
  ds_read_b128 v[220:223], v4
  ds_read_b128 v[224:227], v3 offset:4800
  ds_read_b128 v[228:231], v4 offset:192
  ds_read_b128 v[232:235], v3 offset:9600
  ds_read_b128 v[236:239], v4 offset:384
  s_waitcnt lgkmcnt(4)
  v_mfma_f32_16x16x32_bf16 v[112:115], v[216:219], v[220:223], 0
  ds_read_b128 v[216:219], v3 offset:400
  ds_read_b128 v[220:223], v4 offset:16
  s_waitcnt lgkmcnt(4)
  v_mfma_f32_16x16x32_bf16 v[112:115], v[224:227], v[228:231], v[112:115]
  ds_read_b128 v[224:227], v3 offset:5200
  ds_read_b128 v[228:231], v4 offset:208
  s_waitcnt lgkmcnt(4)
  v_mfma_f32_16x16x32_bf16 v[112:115], v[232:235], v[236:239], v[112:115]
  ds_read_b128 v[232:235], v3 offset:10000
  ds_read_b128 v[236:239], v4 offset:400
  s_waitcnt lgkmcnt(4)
  v_mfma_f32_16x16x32_bf16 v[116:119], v[216:219], v[220:223], 0
  ds_read_b128 v[216:219], v3 offset:800
  ds_read_b128 v[220:223], v4 offset:32
  s_waitcnt lgkmcnt(4)
  v_mfma_f32_16x16x32_bf16 v[116:119], v[224:227], v[228:231], v[116:119]
  ds_read_b128 v[224:227], v3 offset:5600
  ds_read_b128 v[228:231], v4 offset:224
  s_waitcnt lgkmcnt(4)
  v_mfma_f32_16x16x32_bf16 v[116:119], v[232:235], v[236:239], v[116:119]
  ds_read_b128 v[232:235], v3 offset:10400
  ds_read_b128 v[236:239], v4 offset:416
  s_waitcnt lgkmcnt(4)
  v_mfma_f32_16x16x32_bf16 v[120:123], v[216:219], v[220:223], 0
  ds_read_b128 v[216:219], v3 offset:1200
  ds_read_b128 v[220:223], v4 offset:48
  s_waitcnt lgkmcnt(4)
  v_mfma_f32_16x16x32_bf16 v[120:123], v[224:227], v[228:231], v[120:123]
  ds_read_b128 v[224:227], v3 offset:6000
  ds_read_b128 v[228:231], v4 offset:240
  s_waitcnt lgkmcnt(4)
  v_mfma_f32_16x16x32_bf16 v[120:123], v[232:235], v[236:239], v[120:123]
  ds_read_b128 v[232:235], v3 offset:10800
  ds_read_b128 v[236:239], v4 offset:432
  s_waitcnt lgkmcnt(4)
  v_mfma_f32_16x16x32_bf16 v[124:127], v[216:219], v[220:223], 0
  ds_read_b128 v[216:219], v3 offset:1600
  ds_read_b128 v[220:223], v4 offset:64
  s_waitcnt lgkmcnt(4)
  v_mfma_f32_16x16x32_bf16 v[124:127], v[224:227], v[228:231], v[124:127]
  ds_read_b128 v[224:227], v3 offset:6400
  ds_read_b128 v[228:231], v4 offset:256
  s_waitcnt lgkmcnt(4)
  v_mfma_f32_16x16x32_bf16 v[124:127], v[232:235], v[236:239], v[124:127]
  ds_read_b128 v[232:235], v3 offset:11200
  ds_read_b128 v[236:239], v4 offset:448
  s_waitcnt lgkmcnt(4)
  v_mfma_f32_16x16x32_bf16 v[128:131], v[216:219], v[220:223], 0
  ds_read_b128 v[216:219], v3 offset:2000
  ds_read_b128 v[220:223], v4 offset:80
  s_waitcnt lgkmcnt(4)
  v_mfma_f32_16x16x32_bf16 v[128:131], v[224:227], v[228:231], v[128:131]
  ds_read_b128 v[224:227], v3 offset:6800
  ds_read_b128 v[228:231], v4 offset:272
  s_waitcnt lgkmcnt(4)
  v_mfma_f32_16x16x32_bf16 v[128:131], v[232:235], v[236:239], v[128:131]
  ds_read_b128 v[232:235], v3 offset:11600
  ds_read_b128 v[236:239], v4 offset:464
  s_waitcnt lgkmcnt(4)
  v_mfma_f32_16x16x32_bf16 v[132:135], v[216:219], v[220:223], 0
  ds_read_b128 v[216:219], v3 offset:2400
  ds_read_b128 v[220:223], v4 offset:96
  s_waitcnt lgkmcnt(4)
  v_mfma_f32_16x16x32_bf16 v[132:135], v[224:227], v[228:231], v[132:135]
  ds_read_b128 v[224:227], v3 offset:7200
  ds_read_b128 v[228:231], v4 offset:288
  s_waitcnt lgkmcnt(4)
  v_mfma_f32_16x16x32_bf16 v[132:135], v[232:235], v[236:239], v[132:135]
  ds_read_b128 v[232:235], v3 offset:12000
  ds_read_b128 v[236:239], v4 offset:480
  s_waitcnt lgkmcnt(4)
  v_mfma_f32_16x16x32_bf16 v[136:139], v[216:219], v[220:223], 0
  ds_read_b128 v[216:219], v3 offset:2800
  ds_read_b128 v[220:223], v4 offset:112
  s_waitcnt lgkmcnt(4)
  v_mfma_f32_16x16x32_bf16 v[136:139], v[224:227], v[228:231], v[136:139]
  ds_read_b128 v[224:227], v3 offset:7600
  ds_read_b128 v[228:231], v4 offset:304
  s_waitcnt lgkmcnt(4)
  v_mfma_f32_16x16x32_bf16 v[136:139], v[232:235], v[236:239], v[136:139]
  ds_read_b128 v[232:235], v3 offset:12400
  ds_read_b128 v[236:239], v4 offset:496
  s_waitcnt lgkmcnt(4)
  v_mfma_f32_16x16x32_bf16 v[140:143], v[216:219], v[220:223], 0
  ds_read_b128 v[216:219], v3 offset:3200
  ds_read_b128 v[220:223], v4 offset:128
  s_waitcnt lgkmcnt(4)
  v_mfma_f32_16x16x32_bf16 v[140:143], v[224:227], v[228:231], v[140:143]
  ds_read_b128 v[224:227], v3 offset:8000
  ds_read_b128 v[228:231], v4 offset:320
  s_waitcnt lgkmcnt(4)
  v_mfma_f32_16x16x32_bf16 v[140:143], v[232:235], v[236:239], v[140:143]
  ds_read_b128 v[232:235], v3 offset:12800
  ds_read_b128 v[236:239], v4 offset:512
  s_waitcnt lgkmcnt(4)
  v_mfma_f32_16x16x32_bf16 v[144:147], v[216:219], v[220:223], 0
  ds_read_b128 v[216:219], v3 offset:3600
  ds_read_b128 v[220:223], v4 offset:144
  s_waitcnt lgkmcnt(4)
  v_mfma_f32_16x16x32_bf16 v[144:147], v[224:227], v[228:231], v[144:147]
  ds_read_b128 v[224:227], v3 offset:8400
  ds_read_b128 v[228:231], v4 offset:336
  s_waitcnt lgkmcnt(4)
  v_mfma_f32_16x16x32_bf16 v[144:147], v[232:235], v[236:239], v[144:147]
  ds_read_b128 v[232:235], v3 offset:13200
  ds_read_b128 v[236:239], v4 offset:528
  s_waitcnt lgkmcnt(4)
  v_mfma_f32_16x16x32_bf16 v[148:151], v[216:219], v[220:223], 0
  ds_read_b128 v[216:219], v3 offset:4000
  ds_read_b128 v[220:223], v4 offset:160
  s_waitcnt lgkmcnt(4)
  v_mfma_f32_16x16x32_bf16 v[148:151], v[224:227], v[228:231], v[148:151]
  ds_read_b128 v[224:227], v3 offset:8800
  ds_read_b128 v[228:231], v4 offset:352
  s_waitcnt lgkmcnt(4)
  v_mfma_f32_16x16x32_bf16 v[148:151], v[232:235], v[236:239], v[148:151]
  ds_read_b128 v[232:235], v3 offset:13600
  ds_read_b128 v[236:239], v4 offset:544
  s_waitcnt lgkmcnt(4)
  v_mfma_f32_16x16x32_bf16 v[152:155], v[216:219], v[220:223], 0
  ds_read_b128 v[216:219], v3 offset:4400
  ds_read_b128 v[220:223], v4 offset:176
  s_waitcnt lgkmcnt(4)
  v_mfma_f32_16x16x32_bf16 v[152:155], v[224:227], v[228:231], v[152:155]
  ds_read_b128 v[224:227], v3 offset:9200
  ds_read_b128 v[228:231], v4 offset:368
  s_waitcnt lgkmcnt(4)
  v_mfma_f32_16x16x32_bf16 v[152:155], v[232:235], v[236:239], v[152:155]
  ds_read_b128 v[232:235], v3 offset:14000
  ds_read_b128 v[236:239], v4 offset:560
  s_waitcnt lgkmcnt(4)
  v_mfma_f32_16x16x32_bf16 v[156:159], v[216:219], v[220:223], 0
  s_waitcnt lgkmcnt(2)
  v_mfma_f32_16x16x32_bf16 v[156:159], v[224:227], v[228:231], v[156:159]
  s_waitcnt lgkmcnt(0)
  v_mfma_f32_16x16x32_bf16 v[156:159], v[232:235], v[236:239], v[156:159]
  ds_read_b128 v[16:19], v2
  ds_read_b128 v[20:23], v2 offset:32
  ds_read_b128 v[24:27], v2 offset:64
  ds_read_b128 v[28:31], v2 offset:96
  v_pk_add_f32 v[12:13], v[112:113], v[114:115]
  v_pk_mul_f32 v[14:15], v[112:113], v[112:113]
  v_pk_fma_f32 v[14:15], v[114:115], v[114:115], v[14:15]
  v_pk_add_f32 v[12:13], v[12:13], v[116:117]
  v_pk_fma_f32 v[14:15], v[116:117], v[116:117], v[14:15]
  v_pk_add_f32 v[12:13], v[12:13], v[118:119]
  v_pk_fma_f32 v[14:15], v[118:119], v[118:119], v[14:15]
  v_pk_add_f32 v[12:13], v[12:13], v[120:121]
  v_pk_fma_f32 v[14:15], v[120:121], v[120:121], v[14:15]
  v_pk_add_f32 v[12:13], v[12:13], v[122:123]
  v_pk_fma_f32 v[14:15], v[122:123], v[122:123], v[14:15]
  v_pk_add_f32 v[12:13], v[12:13], v[124:125]
  v_pk_fma_f32 v[14:15], v[124:125], v[124:125], v[14:15]
  v_pk_add_f32 v[12:13], v[12:13], v[126:127]
  v_pk_fma_f32 v[14:15], v[126:127], v[126:127], v[14:15]
  v_pk_add_f32 v[12:13], v[12:13], v[128:129]
  v_pk_fma_f32 v[14:15], v[128:129], v[128:129], v[14:15]
  v_pk_add_f32 v[12:13], v[12:13], v[130:131]
  v_pk_fma_f32 v[14:15], v[130:131], v[130:131], v[14:15]
  v_pk_add_f32 v[12:13], v[12:13], v[132:133]
  v_pk_fma_f32 v[14:15], v[132:133], v[132:133], v[14:15]
  v_pk_add_f32 v[12:13], v[12:13], v[134:135]
  v_pk_fma_f32 v[14:15], v[134:135], v[134:135], v[14:15]
  v_pk_add_f32 v[12:13], v[12:13], v[136:137]
  v_pk_fma_f32 v[14:15], v[136:137], v[136:137], v[14:15]
  v_pk_add_f32 v[12:13], v[12:13], v[138:139]
  v_pk_fma_f32 v[14:15], v[138:139], v[138:139], v[14:15]
  v_pk_add_f32 v[12:13], v[12:13], v[140:141]
  v_pk_fma_f32 v[14:15], v[140:141], v[140:141], v[14:15]
  v_pk_add_f32 v[12:13], v[12:13], v[142:143]
  v_pk_fma_f32 v[14:15], v[142:143], v[142:143], v[14:15]
  v_pk_add_f32 v[12:13], v[12:13], v[144:145]
  v_pk_fma_f32 v[14:15], v[144:145], v[144:145], v[14:15]
  v_pk_add_f32 v[12:13], v[12:13], v[146:147]
  v_pk_fma_f32 v[14:15], v[146:147], v[146:147], v[14:15]
  v_pk_add_f32 v[12:13], v[12:13], v[148:149]
  v_pk_fma_f32 v[14:15], v[148:149], v[148:149], v[14:15]
  v_pk_add_f32 v[12:13], v[12:13], v[150:151]
  v_pk_fma_f32 v[14:15], v[150:151], v[150:151], v[14:15]
  v_pk_add_f32 v[12:13], v[12:13], v[152:153]
  v_pk_fma_f32 v[14:15], v[152:153], v[152:153], v[14:15]
  v_pk_add_f32 v[12:13], v[12:13], v[154:155]
  v_pk_fma_f32 v[14:15], v[154:155], v[154:155], v[14:15]
  v_pk_add_f32 v[12:13], v[12:13], v[156:157]
  v_pk_fma_f32 v[14:15], v[156:157], v[156:157], v[14:15]
  v_pk_add_f32 v[12:13], v[12:13], v[158:159]
  v_pk_fma_f32 v[14:15], v[158:159], v[158:159], v[14:15]
  v_add_f32 v12, v12, v13
  v_add_f32 v14, v14, v15
  s_nop 1
  v_permlane32_swap_b32 v12, v14
  v_add_f32 v12, v12, v14
  v_mov_b32 v14, v12
  s_nop 1
  v_permlane32_swap_b32 v12, v14
  v_mul_f32 v12, s24, v12
  v_mul_f32 v13, s24, v14
  v_fma_f32 v13, -v12, v12, v13
  v_max_f32 v13, 0, v13
  v_add_f32 v13, s25, v13
  v_rsq_f32 v13, v13
  v_sub_f32 v12, 0, v12
  v_mul_f32 v14, s22, v13
  v_mul_f32 v12, v12, v14
  v_pk_fma_f32 v[112:113], v[112:113], v[14:15], v[12:13] op_sel_hi:[1,0,0]
  v_pk_fma_f32 v[114:115], v[114:115], v[14:15], v[12:13] op_sel_hi:[1,0,0]
  v_pk_fma_f32 v[116:117], v[116:117], v[14:15], v[12:13] op_sel_hi:[1,0,0]
  v_pk_fma_f32 v[118:119], v[118:119], v[14:15], v[12:13] op_sel_hi:[1,0,0]
  v_pk_fma_f32 v[120:121], v[120:121], v[14:15], v[12:13] op_sel_hi:[1,0,0]
  v_pk_fma_f32 v[122:123], v[122:123], v[14:15], v[12:13] op_sel_hi:[1,0,0]
  v_pk_fma_f32 v[124:125], v[124:125], v[14:15], v[12:13] op_sel_hi:[1,0,0]
  v_pk_fma_f32 v[126:127], v[126:127], v[14:15], v[12:13] op_sel_hi:[1,0,0]
  v_pk_fma_f32 v[128:129], v[128:129], v[14:15], v[12:13] op_sel_hi:[1,0,0]
  v_pk_fma_f32 v[130:131], v[130:131], v[14:15], v[12:13] op_sel_hi:[1,0,0]
  v_pk_fma_f32 v[132:133], v[132:133], v[14:15], v[12:13] op_sel_hi:[1,0,0]
  v_pk_fma_f32 v[134:135], v[134:135], v[14:15], v[12:13] op_sel_hi:[1,0,0]
  v_pk_fma_f32 v[136:137], v[136:137], v[14:15], v[12:13] op_sel_hi:[1,0,0]
  v_pk_fma_f32 v[138:139], v[138:139], v[14:15], v[12:13] op_sel_hi:[1,0,0]
  v_pk_fma_f32 v[140:141], v[140:141], v[14:15], v[12:13] op_sel_hi:[1,0,0]
  v_pk_fma_f32 v[142:143], v[142:143], v[14:15], v[12:13] op_sel_hi:[1,0,0]
  v_pk_fma_f32 v[144:145], v[144:145], v[14:15], v[12:13] op_sel_hi:[1,0,0]
  v_pk_fma_f32 v[146:147], v[146:147], v[14:15], v[12:13] op_sel_hi:[1,0,0]
  v_pk_fma_f32 v[148:149], v[148:149], v[14:15], v[12:13] op_sel_hi:[1,0,0]
  v_pk_fma_f32 v[150:151], v[150:151], v[14:15], v[12:13] op_sel_hi:[1,0,0]
  v_pk_fma_f32 v[152:153], v[152:153], v[14:15], v[12:13] op_sel_hi:[1,0,0]
  v_pk_fma_f32 v[154:155], v[154:155], v[14:15], v[12:13] op_sel_hi:[1,0,0]
  v_pk_fma_f32 v[156:157], v[156:157], v[14:15], v[12:13] op_sel_hi:[1,0,0]
  v_pk_fma_f32 v[158:159], v[158:159], v[14:15], v[12:13] op_sel_hi:[1,0,0]
  v_cvt_pk_bf16_f32 v160, v112, v113
  v_cvt_pk_bf16_f32 v161, v114, v115
  v_cvt_pk_bf16_f32 v162, v116, v117
  v_cvt_pk_bf16_f32 v163, v118, v119
  v_cvt_pk_bf16_f32 v164, v120, v121
  v_cvt_pk_bf16_f32 v165, v122, v123
  v_cvt_pk_bf16_f32 v166, v124, v125
  v_cvt_pk_bf16_f32 v167, v126, v127
  v_cvt_pk_bf16_f32 v168, v128, v129
  v_cvt_pk_bf16_f32 v169, v130, v131
  v_cvt_pk_bf16_f32 v170, v132, v133
  v_cvt_pk_bf16_f32 v171, v134, v135
  v_cvt_pk_bf16_f32 v172, v136, v137
  v_cvt_pk_bf16_f32 v173, v138, v139
  v_cvt_pk_bf16_f32 v174, v140, v141
  v_cvt_pk_bf16_f32 v175, v142, v143
  v_cvt_pk_bf16_f32 v176, v144, v145
  v_cvt_pk_bf16_f32 v177, v146, v147
  v_cvt_pk_bf16_f32 v178, v148, v149
  v_cvt_pk_bf16_f32 v179, v150, v151
  v_cvt_pk_bf16_f32 v180, v152, v153
  v_cvt_pk_bf16_f32 v181, v154, v155
  v_cvt_pk_bf16_f32 v182, v156, v157
  v_cvt_pk_bf16_f32 v183, v158, v159
  v_subrev_u32 v11, 0x4100, v4
  v_add_u32 v4, 0x8200, v4
  v_min_u32 v4, v11, v4
  s_waitcnt lgkmcnt(0)
  s_barrier
  s_mov_b32 s26, 8
  .p2align 6
L_loop:
  v_mfma_f32_32x32x16_bf16 v[16:31], a[0:3], v[160:163], v[16:31]
  ds_read_b128 v[192:195], v1 offset:59392
  ds_read_b128 v[196:199], v1 offset:60416
  v_rcp_f32 v48, v48
  v_rcp_f32 v49, v49
  v_mfma_f32_32x32x16_bf16 v[16:31], a[4:7], v[164:167], v[16:31]
  ds_read_b128 v[200:203], v1 offset:61440
  ds_read_b128 v[204:207], v1 offset:62464
  v_rcp_f32 v50, v50
  v_rcp_f32 v51, v51
  v_mfma_f32_32x32x16_bf16 v[16:31], a[8:11], v[168:171], v[16:31]
  ds_read_b128 v[208:211], v1 offset:63488
  ds_read_b128 v[212:215], v1 offset:64512
  v_rcp_f32 v52, v52
  v_rcp_f32 v53, v53
  v_mfma_f32_32x32x16_bf16 v[16:31], a[12:15], v[172:175], v[16:31]
  ds_read_b128 v[136:139], v5
  ds_read_b128 v[140:143], v5 offset:32
  ds_read_b128 v[144:147], v5 offset:64
  v_rcp_f32 v54, v54
  v_rcp_f32 v55, v55
  v_mfma_f32_32x32x16_bf16 v[16:31], a[16:19], v[176:179], v[16:31]
  ds_read_b128 v[148:151], v5 offset:96
  ds_read_b128 v[152:155], v5 offset:128
  ds_read_b128 v[156:159], v5 offset:160
  v_rcp_f32 v56, v56
  v_rcp_f32 v57, v57
  v_mfma_f32_32x32x16_bf16 v[16:31], a[20:23], v[180:183], v[16:31]
  s_waitcnt lgkmcnt(6)
  v_rcp_f32 v58, v58
  v_rcp_f32 v59, v59
  v_rcp_f32 v60, v60
  v_rcp_f32 v61, v61
  v_rcp_f32 v62, v62
  v_rcp_f32 v63, v63
  v_pk_mul_f32 v[32:33], v[32:33], v[48:49]
  v_pk_mul_f32 v[34:35], v[34:35], v[50:51]
  v_pk_mul_f32 v[36:37], v[36:37], v[52:53]
  v_pk_mul_f32 v[38:39], v[38:39], v[54:55]
  v_pk_mul_f32 v[40:41], v[40:41], v[56:57]
  v_pk_mul_f32 v[42:43], v[42:43], v[58:59]
  v_pk_mul_f32 v[44:45], v[44:45], v[60:61]
  v_pk_mul_f32 v[46:47], v[46:47], v[62:63]
  v_pk_fma_f32 v[48:49], v[16:17], v[16:17], s[20:21] neg_lo:[1,0,1] neg_hi:[1,0,1]
  v_pk_fma_f32 v[50:51], v[18:19], v[18:19], s[20:21] neg_lo:[1,0,1] neg_hi:[1,0,1]
  v_pk_fma_f32 v[52:53], v[20:21], v[20:21], s[20:21] neg_lo:[1,0,1] neg_hi:[1,0,1]
  v_pk_fma_f32 v[54:55], v[22:23], v[22:23], s[20:21] neg_lo:[1,0,1] neg_hi:[1,0,1]
  v_pk_fma_f32 v[56:57], v[24:25], v[24:25], s[20:21] neg_lo:[1,0,1] neg_hi:[1,0,1]
  v_pk_fma_f32 v[58:59], v[26:27], v[26:27], s[20:21] neg_lo:[1,0,1] neg_hi:[1,0,1]
  v_pk_fma_f32 v[60:61], v[28:29], v[28:29], s[20:21] neg_lo:[1,0,1] neg_hi:[1,0,1]
  v_pk_fma_f32 v[62:63], v[30:31], v[30:31], s[20:21] neg_lo:[1,0,1] neg_hi:[1,0,1]
  v_pk_mul_f32 v[48:49], v[16:17], v[48:49]
  v_pk_mul_f32 v[50:51], v[18:19], v[50:51]
  v_pk_mul_f32 v[52:53], v[20:21], v[52:53]
  v_pk_mul_f32 v[54:55], v[22:23], v[54:55]
  v_pk_mul_f32 v[56:57], v[24:25], v[56:57]
  v_cvt_pk_bf16_f32 v184, v32, v33
  v_cvt_pk_bf16_f32 v185, v34, v35
  v_cvt_pk_bf16_f32 v186, v36, v37
  v_cvt_pk_bf16_f32 v187, v38, v39
  v_pk_mul_f32 v[58:59], v[26:27], v[58:59]
  v_pk_mul_f32 v[60:61], v[28:29], v[60:61]
  v_pk_mul_f32 v[62:63], v[30:31], v[62:63]
  v_mfma_f32_32x32x16_bf16 v[64:79], v[192:195], v[184:187], v[64:79]
  s_mov_b32 m0, s30
  v_cvt_pk_bf16_f32 v188, v40, v41
  v_cvt_pk_bf16_f32 v189, v42, v43
  v_cvt_pk_bf16_f32 v190, v44, v45
  v_cvt_pk_bf16_f32 v191, v46, v47
  v_exp_f32 v48, v48
  v_mfma_f32_32x32x16_bf16 v[80:95], v[196:199], v[184:187], v[80:95]
  s_waitcnt lgkmcnt(0)
  ds_read_b128 v[32:35], v2 offset:128
  ds_read_b128 v[36:39], v2 offset:160
  buffer_load_dwordx4 v6, s[4:7], s29 offen lds
  v_exp_f32 v49, v49
  v_exp_f32 v50, v50
  v_mfma_f32_32x32x16_bf16 v[96:111], v[200:203], v[184:187], v[96:111]
  ds_read_b128 v[40:43], v2 offset:192
  ds_read_b128 v[44:47], v2 offset:224
  buffer_load_dwordx4 v7, s[4:7], s29 offen offset:1024 lds
  v_exp_f32 v51, v51
  v_exp_f32 v52, v52
  v_mfma_f32_32x32x16_bf16 v[64:79], v[204:207], v[188:191], v[64:79]
  buffer_load_dwordx4 v8, s[4:7], s29 offen offset:2048 lds
  v_exp_f32 v53, v53
  v_exp_f32 v54, v54
  v_exp_f32 v55, v55
  v_mfma_f32_32x32x16_bf16 v[80:95], v[208:211], v[188:191], v[80:95]
  buffer_load_dwordx4 v9, s[4:7], s29 offen offset:3072 lds
  v_exp_f32 v56, v56
  v_exp_f32 v57, v57
  v_exp_f32 v58, v58
  v_mfma_f32_32x32x16_bf16 v[96:111], v[212:215], v[188:191], v[96:111]
  s_waitcnt lgkmcnt(0)
  v_exp_f32 v59, v59
  v_exp_f32 v60, v60
  v_exp_f32 v61, v61
  v_exp_f32 v62, v62
  v_exp_f32 v63, v63
  v_pk_fma_f32 v[48:49], v[48:49], s[22:23], s[22:23]
  v_pk_fma_f32 v[50:51], v[50:51], s[22:23], s[22:23]
  v_pk_fma_f32 v[52:53], v[52:53], s[22:23], s[22:23]
  v_pk_fma_f32 v[54:55], v[54:55], s[22:23], s[22:23]
  v_pk_fma_f32 v[56:57], v[56:57], s[22:23], s[22:23]
  v_pk_fma_f32 v[58:59], v[58:59], s[22:23], s[22:23]
  v_pk_fma_f32 v[60:61], v[60:61], s[22:23], s[22:23]
  v_pk_fma_f32 v[62:63], v[62:63], s[22:23], s[22:23]
  v_mfma_f32_32x32x16_bf16 v[32:47], a[24:27], v[160:163], v[32:47]
  ds_read_b128 v[192:195], v0 offset:40192
  ds_read_b128 v[196:199], v0 offset:41216
  v_rcp_f32 v48, v48
  v_cvt_pk_bf16_f32 v112, v64, v65
  v_rcp_f32 v49, v49
  v_cvt_pk_bf16_f32 v113, v66, v67
  v_cvt_pk_bf16_f32 v114, v68, v69
  v_mfma_f32_32x32x16_bf16 v[32:47], a[28:31], v[164:167], v[32:47]
  ds_read_b128 v[200:203], v0 offset:42240
  ds_read_b128 v[204:207], v0 offset:43264
  v_rcp_f32 v50, v50
  v_cvt_pk_bf16_f32 v115, v70, v71
  v_rcp_f32 v51, v51
  v_cvt_pk_bf16_f32 v116, v72, v73
  v_cvt_pk_bf16_f32 v117, v74, v75
  v_mfma_f32_32x32x16_bf16 v[32:47], a[32:35], v[168:171], v[32:47]
  ds_read_b128 v[208:211], v0 offset:44288
  ds_read_b128 v[212:215], v0 offset:45312
  v_rcp_f32 v52, v52
  v_cvt_pk_bf16_f32 v118, v76, v77
  v_rcp_f32 v53, v53
  v_cvt_pk_bf16_f32 v119, v78, v79
  v_cvt_pk_bf16_f32 v120, v80, v81
  v_mfma_f32_32x32x16_bf16 v[32:47], a[36:39], v[172:175], v[32:47]
  v_rcp_f32 v54, v54
  v_cvt_pk_bf16_f32 v121, v82, v83
  v_rcp_f32 v55, v55
  v_cvt_pk_bf16_f32 v122, v84, v85
  v_cvt_pk_bf16_f32 v123, v86, v87
  v_rcp_f32 v56, v56
  v_mfma_f32_32x32x16_bf16 v[32:47], a[40:43], v[176:179], v[32:47]
  v_cvt_pk_bf16_f32 v124, v88, v89
  v_rcp_f32 v57, v57
  v_cvt_pk_bf16_f32 v125, v90, v91
  v_cvt_pk_bf16_f32 v126, v92, v93
  v_rcp_f32 v58, v58
  v_cvt_pk_bf16_f32 v127, v94, v95
  v_rcp_f32 v59, v59
  v_mfma_f32_32x32x16_bf16 v[32:47], a[44:47], v[180:183], v[32:47]
  s_waitcnt lgkmcnt(0)
  v_cvt_pk_bf16_f32 v128, v96, v97
  v_cvt_pk_bf16_f32 v129, v98, v99
  v_rcp_f32 v60, v60
  v_cvt_pk_bf16_f32 v130, v100, v101
  v_rcp_f32 v61, v61
  v_cvt_pk_bf16_f32 v131, v102, v103
  v_cvt_pk_bf16_f32 v132, v104, v105
  v_rcp_f32 v62, v62
  v_cvt_pk_bf16_f32 v133, v106, v107
  v_rcp_f32 v63, v63
  v_cvt_pk_bf16_f32 v134, v108, v109
  v_cvt_pk_bf16_f32 v135, v110, v111
  ds_read_b128 v[64:67], v2 offset:1536
  ds_read_b128 v[68:71], v2 offset:1568
  ds_read_b128 v[72:75], v2 offset:1600
  ds_read_b128 v[76:79], v2 offset:1632
  ds_read_b128 v[80:83], v2 offset:1664
  ds_read_b128 v[84:87], v2 offset:1696
  ds_read_b128 v[88:91], v2 offset:1728
  ds_read_b128 v[92:95], v2 offset:1760
  ds_read_b128 v[96:99], v2 offset:1792
  ds_read_b128 v[100:103], v2 offset:1824
  ds_read_b128 v[104:107], v2 offset:1856
  ds_read_b128 v[108:111], v2 offset:1888
  v_pk_mul_f32 v[16:17], v[16:17], v[48:49]
  v_pk_mul_f32 v[18:19], v[18:19], v[50:51]
  v_pk_mul_f32 v[20:21], v[20:21], v[52:53]
  v_pk_mul_f32 v[22:23], v[22:23], v[54:55]
  v_pk_mul_f32 v[24:25], v[24:25], v[56:57]
  v_pk_mul_f32 v[26:27], v[26:27], v[58:59]
  v_pk_mul_f32 v[28:29], v[28:29], v[60:61]
  v_pk_mul_f32 v[30:31], v[30:31], v[62:63]
  v_pk_fma_f32 v[48:49], v[32:33], v[32:33], s[20:21] neg_lo:[1,0,1] neg_hi:[1,0,1]
  v_pk_fma_f32 v[50:51], v[34:35], v[34:35], s[20:21] neg_lo:[1,0,1] neg_hi:[1,0,1]
  v_pk_fma_f32 v[52:53], v[36:37], v[36:37], s[20:21] neg_lo:[1,0,1] neg_hi:[1,0,1]
  v_pk_fma_f32 v[54:55], v[38:39], v[38:39], s[20:21] neg_lo:[1,0,1] neg_hi:[1,0,1]
  v_pk_fma_f32 v[56:57], v[40:41], v[40:41], s[20:21] neg_lo:[1,0,1] neg_hi:[1,0,1]
  v_pk_fma_f32 v[58:59], v[42:43], v[42:43], s[20:21] neg_lo:[1,0,1] neg_hi:[1,0,1]
  v_pk_fma_f32 v[60:61], v[44:45], v[44:45], s[20:21] neg_lo:[1,0,1] neg_hi:[1,0,1]
  v_pk_fma_f32 v[62:63], v[46:47], v[46:47], s[20:21] neg_lo:[1,0,1] neg_hi:[1,0,1]
  v_pk_mul_f32 v[48:49], v[32:33], v[48:49]
  v_pk_mul_f32 v[50:51], v[34:35], v[50:51]
  v_pk_mul_f32 v[52:53], v[36:37], v[52:53]
  v_pk_mul_f32 v[54:55], v[38:39], v[54:55]
  v_pk_mul_f32 v[56:57], v[40:41], v[56:57]
  v_cvt_pk_bf16_f32 v184, v16, v17
  v_cvt_pk_bf16_f32 v185, v18, v19
  v_cvt_pk_bf16_f32 v186, v20, v21
  v_cvt_pk_bf16_f32 v187, v22, v23
  v_pk_mul_f32 v[58:59], v[42:43], v[58:59]
  v_pk_mul_f32 v[60:61], v[44:45], v[60:61]
  v_pk_mul_f32 v[62:63], v[46:47], v[62:63]
  s_waitcnt lgkmcnt(8)
  v_mfma_f32_32x32x16_bf16 v[64:79], v[192:195], v[184:187], v[64:79]
  s_mov_b32 m0, s31
  v_cvt_pk_bf16_f32 v188, v24, v25
  v_cvt_pk_bf16_f32 v189, v26, v27
  v_cvt_pk_bf16_f32 v190, v28, v29
  v_cvt_pk_bf16_f32 v191, v30, v31
  v_exp_f32 v48, v48
  s_waitcnt lgkmcnt(4)
  v_mfma_f32_32x32x16_bf16 v[80:95], v[196:199], v[184:187], v[80:95]
  ds_read_b128 v[16:19], v2 offset:256
  ds_read_b128 v[20:23], v2 offset:288
  buffer_load_dwordx4 v6, s[4:7], s52 offen lds
  v_exp_f32 v49, v49
  v_exp_f32 v50, v50
  s_waitcnt lgkmcnt(2)
  v_mfma_f32_32x32x16_bf16 v[96:111], v[200:203], v[184:187], v[96:111]
  ds_read_b128 v[24:27], v2 offset:320
  ds_read_b128 v[28:31], v2 offset:352
  buffer_load_dwordx4 v7, s[4:7], s52 offen offset:1024 lds
  v_exp_f32 v51, v51
  v_exp_f32 v52, v52
  v_mfma_f32_32x32x16_bf16 v[64:79], v[204:207], v[188:191], v[64:79]
  buffer_load_dwordx4 v8, s[4:7], s52 offen offset:2048 lds
  v_exp_f32 v53, v53
  v_exp_f32 v54, v54
  v_exp_f32 v55, v55
  v_mfma_f32_32x32x16_bf16 v[80:95], v[208:211], v[188:191], v[80:95]
  buffer_load_dwordx4 v9, s[4:7], s52 offen offset:3072 lds
  v_exp_f32 v56, v56
  v_exp_f32 v57, v57
  v_exp_f32 v58, v58
  v_mfma_f32_32x32x16_bf16 v[96:111], v[212:215], v[188:191], v[96:111]
  v_exp_f32 v59, v59
  v_exp_f32 v60, v60
  v_exp_f32 v61, v61
  v_mfma_f32_32x32x16_bf16 v[64:79], v[240:243], v[136:139], v[64:79]
  v_exp_f32 v62, v62
  v_exp_f32 v63, v63
  v_mfma_f32_32x32x16_bf16 v[80:95], v[240:243], v[144:147], v[80:95]
  v_mfma_f32_32x32x16_bf16 v[96:111], v[240:243], v[152:155], v[96:111]
  v_mfma_f32_32x32x16_bf16 v[64:79], v[244:247], v[140:143], v[64:79]
  v_mfma_f32_32x32x16_bf16 v[80:95], v[244:247], v[148:151], v[80:95]
  v_mfma_f32_32x32x16_bf16 v[96:111], v[244:247], v[156:159], v[96:111]
  s_waitcnt lgkmcnt(0)
  v_pk_fma_f32 v[48:49], v[48:49], s[22:23], s[22:23]
  v_pk_fma_f32 v[50:51], v[50:51], s[22:23], s[22:23]
  v_pk_fma_f32 v[52:53], v[52:53], s[22:23], s[22:23]
  v_pk_fma_f32 v[54:55], v[54:55], s[22:23], s[22:23]
  v_pk_fma_f32 v[56:57], v[56:57], s[22:23], s[22:23]
  v_pk_fma_f32 v[58:59], v[58:59], s[22:23], s[22:23]
  v_pk_fma_f32 v[60:61], v[60:61], s[22:23], s[22:23]
  v_pk_fma_f32 v[62:63], v[62:63], s[22:23], s[22:23]
  v_mfma_f32_32x32x16_bf16 v[16:31], a[48:51], v[160:163], v[16:31]
  ds_read_b128 v[192:195], v0 offset:46336
  ds_read_b128 v[196:199], v0 offset:47360
  v_rcp_f32 v48, v48
  v_rcp_f32 v49, v49
  v_mfma_f32_32x32x16_bf16 v[16:31], a[52:55], v[164:167], v[16:31]
  ds_read_b128 v[200:203], v1
  ds_read_b128 v[204:207], v1 offset:1024
  v_rcp_f32 v50, v50
  v_rcp_f32 v51, v51
  v_mfma_f32_32x32x16_bf16 v[16:31], a[56:59], v[168:171], v[16:31]
  ds_read_b128 v[208:211], v1 offset:2048
  ds_read_b128 v[212:215], v1 offset:3072
  v_rcp_f32 v52, v52
  v_rcp_f32 v53, v53
  v_mfma_f32_32x32x16_bf16 v[16:31], a[60:63], v[172:175], v[16:31]
  buffer_store_dwordx4 v[112:115], v10, s[8:11], s28 offen
  v_rcp_f32 v54, v54
  v_rcp_f32 v55, v55
  v_rcp_f32 v56, v56
  v_mfma_f32_32x32x16_bf16 v[16:31], a[64:67], v[176:179], v[16:31]
  v_rcp_f32 v57, v57
  v_rcp_f32 v58, v58
  v_rcp_f32 v59, v59
  v_mfma_f32_32x32x16_bf16 v[16:31], a[68:71], v[180:183], v[16:31]
  s_waitcnt lgkmcnt(0)
  v_rcp_f32 v60, v60
  v_rcp_f32 v61, v61
  v_rcp_f32 v62, v62
  v_rcp_f32 v63, v63
  v_pk_mul_f32 v[32:33], v[32:33], v[48:49]
  v_pk_mul_f32 v[34:35], v[34:35], v[50:51]
  v_pk_mul_f32 v[36:37], v[36:37], v[52:53]
  v_pk_mul_f32 v[38:39], v[38:39], v[54:55]
  v_pk_mul_f32 v[40:41], v[40:41], v[56:57]
  v_pk_mul_f32 v[42:43], v[42:43], v[58:59]
  v_pk_mul_f32 v[44:45], v[44:45], v[60:61]
  v_pk_mul_f32 v[46:47], v[46:47], v[62:63]
  v_pk_fma_f32 v[48:49], v[16:17], v[16:17], s[20:21] neg_lo:[1,0,1] neg_hi:[1,0,1]
  v_pk_fma_f32 v[50:51], v[18:19], v[18:19], s[20:21] neg_lo:[1,0,1] neg_hi:[1,0,1]
  v_pk_fma_f32 v[52:53], v[20:21], v[20:21], s[20:21] neg_lo:[1,0,1] neg_hi:[1,0,1]
  v_pk_fma_f32 v[54:55], v[22:23], v[22:23], s[20:21] neg_lo:[1,0,1] neg_hi:[1,0,1]
  v_pk_fma_f32 v[56:57], v[24:25], v[24:25], s[20:21] neg_lo:[1,0,1] neg_hi:[1,0,1]
  v_pk_fma_f32 v[58:59], v[26:27], v[26:27], s[20:21] neg_lo:[1,0,1] neg_hi:[1,0,1]
  v_pk_fma_f32 v[60:61], v[28:29], v[28:29], s[20:21] neg_lo:[1,0,1] neg_hi:[1,0,1]
  v_pk_fma_f32 v[62:63], v[30:31], v[30:31], s[20:21] neg_lo:[1,0,1] neg_hi:[1,0,1]
  v_pk_mul_f32 v[48:49], v[16:17], v[48:49]
  v_pk_mul_f32 v[50:51], v[18:19], v[50:51]
  v_pk_mul_f32 v[52:53], v[20:21], v[52:53]
  v_pk_mul_f32 v[54:55], v[22:23], v[54:55]
  v_pk_mul_f32 v[56:57], v[24:25], v[56:57]
  v_cvt_pk_bf16_f32 v184, v32, v33
  v_cvt_pk_bf16_f32 v185, v34, v35
  v_cvt_pk_bf16_f32 v186, v36, v37
  v_cvt_pk_bf16_f32 v187, v38, v39
  v_pk_mul_f32 v[58:59], v[26:27], v[58:59]
  v_pk_mul_f32 v[60:61], v[28:29], v[60:61]
  v_pk_mul_f32 v[62:63], v[30:31], v[62:63]
  v_mfma_f32_32x32x16_bf16 v[64:79], v[192:195], v[184:187], v[64:79]
  v_cvt_pk_bf16_f32 v188, v40, v41
  v_cvt_pk_bf16_f32 v189, v42, v43
  v_cvt_pk_bf16_f32 v190, v44, v45
  v_cvt_pk_bf16_f32 v191, v46, v47
  v_exp_f32 v48, v48
  v_mfma_f32_32x32x16_bf16 v[80:95], v[196:199], v[184:187], v[80:95]
  ds_read_b128 v[32:35], v2 offset:384
  ds_read_b128 v[36:39], v2 offset:416
  v_exp_f32 v49, v49
  v_exp_f32 v50, v50
  v_mfma_f32_32x32x16_bf16 v[96:111], v[200:203], v[184:187], v[96:111]
  ds_read_b128 v[40:43], v2 offset:448
  ds_read_b128 v[44:47], v2 offset:480
  v_exp_f32 v51, v51
  v_exp_f32 v52, v52
  v_mfma_f32_32x32x16_bf16 v[64:79], v[204:207], v[188:191], v[64:79]
  buffer_store_dwordx4 v[116:119], v10, s[8:11], s28 offen offset:32
  v_exp_f32 v53, v53
  v_subrev_u32 v11, 0x4100, v5
  v_exp_f32 v54, v54
  v_mfma_f32_32x32x16_bf16 v[80:95], v[208:211], v[188:191], v[80:95]
  v_exp_f32 v55, v55
  v_exp_f32 v56, v56
  v_exp_f32 v57, v57
  v_exp_f32 v58, v58
  v_mfma_f32_32x32x16_bf16 v[96:111], v[212:215], v[188:191], v[96:111]
  s_waitcnt lgkmcnt(0)
  v_add_u32 v5, 0x8200, v5
  v_exp_f32 v59, v59
  v_exp_f32 v60, v60
  v_exp_f32 v61, v61
  v_exp_f32 v62, v62
  v_exp_f32 v63, v63
  v_min_u32 v5, v11, v5
  v_pk_fma_f32 v[48:49], v[48:49], s[22:23], s[22:23]
  v_pk_fma_f32 v[50:51], v[50:51], s[22:23], s[22:23]
  v_pk_fma_f32 v[52:53], v[52:53], s[22:23], s[22:23]
  v_pk_fma_f32 v[54:55], v[54:55], s[22:23], s[22:23]
  v_pk_fma_f32 v[56:57], v[56:57], s[22:23], s[22:23]
  v_pk_fma_f32 v[58:59], v[58:59], s[22:23], s[22:23]
  v_pk_fma_f32 v[60:61], v[60:61], s[22:23], s[22:23]
  v_pk_fma_f32 v[62:63], v[62:63], s[22:23], s[22:23]
  v_mfma_f32_32x32x16_bf16 v[32:47], a[72:75], v[160:163], v[32:47]
  ds_read_b128 v[192:195], v1 offset:4096
  ds_read_b128 v[196:199], v1 offset:5120
  v_rcp_f32 v48, v48
  v_rcp_f32 v49, v49
  v_mfma_f32_32x32x16_bf16 v[32:47], a[76:79], v[164:167], v[32:47]
  ds_read_b128 v[200:203], v1 offset:6144
  ds_read_b128 v[204:207], v1 offset:7168
  v_rcp_f32 v50, v50
  v_rcp_f32 v51, v51
  v_mfma_f32_32x32x16_bf16 v[32:47], a[80:83], v[168:171], v[32:47]
  ds_read_b128 v[208:211], v1 offset:8192
  ds_read_b128 v[212:215], v1 offset:9216
  v_rcp_f32 v52, v52
  v_rcp_f32 v53, v53
  v_mfma_f32_32x32x16_bf16 v[32:47], a[84:87], v[172:175], v[32:47]
  buffer_store_dwordx4 v[120:123], v10, s[8:11], s28 offen offset:64
  v_rcp_f32 v54, v54
  v_rcp_f32 v55, v55
  v_rcp_f32 v56, v56
  v_mfma_f32_32x32x16_bf16 v[32:47], a[88:91], v[176:179], v[32:47]
  v_rcp_f32 v57, v57
  v_rcp_f32 v58, v58
  v_rcp_f32 v59, v59
  v_mfma_f32_32x32x16_bf16 v[32:47], a[92:95], v[180:183], v[32:47]
  s_waitcnt lgkmcnt(0)
  v_rcp_f32 v60, v60
  v_rcp_f32 v61, v61
  v_rcp_f32 v62, v62
  v_rcp_f32 v63, v63
  v_pk_mul_f32 v[16:17], v[16:17], v[48:49]
  v_pk_mul_f32 v[18:19], v[18:19], v[50:51]
  v_pk_mul_f32 v[20:21], v[20:21], v[52:53]
  v_pk_mul_f32 v[22:23], v[22:23], v[54:55]
  v_pk_mul_f32 v[24:25], v[24:25], v[56:57]
  v_pk_mul_f32 v[26:27], v[26:27], v[58:59]
  v_pk_mul_f32 v[28:29], v[28:29], v[60:61]
  v_pk_mul_f32 v[30:31], v[30:31], v[62:63]
  v_pk_fma_f32 v[48:49], v[32:33], v[32:33], s[20:21] neg_lo:[1,0,1] neg_hi:[1,0,1]
  v_pk_fma_f32 v[50:51], v[34:35], v[34:35], s[20:21] neg_lo:[1,0,1] neg_hi:[1,0,1]
  v_pk_fma_f32 v[52:53], v[36:37], v[36:37], s[20:21] neg_lo:[1,0,1] neg_hi:[1,0,1]
  v_pk_fma_f32 v[54:55], v[38:39], v[38:39], s[20:21] neg_lo:[1,0,1] neg_hi:[1,0,1]
  v_pk_fma_f32 v[56:57], v[40:41], v[40:41], s[20:21] neg_lo:[1,0,1] neg_hi:[1,0,1]
  v_pk_fma_f32 v[58:59], v[42:43], v[42:43], s[20:21] neg_lo:[1,0,1] neg_hi:[1,0,1]
  v_pk_fma_f32 v[60:61], v[44:45], v[44:45], s[20:21] neg_lo:[1,0,1] neg_hi:[1,0,1]
  v_pk_fma_f32 v[62:63], v[46:47], v[46:47], s[20:21] neg_lo:[1,0,1] neg_hi:[1,0,1]
  v_pk_mul_f32 v[48:49], v[32:33], v[48:49]
  v_pk_mul_f32 v[50:51], v[34:35], v[50:51]
  v_pk_mul_f32 v[52:53], v[36:37], v[52:53]
  v_pk_mul_f32 v[54:55], v[38:39], v[54:55]
  v_pk_mul_f32 v[56:57], v[40:41], v[56:57]
  v_cvt_pk_bf16_f32 v184, v16, v17
  v_cvt_pk_bf16_f32 v185, v18, v19
  v_cvt_pk_bf16_f32 v186, v20, v21
  v_cvt_pk_bf16_f32 v187, v22, v23
  v_pk_mul_f32 v[58:59], v[42:43], v[58:59]
  v_pk_mul_f32 v[60:61], v[44:45], v[60:61]
  v_pk_mul_f32 v[62:63], v[46:47], v[62:63]
  v_mfma_f32_32x32x16_bf16 v[64:79], v[192:195], v[184:187], v[64:79]
  v_cvt_pk_bf16_f32 v188, v24, v25
  v_cvt_pk_bf16_f32 v189, v26, v27
  v_cvt_pk_bf16_f32 v190, v28, v29
  v_cvt_pk_bf16_f32 v191, v30, v31
  v_exp_f32 v48, v48
  v_mfma_f32_32x32x16_bf16 v[80:95], v[196:199], v[184:187], v[80:95]
  ds_read_b128 v[16:19], v2 offset:512
  ds_read_b128 v[20:23], v2 offset:544
  v_exp_f32 v49, v49
  v_exp_f32 v50, v50
  v_mfma_f32_32x32x16_bf16 v[96:111], v[200:203], v[184:187], v[96:111]
  ds_read_b128 v[24:27], v2 offset:576
  ds_read_b128 v[28:31], v2 offset:608
  v_exp_f32 v51, v51
  v_exp_f32 v52, v52
  v_mfma_f32_32x32x16_bf16 v[64:79], v[204:207], v[188:191], v[64:79]
  buffer_store_dwordx4 v[124:127], v10, s[8:11], s28 offen offset:96
  v_exp_f32 v53, v53
  v_exp_f32 v54, v54
  v_exp_f32 v55, v55
  v_mfma_f32_32x32x16_bf16 v[80:95], v[208:211], v[188:191], v[80:95]
  v_exp_f32 v56, v56
  v_exp_f32 v57, v57
  v_exp_f32 v58, v58
  v_mfma_f32_32x32x16_bf16 v[96:111], v[212:215], v[188:191], v[96:111]
  s_waitcnt lgkmcnt(0)
  v_exp_f32 v59, v59
  v_exp_f32 v60, v60
  v_exp_f32 v61, v61
  v_exp_f32 v62, v62
  v_exp_f32 v63, v63
  v_pk_fma_f32 v[48:49], v[48:49], s[22:23], s[22:23]
  v_pk_fma_f32 v[50:51], v[50:51], s[22:23], s[22:23]
  v_pk_fma_f32 v[52:53], v[52:53], s[22:23], s[22:23]
  v_pk_fma_f32 v[54:55], v[54:55], s[22:23], s[22:23]
  v_pk_fma_f32 v[56:57], v[56:57], s[22:23], s[22:23]
  v_pk_fma_f32 v[58:59], v[58:59], s[22:23], s[22:23]
  v_pk_fma_f32 v[60:61], v[60:61], s[22:23], s[22:23]
  v_pk_fma_f32 v[62:63], v[62:63], s[22:23], s[22:23]
  v_mfma_f32_32x32x16_bf16 v[16:31], a[96:99], v[160:163], v[16:31]
  ds_read_b128 v[248:251], v0
  ds_read_b128 v[192:195], v1 offset:10240
  ds_read_b128 v[196:199], v1 offset:11264
  v_rcp_f32 v48, v48
  v_rcp_f32 v49, v49
  v_mfma_f32_32x32x16_bf16 v[16:31], a[100:103], v[164:167], v[16:31]
  ds_read_b128 v[200:203], v1 offset:12288
  ds_read_b128 v[204:207], v1 offset:13312
  v_rcp_f32 v50, v50
  v_rcp_f32 v51, v51
  v_mfma_f32_32x32x16_bf16 v[16:31], a[104:107], v[168:171], v[16:31]
  ds_read_b128 v[208:211], v1 offset:14336
  ds_read_b128 v[212:215], v1 offset:15360
  v_rcp_f32 v52, v52
  v_rcp_f32 v53, v53
  v_mfma_f32_32x32x16_bf16 v[16:31], a[108:111], v[172:175], v[16:31]
  buffer_store_dwordx4 v[128:131], v10, s[8:11], s28 offen offset:128
  v_rcp_f32 v54, v54
  v_rcp_f32 v55, v55
  v_rcp_f32 v56, v56
  v_mfma_f32_32x32x16_bf16 v[16:31], a[112:115], v[176:179], v[16:31]
  s_waitcnt lgkmcnt(6)
  v_rcp_f32 v57, v57
  v_rcp_f32 v58, v58
  v_rcp_f32 v59, v59
  v_mfma_f32_32x32x16_bf16 v[16:31], v[248:251], v[180:183], v[16:31]
  s_waitcnt lgkmcnt(0)
  v_rcp_f32 v60, v60
  v_rcp_f32 v61, v61
  v_rcp_f32 v62, v62
  v_rcp_f32 v63, v63
  v_pk_mul_f32 v[32:33], v[32:33], v[48:49]
  v_pk_mul_f32 v[34:35], v[34:35], v[50:51]
  v_pk_mul_f32 v[36:37], v[36:37], v[52:53]
  v_pk_mul_f32 v[38:39], v[38:39], v[54:55]
  v_pk_mul_f32 v[40:41], v[40:41], v[56:57]
  v_pk_mul_f32 v[42:43], v[42:43], v[58:59]
  v_pk_mul_f32 v[44:45], v[44:45], v[60:61]
  v_pk_mul_f32 v[46:47], v[46:47], v[62:63]
  v_pk_fma_f32 v[48:49], v[16:17], v[16:17], s[20:21] neg_lo:[1,0,1] neg_hi:[1,0,1]
  v_pk_fma_f32 v[50:51], v[18:19], v[18:19], s[20:21] neg_lo:[1,0,1] neg_hi:[1,0,1]
  v_pk_fma_f32 v[52:53], v[20:21], v[20:21], s[20:21] neg_lo:[1,0,1] neg_hi:[1,0,1]
  v_pk_fma_f32 v[54:55], v[22:23], v[22:23], s[20:21] neg_lo:[1,0,1] neg_hi:[1,0,1]
  v_pk_fma_f32 v[56:57], v[24:25], v[24:25], s[20:21] neg_lo:[1,0,1] neg_hi:[1,0,1]
  v_pk_fma_f32 v[58:59], v[26:27], v[26:27], s[20:21] neg_lo:[1,0,1] neg_hi:[1,0,1]
  v_pk_fma_f32 v[60:61], v[28:29], v[28:29], s[20:21] neg_lo:[1,0,1] neg_hi:[1,0,1]
  v_pk_fma_f32 v[62:63], v[30:31], v[30:31], s[20:21] neg_lo:[1,0,1] neg_hi:[1,0,1]
  v_pk_mul_f32 v[48:49], v[16:17], v[48:49]
  v_pk_mul_f32 v[50:51], v[18:19], v[50:51]
  v_pk_mul_f32 v[52:53], v[20:21], v[52:53]
  v_pk_mul_f32 v[54:55], v[22:23], v[54:55]
  v_pk_mul_f32 v[56:57], v[24:25], v[56:57]
  v_cvt_pk_bf16_f32 v184, v32, v33
  v_cvt_pk_bf16_f32 v185, v34, v35
  v_cvt_pk_bf16_f32 v186, v36, v37
  v_cvt_pk_bf16_f32 v187, v38, v39
  v_pk_mul_f32 v[58:59], v[26:27], v[58:59]
  v_pk_mul_f32 v[60:61], v[28:29], v[60:61]
  v_pk_mul_f32 v[62:63], v[30:31], v[62:63]
  v_mfma_f32_32x32x16_bf16 v[64:79], v[192:195], v[184:187], v[64:79]
  s_waitcnt vmcnt(5)
  ds_read_b128 v[216:219], v3
  ds_read_b128 v[220:223], v4
  v_cvt_pk_bf16_f32 v188, v40, v41
  v_cvt_pk_bf16_f32 v189, v42, v43
  v_cvt_pk_bf16_f32 v190, v44, v45
  v_cvt_pk_bf16_f32 v191, v46, v47
  v_mfma_f32_32x32x16_bf16 v[80:95], v[196:199], v[184:187], v[80:95]
  ds_read_b128 v[32:35], v2 offset:640
  ds_read_b128 v[36:39], v2 offset:672
  ds_read_b128 v[224:227], v3 offset:4800
  ds_read_b128 v[228:231], v4 offset:192
  v_exp_f32 v48, v48
  v_mfma_f32_32x32x16_bf16 v[96:111], v[200:203], v[184:187], v[96:111]
  ds_read_b128 v[40:43], v2 offset:704
  ds_read_b128 v[44:47], v2 offset:736
  ds_read_b128 v[232:235], v3 offset:9600
  ds_read_b128 v[236:239], v4 offset:384
  v_exp_f32 v49, v49
  v_exp_f32 v50, v50
  v_mfma_f32_32x32x16_bf16 v[64:79], v[204:207], v[188:191], v[64:79]
  buffer_store_dwordx4 v[132:135], v10, s[8:11], s28 offen offset:160
  v_exp_f32 v51, v51
  v_exp_f32 v52, v52
  v_exp_f32 v53, v53
  v_mfma_f32_32x32x16_bf16 v[80:95], v[208:211], v[188:191], v[80:95]
  v_exp_f32 v54, v54
  v_exp_f32 v55, v55
  v_exp_f32 v56, v56
  v_exp_f32 v57, v57
  v_mfma_f32_32x32x16_bf16 v[96:111], v[212:215], v[188:191], v[96:111]
  s_waitcnt lgkmcnt(0)
  v_exp_f32 v58, v58
  v_exp_f32 v59, v59
  v_exp_f32 v60, v60
  v_exp_f32 v61, v61
  v_exp_f32 v62, v62
  v_exp_f32 v63, v63
  v_pk_fma_f32 v[48:49], v[48:49], s[22:23], s[22:23]
  v_pk_fma_f32 v[50:51], v[50:51], s[22:23], s[22:23]
  v_pk_fma_f32 v[52:53], v[52:53], s[22:23], s[22:23]
  v_pk_fma_f32 v[54:55], v[54:55], s[22:23], s[22:23]
  v_pk_fma_f32 v[56:57], v[56:57], s[22:23], s[22:23]
  v_pk_fma_f32 v[58:59], v[58:59], s[22:23], s[22:23]
  v_pk_fma_f32 v[60:61], v[60:61], s[22:23], s[22:23]
  v_pk_fma_f32 v[62:63], v[62:63], s[22:23], s[22:23]
  v_mfma_f32_32x32x16_bf16 v[32:47], a[116:119], v[160:163], v[32:47]
  ds_read_b128 v[248:251], v0 offset:1024
  ds_read_b128 v[192:195], v1 offset:16384
  ds_read_b128 v[196:199], v1 offset:17408
  v_rcp_f32 v48, v48
  v_rcp_f32 v49, v49
  v_mfma_f32_16x16x32_bf16 v[112:115], v[216:219], v[220:223], 0
  ds_read_b128 v[216:219], v3 offset:400
  ds_read_b128 v[220:223], v4 offset:16
  v_mfma_f32_32x32x16_bf16 v[32:47], a[120:123], v[164:167], v[32:47]
  ds_read_b128 v[200:203], v1 offset:18432
  ds_read_b128 v[204:207], v1 offset:19456
  v_rcp_f32 v50, v50
  v_rcp_f32 v51, v51
  v_mfma_f32_16x16x32_bf16 v[112:115], v[224:227], v[228:231], v[112:115]
  ds_read_b128 v[224:227], v3 offset:5200
  ds_read_b128 v[228:231], v4 offset:208
  v_mfma_f32_32x32x16_bf16 v[32:47], a[124:127], v[168:171], v[32:47]
  ds_read_b128 v[208:211], v1 offset:20480
  ds_read_b128 v[212:215], v1 offset:21504
  v_rcp_f32 v52, v52
  v_rcp_f32 v53, v53
  v_mfma_f32_16x16x32_bf16 v[112:115], v[232:235], v[236:239], v[112:115]
  ds_read_b128 v[232:235], v3 offset:10000
  ds_read_b128 v[236:239], v4 offset:400
  v_mfma_f32_32x32x16_bf16 v[32:47], a[128:131], v[172:175], v[32:47]
  v_rcp_f32 v54, v54
  v_rcp_f32 v55, v55
  v_rcp_f32 v56, v56
  v_mfma_f32_32x32x16_bf16 v[32:47], a[132:135], v[176:179], v[32:47]
  s_waitcnt lgkmcnt(12)
  v_rcp_f32 v57, v57
  v_rcp_f32 v58, v58
  v_rcp_f32 v59, v59
  v_mfma_f32_32x32x16_bf16 v[32:47], v[248:251], v[180:183], v[32:47]
  s_waitcnt lgkmcnt(0)
  v_rcp_f32 v60, v60
  v_rcp_f32 v61, v61
  v_rcp_f32 v62, v62
  v_rcp_f32 v63, v63
  v_pk_mul_f32 v[16:17], v[16:17], v[48:49]
  v_pk_mul_f32 v[18:19], v[18:19], v[50:51]
  v_pk_mul_f32 v[20:21], v[20:21], v[52:53]
  v_pk_mul_f32 v[22:23], v[22:23], v[54:55]
  v_pk_mul_f32 v[24:25], v[24:25], v[56:57]
  v_pk_mul_f32 v[26:27], v[26:27], v[58:59]
  v_pk_mul_f32 v[28:29], v[28:29], v[60:61]
  v_pk_mul_f32 v[30:31], v[30:31], v[62:63]
  v_pk_add_f32 v[12:13], v[112:113], v[114:115]
  v_pk_mul_f32 v[14:15], v[112:113], v[112:113]
  v_pk_fma_f32 v[14:15], v[114:115], v[114:115], v[14:15]
  v_pk_fma_f32 v[48:49], v[32:33], v[32:33], s[20:21] neg_lo:[1,0,1] neg_hi:[1,0,1]
  v_pk_fma_f32 v[50:51], v[34:35], v[34:35], s[20:21] neg_lo:[1,0,1] neg_hi:[1,0,1]
  v_pk_fma_f32 v[52:53], v[36:37], v[36:37], s[20:21] neg_lo:[1,0,1] neg_hi:[1,0,1]
  v_pk_fma_f32 v[54:55], v[38:39], v[38:39], s[20:21] neg_lo:[1,0,1] neg_hi:[1,0,1]
  v_pk_fma_f32 v[56:57], v[40:41], v[40:41], s[20:21] neg_lo:[1,0,1] neg_hi:[1,0,1]
  v_pk_fma_f32 v[58:59], v[42:43], v[42:43], s[20:21] neg_lo:[1,0,1] neg_hi:[1,0,1]
  v_pk_fma_f32 v[60:61], v[44:45], v[44:45], s[20:21] neg_lo:[1,0,1] neg_hi:[1,0,1]
  v_pk_fma_f32 v[62:63], v[46:47], v[46:47], s[20:21] neg_lo:[1,0,1] neg_hi:[1,0,1]
  v_pk_mul_f32 v[48:49], v[32:33], v[48:49]
  v_pk_mul_f32 v[50:51], v[34:35], v[50:51]
  v_pk_mul_f32 v[52:53], v[36:37], v[52:53]
  v_pk_mul_f32 v[54:55], v[38:39], v[54:55]
  v_pk_mul_f32 v[56:57], v[40:41], v[56:57]
  v_cvt_pk_bf16_f32 v184, v16, v17
  v_cvt_pk_bf16_f32 v185, v18, v19
  v_cvt_pk_bf16_f32 v186, v20, v21
  v_cvt_pk_bf16_f32 v187, v22, v23
  v_pk_mul_f32 v[58:59], v[42:43], v[58:59]
  v_pk_mul_f32 v[60:61], v[44:45], v[60:61]
  v_pk_mul_f32 v[62:63], v[46:47], v[62:63]
  v_mfma_f32_32x32x16_bf16 v[64:79], v[192:195], v[184:187], v[64:79]
  v_cvt_pk_bf16_f32 v188, v24, v25
  v_cvt_pk_bf16_f32 v189, v26, v27
  v_cvt_pk_bf16_f32 v190, v28, v29
  v_cvt_pk_bf16_f32 v191, v30, v31
  v_exp_f32 v48, v48
  v_mfma_f32_16x16x32_bf16 v[116:119], v[216:219], v[220:223], 0
  ds_read_b128 v[216:219], v3 offset:800
  ds_read_b128 v[220:223], v4 offset:32
  v_mfma_f32_32x32x16_bf16 v[80:95], v[196:199], v[184:187], v[80:95]
  ds_read_b128 v[16:19], v2 offset:768
  ds_read_b128 v[20:23], v2 offset:800
  v_exp_f32 v49, v49
  v_exp_f32 v50, v50
  v_mfma_f32_16x16x32_bf16 v[116:119], v[224:227], v[228:231], v[116:119]
  ds_read_b128 v[224:227], v3 offset:5600
  ds_read_b128 v[228:231], v4 offset:224
  v_mfma_f32_32x32x16_bf16 v[96:111], v[200:203], v[184:187], v[96:111]
  ds_read_b128 v[24:27], v2 offset:832
  ds_read_b128 v[28:31], v2 offset:864
  v_exp_f32 v51, v51
  v_exp_f32 v52, v52
  v_mfma_f32_16x16x32_bf16 v[116:119], v[232:235], v[236:239], v[116:119]
  ds_read_b128 v[232:235], v3 offset:10400
  ds_read_b128 v[236:239], v4 offset:416
  v_mfma_f32_32x32x16_bf16 v[64:79], v[204:207], v[188:191], v[64:79]
  v_exp_f32 v53, v53
  v_exp_f32 v54, v54
  v_exp_f32 v55, v55
  v_mfma_f32_32x32x16_bf16 v[80:95], v[208:211], v[188:191], v[80:95]
  v_exp_f32 v56, v56
  v_exp_f32 v57, v57
  v_exp_f32 v58, v58
  v_mfma_f32_32x32x16_bf16 v[96:111], v[212:215], v[188:191], v[96:111]
  s_waitcnt lgkmcnt(0)
  v_exp_f32 v59, v59
  v_exp_f32 v60, v60
  v_exp_f32 v61, v61
  v_exp_f32 v62, v62
  v_exp_f32 v63, v63
  v_pk_add_f32 v[12:13], v[12:13], v[116:117]
  v_pk_fma_f32 v[14:15], v[116:117], v[116:117], v[14:15]
  v_pk_add_f32 v[12:13], v[12:13], v[118:119]
  v_pk_fma_f32 v[14:15], v[118:119], v[118:119], v[14:15]
  v_pk_fma_f32 v[48:49], v[48:49], s[22:23], s[22:23]
  v_pk_fma_f32 v[50:51], v[50:51], s[22:23], s[22:23]
  v_pk_fma_f32 v[52:53], v[52:53], s[22:23], s[22:23]
  v_pk_fma_f32 v[54:55], v[54:55], s[22:23], s[22:23]
  v_pk_fma_f32 v[56:57], v[56:57], s[22:23], s[22:23]
  v_pk_fma_f32 v[58:59], v[58:59], s[22:23], s[22:23]
  v_pk_fma_f32 v[60:61], v[60:61], s[22:23], s[22:23]
  v_pk_fma_f32 v[62:63], v[62:63], s[22:23], s[22:23]
  v_mfma_f32_32x32x16_bf16 v[16:31], a[136:139], v[160:163], v[16:31]
  ds_read_b128 v[248:251], v0 offset:2048
  ds_read_b128 v[192:195], v1 offset:22528
  ds_read_b128 v[196:199], v1 offset:23552
  v_rcp_f32 v48, v48
  v_rcp_f32 v49, v49
  v_mfma_f32_16x16x32_bf16 v[120:123], v[216:219], v[220:223], 0
  ds_read_b128 v[216:219], v3 offset:1200
  ds_read_b128 v[220:223], v4 offset:48
  v_mfma_f32_32x32x16_bf16 v[16:31], a[140:143], v[164:167], v[16:31]
  ds_read_b128 v[200:203], v1 offset:24576
  ds_read_b128 v[204:207], v1 offset:25600
  v_rcp_f32 v50, v50
  v_rcp_f32 v51, v51
  v_mfma_f32_16x16x32_bf16 v[120:123], v[224:227], v[228:231], v[120:123]
  ds_read_b128 v[224:227], v3 offset:6000
  ds_read_b128 v[228:231], v4 offset:240
  v_mfma_f32_32x32x16_bf16 v[16:31], a[144:147], v[168:171], v[16:31]
  ds_read_b128 v[208:211], v1 offset:26624
  ds_read_b128 v[212:215], v1 offset:27648
  v_rcp_f32 v52, v52
  v_rcp_f32 v53, v53
  v_mfma_f32_16x16x32_bf16 v[120:123], v[232:235], v[236:239], v[120:123]
  ds_read_b128 v[232:235], v3 offset:10800
  ds_read_b128 v[236:239], v4 offset:432
  v_mfma_f32_32x32x16_bf16 v[16:31], a[148:151], v[172:175], v[16:31]
  v_rcp_f32 v54, v54
  v_rcp_f32 v55, v55
  v_rcp_f32 v56, v56
  v_mfma_f32_32x32x16_bf16 v[16:31], a[152:155], v[176:179], v[16:31]
  s_waitcnt lgkmcnt(12)
  v_rcp_f32 v57, v57
  v_rcp_f32 v58, v58
  v_rcp_f32 v59, v59
  v_mfma_f32_32x32x16_bf16 v[16:31], v[248:251], v[180:183], v[16:31]
  s_waitcnt lgkmcnt(0)
  v_rcp_f32 v60, v60
  v_rcp_f32 v61, v61
  v_rcp_f32 v62, v62
  v_rcp_f32 v63, v63
  v_pk_mul_f32 v[32:33], v[32:33], v[48:49]
  v_pk_mul_f32 v[34:35], v[34:35], v[50:51]
  v_pk_mul_f32 v[36:37], v[36:37], v[52:53]
  v_pk_mul_f32 v[38:39], v[38:39], v[54:55]
  v_pk_mul_f32 v[40:41], v[40:41], v[56:57]
  v_pk_mul_f32 v[42:43], v[42:43], v[58:59]
  v_pk_mul_f32 v[44:45], v[44:45], v[60:61]
  v_pk_mul_f32 v[46:47], v[46:47], v[62:63]
  v_pk_add_f32 v[12:13], v[12:13], v[120:121]
  v_pk_fma_f32 v[14:15], v[120:121], v[120:121], v[14:15]
  v_pk_add_f32 v[12:13], v[12:13], v[122:123]
  v_pk_fma_f32 v[14:15], v[122:123], v[122:123], v[14:15]
  v_pk_fma_f32 v[48:49], v[16:17], v[16:17], s[20:21] neg_lo:[1,0,1] neg_hi:[1,0,1]
  v_pk_fma_f32 v[50:51], v[18:19], v[18:19], s[20:21] neg_lo:[1,0,1] neg_hi:[1,0,1]
  v_pk_fma_f32 v[52:53], v[20:21], v[20:21], s[20:21] neg_lo:[1,0,1] neg_hi:[1,0,1]
  v_pk_fma_f32 v[54:55], v[22:23], v[22:23], s[20:21] neg_lo:[1,0,1] neg_hi:[1,0,1]
  v_pk_fma_f32 v[56:57], v[24:25], v[24:25], s[20:21] neg_lo:[1,0,1] neg_hi:[1,0,1]
  v_pk_fma_f32 v[58:59], v[26:27], v[26:27], s[20:21] neg_lo:[1,0,1] neg_hi:[1,0,1]
  v_pk_fma_f32 v[60:61], v[28:29], v[28:29], s[20:21] neg_lo:[1,0,1] neg_hi:[1,0,1]
  v_pk_fma_f32 v[62:63], v[30:31], v[30:31], s[20:21] neg_lo:[1,0,1] neg_hi:[1,0,1]
  v_pk_mul_f32 v[48:49], v[16:17], v[48:49]
  v_pk_mul_f32 v[50:51], v[18:19], v[50:51]
  v_pk_mul_f32 v[52:53], v[20:21], v[52:53]
  v_pk_mul_f32 v[54:55], v[22:23], v[54:55]
  v_pk_mul_f32 v[56:57], v[24:25], v[56:57]
  v_cvt_pk_bf16_f32 v184, v32, v33
  v_cvt_pk_bf16_f32 v185, v34, v35
  v_cvt_pk_bf16_f32 v186, v36, v37
  v_cvt_pk_bf16_f32 v187, v38, v39
  v_pk_mul_f32 v[58:59], v[26:27], v[58:59]
  v_pk_mul_f32 v[60:61], v[28:29], v[60:61]
  v_pk_mul_f32 v[62:63], v[30:31], v[62:63]
  v_mfma_f32_32x32x16_bf16 v[64:79], v[192:195], v[184:187], v[64:79]
  s_add_u32 s29, s29, 0x60000
  v_cvt_pk_bf16_f32 v188, v40, v41
  v_cvt_pk_bf16_f32 v189, v42, v43
  v_cvt_pk_bf16_f32 v190, v44, v45
  v_cvt_pk_bf16_f32 v191, v46, v47
  v_exp_f32 v48, v48
  v_mfma_f32_16x16x32_bf16 v[124:127], v[216:219], v[220:223], 0
  ds_read_b128 v[216:219], v3 offset:1600
  ds_read_b128 v[220:223], v4 offset:64
  v_mfma_f32_32x32x16_bf16 v[80:95], v[196:199], v[184:187], v[80:95]
  s_add_u32 s52, s52, 0x60000
  ds_read_b128 v[32:35], v2 offset:896
  ds_read_b128 v[36:39], v2 offset:928
  v_exp_f32 v49, v49
  v_exp_f32 v50, v50
  v_mfma_f32_16x16x32_bf16 v[124:127], v[224:227], v[228:231], v[124:127]
  ds_read_b128 v[224:227], v3 offset:6400
  ds_read_b128 v[228:231], v4 offset:256
  v_mfma_f32_32x32x16_bf16 v[96:111], v[200:203], v[184:187], v[96:111]
  s_mov_b32 s32, s30
  ds_read_b128 v[40:43], v2 offset:960
  ds_read_b128 v[44:47], v2 offset:992
  v_exp_f32 v51, v51
  v_exp_f32 v52, v52
  v_mfma_f32_16x16x32_bf16 v[124:127], v[232:235], v[236:239], v[124:127]
  ds_read_b128 v[232:235], v3 offset:11200
  ds_read_b128 v[236:239], v4 offset:448
  v_mfma_f32_32x32x16_bf16 v[64:79], v[204:207], v[188:191], v[64:79]
  s_add_u32 s30, s33, 32
  v_exp_f32 v53, v53
  v_exp_f32 v54, v54
  v_exp_f32 v55, v55
  v_mfma_f32_32x32x16_bf16 v[80:95], v[208:211], v[188:191], v[80:95]
  s_sub_u32 s33, s31, 0
  v_exp_f32 v56, v56
  v_exp_f32 v57, v57
  v_exp_f32 v58, v58
  v_mfma_f32_32x32x16_bf16 v[96:111], v[212:215], v[188:191], v[96:111]
  s_waitcnt lgkmcnt(0)
  s_sub_u32 s31, s32, 32
  v_exp_f32 v59, v59
  v_exp_f32 v60, v60
  v_exp_f32 v61, v61
  v_exp_f32 v62, v62
  v_exp_f32 v63, v63
  v_pk_add_f32 v[12:13], v[12:13], v[124:125]
  v_pk_fma_f32 v[14:15], v[124:125], v[124:125], v[14:15]
  v_pk_add_f32 v[12:13], v[12:13], v[126:127]
  v_pk_fma_f32 v[14:15], v[126:127], v[126:127], v[14:15]
  v_pk_fma_f32 v[48:49], v[48:49], s[22:23], s[22:23]
  v_pk_fma_f32 v[50:51], v[50:51], s[22:23], s[22:23]
  v_pk_fma_f32 v[52:53], v[52:53], s[22:23], s[22:23]
  v_pk_fma_f32 v[54:55], v[54:55], s[22:23], s[22:23]
  v_pk_fma_f32 v[56:57], v[56:57], s[22:23], s[22:23]
  v_pk_fma_f32 v[58:59], v[58:59], s[22:23], s[22:23]
  v_pk_fma_f32 v[60:61], v[60:61], s[22:23], s[22:23]
  v_pk_fma_f32 v[62:63], v[62:63], s[22:23], s[22:23]
  v_mfma_f32_32x32x16_bf16 v[32:47], a[156:159], v[160:163], v[32:47]
  ds_read_b128 v[248:251], v0 offset:3072
  ds_read_b128 v[192:195], v1 offset:28672
  ds_read_b128 v[196:199], v1 offset:29696
  v_rcp_f32 v48, v48
  v_rcp_f32 v49, v49
  v_mfma_f32_16x16x32_bf16 v[128:131], v[216:219], v[220:223], 0
  ds_read_b128 v[216:219], v3 offset:2000
  ds_read_b128 v[220:223], v4 offset:80
  v_mfma_f32_32x32x16_bf16 v[32:47], a[160:163], v[164:167], v[32:47]
  ds_read_b128 v[200:203], v1 offset:30720
  ds_read_b128 v[204:207], v1 offset:31744
  v_rcp_f32 v50, v50
  v_rcp_f32 v51, v51
  v_mfma_f32_16x16x32_bf16 v[128:131], v[224:227], v[228:231], v[128:131]
  ds_read_b128 v[224:227], v3 offset:6800
  ds_read_b128 v[228:231], v4 offset:272
  v_mfma_f32_32x32x16_bf16 v[32:47], a[164:167], v[168:171], v[32:47]
  ds_read_b128 v[208:211], v1 offset:32768
  ds_read_b128 v[212:215], v1 offset:33792
  v_rcp_f32 v52, v52
  v_rcp_f32 v53, v53
  v_mfma_f32_16x16x32_bf16 v[128:131], v[232:235], v[236:239], v[128:131]
  ds_read_b128 v[232:235], v3 offset:11600
  ds_read_b128 v[236:239], v4 offset:464
  v_mfma_f32_32x32x16_bf16 v[32:47], a[168:171], v[172:175], v[32:47]
  v_rcp_f32 v54, v54
  v_rcp_f32 v55, v55
  v_rcp_f32 v56, v56
  v_mfma_f32_32x32x16_bf16 v[32:47], a[172:175], v[176:179], v[32:47]
  s_waitcnt lgkmcnt(12)
  v_rcp_f32 v57, v57
  v_rcp_f32 v58, v58
  v_rcp_f32 v59, v59
  v_mfma_f32_32x32x16_bf16 v[32:47], v[248:251], v[180:183], v[32:47]
  s_waitcnt lgkmcnt(0)
  v_rcp_f32 v60, v60
  v_rcp_f32 v61, v61
  v_rcp_f32 v62, v62
  v_rcp_f32 v63, v63
  v_pk_mul_f32 v[16:17], v[16:17], v[48:49]
  v_pk_mul_f32 v[18:19], v[18:19], v[50:51]
  v_pk_mul_f32 v[20:21], v[20:21], v[52:53]
  v_pk_mul_f32 v[22:23], v[22:23], v[54:55]
  v_pk_mul_f32 v[24:25], v[24:25], v[56:57]
  v_pk_mul_f32 v[26:27], v[26:27], v[58:59]
  v_pk_mul_f32 v[28:29], v[28:29], v[60:61]
  v_pk_mul_f32 v[30:31], v[30:31], v[62:63]
  v_pk_add_f32 v[12:13], v[12:13], v[128:129]
  v_pk_fma_f32 v[14:15], v[128:129], v[128:129], v[14:15]
  v_pk_add_f32 v[12:13], v[12:13], v[130:131]
  v_pk_fma_f32 v[14:15], v[130:131], v[130:131], v[14:15]
  v_pk_fma_f32 v[48:49], v[32:33], v[32:33], s[20:21] neg_lo:[1,0,1] neg_hi:[1,0,1]
  v_pk_fma_f32 v[50:51], v[34:35], v[34:35], s[20:21] neg_lo:[1,0,1] neg_hi:[1,0,1]
  v_pk_fma_f32 v[52:53], v[36:37], v[36:37], s[20:21] neg_lo:[1,0,1] neg_hi:[1,0,1]
  v_pk_fma_f32 v[54:55], v[38:39], v[38:39], s[20:21] neg_lo:[1,0,1] neg_hi:[1,0,1]
  v_pk_fma_f32 v[56:57], v[40:41], v[40:41], s[20:21] neg_lo:[1,0,1] neg_hi:[1,0,1]
  v_pk_fma_f32 v[58:59], v[42:43], v[42:43], s[20:21] neg_lo:[1,0,1] neg_hi:[1,0,1]
  v_pk_fma_f32 v[60:61], v[44:45], v[44:45], s[20:21] neg_lo:[1,0,1] neg_hi:[1,0,1]
  v_pk_fma_f32 v[62:63], v[46:47], v[46:47], s[20:21] neg_lo:[1,0,1] neg_hi:[1,0,1]
  v_pk_mul_f32 v[48:49], v[32:33], v[48:49]
  v_pk_mul_f32 v[50:51], v[34:35], v[50:51]
  v_pk_mul_f32 v[52:53], v[36:37], v[52:53]
  v_pk_mul_f32 v[54:55], v[38:39], v[54:55]
  v_pk_mul_f32 v[56:57], v[40:41], v[56:57]
  v_cvt_pk_bf16_f32 v184, v16, v17
  v_cvt_pk_bf16_f32 v185, v18, v19
  v_cvt_pk_bf16_f32 v186, v20, v21
  v_cvt_pk_bf16_f32 v187, v22, v23
  v_pk_mul_f32 v[58:59], v[42:43], v[58:59]
  v_pk_mul_f32 v[60:61], v[44:45], v[60:61]
  v_pk_mul_f32 v[62:63], v[46:47], v[62:63]
  v_mfma_f32_32x32x16_bf16 v[64:79], v[192:195], v[184:187], v[64:79]
  s_mov_b32 s28, s34
  v_cvt_pk_bf16_f32 v188, v24, v25
  v_cvt_pk_bf16_f32 v189, v26, v27
  v_cvt_pk_bf16_f32 v190, v28, v29
  v_cvt_pk_bf16_f32 v191, v30, v31
  v_exp_f32 v48, v48
  v_mfma_f32_16x16x32_bf16 v[132:135], v[216:219], v[220:223], 0
  ds_read_b128 v[216:219], v3 offset:2400
  ds_read_b128 v[220:223], v4 offset:96
  v_mfma_f32_32x32x16_bf16 v[80:95], v[196:199], v[184:187], v[80:95]
  s_add_u32 s34, s34, 0x60000
  ds_read_b128 v[16:19], v2 offset:1024
  ds_read_b128 v[20:23], v2 offset:1056
  v_exp_f32 v49, v49
  v_exp_f32 v50, v50
  v_mfma_f32_16x16x32_bf16 v[132:135], v[224:227], v[228:231], v[132:135]
  ds_read_b128 v[224:227], v3 offset:7200
  ds_read_b128 v[228:231], v4 offset:288
  v_mfma_f32_32x32x16_bf16 v[96:111], v[200:203], v[184:187], v[96:111]
  ds_read_b128 v[24:27], v2 offset:1088
  ds_read_b128 v[28:31], v2 offset:1120
  v_exp_f32 v51, v51
  v_exp_f32 v52, v52
  v_mfma_f32_16x16x32_bf16 v[132:135], v[232:235], v[236:239], v[132:135]
  ds_read_b128 v[232:235], v3 offset:12000
  ds_read_b128 v[236:239], v4 offset:480
  v_mfma_f32_32x32x16_bf16 v[64:79], v[204:207], v[188:191], v[64:79]
  v_exp_f32 v53, v53
  v_exp_f32 v54, v54
  v_exp_f32 v55, v55
  v_mfma_f32_32x32x16_bf16 v[80:95], v[208:211], v[188:191], v[80:95]
  v_exp_f32 v56, v56
  v_exp_f32 v57, v57
  v_exp_f32 v58, v58
  v_mfma_f32_32x32x16_bf16 v[96:111], v[212:215], v[188:191], v[96:111]
  s_waitcnt lgkmcnt(0)
  v_exp_f32 v59, v59
  v_exp_f32 v60, v60
  v_exp_f32 v61, v61
  v_exp_f32 v62, v62
  v_exp_f32 v63, v63
  v_pk_add_f32 v[12:13], v[12:13], v[132:133]
  v_pk_fma_f32 v[14:15], v[132:133], v[132:133], v[14:15]
  v_pk_add_f32 v[12:13], v[12:13], v[134:135]
  v_pk_fma_f32 v[14:15], v[134:135], v[134:135], v[14:15]
  v_pk_fma_f32 v[48:49], v[48:49], s[22:23], s[22:23]
  v_pk_fma_f32 v[50:51], v[50:51], s[22:23], s[22:23]
  v_pk_fma_f32 v[52:53], v[52:53], s[22:23], s[22:23]
  v_pk_fma_f32 v[54:55], v[54:55], s[22:23], s[22:23]
  v_pk_fma_f32 v[56:57], v[56:57], s[22:23], s[22:23]
  v_pk_fma_f32 v[58:59], v[58:59], s[22:23], s[22:23]
  v_pk_fma_f32 v[60:61], v[60:61], s[22:23], s[22:23]
  v_pk_fma_f32 v[62:63], v[62:63], s[22:23], s[22:23]
  v_mfma_f32_32x32x16_bf16 v[16:31], a[176:179], v[160:163], v[16:31]
  ds_read_b128 v[248:251], v0 offset:4096
  ds_read_b128 v[192:195], v1 offset:34816
  ds_read_b128 v[196:199], v1 offset:35840
  v_rcp_f32 v48, v48
  v_rcp_f32 v49, v49
  v_mfma_f32_16x16x32_bf16 v[136:139], v[216:219], v[220:223], 0
  ds_read_b128 v[216:219], v3 offset:2800
  ds_read_b128 v[220:223], v4 offset:112
  v_mfma_f32_32x32x16_bf16 v[16:31], a[180:183], v[164:167], v[16:31]
  ds_read_b128 v[200:203], v1 offset:36864
  ds_read_b128 v[204:207], v1 offset:37888
  v_rcp_f32 v50, v50
  v_rcp_f32 v51, v51
  v_mfma_f32_16x16x32_bf16 v[136:139], v[224:227], v[228:231], v[136:139]
  ds_read_b128 v[224:227], v3 offset:7600
  ds_read_b128 v[228:231], v4 offset:304
  v_mfma_f32_32x32x16_bf16 v[16:31], a[184:187], v[168:171], v[16:31]
  ds_read_b128 v[208:211], v1 offset:38912
  ds_read_b128 v[212:215], v1 offset:39936
  v_rcp_f32 v52, v52
  v_rcp_f32 v53, v53
  v_mfma_f32_16x16x32_bf16 v[136:139], v[232:235], v[236:239], v[136:139]
  ds_read_b128 v[232:235], v3 offset:12400
  ds_read_b128 v[236:239], v4 offset:496
  v_mfma_f32_32x32x16_bf16 v[16:31], a[188:191], v[172:175], v[16:31]
  v_rcp_f32 v54, v54
  v_rcp_f32 v55, v55
  v_rcp_f32 v56, v56
  v_mfma_f32_32x32x16_bf16 v[16:31], a[192:195], v[176:179], v[16:31]
  s_waitcnt lgkmcnt(12)
  v_rcp_f32 v57, v57
  v_rcp_f32 v58, v58
  v_rcp_f32 v59, v59
  v_mfma_f32_32x32x16_bf16 v[16:31], v[248:251], v[180:183], v[16:31]
  s_waitcnt lgkmcnt(0)
  v_rcp_f32 v60, v60
  v_rcp_f32 v61, v61
  v_rcp_f32 v62, v62
  v_rcp_f32 v63, v63
  v_pk_mul_f32 v[32:33], v[32:33], v[48:49]
  v_pk_mul_f32 v[34:35], v[34:35], v[50:51]
  v_pk_mul_f32 v[36:37], v[36:37], v[52:53]
  v_pk_mul_f32 v[38:39], v[38:39], v[54:55]
  v_pk_mul_f32 v[40:41], v[40:41], v[56:57]
  v_pk_mul_f32 v[42:43], v[42:43], v[58:59]
  v_pk_mul_f32 v[44:45], v[44:45], v[60:61]
  v_pk_mul_f32 v[46:47], v[46:47], v[62:63]
  v_pk_add_f32 v[12:13], v[12:13], v[136:137]
  v_pk_fma_f32 v[14:15], v[136:137], v[136:137], v[14:15]
  v_pk_add_f32 v[12:13], v[12:13], v[138:139]
  v_pk_fma_f32 v[14:15], v[138:139], v[138:139], v[14:15]
  v_pk_fma_f32 v[48:49], v[16:17], v[16:17], s[20:21] neg_lo:[1,0,1] neg_hi:[1,0,1]
  v_pk_fma_f32 v[50:51], v[18:19], v[18:19], s[20:21] neg_lo:[1,0,1] neg_hi:[1,0,1]
  v_pk_fma_f32 v[52:53], v[20:21], v[20:21], s[20:21] neg_lo:[1,0,1] neg_hi:[1,0,1]
  v_pk_fma_f32 v[54:55], v[22:23], v[22:23], s[20:21] neg_lo:[1,0,1] neg_hi:[1,0,1]
  v_pk_fma_f32 v[56:57], v[24:25], v[24:25], s[20:21] neg_lo:[1,0,1] neg_hi:[1,0,1]
  v_pk_fma_f32 v[58:59], v[26:27], v[26:27], s[20:21] neg_lo:[1,0,1] neg_hi:[1,0,1]
  v_pk_fma_f32 v[60:61], v[28:29], v[28:29], s[20:21] neg_lo:[1,0,1] neg_hi:[1,0,1]
  v_pk_fma_f32 v[62:63], v[30:31], v[30:31], s[20:21] neg_lo:[1,0,1] neg_hi:[1,0,1]
  v_pk_mul_f32 v[48:49], v[16:17], v[48:49]
  v_pk_mul_f32 v[50:51], v[18:19], v[50:51]
  v_pk_mul_f32 v[52:53], v[20:21], v[52:53]
  v_pk_mul_f32 v[54:55], v[22:23], v[54:55]
  v_pk_mul_f32 v[56:57], v[24:25], v[56:57]
  v_cvt_pk_bf16_f32 v184, v32, v33
  v_cvt_pk_bf16_f32 v185, v34, v35
  v_cvt_pk_bf16_f32 v186, v36, v37
  v_cvt_pk_bf16_f32 v187, v38, v39
  v_pk_mul_f32 v[58:59], v[26:27], v[58:59]
  v_pk_mul_f32 v[60:61], v[28:29], v[60:61]
  v_pk_mul_f32 v[62:63], v[30:31], v[62:63]
  v_mfma_f32_32x32x16_bf16 v[64:79], v[192:195], v[184:187], v[64:79]
  v_cvt_pk_bf16_f32 v188, v40, v41
  v_cvt_pk_bf16_f32 v189, v42, v43
  v_cvt_pk_bf16_f32 v190, v44, v45
  v_cvt_pk_bf16_f32 v191, v46, v47
  v_exp_f32 v48, v48
  v_mfma_f32_16x16x32_bf16 v[140:143], v[216:219], v[220:223], 0
  ds_read_b128 v[216:219], v3 offset:3200
  ds_read_b128 v[220:223], v4 offset:128
  v_mfma_f32_32x32x16_bf16 v[80:95], v[196:199], v[184:187], v[80:95]
  ds_read_b128 v[32:35], v2 offset:1152
  ds_read_b128 v[36:39], v2 offset:1184
  v_exp_f32 v49, v49
  v_exp_f32 v50, v50
  v_mfma_f32_16x16x32_bf16 v[140:143], v[224:227], v[228:231], v[140:143]
  ds_read_b128 v[224:227], v3 offset:8000
  ds_read_b128 v[228:231], v4 offset:320
  v_mfma_f32_32x32x16_bf16 v[96:111], v[200:203], v[184:187], v[96:111]
  ds_read_b128 v[40:43], v2 offset:1216
  ds_read_b128 v[44:47], v2 offset:1248
  v_exp_f32 v51, v51
  v_exp_f32 v52, v52
  v_mfma_f32_16x16x32_bf16 v[140:143], v[232:235], v[236:239], v[140:143]
  ds_read_b128 v[232:235], v3 offset:12800
  ds_read_b128 v[236:239], v4 offset:512
  v_mfma_f32_32x32x16_bf16 v[64:79], v[204:207], v[188:191], v[64:79]
  v_exp_f32 v53, v53
  v_exp_f32 v54, v54
  v_exp_f32 v55, v55
  v_mfma_f32_32x32x16_bf16 v[80:95], v[208:211], v[188:191], v[80:95]
  v_exp_f32 v56, v56
  v_exp_f32 v57, v57
  v_exp_f32 v58, v58
  v_mfma_f32_32x32x16_bf16 v[96:111], v[212:215], v[188:191], v[96:111]
  s_waitcnt lgkmcnt(0)
  v_exp_f32 v59, v59
  v_exp_f32 v60, v60
  v_exp_f32 v61, v61
  v_exp_f32 v62, v62
  v_exp_f32 v63, v63
  v_pk_add_f32 v[12:13], v[12:13], v[140:141]
  v_pk_fma_f32 v[14:15], v[140:141], v[140:141], v[14:15]
  v_pk_add_f32 v[12:13], v[12:13], v[142:143]
  v_pk_fma_f32 v[14:15], v[142:143], v[142:143], v[14:15]
  v_pk_fma_f32 v[48:49], v[48:49], s[22:23], s[22:23]
  v_pk_fma_f32 v[50:51], v[50:51], s[22:23], s[22:23]
  v_pk_fma_f32 v[52:53], v[52:53], s[22:23], s[22:23]
  v_pk_fma_f32 v[54:55], v[54:55], s[22:23], s[22:23]
  v_pk_fma_f32 v[56:57], v[56:57], s[22:23], s[22:23]
  v_pk_fma_f32 v[58:59], v[58:59], s[22:23], s[22:23]
  v_pk_fma_f32 v[60:61], v[60:61], s[22:23], s[22:23]
  v_pk_fma_f32 v[62:63], v[62:63], s[22:23], s[22:23]
  v_mfma_f32_32x32x16_bf16 v[32:47], a[196:199], v[160:163], v[32:47]
  ds_read_b128 v[248:251], v0 offset:5120
  ds_read_b128 v[192:195], v1 offset:40960
  ds_read_b128 v[196:199], v1 offset:41984
  v_rcp_f32 v48, v48
  v_rcp_f32 v49, v49
  v_mfma_f32_16x16x32_bf16 v[144:147], v[216:219], v[220:223], 0
  ds_read_b128 v[216:219], v3 offset:3600
  ds_read_b128 v[220:223], v4 offset:144
  v_mfma_f32_32x32x16_bf16 v[32:47], a[200:203], v[164:167], v[32:47]
  ds_read_b128 v[200:203], v1 offset:43008
  ds_read_b128 v[204:207], v1 offset:44032
  v_rcp_f32 v50, v50
  v_rcp_f32 v51, v51
  v_mfma_f32_16x16x32_bf16 v[144:147], v[224:227], v[228:231], v[144:147]
  ds_read_b128 v[224:227], v3 offset:8400
  ds_read_b128 v[228:231], v4 offset:336
  v_mfma_f32_32x32x16_bf16 v[32:47], a[204:207], v[168:171], v[32:47]
  ds_read_b128 v[208:211], v1 offset:45056
  ds_read_b128 v[212:215], v1 offset:46080
  v_rcp_f32 v52, v52
  v_rcp_f32 v53, v53
  v_mfma_f32_16x16x32_bf16 v[144:147], v[232:235], v[236:239], v[144:147]
  ds_read_b128 v[232:235], v3 offset:13200
  ds_read_b128 v[236:239], v4 offset:528
  v_mfma_f32_32x32x16_bf16 v[32:47], a[208:211], v[172:175], v[32:47]
  v_rcp_f32 v54, v54
  v_rcp_f32 v55, v55
  v_rcp_f32 v56, v56
  v_mfma_f32_32x32x16_bf16 v[32:47], a[212:215], v[176:179], v[32:47]
  s_waitcnt lgkmcnt(12)
  v_rcp_f32 v57, v57
  v_rcp_f32 v58, v58
  v_rcp_f32 v59, v59
  v_mfma_f32_32x32x16_bf16 v[32:47], v[248:251], v[180:183], v[32:47]
  s_waitcnt lgkmcnt(0)
  v_rcp_f32 v60, v60
  v_rcp_f32 v61, v61
  v_rcp_f32 v62, v62
  v_rcp_f32 v63, v63
  v_pk_mul_f32 v[16:17], v[16:17], v[48:49]
  v_pk_mul_f32 v[18:19], v[18:19], v[50:51]
  v_pk_mul_f32 v[20:21], v[20:21], v[52:53]
  v_pk_mul_f32 v[22:23], v[22:23], v[54:55]
  v_pk_mul_f32 v[24:25], v[24:25], v[56:57]
  v_pk_mul_f32 v[26:27], v[26:27], v[58:59]
  v_pk_mul_f32 v[28:29], v[28:29], v[60:61]
  v_pk_mul_f32 v[30:31], v[30:31], v[62:63]
  v_pk_add_f32 v[12:13], v[12:13], v[144:145]
  v_pk_fma_f32 v[14:15], v[144:145], v[144:145], v[14:15]
  v_pk_add_f32 v[12:13], v[12:13], v[146:147]
  v_pk_fma_f32 v[14:15], v[146:147], v[146:147], v[14:15]
  v_pk_fma_f32 v[48:49], v[32:33], v[32:33], s[20:21] neg_lo:[1,0,1] neg_hi:[1,0,1]
  v_pk_fma_f32 v[50:51], v[34:35], v[34:35], s[20:21] neg_lo:[1,0,1] neg_hi:[1,0,1]
  v_pk_fma_f32 v[52:53], v[36:37], v[36:37], s[20:21] neg_lo:[1,0,1] neg_hi:[1,0,1]
  v_pk_fma_f32 v[54:55], v[38:39], v[38:39], s[20:21] neg_lo:[1,0,1] neg_hi:[1,0,1]
  v_pk_fma_f32 v[56:57], v[40:41], v[40:41], s[20:21] neg_lo:[1,0,1] neg_hi:[1,0,1]
  v_pk_fma_f32 v[58:59], v[42:43], v[42:43], s[20:21] neg_lo:[1,0,1] neg_hi:[1,0,1]
  v_pk_fma_f32 v[60:61], v[44:45], v[44:45], s[20:21] neg_lo:[1,0,1] neg_hi:[1,0,1]
  v_pk_fma_f32 v[62:63], v[46:47], v[46:47], s[20:21] neg_lo:[1,0,1] neg_hi:[1,0,1]
  v_pk_mul_f32 v[48:49], v[32:33], v[48:49]
  v_pk_mul_f32 v[50:51], v[34:35], v[50:51]
  v_pk_mul_f32 v[52:53], v[36:37], v[52:53]
  v_pk_mul_f32 v[54:55], v[38:39], v[54:55]
  v_pk_mul_f32 v[56:57], v[40:41], v[56:57]
  v_cvt_pk_bf16_f32 v184, v16, v17
  v_cvt_pk_bf16_f32 v185, v18, v19
  v_cvt_pk_bf16_f32 v186, v20, v21
  v_cvt_pk_bf16_f32 v187, v22, v23
  v_pk_mul_f32 v[58:59], v[42:43], v[58:59]
  v_pk_mul_f32 v[60:61], v[44:45], v[60:61]
  v_pk_mul_f32 v[62:63], v[46:47], v[62:63]
  v_mfma_f32_32x32x16_bf16 v[64:79], v[192:195], v[184:187], v[64:79]
  v_cvt_pk_bf16_f32 v188, v24, v25
  v_cvt_pk_bf16_f32 v189, v26, v27
  v_cvt_pk_bf16_f32 v190, v28, v29
  v_cvt_pk_bf16_f32 v191, v30, v31
  v_exp_f32 v48, v48
  v_mfma_f32_16x16x32_bf16 v[148:151], v[216:219], v[220:223], 0
  ds_read_b128 v[216:219], v3 offset:4000
  ds_read_b128 v[220:223], v4 offset:160
  v_mfma_f32_32x32x16_bf16 v[80:95], v[196:199], v[184:187], v[80:95]
  ds_read_b128 v[16:19], v2 offset:1280
  ds_read_b128 v[20:23], v2 offset:1312
  v_exp_f32 v49, v49
  v_exp_f32 v50, v50
  v_mfma_f32_16x16x32_bf16 v[148:151], v[224:227], v[228:231], v[148:151]
  ds_read_b128 v[224:227], v3 offset:8800
  ds_read_b128 v[228:231], v4 offset:352
  v_mfma_f32_32x32x16_bf16 v[96:111], v[200:203], v[184:187], v[96:111]
  ds_read_b128 v[24:27], v2 offset:1344
  ds_read_b128 v[28:31], v2 offset:1376
  v_exp_f32 v51, v51
  v_exp_f32 v52, v52
  v_mfma_f32_16x16x32_bf16 v[148:151], v[232:235], v[236:239], v[148:151]
  ds_read_b128 v[232:235], v3 offset:13600
  ds_read_b128 v[236:239], v4 offset:544
  v_mfma_f32_32x32x16_bf16 v[64:79], v[204:207], v[188:191], v[64:79]
  v_exp_f32 v53, v53
  v_exp_f32 v54, v54
  v_exp_f32 v55, v55
  v_mfma_f32_32x32x16_bf16 v[80:95], v[208:211], v[188:191], v[80:95]
  v_exp_f32 v56, v56
  v_exp_f32 v57, v57
  v_exp_f32 v58, v58
  v_mfma_f32_32x32x16_bf16 v[96:111], v[212:215], v[188:191], v[96:111]
  s_waitcnt lgkmcnt(0)
  v_exp_f32 v59, v59
  v_exp_f32 v60, v60
  v_exp_f32 v61, v61
  v_exp_f32 v62, v62
  v_exp_f32 v63, v63
  v_pk_add_f32 v[12:13], v[12:13], v[148:149]
  v_pk_fma_f32 v[14:15], v[148:149], v[148:149], v[14:15]
  v_pk_add_f32 v[12:13], v[12:13], v[150:151]
  v_pk_fma_f32 v[14:15], v[150:151], v[150:151], v[14:15]
  v_pk_fma_f32 v[48:49], v[48:49], s[22:23], s[22:23]
  v_pk_fma_f32 v[50:51], v[50:51], s[22:23], s[22:23]
  v_pk_fma_f32 v[52:53], v[52:53], s[22:23], s[22:23]
  v_pk_fma_f32 v[54:55], v[54:55], s[22:23], s[22:23]
  v_pk_fma_f32 v[56:57], v[56:57], s[22:23], s[22:23]
  v_pk_fma_f32 v[58:59], v[58:59], s[22:23], s[22:23]
  v_pk_fma_f32 v[60:61], v[60:61], s[22:23], s[22:23]
  v_pk_fma_f32 v[62:63], v[62:63], s[22:23], s[22:23]
  v_mfma_f32_32x32x16_bf16 v[16:31], a[216:219], v[160:163], v[16:31]
  ds_read_b128 v[248:251], v0 offset:6144
  ds_read_b128 v[192:195], v1 offset:47104
  ds_read_b128 v[196:199], v1 offset:48128
  v_rcp_f32 v48, v48
  v_rcp_f32 v49, v49
  v_mfma_f32_16x16x32_bf16 v[152:155], v[216:219], v[220:223], 0
  ds_read_b128 v[216:219], v3 offset:4400
  ds_read_b128 v[220:223], v4 offset:176
  v_mfma_f32_32x32x16_bf16 v[16:31], a[220:223], v[164:167], v[16:31]
  ds_read_b128 v[200:203], v1 offset:49152
  ds_read_b128 v[204:207], v1 offset:50176
  v_rcp_f32 v50, v50
  v_rcp_f32 v51, v51
  v_mfma_f32_16x16x32_bf16 v[152:155], v[224:227], v[228:231], v[152:155]
  ds_read_b128 v[224:227], v3 offset:9200
  ds_read_b128 v[228:231], v4 offset:368
  v_mfma_f32_32x32x16_bf16 v[16:31], a[224:227], v[168:171], v[16:31]
  ds_read_b128 v[208:211], v1 offset:51200
  ds_read_b128 v[212:215], v1 offset:52224
  v_rcp_f32 v52, v52
  v_rcp_f32 v53, v53
  v_mfma_f32_16x16x32_bf16 v[152:155], v[232:235], v[236:239], v[152:155]
  ds_read_b128 v[232:235], v3 offset:14000
  ds_read_b128 v[236:239], v4 offset:560
  v_mfma_f32_32x32x16_bf16 v[16:31], a[228:231], v[172:175], v[16:31]
  v_rcp_f32 v54, v54
  v_rcp_f32 v55, v55
  v_rcp_f32 v56, v56
  v_mfma_f32_32x32x16_bf16 v[16:31], a[232:235], v[176:179], v[16:31]
  s_waitcnt lgkmcnt(12)
  v_rcp_f32 v57, v57
  v_rcp_f32 v58, v58
  v_rcp_f32 v59, v59
  v_mfma_f32_32x32x16_bf16 v[16:31], v[248:251], v[180:183], v[16:31]
  s_waitcnt lgkmcnt(0)
  v_rcp_f32 v60, v60
  v_rcp_f32 v61, v61
  v_rcp_f32 v62, v62
  v_rcp_f32 v63, v63
  v_pk_mul_f32 v[32:33], v[32:33], v[48:49]
  v_pk_mul_f32 v[34:35], v[34:35], v[50:51]
  v_pk_mul_f32 v[36:37], v[36:37], v[52:53]
  v_pk_mul_f32 v[38:39], v[38:39], v[54:55]
  v_pk_mul_f32 v[40:41], v[40:41], v[56:57]
  v_pk_mul_f32 v[42:43], v[42:43], v[58:59]
  v_pk_mul_f32 v[44:45], v[44:45], v[60:61]
  v_pk_mul_f32 v[46:47], v[46:47], v[62:63]
  v_pk_add_f32 v[12:13], v[12:13], v[152:153]
  v_pk_fma_f32 v[14:15], v[152:153], v[152:153], v[14:15]
  v_pk_add_f32 v[12:13], v[12:13], v[154:155]
  v_pk_fma_f32 v[14:15], v[154:155], v[154:155], v[14:15]
  v_pk_fma_f32 v[48:49], v[16:17], v[16:17], s[20:21] neg_lo:[1,0,1] neg_hi:[1,0,1]
  v_pk_fma_f32 v[50:51], v[18:19], v[18:19], s[20:21] neg_lo:[1,0,1] neg_hi:[1,0,1]
  v_pk_fma_f32 v[52:53], v[20:21], v[20:21], s[20:21] neg_lo:[1,0,1] neg_hi:[1,0,1]
  v_pk_fma_f32 v[54:55], v[22:23], v[22:23], s[20:21] neg_lo:[1,0,1] neg_hi:[1,0,1]
  v_pk_fma_f32 v[56:57], v[24:25], v[24:25], s[20:21] neg_lo:[1,0,1] neg_hi:[1,0,1]
  v_pk_fma_f32 v[58:59], v[26:27], v[26:27], s[20:21] neg_lo:[1,0,1] neg_hi:[1,0,1]
  v_pk_fma_f32 v[60:61], v[28:29], v[28:29], s[20:21] neg_lo:[1,0,1] neg_hi:[1,0,1]
  v_pk_fma_f32 v[62:63], v[30:31], v[30:31], s[20:21] neg_lo:[1,0,1] neg_hi:[1,0,1]
  v_pk_mul_f32 v[48:49], v[16:17], v[48:49]
  v_pk_mul_f32 v[50:51], v[18:19], v[50:51]
  v_pk_mul_f32 v[52:53], v[20:21], v[52:53]
  v_pk_mul_f32 v[54:55], v[22:23], v[54:55]
  v_pk_mul_f32 v[56:57], v[24:25], v[56:57]
  v_cvt_pk_bf16_f32 v184, v32, v33
  v_cvt_pk_bf16_f32 v185, v34, v35
  v_cvt_pk_bf16_f32 v186, v36, v37
  v_cvt_pk_bf16_f32 v187, v38, v39
  v_pk_mul_f32 v[58:59], v[26:27], v[58:59]
  v_pk_mul_f32 v[60:61], v[28:29], v[60:61]
  v_pk_mul_f32 v[62:63], v[30:31], v[62:63]
  v_mfma_f32_32x32x16_bf16 v[64:79], v[192:195], v[184:187], v[64:79]
  v_cvt_pk_bf16_f32 v188, v40, v41
  v_cvt_pk_bf16_f32 v189, v42, v43
  v_cvt_pk_bf16_f32 v190, v44, v45
  v_cvt_pk_bf16_f32 v191, v46, v47
  v_exp_f32 v48, v48
  v_mfma_f32_16x16x32_bf16 v[156:159], v[216:219], v[220:223], 0
  v_exp_f32 v49, v49
  v_mfma_f32_32x32x16_bf16 v[80:95], v[196:199], v[184:187], v[80:95]
  ds_read_b128 v[32:35], v2 offset:1408
  ds_read_b128 v[36:39], v2 offset:1440
  v_exp_f32 v50, v50
  v_exp_f32 v51, v51
  v_mfma_f32_16x16x32_bf16 v[156:159], v[224:227], v[228:231], v[156:159]
  v_exp_f32 v52, v52
  v_mfma_f32_32x32x16_bf16 v[96:111], v[200:203], v[184:187], v[96:111]
  ds_read_b128 v[40:43], v2 offset:1472
  ds_read_b128 v[44:47], v2 offset:1504
  v_exp_f32 v53, v53
  v_exp_f32 v54, v54
  v_mfma_f32_16x16x32_bf16 v[156:159], v[232:235], v[236:239], v[156:159]
  v_exp_f32 v55, v55
  v_mfma_f32_32x32x16_bf16 v[64:79], v[204:207], v[188:191], v[64:79]
  v_exp_f32 v56, v56
  v_exp_f32 v57, v57
  v_exp_f32 v58, v58
  v_mfma_f32_32x32x16_bf16 v[80:95], v[208:211], v[188:191], v[80:95]
  v_exp_f32 v59, v59
  v_exp_f32 v60, v60
  v_exp_f32 v61, v61
  v_mfma_f32_32x32x16_bf16 v[96:111], v[212:215], v[188:191], v[96:111]
  s_waitcnt lgkmcnt(0)
  v_exp_f32 v62, v62
  v_exp_f32 v63, v63
  v_pk_add_f32 v[12:13], v[12:13], v[156:157]
  v_pk_fma_f32 v[14:15], v[156:157], v[156:157], v[14:15]
  v_pk_add_f32 v[12:13], v[12:13], v[158:159]
  v_pk_fma_f32 v[14:15], v[158:159], v[158:159], v[14:15]
  v_pk_fma_f32 v[48:49], v[48:49], s[22:23], s[22:23]
  v_pk_fma_f32 v[50:51], v[50:51], s[22:23], s[22:23]
  v_pk_fma_f32 v[52:53], v[52:53], s[22:23], s[22:23]
  v_pk_fma_f32 v[54:55], v[54:55], s[22:23], s[22:23]
  v_pk_fma_f32 v[56:57], v[56:57], s[22:23], s[22:23]
  v_pk_fma_f32 v[58:59], v[58:59], s[22:23], s[22:23]
  v_pk_fma_f32 v[60:61], v[60:61], s[22:23], s[22:23]
  v_pk_fma_f32 v[62:63], v[62:63], s[22:23], s[22:23]
  v_mfma_f32_32x32x16_bf16 v[32:47], a[236:239], v[160:163], v[32:47]
  ds_read_b128 v[248:251], v0 offset:7168
  ds_read_b128 v[192:195], v1 offset:53248
  ds_read_b128 v[196:199], v1 offset:54272
  v_rcp_f32 v48, v48
  v_rcp_f32 v49, v49
  v_add_f32 v12, v12, v13
  v_mfma_f32_32x32x16_bf16 v[32:47], a[240:243], v[164:167], v[32:47]
  ds_read_b128 v[200:203], v1 offset:55296
  ds_read_b128 v[204:207], v1 offset:56320
  v_rcp_f32 v50, v50
  v_add_f32 v14, v14, v15
  v_rcp_f32 v51, v51
  s_nop 0
  v_permlane32_swap_b32 v12, v14
  v_mfma_f32_32x32x16_bf16 v[32:47], a[244:247], v[168:171], v[32:47]
  ds_read_b128 v[208:211], v1 offset:57344
  ds_read_b128 v[212:215], v1 offset:58368
  v_rcp_f32 v52, v52
  v_add_f32 v12, v12, v14
  v_rcp_f32 v53, v53
  v_mov_b32 v14, v12
  v_mfma_f32_32x32x16_bf16 v[32:47], a[248:251], v[172:175], v[32:47]
  v_rcp_f32 v54, v54
  v_permlane32_swap_b32 v12, v14
  v_rcp_f32 v55, v55
  v_mul_f32 v12, s24, v12
  v_rcp_f32 v56, v56
  v_mfma_f32_32x32x16_bf16 v[32:47], a[252:255], v[176:179], v[32:47]
  s_waitcnt lgkmcnt(6)
  v_mul_f32 v13, s24, v14
  v_rcp_f32 v57, v57
  v_fma_f32 v13, -v12, v12, v13
  v_rcp_f32 v58, v58
  v_max_f32 v13, 0, v13
  v_rcp_f32 v59, v59
  v_mfma_f32_32x32x16_bf16 v[32:47], v[248:251], v[180:183], v[32:47]
  s_waitcnt lgkmcnt(0)
  v_add_f32 v13, s25, v13
  v_rcp_f32 v60, v60
  v_rsq_f32 v13, v13
  v_rcp_f32 v61, v61
  v_sub_f32 v12, 0, v12
  v_rcp_f32 v62, v62
  v_mul_f32 v14, s22, v13
  v_rcp_f32 v63, v63
  v_mul_f32 v12, v12, v14
  v_pk_mul_f32 v[16:17], v[16:17], v[48:49]
  v_pk_mul_f32 v[18:19], v[18:19], v[50:51]
  v_pk_mul_f32 v[20:21], v[20:21], v[52:53]
  v_pk_mul_f32 v[22:23], v[22:23], v[54:55]
  v_pk_mul_f32 v[24:25], v[24:25], v[56:57]
  v_pk_mul_f32 v[26:27], v[26:27], v[58:59]
  v_pk_mul_f32 v[28:29], v[28:29], v[60:61]
  v_pk_mul_f32 v[30:31], v[30:31], v[62:63]
  v_pk_fma_f32 v[112:113], v[112:113], v[14:15], v[12:13] op_sel_hi:[1,0,0]
  v_pk_fma_f32 v[114:115], v[114:115], v[14:15], v[12:13] op_sel_hi:[1,0,0]
  v_pk_fma_f32 v[116:117], v[116:117], v[14:15], v[12:13] op_sel_hi:[1,0,0]
  v_pk_fma_f32 v[118:119], v[118:119], v[14:15], v[12:13] op_sel_hi:[1,0,0]
  v_pk_fma_f32 v[120:121], v[120:121], v[14:15], v[12:13] op_sel_hi:[1,0,0]
  v_pk_fma_f32 v[122:123], v[122:123], v[14:15], v[12:13] op_sel_hi:[1,0,0]
  v_pk_fma_f32 v[124:125], v[124:125], v[14:15], v[12:13] op_sel_hi:[1,0,0]
  v_pk_fma_f32 v[126:127], v[126:127], v[14:15], v[12:13] op_sel_hi:[1,0,0]
  v_pk_fma_f32 v[128:129], v[128:129], v[14:15], v[12:13] op_sel_hi:[1,0,0]
  v_pk_fma_f32 v[130:131], v[130:131], v[14:15], v[12:13] op_sel_hi:[1,0,0]
  v_pk_fma_f32 v[132:133], v[132:133], v[14:15], v[12:13] op_sel_hi:[1,0,0]
  v_pk_fma_f32 v[134:135], v[134:135], v[14:15], v[12:13] op_sel_hi:[1,0,0]
  v_pk_fma_f32 v[136:137], v[136:137], v[14:15], v[12:13] op_sel_hi:[1,0,0]
  v_pk_fma_f32 v[138:139], v[138:139], v[14:15], v[12:13] op_sel_hi:[1,0,0]
  v_pk_fma_f32 v[140:141], v[140:141], v[14:15], v[12:13] op_sel_hi:[1,0,0]
  v_pk_fma_f32 v[142:143], v[142:143], v[14:15], v[12:13] op_sel_hi:[1,0,0]
  v_pk_fma_f32 v[144:145], v[144:145], v[14:15], v[12:13] op_sel_hi:[1,0,0]
  v_pk_fma_f32 v[146:147], v[146:147], v[14:15], v[12:13] op_sel_hi:[1,0,0]
  v_pk_fma_f32 v[148:149], v[148:149], v[14:15], v[12:13] op_sel_hi:[1,0,0]
  v_pk_fma_f32 v[150:151], v[150:151], v[14:15], v[12:13] op_sel_hi:[1,0,0]
  v_pk_fma_f32 v[152:153], v[152:153], v[14:15], v[12:13] op_sel_hi:[1,0,0]
  v_pk_fma_f32 v[154:155], v[154:155], v[14:15], v[12:13] op_sel_hi:[1,0,0]
  v_pk_fma_f32 v[156:157], v[156:157], v[14:15], v[12:13] op_sel_hi:[1,0,0]
  v_pk_fma_f32 v[158:159], v[158:159], v[14:15], v[12:13] op_sel_hi:[1,0,0]
  v_pk_fma_f32 v[48:49], v[32:33], v[32:33], s[20:21] neg_lo:[1,0,1] neg_hi:[1,0,1]
  v_pk_fma_f32 v[50:51], v[34:35], v[34:35], s[20:21] neg_lo:[1,0,1] neg_hi:[1,0,1]
  v_pk_fma_f32 v[52:53], v[36:37], v[36:37], s[20:21] neg_lo:[1,0,1] neg_hi:[1,0,1]
  v_pk_fma_f32 v[54:55], v[38:39], v[38:39], s[20:21] neg_lo:[1,0,1] neg_hi:[1,0,1]
  v_pk_fma_f32 v[56:57], v[40:41], v[40:41], s[20:21] neg_lo:[1,0,1] neg_hi:[1,0,1]
  v_pk_fma_f32 v[58:59], v[42:43], v[42:43], s[20:21] neg_lo:[1,0,1] neg_hi:[1,0,1]
  v_pk_fma_f32 v[60:61], v[44:45], v[44:45], s[20:21] neg_lo:[1,0,1] neg_hi:[1,0,1]
  v_pk_fma_f32 v[62:63], v[46:47], v[46:47], s[20:21] neg_lo:[1,0,1] neg_hi:[1,0,1]
  v_pk_mul_f32 v[48:49], v[32:33], v[48:49]
  v_pk_mul_f32 v[50:51], v[34:35], v[50:51]
  v_pk_mul_f32 v[52:53], v[36:37], v[52:53]
  v_pk_mul_f32 v[54:55], v[38:39], v[54:55]
  v_pk_mul_f32 v[56:57], v[40:41], v[56:57]
  v_cvt_pk_bf16_f32 v184, v16, v17
  v_cvt_pk_bf16_f32 v185, v18, v19
  v_cvt_pk_bf16_f32 v186, v20, v21
  v_cvt_pk_bf16_f32 v187, v22, v23
  v_pk_mul_f32 v[58:59], v[42:43], v[58:59]
  v_pk_mul_f32 v[60:61], v[44:45], v[60:61]
  v_pk_mul_f32 v[62:63], v[46:47], v[62:63]
  v_mfma_f32_32x32x16_bf16 v[64:79], v[192:195], v[184:187], v[64:79]
  v_cvt_pk_bf16_f32 v188, v24, v25
  v_cvt_pk_bf16_f32 v189, v26, v27
  v_cvt_pk_bf16_f32 v190, v28, v29
  v_cvt_pk_bf16_f32 v191, v30, v31
  v_exp_f32 v48, v48
  v_cvt_pk_bf16_f32 v160, v112, v113
  v_exp_f32 v49, v49
  v_cvt_pk_bf16_f32 v161, v114, v115
  v_mfma_f32_32x32x16_bf16 v[80:95], v[196:199], v[184:187], v[80:95]
  ds_read_b128 v[16:19], v2
  ds_read_b128 v[20:23], v2 offset:32
  v_cvt_pk_bf16_f32 v162, v116, v117
  v_exp_f32 v50, v50
  v_cvt_pk_bf16_f32 v163, v118, v119
  v_exp_f32 v51, v51
  v_cvt_pk_bf16_f32 v164, v120, v121
  v_cvt_pk_bf16_f32 v165, v122, v123
  v_mfma_f32_32x32x16_bf16 v[96:111], v[200:203], v[184:187], v[96:111]
  ds_read_b128 v[24:27], v2 offset:64
  ds_read_b128 v[28:31], v2 offset:96
  v_exp_f32 v52, v52
  v_cvt_pk_bf16_f32 v166, v124, v125
  v_exp_f32 v53, v53
  v_cvt_pk_bf16_f32 v167, v126, v127
  v_cvt_pk_bf16_f32 v168, v128, v129
  v_mfma_f32_32x32x16_bf16 v[64:79], v[204:207], v[188:191], v[64:79]
  v_exp_f32 v54, v54
  v_cvt_pk_bf16_f32 v169, v130, v131
  v_exp_f32 v55, v55
  v_cvt_pk_bf16_f32 v170, v132, v133
  v_cvt_pk_bf16_f32 v171, v134, v135
  v_exp_f32 v56, v56
  v_cvt_pk_bf16_f32 v172, v136, v137
  v_mfma_f32_32x32x16_bf16 v[80:95], v[208:211], v[188:191], v[80:95]
  v_exp_f32 v57, v57
  v_cvt_pk_bf16_f32 v173, v138, v139
  v_cvt_pk_bf16_f32 v174, v140, v141
  v_exp_f32 v58, v58
  v_cvt_pk_bf16_f32 v175, v142, v143
  v_exp_f32 v59, v59
  v_cvt_pk_bf16_f32 v176, v144, v145
  v_mfma_f32_32x32x16_bf16 v[96:111], v[212:215], v[188:191], v[96:111]
  s_waitcnt lgkmcnt(0)
  v_cvt_pk_bf16_f32 v177, v146, v147
  v_exp_f32 v60, v60
  v_cvt_pk_bf16_f32 v178, v148, v149
  v_exp_f32 v61, v61
  v_cvt_pk_bf16_f32 v179, v150, v151
  v_cvt_pk_bf16_f32 v180, v152, v153
  v_exp_f32 v62, v62
  v_cvt_pk_bf16_f32 v181, v154, v155
  v_exp_f32 v63, v63
  v_cvt_pk_bf16_f32 v182, v156, v157
  v_cvt_pk_bf16_f32 v183, v158, v159
  v_subrev_u32 v11, 0x4100, v4
  v_add_u32 v4, 0x8200, v4
  v_min_u32 v4, v11, v4
  v_pk_fma_f32 v[48:49], v[48:49], s[22:23], s[22:23]
  v_pk_fma_f32 v[50:51], v[50:51], s[22:23], s[22:23]
  v_pk_fma_f32 v[52:53], v[52:53], s[22:23], s[22:23]
  v_pk_fma_f32 v[54:55], v[54:55], s[22:23], s[22:23]
  v_pk_fma_f32 v[56:57], v[56:57], s[22:23], s[22:23]
  v_pk_fma_f32 v[58:59], v[58:59], s[22:23], s[22:23]
  v_pk_fma_f32 v[60:61], v[60:61], s[22:23], s[22:23]
  v_pk_fma_f32 v[62:63], v[62:63], s[22:23], s[22:23]
  s_sub_u32 s26, s26, 1
  s_cmp_lg_u32 s26, 0
  s_cbranch_scc1 L_loop
  ds_read_b128 v[192:195], v1 offset:59392
  ds_read_b128 v[196:199], v1 offset:60416
  ds_read_b128 v[200:203], v1 offset:61440
  ds_read_b128 v[204:207], v1 offset:62464
  ds_read_b128 v[208:211], v1 offset:63488
  ds_read_b128 v[212:215], v1 offset:64512
  v_rcp_f32 v48, v48
  v_rcp_f32 v49, v49
  v_rcp_f32 v50, v50
  v_rcp_f32 v51, v51
  v_rcp_f32 v52, v52
  v_rcp_f32 v53, v53
  v_rcp_f32 v54, v54
  v_rcp_f32 v55, v55
  v_rcp_f32 v56, v56
  v_rcp_f32 v57, v57
  v_rcp_f32 v58, v58
  v_rcp_f32 v59, v59
  v_rcp_f32 v60, v60
  v_rcp_f32 v61, v61
  v_rcp_f32 v62, v62
  v_rcp_f32 v63, v63
  v_pk_mul_f32 v[32:33], v[32:33], v[48:49]
  v_pk_mul_f32 v[34:35], v[34:35], v[50:51]
  v_pk_mul_f32 v[36:37], v[36:37], v[52:53]
  v_pk_mul_f32 v[38:39], v[38:39], v[54:55]
  v_pk_mul_f32 v[40:41], v[40:41], v[56:57]
  v_pk_mul_f32 v[42:43], v[42:43], v[58:59]
  v_pk_mul_f32 v[44:45], v[44:45], v[60:61]
  v_pk_mul_f32 v[46:47], v[46:47], v[62:63]
  v_cvt_pk_bf16_f32 v184, v32, v33
  v_cvt_pk_bf16_f32 v185, v34, v35
  v_cvt_pk_bf16_f32 v186, v36, v37
  v_cvt_pk_bf16_f32 v187, v38, v39
  v_cvt_pk_bf16_f32 v188, v40, v41
  v_cvt_pk_bf16_f32 v189, v42, v43
  v_cvt_pk_bf16_f32 v190, v44, v45
  v_cvt_pk_bf16_f32 v191, v46, v47
  s_waitcnt lgkmcnt(5)
  v_mfma_f32_32x32x16_bf16 v[64:79], v[192:195], v[184:187], v[64:79]
  s_waitcnt lgkmcnt(2)
  v_mfma_f32_32x32x16_bf16 v[64:79], v[204:207], v[188:191], v[64:79]
  v_mfma_f32_32x32x16_bf16 v[80:95], v[196:199], v[184:187], v[80:95]
  s_waitcnt lgkmcnt(1)
  v_mfma_f32_32x32x16_bf16 v[80:95], v[208:211], v[188:191], v[80:95]
  v_mfma_f32_32x32x16_bf16 v[96:111], v[200:203], v[184:187], v[96:111]
  s_waitcnt lgkmcnt(0)
  v_mfma_f32_32x32x16_bf16 v[96:111], v[212:215], v[188:191], v[96:111]
  s_nop 5
  v_cvt_pk_bf16_f32 v112, v64, v65
  v_cvt_pk_bf16_f32 v113, v66, v67
  v_cvt_pk_bf16_f32 v114, v68, v69
  v_cvt_pk_bf16_f32 v115, v70, v71
  buffer_store_dwordx4 v[112:115], v10, s[8:11], s28 offen
  v_cvt_pk_bf16_f32 v116, v72, v73
  v_cvt_pk_bf16_f32 v117, v74, v75
  v_cvt_pk_bf16_f32 v118, v76, v77
  v_cvt_pk_bf16_f32 v119, v78, v79
  buffer_store_dwordx4 v[116:119], v10, s[8:11], s28 offen offset:32
  v_cvt_pk_bf16_f32 v120, v80, v81
  v_cvt_pk_bf16_f32 v121, v82, v83
  v_cvt_pk_bf16_f32 v122, v84, v85
  v_cvt_pk_bf16_f32 v123, v86, v87
  buffer_store_dwordx4 v[120:123], v10, s[8:11], s28 offen offset:64
  v_cvt_pk_bf16_f32 v124, v88, v89
  v_cvt_pk_bf16_f32 v125, v90, v91
  v_cvt_pk_bf16_f32 v126, v92, v93
  v_cvt_pk_bf16_f32 v127, v94, v95
  buffer_store_dwordx4 v[124:127], v10, s[8:11], s28 offen offset:96
  v_cvt_pk_bf16_f32 v128, v96, v97
  v_cvt_pk_bf16_f32 v129, v98, v99
  v_cvt_pk_bf16_f32 v130, v100, v101
  v_cvt_pk_bf16_f32 v131, v102, v103
  buffer_store_dwordx4 v[128:131], v10, s[8:11], s28 offen offset:128
  v_cvt_pk_bf16_f32 v132, v104, v105
  v_cvt_pk_bf16_f32 v133, v106, v107
  v_cvt_pk_bf16_f32 v134, v108, v109
  v_cvt_pk_bf16_f32 v135, v110, v111
  buffer_store_dwordx4 v[132:135], v10, s[8:11], s28 offen offset:160
L_end:
  s_endpgm
.section .rodata,"a"
.p2align 6
.amdhsa_kernel standalone__modern_conv_block_convnext__vision_kernel
  .amdhsa_next_free_vgpr 512
  .amdhsa_next_free_sgpr 102
  .amdhsa_accum_offset 256
  .amdhsa_group_segment_fixed_size 0
  .amdhsa_kernarg_size 80
  .amdhsa_user_sgpr_count 2
  .amdhsa_user_sgpr_kernarg_segment_ptr 1
  .amdhsa_system_sgpr_workgroup_id_x 1
.end_amdhsa_kernel
```

```asm
; @launch grid=(256,1,1) block=(256,1,1) lds=163840
.amdgcn_target "amdgcn-amd-amdhsa--gfx950"
.text
.globl standalone__modern_conv_block_convnext__vision_kernel
.p2align 8
.type standalone__modern_conv_block_convnext__vision_kernel,@function
standalone__modern_conv_block_convnext__vision_kernel:
  s_cmp_ge_u32 s2, 0x100
  s_nop 0
  s_cbranch_scc1 L_end
  s_load_dwordx2 s[64:65], s[0:1], 16
  s_load_dwordx2 s[72:73], s[0:1], 32
  s_load_dwordx2 s[60:61], s[0:1], 8
  s_load_dwordx2 s[80:81], s[0:1], 48
  s_load_dwordx2 s[76:77], s[0:1], 40
  s_load_dwordx2 s[68:69], s[0:1], 24
  s_load_dwordx2 s[4:5], s[0:1], 0
  s_load_dwordx2 s[8:9], s[0:1], 56
  v_mov_b32 v112, v0
  v_and_b32 v113, 63, v0
  v_lshrrev_b32_e64 v114, 6, v0
  v_lshlrev_b32 v115, 4, v113
  v_readfirstlane_b32 s27, v114
  s_mov_b32 s6, 0x3000000
  s_mov_b32 s7, 0x20000
  s_mov_b32 s62, 0x6c0
  s_mov_b32 s63, 0x20000
  s_mov_b32 s66, 0x12000
  s_mov_b32 s67, 0x20000
  s_mov_b32 s70, 0x300
  s_mov_b32 s71, 0x20000
  s_mov_b32 s74, 0x12000
  s_mov_b32 s75, 0x20000
  s_mov_b32 s78, 0xc0
  s_mov_b32 s79, 0x20000
  s_mov_b32 s82, 0xc0
  s_mov_b32 s83, 0x20000
  s_mov_b32 s10, 0x3000000
  s_mov_b32 s11, 0x20000
  s_and_b32 s54, s2, 6
  s_lshl_b32 s54, s54, 1
  s_lshr_b32 s32, s2, 6
  s_add_u32 s54, s54, s32
  s_lshl_b32 s54, s54, 5
  s_and_b32 s53, s2, 1
  s_lshl_b32 s53, s53, 8
  s_and_b32 s32, s2, 56
  s_lshl_b32 s32, s32, 2
  s_add_u32 s53, s53, s32
  s_lshl_b32 s32, s27, 3
  s_add_u32 s53, s53, s32
  s_min_u32 s57, s27, 2
  s_mul_i32 s58, s27, 0x1040
  s_mul_i32 s59, s27, 0x4800
  s_lshl_b32 s32, s2, 2
  s_add_u32 s32, s32, s27
  s_mul_i32 s33, s32, 0xe39
  s_lshr_b32 s33, s33, 16
  s_mul_i32 s33, s33, 18
  s_sub_u32 s36, s32, s33
  s_lshl_b32 s36, s36, 12
  v_lshlrev_b32 v116, 6, v113
  v_and_b32_e64 v117, 7, v113
  v_bfe_u32 v118, v113, 3, 1
  v_bfe_u32 v119, v113, 4, 1
  v_lshrrev_b32_e64 v120, 5, v113
  v_bfe_u32 v121, v113, 2, 1
  v_and_b32 v122, 3, v113
  v_lshrrev_b32 v123, 4, v113
  v_lshlrev_b32_e64 v124, 4, v119
  v_lshl_add_u32 v124, v121, 3, v124
  v_lshl_add_u32 v124, v118, 2, v124
  v_add_u32 v124, v124, v122
  v_lshlrev_b32 v124, 1, v124
  v_lshlrev_b32 v125, 2, v113
  v_lshlrev_b32 v126, 1, v112
  v_and_b32 v127, 31, v113
  v_lshlrev_b32 v128, 1, v127
  s_lshl_b32 s37, s57, 6
  s_lshl_b32 s38, s57, 8
  s_mul_i32 s39, s57, 0x240
  s_cmp_eq_u32 s53, 0
  s_cselect_b32 s35, 12, 0
  s_cmp_eq_u32 s53, 0x1f8
  s_cselect_b32 s55, 12, 0
  s_add_u32 s55, s55, s35
  s_sub_u32 s55, 0x78, s55
  s_mul_i32 s56, s53, 0xc0
  s_add_u32 s56, s56, 0xf40
  v_mov_b32 v129, 0x80000000
  v_mov_b32 v130, v113
  v_mov_b32 v131, 0
  v_lshl_add_u32 v131, v130, 4, v131
  v_add_u32 v131, s56, v131
  v_subrev_u32 v130, s35, v130
  v_cmp_gt_u32 vcc, s55, v130
  s_nop 1
  v_cndmask_b32 v6, v129, v131, vcc
  v_add_u32 v130, 64, v113
  v_subrev_u32 v132, 57, v113
  v_cmp_le_u32 vcc, 57, v113
  v_mov_b32 v131, 0x17c00
  s_nop 0
  v_cndmask_b32 v130, v130, v132, vcc
  v_mov_b32 v132, 0xfffffc00
  v_cndmask_b32_e64 v131, v132, v131, vcc
  v_lshl_add_u32 v131, v130, 4, v131
  v_add_u32 v131, s56, v131
  v_subrev_u32 v130, s35, v130
  v_cmp_gt_u32 vcc, s55, v130
  s_nop 1
  v_cndmask_b32 v7, v129, v131, vcc
  v_add_u32 v130, 7, v113
  v_mov_b32 v131, 0x17800
  v_lshl_add_u32 v131, v130, 4, v131
  v_add_u32 v131, s56, v131
  v_subrev_u32 v130, s35, v130
  v_cmp_gt_u32 vcc, s55, v130
  s_nop 1
  v_cndmask_b32_e64 v8, v129, v131, vcc
  v_add_u32 v130, 0x47, v113
  v_mov_b32 v131, 0x17400
  v_lshl_add_u32 v131, v130, 4, v131
  v_add_u32 v131, s56, v131
  v_subrev_u32 v130, s35, v130
  v_cmp_gt_u32 vcc, s55, v130
  s_nop 1
  v_cndmask_b32_e64 v9, v129, v131, vcc
  s_mul_i32 s40, s54, 0x18000
  s_add_u32 s33, s40, 0xfffe7000
  v_add_u32_e64 v133, s33, v6
  s_add_u32 s33, s40, 0xfffe7400
  v_add_u32_e64 v134, s33, v7
  s_add_u32 s33, s40, 0xfffe7800
  v_add_u32_e64 v135, s33, v8
  s_add_u32 s33, s40, 0xfffe7c00
  v_add_u32_e64 v136, s33, v9
  s_add_u32 s41, s40, 0x17000
  s_add_u32 s42, s40, 0x47000
  s_add_u32 s29, s40, 0x77000
  s_add_u32 s52, s40, 0xa7000
  v_lshlrev_b32 v137, 2, v119
  v_xor_b32 v137, v137, v117
  v_lshlrev_b32 v137, 4, v137
  v_lshrrev_b32 v138, 3, v113
  v_mov_b32 v131, 0x300
  v_mad_u32_u24 v137, v138, v131, v137
  v_lshlrev_b32_e64 v139, 4, v120
  v_mov_b32 v131, 0xc0
  v_mad_u32_u24 v140, v127, v131, v139
  s_mul_i32 s43, s27, 0xc00
  s_add_u32 s44, s59, 0x1800
  s_add_u32 s45, s59, 0x3000
  s_nop 0
  s_waitcnt lgkmcnt(0)
  buffer_load_dword v254, v116, s[64:67], s36 offen
  buffer_load_dword v255, v116, s[72:75], s36 offen
  buffer_load_ushort v141, v126, s[60:63], 0 offen
  buffer_load_ushort v142, v126, s[60:63], 0 offen offset:576
  buffer_load_ushort v143, v126, s[60:63], 0 offen offset:1152
  buffer_load_ushort v144, v128, s[60:63], s39 offen offset:512
  buffer_load_ushort v145, v124, s[80:83], 0 offen
  buffer_load_ushort v146, v124, s[80:83], 0 offen offset:64
  buffer_load_ushort v147, v124, s[80:83], 0 offen offset:128
  buffer_load_ushort v148, v124, s[80:83], s37 offen
  buffer_load_ushort v149, v124, s[76:79], s37 offen
  buffer_load_dword v150, v125, s[68:71], s38 offen
  s_add_u32 m0, s58, 0
  s_nop 0
  buffer_load_dwordx4 v133, s[4:7], 0 offen lds
  s_add_u32 m0, s58, 0x400
  s_nop 0
  buffer_load_dwordx4 v134, s[4:7], 0 offen lds
  s_add_u32 m0, s58, 0x800
  s_nop 0
  buffer_load_dwordx4 v135, s[4:7], 0 offen lds
  s_add_u32 m0, s58, 0xc00
  s_nop 0
  buffer_load_dwordx4 v136, s[4:7], 0 offen lds
  s_add_u32 s33, s59, 0
  s_add_u32 m0, s43, 0x16000
  s_nop 0
  buffer_load_dwordx4 v137, s[64:67], s33 offen lds
  s_add_u32 s33, s59, 0x1800
  s_add_u32 m0, s43, 0x16400
  s_nop 0
  buffer_load_dwordx4 v137, s[64:67], s33 offen lds
  s_add_u32 s33, s59, 0x3000
  s_add_u32 m0, s43, 0x16800
  s_nop 0
  buffer_load_dwordx4 v137, s[64:67], s33 offen lds
  s_add_u32 s33, s59, 0x80
  s_add_u32 m0, s43, 0x19000
  s_nop 0
  buffer_load_dwordx4 v137, s[64:67], s33 offen lds
  s_add_u32 s33, s59, 0x1880
  s_add_u32 m0, s43, 0x19400
  s_nop 0
  buffer_load_dwordx4 v137, s[64:67], s33 offen lds
  s_add_u32 s33, s59, 0x3080
  s_add_u32 m0, s43, 0x19800
  s_nop 0
  buffer_load_dwordx4 v137, s[64:67], s33 offen lds
  s_add_u32 s33, s59, 0x100
  s_add_u32 m0, s43, 0x1c000
  s_nop 0
  buffer_load_dwordx4 v137, s[64:67], s33 offen lds
  s_add_u32 s33, s59, 0x1900
  s_add_u32 m0, s43, 0x1c400
  s_nop 0
  buffer_load_dwordx4 v137, s[64:67], s33 offen lds
  s_add_u32 s33, s59, 0x3100
  s_add_u32 m0, s43, 0x1c800
  s_nop 0
  buffer_load_dwordx4 v137, s[64:67], s33 offen lds
  s_add_u32 s33, s59, 0x180
  s_add_u32 m0, s43, 0x1f000
  s_nop 0
  buffer_load_dwordx4 v137, s[64:67], s33 offen lds
  s_add_u32 s33, s59, 0x1980
  s_add_u32 m0, s43, 0x1f400
  s_nop 0
  buffer_load_dwordx4 v137, s[64:67], s33 offen lds
  s_add_u32 s33, s59, 0x3180
  s_add_u32 m0, s43, 0x1f800
  s_nop 0
  buffer_load_dwordx4 v137, s[64:67], s33 offen lds
  s_add_u32 s33, s59, 0x200
  s_add_u32 m0, s43, 0x22000
  s_nop 0
  buffer_load_dwordx4 v137, s[64:67], s33 offen lds
  s_add_u32 s33, s59, 0x1a00
  s_add_u32 m0, s43, 0x22400
  s_nop 0
  buffer_load_dwordx4 v137, s[64:67], s33 offen lds
  s_add_u32 s33, s59, 0x3200
  s_add_u32 m0, s43, 0x22800
  s_nop 0
  buffer_load_dwordx4 v137, s[64:67], s33 offen lds
  s_add_u32 s33, s59, 0x280
  s_add_u32 m0, s43, 0x25000
  s_nop 0
  buffer_load_dwordx4 v137, s[64:67], s33 offen lds
  s_add_u32 s33, s59, 0x1a80
  s_add_u32 m0, s43, 0x25400
  s_nop 0
  buffer_load_dwordx4 v137, s[64:67], s33 offen lds
  s_add_u32 s33, s59, 0x3280
  s_add_u32 m0, s43, 0x25800
  s_nop 0
  buffer_load_dwordx4 v137, s[64:67], s33 offen lds
  s_mov_b32 s20, 0x409d30fc
  s_mov_b32 s21, 0x409d30fc
  s_mov_b32 s22, 0x3eeff558
  s_mov_b32 s23, 0x3eeff558
  s_mov_b32 s24, 0x3c2aaaab
  s_mov_b32 s25, 0x3727c5ac
  v_lshl_add_u32 v155, v118, 1, v123
  v_lshrrev_b32_e64 v151, 1, v155
  v_mov_b32 v152, 0x4100
  v_mul_u32_u24 v154, v151, v152
  v_and_b32 v151, 1, v151
  v_lshl_add_u32 v154, v151, 5, v154
  v_and_b32_e64 v151, 1, v155
  v_mov_b32 v152, 0x790
  v_mad_u32_u24 v154, v151, v152, v154
  v_mov_b32 v152, 0xc0
  v_mad_u32_u24 v154, v117, v152, v154
  v_add_u32_e64 v4, s58, v154
  v_lshl_add_u32 v156, v118, 1, v119
  v_add_u32_e64 v155, 1, v156
  v_add_u32 v157, 0xc0, v139
  v_lshrrev_b32_e64 v151, 1, v155
  v_mov_b32 v152, 0x4100
  v_mul_u32_u24 v154, v151, v152
  v_and_b32 v151, 1, v151
  v_lshl_add_u32 v154, v151, 5, v154
  v_and_b32_e64 v151, 1, v155
  v_mov_b32 v152, 0x790
  v_mad_u32_u24 v154, v151, v152, v154
  v_mov_b32 v152, 0xc0
  v_mad_u32_u24 v154, v117, v152, v154
  v_add_u32 v154, v154, v157
  v_add_u32 v5, s58, v154
  v_mov_b32 v152, 0x18000
  v_mad_u32_u24 v10, v156, v152, v139
  v_add_u32_e64 v151, s53, v117
  v_mov_b32 v152, 0xc0
  v_mad_u32_u24 v10, v151, v152, v10
  v_add_u32 v2, 0x15840, v139
  v_sub_u32_e64 v151, v123, v121
  v_lshl_add_u32 v152, v118, 2, v122
  v_lshl_add_u32 v152, v151, 3, v152
  v_cmp_gt_u32 vcc, 3, v151
  v_mov_b32 v153, 24
  s_nop 0
  v_cndmask_b32 v152, v153, v152, vcc
  v_lshlrev_b32_e64 v152, 4, v152
  v_add_u32 v3, 0x12000, v152
  v_add_u32 v0, 0xc300, v115
  v_add_u32 v1, 0x18000, v115
  v_lshlrev_b32_e64 v158, 2, v119
  v_lshl_add_u32 v158, v118, 1, v158
  v_bfe_u32 v152, v113, 1, 1
  v_add_u32 v158, v158, v152
  v_cmp_eq_u32 vcc, v121, v120
  v_mov_b32 v153, 8
  s_nop 0
  v_cndmask_b32 v158, v153, v158, vcc
  v_and_b32 v159, 1, v113
  v_lshlrev_b32_e64 v159, 4, v159
  v_mov_b32 v160, 0x3f80
  v_lshlrev_b32_e64 v160, v159, v160
  v_mov_b32 v153, 0xffff
  v_lshlrev_b32_e64 v153, v159, v153
  v_bfe_u32 v151, v113, 1, 2
  v_cmp_eq_u32 vcc, 0, v151
  v_mov_b32 v52, 0
  s_nop 0
  v_cndmask_b32 v48, 0, v153, vcc
  v_cmp_eq_u32 vcc, 1, v151
  v_mov_b32 v53, 0
  s_nop 0
  v_cndmask_b32 v49, 0, v153, vcc
  v_cmp_eq_u32 vcc, 2, v151
  v_mov_b32 v54, 0
  s_nop 0
  v_cndmask_b32 v50, 0, v153, vcc
  v_cmp_eq_u32 vcc, 3, v151
  v_mov_b32 v55, 0
  s_nop 0
  v_cndmask_b32 v51, 0, v153, vcc
  v_mov_b32 v152, 0x190
  v_min_u32 v151, 35, v113
  v_mul_u32_u24 v151, v151, v152
  v_add_u32 v151, 0x12180, v151
  ds_write_b128 v151, v[52:55]
  v_lshrrev_b32 v161, 3, v112
  v_mul_u32_u24 v161, v161, v152
  v_lshl_add_u32 v161, v117, 4, v161
  v_add_u32 v161, 0x12000, v161
  v_lshrrev_b32_e64 v162, 3, v127
  v_mul_u32_u24 v162, v162, v152
  v_lshl_add_u32 v162, v117, 4, v162
  s_lshl_b32 s32, s57, 7
  s_add_u32 s32, s32, 0x15200
  v_add_u32 v162, s32, v162
  s_lshl_b32 s32, s57, 9
  s_add_u32 s32, s32, 0x15840
  v_lshlrev_b32_e64 v163, 3, v113
  v_add_u32 v163, s32, v163
  s_lshl_b32 s32, s57, 7
  s_add_u32 s32, s32, 0x15e40
  v_lshlrev_b32 v164, 2, v127
  v_add_u32 v164, s32, v164
  v_bfe_u32 v165, v113, 2, 2
  v_lshl_add_u32 v166, v120, 2, v165
  v_lshlrev_b32_e64 v248, 7, v166
  v_lshl_add_u32 v248, v119, 5, v248
  v_lshl_add_u32 v248, v122, 3, v248
  v_lshl_add_u32 v248, v118, 6, v248
  v_xor_b32_e64 v249, 64, v248
  v_add_u32 v248, 0x16000, v248
  v_add_u32 v249, 0x16000, v249
  v_add_u32 v250, 0x9000, v248
  v_add_u32 v251, 0x9000, v249
  s_mul_i32 s32, s27, 0x3000
  v_add_u32 v252, s32, v248
  v_add_u32 v253, s32, v249
  buffer_load_dwordx4 v[64:67], v140, s[72:75], s59 offen
  buffer_load_dwordx4 v[68:71], v140, s[72:75], s59 offen offset:32
  buffer_load_dwordx4 v[72:75], v140, s[72:75], s59 offen offset:64
  buffer_load_dwordx4 v[76:79], v140, s[72:75], s59 offen offset:96
  buffer_load_dwordx4 v[80:83], v140, s[72:75], s59 offen offset:128
  buffer_load_dwordx4 v[84:87], v140, s[72:75], s59 offen offset:160
  buffer_load_dwordx4 v[88:91], v140, s[72:75], s44 offen
  buffer_load_dwordx4 v[92:95], v140, s[72:75], s44 offen offset:32
  buffer_load_dwordx4 v[96:99], v140, s[72:75], s44 offen offset:64
  buffer_load_dwordx4 v[100:103], v140, s[72:75], s44 offen offset:96
  buffer_load_dwordx4 v[104:107], v140, s[72:75], s44 offen offset:128
  buffer_load_dwordx4 v[108:111], v140, s[72:75], s44 offen offset:160
  buffer_load_dwordx4 v[32:35], v140, s[72:75], s45 offen
  buffer_load_dwordx4 v[36:39], v140, s[72:75], s45 offen offset:32
  buffer_load_dwordx4 v[40:43], v140, s[72:75], s45 offen offset:64
  buffer_load_dwordx4 v[44:47], v140, s[72:75], s45 offen offset:96
  buffer_load_dwordx4 v[184:187], v140, s[72:75], s45 offen offset:128
  buffer_load_dwordx4 v[188:191], v140, s[72:75], s45 offen offset:160
  s_add_u32 m0, s58, 0x4120
  s_nop 0
  buffer_load_dwordx4 v6, s[4:7], s41 offen lds
  buffer_load_dwordx4 v7, s[4:7], s41 offen offset:1024 lds
  buffer_load_dwordx4 v8, s[4:7], s41 offen offset:2048 lds
  buffer_load_dwordx4 v9, s[4:7], s41 offen offset:3072 lds
  s_add_u32 m0, s58, 0x8200
  s_nop 0
  buffer_load_dwordx4 v6, s[4:7], s42 offen lds
  buffer_load_dwordx4 v7, s[4:7], s42 offen offset:1024 lds
  buffer_load_dwordx4 v8, s[4:7], s42 offen offset:2048 lds
  buffer_load_dwordx4 v9, s[4:7], s42 offen offset:3072 lds
  s_waitcnt vmcnt(57)
  v_lshl_or_b32 v141, v141, 16, v141
  v_and_b32 v16, v48, v141
  v_and_b32 v17, v49, v141
  v_and_b32 v18, v50, v141
  v_and_b32 v19, v51, v141
  ds_write_b128 v161, v[16:19]
  s_waitcnt vmcnt(56)
  v_lshl_or_b32 v142, v142, 16, v142
  v_and_b32 v20, v48, v142
  v_and_b32 v21, v49, v142
  v_and_b32 v22, v50, v142
  v_and_b32 v23, v51, v142
  ds_write_b128 v161, v[20:23] offset:128
  s_waitcnt vmcnt(55)
  v_lshl_or_b32 v143, v143, 16, v143
  v_and_b32 v24, v48, v143
  v_and_b32 v25, v49, v143
  v_and_b32 v26, v50, v143
  v_and_b32 v27, v51, v143
  ds_write_b128 v161, v[24:27] offset:256
  s_waitcnt vmcnt(54)
  v_lshl_or_b32 v144, v144, 16, v144
  v_and_b32 v28, v48, v144
  v_and_b32 v29, v49, v144
  v_and_b32 v30, v50, v144
  v_and_b32 v31, v51, v144
  ds_write_b128 v162, v[28:31]
  s_waitcnt vmcnt(53)
  v_lshlrev_b32 v145, v159, v145
  s_waitcnt vmcnt(52)
  v_lshlrev_b32 v146, v159, v146
  s_waitcnt vmcnt(51)
  v_lshlrev_b32 v147, v159, v147
  v_cmp_eq_u32 vcc, 0, v158
  s_waitcnt vmcnt(48)
  v_lshlrev_b32_e64 v56, 16, v150
  v_and_b32 v57, 0xffff0000, v150
  v_cndmask_b32 v240, 0, v160, vcc
  v_cndmask_b32 v192, 0, v145, vcc
  v_cndmask_b32 v200, 0, v146, vcc
  v_cndmask_b32 v208, 0, v147, vcc
  v_cmp_eq_u32 vcc, 1, v158
  s_nop 1
  v_cndmask_b32 v241, 0, v160, vcc
  v_cndmask_b32 v193, 0, v145, vcc
  v_cndmask_b32 v201, 0, v146, vcc
  v_cndmask_b32 v209, 0, v147, vcc
  v_cmp_eq_u32 vcc, 2, v158
  s_nop 1
  v_cndmask_b32 v242, 0, v160, vcc
  v_cndmask_b32 v194, 0, v145, vcc
  v_cndmask_b32 v202, 0, v146, vcc
  v_cndmask_b32 v210, 0, v147, vcc
  v_cmp_eq_u32 vcc, 3, v158
  s_nop 1
  v_cndmask_b32 v243, 0, v160, vcc
  v_cndmask_b32 v195, 0, v145, vcc
  v_cndmask_b32 v203, 0, v146, vcc
  v_cndmask_b32 v211, 0, v147, vcc
  v_cmp_eq_u32 vcc, 4, v158
  s_nop 1
  v_cndmask_b32 v244, 0, v160, vcc
  v_cndmask_b32 v196, 0, v145, vcc
  v_cndmask_b32 v204, 0, v146, vcc
  v_cndmask_b32 v212, 0, v147, vcc
  v_cmp_eq_u32 vcc, 5, v158
  s_nop 1
  v_cndmask_b32 v245, 0, v160, vcc
  v_cndmask_b32 v197, 0, v145, vcc
  v_cndmask_b32 v205, 0, v146, vcc
  v_cndmask_b32 v213, 0, v147, vcc
  v_cmp_eq_u32 vcc, 6, v158
  s_nop 1
  v_cndmask_b32 v246, 0, v160, vcc
  v_cndmask_b32 v198, 0, v145, vcc
  v_cndmask_b32 v206, 0, v146, vcc
  v_cndmask_b32 v214, 0, v147, vcc
  v_cmp_eq_u32 vcc, 7, v158
  s_nop 1
  v_cndmask_b32 v247, 0, v160, vcc
  v_cndmask_b32 v199, 0, v145, vcc
  v_cndmask_b32 v207, 0, v146, vcc
  v_cndmask_b32 v215, 0, v147, vcc
  v_pk_mul_f32 v[56:57], v[56:57], s[22:23]
  ds_write_b64 v163, v[56:57]
  v_lshlrev_b32 v148, 16, v148
  v_lshlrev_b32 v149, 16, v149
  v_mul_f32_e64 v148, v148, v149
  ds_write_b32 v164, v148
  s_add_u32 s30, s58, 32
  s_add_u32 s31, s58, 0x4100
  s_mov_b32 s34, s40
  s_mov_b32 s28, 0x80000000
  s_waitcnt vmcnt(26)
  s_waitcnt lgkmcnt(0)
  s_barrier
  s_waitcnt vmcnt(25)
  v_mfma_f32_32x32x16_bf16 v[48:63], v[64:67], v[192:195], 0
  s_waitcnt vmcnt(24)
  v_mfma_f32_32x32x16_bf16 v[48:63], v[68:71], v[196:199], v[48:63]
  s_waitcnt vmcnt(23)
  v_mfma_f32_32x32x16_bf16 v[16:31], v[72:75], v[200:203], 0
  ds_read_b64_tr_b16 v[216:217], v252 offset:34816
  ds_read_b64_tr_b16 v[218:219], v252 offset:35840
  ds_read_b64_tr_b16 v[220:221], v253 offset:34816
  ds_read_b64_tr_b16 v[222:223], v253 offset:35840
  s_nop 0
  s_nop 5
  v_cvt_pk_bf16_f32 v64, v48, v49
  v_cvt_pk_bf16_f32 v65, v50, v51
  v_cvt_pk_bf16_f32 v66, v52, v53
  ds_read_b64_tr_b16 a[0:1], v248
  ds_read_b64_tr_b16 a[2:3], v248 offset:1024
  ds_read_b64_tr_b16 a[4:5], v248 offset:2048
  ds_read_b64_tr_b16 a[6:7], v248 offset:3072
  v_cvt_pk_bf16_f32 v67, v54, v55
  s_nop 0
  s_waitcnt vmcnt(22)
  v_mfma_f32_32x32x16_bf16 v[16:31], v[76:79], v[204:207], v[16:31]
  v_cvt_pk_bf16_f32 v68, v56, v57
  ds_read_b64_tr_b16 a[8:9], v248 offset:4096
  ds_read_b64_tr_b16 a[10:11], v248 offset:5120
  ds_read_b64_tr_b16 a[12:13], v248 offset:6144
  ds_read_b64_tr_b16 a[14:15], v248 offset:7168
  v_cvt_pk_bf16_f32 v69, v58, v59
  v_cvt_pk_bf16_f32 v70, v60, v61
  v_cvt_pk_bf16_f32 v71, v62, v63
  ds_read_b64_tr_b16 a[16:17], v248 offset:8192
  ds_read_b64_tr_b16 a[18:19], v248 offset:9216
  ds_read_b64_tr_b16 a[20:21], v248 offset:10240
  ds_read_b64_tr_b16 a[22:23], v248 offset:11264
  s_nop 0
  s_waitcnt vmcnt(21)
  v_mfma_f32_32x32x16_bf16 v[48:63], v[80:83], v[208:211], 0
  v_cvt_pk_bf16_f32 v72, v16, v17
  v_cvt_pk_bf16_f32 v73, v18, v19
  ds_read_b64_tr_b16 a[24:25], v249
  ds_read_b64_tr_b16 a[26:27], v249 offset:1024
  ds_read_b64_tr_b16 a[28:29], v249 offset:2048
  ds_read_b64_tr_b16 a[30:31], v249 offset:3072
  v_cvt_pk_bf16_f32 v74, v20, v21
  v_cvt_pk_bf16_f32 v75, v22, v23
  s_nop 0
  s_waitcnt vmcnt(20)
  v_mfma_f32_32x32x16_bf16 v[48:63], v[84:87], v[212:215], v[48:63]
  ds_read_b64_tr_b16 a[32:33], v249 offset:4096
  ds_read_b64_tr_b16 a[34:35], v249 offset:5120
  ds_read_b64_tr_b16 a[36:37], v249 offset:6144
  ds_read_b64_tr_b16 a[38:39], v249 offset:7168
  v_cvt_pk_bf16_f32 v76, v24, v25
  v_cvt_pk_bf16_f32 v77, v26, v27
  v_cvt_pk_bf16_f32 v78, v28, v29
  ds_read_b64_tr_b16 a[40:41], v249 offset:8192
  ds_read_b64_tr_b16 a[42:43], v249 offset:9216
  ds_read_b64_tr_b16 a[44:45], v249 offset:10240
  ds_read_b64_tr_b16 a[46:47], v249 offset:11264
  v_cvt_pk_bf16_f32 v79, v30, v31
  s_nop 0
  s_waitcnt vmcnt(19)
  v_mfma_f32_32x32x16_bf16 v[16:31], v[88:91], v[192:195], 0
  v_cvt_pk_bf16_f32 v80, v48, v49
  ds_read_b64_tr_b16 a[48:49], v248 offset:12288
  ds_read_b64_tr_b16 a[50:51], v248 offset:13312
  ds_read_b64_tr_b16 a[52:53], v248 offset:14336
  ds_read_b64_tr_b16 a[54:55], v248 offset:15360
  v_cvt_pk_bf16_f32 v81, v50, v51
  v_cvt_pk_bf16_f32 v82, v52, v53
  v_cvt_pk_bf16_f32 v83, v54, v55
  ds_read_b64_tr_b16 a[56:57], v248 offset:16384
  ds_read_b64_tr_b16 a[58:59], v248 offset:17408
  ds_read_b64_tr_b16 a[60:61], v248 offset:18432
  ds_read_b64_tr_b16 a[62:63], v248 offset:19456
  s_nop 0
  s_waitcnt vmcnt(18)
  v_mfma_f32_32x32x16_bf16 v[16:31], v[92:95], v[196:199], v[16:31]
  v_cvt_pk_bf16_f32 v84, v56, v57
  v_cvt_pk_bf16_f32 v85, v58, v59
  ds_read_b64_tr_b16 a[64:65], v248 offset:20480
  ds_read_b64_tr_b16 a[66:67], v248 offset:21504
  ds_read_b64_tr_b16 a[68:69], v248 offset:22528
  ds_read_b64_tr_b16 a[70:71], v248 offset:23552
  v_cvt_pk_bf16_f32 v86, v60, v61
  v_cvt_pk_bf16_f32 v87, v62, v63
  s_nop 0
  s_waitcnt vmcnt(17)
  v_mfma_f32_32x32x16_bf16 v[48:63], v[96:99], v[200:203], 0
  ds_read_b64_tr_b16 a[72:73], v249 offset:12288
  ds_read_b64_tr_b16 a[74:75], v249 offset:13312
  ds_read_b64_tr_b16 a[76:77], v249 offset:14336
  ds_read_b64_tr_b16 a[78:79], v249 offset:15360
  v_cvt_pk_bf16_f32 v88, v16, v17
  v_cvt_pk_bf16_f32 v89, v18, v19
  v_cvt_pk_bf16_f32 v90, v20, v21
  ds_read_b64_tr_b16 a[80:81], v249 offset:16384
  ds_read_b64_tr_b16 a[82:83], v249 offset:17408
  ds_read_b64_tr_b16 a[84:85], v249 offset:18432
  ds_read_b64_tr_b16 a[86:87], v249 offset:19456
  v_cvt_pk_bf16_f32 v91, v22, v23
  s_nop 0
  s_waitcnt vmcnt(16)
  v_mfma_f32_32x32x16_bf16 v[48:63], v[100:103], v[204:207], v[48:63]
  v_cvt_pk_bf16_f32 v92, v24, v25
  ds_read_b64_tr_b16 a[88:89], v249 offset:20480
  ds_read_b64_tr_b16 a[90:91], v249 offset:21504
  ds_read_b64_tr_b16 a[92:93], v249 offset:22528
  ds_read_b64_tr_b16 a[94:95], v249 offset:23552
  v_cvt_pk_bf16_f32 v93, v26, v27
  v_cvt_pk_bf16_f32 v94, v28, v29
  v_cvt_pk_bf16_f32 v95, v30, v31
  ds_read_b64_tr_b16 a[96:97], v248 offset:24576
  ds_read_b64_tr_b16 a[98:99], v248 offset:25600
  ds_read_b64_tr_b16 a[100:101], v248 offset:26624
  ds_read_b64_tr_b16 a[102:103], v248 offset:27648
  s_nop 0
  s_waitcnt vmcnt(15)
  v_mfma_f32_32x32x16_bf16 v[16:31], v[104:107], v[208:211], 0
  v_cvt_pk_bf16_f32 v96, v48, v49
  v_cvt_pk_bf16_f32 v97, v50, v51
  ds_read_b64_tr_b16 a[104:105], v248 offset:28672
  ds_read_b64_tr_b16 a[106:107], v248 offset:29696
  ds_read_b64_tr_b16 a[108:109], v248 offset:30720
  ds_read_b64_tr_b16 a[110:111], v248 offset:31744
  v_cvt_pk_bf16_f32 v98, v52, v53
  v_cvt_pk_bf16_f32 v99, v54, v55
  s_nop 0
  s_waitcnt vmcnt(14)
  v_mfma_f32_32x32x16_bf16 v[16:31], v[108:111], v[212:215], v[16:31]
  ds_read_b64_tr_b16 a[112:113], v248 offset:32768
  ds_read_b64_tr_b16 a[114:115], v248 offset:33792
  ds_read_b64_tr_b16 a[116:117], v249 offset:24576
  ds_read_b64_tr_b16 a[118:119], v249 offset:25600
  v_cvt_pk_bf16_f32 v100, v56, v57
  v_cvt_pk_bf16_f32 v101, v58, v59
  v_cvt_pk_bf16_f32 v102, v60, v61
  ds_read_b64_tr_b16 a[120:121], v249 offset:26624
  ds_read_b64_tr_b16 a[122:123], v249 offset:27648
  ds_read_b64_tr_b16 a[124:125], v249 offset:28672
  ds_read_b64_tr_b16 a[126:127], v249 offset:29696
  v_cvt_pk_bf16_f32 v103, v62, v63
  s_nop 0
  s_waitcnt vmcnt(13)
  v_mfma_f32_32x32x16_bf16 v[48:63], v[32:35], v[192:195], 0
  v_cvt_pk_bf16_f32 v104, v16, v17
  ds_read_b64_tr_b16 a[128:129], v249 offset:30720
  ds_read_b64_tr_b16 a[130:131], v249 offset:31744
  ds_read_b64_tr_b16 a[132:133], v249 offset:32768
  ds_read_b64_tr_b16 a[134:135], v249 offset:33792
  v_cvt_pk_bf16_f32 v105, v18, v19
  v_cvt_pk_bf16_f32 v106, v20, v21
  v_cvt_pk_bf16_f32 v107, v22, v23
  ds_read_b64_tr_b16 a[136:137], v250
  ds_read_b64_tr_b16 a[138:139], v250 offset:1024
  ds_read_b64_tr_b16 a[140:141], v250 offset:2048
  ds_read_b64_tr_b16 a[142:143], v250 offset:3072
  s_nop 0
  s_waitcnt vmcnt(12)
  v_mfma_f32_32x32x16_bf16 v[48:63], v[36:39], v[196:199], v[48:63]
  v_cvt_pk_bf16_f32 v108, v24, v25
  v_cvt_pk_bf16_f32 v109, v26, v27
  ds_read_b64_tr_b16 a[144:145], v250 offset:4096
  ds_read_b64_tr_b16 a[146:147], v250 offset:5120
  ds_read_b64_tr_b16 a[148:149], v250 offset:6144
  ds_read_b64_tr_b16 a[150:151], v250 offset:7168
  v_cvt_pk_bf16_f32 v110, v28, v29
  v_cvt_pk_bf16_f32 v111, v30, v31
  s_nop 0
  s_waitcnt vmcnt(11)
  v_mfma_f32_32x32x16_bf16 v[16:31], v[40:43], v[200:203], 0
  ds_read_b64_tr_b16 a[152:153], v250 offset:8192
  ds_read_b64_tr_b16 a[154:155], v250 offset:9216
  ds_read_b64_tr_b16 a[156:157], v251
  ds_read_b64_tr_b16 a[158:159], v251 offset:1024
  v_cvt_pk_bf16_f32 v32, v48, v49
  v_cvt_pk_bf16_f32 v33, v50, v51
  v_cvt_pk_bf16_f32 v34, v52, v53
  ds_read_b64_tr_b16 a[160:161], v251 offset:2048
  ds_read_b64_tr_b16 a[162:163], v251 offset:3072
  ds_read_b64_tr_b16 a[164:165], v251 offset:4096
  ds_read_b64_tr_b16 a[166:167], v251 offset:5120
  v_cvt_pk_bf16_f32 v35, v54, v55
  s_nop 0
  s_waitcnt vmcnt(10)
  v_mfma_f32_32x32x16_bf16 v[16:31], v[44:47], v[204:207], v[16:31]
  v_cvt_pk_bf16_f32 v36, v56, v57
  ds_read_b64_tr_b16 a[168:169], v251 offset:6144
  ds_read_b64_tr_b16 a[170:171], v251 offset:7168
  ds_read_b64_tr_b16 a[172:173], v251 offset:8192
  ds_read_b64_tr_b16 a[174:175], v251 offset:9216
  v_cvt_pk_bf16_f32 v37, v58, v59
  v_cvt_pk_bf16_f32 v38, v60, v61
  v_cvt_pk_bf16_f32 v39, v62, v63
  ds_read_b64_tr_b16 a[176:177], v250 offset:12288
  ds_read_b64_tr_b16 a[178:179], v250 offset:13312
  ds_read_b64_tr_b16 a[180:181], v250 offset:14336
  ds_read_b64_tr_b16 a[182:183], v250 offset:15360
  s_nop 0
  s_waitcnt vmcnt(9)
  v_mfma_f32_32x32x16_bf16 v[48:63], v[184:187], v[208:211], 0
  v_cvt_pk_bf16_f32 v40, v16, v17
  v_cvt_pk_bf16_f32 v41, v18, v19
  ds_read_b64_tr_b16 a[184:185], v250 offset:16384
  ds_read_b64_tr_b16 a[186:187], v250 offset:17408
  ds_read_b64_tr_b16 a[188:189], v250 offset:18432
  ds_read_b64_tr_b16 a[190:191], v250 offset:19456
  v_cvt_pk_bf16_f32 v42, v20, v21
  v_cvt_pk_bf16_f32 v43, v22, v23
  s_nop 0
  s_waitcnt vmcnt(8)
  v_mfma_f32_32x32x16_bf16 v[48:63], v[188:191], v[212:215], v[48:63]
  ds_read_b64_tr_b16 a[192:193], v250 offset:20480
  ds_read_b64_tr_b16 a[194:195], v250 offset:21504
  ds_read_b64_tr_b16 a[196:197], v251 offset:12288
  ds_read_b64_tr_b16 a[198:199], v251 offset:13312
  v_cvt_pk_bf16_f32 v44, v24, v25
  v_cvt_pk_bf16_f32 v45, v26, v27
  v_cvt_pk_bf16_f32 v46, v28, v29
  ds_read_b64_tr_b16 a[200:201], v251 offset:14336
  ds_read_b64_tr_b16 a[202:203], v251 offset:15360
  ds_read_b64_tr_b16 a[204:205], v251 offset:16384
  ds_read_b64_tr_b16 a[206:207], v251 offset:17408
  v_cvt_pk_bf16_f32 v47, v30, v31
  v_cvt_pk_bf16_f32 v184, v48, v49
  v_cvt_pk_bf16_f32 v185, v50, v51
  ds_read_b64_tr_b16 a[208:209], v251 offset:18432
  ds_read_b64_tr_b16 a[210:211], v251 offset:19456
  ds_read_b64_tr_b16 a[212:213], v251 offset:20480
  ds_read_b64_tr_b16 a[214:215], v251 offset:21504
  v_cvt_pk_bf16_f32 v186, v52, v53
  v_cvt_pk_bf16_f32 v187, v54, v55
  v_cvt_pk_bf16_f32 v188, v56, v57
  ds_read_b64_tr_b16 a[216:217], v250 offset:24576
  ds_read_b64_tr_b16 a[218:219], v250 offset:25600
  ds_read_b64_tr_b16 a[220:221], v250 offset:26624
  ds_read_b64_tr_b16 a[222:223], v250 offset:27648
  v_cvt_pk_bf16_f32 v189, v58, v59
  v_cvt_pk_bf16_f32 v190, v60, v61
  v_cvt_pk_bf16_f32 v191, v62, v63
  ds_read_b64_tr_b16 a[224:225], v250 offset:28672
  ds_read_b64_tr_b16 a[226:227], v250 offset:29696
  ds_read_b64_tr_b16 a[228:229], v250 offset:30720
  ds_read_b64_tr_b16 a[230:231], v250 offset:31744
  ds_read_b64_tr_b16 a[232:233], v250 offset:32768
  ds_read_b64_tr_b16 a[234:235], v250 offset:33792
  ds_read_b64_tr_b16 a[236:237], v251 offset:24576
  ds_read_b64_tr_b16 a[238:239], v251 offset:25600
  ds_read_b64_tr_b16 a[240:241], v251 offset:26624
  ds_read_b64_tr_b16 a[242:243], v251 offset:27648
  ds_read_b64_tr_b16 a[244:245], v251 offset:28672
  ds_read_b64_tr_b16 a[246:247], v251 offset:29696
  ds_read_b64_tr_b16 a[248:249], v251 offset:30720
  ds_read_b64_tr_b16 a[250:251], v251 offset:31744
  ds_read_b64_tr_b16 a[252:253], v251 offset:32768
  ds_read_b64_tr_b16 a[254:255], v251 offset:33792
  s_lshl_b32 s32, s27, 11
  s_add_u32 s33, s59, 0x9d00
  v_add_u32 v254, s32, v0
  v_add_u32 v255, s33, v0
  s_waitcnt lgkmcnt(15)
  ds_write_b128 v254, v[216:219]
  ds_write_b128 v254, v[220:223] offset:1024
  ds_read_b128 v[16:19], v2
  ds_read_b128 v[20:23], v2 offset:32
  ds_read_b128 v[24:27], v2 offset:64
  ds_read_b128 v[28:31], v2 offset:96
  s_waitcnt lgkmcnt(0)
  s_barrier
  ds_write_b128 v255, v[64:67]
  ds_write_b128 v255, v[72:75] offset:1024
  ds_write_b128 v255, v[80:83] offset:2048
  ds_write_b128 v255, v[68:71] offset:3072
  ds_write_b128 v255, v[76:79] offset:4096
  ds_write_b128 v255, v[84:87] offset:5120
  ds_write_b128 v255, v[88:91] offset:6144
  ds_write_b128 v255, v[96:99] offset:7168
  ds_write_b128 v255, v[104:107] offset:8192
  ds_write_b128 v255, v[92:95] offset:9216
  ds_write_b128 v255, v[100:103] offset:10240
  ds_write_b128 v255, v[108:111] offset:11264
  ds_write_b128 v255, v[32:35] offset:12288
  ds_write_b128 v255, v[40:43] offset:13312
  ds_write_b128 v255, v[184:187] offset:14336
  ds_write_b128 v255, v[36:39] offset:15360
  ds_write_b128 v255, v[44:47] offset:16384
  ds_write_b128 v255, v[188:191] offset:17408
  s_add_u32 s33, s58, 0x8200
  s_nop 0
  s_waitcnt vmcnt(0)
  ds_read_b128 v[216:219], v3
  ds_read_b128 v[220:223], v4
  ds_read_b128 v[224:227], v3 offset:4800
  ds_read_b128 v[228:231], v4 offset:192
  ds_read_b128 v[232:235], v3 offset:9600
  ds_read_b128 v[236:239], v4 offset:384
  ds_read_b128 v[160:163], v3 offset:400
  ds_read_b128 v[164:167], v4 offset:16
  ds_read_b128 v[168:171], v3 offset:5200
  ds_read_b128 v[172:175], v4 offset:208
  ds_read_b128 v[176:179], v3 offset:10000
  ds_read_b128 v[180:183], v4 offset:400
  s_waitcnt lgkmcnt(10)
  v_mfma_f32_16x16x32_bf16 v[112:115], v[216:219], v[220:223], 0
  ds_read_b128 v[216:219], v3 offset:800
  ds_read_b128 v[220:223], v4 offset:32
  s_waitcnt lgkmcnt(10)
  v_mfma_f32_16x16x32_bf16 v[112:115], v[224:227], v[228:231], v[112:115]
  ds_read_b128 v[224:227], v3 offset:5600
  ds_read_b128 v[228:231], v4 offset:224
  s_waitcnt lgkmcnt(10)
  v_mfma_f32_16x16x32_bf16 v[112:115], v[232:235], v[236:239], v[112:115]
  s_waitcnt lgkmcnt(8)
  ds_read_b128 v[232:235], v3 offset:10400
  ds_read_b128 v[236:239], v4 offset:416
  v_mfma_f32_16x16x32_bf16 v[116:119], v[160:163], v[164:167], 0
  ds_read_b128 v[160:163], v3 offset:1200
  ds_read_b128 v[164:167], v4 offset:48
  s_waitcnt lgkmcnt(10)
  v_mfma_f32_16x16x32_bf16 v[116:119], v[168:171], v[172:175], v[116:119]
  ds_read_b128 v[168:171], v3 offset:6000
  ds_read_b128 v[172:175], v4 offset:240
  s_waitcnt lgkmcnt(10)
  v_mfma_f32_16x16x32_bf16 v[116:119], v[176:179], v[180:183], v[116:119]
  s_waitcnt lgkmcnt(8)
  ds_read_b128 v[176:179], v3 offset:10800
  ds_read_b128 v[180:183], v4 offset:432
  v_mfma_f32_16x16x32_bf16 v[120:123], v[216:219], v[220:223], 0
  ds_read_b128 v[216:219], v3 offset:1600
  ds_read_b128 v[220:223], v4 offset:64
  s_waitcnt lgkmcnt(10)
  v_mfma_f32_16x16x32_bf16 v[120:123], v[224:227], v[228:231], v[120:123]
  ds_read_b128 v[224:227], v3 offset:6400
  ds_read_b128 v[228:231], v4 offset:256
  s_waitcnt lgkmcnt(10)
  v_mfma_f32_16x16x32_bf16 v[120:123], v[232:235], v[236:239], v[120:123]
  s_waitcnt lgkmcnt(8)
  ds_read_b128 v[232:235], v3 offset:11200
  ds_read_b128 v[236:239], v4 offset:448
  v_mfma_f32_16x16x32_bf16 v[124:127], v[160:163], v[164:167], 0
  ds_read_b128 v[160:163], v3 offset:2000
  ds_read_b128 v[164:167], v4 offset:80
  s_waitcnt lgkmcnt(10)
  v_mfma_f32_16x16x32_bf16 v[124:127], v[168:171], v[172:175], v[124:127]
  ds_read_b128 v[168:171], v3 offset:6800
  ds_read_b128 v[172:175], v4 offset:272
  s_waitcnt lgkmcnt(10)
  v_mfma_f32_16x16x32_bf16 v[124:127], v[176:179], v[180:183], v[124:127]
  s_waitcnt lgkmcnt(8)
  ds_read_b128 v[176:179], v3 offset:11600
  ds_read_b128 v[180:183], v4 offset:464
  v_mfma_f32_16x16x32_bf16 v[128:131], v[216:219], v[220:223], 0
  ds_read_b128 v[216:219], v3 offset:2400
  ds_read_b128 v[220:223], v4 offset:96
  s_waitcnt lgkmcnt(10)
  v_mfma_f32_16x16x32_bf16 v[128:131], v[224:227], v[228:231], v[128:131]
  ds_read_b128 v[224:227], v3 offset:7200
  ds_read_b128 v[228:231], v4 offset:288
  s_waitcnt lgkmcnt(10)
  v_mfma_f32_16x16x32_bf16 v[128:131], v[232:235], v[236:239], v[128:131]
  s_waitcnt lgkmcnt(8)
  ds_read_b128 v[232:235], v3 offset:12000
  ds_read_b128 v[236:239], v4 offset:480
  v_mfma_f32_16x16x32_bf16 v[132:135], v[160:163], v[164:167], 0
  ds_read_b128 v[160:163], v3 offset:2800
  ds_read_b128 v[164:167], v4 offset:112
  s_waitcnt lgkmcnt(10)
  v_mfma_f32_16x16x32_bf16 v[132:135], v[168:171], v[172:175], v[132:135]
  ds_read_b128 v[168:171], v3 offset:7600
  ds_read_b128 v[172:175], v4 offset:304
  s_waitcnt lgkmcnt(10)
  v_mfma_f32_16x16x32_bf16 v[132:135], v[176:179], v[180:183], v[132:135]
  s_waitcnt lgkmcnt(8)
  ds_read_b128 v[176:179], v3 offset:12400
  ds_read_b128 v[180:183], v4 offset:496
  v_mfma_f32_16x16x32_bf16 v[136:139], v[216:219], v[220:223], 0
  ds_read_b128 v[216:219], v3 offset:3200
  ds_read_b128 v[220:223], v4 offset:128
  s_waitcnt lgkmcnt(10)
  v_mfma_f32_16x16x32_bf16 v[136:139], v[224:227], v[228:231], v[136:139]
  ds_read_b128 v[224:227], v3 offset:8000
  ds_read_b128 v[228:231], v4 offset:320
  s_waitcnt lgkmcnt(10)
  v_mfma_f32_16x16x32_bf16 v[136:139], v[232:235], v[236:239], v[136:139]
  s_waitcnt lgkmcnt(8)
  ds_read_b128 v[232:235], v3 offset:12800
  ds_read_b128 v[236:239], v4 offset:512
  v_mfma_f32_16x16x32_bf16 v[140:143], v[160:163], v[164:167], 0
  ds_read_b128 v[160:163], v3 offset:3600
  ds_read_b128 v[164:167], v4 offset:144
  s_waitcnt lgkmcnt(10)
  v_mfma_f32_16x16x32_bf16 v[140:143], v[168:171], v[172:175], v[140:143]
  ds_read_b128 v[168:171], v3 offset:8400
  ds_read_b128 v[172:175], v4 offset:336
  s_waitcnt lgkmcnt(10)
  v_mfma_f32_16x16x32_bf16 v[140:143], v[176:179], v[180:183], v[140:143]
  s_waitcnt lgkmcnt(8)
  ds_read_b128 v[176:179], v3 offset:13200
  ds_read_b128 v[180:183], v4 offset:528
  v_mfma_f32_16x16x32_bf16 v[144:147], v[216:219], v[220:223], 0
  ds_read_b128 v[216:219], v3 offset:4000
  ds_read_b128 v[220:223], v4 offset:160
  s_waitcnt lgkmcnt(10)
  v_mfma_f32_16x16x32_bf16 v[144:147], v[224:227], v[228:231], v[144:147]
  ds_read_b128 v[224:227], v3 offset:8800
  ds_read_b128 v[228:231], v4 offset:352
  s_waitcnt lgkmcnt(10)
  v_mfma_f32_16x16x32_bf16 v[144:147], v[232:235], v[236:239], v[144:147]
  s_waitcnt lgkmcnt(8)
  ds_read_b128 v[232:235], v3 offset:13600
  ds_read_b128 v[236:239], v4 offset:544
  v_mfma_f32_16x16x32_bf16 v[148:151], v[160:163], v[164:167], 0
  ds_read_b128 v[160:163], v3 offset:4400
  ds_read_b128 v[164:167], v4 offset:176
  s_waitcnt lgkmcnt(10)
  v_mfma_f32_16x16x32_bf16 v[148:151], v[168:171], v[172:175], v[148:151]
  ds_read_b128 v[168:171], v3 offset:9200
  ds_read_b128 v[172:175], v4 offset:368
  s_waitcnt lgkmcnt(10)
  v_mfma_f32_16x16x32_bf16 v[148:151], v[176:179], v[180:183], v[148:151]
  s_waitcnt lgkmcnt(8)
  ds_read_b128 v[176:179], v3 offset:14000
  ds_read_b128 v[180:183], v4 offset:560
  v_mfma_f32_16x16x32_bf16 v[152:155], v[216:219], v[220:223], 0
  s_waitcnt lgkmcnt(8)
  v_mfma_f32_16x16x32_bf16 v[152:155], v[224:227], v[228:231], v[152:155]
  s_waitcnt lgkmcnt(6)
  v_mfma_f32_16x16x32_bf16 v[152:155], v[232:235], v[236:239], v[152:155]
  s_waitcnt lgkmcnt(4)
  v_mfma_f32_16x16x32_bf16 v[156:159], v[160:163], v[164:167], 0
  s_waitcnt lgkmcnt(2)
  v_mfma_f32_16x16x32_bf16 v[156:159], v[168:171], v[172:175], v[156:159]
  s_waitcnt lgkmcnt(0)
  v_mfma_f32_16x16x32_bf16 v[156:159], v[176:179], v[180:183], v[156:159]
  v_pk_add_f32 v[12:13], v[112:113], v[114:115]
  v_pk_mul_f32 v[14:15], v[112:113], v[112:113]
  v_pk_fma_f32 v[14:15], v[114:115], v[114:115], v[14:15]
  v_pk_add_f32 v[12:13], v[12:13], v[116:117]
  v_pk_fma_f32 v[14:15], v[116:117], v[116:117], v[14:15]
  v_pk_add_f32 v[12:13], v[12:13], v[118:119]
  v_pk_fma_f32 v[14:15], v[118:119], v[118:119], v[14:15]
  v_pk_add_f32 v[12:13], v[12:13], v[120:121]
  v_pk_fma_f32 v[14:15], v[120:121], v[120:121], v[14:15]
  v_pk_add_f32 v[12:13], v[12:13], v[122:123]
  v_pk_fma_f32 v[14:15], v[122:123], v[122:123], v[14:15]
  v_pk_add_f32 v[12:13], v[12:13], v[124:125]
  v_pk_fma_f32 v[14:15], v[124:125], v[124:125], v[14:15]
  v_pk_add_f32 v[12:13], v[12:13], v[126:127]
  v_pk_fma_f32 v[14:15], v[126:127], v[126:127], v[14:15]
  v_pk_add_f32 v[12:13], v[12:13], v[128:129]
  v_pk_fma_f32 v[14:15], v[128:129], v[128:129], v[14:15]
  v_pk_add_f32 v[12:13], v[12:13], v[130:131]
  v_pk_fma_f32 v[14:15], v[130:131], v[130:131], v[14:15]
  v_pk_add_f32 v[12:13], v[12:13], v[132:133]
  v_pk_fma_f32 v[14:15], v[132:133], v[132:133], v[14:15]
  v_pk_add_f32 v[12:13], v[12:13], v[134:135]
  v_pk_fma_f32 v[14:15], v[134:135], v[134:135], v[14:15]
  v_pk_add_f32 v[12:13], v[12:13], v[136:137]
  v_pk_fma_f32 v[14:15], v[136:137], v[136:137], v[14:15]
  v_pk_add_f32 v[12:13], v[12:13], v[138:139]
  v_pk_fma_f32 v[14:15], v[138:139], v[138:139], v[14:15]
  v_pk_add_f32 v[12:13], v[12:13], v[140:141]
  v_pk_fma_f32 v[14:15], v[140:141], v[140:141], v[14:15]
  v_pk_add_f32 v[12:13], v[12:13], v[142:143]
  v_pk_fma_f32 v[14:15], v[142:143], v[142:143], v[14:15]
  v_pk_add_f32 v[12:13], v[12:13], v[144:145]
  v_pk_fma_f32 v[14:15], v[144:145], v[144:145], v[14:15]
  v_pk_add_f32 v[12:13], v[12:13], v[146:147]
  v_pk_fma_f32 v[14:15], v[146:147], v[146:147], v[14:15]
  v_pk_add_f32 v[12:13], v[12:13], v[148:149]
  v_pk_fma_f32 v[14:15], v[148:149], v[148:149], v[14:15]
  v_pk_add_f32 v[12:13], v[12:13], v[150:151]
  v_pk_fma_f32 v[14:15], v[150:151], v[150:151], v[14:15]
  v_pk_add_f32 v[12:13], v[12:13], v[152:153]
  v_pk_fma_f32 v[14:15], v[152:153], v[152:153], v[14:15]
  v_pk_add_f32 v[12:13], v[12:13], v[154:155]
  v_pk_fma_f32 v[14:15], v[154:155], v[154:155], v[14:15]
  v_pk_add_f32 v[12:13], v[12:13], v[156:157]
  v_pk_fma_f32 v[14:15], v[156:157], v[156:157], v[14:15]
  v_pk_add_f32 v[12:13], v[12:13], v[158:159]
  v_pk_fma_f32 v[14:15], v[158:159], v[158:159], v[14:15]
  v_add_f32 v12, v12, v13
  v_add_f32 v14, v14, v15
  s_nop 1
  v_permlane32_swap_b32 v12, v14
  v_add_f32 v12, v12, v14
  v_mov_b32 v14, v12
  s_nop 1
  v_permlane32_swap_b32 v12, v14
  v_mul_f32 v12, s24, v12
  v_mul_f32 v13, s24, v14
  v_fma_f32 v13, -v12, v12, v13
  v_max_f32 v13, 0, v13
  v_add_f32 v13, s25, v13
  v_rsq_f32 v13, v13
  v_sub_f32 v12, 0, v12
  v_mul_f32 v14, s22, v13
  v_mul_f32 v12, v12, v14
  v_pk_fma_f32 v[112:113], v[112:113], v[14:15], v[12:13] op_sel_hi:[1,0,0]
  v_pk_fma_f32 v[114:115], v[114:115], v[14:15], v[12:13] op_sel_hi:[1,0,0]
  v_pk_fma_f32 v[116:117], v[116:117], v[14:15], v[12:13] op_sel_hi:[1,0,0]
  v_pk_fma_f32 v[118:119], v[118:119], v[14:15], v[12:13] op_sel_hi:[1,0,0]
  v_pk_fma_f32 v[120:121], v[120:121], v[14:15], v[12:13] op_sel_hi:[1,0,0]
  v_pk_fma_f32 v[122:123], v[122:123], v[14:15], v[12:13] op_sel_hi:[1,0,0]
  v_pk_fma_f32 v[124:125], v[124:125], v[14:15], v[12:13] op_sel_hi:[1,0,0]
  v_pk_fma_f32 v[126:127], v[126:127], v[14:15], v[12:13] op_sel_hi:[1,0,0]
  v_pk_fma_f32 v[128:129], v[128:129], v[14:15], v[12:13] op_sel_hi:[1,0,0]
  v_pk_fma_f32 v[130:131], v[130:131], v[14:15], v[12:13] op_sel_hi:[1,0,0]
  v_pk_fma_f32 v[132:133], v[132:133], v[14:15], v[12:13] op_sel_hi:[1,0,0]
  v_pk_fma_f32 v[134:135], v[134:135], v[14:15], v[12:13] op_sel_hi:[1,0,0]
  v_pk_fma_f32 v[136:137], v[136:137], v[14:15], v[12:13] op_sel_hi:[1,0,0]
  v_pk_fma_f32 v[138:139], v[138:139], v[14:15], v[12:13] op_sel_hi:[1,0,0]
  v_pk_fma_f32 v[140:141], v[140:141], v[14:15], v[12:13] op_sel_hi:[1,0,0]
  v_pk_fma_f32 v[142:143], v[142:143], v[14:15], v[12:13] op_sel_hi:[1,0,0]
  v_pk_fma_f32 v[144:145], v[144:145], v[14:15], v[12:13] op_sel_hi:[1,0,0]
  v_pk_fma_f32 v[146:147], v[146:147], v[14:15], v[12:13] op_sel_hi:[1,0,0]
  v_pk_fma_f32 v[148:149], v[148:149], v[14:15], v[12:13] op_sel_hi:[1,0,0]
  v_pk_fma_f32 v[150:151], v[150:151], v[14:15], v[12:13] op_sel_hi:[1,0,0]
  v_pk_fma_f32 v[152:153], v[152:153], v[14:15], v[12:13] op_sel_hi:[1,0,0]
  v_pk_fma_f32 v[154:155], v[154:155], v[14:15], v[12:13] op_sel_hi:[1,0,0]
  v_pk_fma_f32 v[156:157], v[156:157], v[14:15], v[12:13] op_sel_hi:[1,0,0]
  v_pk_fma_f32 v[158:159], v[158:159], v[14:15], v[12:13] op_sel_hi:[1,0,0]
  v_cvt_pk_bf16_f32 v160, v112, v113
  v_cvt_pk_bf16_f32 v161, v114, v115
  v_cvt_pk_bf16_f32 v162, v116, v117
  v_cvt_pk_bf16_f32 v163, v118, v119
  v_cvt_pk_bf16_f32 v164, v120, v121
  v_cvt_pk_bf16_f32 v165, v122, v123
  v_cvt_pk_bf16_f32 v166, v124, v125
  v_cvt_pk_bf16_f32 v167, v126, v127
  v_cvt_pk_bf16_f32 v168, v128, v129
  v_cvt_pk_bf16_f32 v169, v130, v131
  v_cvt_pk_bf16_f32 v170, v132, v133
  v_cvt_pk_bf16_f32 v171, v134, v135
  v_cvt_pk_bf16_f32 v172, v136, v137
  v_cvt_pk_bf16_f32 v173, v138, v139
  v_cvt_pk_bf16_f32 v174, v140, v141
  v_cvt_pk_bf16_f32 v175, v142, v143
  v_cvt_pk_bf16_f32 v176, v144, v145
  v_cvt_pk_bf16_f32 v177, v146, v147
  v_cvt_pk_bf16_f32 v178, v148, v149
  v_cvt_pk_bf16_f32 v179, v150, v151
  v_cvt_pk_bf16_f32 v180, v152, v153
  v_cvt_pk_bf16_f32 v181, v154, v155
  v_cvt_pk_bf16_f32 v182, v156, v157
  v_cvt_pk_bf16_f32 v183, v158, v159
  v_subrev_u32 v11, 0x4100, v4
  v_add_u32 v4, 0x8200, v4
  v_min_u32 v4, v11, v4
  s_barrier
  s_mov_b32 s26, 8
  .p2align 6
L_loop:
  v_mfma_f32_32x32x16_bf16 v[16:31], a[0:3], v[160:163], v[16:31]
  ds_read_b128 v[192:195], v1 offset:59392
  ds_read_b128 v[196:199], v1 offset:60416
  v_rcp_f32 v48, v48
  v_rcp_f32 v49, v49
  v_mfma_f32_32x32x16_bf16 v[16:31], a[4:7], v[164:167], v[16:31]
  ds_read_b128 v[200:203], v1 offset:61440
  ds_read_b128 v[204:207], v1 offset:62464
  v_rcp_f32 v50, v50
  v_rcp_f32 v51, v51
  v_mfma_f32_32x32x16_bf16 v[16:31], a[8:11], v[168:171], v[16:31]
  ds_read_b128 v[208:211], v1 offset:63488
  ds_read_b128 v[212:215], v1 offset:64512
  v_rcp_f32 v52, v52
  v_rcp_f32 v53, v53
  v_mfma_f32_32x32x16_bf16 v[16:31], a[12:15], v[172:175], v[16:31]
  ds_read_b128 v[136:139], v5
  ds_read_b128 v[140:143], v5 offset:32
  ds_read_b128 v[144:147], v5 offset:64
  v_rcp_f32 v54, v54
  v_rcp_f32 v55, v55
  v_mfma_f32_32x32x16_bf16 v[16:31], a[16:19], v[176:179], v[16:31]
  ds_read_b128 v[148:151], v5 offset:96
  ds_read_b128 v[152:155], v5 offset:128
  ds_read_b128 v[156:159], v5 offset:160
  v_rcp_f32 v56, v56
  v_rcp_f32 v57, v57
  v_mfma_f32_32x32x16_bf16 v[16:31], a[20:23], v[180:183], v[16:31]
  s_waitcnt lgkmcnt(6)
  v_rcp_f32 v58, v58
  v_rcp_f32 v59, v59
  v_rcp_f32 v60, v60
  v_rcp_f32 v61, v61
  v_rcp_f32 v62, v62
  v_rcp_f32_e64 v63, v63
  v_pk_mul_f32 v[32:33], v[32:33], v[48:49]
  v_pk_mul_f32 v[34:35], v[34:35], v[50:51]
  v_pk_mul_f32 v[36:37], v[36:37], v[52:53]
  v_pk_mul_f32 v[38:39], v[38:39], v[54:55]
  v_pk_mul_f32 v[40:41], v[40:41], v[56:57]
  v_pk_mul_f32 v[42:43], v[42:43], v[58:59]
  v_pk_mul_f32 v[44:45], v[44:45], v[60:61]
  v_pk_mul_f32 v[46:47], v[46:47], v[62:63]
  v_pk_fma_f32 v[48:49], v[16:17], v[16:17], s[20:21] neg_lo:[1,0,1] neg_hi:[1,0,1]
  v_pk_fma_f32 v[50:51], v[18:19], v[18:19], s[20:21] neg_lo:[1,0,1] neg_hi:[1,0,1]
  v_pk_fma_f32 v[52:53], v[20:21], v[20:21], s[20:21] neg_lo:[1,0,1] neg_hi:[1,0,1]
  v_pk_fma_f32 v[54:55], v[22:23], v[22:23], s[20:21] neg_lo:[1,0,1] neg_hi:[1,0,1]
  v_pk_fma_f32 v[56:57], v[24:25], v[24:25], s[20:21] neg_lo:[1,0,1] neg_hi:[1,0,1]
  v_pk_fma_f32 v[58:59], v[26:27], v[26:27], s[20:21] neg_lo:[1,0,1] neg_hi:[1,0,1]
  v_pk_fma_f32 v[60:61], v[28:29], v[28:29], s[20:21] neg_lo:[1,0,1] neg_hi:[1,0,1]
  v_pk_fma_f32 v[62:63], v[30:31], v[30:31], s[20:21] neg_lo:[1,0,1] neg_hi:[1,0,1]
  v_pk_mul_f32 v[48:49], v[16:17], v[48:49]
  v_pk_mul_f32 v[50:51], v[18:19], v[50:51]
  v_pk_mul_f32 v[52:53], v[20:21], v[52:53]
  v_pk_mul_f32 v[54:55], v[22:23], v[54:55]
  v_pk_mul_f32 v[56:57], v[24:25], v[56:57]
  v_cvt_pk_bf16_f32 v184, v32, v33
  v_cvt_pk_bf16_f32 v185, v34, v35
  v_cvt_pk_bf16_f32 v186, v36, v37
  v_cvt_pk_bf16_f32 v187, v38, v39
  v_pk_mul_f32 v[58:59], v[26:27], v[58:59]
  v_pk_mul_f32 v[60:61], v[28:29], v[60:61]
  v_pk_mul_f32 v[62:63], v[30:31], v[62:63]
  v_mfma_f32_32x32x16_bf16 v[64:79], v[192:195], v[184:187], v[64:79]
  s_nop 0
  s_mov_b32 m0, s30
  v_cvt_pk_bf16_f32 v188, v40, v41
  v_cvt_pk_bf16_f32 v189, v42, v43
  v_cvt_pk_bf16_f32 v190, v44, v45
  v_cvt_pk_bf16_f32 v191, v46, v47
  v_exp_f32 v48, v48
  v_mfma_f32_32x32x16_bf16 v[80:95], v[196:199], v[184:187], v[80:95]
  s_waitcnt lgkmcnt(0)
  ds_read_b128 v[32:35], v2 offset:128
  ds_read_b128 v[36:39], v2 offset:160
  buffer_load_dwordx4 v6, s[4:7], s29 offen lds
  v_exp_f32 v49, v49
  v_exp_f32 v50, v50
  v_mfma_f32_32x32x16_bf16 v[96:111], v[200:203], v[184:187], v[96:111]
  ds_read_b128 v[40:43], v2 offset:192
  ds_read_b128 v[44:47], v2 offset:224
  buffer_load_dwordx4 v7, s[4:7], s29 offen offset:1024 lds
  v_exp_f32 v51, v51
  v_exp_f32 v52, v52
  v_mfma_f32_32x32x16_bf16 v[64:79], v[204:207], v[188:191], v[64:79]
  buffer_load_dwordx4 v8, s[4:7], s29 offen offset:2048 lds
  v_exp_f32 v53, v53
  v_exp_f32 v54, v54
  v_exp_f32_e64 v55, v55
  v_mfma_f32_32x32x16_bf16 v[80:95], v[208:211], v[188:191], v[80:95]
  buffer_load_dwordx4 v9, s[4:7], s29 offen offset:3072 lds
  v_exp_f32 v56, v56
  v_exp_f32 v57, v57
  v_exp_f32_e64 v58, v58
  v_mfma_f32_32x32x16_bf16 v[96:111], v[212:215], v[188:191], v[96:111]
  s_waitcnt lgkmcnt(0)
  v_exp_f32 v59, v59
  v_exp_f32 v60, v60
  v_exp_f32 v61, v61
  v_exp_f32 v62, v62
  v_exp_f32 v63, v63
  v_pk_fma_f32 v[48:49], v[48:49], s[22:23], s[22:23]
  v_pk_fma_f32 v[50:51], v[50:51], s[22:23], s[22:23]
  v_pk_fma_f32 v[52:53], v[52:53], s[22:23], s[22:23]
  v_pk_fma_f32 v[54:55], v[54:55], s[22:23], s[22:23]
  v_pk_fma_f32 v[56:57], v[56:57], s[22:23], s[22:23]
  v_pk_fma_f32 v[58:59], v[58:59], s[22:23], s[22:23]
  v_pk_fma_f32 v[60:61], v[60:61], s[22:23], s[22:23]
  v_pk_fma_f32 v[62:63], v[62:63], s[22:23], s[22:23]
  v_mfma_f32_32x32x16_bf16 v[32:47], a[24:27], v[160:163], v[32:47]
  ds_read_b128 v[192:195], v0 offset:40192
  ds_read_b128 v[196:199], v0 offset:41216
  v_rcp_f32_e64 v48, v48
  v_cvt_pk_bf16_f32 v112, v64, v65
  v_rcp_f32_e64 v49, v49
  v_cvt_pk_bf16_f32 v113, v66, v67
  v_cvt_pk_bf16_f32 v114, v68, v69
  v_mfma_f32_32x32x16_bf16 v[32:47], a[28:31], v[164:167], v[32:47]
  ds_read_b128 v[200:203], v0 offset:42240
  ds_read_b128 v[204:207], v0 offset:43264
  v_rcp_f32_e64 v50, v50
  v_cvt_pk_bf16_f32 v115, v70, v71
  v_rcp_f32_e64 v51, v51
  v_cvt_pk_bf16_f32 v116, v72, v73
  v_cvt_pk_bf16_f32 v117, v74, v75
  v_mfma_f32_32x32x16_bf16 v[32:47], a[32:35], v[168:171], v[32:47]
  ds_read_b128 v[208:211], v0 offset:44288
  ds_read_b128 v[212:215], v0 offset:45312
  v_rcp_f32_e64 v52, v52
  v_cvt_pk_bf16_f32 v118, v76, v77
  v_rcp_f32_e64 v53, v53
  v_cvt_pk_bf16_f32 v119, v78, v79
  v_cvt_pk_bf16_f32 v120, v80, v81
  v_mfma_f32_32x32x16_bf16 v[32:47], a[36:39], v[172:175], v[32:47]
  v_rcp_f32_e64 v54, v54
  v_cvt_pk_bf16_f32 v121, v82, v83
  v_rcp_f32_e64 v55, v55
  v_cvt_pk_bf16_f32 v122, v84, v85
  v_cvt_pk_bf16_f32 v123, v86, v87
  v_rcp_f32_e64 v56, v56
  v_mfma_f32_32x32x16_bf16 v[32:47], a[40:43], v[176:179], v[32:47]
  v_cvt_pk_bf16_f32 v124, v88, v89
  v_rcp_f32_e64 v57, v57
  v_cvt_pk_bf16_f32 v125, v90, v91
  v_cvt_pk_bf16_f32 v126, v92, v93
  v_rcp_f32_e64 v58, v58
  v_cvt_pk_bf16_f32 v127, v94, v95
  v_rcp_f32 v59, v59
  v_mfma_f32_32x32x16_bf16 v[32:47], a[44:47], v[180:183], v[32:47]
  s_waitcnt lgkmcnt(0)
  v_cvt_pk_bf16_f32 v128, v96, v97
  v_cvt_pk_bf16_f32 v129, v98, v99
  v_rcp_f32_e64 v60, v60
  v_cvt_pk_bf16_f32 v130, v100, v101
  v_rcp_f32_e64 v61, v61
  v_cvt_pk_bf16_f32 v131, v102, v103
  v_cvt_pk_bf16_f32 v132, v104, v105
  v_rcp_f32_e64 v62, v62
  v_cvt_pk_bf16_f32 v133, v106, v107
  v_rcp_f32_e64 v63, v63
  v_cvt_pk_bf16_f32 v134, v108, v109
  v_cvt_pk_bf16_f32 v135, v110, v111
  ds_read_b128 v[64:67], v2 offset:1536
  ds_read_b128 v[68:71], v2 offset:1568
  ds_read_b128 v[72:75], v2 offset:1600
  ds_read_b128 v[76:79], v2 offset:1632
  ds_read_b128 v[80:83], v2 offset:1664
  ds_read_b128 v[84:87], v2 offset:1696
  ds_read_b128 v[88:91], v2 offset:1728
  ds_read_b128 v[92:95], v2 offset:1760
  ds_read_b128 v[96:99], v2 offset:1792
  ds_read_b128 v[100:103], v2 offset:1824
  ds_read_b128 v[104:107], v2 offset:1856
  ds_read_b128 v[108:111], v2 offset:1888
  v_pk_mul_f32 v[16:17], v[16:17], v[48:49]
  v_pk_mul_f32 v[18:19], v[18:19], v[50:51]
  v_pk_mul_f32 v[20:21], v[20:21], v[52:53]
  v_pk_mul_f32 v[22:23], v[22:23], v[54:55]
  v_pk_mul_f32 v[24:25], v[24:25], v[56:57]
  v_pk_mul_f32 v[26:27], v[26:27], v[58:59]
  v_pk_mul_f32 v[28:29], v[28:29], v[60:61]
  v_pk_mul_f32 v[30:31], v[30:31], v[62:63]
  v_pk_fma_f32 v[48:49], v[32:33], v[32:33], s[20:21] neg_lo:[1,0,1] neg_hi:[1,0,1]
  v_pk_fma_f32 v[50:51], v[34:35], v[34:35], s[20:21] neg_lo:[1,0,1] neg_hi:[1,0,1]
  v_pk_fma_f32 v[52:53], v[36:37], v[36:37], s[20:21] neg_lo:[1,0,1] neg_hi:[1,0,1]
  v_pk_fma_f32 v[54:55], v[38:39], v[38:39], s[20:21] neg_lo:[1,0,1] neg_hi:[1,0,1]
  v_pk_fma_f32 v[56:57], v[40:41], v[40:41], s[20:21] neg_lo:[1,0,1] neg_hi:[1,0,1]
  v_pk_fma_f32 v[58:59], v[42:43], v[42:43], s[20:21] neg_lo:[1,0,1] neg_hi:[1,0,1]
  v_pk_fma_f32 v[60:61], v[44:45], v[44:45], s[20:21] neg_lo:[1,0,1] neg_hi:[1,0,1]
  v_pk_fma_f32 v[62:63], v[46:47], v[46:47], s[20:21] neg_lo:[1,0,1] neg_hi:[1,0,1]
  v_pk_mul_f32 v[48:49], v[32:33], v[48:49]
  v_pk_mul_f32 v[50:51], v[34:35], v[50:51]
  v_pk_mul_f32 v[52:53], v[36:37], v[52:53]
  v_pk_mul_f32 v[54:55], v[38:39], v[54:55]
  v_pk_mul_f32 v[56:57], v[40:41], v[56:57]
  v_cvt_pk_bf16_f32 v184, v16, v17
  v_cvt_pk_bf16_f32 v185, v18, v19
  v_cvt_pk_bf16_f32 v186, v20, v21
  v_cvt_pk_bf16_f32 v187, v22, v23
  v_pk_mul_f32 v[58:59], v[42:43], v[58:59]
  v_pk_mul_f32 v[60:61], v[44:45], v[60:61]
  v_pk_mul_f32 v[62:63], v[46:47], v[62:63]
  s_waitcnt lgkmcnt(8)
  v_mfma_f32_32x32x16_bf16 v[64:79], v[192:195], v[184:187], v[64:79]
  s_mov_b32 m0, s31
  v_cvt_pk_bf16_f32 v188, v24, v25
  v_cvt_pk_bf16_f32 v189, v26, v27
  v_cvt_pk_bf16_f32 v190, v28, v29
  v_cvt_pk_bf16_f32 v191, v30, v31
  v_exp_f32 v48, v48
  s_waitcnt lgkmcnt(4)
  v_mfma_f32_32x32x16_bf16 v[80:95], v[196:199], v[184:187], v[80:95]
  ds_read_b128 v[16:19], v2 offset:256
  ds_read_b128 v[20:23], v2 offset:288
  buffer_load_dwordx4 v6, s[4:7], s52 offen lds
  v_exp_f32_e64 v49, v49
  v_exp_f32 v50, v50
  s_waitcnt lgkmcnt(2)
  v_mfma_f32_32x32x16_bf16 v[96:111], v[200:203], v[184:187], v[96:111]
  ds_read_b128 v[24:27], v2 offset:320
  ds_read_b128 v[28:31], v2 offset:352
  buffer_load_dwordx4 v7, s[4:7], s52 offen offset:1024 lds
  v_exp_f32 v51, v51
  v_exp_f32 v52, v52
  v_mfma_f32_32x32x16_bf16 v[64:79], v[204:207], v[188:191], v[64:79]
  buffer_load_dwordx4 v8, s[4:7], s52 offen offset:2048 lds
  v_exp_f32 v53, v53
  v_exp_f32 v54, v54
  v_exp_f32_e64 v55, v55
  v_mfma_f32_32x32x16_bf16 v[80:95], v[208:211], v[188:191], v[80:95]
  buffer_load_dwordx4 v9, s[4:7], s52 offen offset:3072 lds
  v_exp_f32 v56, v56
  v_exp_f32 v57, v57
  v_exp_f32_e64 v58, v58
  v_mfma_f32_32x32x16_bf16 v[96:111], v[212:215], v[188:191], v[96:111]
  v_exp_f32 v59, v59
  v_exp_f32 v60, v60
  v_exp_f32_e64 v61, v61
  v_mfma_f32_32x32x16_bf16 v[64:79], v[240:243], v[136:139], v[64:79]
  v_exp_f32 v62, v62
  v_exp_f32 v63, v63
  v_mfma_f32_32x32x16_bf16 v[80:95], v[240:243], v[144:147], v[80:95]
  v_mfma_f32_32x32x16_bf16 v[96:111], v[240:243], v[152:155], v[96:111]
  v_mfma_f32_32x32x16_bf16 v[64:79], v[244:247], v[140:143], v[64:79]
  v_mfma_f32_32x32x16_bf16 v[80:95], v[244:247], v[148:151], v[80:95]
  v_mfma_f32_32x32x16_bf16 v[96:111], v[244:247], v[156:159], v[96:111]
  s_nop 0
  s_waitcnt lgkmcnt(0)
  v_pk_fma_f32 v[48:49], v[48:49], s[22:23], s[22:23]
  v_pk_fma_f32 v[50:51], v[50:51], s[22:23], s[22:23]
  v_pk_fma_f32 v[52:53], v[52:53], s[22:23], s[22:23]
  v_pk_fma_f32 v[54:55], v[54:55], s[22:23], s[22:23]
  v_pk_fma_f32 v[56:57], v[56:57], s[22:23], s[22:23]
  v_pk_fma_f32 v[58:59], v[58:59], s[22:23], s[22:23]
  v_pk_fma_f32 v[60:61], v[60:61], s[22:23], s[22:23]
  v_pk_fma_f32 v[62:63], v[62:63], s[22:23], s[22:23]
  v_mfma_f32_32x32x16_bf16 v[16:31], a[48:51], v[160:163], v[16:31]
  ds_read_b128 v[192:195], v0 offset:46336
  ds_read_b128 v[196:199], v0 offset:47360
  v_rcp_f32 v48, v48
  v_rcp_f32 v49, v49
  v_mfma_f32_32x32x16_bf16 v[16:31], a[52:55], v[164:167], v[16:31]
  ds_read_b128 v[200:203], v1
  ds_read_b128 v[204:207], v1 offset:1024
  v_rcp_f32 v50, v50
  v_rcp_f32 v51, v51
  v_mfma_f32_32x32x16_bf16 v[16:31], a[56:59], v[168:171], v[16:31]
  ds_read_b128 v[208:211], v1 offset:2048
  ds_read_b128 v[212:215], v1 offset:3072
  v_rcp_f32 v52, v52
  v_rcp_f32 v53, v53
  v_mfma_f32_32x32x16_bf16 v[16:31], a[60:63], v[172:175], v[16:31]
  buffer_store_dwordx4 v[112:115], v10, s[8:11], s28 offen
  v_rcp_f32 v54, v54
  v_rcp_f32 v55, v55
  v_rcp_f32_e64 v56, v56
  v_mfma_f32_32x32x16_bf16 v[16:31], a[64:67], v[176:179], v[16:31]
  v_rcp_f32 v57, v57
  v_rcp_f32 v58, v58
  v_rcp_f32_e64 v59, v59
  v_mfma_f32_32x32x16_bf16 v[16:31], a[68:71], v[180:183], v[16:31]
  s_waitcnt lgkmcnt(0)
  v_rcp_f32 v60, v60
  v_rcp_f32 v61, v61
  v_rcp_f32 v62, v62
  v_rcp_f32_e64 v63, v63
  v_pk_mul_f32 v[32:33], v[32:33], v[48:49]
  v_pk_mul_f32 v[34:35], v[34:35], v[50:51]
  v_pk_mul_f32 v[36:37], v[36:37], v[52:53]
  v_pk_mul_f32 v[38:39], v[38:39], v[54:55]
  v_pk_mul_f32 v[40:41], v[40:41], v[56:57]
  v_pk_mul_f32 v[42:43], v[42:43], v[58:59]
  v_pk_mul_f32 v[44:45], v[44:45], v[60:61]
  v_pk_mul_f32 v[46:47], v[46:47], v[62:63]
  v_pk_fma_f32 v[48:49], v[16:17], v[16:17], s[20:21] neg_lo:[1,0,1] neg_hi:[1,0,1]
  v_pk_fma_f32 v[50:51], v[18:19], v[18:19], s[20:21] neg_lo:[1,0,1] neg_hi:[1,0,1]
  v_pk_fma_f32 v[52:53], v[20:21], v[20:21], s[20:21] neg_lo:[1,0,1] neg_hi:[1,0,1]
  v_pk_fma_f32 v[54:55], v[22:23], v[22:23], s[20:21] neg_lo:[1,0,1] neg_hi:[1,0,1]
  v_pk_fma_f32 v[56:57], v[24:25], v[24:25], s[20:21] neg_lo:[1,0,1] neg_hi:[1,0,1]
  v_pk_fma_f32 v[58:59], v[26:27], v[26:27], s[20:21] neg_lo:[1,0,1] neg_hi:[1,0,1]
  v_pk_fma_f32 v[60:61], v[28:29], v[28:29], s[20:21] neg_lo:[1,0,1] neg_hi:[1,0,1]
  v_pk_fma_f32 v[62:63], v[30:31], v[30:31], s[20:21] neg_lo:[1,0,1] neg_hi:[1,0,1]
  v_pk_mul_f32 v[48:49], v[16:17], v[48:49]
  v_pk_mul_f32 v[50:51], v[18:19], v[50:51]
  v_pk_mul_f32 v[52:53], v[20:21], v[52:53]
  v_pk_mul_f32 v[54:55], v[22:23], v[54:55]
  v_pk_mul_f32 v[56:57], v[24:25], v[56:57]
  v_cvt_pk_bf16_f32 v184, v32, v33
  v_cvt_pk_bf16_f32 v185, v34, v35
  v_cvt_pk_bf16_f32 v186, v36, v37
  v_cvt_pk_bf16_f32 v187, v38, v39
  v_pk_mul_f32 v[58:59], v[26:27], v[58:59]
  v_pk_mul_f32 v[60:61], v[28:29], v[60:61]
  v_pk_mul_f32 v[62:63], v[30:31], v[62:63]
  v_mfma_f32_32x32x16_bf16 v[64:79], v[192:195], v[184:187], v[64:79]
  v_cvt_pk_bf16_f32 v188, v40, v41
  v_cvt_pk_bf16_f32 v189, v42, v43
  v_cvt_pk_bf16_f32 v190, v44, v45
  v_cvt_pk_bf16_f32 v191, v46, v47
  v_exp_f32_e64 v48, v48
  v_mfma_f32_32x32x16_bf16 v[80:95], v[196:199], v[184:187], v[80:95]
  ds_read_b128 v[32:35], v2 offset:384
  ds_read_b128 v[36:39], v2 offset:416
  v_exp_f32 v49, v49
  v_exp_f32 v50, v50
  v_mfma_f32_32x32x16_bf16 v[96:111], v[200:203], v[184:187], v[96:111]
  ds_read_b128 v[40:43], v2 offset:448
  ds_read_b128 v[44:47], v2 offset:480
  v_exp_f32 v51, v51
  v_exp_f32 v52, v52
  v_mfma_f32_32x32x16_bf16 v[64:79], v[204:207], v[188:191], v[64:79]
  buffer_store_dwordx4 v[116:119], v10, s[8:11], s28 offen offset:32
  v_exp_f32_e64 v53, v53
  v_subrev_u32 v11, 0x4100, v5
  v_exp_f32_e64 v54, v54
  v_mfma_f32_32x32x16_bf16 v[80:95], v[208:211], v[188:191], v[80:95]
  v_exp_f32 v55, v55
  v_exp_f32 v56, v56
  v_exp_f32 v57, v57
  v_exp_f32 v58, v58
  v_mfma_f32_32x32x16_bf16 v[96:111], v[212:215], v[188:191], v[96:111]
  s_waitcnt lgkmcnt(0)
  v_add_u32 v5, 0x8200, v5
  v_exp_f32 v59, v59
  v_exp_f32 v60, v60
  v_exp_f32 v61, v61
  v_exp_f32 v62, v62
  v_exp_f32 v63, v63
  v_min_u32_e64 v5, v11, v5
  v_pk_fma_f32 v[48:49], v[48:49], s[22:23], s[22:23]
  v_pk_fma_f32 v[50:51], v[50:51], s[22:23], s[22:23]
  v_pk_fma_f32 v[52:53], v[52:53], s[22:23], s[22:23]
  v_pk_fma_f32 v[54:55], v[54:55], s[22:23], s[22:23]
  v_pk_fma_f32 v[56:57], v[56:57], s[22:23], s[22:23]
  v_pk_fma_f32 v[58:59], v[58:59], s[22:23], s[22:23]
  v_pk_fma_f32 v[60:61], v[60:61], s[22:23], s[22:23]
  v_pk_fma_f32 v[62:63], v[62:63], s[22:23], s[22:23]
  v_mfma_f32_32x32x16_bf16 v[32:47], a[72:75], v[160:163], v[32:47]
  ds_read_b128 v[192:195], v1 offset:4096
  ds_read_b128 v[196:199], v1 offset:5120
  v_rcp_f32 v48, v48
  v_rcp_f32 v49, v49
  v_mfma_f32_32x32x16_bf16 v[32:47], a[76:79], v[164:167], v[32:47]
  ds_read_b128 v[200:203], v1 offset:6144
  ds_read_b128 v[204:207], v1 offset:7168
  v_rcp_f32 v50, v50
  v_rcp_f32 v51, v51
  v_mfma_f32_32x32x16_bf16 v[32:47], a[80:83], v[168:171], v[32:47]
  ds_read_b128 v[208:211], v1 offset:8192
  ds_read_b128 v[212:215], v1 offset:9216
  v_rcp_f32 v52, v52
  v_rcp_f32 v53, v53
  v_mfma_f32_32x32x16_bf16 v[32:47], a[84:87], v[172:175], v[32:47]
  buffer_store_dwordx4 v[120:123], v10, s[8:11], s28 offen offset:64
  v_rcp_f32 v54, v54
  v_rcp_f32 v55, v55
  v_rcp_f32_e64 v56, v56
  v_mfma_f32_32x32x16_bf16 v[32:47], a[88:91], v[176:179], v[32:47]
  v_rcp_f32 v57, v57
  v_rcp_f32 v58, v58
  v_rcp_f32_e64 v59, v59
  v_mfma_f32_32x32x16_bf16 v[32:47], a[92:95], v[180:183], v[32:47]
  s_waitcnt lgkmcnt(0)
  v_rcp_f32 v60, v60
  v_rcp_f32 v61, v61
  v_rcp_f32 v62, v62
  v_rcp_f32_e64 v63, v63
  v_pk_mul_f32 v[16:17], v[16:17], v[48:49]
  v_pk_mul_f32 v[18:19], v[18:19], v[50:51]
  v_pk_mul_f32 v[20:21], v[20:21], v[52:53]
  v_pk_mul_f32 v[22:23], v[22:23], v[54:55]
  v_pk_mul_f32 v[24:25], v[24:25], v[56:57]
  v_pk_mul_f32 v[26:27], v[26:27], v[58:59]
  v_pk_mul_f32 v[28:29], v[28:29], v[60:61]
  v_pk_mul_f32 v[30:31], v[30:31], v[62:63]
  v_pk_fma_f32 v[48:49], v[32:33], v[32:33], s[20:21] neg_lo:[1,0,1] neg_hi:[1,0,1]
  v_pk_fma_f32 v[50:51], v[34:35], v[34:35], s[20:21] neg_lo:[1,0,1] neg_hi:[1,0,1]
  v_pk_fma_f32 v[52:53], v[36:37], v[36:37], s[20:21] neg_lo:[1,0,1] neg_hi:[1,0,1]
  v_pk_fma_f32 v[54:55], v[38:39], v[38:39], s[20:21] neg_lo:[1,0,1] neg_hi:[1,0,1]
  v_pk_fma_f32 v[56:57], v[40:41], v[40:41], s[20:21] neg_lo:[1,0,1] neg_hi:[1,0,1]
  v_pk_fma_f32 v[58:59], v[42:43], v[42:43], s[20:21] neg_lo:[1,0,1] neg_hi:[1,0,1]
  v_pk_fma_f32 v[60:61], v[44:45], v[44:45], s[20:21] neg_lo:[1,0,1] neg_hi:[1,0,1]
  v_pk_fma_f32 v[62:63], v[46:47], v[46:47], s[20:21] neg_lo:[1,0,1] neg_hi:[1,0,1]
  v_pk_mul_f32 v[48:49], v[32:33], v[48:49]
  v_pk_mul_f32 v[50:51], v[34:35], v[50:51]
  v_pk_mul_f32 v[52:53], v[36:37], v[52:53]
  v_pk_mul_f32 v[54:55], v[38:39], v[54:55]
  v_pk_mul_f32 v[56:57], v[40:41], v[56:57]
  v_cvt_pk_bf16_f32 v184, v16, v17
  v_cvt_pk_bf16_f32 v185, v18, v19
  v_cvt_pk_bf16_f32 v186, v20, v21
  v_cvt_pk_bf16_f32 v187, v22, v23
  v_pk_mul_f32 v[58:59], v[42:43], v[58:59]
  v_pk_mul_f32 v[60:61], v[44:45], v[60:61]
  v_pk_mul_f32 v[62:63], v[46:47], v[62:63]
  v_mfma_f32_32x32x16_bf16 v[64:79], v[192:195], v[184:187], v[64:79]
  v_cvt_pk_bf16_f32 v188, v24, v25
  v_cvt_pk_bf16_f32 v189, v26, v27
  v_cvt_pk_bf16_f32 v190, v28, v29
  v_cvt_pk_bf16_f32 v191, v30, v31
  v_exp_f32_e64 v48, v48
  v_mfma_f32_32x32x16_bf16 v[80:95], v[196:199], v[184:187], v[80:95]
  ds_read_b128 v[16:19], v2 offset:512
  ds_read_b128 v[20:23], v2 offset:544
  v_exp_f32 v49, v49
  v_exp_f32 v50, v50
  v_mfma_f32_32x32x16_bf16 v[96:111], v[200:203], v[184:187], v[96:111]
  ds_read_b128 v[24:27], v2 offset:576
  ds_read_b128 v[28:31], v2 offset:608
  v_exp_f32 v51, v51
  v_exp_f32 v52, v52
  v_mfma_f32_32x32x16_bf16 v[64:79], v[204:207], v[188:191], v[64:79]
  buffer_store_dwordx4 v[124:127], v10, s[8:11], s28 offen offset:96
  v_exp_f32 v53, v53
  v_exp_f32 v54, v54
  v_exp_f32_e64 v55, v55
  v_mfma_f32_32x32x16_bf16 v[80:95], v[208:211], v[188:191], v[80:95]
  v_exp_f32 v56, v56
  v_exp_f32 v57, v57
  v_exp_f32_e64 v58, v58
  v_mfma_f32_32x32x16_bf16 v[96:111], v[212:215], v[188:191], v[96:111]
  s_waitcnt lgkmcnt(0)
  v_exp_f32 v59, v59
  v_exp_f32 v60, v60
  v_exp_f32 v61, v61
  v_exp_f32 v62, v62
  v_exp_f32 v63, v63
  v_pk_fma_f32 v[48:49], v[48:49], s[22:23], s[22:23]
  v_pk_fma_f32 v[50:51], v[50:51], s[22:23], s[22:23]
  v_pk_fma_f32 v[52:53], v[52:53], s[22:23], s[22:23]
  v_pk_fma_f32 v[54:55], v[54:55], s[22:23], s[22:23]
  v_pk_fma_f32 v[56:57], v[56:57], s[22:23], s[22:23]
  v_pk_fma_f32 v[58:59], v[58:59], s[22:23], s[22:23]
  v_pk_fma_f32 v[60:61], v[60:61], s[22:23], s[22:23]
  v_pk_fma_f32 v[62:63], v[62:63], s[22:23], s[22:23]
  v_mfma_f32_32x32x16_bf16 v[16:31], a[96:99], v[160:163], v[16:31]
  ds_read_b128 v[248:251], v0
  ds_read_b128 v[192:195], v1 offset:10240
  ds_read_b128 v[196:199], v1 offset:11264
  v_rcp_f32 v48, v48
  v_rcp_f32 v49, v49
  v_mfma_f32_32x32x16_bf16 v[16:31], a[100:103], v[164:167], v[16:31]
  ds_read_b128 v[200:203], v1 offset:12288
  ds_read_b128 v[204:207], v1 offset:13312
  v_rcp_f32 v50, v50
  v_rcp_f32 v51, v51
  v_mfma_f32_32x32x16_bf16 v[16:31], a[104:107], v[168:171], v[16:31]
  ds_read_b128 v[208:211], v1 offset:14336
  ds_read_b128 v[212:215], v1 offset:15360
  v_rcp_f32 v52, v52
  v_rcp_f32 v53, v53
  v_mfma_f32_32x32x16_bf16 v[16:31], a[108:111], v[172:175], v[16:31]
  buffer_store_dwordx4 v[128:131], v10, s[8:11], s28 offen offset:128
  v_rcp_f32 v54, v54
  v_rcp_f32 v55, v55
  v_rcp_f32_e64 v56, v56
  v_mfma_f32_32x32x16_bf16 v[16:31], a[112:115], v[176:179], v[16:31]
  s_waitcnt lgkmcnt(6)
  v_rcp_f32 v57, v57
  v_rcp_f32 v58, v58
  v_rcp_f32 v59, v59
  v_mfma_f32_32x32x16_bf16 v[16:31], v[248:251], v[180:183], v[16:31]
  s_waitcnt lgkmcnt(0)
  v_rcp_f32 v60, v60
  v_rcp_f32 v61, v61
  v_rcp_f32 v62, v62
  v_rcp_f32_e64 v63, v63
  v_pk_mul_f32 v[32:33], v[32:33], v[48:49]
  v_pk_mul_f32 v[34:35], v[34:35], v[50:51]
  v_pk_mul_f32 v[36:37], v[36:37], v[52:53]
  v_pk_mul_f32 v[38:39], v[38:39], v[54:55]
  v_pk_mul_f32 v[40:41], v[40:41], v[56:57]
  v_pk_mul_f32 v[42:43], v[42:43], v[58:59]
  v_pk_mul_f32 v[44:45], v[44:45], v[60:61]
  v_pk_mul_f32 v[46:47], v[46:47], v[62:63]
  v_pk_fma_f32 v[48:49], v[16:17], v[16:17], s[20:21] neg_lo:[1,0,1] neg_hi:[1,0,1]
  v_pk_fma_f32 v[50:51], v[18:19], v[18:19], s[20:21] neg_lo:[1,0,1] neg_hi:[1,0,1]
  v_pk_fma_f32 v[52:53], v[20:21], v[20:21], s[20:21] neg_lo:[1,0,1] neg_hi:[1,0,1]
  v_pk_fma_f32 v[54:55], v[22:23], v[22:23], s[20:21] neg_lo:[1,0,1] neg_hi:[1,0,1]
  v_pk_fma_f32 v[56:57], v[24:25], v[24:25], s[20:21] neg_lo:[1,0,1] neg_hi:[1,0,1]
  v_pk_fma_f32 v[58:59], v[26:27], v[26:27], s[20:21] neg_lo:[1,0,1] neg_hi:[1,0,1]
  v_pk_fma_f32 v[60:61], v[28:29], v[28:29], s[20:21] neg_lo:[1,0,1] neg_hi:[1,0,1]
  v_pk_fma_f32 v[62:63], v[30:31], v[30:31], s[20:21] neg_lo:[1,0,1] neg_hi:[1,0,1]
  v_pk_mul_f32 v[48:49], v[16:17], v[48:49]
  v_pk_mul_f32 v[50:51], v[18:19], v[50:51]
  v_pk_mul_f32 v[52:53], v[20:21], v[52:53]
  v_pk_mul_f32 v[54:55], v[22:23], v[54:55]
  v_pk_mul_f32 v[56:57], v[24:25], v[56:57]
  v_cvt_pk_bf16_f32 v184, v32, v33
  v_cvt_pk_bf16_f32 v185, v34, v35
  v_cvt_pk_bf16_f32 v186, v36, v37
  v_cvt_pk_bf16_f32 v187, v38, v39
  v_pk_mul_f32 v[58:59], v[26:27], v[58:59]
  v_pk_mul_f32 v[60:61], v[28:29], v[60:61]
  v_pk_mul_f32 v[62:63], v[30:31], v[62:63]
  v_mfma_f32_32x32x16_bf16 v[64:79], v[192:195], v[184:187], v[64:79]
  s_nop 0
  s_waitcnt vmcnt(5)
  ds_read_b128 v[216:219], v3
  ds_read_b128 v[220:223], v4
  v_cvt_pk_bf16_f32 v188, v40, v41
  v_cvt_pk_bf16_f32 v189, v42, v43
  v_cvt_pk_bf16_f32 v190, v44, v45
  v_cvt_pk_bf16_f32 v191, v46, v47
  v_mfma_f32_32x32x16_bf16 v[80:95], v[196:199], v[184:187], v[80:95]
  ds_read_b128 v[32:35], v2 offset:640
  ds_read_b128 v[36:39], v2 offset:672
  ds_read_b128 v[224:227], v3 offset:4800
  ds_read_b128 v[228:231], v4 offset:192
  v_exp_f32_e64 v48, v48
  v_mfma_f32_32x32x16_bf16 v[96:111], v[200:203], v[184:187], v[96:111]
  ds_read_b128 v[40:43], v2 offset:704
  ds_read_b128 v[44:47], v2 offset:736
  ds_read_b128 v[232:235], v3 offset:9600
  ds_read_b128 v[236:239], v4 offset:384
  v_exp_f32 v49, v49
  v_exp_f32 v50, v50
  v_mfma_f32_32x32x16_bf16 v[64:79], v[204:207], v[188:191], v[64:79]
  buffer_store_dwordx4 v[132:135], v10, s[8:11], s28 offen offset:160
  v_exp_f32 v51, v51
  v_exp_f32 v52, v52
  v_exp_f32_e64 v53, v53
  v_mfma_f32_32x32x16_bf16 v[80:95], v[208:211], v[188:191], v[80:95]
  v_exp_f32 v54, v54
  v_exp_f32 v55, v55
  v_exp_f32 v56, v56
  v_exp_f32 v57, v57
  v_mfma_f32_32x32x16_bf16 v[96:111], v[212:215], v[188:191], v[96:111]
  s_waitcnt lgkmcnt(0)
  v_exp_f32 v58, v58
  v_exp_f32 v59, v59
  v_exp_f32 v60, v60
  v_exp_f32 v61, v61
  v_exp_f32 v62, v62
  v_exp_f32_e64 v63, v63
  v_pk_fma_f32 v[48:49], v[48:49], s[22:23], s[22:23]
  v_pk_fma_f32 v[50:51], v[50:51], s[22:23], s[22:23]
  v_pk_fma_f32 v[52:53], v[52:53], s[22:23], s[22:23]
  v_pk_fma_f32 v[54:55], v[54:55], s[22:23], s[22:23]
  v_pk_fma_f32 v[56:57], v[56:57], s[22:23], s[22:23]
  v_pk_fma_f32 v[58:59], v[58:59], s[22:23], s[22:23]
  v_pk_fma_f32 v[60:61], v[60:61], s[22:23], s[22:23]
  v_pk_fma_f32 v[62:63], v[62:63], s[22:23], s[22:23]
  v_mfma_f32_32x32x16_bf16 v[32:47], a[116:119], v[160:163], v[32:47]
  ds_read_b128 v[248:251], v0 offset:1024
  ds_read_b128 v[192:195], v1 offset:16384
  ds_read_b128 v[196:199], v1 offset:17408
  v_rcp_f32 v48, v48
  v_rcp_f32 v49, v49
  v_mfma_f32_16x16x32_bf16 v[112:115], v[216:219], v[220:223], 0
  ds_read_b128 v[216:219], v3 offset:400
  ds_read_b128 v[220:223], v4 offset:16
  v_mfma_f32_32x32x16_bf16 v[32:47], a[120:123], v[164:167], v[32:47]
  ds_read_b128 v[200:203], v1 offset:18432
  ds_read_b128 v[204:207], v1 offset:19456
  v_rcp_f32 v50, v50
  v_rcp_f32 v51, v51
  v_mfma_f32_16x16x32_bf16 v[112:115], v[224:227], v[228:231], v[112:115]
  ds_read_b128 v[224:227], v3 offset:5200
  ds_read_b128 v[228:231], v4 offset:208
  v_mfma_f32_32x32x16_bf16 v[32:47], a[124:127], v[168:171], v[32:47]
  ds_read_b128 v[208:211], v1 offset:20480
  ds_read_b128 v[212:215], v1 offset:21504
  v_rcp_f32 v52, v52
  v_rcp_f32 v53, v53
  v_mfma_f32_16x16x32_bf16 v[112:115], v[232:235], v[236:239], v[112:115]
  ds_read_b128 v[232:235], v3 offset:10000
  ds_read_b128 v[236:239], v4 offset:400
  v_mfma_f32_32x32x16_bf16 v[32:47], a[128:131], v[172:175], v[32:47]
  v_rcp_f32 v54, v54
  v_rcp_f32 v55, v55
  v_rcp_f32_e64 v56, v56
  v_mfma_f32_32x32x16_bf16 v[32:47], a[132:135], v[176:179], v[32:47]
  s_waitcnt lgkmcnt(12)
  v_rcp_f32 v57, v57
  v_rcp_f32 v58, v58
  v_rcp_f32 v59, v59
  v_mfma_f32_32x32x16_bf16 v[32:47], v[248:251], v[180:183], v[32:47]
  s_waitcnt lgkmcnt(0)
  v_rcp_f32 v60, v60
  v_rcp_f32 v61, v61
  v_rcp_f32 v62, v62
  v_rcp_f32_e64 v63, v63
  v_pk_mul_f32 v[16:17], v[16:17], v[48:49]
  v_pk_mul_f32 v[18:19], v[18:19], v[50:51]
  v_pk_mul_f32 v[20:21], v[20:21], v[52:53]
  v_pk_mul_f32 v[22:23], v[22:23], v[54:55]
  v_pk_mul_f32 v[24:25], v[24:25], v[56:57]
  v_pk_mul_f32 v[26:27], v[26:27], v[58:59]
  v_pk_mul_f32 v[28:29], v[28:29], v[60:61]
  v_pk_mul_f32 v[30:31], v[30:31], v[62:63]
  v_pk_add_f32 v[12:13], v[112:113], v[114:115]
  v_pk_mul_f32 v[14:15], v[112:113], v[112:113]
  v_pk_fma_f32 v[14:15], v[114:115], v[114:115], v[14:15]
  v_pk_fma_f32 v[48:49], v[32:33], v[32:33], s[20:21] neg_lo:[1,0,1] neg_hi:[1,0,1]
  v_pk_fma_f32 v[50:51], v[34:35], v[34:35], s[20:21] neg_lo:[1,0,1] neg_hi:[1,0,1]
  v_pk_fma_f32 v[52:53], v[36:37], v[36:37], s[20:21] neg_lo:[1,0,1] neg_hi:[1,0,1]
  v_pk_fma_f32 v[54:55], v[38:39], v[38:39], s[20:21] neg_lo:[1,0,1] neg_hi:[1,0,1]
  v_pk_fma_f32 v[56:57], v[40:41], v[40:41], s[20:21] neg_lo:[1,0,1] neg_hi:[1,0,1]
  v_pk_fma_f32 v[58:59], v[42:43], v[42:43], s[20:21] neg_lo:[1,0,1] neg_hi:[1,0,1]
  v_pk_fma_f32 v[60:61], v[44:45], v[44:45], s[20:21] neg_lo:[1,0,1] neg_hi:[1,0,1]
  v_pk_fma_f32 v[62:63], v[46:47], v[46:47], s[20:21] neg_lo:[1,0,1] neg_hi:[1,0,1]
  v_pk_mul_f32 v[48:49], v[32:33], v[48:49]
  v_pk_mul_f32 v[50:51], v[34:35], v[50:51]
  v_pk_mul_f32 v[52:53], v[36:37], v[52:53]
  v_pk_mul_f32 v[54:55], v[38:39], v[54:55]
  v_pk_mul_f32 v[56:57], v[40:41], v[56:57]
  v_cvt_pk_bf16_f32 v184, v16, v17
  v_cvt_pk_bf16_f32 v185, v18, v19
  v_cvt_pk_bf16_f32 v186, v20, v21
  v_cvt_pk_bf16_f32 v187, v22, v23
  v_pk_mul_f32 v[58:59], v[42:43], v[58:59]
  v_pk_mul_f32 v[60:61], v[44:45], v[60:61]
  v_pk_mul_f32 v[62:63], v[46:47], v[62:63]
  v_mfma_f32_32x32x16_bf16 v[64:79], v[192:195], v[184:187], v[64:79]
  v_cvt_pk_bf16_f32 v188, v24, v25
  v_cvt_pk_bf16_f32 v189, v26, v27
  v_cvt_pk_bf16_f32 v190, v28, v29
  v_cvt_pk_bf16_f32 v191, v30, v31
  v_exp_f32_e64 v48, v48
  v_mfma_f32_16x16x32_bf16 v[116:119], v[216:219], v[220:223], 0
  ds_read_b128 v[216:219], v3 offset:800
  ds_read_b128 v[220:223], v4 offset:32
  v_mfma_f32_32x32x16_bf16 v[80:95], v[196:199], v[184:187], v[80:95]
  ds_read_b128 v[16:19], v2 offset:768
  ds_read_b128 v[20:23], v2 offset:800
  v_exp_f32 v49, v49
  v_exp_f32 v50, v50
  v_mfma_f32_16x16x32_bf16 v[116:119], v[224:227], v[228:231], v[116:119]
  ds_read_b128 v[224:227], v3 offset:5600
  ds_read_b128 v[228:231], v4 offset:224
  v_mfma_f32_32x32x16_bf16 v[96:111], v[200:203], v[184:187], v[96:111]
  ds_read_b128 v[24:27], v2 offset:832
  ds_read_b128 v[28:31], v2 offset:864
  v_exp_f32 v51, v51
  v_exp_f32 v52, v52
  v_mfma_f32_16x16x32_bf16 v[116:119], v[232:235], v[236:239], v[116:119]
  ds_read_b128 v[232:235], v3 offset:10400
  ds_read_b128 v[236:239], v4 offset:416
  v_mfma_f32_32x32x16_bf16 v[64:79], v[204:207], v[188:191], v[64:79]
  v_exp_f32 v53, v53
  v_exp_f32 v54, v54
  v_exp_f32_e64 v55, v55
  v_mfma_f32_32x32x16_bf16 v[80:95], v[208:211], v[188:191], v[80:95]
  v_exp_f32 v56, v56
  v_exp_f32 v57, v57
  v_exp_f32_e64 v58, v58
  v_mfma_f32_32x32x16_bf16 v[96:111], v[212:215], v[188:191], v[96:111]
  s_waitcnt lgkmcnt(0)
  v_exp_f32 v59, v59
  v_exp_f32 v60, v60
  v_exp_f32 v61, v61
  v_exp_f32 v62, v62
  v_exp_f32 v63, v63
  v_pk_add_f32 v[12:13], v[12:13], v[116:117]
  v_pk_fma_f32 v[14:15], v[116:117], v[116:117], v[14:15]
  v_pk_add_f32 v[12:13], v[12:13], v[118:119]
  v_pk_fma_f32 v[14:15], v[118:119], v[118:119], v[14:15]
  v_pk_fma_f32 v[48:49], v[48:49], s[22:23], s[22:23]
  v_pk_fma_f32 v[50:51], v[50:51], s[22:23], s[22:23]
  v_pk_fma_f32 v[52:53], v[52:53], s[22:23], s[22:23]
  v_pk_fma_f32 v[54:55], v[54:55], s[22:23], s[22:23]
  v_pk_fma_f32 v[56:57], v[56:57], s[22:23], s[22:23]
  v_pk_fma_f32 v[58:59], v[58:59], s[22:23], s[22:23]
  v_pk_fma_f32 v[60:61], v[60:61], s[22:23], s[22:23]
  v_pk_fma_f32 v[62:63], v[62:63], s[22:23], s[22:23]
  v_mfma_f32_32x32x16_bf16 v[16:31], a[136:139], v[160:163], v[16:31]
  ds_read_b128 v[248:251], v0 offset:2048
  ds_read_b128 v[192:195], v1 offset:22528
  ds_read_b128 v[196:199], v1 offset:23552
  v_rcp_f32 v48, v48
  v_rcp_f32 v49, v49
  v_mfma_f32_16x16x32_bf16 v[120:123], v[216:219], v[220:223], 0
  ds_read_b128 v[216:219], v3 offset:1200
  ds_read_b128 v[220:223], v4 offset:48
  v_mfma_f32_32x32x16_bf16 v[16:31], a[140:143], v[164:167], v[16:31]
  ds_read_b128 v[200:203], v1 offset:24576
  ds_read_b128 v[204:207], v1 offset:25600
  v_rcp_f32 v50, v50
  v_rcp_f32 v51, v51
  v_mfma_f32_16x16x32_bf16 v[120:123], v[224:227], v[228:231], v[120:123]
  ds_read_b128 v[224:227], v3 offset:6000
  ds_read_b128 v[228:231], v4 offset:240
  v_mfma_f32_32x32x16_bf16 v[16:31], a[144:147], v[168:171], v[16:31]
  ds_read_b128 v[208:211], v1 offset:26624
  ds_read_b128 v[212:215], v1 offset:27648
  v_rcp_f32 v52, v52
  v_rcp_f32 v53, v53
  v_mfma_f32_16x16x32_bf16 v[120:123], v[232:235], v[236:239], v[120:123]
  ds_read_b128 v[232:235], v3 offset:10800
  ds_read_b128 v[236:239], v4 offset:432
  v_mfma_f32_32x32x16_bf16 v[16:31], a[148:151], v[172:175], v[16:31]
  v_rcp_f32 v54, v54
  v_rcp_f32 v55, v55
  v_rcp_f32_e64 v56, v56
  v_mfma_f32_32x32x16_bf16 v[16:31], a[152:155], v[176:179], v[16:31]
  s_waitcnt lgkmcnt(12)
  v_rcp_f32 v57, v57
  v_rcp_f32 v58, v58
  v_rcp_f32 v59, v59
  v_mfma_f32_32x32x16_bf16 v[16:31], v[248:251], v[180:183], v[16:31]
  s_waitcnt lgkmcnt(0)
  v_rcp_f32 v60, v60
  v_rcp_f32 v61, v61
  v_rcp_f32 v62, v62
  v_rcp_f32_e64 v63, v63
  v_pk_mul_f32 v[32:33], v[32:33], v[48:49]
  v_pk_mul_f32 v[34:35], v[34:35], v[50:51]
  v_pk_mul_f32 v[36:37], v[36:37], v[52:53]
  v_pk_mul_f32 v[38:39], v[38:39], v[54:55]
  v_pk_mul_f32 v[40:41], v[40:41], v[56:57]
  v_pk_mul_f32 v[42:43], v[42:43], v[58:59]
  v_pk_mul_f32 v[44:45], v[44:45], v[60:61]
  v_pk_mul_f32 v[46:47], v[46:47], v[62:63]
  v_pk_add_f32 v[12:13], v[12:13], v[120:121]
  v_pk_fma_f32 v[14:15], v[120:121], v[120:121], v[14:15]
  v_pk_add_f32 v[12:13], v[12:13], v[122:123]
  v_pk_fma_f32 v[14:15], v[122:123], v[122:123], v[14:15]
  v_pk_fma_f32 v[48:49], v[16:17], v[16:17], s[20:21] neg_lo:[1,0,1] neg_hi:[1,0,1]
  v_pk_fma_f32 v[50:51], v[18:19], v[18:19], s[20:21] neg_lo:[1,0,1] neg_hi:[1,0,1]
  v_pk_fma_f32 v[52:53], v[20:21], v[20:21], s[20:21] neg_lo:[1,0,1] neg_hi:[1,0,1]
  v_pk_fma_f32 v[54:55], v[22:23], v[22:23], s[20:21] neg_lo:[1,0,1] neg_hi:[1,0,1]
  v_pk_fma_f32 v[56:57], v[24:25], v[24:25], s[20:21] neg_lo:[1,0,1] neg_hi:[1,0,1]
  v_pk_fma_f32 v[58:59], v[26:27], v[26:27], s[20:21] neg_lo:[1,0,1] neg_hi:[1,0,1]
  v_pk_fma_f32 v[60:61], v[28:29], v[28:29], s[20:21] neg_lo:[1,0,1] neg_hi:[1,0,1]
  v_pk_fma_f32 v[62:63], v[30:31], v[30:31], s[20:21] neg_lo:[1,0,1] neg_hi:[1,0,1]
  v_pk_mul_f32 v[48:49], v[16:17], v[48:49]
  v_pk_mul_f32 v[50:51], v[18:19], v[50:51]
  v_pk_mul_f32 v[52:53], v[20:21], v[52:53]
  v_pk_mul_f32 v[54:55], v[22:23], v[54:55]
  v_pk_mul_f32 v[56:57], v[24:25], v[56:57]
  v_cvt_pk_bf16_f32 v184, v32, v33
  v_cvt_pk_bf16_f32 v185, v34, v35
  v_cvt_pk_bf16_f32 v186, v36, v37
  v_cvt_pk_bf16_f32 v187, v38, v39
  v_pk_mul_f32 v[58:59], v[26:27], v[58:59]
  v_pk_mul_f32 v[60:61], v[28:29], v[60:61]
  v_pk_mul_f32 v[62:63], v[30:31], v[62:63]
  v_mfma_f32_32x32x16_bf16 v[64:79], v[192:195], v[184:187], v[64:79]
  s_add_u32 s29, s29, 0x60000
  v_cvt_pk_bf16_f32 v188, v40, v41
  v_cvt_pk_bf16_f32 v189, v42, v43
  v_cvt_pk_bf16_f32 v190, v44, v45
  v_cvt_pk_bf16_f32 v191, v46, v47
  v_exp_f32_e64 v48, v48
  v_mfma_f32_16x16x32_bf16 v[124:127], v[216:219], v[220:223], 0
  ds_read_b128 v[216:219], v3 offset:1600
  ds_read_b128 v[220:223], v4 offset:64
  v_mfma_f32_32x32x16_bf16 v[80:95], v[196:199], v[184:187], v[80:95]
  s_add_u32 s52, s52, 0x60000
  ds_read_b128 v[32:35], v2 offset:896
  ds_read_b128 v[36:39], v2 offset:928
  v_exp_f32 v49, v49
  v_exp_f32 v50, v50
  v_mfma_f32_16x16x32_bf16 v[124:127], v[224:227], v[228:231], v[124:127]
  ds_read_b128 v[224:227], v3 offset:6400
  ds_read_b128 v[228:231], v4 offset:256
  v_mfma_f32_32x32x16_bf16 v[96:111], v[200:203], v[184:187], v[96:111]
  s_mov_b32 s32, s30
  ds_read_b128 v[40:43], v2 offset:960
  ds_read_b128 v[44:47], v2 offset:992
  v_exp_f32 v51, v51
  v_exp_f32_e64 v52, v52
  v_mfma_f32_16x16x32_bf16 v[124:127], v[232:235], v[236:239], v[124:127]
  ds_read_b128 v[232:235], v3 offset:11200
  ds_read_b128 v[236:239], v4 offset:448
  v_mfma_f32_32x32x16_bf16 v[64:79], v[204:207], v[188:191], v[64:79]
  s_add_u32 s30, s33, 32
  v_exp_f32 v53, v53
  v_exp_f32 v54, v54
  v_exp_f32 v55, v55
  v_mfma_f32_32x32x16_bf16 v[80:95], v[208:211], v[188:191], v[80:95]
  s_sub_u32 s33, s31, 0
  v_exp_f32 v56, v56
  v_exp_f32 v57, v57
  v_exp_f32 v58, v58
  v_mfma_f32_32x32x16_bf16 v[96:111], v[212:215], v[188:191], v[96:111]
  s_waitcnt lgkmcnt(0)
  s_sub_u32 s31, s32, 32
  v_exp_f32 v59, v59
  v_exp_f32 v60, v60
  v_exp_f32 v61, v61
  v_exp_f32 v62, v62
  v_exp_f32_e64 v63, v63
  v_pk_add_f32 v[12:13], v[12:13], v[124:125]
  v_pk_fma_f32 v[14:15], v[124:125], v[124:125], v[14:15]
  v_pk_add_f32 v[12:13], v[12:13], v[126:127]
  v_pk_fma_f32 v[14:15], v[126:127], v[126:127], v[14:15]
  v_pk_fma_f32 v[48:49], v[48:49], s[22:23], s[22:23]
  v_pk_fma_f32 v[50:51], v[50:51], s[22:23], s[22:23]
  v_pk_fma_f32 v[52:53], v[52:53], s[22:23], s[22:23]
  v_pk_fma_f32 v[54:55], v[54:55], s[22:23], s[22:23]
  v_pk_fma_f32 v[56:57], v[56:57], s[22:23], s[22:23]
  v_pk_fma_f32 v[58:59], v[58:59], s[22:23], s[22:23]
  v_pk_fma_f32 v[60:61], v[60:61], s[22:23], s[22:23]
  v_pk_fma_f32 v[62:63], v[62:63], s[22:23], s[22:23]
  v_mfma_f32_32x32x16_bf16 v[32:47], a[156:159], v[160:163], v[32:47]
  ds_read_b128 v[248:251], v0 offset:3072
  ds_read_b128 v[192:195], v1 offset:28672
  ds_read_b128 v[196:199], v1 offset:29696
  v_rcp_f32 v48, v48
  v_rcp_f32 v49, v49
  v_mfma_f32_16x16x32_bf16 v[128:131], v[216:219], v[220:223], 0
  ds_read_b128 v[216:219], v3 offset:2000
  ds_read_b128 v[220:223], v4 offset:80
  v_mfma_f32_32x32x16_bf16 v[32:47], a[160:163], v[164:167], v[32:47]
  ds_read_b128 v[200:203], v1 offset:30720
  ds_read_b128 v[204:207], v1 offset:31744
  v_rcp_f32 v50, v50
  v_rcp_f32 v51, v51
  v_mfma_f32_16x16x32_bf16 v[128:131], v[224:227], v[228:231], v[128:131]
  ds_read_b128 v[224:227], v3 offset:6800
  ds_read_b128 v[228:231], v4 offset:272
  v_mfma_f32_32x32x16_bf16 v[32:47], a[164:167], v[168:171], v[32:47]
  ds_read_b128 v[208:211], v1 offset:32768
  ds_read_b128 v[212:215], v1 offset:33792
  v_rcp_f32 v52, v52
  v_rcp_f32 v53, v53
  v_mfma_f32_16x16x32_bf16 v[128:131], v[232:235], v[236:239], v[128:131]
  ds_read_b128 v[232:235], v3 offset:11600
  ds_read_b128 v[236:239], v4 offset:464
  v_mfma_f32_32x32x16_bf16 v[32:47], a[168:171], v[172:175], v[32:47]
  v_rcp_f32 v54, v54
  v_rcp_f32 v55, v55
  v_rcp_f32_e64 v56, v56
  v_mfma_f32_32x32x16_bf16 v[32:47], a[172:175], v[176:179], v[32:47]
  s_waitcnt lgkmcnt(12)
  v_rcp_f32 v57, v57
  v_rcp_f32 v58, v58
  v_rcp_f32 v59, v59
  v_mfma_f32_32x32x16_bf16 v[32:47], v[248:251], v[180:183], v[32:47]
  s_waitcnt lgkmcnt(0)
  v_rcp_f32 v60, v60
  v_rcp_f32 v61, v61
  v_rcp_f32 v62, v62
  v_rcp_f32_e64 v63, v63
  v_pk_mul_f32 v[16:17], v[16:17], v[48:49]
  v_pk_mul_f32 v[18:19], v[18:19], v[50:51]
  v_pk_mul_f32 v[20:21], v[20:21], v[52:53]
  v_pk_mul_f32 v[22:23], v[22:23], v[54:55]
  v_pk_mul_f32 v[24:25], v[24:25], v[56:57]
  v_pk_mul_f32 v[26:27], v[26:27], v[58:59]
  v_pk_mul_f32 v[28:29], v[28:29], v[60:61]
  v_pk_mul_f32 v[30:31], v[30:31], v[62:63]
  v_pk_add_f32 v[12:13], v[12:13], v[128:129]
  v_pk_fma_f32 v[14:15], v[128:129], v[128:129], v[14:15]
  v_pk_add_f32 v[12:13], v[12:13], v[130:131]
  v_pk_fma_f32 v[14:15], v[130:131], v[130:131], v[14:15]
  v_pk_fma_f32 v[48:49], v[32:33], v[32:33], s[20:21] neg_lo:[1,0,1] neg_hi:[1,0,1]
  v_pk_fma_f32 v[50:51], v[34:35], v[34:35], s[20:21] neg_lo:[1,0,1] neg_hi:[1,0,1]
  v_pk_fma_f32 v[52:53], v[36:37], v[36:37], s[20:21] neg_lo:[1,0,1] neg_hi:[1,0,1]
  v_pk_fma_f32 v[54:55], v[38:39], v[38:39], s[20:21] neg_lo:[1,0,1] neg_hi:[1,0,1]
  v_pk_fma_f32 v[56:57], v[40:41], v[40:41], s[20:21] neg_lo:[1,0,1] neg_hi:[1,0,1]
  v_pk_fma_f32 v[58:59], v[42:43], v[42:43], s[20:21] neg_lo:[1,0,1] neg_hi:[1,0,1]
  v_pk_fma_f32 v[60:61], v[44:45], v[44:45], s[20:21] neg_lo:[1,0,1] neg_hi:[1,0,1]
  v_pk_fma_f32 v[62:63], v[46:47], v[46:47], s[20:21] neg_lo:[1,0,1] neg_hi:[1,0,1]
  v_pk_mul_f32 v[48:49], v[32:33], v[48:49]
  v_pk_mul_f32 v[50:51], v[34:35], v[50:51]
  v_pk_mul_f32 v[52:53], v[36:37], v[52:53]
  v_pk_mul_f32 v[54:55], v[38:39], v[54:55]
  v_pk_mul_f32 v[56:57], v[40:41], v[56:57]
  v_cvt_pk_bf16_f32 v184, v16, v17
  v_cvt_pk_bf16_f32 v185, v18, v19
  v_cvt_pk_bf16_f32 v186, v20, v21
  v_cvt_pk_bf16_f32 v187, v22, v23
  v_pk_mul_f32 v[58:59], v[42:43], v[58:59]
  v_pk_mul_f32 v[60:61], v[44:45], v[60:61]
  v_pk_mul_f32 v[62:63], v[46:47], v[62:63]
  v_mfma_f32_32x32x16_bf16 v[64:79], v[192:195], v[184:187], v[64:79]
  s_mov_b32 s28, s34
  v_cvt_pk_bf16_f32 v188, v24, v25
  v_cvt_pk_bf16_f32 v189, v26, v27
  v_cvt_pk_bf16_f32 v190, v28, v29
  v_cvt_pk_bf16_f32 v191, v30, v31
  v_exp_f32 v48, v48
  v_mfma_f32_16x16x32_bf16 v[132:135], v[216:219], v[220:223], 0
  ds_read_b128 v[216:219], v3 offset:2400
  ds_read_b128 v[220:223], v4 offset:96
  v_mfma_f32_32x32x16_bf16 v[80:95], v[196:199], v[184:187], v[80:95]
  s_add_u32 s34, s34, 0x60000
  ds_read_b128 v[16:19], v2 offset:1024
  ds_read_b128 v[20:23], v2 offset:1056
  v_exp_f32 v49, v49
  v_exp_f32 v50, v50
  v_mfma_f32_16x16x32_bf16 v[132:135], v[224:227], v[228:231], v[132:135]
  ds_read_b128 v[224:227], v3 offset:7200
  ds_read_b128 v[228:231], v4 offset:288
  v_mfma_f32_32x32x16_bf16 v[96:111], v[200:203], v[184:187], v[96:111]
  ds_read_b128 v[24:27], v2 offset:1088
  ds_read_b128 v[28:31], v2 offset:1120
  v_exp_f32 v51, v51
  v_exp_f32 v52, v52
  v_mfma_f32_16x16x32_bf16 v[132:135], v[232:235], v[236:239], v[132:135]
  ds_read_b128 v[232:235], v3 offset:12000
  ds_read_b128 v[236:239], v4 offset:480
  v_mfma_f32_32x32x16_bf16 v[64:79], v[204:207], v[188:191], v[64:79]
  v_exp_f32 v53, v53
  v_exp_f32 v54, v54
  v_exp_f32_e64 v55, v55
  v_mfma_f32_32x32x16_bf16 v[80:95], v[208:211], v[188:191], v[80:95]
  v_exp_f32 v56, v56
  v_exp_f32 v57, v57
  v_exp_f32_e64 v58, v58
  v_mfma_f32_32x32x16_bf16 v[96:111], v[212:215], v[188:191], v[96:111]
  s_waitcnt lgkmcnt(0)
  v_exp_f32 v59, v59
  v_exp_f32 v60, v60
  v_exp_f32 v61, v61
  v_exp_f32 v62, v62
  v_exp_f32 v63, v63
  v_pk_add_f32 v[12:13], v[12:13], v[132:133]
  v_pk_fma_f32 v[14:15], v[132:133], v[132:133], v[14:15]
  v_pk_add_f32 v[12:13], v[12:13], v[134:135]
  v_pk_fma_f32 v[14:15], v[134:135], v[134:135], v[14:15]
  v_pk_fma_f32 v[48:49], v[48:49], s[22:23], s[22:23]
  v_pk_fma_f32 v[50:51], v[50:51], s[22:23], s[22:23]
  v_pk_fma_f32 v[52:53], v[52:53], s[22:23], s[22:23]
  v_pk_fma_f32 v[54:55], v[54:55], s[22:23], s[22:23]
  v_pk_fma_f32 v[56:57], v[56:57], s[22:23], s[22:23]
  v_pk_fma_f32 v[58:59], v[58:59], s[22:23], s[22:23]
  v_pk_fma_f32 v[60:61], v[60:61], s[22:23], s[22:23]
  v_pk_fma_f32 v[62:63], v[62:63], s[22:23], s[22:23]
  v_mfma_f32_32x32x16_bf16 v[16:31], a[176:179], v[160:163], v[16:31]
  ds_read_b128 v[248:251], v0 offset:4096
  ds_read_b128 v[192:195], v1 offset:34816
  ds_read_b128 v[196:199], v1 offset:35840
  v_rcp_f32 v48, v48
  v_rcp_f32 v49, v49
  v_mfma_f32_16x16x32_bf16 v[136:139], v[216:219], v[220:223], 0
  ds_read_b128 v[216:219], v3 offset:2800
  ds_read_b128 v[220:223], v4 offset:112
  v_mfma_f32_32x32x16_bf16 v[16:31], a[180:183], v[164:167], v[16:31]
  ds_read_b128 v[200:203], v1 offset:36864
  ds_read_b128 v[204:207], v1 offset:37888
  v_rcp_f32 v50, v50
  v_rcp_f32 v51, v51
  v_mfma_f32_16x16x32_bf16 v[136:139], v[224:227], v[228:231], v[136:139]
  ds_read_b128 v[224:227], v3 offset:7600
  ds_read_b128 v[228:231], v4 offset:304
  v_mfma_f32_32x32x16_bf16 v[16:31], a[184:187], v[168:171], v[16:31]
  ds_read_b128 v[208:211], v1 offset:38912
  ds_read_b128 v[212:215], v1 offset:39936
  v_rcp_f32 v52, v52
  v_rcp_f32 v53, v53
  v_mfma_f32_16x16x32_bf16 v[136:139], v[232:235], v[236:239], v[136:139]
  ds_read_b128 v[232:235], v3 offset:12400
  ds_read_b128 v[236:239], v4 offset:496
  v_mfma_f32_32x32x16_bf16 v[16:31], a[188:191], v[172:175], v[16:31]
  v_rcp_f32 v54, v54
  v_rcp_f32 v55, v55
  v_rcp_f32_e64 v56, v56
  v_mfma_f32_32x32x16_bf16 v[16:31], a[192:195], v[176:179], v[16:31]
  s_waitcnt lgkmcnt(12)
  v_rcp_f32 v57, v57
  v_rcp_f32 v58, v58
  v_rcp_f32 v59, v59
  v_mfma_f32_32x32x16_bf16 v[16:31], v[248:251], v[180:183], v[16:31]
  s_waitcnt lgkmcnt(0)
  v_rcp_f32 v60, v60
  v_rcp_f32 v61, v61
  v_rcp_f32 v62, v62
  v_rcp_f32_e64 v63, v63
  v_pk_mul_f32 v[32:33], v[32:33], v[48:49]
  v_pk_mul_f32 v[34:35], v[34:35], v[50:51]
  v_pk_mul_f32 v[36:37], v[36:37], v[52:53]
  v_pk_mul_f32 v[38:39], v[38:39], v[54:55]
  v_pk_mul_f32 v[40:41], v[40:41], v[56:57]
  v_pk_mul_f32 v[42:43], v[42:43], v[58:59]
  v_pk_mul_f32 v[44:45], v[44:45], v[60:61]
  v_pk_mul_f32 v[46:47], v[46:47], v[62:63]
  v_pk_add_f32 v[12:13], v[12:13], v[136:137]
  v_pk_fma_f32 v[14:15], v[136:137], v[136:137], v[14:15]
  v_pk_add_f32 v[12:13], v[12:13], v[138:139]
  v_pk_fma_f32 v[14:15], v[138:139], v[138:139], v[14:15]
  v_pk_fma_f32 v[48:49], v[16:17], v[16:17], s[20:21] neg_lo:[1,0,1] neg_hi:[1,0,1]
  v_pk_fma_f32 v[50:51], v[18:19], v[18:19], s[20:21] neg_lo:[1,0,1] neg_hi:[1,0,1]
  v_pk_fma_f32 v[52:53], v[20:21], v[20:21], s[20:21] neg_lo:[1,0,1] neg_hi:[1,0,1]
  v_pk_fma_f32 v[54:55], v[22:23], v[22:23], s[20:21] neg_lo:[1,0,1] neg_hi:[1,0,1]
  v_pk_fma_f32 v[56:57], v[24:25], v[24:25], s[20:21] neg_lo:[1,0,1] neg_hi:[1,0,1]
  v_pk_fma_f32 v[58:59], v[26:27], v[26:27], s[20:21] neg_lo:[1,0,1] neg_hi:[1,0,1]
  v_pk_fma_f32 v[60:61], v[28:29], v[28:29], s[20:21] neg_lo:[1,0,1] neg_hi:[1,0,1]
  v_pk_fma_f32 v[62:63], v[30:31], v[30:31], s[20:21] neg_lo:[1,0,1] neg_hi:[1,0,1]
  v_pk_mul_f32 v[48:49], v[16:17], v[48:49]
  v_pk_mul_f32 v[50:51], v[18:19], v[50:51]
  v_pk_mul_f32 v[52:53], v[20:21], v[52:53]
  v_pk_mul_f32 v[54:55], v[22:23], v[54:55]
  v_pk_mul_f32 v[56:57], v[24:25], v[56:57]
  v_cvt_pk_bf16_f32 v184, v32, v33
  v_cvt_pk_bf16_f32 v185, v34, v35
  v_cvt_pk_bf16_f32 v186, v36, v37
  v_cvt_pk_bf16_f32 v187, v38, v39
  v_pk_mul_f32 v[58:59], v[26:27], v[58:59]
  v_pk_mul_f32 v[60:61], v[28:29], v[60:61]
  v_pk_mul_f32 v[62:63], v[30:31], v[62:63]
  v_mfma_f32_32x32x16_bf16 v[64:79], v[192:195], v[184:187], v[64:79]
  v_cvt_pk_bf16_f32 v188, v40, v41
  v_cvt_pk_bf16_f32 v189, v42, v43
  v_cvt_pk_bf16_f32 v190, v44, v45
  v_cvt_pk_bf16_f32 v191, v46, v47
  v_exp_f32_e64 v48, v48
  v_mfma_f32_16x16x32_bf16 v[140:143], v[216:219], v[220:223], 0
  ds_read_b128 v[216:219], v3 offset:3200
  ds_read_b128 v[220:223], v4 offset:128
  v_mfma_f32_32x32x16_bf16 v[80:95], v[196:199], v[184:187], v[80:95]
  ds_read_b128 v[32:35], v2 offset:1152
  ds_read_b128 v[36:39], v2 offset:1184
  v_exp_f32 v49, v49
  v_exp_f32 v50, v50
  v_mfma_f32_16x16x32_bf16 v[140:143], v[224:227], v[228:231], v[140:143]
  ds_read_b128 v[224:227], v3 offset:8000
  ds_read_b128 v[228:231], v4 offset:320
  v_mfma_f32_32x32x16_bf16 v[96:111], v[200:203], v[184:187], v[96:111]
  ds_read_b128 v[40:43], v2 offset:1216
  ds_read_b128 v[44:47], v2 offset:1248
  v_exp_f32 v51, v51
  v_exp_f32 v52, v52
  v_mfma_f32_16x16x32_bf16 v[140:143], v[232:235], v[236:239], v[140:143]
  ds_read_b128 v[232:235], v3 offset:12800
  ds_read_b128 v[236:239], v4 offset:512
  v_mfma_f32_32x32x16_bf16 v[64:79], v[204:207], v[188:191], v[64:79]
  v_exp_f32 v53, v53
  v_exp_f32 v54, v54
  v_exp_f32_e64 v55, v55
  v_mfma_f32_32x32x16_bf16 v[80:95], v[208:211], v[188:191], v[80:95]
  v_exp_f32 v56, v56
  v_exp_f32 v57, v57
  v_exp_f32_e64 v58, v58
  v_mfma_f32_32x32x16_bf16 v[96:111], v[212:215], v[188:191], v[96:111]
  s_waitcnt lgkmcnt(0)
  v_exp_f32 v59, v59
  v_exp_f32 v60, v60
  v_exp_f32 v61, v61
  v_exp_f32 v62, v62
  v_exp_f32 v63, v63
  v_pk_add_f32 v[12:13], v[12:13], v[140:141]
  v_pk_fma_f32 v[14:15], v[140:141], v[140:141], v[14:15]
  v_pk_add_f32 v[12:13], v[12:13], v[142:143]
  v_pk_fma_f32 v[14:15], v[142:143], v[142:143], v[14:15]
  v_pk_fma_f32 v[48:49], v[48:49], s[22:23], s[22:23]
  v_pk_fma_f32 v[50:51], v[50:51], s[22:23], s[22:23]
  v_pk_fma_f32 v[52:53], v[52:53], s[22:23], s[22:23]
  v_pk_fma_f32 v[54:55], v[54:55], s[22:23], s[22:23]
  v_pk_fma_f32 v[56:57], v[56:57], s[22:23], s[22:23]
  v_pk_fma_f32 v[58:59], v[58:59], s[22:23], s[22:23]
  v_pk_fma_f32 v[60:61], v[60:61], s[22:23], s[22:23]
  v_pk_fma_f32 v[62:63], v[62:63], s[22:23], s[22:23]
  v_mfma_f32_32x32x16_bf16 v[32:47], a[196:199], v[160:163], v[32:47]
  ds_read_b128 v[248:251], v0 offset:5120
  ds_read_b128 v[192:195], v1 offset:40960
  ds_read_b128 v[196:199], v1 offset:41984
  v_rcp_f32 v48, v48
  v_rcp_f32 v49, v49
  v_mfma_f32_16x16x32_bf16 v[144:147], v[216:219], v[220:223], 0
  ds_read_b128 v[216:219], v3 offset:3600
  ds_read_b128 v[220:223], v4 offset:144
  v_mfma_f32_32x32x16_bf16 v[32:47], a[200:203], v[164:167], v[32:47]
  ds_read_b128 v[200:203], v1 offset:43008
  ds_read_b128 v[204:207], v1 offset:44032
  v_rcp_f32 v50, v50
  v_rcp_f32 v51, v51
  v_mfma_f32_16x16x32_bf16 v[144:147], v[224:227], v[228:231], v[144:147]
  ds_read_b128 v[224:227], v3 offset:8400
  ds_read_b128 v[228:231], v4 offset:336
  v_mfma_f32_32x32x16_bf16 v[32:47], a[204:207], v[168:171], v[32:47]
  ds_read_b128 v[208:211], v1 offset:45056
  ds_read_b128 v[212:215], v1 offset:46080
  v_rcp_f32 v52, v52
  v_rcp_f32 v53, v53
  v_mfma_f32_16x16x32_bf16 v[144:147], v[232:235], v[236:239], v[144:147]
  ds_read_b128 v[232:235], v3 offset:13200
  ds_read_b128 v[236:239], v4 offset:528
  v_mfma_f32_32x32x16_bf16 v[32:47], a[208:211], v[172:175], v[32:47]
  v_rcp_f32 v54, v54
  v_rcp_f32 v55, v55
  v_rcp_f32_e64 v56, v56
  v_mfma_f32_32x32x16_bf16 v[32:47], a[212:215], v[176:179], v[32:47]
  s_waitcnt lgkmcnt(12)
  v_rcp_f32 v57, v57
  v_rcp_f32 v58, v58
  v_rcp_f32 v59, v59
  v_mfma_f32_32x32x16_bf16 v[32:47], v[248:251], v[180:183], v[32:47]
  s_waitcnt lgkmcnt(0)
  v_rcp_f32 v60, v60
  v_rcp_f32 v61, v61
  v_rcp_f32 v62, v62
  v_rcp_f32_e64 v63, v63
  v_pk_mul_f32 v[16:17], v[16:17], v[48:49]
  v_pk_mul_f32 v[18:19], v[18:19], v[50:51]
  v_pk_mul_f32 v[20:21], v[20:21], v[52:53]
  v_pk_mul_f32 v[22:23], v[22:23], v[54:55]
  v_pk_mul_f32 v[24:25], v[24:25], v[56:57]
  v_pk_mul_f32 v[26:27], v[26:27], v[58:59]
  v_pk_mul_f32 v[28:29], v[28:29], v[60:61]
  v_pk_mul_f32 v[30:31], v[30:31], v[62:63]
  v_pk_add_f32 v[12:13], v[12:13], v[144:145]
  v_pk_fma_f32 v[14:15], v[144:145], v[144:145], v[14:15]
  v_pk_add_f32 v[12:13], v[12:13], v[146:147]
  v_pk_fma_f32 v[14:15], v[146:147], v[146:147], v[14:15]
  v_pk_fma_f32 v[48:49], v[32:33], v[32:33], s[20:21] neg_lo:[1,0,1] neg_hi:[1,0,1]
  v_pk_fma_f32 v[50:51], v[34:35], v[34:35], s[20:21] neg_lo:[1,0,1] neg_hi:[1,0,1]
  v_pk_fma_f32 v[52:53], v[36:37], v[36:37], s[20:21] neg_lo:[1,0,1] neg_hi:[1,0,1]
  v_pk_fma_f32 v[54:55], v[38:39], v[38:39], s[20:21] neg_lo:[1,0,1] neg_hi:[1,0,1]
  v_pk_fma_f32 v[56:57], v[40:41], v[40:41], s[20:21] neg_lo:[1,0,1] neg_hi:[1,0,1]
  v_pk_fma_f32 v[58:59], v[42:43], v[42:43], s[20:21] neg_lo:[1,0,1] neg_hi:[1,0,1]
  v_pk_fma_f32 v[60:61], v[44:45], v[44:45], s[20:21] neg_lo:[1,0,1] neg_hi:[1,0,1]
  v_pk_fma_f32 v[62:63], v[46:47], v[46:47], s[20:21] neg_lo:[1,0,1] neg_hi:[1,0,1]
  v_pk_mul_f32 v[48:49], v[32:33], v[48:49]
  v_pk_mul_f32 v[50:51], v[34:35], v[50:51]
  v_pk_mul_f32 v[52:53], v[36:37], v[52:53]
  v_pk_mul_f32 v[54:55], v[38:39], v[54:55]
  v_pk_mul_f32 v[56:57], v[40:41], v[56:57]
  v_cvt_pk_bf16_f32 v184, v16, v17
  v_cvt_pk_bf16_f32 v185, v18, v19
  v_cvt_pk_bf16_f32 v186, v20, v21
  v_cvt_pk_bf16_f32 v187, v22, v23
  v_pk_mul_f32 v[58:59], v[42:43], v[58:59]
  v_pk_mul_f32 v[60:61], v[44:45], v[60:61]
  v_pk_mul_f32 v[62:63], v[46:47], v[62:63]
  v_mfma_f32_32x32x16_bf16 v[64:79], v[192:195], v[184:187], v[64:79]
  v_cvt_pk_bf16_f32 v188, v24, v25
  v_cvt_pk_bf16_f32 v189, v26, v27
  v_cvt_pk_bf16_f32 v190, v28, v29
  v_cvt_pk_bf16_f32 v191, v30, v31
  v_exp_f32_e64 v48, v48
  v_mfma_f32_16x16x32_bf16 v[148:151], v[216:219], v[220:223], 0
  ds_read_b128 v[216:219], v3 offset:4000
  ds_read_b128 v[220:223], v4 offset:160
  v_mfma_f32_32x32x16_bf16 v[80:95], v[196:199], v[184:187], v[80:95]
  ds_read_b128 v[16:19], v2 offset:1280
  ds_read_b128 v[20:23], v2 offset:1312
  v_exp_f32 v49, v49
  v_exp_f32 v50, v50
  v_mfma_f32_16x16x32_bf16 v[148:151], v[224:227], v[228:231], v[148:151]
  ds_read_b128 v[224:227], v3 offset:8800
  ds_read_b128 v[228:231], v4 offset:352
  v_mfma_f32_32x32x16_bf16 v[96:111], v[200:203], v[184:187], v[96:111]
  ds_read_b128 v[24:27], v2 offset:1344
  ds_read_b128 v[28:31], v2 offset:1376
  v_exp_f32 v51, v51
  v_exp_f32 v52, v52
  v_mfma_f32_16x16x32_bf16 v[148:151], v[232:235], v[236:239], v[148:151]
  ds_read_b128 v[232:235], v3 offset:13600
  ds_read_b128 v[236:239], v4 offset:544
  v_mfma_f32_32x32x16_bf16 v[64:79], v[204:207], v[188:191], v[64:79]
  v_exp_f32 v53, v53
  v_exp_f32 v54, v54
  v_exp_f32_e64 v55, v55
  v_mfma_f32_32x32x16_bf16 v[80:95], v[208:211], v[188:191], v[80:95]
  v_exp_f32 v56, v56
  v_exp_f32 v57, v57
  v_exp_f32_e64 v58, v58
  v_mfma_f32_32x32x16_bf16 v[96:111], v[212:215], v[188:191], v[96:111]
  s_waitcnt lgkmcnt(0)
  v_exp_f32 v59, v59
  v_exp_f32 v60, v60
  v_exp_f32 v61, v61
  v_exp_f32 v62, v62
  v_exp_f32 v63, v63
  v_pk_add_f32 v[12:13], v[12:13], v[148:149]
  v_pk_fma_f32 v[14:15], v[148:149], v[148:149], v[14:15]
  v_pk_add_f32 v[12:13], v[12:13], v[150:151]
  v_pk_fma_f32 v[14:15], v[150:151], v[150:151], v[14:15]
  v_pk_fma_f32 v[48:49], v[48:49], s[22:23], s[22:23]
  v_pk_fma_f32 v[50:51], v[50:51], s[22:23], s[22:23]
  v_pk_fma_f32 v[52:53], v[52:53], s[22:23], s[22:23]
  v_pk_fma_f32 v[54:55], v[54:55], s[22:23], s[22:23]
  v_pk_fma_f32 v[56:57], v[56:57], s[22:23], s[22:23]
  v_pk_fma_f32 v[58:59], v[58:59], s[22:23], s[22:23]
  v_pk_fma_f32 v[60:61], v[60:61], s[22:23], s[22:23]
  v_pk_fma_f32 v[62:63], v[62:63], s[22:23], s[22:23]
  v_mfma_f32_32x32x16_bf16 v[16:31], a[216:219], v[160:163], v[16:31]
  ds_read_b128 v[248:251], v0 offset:6144
  ds_read_b128 v[192:195], v1 offset:47104
  ds_read_b128 v[196:199], v1 offset:48128
  v_rcp_f32 v48, v48
  v_rcp_f32 v49, v49
  v_mfma_f32_16x16x32_bf16 v[152:155], v[216:219], v[220:223], 0
  ds_read_b128 v[216:219], v3 offset:4400
  ds_read_b128 v[220:223], v4 offset:176
  v_mfma_f32_32x32x16_bf16 v[16:31], a[220:223], v[164:167], v[16:31]
  ds_read_b128 v[200:203], v1 offset:49152
  ds_read_b128 v[204:207], v1 offset:50176
  v_rcp_f32 v50, v50
  v_rcp_f32 v51, v51
  v_mfma_f32_16x16x32_bf16 v[152:155], v[224:227], v[228:231], v[152:155]
  ds_read_b128 v[224:227], v3 offset:9200
  ds_read_b128 v[228:231], v4 offset:368
  v_mfma_f32_32x32x16_bf16 v[16:31], a[224:227], v[168:171], v[16:31]
  ds_read_b128 v[208:211], v1 offset:51200
  ds_read_b128 v[212:215], v1 offset:52224
  v_rcp_f32 v52, v52
  v_rcp_f32 v53, v53
  v_mfma_f32_16x16x32_bf16 v[152:155], v[232:235], v[236:239], v[152:155]
  ds_read_b128 v[232:235], v3 offset:14000
  ds_read_b128 v[236:239], v4 offset:560
  v_mfma_f32_32x32x16_bf16 v[16:31], a[228:231], v[172:175], v[16:31]
  v_rcp_f32 v54, v54
  v_rcp_f32 v55, v55
  v_rcp_f32_e64 v56, v56
  v_mfma_f32_32x32x16_bf16 v[16:31], a[232:235], v[176:179], v[16:31]
  s_waitcnt lgkmcnt(12)
  v_rcp_f32 v57, v57
  v_rcp_f32 v58, v58
  v_rcp_f32 v59, v59
  v_mfma_f32_32x32x16_bf16 v[16:31], v[248:251], v[180:183], v[16:31]
  s_waitcnt lgkmcnt(0)
  v_rcp_f32 v60, v60
  v_rcp_f32 v61, v61
  v_rcp_f32 v62, v62
  v_rcp_f32_e64 v63, v63
  v_pk_mul_f32 v[32:33], v[32:33], v[48:49]
  v_pk_mul_f32 v[34:35], v[34:35], v[50:51]
  v_pk_mul_f32 v[36:37], v[36:37], v[52:53]
  v_pk_mul_f32 v[38:39], v[38:39], v[54:55]
  v_pk_mul_f32 v[40:41], v[40:41], v[56:57]
  v_pk_mul_f32 v[42:43], v[42:43], v[58:59]
  v_pk_mul_f32 v[44:45], v[44:45], v[60:61]
  v_pk_mul_f32 v[46:47], v[46:47], v[62:63]
  v_pk_add_f32 v[12:13], v[12:13], v[152:153]
  v_pk_fma_f32 v[14:15], v[152:153], v[152:153], v[14:15]
  v_pk_add_f32 v[12:13], v[12:13], v[154:155]
  v_pk_fma_f32 v[14:15], v[154:155], v[154:155], v[14:15]
  v_pk_fma_f32 v[48:49], v[16:17], v[16:17], s[20:21] neg_lo:[1,0,1] neg_hi:[1,0,1]
  v_pk_fma_f32 v[50:51], v[18:19], v[18:19], s[20:21] neg_lo:[1,0,1] neg_hi:[1,0,1]
  v_pk_fma_f32 v[52:53], v[20:21], v[20:21], s[20:21] neg_lo:[1,0,1] neg_hi:[1,0,1]
  v_pk_fma_f32 v[54:55], v[22:23], v[22:23], s[20:21] neg_lo:[1,0,1] neg_hi:[1,0,1]
  v_pk_fma_f32 v[56:57], v[24:25], v[24:25], s[20:21] neg_lo:[1,0,1] neg_hi:[1,0,1]
  v_pk_fma_f32 v[58:59], v[26:27], v[26:27], s[20:21] neg_lo:[1,0,1] neg_hi:[1,0,1]
  v_pk_fma_f32 v[60:61], v[28:29], v[28:29], s[20:21] neg_lo:[1,0,1] neg_hi:[1,0,1]
  v_pk_fma_f32 v[62:63], v[30:31], v[30:31], s[20:21] neg_lo:[1,0,1] neg_hi:[1,0,1]
  v_pk_mul_f32 v[48:49], v[16:17], v[48:49]
  v_pk_mul_f32 v[50:51], v[18:19], v[50:51]
  v_pk_mul_f32 v[52:53], v[20:21], v[52:53]
  v_pk_mul_f32 v[54:55], v[22:23], v[54:55]
  v_pk_mul_f32 v[56:57], v[24:25], v[56:57]
  v_cvt_pk_bf16_f32 v184, v32, v33
  v_cvt_pk_bf16_f32 v185, v34, v35
  v_cvt_pk_bf16_f32 v186, v36, v37
  v_cvt_pk_bf16_f32 v187, v38, v39
  v_pk_mul_f32 v[58:59], v[26:27], v[58:59]
  v_pk_mul_f32 v[60:61], v[28:29], v[60:61]
  v_pk_mul_f32 v[62:63], v[30:31], v[62:63]
  v_mfma_f32_32x32x16_bf16 v[64:79], v[192:195], v[184:187], v[64:79]
  v_cvt_pk_bf16_f32 v188, v40, v41
  v_cvt_pk_bf16_f32 v189, v42, v43
  v_cvt_pk_bf16_f32 v190, v44, v45
  v_cvt_pk_bf16_f32 v191, v46, v47
  v_exp_f32_e64 v48, v48
  v_mfma_f32_16x16x32_bf16 v[156:159], v[216:219], v[220:223], 0
  v_exp_f32_e64 v49, v49
  v_mfma_f32_32x32x16_bf16 v[80:95], v[196:199], v[184:187], v[80:95]
  ds_read_b128 v[32:35], v2 offset:1408
  ds_read_b128 v[36:39], v2 offset:1440
  v_exp_f32 v50, v50
  v_exp_f32 v51, v51
  v_mfma_f32_16x16x32_bf16 v[156:159], v[224:227], v[228:231], v[156:159]
  v_exp_f32_e64 v52, v52
  v_mfma_f32_32x32x16_bf16 v[96:111], v[200:203], v[184:187], v[96:111]
  ds_read_b128 v[40:43], v2 offset:1472
  ds_read_b128 v[44:47], v2 offset:1504
  v_exp_f32 v53, v53
  v_exp_f32 v54, v54
  v_mfma_f32_16x16x32_bf16 v[156:159], v[232:235], v[236:239], v[156:159]
  v_exp_f32_e64 v55, v55
  v_mfma_f32_32x32x16_bf16 v[64:79], v[204:207], v[188:191], v[64:79]
  v_exp_f32 v56, v56
  v_exp_f32 v57, v57
  v_exp_f32_e64 v58, v58
  v_mfma_f32_32x32x16_bf16 v[80:95], v[208:211], v[188:191], v[80:95]
  v_exp_f32 v59, v59
  v_exp_f32 v60, v60
  v_exp_f32_e64 v61, v61
  v_mfma_f32_32x32x16_bf16 v[96:111], v[212:215], v[188:191], v[96:111]
  s_waitcnt lgkmcnt(0)
  v_exp_f32 v62, v62
  v_exp_f32_e64 v63, v63
  v_pk_add_f32 v[12:13], v[12:13], v[156:157]
  v_pk_fma_f32 v[14:15], v[156:157], v[156:157], v[14:15]
  v_pk_add_f32 v[12:13], v[12:13], v[158:159]
  v_pk_fma_f32 v[14:15], v[158:159], v[158:159], v[14:15]
  v_pk_fma_f32 v[48:49], v[48:49], s[22:23], s[22:23]
  v_pk_fma_f32 v[50:51], v[50:51], s[22:23], s[22:23]
  v_pk_fma_f32 v[52:53], v[52:53], s[22:23], s[22:23]
  v_pk_fma_f32 v[54:55], v[54:55], s[22:23], s[22:23]
  v_pk_fma_f32 v[56:57], v[56:57], s[22:23], s[22:23]
  v_pk_fma_f32 v[58:59], v[58:59], s[22:23], s[22:23]
  v_pk_fma_f32 v[60:61], v[60:61], s[22:23], s[22:23]
  v_pk_fma_f32 v[62:63], v[62:63], s[22:23], s[22:23]
  v_mfma_f32_32x32x16_bf16 v[32:47], a[236:239], v[160:163], v[32:47]
  ds_read_b128 v[248:251], v0 offset:7168
  ds_read_b128 v[192:195], v1 offset:53248
  ds_read_b128 v[196:199], v1 offset:54272
  v_rcp_f32 v48, v48
  v_rcp_f32 v49, v49
  v_add_f32_e64 v12, v12, v13
  v_mfma_f32_32x32x16_bf16 v[32:47], a[240:243], v[164:167], v[32:47]
  ds_read_b128 v[200:203], v1 offset:55296
  ds_read_b128 v[204:207], v1 offset:56320
  v_rcp_f32 v50, v50
  v_add_f32 v14, v14, v15
  v_rcp_f32_e64 v51, v51
  s_nop 0
  v_permlane32_swap_b32 v12, v14
  v_mfma_f32_32x32x16_bf16 v[32:47], a[244:247], v[168:171], v[32:47]
  ds_read_b128 v[208:211], v1 offset:57344
  ds_read_b128 v[212:215], v1 offset:58368
  v_rcp_f32 v52, v52
  v_add_f32 v12, v12, v14
  v_rcp_f32 v53, v53
  v_mov_b32 v14, v12
  v_mfma_f32_32x32x16_bf16 v[32:47], a[248:251], v[172:175], v[32:47]
  v_rcp_f32 v54, v54
  v_permlane32_swap_b32 v12, v14
  v_rcp_f32 v55, v55
  v_mul_f32 v12, s24, v12
  v_rcp_f32_e64 v56, v56
  v_mfma_f32_32x32x16_bf16 v[32:47], a[252:255], v[176:179], v[32:47]
  s_waitcnt lgkmcnt(6)
  v_mul_f32 v13, s24, v14
  v_rcp_f32_e64 v57, v57
  v_fma_f32 v13, -v12, v12, v13
  v_rcp_f32 v58, v58
  v_max_f32 v13, 0, v13
  v_rcp_f32_e64 v59, v59
  v_mfma_f32_32x32x16_bf16 v[32:47], v[248:251], v[180:183], v[32:47]
  s_waitcnt lgkmcnt(0)
  v_add_f32 v13, s25, v13
  v_rcp_f32 v60, v60
  v_rsq_f32 v13, v13
  v_rcp_f32 v61, v61
  v_sub_f32 v12, 0, v12
  v_rcp_f32 v62, v62
  v_mul_f32 v14, s22, v13
  v_rcp_f32 v63, v63
  v_mul_f32 v12, v12, v14
  v_pk_mul_f32 v[16:17], v[16:17], v[48:49]
  v_pk_mul_f32 v[18:19], v[18:19], v[50:51]
  v_pk_mul_f32 v[20:21], v[20:21], v[52:53]
  v_pk_mul_f32 v[22:23], v[22:23], v[54:55]
  v_pk_mul_f32 v[24:25], v[24:25], v[56:57]
  v_pk_mul_f32 v[26:27], v[26:27], v[58:59]
  v_pk_mul_f32 v[28:29], v[28:29], v[60:61]
  v_pk_mul_f32 v[30:31], v[30:31], v[62:63]
  v_pk_fma_f32 v[112:113], v[112:113], v[14:15], v[12:13] op_sel_hi:[1,0,0]
  v_pk_fma_f32 v[114:115], v[114:115], v[14:15], v[12:13] op_sel_hi:[1,0,0]
  v_pk_fma_f32 v[116:117], v[116:117], v[14:15], v[12:13] op_sel_hi:[1,0,0]
  v_pk_fma_f32 v[118:119], v[118:119], v[14:15], v[12:13] op_sel_hi:[1,0,0]
  v_pk_fma_f32 v[120:121], v[120:121], v[14:15], v[12:13] op_sel_hi:[1,0,0]
  v_pk_fma_f32 v[122:123], v[122:123], v[14:15], v[12:13] op_sel_hi:[1,0,0]
  v_pk_fma_f32 v[124:125], v[124:125], v[14:15], v[12:13] op_sel_hi:[1,0,0]
  v_pk_fma_f32 v[126:127], v[126:127], v[14:15], v[12:13] op_sel_hi:[1,0,0]
  v_pk_fma_f32 v[128:129], v[128:129], v[14:15], v[12:13] op_sel_hi:[1,0,0]
  v_pk_fma_f32 v[130:131], v[130:131], v[14:15], v[12:13] op_sel_hi:[1,0,0]
  v_pk_fma_f32 v[132:133], v[132:133], v[14:15], v[12:13] op_sel_hi:[1,0,0]
  v_pk_fma_f32 v[134:135], v[134:135], v[14:15], v[12:13] op_sel_hi:[1,0,0]
  v_pk_fma_f32 v[136:137], v[136:137], v[14:15], v[12:13] op_sel_hi:[1,0,0]
  v_pk_fma_f32 v[138:139], v[138:139], v[14:15], v[12:13] op_sel_hi:[1,0,0]
  v_pk_fma_f32 v[140:141], v[140:141], v[14:15], v[12:13] op_sel_hi:[1,0,0]
  v_pk_fma_f32 v[142:143], v[142:143], v[14:15], v[12:13] op_sel_hi:[1,0,0]
  v_pk_fma_f32 v[144:145], v[144:145], v[14:15], v[12:13] op_sel_hi:[1,0,0]
  v_pk_fma_f32 v[146:147], v[146:147], v[14:15], v[12:13] op_sel_hi:[1,0,0]
  v_pk_fma_f32 v[148:149], v[148:149], v[14:15], v[12:13] op_sel_hi:[1,0,0]
  v_pk_fma_f32 v[150:151], v[150:151], v[14:15], v[12:13] op_sel_hi:[1,0,0]
  v_pk_fma_f32 v[152:153], v[152:153], v[14:15], v[12:13] op_sel_hi:[1,0,0]
  v_pk_fma_f32 v[154:155], v[154:155], v[14:15], v[12:13] op_sel_hi:[1,0,0]
  v_pk_fma_f32 v[156:157], v[156:157], v[14:15], v[12:13] op_sel_hi:[1,0,0]
  v_pk_fma_f32 v[158:159], v[158:159], v[14:15], v[12:13] op_sel_hi:[1,0,0]
  v_pk_fma_f32 v[48:49], v[32:33], v[32:33], s[20:21] neg_lo:[1,0,1] neg_hi:[1,0,1]
  v_pk_fma_f32 v[50:51], v[34:35], v[34:35], s[20:21] neg_lo:[1,0,1] neg_hi:[1,0,1]
  v_pk_fma_f32 v[52:53], v[36:37], v[36:37], s[20:21] neg_lo:[1,0,1] neg_hi:[1,0,1]
  v_pk_fma_f32 v[54:55], v[38:39], v[38:39], s[20:21] neg_lo:[1,0,1] neg_hi:[1,0,1]
  v_pk_fma_f32 v[56:57], v[40:41], v[40:41], s[20:21] neg_lo:[1,0,1] neg_hi:[1,0,1]
  v_pk_fma_f32 v[58:59], v[42:43], v[42:43], s[20:21] neg_lo:[1,0,1] neg_hi:[1,0,1]
  v_pk_fma_f32 v[60:61], v[44:45], v[44:45], s[20:21] neg_lo:[1,0,1] neg_hi:[1,0,1]
  v_pk_fma_f32 v[62:63], v[46:47], v[46:47], s[20:21] neg_lo:[1,0,1] neg_hi:[1,0,1]
  v_pk_mul_f32 v[48:49], v[32:33], v[48:49]
  v_pk_mul_f32 v[50:51], v[34:35], v[50:51]
  v_pk_mul_f32 v[52:53], v[36:37], v[52:53]
  v_pk_mul_f32 v[54:55], v[38:39], v[54:55]
  v_pk_mul_f32 v[56:57], v[40:41], v[56:57]
  v_cvt_pk_bf16_f32 v184, v16, v17
  v_cvt_pk_bf16_f32 v185, v18, v19
  v_cvt_pk_bf16_f32 v186, v20, v21
  v_cvt_pk_bf16_f32 v187, v22, v23
  v_pk_mul_f32 v[58:59], v[42:43], v[58:59]
  v_pk_mul_f32 v[60:61], v[44:45], v[60:61]
  v_pk_mul_f32 v[62:63], v[46:47], v[62:63]
  v_mfma_f32_32x32x16_bf16 v[64:79], v[192:195], v[184:187], v[64:79]
  v_cvt_pk_bf16_f32 v188, v24, v25
  v_cvt_pk_bf16_f32 v189, v26, v27
  v_cvt_pk_bf16_f32 v190, v28, v29
  v_cvt_pk_bf16_f32 v191, v30, v31
  v_exp_f32_e64 v48, v48
  v_cvt_pk_bf16_f32 v160, v112, v113
  v_exp_f32_e64 v49, v49
  v_cvt_pk_bf16_f32 v161, v114, v115
  v_mfma_f32_32x32x16_bf16 v[80:95], v[196:199], v[184:187], v[80:95]
  ds_read_b128 v[16:19], v2
  ds_read_b128 v[20:23], v2 offset:32
  v_cvt_pk_bf16_f32 v162, v116, v117
  v_exp_f32_e64 v50, v50
  v_cvt_pk_bf16_f32 v163, v118, v119
  v_exp_f32_e64 v51, v51
  v_cvt_pk_bf16_f32 v164, v120, v121
  v_cvt_pk_bf16_f32 v165, v122, v123
  v_mfma_f32_32x32x16_bf16 v[96:111], v[200:203], v[184:187], v[96:111]
  ds_read_b128 v[24:27], v2 offset:64
  ds_read_b128 v[28:31], v2 offset:96
  v_exp_f32_e64 v52, v52
  v_cvt_pk_bf16_f32 v166, v124, v125
  v_exp_f32_e64 v53, v53
  v_cvt_pk_bf16_f32 v167, v126, v127
  v_cvt_pk_bf16_f32 v168, v128, v129
  v_mfma_f32_32x32x16_bf16 v[64:79], v[204:207], v[188:191], v[64:79]
  v_exp_f32_e64 v54, v54
  v_cvt_pk_bf16_f32 v169, v130, v131
  v_exp_f32_e64 v55, v55
  v_cvt_pk_bf16_f32 v170, v132, v133
  v_cvt_pk_bf16_f32 v171, v134, v135
  v_exp_f32_e64 v56, v56
  v_cvt_pk_bf16_f32 v172, v136, v137
  v_mfma_f32_32x32x16_bf16 v[80:95], v[208:211], v[188:191], v[80:95]
  v_exp_f32_e64 v57, v57
  v_cvt_pk_bf16_f32 v173, v138, v139
  v_cvt_pk_bf16_f32 v174, v140, v141
  v_exp_f32_e64 v58, v58
  v_cvt_pk_bf16_f32 v175, v142, v143
  v_exp_f32_e64 v59, v59
  v_cvt_pk_bf16_f32 v176, v144, v145
  v_mfma_f32_32x32x16_bf16 v[96:111], v[212:215], v[188:191], v[96:111]
  s_waitcnt lgkmcnt(0)
  v_cvt_pk_bf16_f32 v177, v146, v147
  v_exp_f32 v60, v60
  v_cvt_pk_bf16_f32 v178, v148, v149
  v_exp_f32_e64 v61, v61
  v_cvt_pk_bf16_f32 v179, v150, v151
  v_cvt_pk_bf16_f32 v180, v152, v153
  v_exp_f32_e64 v62, v62
  v_cvt_pk_bf16_f32 v181, v154, v155
  v_exp_f32_e64 v63, v63
  v_cvt_pk_bf16_f32 v182, v156, v157
  v_cvt_pk_bf16_f32 v183, v158, v159
  v_subrev_u32 v11, 0x4100, v4
  v_add_u32 v4, 0x8200, v4
  v_min_u32_e64 v4, v11, v4
  v_pk_fma_f32 v[48:49], v[48:49], s[22:23], s[22:23]
  v_pk_fma_f32 v[50:51], v[50:51], s[22:23], s[22:23]
  v_pk_fma_f32 v[52:53], v[52:53], s[22:23], s[22:23]
  v_pk_fma_f32 v[54:55], v[54:55], s[22:23], s[22:23]
  v_pk_fma_f32 v[56:57], v[56:57], s[22:23], s[22:23]
  v_pk_fma_f32 v[58:59], v[58:59], s[22:23], s[22:23]
  v_pk_fma_f32 v[60:61], v[60:61], s[22:23], s[22:23]
  v_pk_fma_f32 v[62:63], v[62:63], s[22:23], s[22:23]
  s_sub_u32 s26, s26, 1
  s_cmp_lg_u32 s26, 0
  s_nop 0
  s_cbranch_scc1 L_loop
  ds_read_b128 v[192:195], v1 offset:59392
  ds_read_b128 v[196:199], v1 offset:60416
  ds_read_b128 v[200:203], v1 offset:61440
  ds_read_b128 v[204:207], v1 offset:62464
  ds_read_b128 v[208:211], v1 offset:63488
  ds_read_b128 v[212:215], v1 offset:64512
  v_rcp_f32 v48, v48
  v_rcp_f32 v49, v49
  v_rcp_f32 v50, v50
  v_rcp_f32 v51, v51
  v_rcp_f32 v52, v52
  v_rcp_f32 v53, v53
  v_rcp_f32 v54, v54
  v_rcp_f32 v55, v55
  v_rcp_f32 v56, v56
  v_rcp_f32 v57, v57
  v_rcp_f32 v58, v58
  v_rcp_f32 v59, v59
  v_rcp_f32 v60, v60
  v_rcp_f32 v61, v61
  v_rcp_f32 v62, v62
  v_rcp_f32 v63, v63
  v_pk_mul_f32 v[32:33], v[32:33], v[48:49]
  v_pk_mul_f32 v[34:35], v[34:35], v[50:51]
  v_pk_mul_f32 v[36:37], v[36:37], v[52:53]
  v_pk_mul_f32 v[38:39], v[38:39], v[54:55]
  v_pk_mul_f32 v[40:41], v[40:41], v[56:57]
  v_pk_mul_f32 v[42:43], v[42:43], v[58:59]
  v_pk_mul_f32 v[44:45], v[44:45], v[60:61]
  v_pk_mul_f32 v[46:47], v[46:47], v[62:63]
  v_cvt_pk_bf16_f32 v184, v32, v33
  v_cvt_pk_bf16_f32 v185, v34, v35
  v_cvt_pk_bf16_f32 v186, v36, v37
  v_cvt_pk_bf16_f32 v187, v38, v39
  v_cvt_pk_bf16_f32 v188, v40, v41
  v_cvt_pk_bf16_f32 v189, v42, v43
  v_cvt_pk_bf16_f32 v190, v44, v45
  v_cvt_pk_bf16_f32 v191, v46, v47
  s_waitcnt lgkmcnt(5)
  v_mfma_f32_32x32x16_bf16 v[64:79], v[192:195], v[184:187], v[64:79]
  s_waitcnt lgkmcnt(2)
  v_mfma_f32_32x32x16_bf16 v[64:79], v[204:207], v[188:191], v[64:79]
  v_mfma_f32_32x32x16_bf16 v[80:95], v[196:199], v[184:187], v[80:95]
  s_nop 0
  s_waitcnt lgkmcnt(1)
  v_mfma_f32_32x32x16_bf16 v[80:95], v[208:211], v[188:191], v[80:95]
  v_mfma_f32_32x32x16_bf16 v[96:111], v[200:203], v[184:187], v[96:111]
  s_waitcnt lgkmcnt(0)
  v_mfma_f32_32x32x16_bf16 v[96:111], v[212:215], v[188:191], v[96:111]
  s_nop 5
  v_cvt_pk_bf16_f32 v112, v64, v65
  v_cvt_pk_bf16_f32 v113, v66, v67
  v_cvt_pk_bf16_f32 v114, v68, v69
  v_cvt_pk_bf16_f32 v115, v70, v71
  buffer_store_dwordx4 v[112:115], v10, s[8:11], s28 offen
  v_cvt_pk_bf16_f32 v116, v72, v73
  v_cvt_pk_bf16_f32 v117, v74, v75
  v_cvt_pk_bf16_f32 v118, v76, v77
  v_cvt_pk_bf16_f32 v119, v78, v79
  buffer_store_dwordx4 v[116:119], v10, s[8:11], s28 offen offset:32
  v_cvt_pk_bf16_f32 v120, v80, v81
  v_cvt_pk_bf16_f32 v121, v82, v83
  v_cvt_pk_bf16_f32 v122, v84, v85
  v_cvt_pk_bf16_f32 v123, v86, v87
  buffer_store_dwordx4 v[120:123], v10, s[8:11], s28 offen offset:64
  v_cvt_pk_bf16_f32 v124, v88, v89
  v_cvt_pk_bf16_f32 v125, v90, v91
  v_cvt_pk_bf16_f32 v126, v92, v93
  v_cvt_pk_bf16_f32 v127, v94, v95
  buffer_store_dwordx4 v[124:127], v10, s[8:11], s28 offen offset:96
  v_cvt_pk_bf16_f32 v128, v96, v97
  v_cvt_pk_bf16_f32 v129, v98, v99
  v_cvt_pk_bf16_f32 v130, v100, v101
  v_cvt_pk_bf16_f32 v131, v102, v103
  buffer_store_dwordx4 v[128:131], v10, s[8:11], s28 offen offset:128
  v_cvt_pk_bf16_f32 v132, v104, v105
  v_cvt_pk_bf16_f32 v133, v106, v107
  v_cvt_pk_bf16_f32 v134, v108, v109
  v_cvt_pk_bf16_f32 v135, v110, v111
  buffer_store_dwordx4 v[132:135], v10, s[8:11], s28 offen offset:160
L_end:
  s_endpgm
.section .rodata,"a"
.p2align 6
.amdhsa_kernel standalone__modern_conv_block_convnext__vision_kernel
  .amdhsa_next_free_vgpr 512
  .amdhsa_next_free_sgpr 102
  .amdhsa_accum_offset 256
  .amdhsa_group_segment_fixed_size 0
  .amdhsa_kernarg_size 80
  .amdhsa_user_sgpr_count 2
  .amdhsa_user_sgpr_kernarg_segment_ptr 1
  .amdhsa_system_sgpr_workgroup_id_x 1
.end_amdhsa_kernel
```

```asm
; @launch grid=(256,1,1) block=(256,1,1) lds=163840
.amdgcn_target "amdgcn-amd-amdhsa--gfx950"
.text
.globl standalone__modern_conv_block_convnext__vision_kernel
.p2align 8
.type standalone__modern_conv_block_convnext__vision_kernel,@function
standalone__modern_conv_block_convnext__vision_kernel:
  s_cmp_ge_u32 s2, 0x100
  s_cbranch_scc1 L_end
  s_getpc_b64 s[40:41]
L_pc:
  v_lshlrev_b32_e64 v249, 7, v0
  v_min_u32 v249, L_end-L_pc, v249
  global_load_dword v249, v249, s[40:41]
  v_lshlrev_b32_e64 v248, 7, v0
  v_add_u32 v248, 0x8000, v248
  v_min_u32 v248, L_end-L_pc, v248
  global_load_dword v249, v248, s[40:41]
  s_load_dwordx2 s[4:5], s[0:1], 0
  s_load_dwordx2 s[64:65], s[0:1], 16
  s_load_dwordx2 s[68:69], s[0:1], 24
  s_load_dwordx2 s[72:73], s[0:1], 32
  s_load_dwordx2 s[60:61], s[0:1], 8
  s_load_dwordx2 s[80:81], s[0:1], 48
  s_load_dwordx2 s[76:77], s[0:1], 40
  s_load_dwordx2 s[8:9], s[0:1], 56
  v_lshrrev_b32_e64 v112, 6, v0
  v_and_b32 v113, 63, v0
  v_readfirstlane_b32 s27, v112
  s_and_b32 s54, s2, 6
  s_lshl_b32 s54, s54, 1
  s_lshr_b32 s32, s2, 6
  s_add_u32 s54, s54, s32
  s_lshl_b32 s54, s54, 5
  s_and_b32 s53, s2, 1
  s_lshl_b32 s53, s53, 8
  s_and_b32 s32, s2, 56
  s_lshl_b32 s32, s32, 2
  s_add_u32 s53, s53, s32
  s_lshl_b32 s32, s27, 3
  s_add_u32 s53, s53, s32
  s_mul_i32 s57, s54, 0x18000
  s_mul_i32 s59, s53, 0xc0
  s_add_u32 s59, s59, 0xf40
  s_cmp_lg_u32 s27, 3
  s_cbranch_scc1 L_pa
  s_mov_b32 s6, 0x3000000
  s_mov_b32 s7, 0x20000
  v_add_u32 v114, 64, v113
  v_subrev_u32 v121, 57, v113
  v_cmp_le_u32 vcc, 57, v113
  v_add_u32 v115, 7, v113
  v_add_u32 v116, 0x47, v113
  v_mov_b32 v118, 0x17c00
  v_cndmask_b32_e64 v114, v114, v121, vcc
  v_mov_b32 v121, 0xfffffc00
  v_cndmask_b32_e64 v118, v121, v118, vcc
  v_lshl_add_u32 v117, v113, 4, s59
  v_lshl_add_u32 v118, v114, 4, v118
  v_add_u32 v118, s59, v118
  v_add_u32 v119, 0x17870, v117
  v_add_u32 v120, 0x17870, v117
  v_mov_b32 v122, 0x80000000
  s_movk_i32 s35, 0x78
  v_cmp_gt_u32 s[36:37], s35, v113
  v_cmp_gt_u32 s[38:39], s35, v114
  v_cmp_gt_u32 s[40:41], s35, v115
  v_cmp_gt_u32 s[42:43], s35, v116
  v_cndmask_b32 v123, v122, v117, s[36:37]
  v_cndmask_b32 v124, v122, v118, s[38:39]
  v_cndmask_b32 v125, v122, v119, s[40:41]
  v_cndmask_b32 v126, v122, v120, s[42:43]
  s_add_u32 s44, s57, 0x16400
  s_waitcnt lgkmcnt(0)
  s_mov_b32 m0, 0x5160
  s_nop 0
  buffer_load_dwordx4 v123, s[4:7], s44 offen lds
  buffer_load_dwordx4 v124, s[4:7], s44 offen offset:1024 lds
  buffer_load_dwordx4 v125, s[4:7], s44 offen offset:2048 lds
  buffer_load_dwordx4 v126, s[4:7], s44 offen offset:3072 lds
  s_add_u32 s45, s44, 0x600
  s_add_u32 s46, s44, 0x30000
  s_add_u32 s47, s44, 0x30600
  s_mov_b32 m0, 0x61a0
  s_nop 0
  buffer_load_dwordx4 v123, s[4:7], s45 offen lds
  buffer_load_dwordx4 v124, s[4:7], s45 offen offset:1024 lds
  buffer_load_dwordx4 v125, s[4:7], s45 offen offset:2048 lds
  buffer_load_dwordx4 v126, s[4:7], s45 offen offset:3072 lds
  s_cmp_eq_u32 s53, 0x1f8
  s_cselect_b32 s35, 12, 0
  s_sub_u32 s35, 0x78, s35
  v_cmp_gt_u32 s[36:37], s35, v113
  v_cmp_gt_u32 s[38:39], s35, v114
  v_cmp_gt_u32 s[40:41], s35, v115
  v_cmp_gt_u32 s[42:43], s35, v116
  v_cndmask_b32 v6, v122, v117, s[36:37]
  v_cndmask_b32 v7, v122, v118, s[38:39]
  v_cndmask_b32 v8, v122, v119, s[40:41]
  v_cndmask_b32 v9, v122, v120, s[42:43]
  s_mov_b32 m0, 0x9240
  s_nop 0
  buffer_load_dwordx4 v123, s[4:7], s46 offen lds
  buffer_load_dwordx4 v124, s[4:7], s46 offen offset:1024 lds
  buffer_load_dwordx4 v125, s[4:7], s46 offen offset:2048 lds
  buffer_load_dwordx4 v126, s[4:7], s46 offen offset:3072 lds
  s_mov_b32 m0, 0xa280
  s_nop 0
  buffer_load_dwordx4 v123, s[4:7], s47 offen lds
  buffer_load_dwordx4 v124, s[4:7], s47 offen offset:1024 lds
  buffer_load_dwordx4 v125, s[4:7], s47 offen offset:2048 lds
  buffer_load_dwordx4 v126, s[4:7], s47 offen offset:3072 lds
  s_cmp_eq_u32 s53, 24
  s_cselect_b32 s35, 12, 0
  s_sub_u32 s55, 0x78, s35
  v_subrev_u32_e64 v127, s35, v113
  v_cmp_gt_u32 s[36:37], s55, v127
  v_subrev_u32_e64 v128, s35, v114
  v_cmp_gt_u32 s[38:39], s55, v128
  v_subrev_u32_e64 v129, s35, v115
  v_cmp_gt_u32 s[40:41], s55, v129
  v_subrev_u32_e64 v130, s35, v116
  v_cmp_gt_u32 s[42:43], s55, v130
  v_cndmask_b32 v127, v122, v117, s[36:37]
  v_cndmask_b32 v128, v122, v118, s[38:39]
  v_cndmask_b32 v129, v122, v119, s[40:41]
  v_cndmask_b32 v130, v122, v120, s[42:43]
  s_add_u32 s45, s44, 0xc00
  s_add_u32 s46, s44, 0x30c00
  s_sub_u32 s47, s44, 0x600
  s_add_u32 s48, s44, 0x2fa00
  s_mov_b32 m0, 0x71e0
  s_nop 0
  buffer_load_dwordx4 v6, s[4:7], s45 offen lds
  buffer_load_dwordx4 v7, s[4:7], s45 offen offset:1024 lds
  buffer_load_dwordx4 v8, s[4:7], s45 offen offset:2048 lds
  buffer_load_dwordx4 v9, s[4:7], s45 offen offset:3072 lds
  s_mov_b32 m0, 0xb2c0
  s_nop 0
  buffer_load_dwordx4 v6, s[4:7], s46 offen lds
  buffer_load_dwordx4 v7, s[4:7], s46 offen offset:1024 lds
  buffer_load_dwordx4 v8, s[4:7], s46 offen offset:2048 lds
  buffer_load_dwordx4 v9, s[4:7], s46 offen offset:3072 lds
  s_mov_b32 m0, 0x4120
  s_nop 0
  buffer_load_dwordx4 v127, s[4:7], s47 offen lds
  buffer_load_dwordx4 v128, s[4:7], s47 offen offset:1024 lds
  buffer_load_dwordx4 v129, s[4:7], s47 offen offset:2048 lds
  buffer_load_dwordx4 v130, s[4:7], s47 offen offset:3072 lds
  s_mov_b32 m0, 0x8200
  s_nop 0
  buffer_load_dwordx4 v127, s[4:7], s48 offen lds
  buffer_load_dwordx4 v128, s[4:7], s48 offen offset:1024 lds
  buffer_load_dwordx4 v129, s[4:7], s48 offen offset:2048 lds
  buffer_load_dwordx4 v130, s[4:7], s48 offen offset:3072 lds
  s_movk_i32 s49, 0x600
  s_add_u32 s35, s57, 0xfffe6400
  v_add_u32 v117, s35, v123
  s_add_u32 s35, s57, 0xfffe6800
  v_add_u32_e64 v118, s35, v124
  s_add_u32 s35, s57, 0xfffe6c00
  v_add_u32_e64 v119, s35, v125
  s_add_u32 s35, s57, 0xfffe7000
  v_add_u32_e64 v120, s35, v126
  s_mov_b32 m0, 0x1040
  s_nop 0
  buffer_load_dwordx4 v117, s[4:7], 0 offen lds
  s_mov_b32 m0, 0x1440
  s_nop 0
  buffer_load_dwordx4 v118, s[4:7], 0 offen lds
  s_mov_b32 m0, 0x1840
  s_nop 0
  buffer_load_dwordx4 v119, s[4:7], 0 offen lds
  s_mov_b32 m0, 0x1c40
  s_nop 0
  buffer_load_dwordx4 v120, s[4:7], 0 offen lds
  s_mov_b32 m0, 0x2080
  s_nop 0
  buffer_load_dwordx4 v117, s[4:7], s49 offen lds
  s_mov_b32 m0, 0x2480
  s_nop 0
  buffer_load_dwordx4 v118, s[4:7], s49 offen lds
  s_mov_b32 m0, 0x2880
  s_nop 0
  buffer_load_dwordx4 v119, s[4:7], s49 offen lds
  s_mov_b32 m0, 0x2c80
  s_nop 0
  buffer_load_dwordx4 v120, s[4:7], s49 offen lds
  s_add_u32 s35, s57, 0xfffe7000
  v_add_u32_e64 v117, s35, v6
  s_add_u32 s35, s57, 0xfffe7400
  v_add_u32_e64 v118, s35, v7
  s_add_u32 s35, s57, 0xfffe7800
  v_add_u32_e64 v119, s35, v8
  s_add_u32 s35, s57, 0xfffe7c00
  v_add_u32_e64 v120, s35, v9
  s_mov_b32 m0, 0x30c0
  s_nop 0
  buffer_load_dwordx4 v117, s[4:7], 0 offen lds
  s_mov_b32 m0, 0x34c0
  s_nop 0
  buffer_load_dwordx4 v118, s[4:7], 0 offen lds
  s_mov_b32 m0, 0x38c0
  s_nop 0
  buffer_load_dwordx4 v119, s[4:7], 0 offen lds
  s_mov_b32 m0, 0x3cc0
  s_nop 0
  buffer_load_dwordx4 v120, s[4:7], 0 offen lds
  s_add_u32 s35, s57, 0xfffe5e00
  v_add_u32_e64 v117, s35, v127
  s_add_u32 s35, s57, 0xfffe6200
  v_add_u32_e64 v118, s35, v128
  s_add_u32 s35, s57, 0xfffe6600
  v_add_u32_e64 v119, s35, v129
  s_add_u32 s35, s57, 0xfffe6a00
  v_add_u32 v120, s35, v130
  s_mov_b32 m0, 0
  s_nop 0
  buffer_load_dwordx4 v117, s[4:7], 0 offen lds
  s_mov_b32 m0, 0x400
  s_nop 0
  buffer_load_dwordx4 v118, s[4:7], 0 offen lds
  s_mov_b32 m0, 0x800
  s_nop 0
  buffer_load_dwordx4 v119, s[4:7], 0 offen lds
  s_mov_b32 m0, 0xc00
  s_nop 0
  buffer_load_dwordx4 v120, s[4:7], 0 offen lds
  s_mov_b32 s10, 0x3000000
  s_mov_b32 s11, 0x20000
  v_and_b32_e64 v131, 7, v113
  v_bfe_u32 v132, v113, 3, 1
  v_bfe_u32 v133, v113, 4, 1
  v_lshrrev_b32_e64 v134, 5, v113
  v_bfe_u32 v135, v113, 2, 1
  v_and_b32 v136, 3, v113
  v_lshrrev_b32 v137, 4, v113
  v_lshlrev_b32 v138, 4, v113
  v_lshlrev_b32 v139, 4, v134
  s_mul_i32 s58, s27, 0x1040
  s_mov_b32 s20, 0x409d30fc
  s_mov_b32 s21, 0x409d30fc
  s_mov_b32 s22, 0x3eeff558
  s_mov_b32 s23, 0x3eeff558
  s_mov_b32 s24, 0x3c2aaaab
  s_mov_b32 s25, 0x3727c5ac
  s_mov_b32 s12, 0
  s_mov_b32 s13, -1
  s_add_u32 s29, s57, 0x77000
  s_add_u32 s52, s57, 0xa7000
  v_mul_u32_u24 v176, 0xc0, v131
  v_add_u32_e64 v142, s58, v176
  v_lshl_add_u32 v177, v132, 1, v137
  v_lshrrev_b32_e64 v140, 1, v177
  v_mul_u32_u24 v143, 0x4100, v140
  v_and_b32_e64 v140, 1, v140
  v_lshl_add_u32 v143, v140, 5, v143
  v_and_b32_e64 v140, 1, v177
  v_mul_u32_u24 v140, 0x790, v140
  v_add3_u32 v4, v143, v140, v142
  v_lshl_add_u32 v178, v132, 1, v133
  v_add_u32_e64 v177, 1, v178
  v_add_u32 v142, 0xc0, v142
  v_add_u32 v142, v142, v139
  v_lshrrev_b32 v140, 1, v177
  v_mul_u32_u24 v143, 0x4100, v140
  v_and_b32_e64 v140, 1, v140
  v_lshl_add_u32 v143, v140, 5, v143
  v_and_b32_e64 v140, 1, v177
  v_mul_u32_u24 v140, 0x790, v140
  v_add3_u32 v5, v143, v140, v142
  v_mul_u32_u24 v140, 0x18000, v178
  v_add3_u32 v10, v140, v139, v176
  s_sub_u32 s32, s59, 0xf40
  v_add_u32_e64 v10, s32, v10
  v_add_u32 v2, 0xfb40, v139
  v_sub_u32_e64 v140, v137, v135
  v_lshl_add_u32 v141, v132, 2, v136
  v_lshl_add_u32 v141, v140, 3, v141
  v_min_u32 v141, 24, v141
  v_lshlrev_b32 v141, 4, v141
  v_add_u32 v3, 0xc300, v141
  v_add_u32 v0, 0x10000, v138
  v_add_u32 v1, 0x20000, v138
  v_and_b32_e64 v140, 15, v113
  v_lshlrev_b32 v140, 7, v140
  v_mul_u32_u24 v141, 0x18000, v137
  s_sub_u32 s32, s59, 64
  v_add3_u32 v248, v140, v141, s32
  v_mov_b32 v250, 0x3ef00000
  s_add_u32 s30, s58, 32
  s_add_u32 s31, s58, 0x4100
  s_mov_b32 s34, s57
  s_mov_b32 s28, 0x80000000
  s_add_u32 s33, s58, 0x8200
  v_and_b32 v180, 1, v113
  v_lshlrev_b32 v180, 4, v180
  v_lshlrev_b32_e64 v181, 2, v133
  v_lshl_add_u32 v181, v132, 1, v181
  v_bfe_u32 v179, v113, 1, 1
  v_add_u32 v181, v181, v179
  v_xor_b32 v179, v135, v134
  v_lshl_add_u32 v181, v179, 3, v181
  v_lshlrev_b32 v181, v181, 1
  v_mov_b32 v179, 0x3f80
  v_lshlrev_b32_e64 v179, v180, v179
  v_bfe_i32 v48, v181, 0, 1
  v_and_b32_e64 v240, v48, v179
  v_bfe_i32 v49, v181, 1, 1
  v_and_b32_e64 v241, v49, v179
  v_bfe_i32 v50, v181, 2, 1
  v_and_b32_e64 v242, v50, v179
  v_bfe_i32 v51, v181, 3, 1
  v_and_b32_e64 v243, v51, v179
  v_bfe_i32 v52, v181, 4, 1
  v_and_b32_e64 v244, v52, v179
  v_bfe_i32 v53, v181, 5, 1
  v_and_b32_e64 v245, v53, v179
  v_bfe_i32 v54, v181, 6, 1
  v_and_b32_e64 v246, v54, v179
  v_bfe_i32 v55, v181, 7, 1
  v_and_b32 v247, v55, v179
  s_barrier
  ds_read_b128 a[0:3], v0 offset:12288
  ds_read_b128 a[4:7], v0 offset:13312
  ds_read_b128 a[8:11], v0 offset:16384
  ds_read_b128 a[12:15], v0 offset:17408
  ds_read_b128 a[16:19], v0 offset:20480
  ds_read_b128 a[20:23], v0 offset:21504
  ds_read_b128 a[24:27], v0 offset:14336
  ds_read_b128 a[28:31], v0 offset:15360
  ds_read_b128 a[32:35], v0 offset:18432
  ds_read_b128 a[36:39], v0 offset:19456
  ds_read_b128 a[40:43], v0 offset:22528
  ds_read_b128 a[44:47], v0 offset:23552
  ds_read_b128 a[48:51], v0 offset:24576
  ds_read_b128 a[52:55], v0 offset:25600
  ds_read_b128 a[56:59], v0 offset:28672
  ds_read_b128 a[60:63], v0 offset:29696
  ds_read_b128 a[64:67], v0 offset:32768
  ds_read_b128 a[68:71], v0 offset:33792
  ds_read_b128 a[72:75], v0 offset:26624
  ds_read_b128 a[76:79], v0 offset:27648
  ds_read_b128 a[80:83], v0 offset:30720
  ds_read_b128 a[84:87], v0 offset:31744
  ds_read_b128 a[88:91], v0 offset:34816
  ds_read_b128 a[92:95], v0 offset:35840
  ds_read_b128 a[96:99], v0 offset:36864
  ds_read_b128 a[100:103], v0 offset:37888
  ds_read_b128 a[104:107], v0 offset:40960
  ds_read_b128 a[108:111], v0 offset:41984
  ds_read_b128 a[112:115], v0 offset:45056
  ds_read_b128 a[116:119], v0 offset:46080
  ds_read_b128 a[120:123], v0 offset:38912
  ds_read_b128 a[124:127], v0 offset:39936
  ds_read_b128 a[128:131], v0 offset:43008
  ds_read_b128 a[132:135], v0 offset:44032
  ds_read_b128 a[136:139], v0 offset:47104
  ds_read_b128 a[140:143], v0 offset:48128
  ds_read_b128 a[144:147], v0 offset:49152
  ds_read_b128 a[148:151], v0 offset:50176
  ds_read_b128 a[152:155], v0 offset:53248
  ds_read_b128 a[156:159], v0 offset:54272
  ds_read_b128 a[160:163], v0 offset:57344
  ds_read_b128 a[164:167], v0 offset:58368
  ds_read_b128 a[168:171], v0 offset:51200
  ds_read_b128 a[172:175], v0 offset:52224
  ds_read_b128 a[176:179], v0 offset:55296
  ds_read_b128 a[180:183], v0 offset:56320
  ds_read_b128 a[184:187], v0 offset:59392
  ds_read_b128 a[188:191], v0 offset:60416
  ds_read_b128 a[192:195], v0 offset:61440
  ds_read_b128 a[196:199], v0 offset:62464
  ds_read_b128 a[200:203], v1
  ds_read_b128 a[204:207], v1 offset:1024
  ds_read_b128 a[208:211], v1 offset:4096
  ds_read_b128 a[212:215], v1 offset:5120
  ds_read_b128 a[216:219], v0 offset:63488
  ds_read_b128 a[220:223], v0 offset:64512
  ds_read_b128 a[224:227], v1 offset:2048
  ds_read_b128 a[228:231], v1 offset:3072
  ds_read_b128 a[232:235], v1 offset:6144
  ds_read_b128 a[236:239], v1 offset:7168
  ds_read_b128 a[240:243], v3 offset:2400
  ds_read_b128 a[244:247], v3 offset:7200
  ds_read_b128 a[248:251], v3 offset:12000
  ds_read_b128 a[252:255], v3 offset:3200
  s_waitcnt lgkmcnt(0)
  s_barrier
  s_waitcnt vmcnt(0)
  s_branch L_join
L_pa:
  s_mov_b32 s66, 0x12000
  s_mov_b32 s67, 0x20000
  s_mov_b32 s70, 0x300
  s_mov_b32 s71, 0x20000
  v_and_b32_e64 v114, 7, v113
  v_bfe_u32 v115, v113, 3, 1
  v_bfe_u32 v116, v113, 4, 1
  v_lshrrev_b32_e64 v117, 5, v113
  v_bfe_u32 v118, v113, 2, 1
  v_and_b32 v119, 3, v113
  v_lshrrev_b32 v120, 4, v113
  v_lshlrev_b32 v121, 4, v113
  v_lshlrev_b32 v122, 4, v117
  v_lshrrev_b32 v123, 3, v113
  v_lshrrev_b32 v124, 1, v123
  v_xor_b32 v124, v124, v114
  v_lshlrev_b32 v124, 4, v124
  v_mul_u32_u24 v123, 0x300, v123
  v_add_u32 v124, v124, v123
  v_xor_b32 v125, 64, v124
  v_lshlrev_b32_e64 v126, 4, v116
  v_lshl_add_u32 v126, v118, 3, v126
  v_lshl_add_u32 v126, v115, 2, v126
  v_add_u32 v126, v126, v119
  v_lshlrev_b32 v127, 1, v126
  v_lshl_add_u32 v128, v117, 6, v127
  s_mul_i32 s44, s27, 0x6000
  s_add_u32 s45, s44, 0x1800
  s_add_u32 s46, s44, 0x3000
  s_add_u32 s47, s44, 0x4800
  s_mov_b32 s48, 0x11d00
  s_lshl_b32 s49, s27, 12
  s_waitcnt lgkmcnt(0)
  buffer_load_ushort a32, v128, s[64:67], s48 offen
  buffer_load_ushort a33, v128, s[68:71], 0 offen
  s_add_u32 m0, s49, 0x10000
  s_nop 0
  buffer_load_dwordx4 v124, s[64:67], s44 offen lds
  s_add_u32 m0, s49, 0x10400
  s_nop 0
  buffer_load_dwordx4 v125, s[64:67], s45 offen lds
  s_add_u32 m0, s49, 0x10800
  s_nop 0
  buffer_load_dwordx4 v124, s[64:67], s46 offen lds
  s_add_u32 m0, s49, 0x10c00
  s_nop 0
  buffer_load_dwordx4 v125, s[64:67], s47 offen lds
  buffer_load_ushort a34, v128, s[64:67], s48 offen offset:128
  buffer_load_ushort a35, v128, s[68:71], 0 offen offset:128
  s_add_u32 m0, s49, 0x12f80
  s_nop 0
  buffer_load_dwordx4 v124, s[64:67], s44 offen offset:128 lds
  s_add_u32 m0, s49, 0x13380
  s_nop 0
  buffer_load_dwordx4 v125, s[64:67], s45 offen offset:128 lds
  s_add_u32 m0, s49, 0x13780
  s_nop 0
  buffer_load_dwordx4 v124, s[64:67], s46 offen offset:128 lds
  s_add_u32 m0, s49, 0x13b80
  s_nop 0
  buffer_load_dwordx4 v125, s[64:67], s47 offen offset:128 lds
  buffer_load_ushort a36, v128, s[64:67], s48 offen offset:256
  buffer_load_ushort a37, v128, s[68:71], 0 offen offset:256
  s_add_u32 m0, s49, 0x15f00
  s_nop 0
  buffer_load_dwordx4 v124, s[64:67], s44 offen offset:256 lds
  s_add_u32 m0, s49, 0x16300
  s_nop 0
  buffer_load_dwordx4 v125, s[64:67], s45 offen offset:256 lds
  s_add_u32 m0, s49, 0x16700
  s_nop 0
  buffer_load_dwordx4 v124, s[64:67], s46 offen offset:256 lds
  s_add_u32 m0, s49, 0x16b00
  s_nop 0
  buffer_load_dwordx4 v125, s[64:67], s47 offen offset:256 lds
  buffer_load_ushort a38, v128, s[64:67], s48 offen offset:384
  buffer_load_ushort a39, v128, s[68:71], 0 offen offset:384
  s_add_u32 m0, s49, 0x18e80
  s_nop 0
  buffer_load_dwordx4 v124, s[64:67], s44 offen offset:384 lds
  s_add_u32 m0, s49, 0x19280
  s_nop 0
  buffer_load_dwordx4 v125, s[64:67], s45 offen offset:384 lds
  s_add_u32 m0, s49, 0x19680
  s_nop 0
  buffer_load_dwordx4 v124, s[64:67], s46 offen offset:384 lds
  s_add_u32 m0, s49, 0x19a80
  s_nop 0
  buffer_load_dwordx4 v125, s[64:67], s47 offen offset:384 lds
  s_mov_b32 s74, 0x12000
  s_mov_b32 s75, 0x20000
  s_mov_b32 s62, 0x6c0
  s_mov_b32 s63, 0x20000
  s_mov_b32 s82, 0xc0
  s_mov_b32 s83, 0x20000
  s_mov_b32 s78, 0xc0
  s_mov_b32 s79, 0x20000
  s_mov_b32 s6, 0x3000000
  s_mov_b32 s7, 0x20000
  s_mov_b32 s10, 0x3000000
  s_mov_b32 s11, 0x20000
  v_and_b32 v130, 1, v113
  v_lshlrev_b32 v130, 4, v130
  v_lshlrev_b32_e64 v131, 2, v116
  v_lshl_add_u32 v131, v115, 1, v131
  v_bfe_u32 v129, v113, 1, 1
  v_add_u32 v131, v131, v129
  v_xor_b32 v129, v118, v117
  v_lshl_add_u32 v131, v129, 3, v131
  v_lshlrev_b32 v131, v131, 1
  v_mov_b32 v129, 0x3f80
  v_lshlrev_b32_e64 v129, v130, v129
  v_bfe_i32 v40, v131, 0, 1
  v_and_b32_e64 v240, v40, v129
  v_bfe_i32 v41, v131, 1, 1
  v_and_b32_e64 v241, v41, v129
  v_bfe_i32 v42, v131, 2, 1
  v_and_b32_e64 v242, v42, v129
  v_bfe_i32 v43, v131, 3, 1
  v_and_b32_e64 v243, v43, v129
  v_bfe_i32 v44, v131, 4, 1
  v_and_b32_e64 v244, v44, v129
  v_bfe_i32 v45, v131, 5, 1
  v_and_b32_e64 v245, v45, v129
  v_bfe_i32 v46, v131, 6, 1
  v_and_b32_e64 v246, v46, v129
  v_bfe_i32 v47, v131, 7, 1
  v_and_b32_e64 v247, v47, v129
  v_and_b32 v132, 31, v113
  s_cmp_eq_u32 s27, 2
  s_cselect_b32 s32, 0x3f80, 0
  v_mov_b32 v135, 0xbf80
  v_mul_u32_u24 v133, v117, v135
  v_sub_u32 v134, v135, v133
  v_accvgpr_write_b32 a248, v134
  v_accvgpr_write_b32 a252, v133
  v_add_u32 v135, 1, v132
  v_lshrrev_b32 v135, 5, v135
  v_mul_u32_u24 v135, s32, v135
  v_mul_u32_u24 v133, v117, v135
  v_sub_u32_e64 v134, v135, v133
  v_accvgpr_write_b32 a249, v134
  v_accvgpr_write_b32 a253, v133
  v_accvgpr_write_b32 a250, 0
  v_accvgpr_write_b32 a251, 0
  v_accvgpr_write_b32 a254, 0
  v_accvgpr_write_b32 a255, 0
  v_accvgpr_write_b32 a44, 0
  v_accvgpr_write_b32 a45, 0
  v_bfe_u32 v133, v113, 1, 3
  v_xor_b32 v133, v133, v117
  v_lshlrev_b32 v133, 4, v133
  v_lshl_add_u32 v133, v132, 7, v133
  s_add_u32 s32, s49, 0x10000
  v_add_u32 v136, s32, v133
  v_xor_b32 v137, 32, v136
  v_xor_b32_e64 v138, 64, v136
  v_xor_b32 v139, 0x60, v136
  v_add_u32_e64 v140, s32, v121
  buffer_load_ushort a40, v128, s[64:67], s48 offen offset:512
  buffer_load_ushort a41, v128, s[68:71], 0 offen offset:512
  s_add_u32 m0, s49, 0x1be00
  s_nop 0
  buffer_load_dwordx4 v124, s[64:67], s44 offen offset:512 lds
  s_add_u32 m0, s49, 0x1c200
  s_nop 0
  buffer_load_dwordx4 v125, s[64:67], s45 offen offset:512 lds
  s_add_u32 m0, s49, 0x1c600
  s_nop 0
  buffer_load_dwordx4 v124, s[64:67], s46 offen offset:512 lds
  s_add_u32 m0, s49, 0x1ca00
  s_nop 0
  buffer_load_dwordx4 v125, s[64:67], s47 offen offset:512 lds
  buffer_load_ushort a42, v128, s[64:67], s48 offen offset:640
  buffer_load_ushort a43, v128, s[68:71], 0 offen offset:640
  s_add_u32 m0, s49, 0x1ed80
  s_nop 0
  buffer_load_dwordx4 v124, s[64:67], s44 offen offset:640 lds
  s_add_u32 m0, s49, 0x1f180
  s_nop 0
  buffer_load_dwordx4 v125, s[64:67], s45 offen offset:640 lds
  s_add_u32 m0, s49, 0x1f580
  s_nop 0
  buffer_load_dwordx4 v124, s[64:67], s46 offen offset:640 lds
  s_add_u32 m0, s49, 0x1f980
  s_nop 0
  buffer_load_dwordx4 v125, s[64:67], s47 offen offset:640 lds
  s_lshl_b32 s50, s27, 6
  s_mul_i32 s51, s27, 0x240
  v_lshlrev_b32 v141, 1, v113
  buffer_load_ushort v142, v141, s[60:63], s51 offen
  buffer_load_ushort v143, v141, s[60:63], s51 offen offset:128
  buffer_load_ushort v176, v141, s[60:63], s51 offen offset:256
  buffer_load_ushort v177, v141, s[60:63], s51 offen offset:384
  v_lshlrev_b32_e64 v133, 1, v132
  buffer_load_ushort v178, v133, s[60:63], s51 offen offset:512
  buffer_load_ushort v179, v127, s[80:83], s50 offen
  buffer_load_ushort v180, v127, s[76:79], s50 offen
  v_mul_u32_u24 v181, 0xc0, v126
  v_add3_u32 v181, v181, v122, s50
  s_nop 0
  s_waitcnt vmcnt(37)
  ds_read_b128 a[0:3], v136
  ds_read_b128 a[4:7], v137
  ds_read_b128 a[8:11], v138
  ds_read_b128 a[12:15], v139
  v_add_u32 v182, 64, v113
  v_subrev_u32 v237, 57, v113
  v_cmp_le_u32 vcc, 57, v113
  v_add_u32 v183, 7, v113
  v_add_u32 v232, 0x47, v113
  v_mov_b32 v234, 0x17c00
  v_cndmask_b32_e64 v182, v182, v237, vcc
  v_mov_b32 v237, 0xfffffc00
  v_cndmask_b32_e64 v234, v237, v234, vcc
  v_lshl_add_u32 v233, v113, 4, s59
  v_lshl_add_u32 v234, v182, 4, v234
  v_add_u32_e64 v234, s59, v234
  v_add_u32 v235, 0x17870, v233
  v_add_u32 v236, 0x17870, v233
  v_mov_b32 v238, 0x80000000
  s_cmp_eq_u32 s53, 0
  s_cselect_b32 s35, 12, 0
  s_sub_u32 s55, 0x78, s35
  v_subrev_u32_e64 v6, s35, v113
  v_cmp_gt_u32 s[36:37], s55, v6
  v_subrev_u32_e64 v7, s35, v182
  v_cmp_gt_u32 s[38:39], s55, v7
  v_subrev_u32_e64 v8, s35, v183
  v_cmp_gt_u32 s[40:41], s55, v8
  v_subrev_u32_e64 v9, s35, v232
  v_cmp_gt_u32 s[42:43], s55, v9
  v_cndmask_b32 v6, v238, v233, s[36:37]
  v_cndmask_b32 v7, v238, v234, s[38:39]
  v_cndmask_b32 v8, v238, v235, s[40:41]
  v_cndmask_b32 v9, v238, v236, s[42:43]
  s_mul_i32 s58, s27, 0x1040
  s_mov_b32 s20, 0x409d30fc
  s_mov_b32 s21, 0x409d30fc
  s_mov_b32 s22, 0x3eeff558
  s_mov_b32 s23, 0x3eeff558
  s_mov_b32 s24, 0x3c2aaaab
  s_mov_b32 s25, 0x3727c5ac
  s_mov_b32 s12, 0
  s_mov_b32 s13, -1
  s_add_u32 s29, s57, 0x77000
  s_add_u32 s52, s57, 0xa7000
  v_mul_u32_u24 v187, 0xc0, v114
  v_add_u32_e64 v185, s58, v187
  v_lshl_add_u32 v188, v115, 1, v120
  v_lshrrev_b32_e64 v239, 1, v188
  v_mul_u32_u24 v186, 0x4100, v239
  v_and_b32_e64 v239, 1, v239
  v_lshl_add_u32 v186, v239, 5, v186
  v_and_b32_e64 v239, 1, v188
  v_mul_u32_u24 v239, 0x790, v239
  v_add3_u32 v4, v186, v239, v185
  v_lshl_add_u32 v189, v115, 1, v116
  v_add_u32_e64 v188, 1, v189
  v_add_u32 v185, 0xc0, v185
  v_add_u32 v185, v185, v122
  v_lshrrev_b32 v239, 1, v188
  v_mul_u32_u24 v186, 0x4100, v239
  v_and_b32_e64 v239, 1, v239
  v_lshl_add_u32 v186, v239, 5, v186
  v_and_b32_e64 v239, 1, v188
  v_mul_u32_u24 v239, 0x790, v239
  v_add3_u32 v5, v186, v239, v185
  v_mul_u32_u24 v239, 0x18000, v189
  v_add3_u32 v10, v239, v122, v187
  s_sub_u32 s32, s59, 0xf40
  v_add_u32_e64 v10, s32, v10
  v_add_u32 v2, 0xfb40, v122
  v_sub_u32_e64 v239, v120, v118
  v_lshl_add_u32 v184, v115, 2, v119
  v_lshl_add_u32 v184, v239, 3, v184
  v_min_u32 v184, 24, v184
  v_lshlrev_b32 v184, 4, v184
  v_add_u32 v3, 0xc300, v184
  v_add_u32 v0, 0x10000, v121
  v_add_u32 v1, 0x20000, v121
  v_and_b32_e64 v239, 15, v113
  v_lshlrev_b32 v239, 7, v239
  v_mul_u32_u24 v184, 0x18000, v120
  s_sub_u32 s32, s59, 64
  v_add3_u32 v248, v239, v184, s32
  v_mov_b32 v250, 0x3ef00000
  s_add_u32 s30, s58, 32
  s_add_u32 s31, s58, 0x4100
  s_mov_b32 s34, s57
  s_mov_b32 s28, 0x80000000
  s_add_u32 s33, s58, 0x8200
  s_waitcnt lgkmcnt(3)
  v_mfma_f32_32x32x16_bf16 v[48:63], a[0:3], v[240:243], 0
  s_waitcnt vmcnt(31)
  ds_read_b128 a[16:19], v136 offset:12288
  ds_read_b128 a[20:23], v137 offset:12288
  ds_read_b128 a[24:27], v138 offset:12288
  ds_read_b128 a[28:31], v139 offset:12288
  s_nop 0
  s_waitcnt lgkmcnt(6)
  v_mfma_f32_32x32x16_bf16 v[48:63], a[4:7], v[244:247], v[48:63]
  s_mov_b32 s14, 0x1800
  buffer_load_dwordx4 v[64:67], v181, s[72:75], s14 offen
  buffer_load_dwordx4 v[68:71], v181, s[72:75], s14 offen offset:32
  v_mfma_f32_32x32x16_bf16 v[48:63], a[248:251], a[32:35], v[48:63]
  s_waitcnt lgkmcnt(5)
  v_mfma_f32_32x32x16_bf16 v[160:175], a[8:11], v[240:243], 0
  s_waitcnt lgkmcnt(4)
  v_mfma_f32_32x32x16_bf16 v[160:175], a[12:15], v[244:247], v[160:175]
  s_mov_b32 s14, 0x3000
  buffer_load_dwordx4 v[72:75], v181, s[72:75], s14 offen
  buffer_load_dwordx4 v[76:79], v181, s[72:75], s14 offen offset:32
  v_mfma_f32_32x32x16_bf16 v[160:175], a[252:255], a[32:35], v[160:175]
  s_waitcnt lgkmcnt(3)
  v_mfma_f32_32x32x16_bf16 v[216:231], a[16:19], v[240:243], 0
  s_waitcnt vmcnt(29)
  ds_read_b128 a[0:3], v136 offset:24576
  ds_read_b128 a[4:7], v137 offset:24576
  ds_read_b128 a[8:11], v138 offset:24576
  ds_read_b128 a[12:15], v139 offset:24576
  v_cvt_pk_bf16_f32 v48, v48, v49
  v_cvt_pk_bf16_f32 v49, v50, v51
  v_cvt_pk_bf16_f32 v50, v52, v53
  v_cvt_pk_bf16_f32 v51, v54, v55
  s_nop 0
  s_waitcnt lgkmcnt(6)
  v_mfma_f32_32x32x16_bf16 v[216:231], a[20:23], v[244:247], v[216:231]
  s_mov_b32 s14, 0x4800
  buffer_load_dwordx4 v[80:83], v181, s[72:75], s14 offen
  buffer_load_dwordx4 v[84:87], v181, s[72:75], s14 offen offset:32
  v_cvt_pk_bf16_f32 v52, v56, v57
  v_cvt_pk_bf16_f32 v53, v58, v59
  v_cvt_pk_bf16_f32 v54, v60, v61
  v_cvt_pk_bf16_f32 v55, v62, v63
  v_mfma_f32_32x32x16_bf16 v[216:231], a[248:251], a[34:37], v[216:231]
  ds_write_b128 v140, v[48:51]
  ds_write_b128 v140, v[52:55] offset:1024
  s_waitcnt lgkmcnt(7)
  v_mfma_f32_32x32x16_bf16 v[144:159], a[24:27], v[240:243], 0
  v_cvt_pk_bf16_f32 v160, v160, v161
  v_cvt_pk_bf16_f32 v161, v162, v163
  v_cvt_pk_bf16_f32 v162, v164, v165
  v_cvt_pk_bf16_f32 v163, v166, v167
  s_waitcnt lgkmcnt(6)
  v_mfma_f32_32x32x16_bf16 v[144:159], a[28:31], v[244:247], v[144:159]
  s_mov_b32 s14, 0x6000
  buffer_load_dwordx4 v[88:91], v181, s[72:75], s14 offen
  buffer_load_dwordx4 v[92:95], v181, s[72:75], s14 offen offset:32
  v_cvt_pk_bf16_f32 v164, v168, v169
  v_cvt_pk_bf16_f32 v165, v170, v171
  v_cvt_pk_bf16_f32 v166, v172, v173
  v_cvt_pk_bf16_f32 v167, v174, v175
  v_mfma_f32_32x32x16_bf16 v[144:159], a[252:255], a[34:37], v[144:159]
  ds_write_b128 v140, v[160:163] offset:2048
  ds_write_b128 v140, v[164:167] offset:3072
  s_waitcnt lgkmcnt(7)
  v_mfma_f32_32x32x16_bf16 v[48:63], a[0:3], v[240:243], 0
  s_waitcnt vmcnt(27)
  ds_read_b128 a[16:19], v136 offset:36864
  ds_read_b128 a[20:23], v137 offset:36864
  ds_read_b128 a[24:27], v138 offset:36864
  ds_read_b128 a[28:31], v139 offset:36864
  v_cvt_pk_bf16_f32 v216, v216, v217
  v_cvt_pk_bf16_f32 v217, v218, v219
  v_cvt_pk_bf16_f32 v218, v220, v221
  v_cvt_pk_bf16_f32 v219, v222, v223
  s_nop 0
  s_waitcnt lgkmcnt(10)
  v_mfma_f32_32x32x16_bf16 v[48:63], a[4:7], v[244:247], v[48:63]
  s_mov_b32 s14, 0x7800
  buffer_load_dwordx4 v[96:99], v181, s[72:75], s14 offen
  buffer_load_dwordx4 v[100:103], v181, s[72:75], s14 offen offset:32
  v_cvt_pk_bf16_f32 v220, v224, v225
  v_cvt_pk_bf16_f32 v221, v226, v227
  v_cvt_pk_bf16_f32 v222, v228, v229
  v_cvt_pk_bf16_f32 v223, v230, v231
  v_mfma_f32_32x32x16_bf16 v[48:63], a[248:251], a[36:39], v[48:63]
  ds_write_b128 v140, v[216:219] offset:12288
  ds_write_b128 v140, v[220:223] offset:13312
  s_waitcnt lgkmcnt(11)
  v_mfma_f32_32x32x16_bf16 v[160:175], a[8:11], v[240:243], 0
  v_cvt_pk_bf16_f32 v144, v144, v145
  v_cvt_pk_bf16_f32 v145, v146, v147
  v_cvt_pk_bf16_f32 v146, v148, v149
  v_cvt_pk_bf16_f32 v147, v150, v151
  s_waitcnt lgkmcnt(10)
  v_mfma_f32_32x32x16_bf16 v[160:175], a[12:15], v[244:247], v[160:175]
  s_mov_b32 s14, 0x9000
  buffer_load_dwordx4 v[104:107], v181, s[72:75], s14 offen
  buffer_load_dwordx4 v[108:111], v181, s[72:75], s14 offen offset:32
  v_cvt_pk_bf16_f32 v148, v152, v153
  v_cvt_pk_bf16_f32 v149, v154, v155
  v_cvt_pk_bf16_f32 v150, v156, v157
  v_cvt_pk_bf16_f32 v151, v158, v159
  v_mfma_f32_32x32x16_bf16 v[160:175], a[252:255], a[36:39], v[160:175]
  ds_write_b128 v140, v[144:147] offset:14336
  ds_write_b128 v140, v[148:151] offset:15360
  s_waitcnt lgkmcnt(7)
  v_mfma_f32_32x32x16_bf16 v[216:231], a[16:19], v[240:243], 0
  s_waitcnt vmcnt(25)
  ds_read_b128 a[0:3], v136 offset:49152
  ds_read_b128 a[4:7], v137 offset:49152
  ds_read_b128 a[8:11], v138 offset:49152
  ds_read_b128 a[12:15], v139 offset:49152
  v_cvt_pk_bf16_f32 v48, v48, v49
  v_cvt_pk_bf16_f32 v49, v50, v51
  v_cvt_pk_bf16_f32 v50, v52, v53
  v_cvt_pk_bf16_f32 v51, v54, v55
  s_nop 0
  s_waitcnt lgkmcnt(10)
  v_mfma_f32_32x32x16_bf16 v[216:231], a[20:23], v[244:247], v[216:231]
  s_mov_b32 s14, 0xa800
  buffer_load_dwordx4 v[192:195], v181, s[72:75], s14 offen
  buffer_load_dwordx4 v[196:199], v181, s[72:75], s14 offen offset:32
  v_cvt_pk_bf16_f32 v52, v56, v57
  v_cvt_pk_bf16_f32 v53, v58, v59
  v_cvt_pk_bf16_f32 v54, v60, v61
  v_cvt_pk_bf16_f32 v55, v62, v63
  v_mfma_f32_32x32x16_bf16 v[216:231], a[248:251], a[38:41], v[216:231]
  ds_write_b128 v140, v[48:51] offset:24576
  ds_write_b128 v140, v[52:55] offset:25600
  s_waitcnt lgkmcnt(11)
  v_mfma_f32_32x32x16_bf16 v[144:159], a[24:27], v[240:243], 0
  v_cvt_pk_bf16_f32 v160, v160, v161
  v_cvt_pk_bf16_f32 v161, v162, v163
  v_cvt_pk_bf16_f32 v162, v164, v165
  v_cvt_pk_bf16_f32 v163, v166, v167
  s_waitcnt lgkmcnt(10)
  v_mfma_f32_32x32x16_bf16 v[144:159], a[28:31], v[244:247], v[144:159]
  s_mov_b32 s14, 0xc000
  buffer_load_dwordx4 v[200:203], v181, s[72:75], s14 offen
  buffer_load_dwordx4 v[204:207], v181, s[72:75], s14 offen offset:32
  v_cvt_pk_bf16_f32 v164, v168, v169
  v_cvt_pk_bf16_f32 v165, v170, v171
  v_cvt_pk_bf16_f32 v166, v172, v173
  v_cvt_pk_bf16_f32 v167, v174, v175
  v_mfma_f32_32x32x16_bf16 v[144:159], a[252:255], a[38:41], v[144:159]
  ds_write_b128 v140, v[160:163] offset:26624
  ds_write_b128 v140, v[164:167] offset:27648
  s_waitcnt lgkmcnt(7)
  v_mfma_f32_32x32x16_bf16 v[48:63], a[0:3], v[240:243], 0
  s_waitcnt vmcnt(23)
  ds_read_b128 a[16:19], v136 offset:61440
  ds_read_b128 a[20:23], v137 offset:61440
  ds_read_b128 a[24:27], v138 offset:61440
  ds_read_b128 a[28:31], v139 offset:61440
  v_cvt_pk_bf16_f32 v216, v216, v217
  v_cvt_pk_bf16_f32 v217, v218, v219
  v_cvt_pk_bf16_f32 v218, v220, v221
  v_cvt_pk_bf16_f32 v219, v222, v223
  s_nop 0
  s_waitcnt lgkmcnt(10)
  v_mfma_f32_32x32x16_bf16 v[48:63], a[4:7], v[244:247], v[48:63]
  s_mov_b32 s14, 0xd800
  buffer_load_dwordx4 v[16:19], v181, s[72:75], s14 offen
  buffer_load_dwordx4 v[20:23], v181, s[72:75], s14 offen offset:32
  v_cvt_pk_bf16_f32 v220, v224, v225
  v_cvt_pk_bf16_f32 v221, v226, v227
  v_cvt_pk_bf16_f32 v222, v228, v229
  v_cvt_pk_bf16_f32 v223, v230, v231
  v_mfma_f32_32x32x16_bf16 v[48:63], a[248:251], a[40:43], v[48:63]
  ds_write_b128 v140, v[216:219] offset:36864
  ds_write_b128 v140, v[220:223] offset:37888
  s_waitcnt lgkmcnt(11)
  v_mfma_f32_32x32x16_bf16 v[160:175], a[8:11], v[240:243], 0
  v_cvt_pk_bf16_f32 v144, v144, v145
  v_cvt_pk_bf16_f32 v145, v146, v147
  v_cvt_pk_bf16_f32 v146, v148, v149
  v_cvt_pk_bf16_f32 v147, v150, v151
  s_waitcnt lgkmcnt(10)
  v_mfma_f32_32x32x16_bf16 v[160:175], a[12:15], v[244:247], v[160:175]
  s_mov_b32 s14, 0xf000
  buffer_load_dwordx4 v[24:27], v181, s[72:75], s14 offen
  buffer_load_dwordx4 v[28:31], v181, s[72:75], s14 offen offset:32
  v_cvt_pk_bf16_f32 v148, v152, v153
  v_cvt_pk_bf16_f32 v149, v154, v155
  v_cvt_pk_bf16_f32 v150, v156, v157
  v_cvt_pk_bf16_f32 v151, v158, v159
  v_mfma_f32_32x32x16_bf16 v[160:175], a[252:255], a[40:43], v[160:175]
  ds_write_b128 v140, v[144:147] offset:38912
  ds_write_b128 v140, v[148:151] offset:39936
  s_waitcnt lgkmcnt(7)
  v_mfma_f32_32x32x16_bf16 v[216:231], a[16:19], v[240:243], 0
  v_cvt_pk_bf16_f32 v48, v48, v49
  v_cvt_pk_bf16_f32 v49, v50, v51
  v_cvt_pk_bf16_f32 v50, v52, v53
  v_cvt_pk_bf16_f32 v51, v54, v55
  s_waitcnt lgkmcnt(6)
  v_mfma_f32_32x32x16_bf16 v[216:231], a[20:23], v[244:247], v[216:231]
  v_cvt_pk_bf16_f32 v52, v56, v57
  v_cvt_pk_bf16_f32 v53, v58, v59
  v_cvt_pk_bf16_f32 v54, v60, v61
  v_cvt_pk_bf16_f32 v55, v62, v63
  v_mfma_f32_32x32x16_bf16 v[216:231], a[248:251], a[42:45], v[216:231]
  ds_write_b128 v140, v[48:51] offset:49152
  ds_write_b128 v140, v[52:55] offset:50176
  s_waitcnt lgkmcnt(7)
  v_mfma_f32_32x32x16_bf16 v[144:159], a[24:27], v[240:243], 0
  v_cvt_pk_bf16_f32 v160, v160, v161
  v_cvt_pk_bf16_f32 v161, v162, v163
  v_cvt_pk_bf16_f32 v162, v164, v165
  v_cvt_pk_bf16_f32 v163, v166, v167
  s_waitcnt lgkmcnt(6)
  v_mfma_f32_32x32x16_bf16 v[144:159], a[28:31], v[244:247], v[144:159]
  v_cvt_pk_bf16_f32 v164, v168, v169
  v_cvt_pk_bf16_f32 v165, v170, v171
  v_cvt_pk_bf16_f32 v166, v172, v173
  v_cvt_pk_bf16_f32 v167, v174, v175
  v_mfma_f32_32x32x16_bf16 v[144:159], a[252:255], a[42:45], v[144:159]
  ds_write_b128 v140, v[160:163] offset:51200
  ds_write_b128 v140, v[164:167] offset:52224
  v_cvt_pk_bf16_f32 v216, v216, v217
  v_cvt_pk_bf16_f32 v217, v218, v219
  v_cvt_pk_bf16_f32 v218, v220, v221
  v_cvt_pk_bf16_f32 v219, v222, v223
  v_cvt_pk_bf16_f32 v220, v224, v225
  v_cvt_pk_bf16_f32 v221, v226, v227
  v_cvt_pk_bf16_f32 v222, v228, v229
  v_cvt_pk_bf16_f32 v223, v230, v231
  ds_write_b128 v140, v[216:219] offset:61440
  ds_write_b128 v140, v[220:223] offset:62464
  v_cvt_pk_bf16_f32 v144, v144, v145
  v_cvt_pk_bf16_f32 v145, v146, v147
  v_cvt_pk_bf16_f32 v146, v148, v149
  v_cvt_pk_bf16_f32 v147, v150, v151
  v_cvt_pk_bf16_f32 v148, v152, v153
  v_cvt_pk_bf16_f32 v149, v154, v155
  v_cvt_pk_bf16_f32 v150, v156, v157
  v_cvt_pk_bf16_f32 v151, v158, v159
  ds_write_b128 v140, v[144:147] offset:63488
  ds_write_b128 v140, v[148:151] offset:64512
  v_mov_b32 v135, 0xffff
  v_lshlrev_b32_e64 v135, v130, v135
  v_bfe_u32 v133, v113, 1, 2
  v_lshlrev_b32 v133, v133, 1
  v_bfe_i32 v48, v133, 0, 1
  v_mov_b32 v52, 0
  v_and_b32 v48, v48, v135
  v_bfe_i32 v49, v133, 1, 1
  v_mov_b32 v53, 0
  v_and_b32 v49, v49, v135
  v_bfe_i32 v50, v133, 2, 1
  v_mov_b32 v54, 0
  v_and_b32 v50, v50, v135
  v_bfe_i32 v51, v133, 3, 1
  v_mov_b32 v55, 0
  v_and_b32 v51, v51, v135
  v_min_u32_e64 v133, 35, v113
  v_mul_u32_u24 v133, 0x190, v133
  ds_write_b128 v133, v[52:55] offset:50304
  s_lshl_b32 s32, s27, 7
  v_lshrrev_b32 v133, 3, v113
  v_mul_u32_u24 v133, 0x190, v133
  v_lshl_add_u32 v133, v114, 4, v133
  v_add_u32 v133, s32, v133
  v_lshrrev_b32 v134, 3, v132
  v_mul_u32_u24 v134, 0x190, v134
  v_lshl_add_u32 v134, v114, 4, v134
  v_add_u32 v134, s32, v134
  s_waitcnt vmcnt(26)
  v_lshl_or_b32 v142, v142, 16, v142
  v_and_b32 v160, v48, v142
  v_and_b32 v161, v49, v142
  v_and_b32 v162, v50, v142
  v_and_b32 v163, v51, v142
  ds_write_b128 v133, v[160:163] offset:49920
  s_waitcnt vmcnt(25)
  v_lshl_or_b32 v143, v143, 16, v143
  v_and_b32 v164, v48, v143
  v_and_b32 v165, v49, v143
  v_and_b32 v166, v50, v143
  v_and_b32 v167, v51, v143
  ds_write_b128 v133, v[164:167] offset:53120
  s_waitcnt vmcnt(24)
  v_lshl_or_b32 v176, v176, 16, v176
  v_and_b32 v168, v48, v176
  v_and_b32 v169, v49, v176
  v_and_b32 v170, v50, v176
  v_and_b32 v171, v51, v176
  ds_write_b128 v133, v[168:171] offset:56320
  s_waitcnt vmcnt(23)
  v_lshl_or_b32 v177, v177, 16, v177
  v_and_b32 v172, v48, v177
  v_and_b32 v173, v49, v177
  v_and_b32 v174, v50, v177
  v_and_b32 v175, v51, v177
  ds_write_b128 v133, v[172:175] offset:59520
  s_waitcnt vmcnt(22)
  v_lshl_or_b32 v178, v178, 16, v178
  v_and_b32 v160, v48, v178
  v_and_b32 v161, v49, v178
  v_and_b32 v162, v50, v178
  v_and_b32 v163, v51, v178
  ds_write_b128 v134, v[160:163] offset:62720
  s_waitcnt vmcnt(21)
  v_lshlrev_b32 v135, 16, v179
  s_waitcnt vmcnt(20)
  v_lshlrev_b32 v180, 16, v180
  v_mul_f32_e64 v180, v135, v180
  v_lshl_add_u32 v135, v132, 2, s32
  v_lshlrev_b32_e64 v179, v130, v179
  ds_write_b32 v135, v180 offset:64320
  v_and_b32 v40, v40, v179
  v_and_b32 v41, v41, v179
  v_and_b32 v42, v42, v179
  v_and_b32 v43, v43, v179
  v_and_b32 v44, v44, v179
  v_and_b32 v45, v45, v179
  v_and_b32 v46, v46, v179
  v_and_b32 v47, v47, v179
  v_accvgpr_write_b32 a240, v40
  v_accvgpr_write_b32 a241, v41
  v_accvgpr_write_b32 a242, v42
  v_accvgpr_write_b32 a243, v43
  v_accvgpr_write_b32 a244, v44
  v_accvgpr_write_b32 a245, v45
  v_accvgpr_write_b32 a246, v46
  v_accvgpr_write_b32 a247, v47
  s_mov_b32 s14, 0x10800
  buffer_load_dwordx4 v[32:35], v181, s[72:75], s14 offen
  buffer_load_dwordx4 v[36:39], v181, s[72:75], s14 offen offset:32
  s_mov_b32 s14, 0
  buffer_load_dwordx4 v[40:43], v181, s[72:75], s14 offen
  buffer_load_dwordx4 v[44:47], v181, s[72:75], s14 offen offset:32
  s_lshl_b32 s32, s27, 10
  v_add_u32_e64 v133, s32, v0
  v_add_u32 v134, s32, v1
  s_waitcnt lgkmcnt(0)
  s_barrier
  s_waitcnt vmcnt(23)
  v_mfma_f32_32x32x16_bf16 v[48:63], v[64:67], a[240:243], 0
  ds_read_b128 a[0:3], v0 offset:12288
  ds_read_b128 a[4:7], v0 offset:13312
  ds_read_b128 a[8:11], v0 offset:16384
  s_waitcnt vmcnt(22)
  v_mfma_f32_32x32x16_bf16 v[48:63], v[68:71], a[244:247], v[48:63]
  ds_read_b128 a[12:15], v0 offset:17408
  ds_read_b128 a[16:19], v0 offset:20480
  s_waitcnt vmcnt(21)
  v_mfma_f32_32x32x16_bf16 v[160:175], v[72:75], a[240:243], 0
  ds_read_b128 a[20:23], v0 offset:21504
  ds_read_b128 a[24:27], v0 offset:14336
  ds_read_b128 a[28:31], v0 offset:15360
  s_waitcnt vmcnt(20)
  v_mfma_f32_32x32x16_bf16 v[160:175], v[76:79], a[244:247], v[160:175]
  ds_read_b128 a[32:35], v0 offset:18432
  ds_read_b128 a[36:39], v0 offset:19456
  s_waitcnt vmcnt(19)
  v_mfma_f32_32x32x16_bf16 v[216:231], v[80:83], a[240:243], 0
  ds_read_b128 a[40:43], v0 offset:22528
  ds_read_b128 a[44:47], v0 offset:23552
  ds_read_b128 a[48:51], v0 offset:24576
  v_cvt_pk_bf16_f32 v64, v48, v49
  v_cvt_pk_bf16_f32 v65, v50, v51
  v_cvt_pk_bf16_f32 v66, v52, v53
  v_cvt_pk_bf16_f32 v67, v54, v55
  s_waitcnt vmcnt(18)
  v_mfma_f32_32x32x16_bf16 v[216:231], v[84:87], a[244:247], v[216:231]
  ds_read_b128 a[52:55], v0 offset:25600
  ds_read_b128 a[56:59], v0 offset:28672
  v_cvt_pk_bf16_f32 v68, v56, v57
  v_cvt_pk_bf16_f32 v69, v58, v59
  v_cvt_pk_bf16_f32 v70, v60, v61
  v_cvt_pk_bf16_f32 v71, v62, v63
  s_waitcnt vmcnt(17)
  v_mfma_f32_32x32x16_bf16 v[144:159], v[88:91], a[240:243], 0
  ds_read_b128 a[60:63], v0 offset:29696
  ds_read_b128 a[64:67], v0 offset:32768
  ds_read_b128 a[68:71], v0 offset:33792
  v_cvt_pk_bf16_f32 v72, v160, v161
  v_cvt_pk_bf16_f32 v73, v162, v163
  v_cvt_pk_bf16_f32 v74, v164, v165
  v_cvt_pk_bf16_f32 v75, v166, v167
  s_nop 0
  s_waitcnt vmcnt(16)
  v_mfma_f32_32x32x16_bf16 v[144:159], v[92:95], a[244:247], v[144:159]
  ds_read_b128 a[72:75], v0 offset:26624
  ds_read_b128 a[76:79], v0 offset:27648
  v_cvt_pk_bf16_f32 v76, v168, v169
  v_cvt_pk_bf16_f32 v77, v170, v171
  v_cvt_pk_bf16_f32 v78, v172, v173
  v_cvt_pk_bf16_f32 v79, v174, v175
  ds_write_b128 v134, v[64:67] offset:8192
  ds_write_b128 v134, v[68:71] offset:11264
  s_nop 0
  s_waitcnt vmcnt(15)
  v_mfma_f32_32x32x16_bf16 v[48:63], v[96:99], a[240:243], 0
  ds_read_b128 a[80:83], v0 offset:30720
  ds_read_b128 a[84:87], v0 offset:31744
  ds_read_b128 a[88:91], v0 offset:34816
  v_cvt_pk_bf16_f32 v80, v216, v217
  v_cvt_pk_bf16_f32 v81, v218, v219
  v_cvt_pk_bf16_f32 v82, v220, v221
  v_cvt_pk_bf16_f32 v83, v222, v223
  s_nop 0
  s_waitcnt vmcnt(14)
  v_mfma_f32_32x32x16_bf16 v[48:63], v[100:103], a[244:247], v[48:63]
  ds_read_b128 a[92:95], v0 offset:35840
  ds_read_b128 a[96:99], v0 offset:36864
  v_cvt_pk_bf16_f32 v84, v224, v225
  v_cvt_pk_bf16_f32 v85, v226, v227
  v_cvt_pk_bf16_f32 v86, v228, v229
  v_cvt_pk_bf16_f32 v87, v230, v231
  ds_write_b128 v134, v[72:75] offset:14336
  ds_write_b128 v134, v[76:79] offset:17408
  s_nop 0
  s_waitcnt vmcnt(13)
  v_mfma_f32_32x32x16_bf16 v[160:175], v[104:107], a[240:243], 0
  ds_read_b128 a[100:103], v0 offset:37888
  ds_read_b128 a[104:107], v0 offset:40960
  ds_read_b128 a[108:111], v0 offset:41984
  v_cvt_pk_bf16_f32 v88, v144, v145
  v_cvt_pk_bf16_f32 v89, v146, v147
  v_cvt_pk_bf16_f32 v90, v148, v149
  v_cvt_pk_bf16_f32 v91, v150, v151
  s_nop 0
  s_waitcnt vmcnt(12)
  v_mfma_f32_32x32x16_bf16 v[160:175], v[108:111], a[244:247], v[160:175]
  ds_read_b128 a[112:115], v0 offset:45056
  ds_read_b128 a[116:119], v0 offset:46080
  v_cvt_pk_bf16_f32 v92, v152, v153
  v_cvt_pk_bf16_f32 v93, v154, v155
  v_cvt_pk_bf16_f32 v94, v156, v157
  v_cvt_pk_bf16_f32 v95, v158, v159
  ds_write_b128 v134, v[80:83] offset:20480
  ds_write_b128 v134, v[84:87] offset:23552
  s_nop 0
  s_waitcnt vmcnt(11)
  v_mfma_f32_32x32x16_bf16 v[216:231], v[192:195], a[240:243], 0
  ds_read_b128 a[120:123], v0 offset:38912
  ds_read_b128 a[124:127], v0 offset:39936
  ds_read_b128 a[128:131], v0 offset:43008
  v_cvt_pk_bf16_f32 v96, v48, v49
  v_cvt_pk_bf16_f32 v97, v50, v51
  v_cvt_pk_bf16_f32 v98, v52, v53
  v_cvt_pk_bf16_f32 v99, v54, v55
  s_nop 0
  s_waitcnt vmcnt(10)
  v_mfma_f32_32x32x16_bf16 v[216:231], v[196:199], a[244:247], v[216:231]
  ds_read_b128 a[132:135], v0 offset:44032
  ds_read_b128 a[136:139], v0 offset:47104
  v_cvt_pk_bf16_f32 v100, v56, v57
  v_cvt_pk_bf16_f32 v101, v58, v59
  v_cvt_pk_bf16_f32 v102, v60, v61
  v_cvt_pk_bf16_f32 v103, v62, v63
  ds_write_b128 v134, v[88:91] offset:26624
  ds_write_b128 v134, v[92:95] offset:29696
  s_nop 0
  s_waitcnt vmcnt(9)
  v_mfma_f32_32x32x16_bf16 v[144:159], v[200:203], a[240:243], 0
  ds_read_b128 a[140:143], v0 offset:48128
  ds_read_b128 a[144:147], v0 offset:49152
  ds_read_b128 a[148:151], v0 offset:50176
  v_cvt_pk_bf16_f32 v104, v160, v161
  v_cvt_pk_bf16_f32 v105, v162, v163
  v_cvt_pk_bf16_f32 v106, v164, v165
  v_cvt_pk_bf16_f32 v107, v166, v167
  s_waitcnt vmcnt(8)
  v_mfma_f32_32x32x16_bf16 v[144:159], v[204:207], a[244:247], v[144:159]
  ds_read_b128 a[152:155], v0 offset:53248
  ds_read_b128 a[156:159], v0 offset:54272
  v_cvt_pk_bf16_f32 v108, v168, v169
  v_cvt_pk_bf16_f32 v109, v170, v171
  v_cvt_pk_bf16_f32 v110, v172, v173
  v_cvt_pk_bf16_f32 v111, v174, v175
  s_waitcnt vmcnt(7)
  v_mfma_f32_32x32x16_bf16 v[48:63], v[16:19], a[240:243], 0
  ds_read_b128 a[160:163], v0 offset:57344
  ds_read_b128 a[164:167], v0 offset:58368
  ds_read_b128 a[168:171], v0 offset:51200
  v_cvt_pk_bf16_f32 v192, v216, v217
  v_cvt_pk_bf16_f32 v193, v218, v219
  v_cvt_pk_bf16_f32 v194, v220, v221
  v_cvt_pk_bf16_f32 v195, v222, v223
  s_waitcnt vmcnt(6)
  v_mfma_f32_32x32x16_bf16 v[48:63], v[20:23], a[244:247], v[48:63]
  ds_read_b128 a[172:175], v0 offset:52224
  ds_read_b128 a[176:179], v0 offset:55296
  v_cvt_pk_bf16_f32 v196, v224, v225
  v_cvt_pk_bf16_f32 v197, v226, v227
  v_cvt_pk_bf16_f32 v198, v228, v229
  v_cvt_pk_bf16_f32 v199, v230, v231
  s_waitcnt vmcnt(5)
  v_mfma_f32_32x32x16_bf16 v[160:175], v[24:27], a[240:243], 0
  ds_read_b128 a[180:183], v0 offset:56320
  ds_read_b128 a[184:187], v0 offset:59392
  ds_read_b128 a[188:191], v0 offset:60416
  v_cvt_pk_bf16_f32 v200, v144, v145
  v_cvt_pk_bf16_f32 v201, v146, v147
  v_cvt_pk_bf16_f32 v202, v148, v149
  v_cvt_pk_bf16_f32 v203, v150, v151
  s_waitcnt vmcnt(4)
  v_mfma_f32_32x32x16_bf16 v[160:175], v[28:31], a[244:247], v[160:175]
  ds_read_b128 a[192:195], v0 offset:61440
  ds_read_b128 a[196:199], v0 offset:62464
  v_cvt_pk_bf16_f32 v204, v152, v153
  v_cvt_pk_bf16_f32 v205, v154, v155
  v_cvt_pk_bf16_f32 v206, v156, v157
  v_cvt_pk_bf16_f32 v207, v158, v159
  s_waitcnt vmcnt(3)
  v_mfma_f32_32x32x16_bf16 v[216:231], v[32:35], a[240:243], 0
  ds_read_b128 a[200:203], v1
  ds_read_b128 a[204:207], v1 offset:1024
  ds_read_b128 a[208:211], v1 offset:4096
  v_cvt_pk_bf16_f32 v16, v48, v49
  v_cvt_pk_bf16_f32 v17, v50, v51
  v_cvt_pk_bf16_f32 v18, v52, v53
  v_cvt_pk_bf16_f32 v19, v54, v55
  s_waitcnt vmcnt(2)
  v_mfma_f32_32x32x16_bf16 v[216:231], v[36:39], a[244:247], v[216:231]
  ds_read_b128 a[212:215], v1 offset:5120
  ds_read_b128 a[216:219], v0 offset:63488
  v_cvt_pk_bf16_f32 v20, v56, v57
  v_cvt_pk_bf16_f32 v21, v58, v59
  v_cvt_pk_bf16_f32 v22, v60, v61
  v_cvt_pk_bf16_f32 v23, v62, v63
  s_waitcnt vmcnt(1)
  v_mfma_f32_32x32x16_bf16 v[144:159], v[40:43], a[240:243], 0
  ds_read_b128 a[220:223], v0 offset:64512
  ds_read_b128 a[224:227], v1 offset:2048
  ds_read_b128 a[228:231], v1 offset:3072
  v_cvt_pk_bf16_f32 v24, v160, v161
  v_cvt_pk_bf16_f32 v25, v162, v163
  v_cvt_pk_bf16_f32 v26, v164, v165
  v_cvt_pk_bf16_f32 v27, v166, v167
  s_nop 0
  s_waitcnt vmcnt(0)
  v_mfma_f32_32x32x16_bf16 v[144:159], v[44:47], a[244:247], v[144:159]
  ds_read_b128 a[232:235], v1 offset:6144
  ds_read_b128 a[236:239], v1 offset:7168
  v_cvt_pk_bf16_f32 v28, v168, v169
  v_cvt_pk_bf16_f32 v29, v170, v171
  v_cvt_pk_bf16_f32 v30, v172, v173
  v_cvt_pk_bf16_f32 v31, v174, v175
  v_cvt_pk_bf16_f32 v32, v216, v217
  v_cvt_pk_bf16_f32 v33, v218, v219
  v_cvt_pk_bf16_f32 v34, v220, v221
  v_cvt_pk_bf16_f32 v35, v222, v223
  v_cvt_pk_bf16_f32 v36, v224, v225
  v_cvt_pk_bf16_f32 v37, v226, v227
  v_cvt_pk_bf16_f32 v38, v228, v229
  v_cvt_pk_bf16_f32 v39, v230, v231
  v_cvt_pk_bf16_f32 v40, v144, v145
  v_cvt_pk_bf16_f32 v41, v146, v147
  v_cvt_pk_bf16_f32 v42, v148, v149
  v_cvt_pk_bf16_f32 v43, v150, v151
  v_cvt_pk_bf16_f32 v44, v152, v153
  v_cvt_pk_bf16_f32 v45, v154, v155
  v_cvt_pk_bf16_f32 v46, v156, v157
  v_cvt_pk_bf16_f32 v47, v158, v159
  s_waitcnt lgkmcnt(0)
  s_barrier
  ds_write_b128 v133, v[96:99] offset:24576
  ds_write_b128 v133, v[100:103] offset:27648
  ds_write_b128 v133, v[104:107] offset:30720
  ds_write_b128 v133, v[108:111] offset:33792
  ds_write_b128 v133, v[192:195] offset:36864
  ds_write_b128 v133, v[196:199] offset:39936
  ds_write_b128 v133, v[200:203] offset:43008
  ds_write_b128 v133, v[204:207] offset:46080
  ds_write_b128 v133, v[16:19] offset:49152
  ds_write_b128 v133, v[20:23] offset:52224
  ds_write_b128 v133, v[24:27] offset:55296
  ds_write_b128 v133, v[28:31] offset:58368
  ds_write_b128 v133, v[32:35] offset:61440
  ds_write_b128 v133, v[36:39] offset:64512
  ds_write_b128 v134, v[40:43] offset:2048
  ds_write_b128 v134, v[44:47] offset:5120
  ds_read_b128 a[240:243], v3 offset:2400
  ds_read_b128 a[244:247], v3 offset:7200
  ds_read_b128 a[248:251], v3 offset:12000
  ds_read_b128 a[252:255], v3 offset:3200
  s_waitcnt lgkmcnt(0)
L_join:
  s_barrier
  ds_read_b128 v[216:219], v3
  ds_read_b128 v[220:223], v4
  ds_read_b128 v[224:227], v3 offset:4800
  ds_read_b128 v[228:231], v4 offset:192
  ds_read_b128 v[232:235], v3 offset:9600
  ds_read_b128 v[236:239], v4 offset:384
  ds_read_b128 v[160:163], v3 offset:400
  ds_read_b128 v[164:167], v4 offset:16
  ds_read_b128 v[168:171], v3 offset:5200
  ds_read_b128 v[172:175], v4 offset:208
  ds_read_b128 v[176:179], v3 offset:10000
  ds_read_b128 v[180:183], v4 offset:400
  buffer_load_dword v249, v248, s[4:7], s29 offen
  s_waitcnt lgkmcnt(10)
  v_mfma_f32_16x16x32_bf16 v[112:115], v[216:219], v[220:223], 0
  ds_read_b128 v[216:219], v3 offset:800
  ds_read_b128 v[220:223], v4 offset:32
  s_waitcnt lgkmcnt(10)
  v_mfma_f32_16x16x32_bf16 v[112:115], v[224:227], v[228:231], v[112:115]
  ds_read_b128 v[224:227], v3 offset:5600
  ds_read_b128 v[228:231], v4 offset:224
  s_waitcnt lgkmcnt(10)
  v_mfma_f32_16x16x32_bf16 v[112:115], v[232:235], v[236:239], v[112:115]
  s_waitcnt lgkmcnt(8)
  ds_read_b128 v[232:235], v3 offset:10400
  ds_read_b128 v[236:239], v4 offset:416
  v_mfma_f32_16x16x32_bf16 v[116:119], v[160:163], v[164:167], 0
  ds_read_b128 v[160:163], v3 offset:1200
  ds_read_b128 v[164:167], v4 offset:48
  s_waitcnt lgkmcnt(10)
  v_mfma_f32_16x16x32_bf16 v[116:119], v[168:171], v[172:175], v[116:119]
  ds_read_b128 v[168:171], v3 offset:6000
  ds_read_b128 v[172:175], v4 offset:240
  s_waitcnt lgkmcnt(10)
  v_mfma_f32_16x16x32_bf16 v[116:119], v[176:179], v[180:183], v[116:119]
  s_waitcnt lgkmcnt(8)
  ds_read_b128 v[176:179], v3 offset:10800
  ds_read_b128 v[180:183], v4 offset:432
  v_mfma_f32_16x16x32_bf16 v[120:123], v[216:219], v[220:223], 0
  ds_read_b128 v[216:219], v3 offset:1600
  ds_read_b128 v[220:223], v4 offset:64
  s_waitcnt lgkmcnt(10)
  v_mfma_f32_16x16x32_bf16 v[120:123], v[224:227], v[228:231], v[120:123]
  ds_read_b128 v[224:227], v3 offset:6400
  ds_read_b128 v[228:231], v4 offset:256
  s_waitcnt lgkmcnt(10)
  v_mfma_f32_16x16x32_bf16 v[120:123], v[232:235], v[236:239], v[120:123]
  s_waitcnt lgkmcnt(8)
  ds_read_b128 v[232:235], v3 offset:11200
  ds_read_b128 v[236:239], v4 offset:448
  v_mfma_f32_16x16x32_bf16 v[124:127], v[160:163], v[164:167], 0
  ds_read_b128 v[160:163], v3 offset:2000
  ds_read_b128 v[164:167], v4 offset:80
  s_waitcnt lgkmcnt(10)
  v_mfma_f32_16x16x32_bf16 v[124:127], v[168:171], v[172:175], v[124:127]
  ds_read_b128 v[168:171], v3 offset:6800
  ds_read_b128 v[172:175], v4 offset:272
  s_waitcnt lgkmcnt(10)
  v_mfma_f32_16x16x32_bf16 v[124:127], v[176:179], v[180:183], v[124:127]
  s_waitcnt lgkmcnt(8)
  ds_read_b128 v[176:179], v3 offset:11600
  ds_read_b128 v[180:183], v4 offset:464
  v_mfma_f32_16x16x32_bf16 v[128:131], v[216:219], v[220:223], 0
  ds_read_b128 v[216:219], v3 offset:2400
  ds_read_b128 v[220:223], v4 offset:96
  s_waitcnt lgkmcnt(10)
  v_mfma_f32_16x16x32_bf16 v[128:131], v[224:227], v[228:231], v[128:131]
  ds_read_b128 v[224:227], v3 offset:7200
  ds_read_b128 v[228:231], v4 offset:288
  s_waitcnt lgkmcnt(10)
  v_mfma_f32_16x16x32_bf16 v[128:131], v[232:235], v[236:239], v[128:131]
  s_waitcnt lgkmcnt(8)
  ds_read_b128 v[232:235], v3 offset:12000
  ds_read_b128 v[236:239], v4 offset:480
  v_mfma_f32_16x16x32_bf16 v[132:135], v[160:163], v[164:167], 0
  ds_read_b128 v[160:163], v3 offset:2800
  ds_read_b128 v[164:167], v4 offset:112
  s_waitcnt lgkmcnt(10)
  v_mfma_f32_16x16x32_bf16 v[132:135], v[168:171], v[172:175], v[132:135]
  ds_read_b128 v[168:171], v3 offset:7600
  ds_read_b128 v[172:175], v4 offset:304
  s_waitcnt lgkmcnt(10)
  v_mfma_f32_16x16x32_bf16 v[132:135], v[176:179], v[180:183], v[132:135]
  s_waitcnt lgkmcnt(8)
  ds_read_b128 v[176:179], v3 offset:12400
  ds_read_b128 v[180:183], v4 offset:496
  v_mfma_f32_16x16x32_bf16 v[136:139], v[216:219], v[220:223], 0
  ds_read_b128 v[216:219], v3 offset:3200
  ds_read_b128 v[220:223], v4 offset:128
  s_waitcnt lgkmcnt(10)
  v_mfma_f32_16x16x32_bf16 v[136:139], v[224:227], v[228:231], v[136:139]
  ds_read_b128 v[224:227], v3 offset:8000
  ds_read_b128 v[228:231], v4 offset:320
  s_waitcnt lgkmcnt(10)
  v_mfma_f32_16x16x32_bf16 v[136:139], v[232:235], v[236:239], v[136:139]
  s_waitcnt lgkmcnt(8)
  ds_read_b128 v[232:235], v3 offset:12800
  ds_read_b128 v[236:239], v4 offset:512
  v_mfma_f32_16x16x32_bf16 v[140:143], v[160:163], v[164:167], 0
  ds_read_b128 v[160:163], v3 offset:3600
  ds_read_b128 v[164:167], v4 offset:144
  s_waitcnt lgkmcnt(10)
  v_mfma_f32_16x16x32_bf16 v[140:143], v[168:171], v[172:175], v[140:143]
  ds_read_b128 v[168:171], v3 offset:8400
  ds_read_b128 v[172:175], v4 offset:336
  s_waitcnt lgkmcnt(10)
  v_mfma_f32_16x16x32_bf16 v[140:143], v[176:179], v[180:183], v[140:143]
  s_waitcnt lgkmcnt(8)
  ds_read_b128 v[176:179], v3 offset:13200
  ds_read_b128 v[180:183], v4 offset:528
  v_mfma_f32_16x16x32_bf16 v[144:147], v[216:219], v[220:223], 0
  ds_read_b128 v[216:219], v3 offset:4000
  ds_read_b128 v[220:223], v4 offset:160
  s_waitcnt lgkmcnt(10)
  v_mfma_f32_16x16x32_bf16 v[144:147], v[224:227], v[228:231], v[144:147]
  ds_read_b128 v[224:227], v3 offset:8800
  ds_read_b128 v[228:231], v4 offset:352
  s_waitcnt lgkmcnt(10)
  v_mfma_f32_16x16x32_bf16 v[144:147], v[232:235], v[236:239], v[144:147]
  s_waitcnt lgkmcnt(8)
  ds_read_b128 v[232:235], v3 offset:13600
  ds_read_b128 v[236:239], v4 offset:544
  v_mfma_f32_16x16x32_bf16 v[148:151], v[160:163], v[164:167], 0
  ds_read_b128 v[160:163], v3 offset:4400
  ds_read_b128 v[164:167], v4 offset:176
  s_waitcnt lgkmcnt(10)
  v_mfma_f32_16x16x32_bf16 v[148:151], v[168:171], v[172:175], v[148:151]
  ds_read_b128 v[168:171], v3 offset:9200
  ds_read_b128 v[172:175], v4 offset:368
  s_waitcnt lgkmcnt(10)
  v_mfma_f32_16x16x32_bf16 v[148:151], v[176:179], v[180:183], v[148:151]
  s_waitcnt lgkmcnt(8)
  ds_read_b128 v[176:179], v3 offset:14000
  ds_read_b128 v[180:183], v4 offset:560
  v_mfma_f32_16x16x32_bf16 v[152:155], v[216:219], v[220:223], 0
  ds_read_b128 v[216:219], v0 offset:2048
  ds_read_b128 v[220:223], v0 offset:3072
  s_waitcnt lgkmcnt(10)
  v_mfma_f32_16x16x32_bf16 v[152:155], v[224:227], v[228:231], v[152:155]
  ds_read_b128 v[224:227], v0 offset:6144
  ds_read_b128 v[228:231], v0 offset:7168
  s_waitcnt lgkmcnt(10)
  v_mfma_f32_16x16x32_bf16 v[152:155], v[232:235], v[236:239], v[152:155]
  s_waitcnt lgkmcnt(8)
  ds_read_b128 v[232:235], v0 offset:10240
  ds_read_b128 v[236:239], v0 offset:11264
  v_mfma_f32_16x16x32_bf16 v[156:159], v[160:163], v[164:167], 0
  s_waitcnt lgkmcnt(8)
  v_mfma_f32_16x16x32_bf16 v[156:159], v[168:171], v[172:175], v[156:159]
  s_waitcnt lgkmcnt(6)
  v_mfma_f32_16x16x32_bf16 v[156:159], v[176:179], v[180:183], v[156:159]
  v_pk_add_f32 v[12:13], v[112:113], v[114:115]
  v_pk_mul_f32 v[14:15], v[112:113], v[112:113]
  v_pk_fma_f32 v[14:15], v[114:115], v[114:115], v[14:15]
  v_pk_add_f32 v[12:13], v[12:13], v[116:117]
  v_pk_fma_f32 v[14:15], v[116:117], v[116:117], v[14:15]
  v_pk_add_f32 v[12:13], v[12:13], v[118:119]
  v_pk_fma_f32 v[14:15], v[118:119], v[118:119], v[14:15]
  v_pk_add_f32 v[12:13], v[12:13], v[120:121]
  v_pk_fma_f32 v[14:15], v[120:121], v[120:121], v[14:15]
  v_pk_add_f32 v[12:13], v[12:13], v[122:123]
  v_pk_fma_f32 v[14:15], v[122:123], v[122:123], v[14:15]
  v_pk_add_f32 v[12:13], v[12:13], v[124:125]
  v_pk_fma_f32 v[14:15], v[124:125], v[124:125], v[14:15]
  v_pk_add_f32 v[12:13], v[12:13], v[126:127]
  v_pk_fma_f32 v[14:15], v[126:127], v[126:127], v[14:15]
  v_pk_add_f32 v[12:13], v[12:13], v[128:129]
  v_pk_fma_f32 v[14:15], v[128:129], v[128:129], v[14:15]
  v_pk_add_f32 v[12:13], v[12:13], v[130:131]
  v_pk_fma_f32 v[14:15], v[130:131], v[130:131], v[14:15]
  v_pk_add_f32 v[12:13], v[12:13], v[132:133]
  v_pk_fma_f32 v[14:15], v[132:133], v[132:133], v[14:15]
  v_pk_add_f32 v[12:13], v[12:13], v[134:135]
  v_pk_fma_f32 v[14:15], v[134:135], v[134:135], v[14:15]
  v_pk_add_f32 v[12:13], v[12:13], v[136:137]
  v_pk_fma_f32 v[14:15], v[136:137], v[136:137], v[14:15]
  v_pk_add_f32 v[12:13], v[12:13], v[138:139]
  v_pk_fma_f32 v[14:15], v[138:139], v[138:139], v[14:15]
  v_pk_add_f32 v[12:13], v[12:13], v[140:141]
  v_pk_fma_f32 v[14:15], v[140:141], v[140:141], v[14:15]
  v_pk_add_f32 v[12:13], v[12:13], v[142:143]
  v_pk_fma_f32 v[14:15], v[142:143], v[142:143], v[14:15]
  v_pk_add_f32 v[12:13], v[12:13], v[144:145]
  v_pk_fma_f32 v[14:15], v[144:145], v[144:145], v[14:15]
  v_pk_add_f32 v[12:13], v[12:13], v[146:147]
  v_pk_fma_f32 v[14:15], v[146:147], v[146:147], v[14:15]
  v_pk_add_f32 v[12:13], v[12:13], v[148:149]
  v_pk_fma_f32 v[14:15], v[148:149], v[148:149], v[14:15]
  v_pk_add_f32 v[12:13], v[12:13], v[150:151]
  v_pk_fma_f32 v[14:15], v[150:151], v[150:151], v[14:15]
  v_pk_add_f32 v[12:13], v[12:13], v[152:153]
  v_pk_fma_f32 v[14:15], v[152:153], v[152:153], v[14:15]
  v_pk_add_f32 v[12:13], v[12:13], v[154:155]
  v_pk_fma_f32 v[14:15], v[154:155], v[154:155], v[14:15]
  v_pk_add_f32 v[12:13], v[12:13], v[156:157]
  v_pk_fma_f32 v[14:15], v[156:157], v[156:157], v[14:15]
  v_pk_add_f32 v[12:13], v[12:13], v[158:159]
  v_pk_fma_f32 v[14:15], v[158:159], v[158:159], v[14:15]
  v_add_f32 v12, v12, v13
  v_add_f32 v14, v14, v15
  s_nop 1
  v_permlane32_swap_b32 v12, v14
  v_add_f32 v12, v12, v14
  v_mov_b32 v14, v12
  s_nop 1
  v_permlane32_swap_b32 v12, v14
  v_mul_f32 v12, s24, v12
  v_mul_f32 v13, s24, v14
  v_fma_f32 v13, -v12, v12, v13
  v_max_f32 v13, 0, v13
  v_add_f32 v13, s25, v13
  v_rsq_f32 v13, v13
  s_nop 0
  v_mul_f32_e64 v14, s22, v13
  v_mul_f32_e64 v12, -v12, v14
  v_pk_fma_f32 v[112:113], v[112:113], v[14:15], v[12:13] op_sel_hi:[1,0,0]
  v_pk_fma_f32 v[114:115], v[114:115], v[14:15], v[12:13] op_sel_hi:[1,0,0]
  v_pk_fma_f32 v[116:117], v[116:117], v[14:15], v[12:13] op_sel_hi:[1,0,0]
  v_pk_fma_f32 v[118:119], v[118:119], v[14:15], v[12:13] op_sel_hi:[1,0,0]
  v_pk_fma_f32 v[120:121], v[120:121], v[14:15], v[12:13] op_sel_hi:[1,0,0]
  v_pk_fma_f32 v[122:123], v[122:123], v[14:15], v[12:13] op_sel_hi:[1,0,0]
  v_pk_fma_f32 v[124:125], v[124:125], v[14:15], v[12:13] op_sel_hi:[1,0,0]
  v_pk_fma_f32 v[126:127], v[126:127], v[14:15], v[12:13] op_sel_hi:[1,0,0]
  v_pk_fma_f32 v[128:129], v[128:129], v[14:15], v[12:13] op_sel_hi:[1,0,0]
  v_pk_fma_f32 v[130:131], v[130:131], v[14:15], v[12:13] op_sel_hi:[1,0,0]
  v_pk_fma_f32 v[132:133], v[132:133], v[14:15], v[12:13] op_sel_hi:[1,0,0]
  v_pk_fma_f32 v[134:135], v[134:135], v[14:15], v[12:13] op_sel_hi:[1,0,0]
  v_pk_fma_f32 v[136:137], v[136:137], v[14:15], v[12:13] op_sel_hi:[1,0,0]
  v_pk_fma_f32 v[138:139], v[138:139], v[14:15], v[12:13] op_sel_hi:[1,0,0]
  v_pk_fma_f32 v[140:141], v[140:141], v[14:15], v[12:13] op_sel_hi:[1,0,0]
  v_pk_fma_f32 v[142:143], v[142:143], v[14:15], v[12:13] op_sel_hi:[1,0,0]
  v_pk_fma_f32 v[144:145], v[144:145], v[14:15], v[12:13] op_sel_hi:[1,0,0]
  v_pk_fma_f32 v[146:147], v[146:147], v[14:15], v[12:13] op_sel_hi:[1,0,0]
  v_pk_fma_f32 v[148:149], v[148:149], v[14:15], v[12:13] op_sel_hi:[1,0,0]
  v_pk_fma_f32 v[150:151], v[150:151], v[14:15], v[12:13] op_sel_hi:[1,0,0]
  v_pk_fma_f32 v[152:153], v[152:153], v[14:15], v[12:13] op_sel_hi:[1,0,0]
  v_pk_fma_f32 v[154:155], v[154:155], v[14:15], v[12:13] op_sel_hi:[1,0,0]
  v_pk_fma_f32 v[156:157], v[156:157], v[14:15], v[12:13] op_sel_hi:[1,0,0]
  v_pk_fma_f32 v[158:159], v[158:159], v[14:15], v[12:13] op_sel_hi:[1,0,0]
  v_cndmask_b32 v159, v159, v250, s[12:13]
  v_cvt_pk_bf16_f32 v160, v112, v113
  v_cvt_pk_bf16_f32 v161, v114, v115
  v_cvt_pk_bf16_f32 v162, v116, v117
  v_cvt_pk_bf16_f32 v163, v118, v119
  v_cvt_pk_bf16_f32 v164, v120, v121
  v_cvt_pk_bf16_f32 v165, v122, v123
  v_cvt_pk_bf16_f32 v166, v124, v125
  v_cvt_pk_bf16_f32 v167, v126, v127
  v_cvt_pk_bf16_f32 v168, v128, v129
  v_cvt_pk_bf16_f32 v169, v130, v131
  v_cvt_pk_bf16_f32 v170, v132, v133
  v_cvt_pk_bf16_f32 v171, v134, v135
  v_cvt_pk_bf16_f32 v172, v136, v137
  v_cvt_pk_bf16_f32 v173, v138, v139
  v_cvt_pk_bf16_f32 v174, v140, v141
  v_cvt_pk_bf16_f32 v175, v142, v143
  v_cvt_pk_bf16_f32 v176, v144, v145
  v_cvt_pk_bf16_f32 v177, v146, v147
  v_cvt_pk_bf16_f32 v178, v148, v149
  v_cvt_pk_bf16_f32 v179, v150, v151
  v_cvt_pk_bf16_f32 v180, v152, v153
  v_cvt_pk_bf16_f32 v181, v154, v155
  v_cvt_pk_bf16_f32 v182, v156, v157
  v_cvt_pk_bf16_f32 v183, v158, v159
  s_waitcnt lgkmcnt(5)
  v_mfma_f32_32x32x16_bf16 v[16:31], v[216:219], v[160:163], 0
  ds_read_b128 v[136:139], v5
  ds_read_b128 v[140:143], v5 offset:32
  ds_read_b128 v[144:147], v5 offset:64
  s_waitcnt lgkmcnt(7)
  v_mfma_f32_32x32x16_bf16 v[16:31], v[220:223], v[164:167], v[16:31]
  ds_read_b128 v[148:151], v5 offset:96
  ds_read_b128 v[152:155], v5 offset:128
  ds_read_b128 v[156:159], v5 offset:160
  s_waitcnt lgkmcnt(9)
  v_mfma_f32_32x32x16_bf16 v[16:31], v[224:227], v[168:171], v[16:31]
  s_waitcnt lgkmcnt(8)
  v_mfma_f32_32x32x16_bf16 v[16:31], v[228:231], v[172:175], v[16:31]
  s_waitcnt lgkmcnt(7)
  v_mfma_f32_32x32x16_bf16 v[16:31], v[232:235], v[176:179], v[16:31]
  s_waitcnt lgkmcnt(6)
  v_mfma_f32_32x32x16_bf16 v[16:31], v[236:239], v[180:183], v[16:31]
  s_waitcnt lgkmcnt(0)
  s_nop 10
  v_pk_fma_f32 v[48:49], v[16:17], v[16:17], s[20:21] neg_lo:[1,0,1] neg_hi:[1,0,1]
  v_pk_fma_f32 v[50:51], v[18:19], v[18:19], s[20:21] neg_lo:[1,0,1] neg_hi:[1,0,1]
  v_pk_fma_f32 v[52:53], v[20:21], v[20:21], s[20:21] neg_lo:[1,0,1] neg_hi:[1,0,1]
  v_pk_fma_f32 v[54:55], v[22:23], v[22:23], s[20:21] neg_lo:[1,0,1] neg_hi:[1,0,1]
  v_pk_fma_f32 v[56:57], v[24:25], v[24:25], s[20:21] neg_lo:[1,0,1] neg_hi:[1,0,1]
  v_pk_fma_f32 v[58:59], v[26:27], v[26:27], s[20:21] neg_lo:[1,0,1] neg_hi:[1,0,1]
  v_pk_fma_f32 v[60:61], v[28:29], v[28:29], s[20:21] neg_lo:[1,0,1] neg_hi:[1,0,1]
  v_pk_fma_f32 v[62:63], v[30:31], v[30:31], s[20:21] neg_lo:[1,0,1] neg_hi:[1,0,1]
  v_pk_mul_f32 v[48:49], v[16:17], v[48:49]
  v_pk_mul_f32 v[50:51], v[18:19], v[50:51]
  v_pk_mul_f32 v[52:53], v[20:21], v[52:53]
  v_pk_mul_f32 v[54:55], v[22:23], v[54:55]
  v_pk_mul_f32 v[56:57], v[24:25], v[56:57]
  v_pk_mul_f32 v[58:59], v[26:27], v[58:59]
  v_pk_mul_f32 v[60:61], v[28:29], v[60:61]
  v_pk_mul_f32 v[62:63], v[30:31], v[62:63]
  s_mov_b32 m0, s30
  v_exp_f32 v48, v48
  buffer_load_dwordx4 v6, s[4:7], s29 offen lds
  buffer_load_dwordx4 v7, s[4:7], s29 offen offset:1024 lds
  buffer_load_dwordx4 v8, s[4:7], s29 offen offset:2048 lds
  buffer_load_dwordx4 v9, s[4:7], s29 offen offset:3072 lds
  v_exp_f32 v49, v49
  v_exp_f32 v50, v50
  v_exp_f32 v51, v51
  v_exp_f32 v52, v52
  v_exp_f32 v53, v53
  v_exp_f32 v54, v54
  v_exp_f32 v55, v55
  v_exp_f32 v56, v56
  v_exp_f32 v57, v57
  v_exp_f32 v58, v58
  v_exp_f32 v59, v59
  v_exp_f32 v60, v60
  v_exp_f32 v61, v61
  v_exp_f32 v62, v62
  v_exp_f32_e64 v63, v63
  v_pk_fma_f32 v[48:49], v[48:49], s[22:23], s[22:23]
  v_pk_fma_f32 v[50:51], v[50:51], s[22:23], s[22:23]
  v_pk_fma_f32 v[52:53], v[52:53], s[22:23], s[22:23]
  v_pk_fma_f32 v[54:55], v[54:55], s[22:23], s[22:23]
  v_pk_fma_f32 v[56:57], v[56:57], s[22:23], s[22:23]
  v_pk_fma_f32 v[58:59], v[58:59], s[22:23], s[22:23]
  v_pk_fma_f32 v[60:61], v[60:61], s[22:23], s[22:23]
  v_pk_fma_f32 v[62:63], v[62:63], s[22:23], s[22:23]
  v_mfma_f32_32x32x16_bf16 v[32:47], a[0:3], v[160:163], 0
  ds_read_b128 v[64:67], v2
  ds_read_b128 v[68:71], v2 offset:32
  ds_read_b128 v[72:75], v2 offset:64
  v_rcp_f32_e64 v48, v48
  v_mfma_f32_32x32x16_bf16 v[32:47], a[4:7], v[164:167], v[32:47]
  ds_read_b128 v[76:79], v2 offset:96
  ds_read_b128 v[80:83], v2 offset:128
  ds_read_b128 v[84:87], v2 offset:160
  v_rcp_f32_e64 v49, v49
  v_mfma_f32_32x32x16_bf16 v[32:47], a[8:11], v[168:171], v[32:47]
  ds_read_b128 v[88:91], v2 offset:192
  ds_read_b128 v[92:95], v2 offset:224
  ds_read_b128 v[96:99], v2 offset:256
  v_rcp_f32_e64 v50, v50
  v_mfma_f32_32x32x16_bf16 v[32:47], a[12:15], v[172:175], v[32:47]
  ds_read_b128 v[100:103], v2 offset:288
  ds_read_b128 v[104:107], v2 offset:320
  ds_read_b128 v[108:111], v2 offset:352
  v_rcp_f32_e64 v51, v51
  v_mfma_f32_32x32x16_bf16 v[32:47], a[16:19], v[176:179], v[32:47]
  v_rcp_f32 v52, v52
  v_rcp_f32 v53, v53
  v_rcp_f32_e64 v54, v54
  v_mfma_f32_32x32x16_bf16 v[32:47], a[20:23], v[180:183], v[32:47]
  s_waitcnt lgkmcnt(0)
  v_rcp_f32 v55, v55
  v_rcp_f32 v56, v56
  v_rcp_f32 v57, v57
  v_mfma_f32_32x32x16_bf16 v[64:79], v[240:243], v[136:139], v[64:79]
  ds_read_b128 v[192:195], v1 offset:8192
  ds_read_b128 v[196:199], v1 offset:9216
  v_rcp_f32 v58, v58
  v_rcp_f32 v59, v59
  v_mfma_f32_32x32x16_bf16 v[64:79], v[244:247], v[140:143], v[64:79]
  ds_read_b128 v[200:203], v1 offset:10240
  ds_read_b128 v[204:207], v1 offset:11264
  v_rcp_f32 v60, v60
  v_rcp_f32 v61, v61
  v_mfma_f32_32x32x16_bf16 v[80:95], v[240:243], v[144:147], v[80:95]
  ds_read_b128 v[208:211], v1 offset:12288
  ds_read_b128 v[212:215], v1 offset:13312
  v_rcp_f32_e64 v62, v62
  v_rcp_f32 v63, v63
  v_mfma_f32_32x32x16_bf16 v[80:95], v[244:247], v[148:151], v[80:95]
  v_mfma_f32_32x32x16_bf16 v[96:111], v[240:243], v[152:155], v[96:111]
  v_mfma_f32_32x32x16_bf16 v[96:111], v[244:247], v[156:159], v[96:111]
  s_waitcnt lgkmcnt(0)
  v_pk_mul_f32 v[16:17], v[16:17], v[48:49]
  v_pk_mul_f32 v[18:19], v[18:19], v[50:51]
  v_pk_mul_f32 v[20:21], v[20:21], v[52:53]
  v_pk_mul_f32 v[22:23], v[22:23], v[54:55]
  v_pk_mul_f32 v[24:25], v[24:25], v[56:57]
  v_pk_mul_f32 v[26:27], v[26:27], v[58:59]
  v_pk_mul_f32 v[28:29], v[28:29], v[60:61]
  v_pk_mul_f32 v[30:31], v[30:31], v[62:63]
  v_pk_fma_f32 v[48:49], v[32:33], v[32:33], s[20:21] neg_lo:[1,0,1] neg_hi:[1,0,1]
  v_pk_fma_f32 v[50:51], v[34:35], v[34:35], s[20:21] neg_lo:[1,0,1] neg_hi:[1,0,1]
  v_pk_fma_f32 v[52:53], v[36:37], v[36:37], s[20:21] neg_lo:[1,0,1] neg_hi:[1,0,1]
  v_pk_fma_f32 v[54:55], v[38:39], v[38:39], s[20:21] neg_lo:[1,0,1] neg_hi:[1,0,1]
  v_pk_fma_f32 v[56:57], v[40:41], v[40:41], s[20:21] neg_lo:[1,0,1] neg_hi:[1,0,1]
  v_pk_fma_f32 v[58:59], v[42:43], v[42:43], s[20:21] neg_lo:[1,0,1] neg_hi:[1,0,1]
  v_pk_fma_f32 v[60:61], v[44:45], v[44:45], s[20:21] neg_lo:[1,0,1] neg_hi:[1,0,1]
  v_pk_fma_f32 v[62:63], v[46:47], v[46:47], s[20:21] neg_lo:[1,0,1] neg_hi:[1,0,1]
  v_pk_mul_f32 v[48:49], v[32:33], v[48:49]
  v_pk_mul_f32 v[50:51], v[34:35], v[50:51]
  v_pk_mul_f32 v[52:53], v[36:37], v[52:53]
  v_pk_mul_f32 v[54:55], v[38:39], v[54:55]
  v_pk_mul_f32 v[56:57], v[40:41], v[56:57]
  v_cvt_pk_bf16_f32 v184, v16, v17
  v_cvt_pk_bf16_f32 v185, v18, v19
  v_cvt_pk_bf16_f32 v186, v20, v21
  v_cvt_pk_bf16_f32 v187, v22, v23
  v_pk_mul_f32 v[58:59], v[42:43], v[58:59]
  v_pk_mul_f32 v[60:61], v[44:45], v[60:61]
  v_pk_mul_f32 v[62:63], v[46:47], v[62:63]
  v_mfma_f32_32x32x16_bf16 v[64:79], v[192:195], v[184:187], v[64:79]
  s_mov_b32 m0, s31
  v_cvt_pk_bf16_f32 v188, v24, v25
  v_cvt_pk_bf16_f32 v189, v26, v27
  v_cvt_pk_bf16_f32 v190, v28, v29
  v_cvt_pk_bf16_f32 v191, v30, v31
  v_exp_f32 v48, v48
  v_mfma_f32_32x32x16_bf16 v[80:95], v[196:199], v[184:187], v[80:95]
  buffer_load_dwordx4 v6, s[4:7], s52 offen lds
  v_exp_f32 v49, v49
  v_exp_f32 v50, v50
  v_exp_f32_e64 v51, v51
  v_mfma_f32_32x32x16_bf16 v[96:111], v[200:203], v[184:187], v[96:111]
  buffer_load_dwordx4 v7, s[4:7], s52 offen offset:1024 lds
  v_exp_f32 v52, v52
  v_exp_f32 v53, v53
  v_mfma_f32_32x32x16_bf16 v[64:79], v[204:207], v[188:191], v[64:79]
  buffer_load_dwordx4 v8, s[4:7], s52 offen offset:2048 lds
  v_exp_f32 v54, v54
  v_exp_f32 v55, v55
  v_exp_f32_e64 v56, v56
  v_mfma_f32_32x32x16_bf16 v[80:95], v[208:211], v[188:191], v[80:95]
  buffer_load_dwordx4 v9, s[4:7], s52 offen offset:3072 lds
  v_exp_f32 v57, v57
  v_exp_f32 v58, v58
  v_mfma_f32_32x32x16_bf16 v[96:111], v[212:215], v[188:191], v[96:111]
  v_exp_f32 v59, v59
  v_exp_f32 v60, v60
  v_exp_f32 v61, v61
  v_exp_f32 v62, v62
  v_exp_f32_e64 v63, v63
  v_pk_fma_f32 v[48:49], v[48:49], s[22:23], s[22:23]
  v_pk_fma_f32 v[50:51], v[50:51], s[22:23], s[22:23]
  v_pk_fma_f32 v[52:53], v[52:53], s[22:23], s[22:23]
  v_pk_fma_f32 v[54:55], v[54:55], s[22:23], s[22:23]
  v_pk_fma_f32 v[56:57], v[56:57], s[22:23], s[22:23]
  v_pk_fma_f32 v[58:59], v[58:59], s[22:23], s[22:23]
  v_pk_fma_f32 v[60:61], v[60:61], s[22:23], s[22:23]
  v_pk_fma_f32 v[62:63], v[62:63], s[22:23], s[22:23]
  v_mfma_f32_32x32x16_bf16 v[16:31], a[24:27], v[160:163], 0
  ds_read_b128 v[192:195], v1 offset:14336
  ds_read_b128 v[196:199], v1 offset:15360
  v_rcp_f32 v48, v48
  v_rcp_f32 v49, v49
  v_mfma_f32_32x32x16_bf16 v[16:31], a[28:31], v[164:167], v[16:31]
  ds_read_b128 v[200:203], v1 offset:16384
  ds_read_b128 v[204:207], v1 offset:17408
  v_rcp_f32 v50, v50
  v_rcp_f32 v51, v51
  v_mfma_f32_32x32x16_bf16 v[16:31], a[32:35], v[168:171], v[16:31]
  ds_read_b128 v[208:211], v1 offset:18432
  ds_read_b128 v[212:215], v1 offset:19456
  v_rcp_f32 v52, v52
  v_rcp_f32 v53, v53
  v_mfma_f32_32x32x16_bf16 v[16:31], a[36:39], v[172:175], v[16:31]
  v_rcp_f32 v54, v54
  v_rcp_f32 v55, v55
  v_rcp_f32_e64 v56, v56
  v_mfma_f32_32x32x16_bf16 v[16:31], a[40:43], v[176:179], v[16:31]
  v_rcp_f32 v57, v57
  v_rcp_f32 v58, v58
  v_rcp_f32_e64 v59, v59
  v_mfma_f32_32x32x16_bf16 v[16:31], a[44:47], v[180:183], v[16:31]
  s_waitcnt lgkmcnt(0)
  v_rcp_f32 v60, v60
  v_rcp_f32 v61, v61
  v_rcp_f32 v62, v62
  v_rcp_f32_e64 v63, v63
  v_pk_mul_f32 v[32:33], v[32:33], v[48:49]
  v_pk_mul_f32 v[34:35], v[34:35], v[50:51]
  v_pk_mul_f32 v[36:37], v[36:37], v[52:53]
  v_pk_mul_f32 v[38:39], v[38:39], v[54:55]
  v_pk_mul_f32 v[40:41], v[40:41], v[56:57]
  v_pk_mul_f32 v[42:43], v[42:43], v[58:59]
  v_pk_mul_f32 v[44:45], v[44:45], v[60:61]
  v_pk_mul_f32 v[46:47], v[46:47], v[62:63]
  v_pk_fma_f32 v[48:49], v[16:17], v[16:17], s[20:21] neg_lo:[1,0,1] neg_hi:[1,0,1]
  v_pk_fma_f32 v[50:51], v[18:19], v[18:19], s[20:21] neg_lo:[1,0,1] neg_hi:[1,0,1]
  v_pk_fma_f32 v[52:53], v[20:21], v[20:21], s[20:21] neg_lo:[1,0,1] neg_hi:[1,0,1]
  v_pk_fma_f32 v[54:55], v[22:23], v[22:23], s[20:21] neg_lo:[1,0,1] neg_hi:[1,0,1]
  v_pk_fma_f32 v[56:57], v[24:25], v[24:25], s[20:21] neg_lo:[1,0,1] neg_hi:[1,0,1]
  v_pk_fma_f32 v[58:59], v[26:27], v[26:27], s[20:21] neg_lo:[1,0,1] neg_hi:[1,0,1]
  v_pk_fma_f32 v[60:61], v[28:29], v[28:29], s[20:21] neg_lo:[1,0,1] neg_hi:[1,0,1]
  v_pk_fma_f32 v[62:63], v[30:31], v[30:31], s[20:21] neg_lo:[1,0,1] neg_hi:[1,0,1]
  v_pk_mul_f32 v[48:49], v[16:17], v[48:49]
  v_pk_mul_f32 v[50:51], v[18:19], v[50:51]
  v_pk_mul_f32 v[52:53], v[20:21], v[52:53]
  v_pk_mul_f32 v[54:55], v[22:23], v[54:55]
  v_pk_mul_f32 v[56:57], v[24:25], v[56:57]
  v_cvt_pk_bf16_f32 v184, v32, v33
  v_cvt_pk_bf16_f32 v185, v34, v35
  v_cvt_pk_bf16_f32 v186, v36, v37
  v_cvt_pk_bf16_f32 v187, v38, v39
  v_pk_mul_f32 v[58:59], v[26:27], v[58:59]
  v_pk_mul_f32 v[60:61], v[28:29], v[60:61]
  v_pk_mul_f32 v[62:63], v[30:31], v[62:63]
  v_mfma_f32_32x32x16_bf16 v[64:79], v[192:195], v[184:187], v[64:79]
  v_cvt_pk_bf16_f32 v188, v40, v41
  v_cvt_pk_bf16_f32 v189, v42, v43
  v_cvt_pk_bf16_f32 v190, v44, v45
  v_cvt_pk_bf16_f32 v191, v46, v47
  v_exp_f32_e64 v48, v48
  v_mfma_f32_32x32x16_bf16 v[80:95], v[196:199], v[184:187], v[80:95]
  v_exp_f32 v49, v49
  v_exp_f32 v50, v50
  v_exp_f32_e64 v51, v51
  v_mfma_f32_32x32x16_bf16 v[96:111], v[200:203], v[184:187], v[96:111]
  v_exp_f32 v52, v52
  v_exp_f32 v53, v53
  v_subrev_u32 v11, 0x4100, v5
  v_mfma_f32_32x32x16_bf16 v[64:79], v[204:207], v[188:191], v[64:79]
  v_exp_f32 v54, v54
  v_exp_f32 v55, v55
  v_exp_f32_e64 v56, v56
  v_mfma_f32_32x32x16_bf16 v[80:95], v[208:211], v[188:191], v[80:95]
  v_exp_f32 v57, v57
  v_exp_f32 v58, v58
  v_add_u32 v5, 0x8200, v5
  v_exp_f32_e64 v59, v59
  v_mfma_f32_32x32x16_bf16 v[96:111], v[212:215], v[188:191], v[96:111]
  v_exp_f32 v60, v60
  v_exp_f32 v61, v61
  v_exp_f32 v62, v62
  v_exp_f32 v63, v63
  v_min_u32_e64 v5, v11, v5
  v_pk_fma_f32 v[48:49], v[48:49], s[22:23], s[22:23]
  v_pk_fma_f32 v[50:51], v[50:51], s[22:23], s[22:23]
  v_pk_fma_f32 v[52:53], v[52:53], s[22:23], s[22:23]
  v_pk_fma_f32 v[54:55], v[54:55], s[22:23], s[22:23]
  v_pk_fma_f32 v[56:57], v[56:57], s[22:23], s[22:23]
  v_pk_fma_f32 v[58:59], v[58:59], s[22:23], s[22:23]
  v_pk_fma_f32 v[60:61], v[60:61], s[22:23], s[22:23]
  v_pk_fma_f32 v[62:63], v[62:63], s[22:23], s[22:23]
  v_mfma_f32_32x32x16_bf16 v[32:47], a[48:51], v[160:163], 0
  ds_read_b128 v[192:195], v1 offset:20480
  ds_read_b128 v[196:199], v1 offset:21504
  v_rcp_f32 v48, v48
  v_rcp_f32 v49, v49
  v_mfma_f32_32x32x16_bf16 v[32:47], a[52:55], v[164:167], v[32:47]
  ds_read_b128 v[200:203], v1 offset:22528
  ds_read_b128 v[204:207], v1 offset:23552
  v_rcp_f32 v50, v50
  v_rcp_f32 v51, v51
  v_mfma_f32_32x32x16_bf16 v[32:47], a[56:59], v[168:171], v[32:47]
  ds_read_b128 v[208:211], v1 offset:24576
  ds_read_b128 v[212:215], v1 offset:25600
  v_rcp_f32 v52, v52
  v_rcp_f32 v53, v53
  v_mfma_f32_32x32x16_bf16 v[32:47], a[60:63], v[172:175], v[32:47]
  v_rcp_f32 v54, v54
  v_rcp_f32 v55, v55
  v_rcp_f32_e64 v56, v56
  v_mfma_f32_32x32x16_bf16 v[32:47], a[64:67], v[176:179], v[32:47]
  v_rcp_f32 v57, v57
  v_rcp_f32 v58, v58
  v_rcp_f32_e64 v59, v59
  v_mfma_f32_32x32x16_bf16 v[32:47], a[68:71], v[180:183], v[32:47]
  s_waitcnt lgkmcnt(0)
  v_rcp_f32 v60, v60
  v_rcp_f32 v61, v61
  v_rcp_f32 v62, v62
  v_rcp_f32_e64 v63, v63
  v_pk_mul_f32 v[16:17], v[16:17], v[48:49]
  v_pk_mul_f32 v[18:19], v[18:19], v[50:51]
  v_pk_mul_f32 v[20:21], v[20:21], v[52:53]
  v_pk_mul_f32 v[22:23], v[22:23], v[54:55]
  v_pk_mul_f32 v[24:25], v[24:25], v[56:57]
  v_pk_mul_f32 v[26:27], v[26:27], v[58:59]
  v_pk_mul_f32 v[28:29], v[28:29], v[60:61]
  v_pk_mul_f32 v[30:31], v[30:31], v[62:63]
  v_pk_fma_f32 v[48:49], v[32:33], v[32:33], s[20:21] neg_lo:[1,0,1] neg_hi:[1,0,1]
  v_pk_fma_f32 v[50:51], v[34:35], v[34:35], s[20:21] neg_lo:[1,0,1] neg_hi:[1,0,1]
  v_pk_fma_f32 v[52:53], v[36:37], v[36:37], s[20:21] neg_lo:[1,0,1] neg_hi:[1,0,1]
  v_pk_fma_f32 v[54:55], v[38:39], v[38:39], s[20:21] neg_lo:[1,0,1] neg_hi:[1,0,1]
  v_pk_fma_f32 v[56:57], v[40:41], v[40:41], s[20:21] neg_lo:[1,0,1] neg_hi:[1,0,1]
  v_pk_fma_f32 v[58:59], v[42:43], v[42:43], s[20:21] neg_lo:[1,0,1] neg_hi:[1,0,1]
  v_pk_fma_f32 v[60:61], v[44:45], v[44:45], s[20:21] neg_lo:[1,0,1] neg_hi:[1,0,1]
  v_pk_fma_f32 v[62:63], v[46:47], v[46:47], s[20:21] neg_lo:[1,0,1] neg_hi:[1,0,1]
  v_pk_mul_f32 v[48:49], v[32:33], v[48:49]
  v_pk_mul_f32 v[50:51], v[34:35], v[50:51]
  v_pk_mul_f32 v[52:53], v[36:37], v[52:53]
  v_pk_mul_f32 v[54:55], v[38:39], v[54:55]
  v_pk_mul_f32 v[56:57], v[40:41], v[56:57]
  v_cvt_pk_bf16_f32 v184, v16, v17
  v_cvt_pk_bf16_f32 v185, v18, v19
  v_cvt_pk_bf16_f32 v186, v20, v21
  v_cvt_pk_bf16_f32 v187, v22, v23
  v_pk_mul_f32 v[58:59], v[42:43], v[58:59]
  v_pk_mul_f32 v[60:61], v[44:45], v[60:61]
  v_pk_mul_f32 v[62:63], v[46:47], v[62:63]
  v_mfma_f32_32x32x16_bf16 v[64:79], v[192:195], v[184:187], v[64:79]
  s_add_u32 s29, s29, 0x60000
  v_cvt_pk_bf16_f32 v188, v24, v25
  v_cvt_pk_bf16_f32 v189, v26, v27
  v_cvt_pk_bf16_f32 v190, v28, v29
  v_cvt_pk_bf16_f32 v191, v30, v31
  v_exp_f32_e64 v48, v48
  v_mfma_f32_32x32x16_bf16 v[80:95], v[196:199], v[184:187], v[80:95]
  s_add_u32 s52, s52, 0x60000
  v_exp_f32 v49, v49
  v_exp_f32 v50, v50
  v_exp_f32_e64 v51, v51
  v_mfma_f32_32x32x16_bf16 v[96:111], v[200:203], v[184:187], v[96:111]
  s_mov_b32 s32, s30
  v_exp_f32 v52, v52
  v_exp_f32_e64 v53, v53
  v_subrev_u32 v11, 0x4100, v4
  v_mfma_f32_32x32x16_bf16 v[64:79], v[204:207], v[188:191], v[64:79]
  s_add_u32 s30, s33, 32
  v_exp_f32 v54, v54
  v_exp_f32 v55, v55
  v_exp_f32 v56, v56
  v_mfma_f32_32x32x16_bf16 v[80:95], v[208:211], v[188:191], v[80:95]
  s_sub_u32 s33, s31, 0
  v_exp_f32 v57, v57
  v_exp_f32_e64 v58, v58
  v_add_u32 v4, 0x8200, v4
  v_exp_f32_e64 v59, v59
  v_mfma_f32_32x32x16_bf16 v[96:111], v[212:215], v[188:191], v[96:111]
  v_exp_f32 v60, v60
  v_exp_f32 v61, v61
  v_exp_f32 v62, v62
  v_exp_f32 v63, v63
  v_min_u32_e64 v4, v11, v4
  v_pk_fma_f32 v[48:49], v[48:49], s[22:23], s[22:23]
  v_pk_fma_f32 v[50:51], v[50:51], s[22:23], s[22:23]
  v_pk_fma_f32 v[52:53], v[52:53], s[22:23], s[22:23]
  v_pk_fma_f32 v[54:55], v[54:55], s[22:23], s[22:23]
  v_pk_fma_f32 v[56:57], v[56:57], s[22:23], s[22:23]
  v_pk_fma_f32 v[58:59], v[58:59], s[22:23], s[22:23]
  v_pk_fma_f32 v[60:61], v[60:61], s[22:23], s[22:23]
  v_pk_fma_f32 v[62:63], v[62:63], s[22:23], s[22:23]
  v_mfma_f32_32x32x16_bf16 v[16:31], a[72:75], v[160:163], 0
  ds_read_b128 v[192:195], v1 offset:26624
  ds_read_b128 v[196:199], v1 offset:27648
  v_rcp_f32 v48, v48
  v_rcp_f32 v49, v49
  v_mfma_f32_32x32x16_bf16 v[16:31], a[76:79], v[164:167], v[16:31]
  ds_read_b128 v[200:203], v1 offset:28672
  ds_read_b128 v[204:207], v1 offset:29696
  v_rcp_f32 v50, v50
  v_rcp_f32 v51, v51
  v_mfma_f32_32x32x16_bf16 v[16:31], a[80:83], v[168:171], v[16:31]
  ds_read_b128 v[208:211], v1 offset:30720
  ds_read_b128 v[212:215], v1 offset:31744
  v_rcp_f32 v52, v52
  v_rcp_f32 v53, v53
  v_mfma_f32_32x32x16_bf16 v[16:31], a[84:87], v[172:175], v[16:31]
  s_waitcnt vmcnt(8)
  buffer_load_dword v249, v248, s[4:7], s29 offen
  v_rcp_f32 v54, v54
  v_rcp_f32_e64 v55, v55
  v_mfma_f32_32x32x16_bf16 v[16:31], a[88:91], v[176:179], v[16:31]
  v_rcp_f32 v56, v56
  v_rcp_f32 v57, v57
  v_rcp_f32_e64 v58, v58
  v_mfma_f32_32x32x16_bf16 v[16:31], a[92:95], v[180:183], v[16:31]
  s_waitcnt lgkmcnt(0)
  v_rcp_f32 v59, v59
  v_rcp_f32 v60, v60
  v_rcp_f32 v61, v61
  v_rcp_f32 v62, v62
  v_rcp_f32 v63, v63
  v_pk_mul_f32 v[32:33], v[32:33], v[48:49]
  v_pk_mul_f32 v[34:35], v[34:35], v[50:51]
  v_pk_mul_f32 v[36:37], v[36:37], v[52:53]
  v_pk_mul_f32 v[38:39], v[38:39], v[54:55]
  v_pk_mul_f32 v[40:41], v[40:41], v[56:57]
  v_pk_mul_f32 v[42:43], v[42:43], v[58:59]
  v_pk_mul_f32 v[44:45], v[44:45], v[60:61]
  v_pk_mul_f32 v[46:47], v[46:47], v[62:63]
  v_pk_fma_f32 v[48:49], v[16:17], v[16:17], s[20:21] neg_lo:[1,0,1] neg_hi:[1,0,1]
  v_pk_fma_f32 v[50:51], v[18:19], v[18:19], s[20:21] neg_lo:[1,0,1] neg_hi:[1,0,1]
  v_pk_fma_f32 v[52:53], v[20:21], v[20:21], s[20:21] neg_lo:[1,0,1] neg_hi:[1,0,1]
  v_pk_fma_f32 v[54:55], v[22:23], v[22:23], s[20:21] neg_lo:[1,0,1] neg_hi:[1,0,1]
  v_pk_fma_f32 v[56:57], v[24:25], v[24:25], s[20:21] neg_lo:[1,0,1] neg_hi:[1,0,1]
  v_pk_fma_f32 v[58:59], v[26:27], v[26:27], s[20:21] neg_lo:[1,0,1] neg_hi:[1,0,1]
  v_pk_fma_f32 v[60:61], v[28:29], v[28:29], s[20:21] neg_lo:[1,0,1] neg_hi:[1,0,1]
  v_pk_fma_f32 v[62:63], v[30:31], v[30:31], s[20:21] neg_lo:[1,0,1] neg_hi:[1,0,1]
  v_pk_mul_f32 v[48:49], v[16:17], v[48:49]
  v_pk_mul_f32 v[50:51], v[18:19], v[50:51]
  v_pk_mul_f32 v[52:53], v[20:21], v[52:53]
  v_pk_mul_f32 v[54:55], v[22:23], v[54:55]
  v_pk_mul_f32 v[56:57], v[24:25], v[56:57]
  v_cvt_pk_bf16_f32 v184, v32, v33
  v_cvt_pk_bf16_f32 v185, v34, v35
  v_cvt_pk_bf16_f32 v186, v36, v37
  v_cvt_pk_bf16_f32 v187, v38, v39
  v_pk_mul_f32 v[58:59], v[26:27], v[58:59]
  v_pk_mul_f32 v[60:61], v[28:29], v[60:61]
  v_pk_mul_f32 v[62:63], v[30:31], v[62:63]
  v_mfma_f32_32x32x16_bf16 v[64:79], v[192:195], v[184:187], v[64:79]
  s_nop 0
  s_waitcnt vmcnt(1)
  ds_read_b128 v[220:223], v4 offset:96
  v_cvt_pk_bf16_f32 v188, v40, v41
  v_cvt_pk_bf16_f32 v189, v42, v43
  v_cvt_pk_bf16_f32 v190, v44, v45
  v_cvt_pk_bf16_f32 v191, v46, v47
  v_mfma_f32_32x32x16_bf16 v[80:95], v[196:199], v[184:187], v[80:95]
  ds_read_b128 v[228:231], v4 offset:288
  v_exp_f32 v48, v48
  v_exp_f32 v49, v49
  v_exp_f32_e64 v50, v50
  v_mfma_f32_32x32x16_bf16 v[96:111], v[200:203], v[184:187], v[96:111]
  ds_read_b128 v[236:239], v4 offset:480
  v_exp_f32 v51, v51
  v_exp_f32 v52, v52
  v_mfma_f32_32x32x16_bf16 v[64:79], v[204:207], v[188:191], v[64:79]
  v_exp_f32 v53, v53
  v_exp_f32 v54, v54
  v_exp_f32_e64 v55, v55
  v_mfma_f32_32x32x16_bf16 v[80:95], v[208:211], v[188:191], v[80:95]
  v_exp_f32 v56, v56
  v_exp_f32 v57, v57
  v_exp_f32_e64 v58, v58
  v_mfma_f32_32x32x16_bf16 v[96:111], v[212:215], v[188:191], v[96:111]
  s_waitcnt lgkmcnt(0)
  v_exp_f32 v59, v59
  v_exp_f32 v60, v60
  v_exp_f32 v61, v61
  v_exp_f32 v62, v62
  v_exp_f32 v63, v63
  v_pk_fma_f32 v[48:49], v[48:49], s[22:23], s[22:23]
  v_pk_fma_f32 v[50:51], v[50:51], s[22:23], s[22:23]
  v_pk_fma_f32 v[52:53], v[52:53], s[22:23], s[22:23]
  v_pk_fma_f32 v[54:55], v[54:55], s[22:23], s[22:23]
  v_pk_fma_f32 v[56:57], v[56:57], s[22:23], s[22:23]
  v_pk_fma_f32 v[58:59], v[58:59], s[22:23], s[22:23]
  v_pk_fma_f32 v[60:61], v[60:61], s[22:23], s[22:23]
  v_pk_fma_f32 v[62:63], v[62:63], s[22:23], s[22:23]
  v_mfma_f32_32x32x16_bf16 v[32:47], a[96:99], v[160:163], 0
  ds_read_b128 v[192:195], v0 offset:24576
  ds_read_b128 v[196:199], v0 offset:25600
  v_rcp_f32 v48, v48
  v_rcp_f32 v49, v49
  v_mfma_f32_16x16x32_bf16 v[136:139], a[240:243], v[220:223], 0
  ds_read_b128 v[216:219], v3 offset:2800
  ds_read_b128 v[220:223], v4 offset:112
  v_mfma_f32_32x32x16_bf16 v[32:47], a[100:103], v[164:167], v[32:47]
  ds_read_b128 v[200:203], v0 offset:26624
  ds_read_b128 v[204:207], v0 offset:27648
  v_rcp_f32 v50, v50
  v_rcp_f32 v51, v51
  v_mfma_f32_16x16x32_bf16 v[136:139], a[244:247], v[228:231], v[136:139]
  ds_read_b128 v[224:227], v3 offset:7600
  ds_read_b128 v[228:231], v4 offset:304
  v_mfma_f32_32x32x16_bf16 v[32:47], a[104:107], v[168:171], v[32:47]
  ds_read_b128 v[208:211], v0 offset:28672
  ds_read_b128 v[212:215], v0 offset:29696
  v_rcp_f32 v52, v52
  v_rcp_f32 v53, v53
  v_mfma_f32_16x16x32_bf16 v[136:139], a[248:251], v[236:239], v[136:139]
  ds_read_b128 v[232:235], v3 offset:12400
  ds_read_b128 v[236:239], v4 offset:496
  v_mfma_f32_32x32x16_bf16 v[32:47], a[108:111], v[172:175], v[32:47]
  v_rcp_f32 v54, v54
  v_rcp_f32 v55, v55
  v_rcp_f32_e64 v56, v56
  v_mfma_f32_32x32x16_bf16 v[32:47], a[112:115], v[176:179], v[32:47]
  v_rcp_f32 v57, v57
  v_rcp_f32 v58, v58
  v_rcp_f32_e64 v59, v59
  v_mfma_f32_32x32x16_bf16 v[32:47], a[116:119], v[180:183], v[32:47]
  s_waitcnt lgkmcnt(0)
  v_rcp_f32 v60, v60
  v_rcp_f32 v61, v61
  v_rcp_f32 v62, v62
  v_rcp_f32_e64 v63, v63
  v_pk_mul_f32 v[16:17], v[16:17], v[48:49]
  v_pk_mul_f32 v[18:19], v[18:19], v[50:51]
  v_pk_mul_f32 v[20:21], v[20:21], v[52:53]
  v_pk_mul_f32 v[22:23], v[22:23], v[54:55]
  v_pk_mul_f32 v[24:25], v[24:25], v[56:57]
  v_pk_mul_f32 v[26:27], v[26:27], v[58:59]
  v_pk_mul_f32 v[28:29], v[28:29], v[60:61]
  v_pk_mul_f32 v[30:31], v[30:31], v[62:63]
  v_pk_add_f32 v[12:13], v[136:137], v[138:139]
  v_pk_mul_f32 v[14:15], v[136:137], v[136:137]
  v_pk_fma_f32 v[14:15], v[138:139], v[138:139], v[14:15]
  v_pk_fma_f32 v[48:49], v[32:33], v[32:33], s[20:21] neg_lo:[1,0,1] neg_hi:[1,0,1]
  v_pk_fma_f32 v[50:51], v[34:35], v[34:35], s[20:21] neg_lo:[1,0,1] neg_hi:[1,0,1]
  v_pk_fma_f32 v[52:53], v[36:37], v[36:37], s[20:21] neg_lo:[1,0,1] neg_hi:[1,0,1]
  v_pk_fma_f32 v[54:55], v[38:39], v[38:39], s[20:21] neg_lo:[1,0,1] neg_hi:[1,0,1]
  v_pk_fma_f32 v[56:57], v[40:41], v[40:41], s[20:21] neg_lo:[1,0,1] neg_hi:[1,0,1]
  v_pk_fma_f32 v[58:59], v[42:43], v[42:43], s[20:21] neg_lo:[1,0,1] neg_hi:[1,0,1]
  v_pk_fma_f32 v[60:61], v[44:45], v[44:45], s[20:21] neg_lo:[1,0,1] neg_hi:[1,0,1]
  v_pk_fma_f32 v[62:63], v[46:47], v[46:47], s[20:21] neg_lo:[1,0,1] neg_hi:[1,0,1]
  v_pk_mul_f32 v[48:49], v[32:33], v[48:49]
  v_pk_mul_f32 v[50:51], v[34:35], v[50:51]
  v_pk_mul_f32 v[52:53], v[36:37], v[52:53]
  v_pk_mul_f32 v[54:55], v[38:39], v[54:55]
  v_pk_mul_f32 v[56:57], v[40:41], v[56:57]
  v_pk_mul_f32 v[58:59], v[42:43], v[58:59]
  v_pk_mul_f32 v[60:61], v[44:45], v[60:61]
  v_pk_mul_f32 v[62:63], v[46:47], v[62:63]
  v_mfma_f32_16x16x32_bf16 v[140:143], v[216:219], v[220:223], 0
  v_cvt_pk_bf16_f32 v184, v16, v17
  v_cvt_pk_bf16_f32 v185, v18, v19
  v_mfma_f32_16x16x32_bf16 v[140:143], v[224:227], v[228:231], v[140:143]
  v_cvt_pk_bf16_f32 v186, v20, v21
  v_cvt_pk_bf16_f32 v187, v22, v23
  v_mfma_f32_16x16x32_bf16 v[140:143], v[232:235], v[236:239], v[140:143]
  ds_read_b128 v[220:223], v4 offset:128
  v_mfma_f32_32x32x16_bf16 v[64:79], v[192:195], v[184:187], v[64:79]
  ds_read_b128 v[224:227], v3 offset:8000
  ds_read_b128 v[228:231], v4 offset:320
  v_cvt_pk_bf16_f32 v188, v24, v25
  v_cvt_pk_bf16_f32 v189, v26, v27
  v_cvt_pk_bf16_f32 v190, v28, v29
  v_cvt_pk_bf16_f32 v191, v30, v31
  v_mfma_f32_32x32x16_bf16 v[80:95], v[196:199], v[184:187], v[80:95]
  ds_read_b128 v[232:235], v3 offset:12800
  ds_read_b128 v[236:239], v4 offset:512
  v_exp_f32 v48, v48
  v_exp_f32 v49, v49
  v_mfma_f32_32x32x16_bf16 v[96:111], v[200:203], v[184:187], v[96:111]
  s_sub_u32 s31, s32, 32
  v_exp_f32 v50, v50
  v_exp_f32 v51, v51
  v_exp_f32 v52, v52
  v_mfma_f32_32x32x16_bf16 v[64:79], v[204:207], v[188:191], v[64:79]
  v_exp_f32 v53, v53
  v_exp_f32 v54, v54
  v_exp_f32_e64 v55, v55
  v_mfma_f32_32x32x16_bf16 v[80:95], v[208:211], v[188:191], v[80:95]
  v_exp_f32 v56, v56
  v_exp_f32 v57, v57
  v_exp_f32_e64 v58, v58
  v_mfma_f32_32x32x16_bf16 v[96:111], v[212:215], v[188:191], v[96:111]
  s_waitcnt lgkmcnt(0)
  v_exp_f32 v59, v59
  v_exp_f32 v60, v60
  v_exp_f32 v61, v61
  v_exp_f32 v62, v62
  v_exp_f32 v63, v63
  v_pk_add_f32 v[12:13], v[12:13], v[140:141]
  v_pk_fma_f32 v[14:15], v[140:141], v[140:141], v[14:15]
  v_pk_add_f32 v[12:13], v[12:13], v[142:143]
  v_pk_fma_f32 v[14:15], v[142:143], v[142:143], v[14:15]
  v_pk_fma_f32 v[48:49], v[48:49], s[22:23], s[22:23]
  v_pk_fma_f32 v[50:51], v[50:51], s[22:23], s[22:23]
  v_pk_fma_f32 v[52:53], v[52:53], s[22:23], s[22:23]
  v_pk_fma_f32 v[54:55], v[54:55], s[22:23], s[22:23]
  v_pk_fma_f32 v[56:57], v[56:57], s[22:23], s[22:23]
  v_pk_fma_f32 v[58:59], v[58:59], s[22:23], s[22:23]
  v_pk_fma_f32 v[60:61], v[60:61], s[22:23], s[22:23]
  v_pk_fma_f32 v[62:63], v[62:63], s[22:23], s[22:23]
  v_mfma_f32_32x32x16_bf16 v[16:31], a[120:123], v[160:163], 0
  ds_read_b128 v[192:195], v0 offset:30720
  ds_read_b128 v[196:199], v0 offset:31744
  v_rcp_f32 v48, v48
  v_rcp_f32 v49, v49
  v_mfma_f32_16x16x32_bf16 v[144:147], a[252:255], v[220:223], 0
  ds_read_b128 v[216:219], v3 offset:3600
  ds_read_b128 v[220:223], v4 offset:144
  v_mfma_f32_32x32x16_bf16 v[16:31], a[124:127], v[164:167], v[16:31]
  ds_read_b128 v[200:203], v0 offset:32768
  ds_read_b128 v[204:207], v0 offset:33792
  v_rcp_f32 v50, v50
  v_rcp_f32 v51, v51
  v_mfma_f32_16x16x32_bf16 v[144:147], v[224:227], v[228:231], v[144:147]
  ds_read_b128 v[224:227], v3 offset:8400
  ds_read_b128 v[228:231], v4 offset:336
  v_mfma_f32_32x32x16_bf16 v[16:31], a[128:131], v[168:171], v[16:31]
  ds_read_b128 v[208:211], v0 offset:34816
  ds_read_b128 v[212:215], v0 offset:35840
  v_rcp_f32 v52, v52
  v_rcp_f32 v53, v53
  v_mfma_f32_16x16x32_bf16 v[144:147], v[232:235], v[236:239], v[144:147]
  ds_read_b128 v[232:235], v3 offset:13200
  ds_read_b128 v[236:239], v4 offset:528
  v_mfma_f32_32x32x16_bf16 v[16:31], a[132:135], v[172:175], v[16:31]
  v_rcp_f32 v54, v54
  v_rcp_f32 v55, v55
  v_rcp_f32_e64 v56, v56
  v_mfma_f32_32x32x16_bf16 v[16:31], a[136:139], v[176:179], v[16:31]
  v_rcp_f32 v57, v57
  v_rcp_f32 v58, v58
  v_rcp_f32_e64 v59, v59
  v_mfma_f32_32x32x16_bf16 v[16:31], a[140:143], v[180:183], v[16:31]
  s_waitcnt lgkmcnt(0)
  v_rcp_f32 v60, v60
  v_rcp_f32 v61, v61
  v_rcp_f32 v62, v62
  v_rcp_f32_e64 v63, v63
  v_pk_mul_f32 v[32:33], v[32:33], v[48:49]
  v_pk_mul_f32 v[34:35], v[34:35], v[50:51]
  v_pk_mul_f32 v[36:37], v[36:37], v[52:53]
  v_pk_mul_f32 v[38:39], v[38:39], v[54:55]
  v_pk_mul_f32 v[40:41], v[40:41], v[56:57]
  v_pk_mul_f32 v[42:43], v[42:43], v[58:59]
  v_pk_mul_f32 v[44:45], v[44:45], v[60:61]
  v_pk_mul_f32 v[46:47], v[46:47], v[62:63]
  v_pk_add_f32 v[12:13], v[12:13], v[144:145]
  v_pk_fma_f32 v[14:15], v[144:145], v[144:145], v[14:15]
  v_pk_add_f32 v[12:13], v[12:13], v[146:147]
  v_pk_fma_f32 v[14:15], v[146:147], v[146:147], v[14:15]
  v_pk_fma_f32 v[48:49], v[16:17], v[16:17], s[20:21] neg_lo:[1,0,1] neg_hi:[1,0,1]
  v_pk_fma_f32 v[50:51], v[18:19], v[18:19], s[20:21] neg_lo:[1,0,1] neg_hi:[1,0,1]
  v_pk_fma_f32 v[52:53], v[20:21], v[20:21], s[20:21] neg_lo:[1,0,1] neg_hi:[1,0,1]
  v_pk_fma_f32 v[54:55], v[22:23], v[22:23], s[20:21] neg_lo:[1,0,1] neg_hi:[1,0,1]
  v_pk_fma_f32 v[56:57], v[24:25], v[24:25], s[20:21] neg_lo:[1,0,1] neg_hi:[1,0,1]
  v_pk_fma_f32 v[58:59], v[26:27], v[26:27], s[20:21] neg_lo:[1,0,1] neg_hi:[1,0,1]
  v_pk_fma_f32 v[60:61], v[28:29], v[28:29], s[20:21] neg_lo:[1,0,1] neg_hi:[1,0,1]
  v_pk_fma_f32 v[62:63], v[30:31], v[30:31], s[20:21] neg_lo:[1,0,1] neg_hi:[1,0,1]
  v_pk_mul_f32 v[48:49], v[16:17], v[48:49]
  v_pk_mul_f32 v[50:51], v[18:19], v[50:51]
  v_pk_mul_f32 v[52:53], v[20:21], v[52:53]
  v_pk_mul_f32 v[54:55], v[22:23], v[54:55]
  v_pk_mul_f32 v[56:57], v[24:25], v[56:57]
  v_pk_mul_f32 v[58:59], v[26:27], v[58:59]
  v_pk_mul_f32 v[60:61], v[28:29], v[60:61]
  v_pk_mul_f32 v[62:63], v[30:31], v[62:63]
  v_mfma_f32_16x16x32_bf16 v[148:151], v[216:219], v[220:223], 0
  v_cvt_pk_bf16_f32 v184, v32, v33
  v_cvt_pk_bf16_f32 v185, v34, v35
  v_mfma_f32_16x16x32_bf16 v[148:151], v[224:227], v[228:231], v[148:151]
  v_cvt_pk_bf16_f32 v186, v36, v37
  v_cvt_pk_bf16_f32 v187, v38, v39
  v_mfma_f32_16x16x32_bf16 v[148:151], v[232:235], v[236:239], v[148:151]
  ds_read_b128 v[216:219], v3 offset:4000
  ds_read_b128 v[220:223], v4 offset:160
  v_mfma_f32_32x32x16_bf16 v[64:79], v[192:195], v[184:187], v[64:79]
  ds_read_b128 v[224:227], v3 offset:8800
  ds_read_b128 v[228:231], v4 offset:352
  v_cvt_pk_bf16_f32 v188, v40, v41
  v_cvt_pk_bf16_f32 v189, v42, v43
  v_cvt_pk_bf16_f32 v190, v44, v45
  v_cvt_pk_bf16_f32 v191, v46, v47
  v_mfma_f32_32x32x16_bf16 v[80:95], v[196:199], v[184:187], v[80:95]
  ds_read_b128 v[232:235], v3 offset:13600
  ds_read_b128 v[236:239], v4 offset:544
  v_exp_f32 v48, v48
  v_exp_f32 v49, v49
  v_mfma_f32_32x32x16_bf16 v[96:111], v[200:203], v[184:187], v[96:111]
  v_exp_f32 v50, v50
  v_exp_f32 v51, v51
  v_exp_f32_e64 v52, v52
  v_mfma_f32_32x32x16_bf16 v[64:79], v[204:207], v[188:191], v[64:79]
  v_exp_f32 v53, v53
  v_exp_f32 v54, v54
  v_exp_f32_e64 v55, v55
  v_mfma_f32_32x32x16_bf16 v[80:95], v[208:211], v[188:191], v[80:95]
  v_exp_f32 v56, v56
  v_exp_f32 v57, v57
  v_exp_f32_e64 v58, v58
  v_mfma_f32_32x32x16_bf16 v[96:111], v[212:215], v[188:191], v[96:111]
  s_waitcnt lgkmcnt(0)
  v_exp_f32 v59, v59
  v_exp_f32 v60, v60
  v_exp_f32 v61, v61
  v_exp_f32 v62, v62
  v_exp_f32 v63, v63
  v_pk_add_f32 v[12:13], v[12:13], v[148:149]
  v_pk_fma_f32 v[14:15], v[148:149], v[148:149], v[14:15]
  v_pk_add_f32 v[12:13], v[12:13], v[150:151]
  v_pk_fma_f32 v[14:15], v[150:151], v[150:151], v[14:15]
  v_pk_fma_f32 v[48:49], v[48:49], s[22:23], s[22:23]
  v_pk_fma_f32 v[50:51], v[50:51], s[22:23], s[22:23]
  v_pk_fma_f32 v[52:53], v[52:53], s[22:23], s[22:23]
  v_pk_fma_f32 v[54:55], v[54:55], s[22:23], s[22:23]
  v_pk_fma_f32 v[56:57], v[56:57], s[22:23], s[22:23]
  v_pk_fma_f32 v[58:59], v[58:59], s[22:23], s[22:23]
  v_pk_fma_f32 v[60:61], v[60:61], s[22:23], s[22:23]
  v_pk_fma_f32 v[62:63], v[62:63], s[22:23], s[22:23]
  v_mfma_f32_32x32x16_bf16 v[32:47], a[144:147], v[160:163], 0
  ds_read_b128 v[192:195], v0 offset:36864
  ds_read_b128 v[196:199], v0 offset:37888
  v_rcp_f32 v48, v48
  v_rcp_f32 v49, v49
  v_mfma_f32_16x16x32_bf16 v[152:155], v[216:219], v[220:223], 0
  ds_read_b128 v[216:219], v3 offset:4400
  ds_read_b128 v[220:223], v4 offset:176
  v_mfma_f32_32x32x16_bf16 v[32:47], a[148:151], v[164:167], v[32:47]
  ds_read_b128 v[200:203], v0 offset:38912
  ds_read_b128 v[204:207], v0 offset:39936
  v_rcp_f32 v50, v50
  v_rcp_f32 v51, v51
  v_mfma_f32_16x16x32_bf16 v[152:155], v[224:227], v[228:231], v[152:155]
  ds_read_b128 v[224:227], v3 offset:9200
  ds_read_b128 v[228:231], v4 offset:368
  v_mfma_f32_32x32x16_bf16 v[32:47], a[152:155], v[168:171], v[32:47]
  ds_read_b128 v[208:211], v0 offset:40960
  ds_read_b128 v[212:215], v0 offset:41984
  v_rcp_f32 v52, v52
  v_rcp_f32 v53, v53
  v_mfma_f32_16x16x32_bf16 v[152:155], v[232:235], v[236:239], v[152:155]
  ds_read_b128 v[232:235], v3 offset:14000
  ds_read_b128 v[236:239], v4 offset:560
  v_mfma_f32_32x32x16_bf16 v[32:47], a[156:159], v[172:175], v[32:47]
  v_rcp_f32 v54, v54
  v_rcp_f32 v55, v55
  v_rcp_f32_e64 v56, v56
  v_mfma_f32_32x32x16_bf16 v[32:47], a[160:163], v[176:179], v[32:47]
  v_rcp_f32 v57, v57
  v_rcp_f32 v58, v58
  v_rcp_f32_e64 v59, v59
  v_mfma_f32_32x32x16_bf16 v[32:47], a[164:167], v[180:183], v[32:47]
  s_waitcnt lgkmcnt(0)
  v_rcp_f32 v60, v60
  v_rcp_f32 v61, v61
  v_rcp_f32 v62, v62
  v_rcp_f32_e64 v63, v63
  v_pk_mul_f32 v[16:17], v[16:17], v[48:49]
  v_pk_mul_f32 v[18:19], v[18:19], v[50:51]
  v_pk_mul_f32 v[20:21], v[20:21], v[52:53]
  v_pk_mul_f32 v[22:23], v[22:23], v[54:55]
  v_pk_mul_f32 v[24:25], v[24:25], v[56:57]
  v_pk_mul_f32 v[26:27], v[26:27], v[58:59]
  v_pk_mul_f32 v[28:29], v[28:29], v[60:61]
  v_pk_mul_f32 v[30:31], v[30:31], v[62:63]
  v_pk_add_f32 v[12:13], v[12:13], v[152:153]
  v_pk_fma_f32 v[14:15], v[152:153], v[152:153], v[14:15]
  v_pk_add_f32 v[12:13], v[12:13], v[154:155]
  v_pk_fma_f32 v[14:15], v[154:155], v[154:155], v[14:15]
  v_pk_fma_f32 v[48:49], v[32:33], v[32:33], s[20:21] neg_lo:[1,0,1] neg_hi:[1,0,1]
  v_pk_fma_f32 v[50:51], v[34:35], v[34:35], s[20:21] neg_lo:[1,0,1] neg_hi:[1,0,1]
  v_pk_fma_f32 v[52:53], v[36:37], v[36:37], s[20:21] neg_lo:[1,0,1] neg_hi:[1,0,1]
  v_pk_fma_f32 v[54:55], v[38:39], v[38:39], s[20:21] neg_lo:[1,0,1] neg_hi:[1,0,1]
  v_pk_fma_f32 v[56:57], v[40:41], v[40:41], s[20:21] neg_lo:[1,0,1] neg_hi:[1,0,1]
  v_pk_fma_f32 v[58:59], v[42:43], v[42:43], s[20:21] neg_lo:[1,0,1] neg_hi:[1,0,1]
  v_pk_fma_f32 v[60:61], v[44:45], v[44:45], s[20:21] neg_lo:[1,0,1] neg_hi:[1,0,1]
  v_pk_fma_f32 v[62:63], v[46:47], v[46:47], s[20:21] neg_lo:[1,0,1] neg_hi:[1,0,1]
  v_pk_mul_f32 v[48:49], v[32:33], v[48:49]
  v_pk_mul_f32 v[50:51], v[34:35], v[50:51]
  v_pk_mul_f32 v[52:53], v[36:37], v[52:53]
  v_pk_mul_f32 v[54:55], v[38:39], v[54:55]
  v_pk_mul_f32 v[56:57], v[40:41], v[56:57]
  v_pk_mul_f32 v[58:59], v[42:43], v[58:59]
  v_pk_mul_f32 v[60:61], v[44:45], v[60:61]
  v_pk_mul_f32 v[62:63], v[46:47], v[62:63]
  v_mfma_f32_16x16x32_bf16 v[156:159], v[216:219], v[220:223], 0
  v_cvt_pk_bf16_f32 v184, v16, v17
  v_cvt_pk_bf16_f32 v185, v18, v19
  v_mfma_f32_16x16x32_bf16 v[156:159], v[224:227], v[228:231], v[156:159]
  v_cvt_pk_bf16_f32 v186, v20, v21
  v_cvt_pk_bf16_f32 v187, v22, v23
  v_mfma_f32_16x16x32_bf16 v[156:159], v[232:235], v[236:239], v[156:159]
  ds_read_b128 v[216:219], v3
  ds_read_b128 v[220:223], v4
  v_mfma_f32_32x32x16_bf16 v[64:79], v[192:195], v[184:187], v[64:79]
  ds_read_b128 v[224:227], v3 offset:4800
  ds_read_b128 v[228:231], v4 offset:192
  v_cvt_pk_bf16_f32 v188, v24, v25
  v_cvt_pk_bf16_f32 v189, v26, v27
  v_cvt_pk_bf16_f32 v190, v28, v29
  v_cvt_pk_bf16_f32 v191, v30, v31
  v_mfma_f32_32x32x16_bf16 v[80:95], v[196:199], v[184:187], v[80:95]
  ds_read_b128 v[232:235], v3 offset:9600
  ds_read_b128 v[236:239], v4 offset:384
  v_exp_f32 v48, v48
  v_exp_f32 v49, v49
  v_mfma_f32_32x32x16_bf16 v[96:111], v[200:203], v[184:187], v[96:111]
  v_exp_f32 v50, v50
  v_exp_f32 v51, v51
  v_exp_f32_e64 v52, v52
  v_mfma_f32_32x32x16_bf16 v[64:79], v[204:207], v[188:191], v[64:79]
  v_exp_f32 v53, v53
  v_exp_f32 v54, v54
  v_exp_f32_e64 v55, v55
  v_mfma_f32_32x32x16_bf16 v[80:95], v[208:211], v[188:191], v[80:95]
  v_exp_f32 v56, v56
  v_exp_f32 v57, v57
  v_exp_f32_e64 v58, v58
  v_mfma_f32_32x32x16_bf16 v[96:111], v[212:215], v[188:191], v[96:111]
  s_waitcnt lgkmcnt(0)
  v_exp_f32 v59, v59
  v_exp_f32 v60, v60
  v_exp_f32 v61, v61
  v_exp_f32 v62, v62
  v_exp_f32 v63, v63
  v_pk_add_f32 v[12:13], v[12:13], v[156:157]
  v_pk_fma_f32 v[14:15], v[156:157], v[156:157], v[14:15]
  v_pk_add_f32 v[12:13], v[12:13], v[158:159]
  v_pk_fma_f32 v[14:15], v[158:159], v[158:159], v[14:15]
  v_pk_fma_f32 v[48:49], v[48:49], s[22:23], s[22:23]
  v_pk_fma_f32 v[50:51], v[50:51], s[22:23], s[22:23]
  v_pk_fma_f32 v[52:53], v[52:53], s[22:23], s[22:23]
  v_pk_fma_f32 v[54:55], v[54:55], s[22:23], s[22:23]
  v_pk_fma_f32 v[56:57], v[56:57], s[22:23], s[22:23]
  v_pk_fma_f32 v[58:59], v[58:59], s[22:23], s[22:23]
  v_pk_fma_f32 v[60:61], v[60:61], s[22:23], s[22:23]
  v_pk_fma_f32 v[62:63], v[62:63], s[22:23], s[22:23]
  v_mfma_f32_32x32x16_bf16 v[16:31], a[168:171], v[160:163], 0
  ds_read_b128 v[192:195], v0 offset:43008
  ds_read_b128 v[196:199], v0 offset:44032
  v_rcp_f32 v48, v48
  v_rcp_f32 v49, v49
  v_mfma_f32_16x16x32_bf16 v[112:115], v[216:219], v[220:223], 0
  ds_read_b128 v[216:219], v3 offset:400
  ds_read_b128 v[220:223], v4 offset:16
  v_mfma_f32_32x32x16_bf16 v[16:31], a[172:175], v[164:167], v[16:31]
  ds_read_b128 v[200:203], v0 offset:45056
  ds_read_b128 v[204:207], v0 offset:46080
  v_rcp_f32 v50, v50
  v_rcp_f32 v51, v51
  v_mfma_f32_16x16x32_bf16 v[112:115], v[224:227], v[228:231], v[112:115]
  ds_read_b128 v[224:227], v3 offset:5200
  ds_read_b128 v[228:231], v4 offset:208
  v_mfma_f32_32x32x16_bf16 v[16:31], a[176:179], v[168:171], v[16:31]
  ds_read_b128 v[208:211], v0 offset:47104
  ds_read_b128 v[212:215], v0 offset:48128
  v_rcp_f32 v52, v52
  v_rcp_f32 v53, v53
  v_mfma_f32_16x16x32_bf16 v[112:115], v[232:235], v[236:239], v[112:115]
  ds_read_b128 v[232:235], v3 offset:10000
  ds_read_b128 v[236:239], v4 offset:400
  v_mfma_f32_32x32x16_bf16 v[16:31], a[180:183], v[172:175], v[16:31]
  v_rcp_f32 v54, v54
  v_rcp_f32 v55, v55
  v_rcp_f32_e64 v56, v56
  v_mfma_f32_32x32x16_bf16 v[16:31], a[184:187], v[176:179], v[16:31]
  v_rcp_f32 v57, v57
  v_rcp_f32 v58, v58
  v_rcp_f32_e64 v59, v59
  v_mfma_f32_32x32x16_bf16 v[16:31], a[188:191], v[180:183], v[16:31]
  s_waitcnt lgkmcnt(0)
  v_rcp_f32 v60, v60
  v_rcp_f32 v61, v61
  v_rcp_f32 v62, v62
  v_rcp_f32_e64 v63, v63
  v_pk_mul_f32 v[32:33], v[32:33], v[48:49]
  v_pk_mul_f32 v[34:35], v[34:35], v[50:51]
  v_pk_mul_f32 v[36:37], v[36:37], v[52:53]
  v_pk_mul_f32 v[38:39], v[38:39], v[54:55]
  v_pk_mul_f32 v[40:41], v[40:41], v[56:57]
  v_pk_mul_f32 v[42:43], v[42:43], v[58:59]
  v_pk_mul_f32 v[44:45], v[44:45], v[60:61]
  v_pk_mul_f32 v[46:47], v[46:47], v[62:63]
  v_pk_add_f32 v[12:13], v[12:13], v[112:113]
  v_pk_fma_f32 v[14:15], v[112:113], v[112:113], v[14:15]
  v_pk_add_f32 v[12:13], v[12:13], v[114:115]
  v_pk_fma_f32 v[14:15], v[114:115], v[114:115], v[14:15]
  v_pk_fma_f32 v[48:49], v[16:17], v[16:17], s[20:21] neg_lo:[1,0,1] neg_hi:[1,0,1]
  v_pk_fma_f32 v[50:51], v[18:19], v[18:19], s[20:21] neg_lo:[1,0,1] neg_hi:[1,0,1]
  v_pk_fma_f32 v[52:53], v[20:21], v[20:21], s[20:21] neg_lo:[1,0,1] neg_hi:[1,0,1]
  v_pk_fma_f32 v[54:55], v[22:23], v[22:23], s[20:21] neg_lo:[1,0,1] neg_hi:[1,0,1]
  v_pk_fma_f32 v[56:57], v[24:25], v[24:25], s[20:21] neg_lo:[1,0,1] neg_hi:[1,0,1]
  v_pk_fma_f32 v[58:59], v[26:27], v[26:27], s[20:21] neg_lo:[1,0,1] neg_hi:[1,0,1]
  v_pk_fma_f32 v[60:61], v[28:29], v[28:29], s[20:21] neg_lo:[1,0,1] neg_hi:[1,0,1]
  v_pk_fma_f32 v[62:63], v[30:31], v[30:31], s[20:21] neg_lo:[1,0,1] neg_hi:[1,0,1]
  v_pk_mul_f32 v[48:49], v[16:17], v[48:49]
  v_pk_mul_f32 v[50:51], v[18:19], v[50:51]
  v_pk_mul_f32 v[52:53], v[20:21], v[52:53]
  v_pk_mul_f32 v[54:55], v[22:23], v[54:55]
  v_pk_mul_f32 v[56:57], v[24:25], v[56:57]
  v_pk_mul_f32 v[58:59], v[26:27], v[58:59]
  v_pk_mul_f32 v[60:61], v[28:29], v[60:61]
  v_pk_mul_f32 v[62:63], v[30:31], v[62:63]
  v_mfma_f32_16x16x32_bf16 v[116:119], v[216:219], v[220:223], 0
  v_cvt_pk_bf16_f32 v184, v32, v33
  v_cvt_pk_bf16_f32 v185, v34, v35
  v_mfma_f32_16x16x32_bf16 v[116:119], v[224:227], v[228:231], v[116:119]
  v_cvt_pk_bf16_f32 v186, v36, v37
  v_cvt_pk_bf16_f32 v187, v38, v39
  v_mfma_f32_16x16x32_bf16 v[116:119], v[232:235], v[236:239], v[116:119]
  ds_read_b128 v[216:219], v3 offset:800
  ds_read_b128 v[220:223], v4 offset:32
  v_mfma_f32_32x32x16_bf16 v[64:79], v[192:195], v[184:187], v[64:79]
  ds_read_b128 v[224:227], v3 offset:5600
  ds_read_b128 v[228:231], v4 offset:224
  v_cvt_pk_bf16_f32 v188, v40, v41
  v_cvt_pk_bf16_f32 v189, v42, v43
  v_cvt_pk_bf16_f32 v190, v44, v45
  v_cvt_pk_bf16_f32 v191, v46, v47
  v_mfma_f32_32x32x16_bf16 v[80:95], v[196:199], v[184:187], v[80:95]
  ds_read_b128 v[232:235], v3 offset:10400
  ds_read_b128 v[236:239], v4 offset:416
  v_exp_f32 v48, v48
  v_exp_f32 v49, v49
  v_mfma_f32_32x32x16_bf16 v[96:111], v[200:203], v[184:187], v[96:111]
  v_exp_f32 v50, v50
  v_exp_f32 v51, v51
  v_exp_f32_e64 v52, v52
  v_mfma_f32_32x32x16_bf16 v[64:79], v[204:207], v[188:191], v[64:79]
  v_exp_f32 v53, v53
  v_exp_f32 v54, v54
  v_exp_f32_e64 v55, v55
  v_mfma_f32_32x32x16_bf16 v[80:95], v[208:211], v[188:191], v[80:95]
  v_exp_f32 v56, v56
  v_exp_f32 v57, v57
  v_exp_f32_e64 v58, v58
  v_mfma_f32_32x32x16_bf16 v[96:111], v[212:215], v[188:191], v[96:111]
  s_waitcnt lgkmcnt(0)
  v_exp_f32 v59, v59
  v_exp_f32 v60, v60
  v_exp_f32 v61, v61
  v_exp_f32 v62, v62
  v_exp_f32 v63, v63
  v_pk_add_f32 v[12:13], v[12:13], v[116:117]
  v_pk_fma_f32 v[14:15], v[116:117], v[116:117], v[14:15]
  v_pk_add_f32 v[12:13], v[12:13], v[118:119]
  v_pk_fma_f32 v[14:15], v[118:119], v[118:119], v[14:15]
  v_pk_fma_f32 v[48:49], v[48:49], s[22:23], s[22:23]
  v_pk_fma_f32 v[50:51], v[50:51], s[22:23], s[22:23]
  v_pk_fma_f32 v[52:53], v[52:53], s[22:23], s[22:23]
  v_pk_fma_f32 v[54:55], v[54:55], s[22:23], s[22:23]
  v_pk_fma_f32 v[56:57], v[56:57], s[22:23], s[22:23]
  v_pk_fma_f32 v[58:59], v[58:59], s[22:23], s[22:23]
  v_pk_fma_f32 v[60:61], v[60:61], s[22:23], s[22:23]
  v_pk_fma_f32 v[62:63], v[62:63], s[22:23], s[22:23]
  v_mfma_f32_32x32x16_bf16 v[32:47], a[192:195], v[160:163], 0
  ds_read_b128 v[192:195], v0 offset:49152
  ds_read_b128 v[196:199], v0 offset:50176
  v_rcp_f32 v48, v48
  v_rcp_f32 v49, v49
  v_mfma_f32_16x16x32_bf16 v[120:123], v[216:219], v[220:223], 0
  ds_read_b128 v[216:219], v3 offset:1200
  ds_read_b128 v[220:223], v4 offset:48
  v_mfma_f32_32x32x16_bf16 v[32:47], a[196:199], v[164:167], v[32:47]
  ds_read_b128 v[200:203], v0 offset:51200
  ds_read_b128 v[204:207], v0 offset:52224
  v_rcp_f32 v50, v50
  v_rcp_f32 v51, v51
  v_mfma_f32_16x16x32_bf16 v[120:123], v[224:227], v[228:231], v[120:123]
  ds_read_b128 v[224:227], v3 offset:6000
  ds_read_b128 v[228:231], v4 offset:240
  v_mfma_f32_32x32x16_bf16 v[32:47], a[200:203], v[168:171], v[32:47]
  ds_read_b128 v[208:211], v0 offset:53248
  ds_read_b128 v[212:215], v0 offset:54272
  v_rcp_f32 v52, v52
  v_rcp_f32 v53, v53
  v_mfma_f32_16x16x32_bf16 v[120:123], v[232:235], v[236:239], v[120:123]
  ds_read_b128 v[232:235], v3 offset:10800
  ds_read_b128 v[236:239], v4 offset:432
  v_mfma_f32_32x32x16_bf16 v[32:47], a[204:207], v[172:175], v[32:47]
  v_rcp_f32 v54, v54
  v_rcp_f32 v55, v55
  v_rcp_f32_e64 v56, v56
  v_mfma_f32_32x32x16_bf16 v[32:47], a[208:211], v[176:179], v[32:47]
  v_rcp_f32 v57, v57
  v_rcp_f32 v58, v58
  v_rcp_f32_e64 v59, v59
  v_mfma_f32_32x32x16_bf16 v[32:47], a[212:215], v[180:183], v[32:47]
  s_waitcnt lgkmcnt(0)
  v_rcp_f32 v60, v60
  v_rcp_f32 v61, v61
  v_rcp_f32 v62, v62
  v_rcp_f32_e64 v63, v63
  v_pk_mul_f32 v[16:17], v[16:17], v[48:49]
  v_pk_mul_f32 v[18:19], v[18:19], v[50:51]
  v_pk_mul_f32 v[20:21], v[20:21], v[52:53]
  v_pk_mul_f32 v[22:23], v[22:23], v[54:55]
  v_pk_mul_f32 v[24:25], v[24:25], v[56:57]
  v_pk_mul_f32 v[26:27], v[26:27], v[58:59]
  v_pk_mul_f32 v[28:29], v[28:29], v[60:61]
  v_pk_mul_f32 v[30:31], v[30:31], v[62:63]
  v_pk_add_f32 v[12:13], v[12:13], v[120:121]
  v_pk_fma_f32 v[14:15], v[120:121], v[120:121], v[14:15]
  v_pk_add_f32 v[12:13], v[12:13], v[122:123]
  v_pk_fma_f32 v[14:15], v[122:123], v[122:123], v[14:15]
  v_pk_fma_f32 v[48:49], v[32:33], v[32:33], s[20:21] neg_lo:[1,0,1] neg_hi:[1,0,1]
  v_pk_fma_f32 v[50:51], v[34:35], v[34:35], s[20:21] neg_lo:[1,0,1] neg_hi:[1,0,1]
  v_pk_fma_f32 v[52:53], v[36:37], v[36:37], s[20:21] neg_lo:[1,0,1] neg_hi:[1,0,1]
  v_pk_fma_f32 v[54:55], v[38:39], v[38:39], s[20:21] neg_lo:[1,0,1] neg_hi:[1,0,1]
  v_pk_fma_f32 v[56:57], v[40:41], v[40:41], s[20:21] neg_lo:[1,0,1] neg_hi:[1,0,1]
  v_pk_fma_f32 v[58:59], v[42:43], v[42:43], s[20:21] neg_lo:[1,0,1] neg_hi:[1,0,1]
  v_pk_fma_f32 v[60:61], v[44:45], v[44:45], s[20:21] neg_lo:[1,0,1] neg_hi:[1,0,1]
  v_pk_fma_f32 v[62:63], v[46:47], v[46:47], s[20:21] neg_lo:[1,0,1] neg_hi:[1,0,1]
  v_pk_mul_f32 v[48:49], v[32:33], v[48:49]
  v_pk_mul_f32 v[50:51], v[34:35], v[50:51]
  v_pk_mul_f32 v[52:53], v[36:37], v[52:53]
  v_pk_mul_f32 v[54:55], v[38:39], v[54:55]
  v_pk_mul_f32 v[56:57], v[40:41], v[56:57]
  v_pk_mul_f32 v[58:59], v[42:43], v[58:59]
  v_pk_mul_f32 v[60:61], v[44:45], v[60:61]
  v_pk_mul_f32 v[62:63], v[46:47], v[62:63]
  v_mfma_f32_16x16x32_bf16 v[124:127], v[216:219], v[220:223], 0
  v_cvt_pk_bf16_f32 v184, v16, v17
  v_cvt_pk_bf16_f32 v185, v18, v19
  v_mfma_f32_16x16x32_bf16 v[124:127], v[224:227], v[228:231], v[124:127]
  v_cvt_pk_bf16_f32 v186, v20, v21
  v_cvt_pk_bf16_f32 v187, v22, v23
  v_mfma_f32_16x16x32_bf16 v[124:127], v[232:235], v[236:239], v[124:127]
  ds_read_b128 v[216:219], v3 offset:1600
  ds_read_b128 v[220:223], v4 offset:64
  v_mfma_f32_32x32x16_bf16 v[64:79], v[192:195], v[184:187], v[64:79]
  ds_read_b128 v[224:227], v3 offset:6400
  ds_read_b128 v[228:231], v4 offset:256
  v_cvt_pk_bf16_f32 v188, v24, v25
  v_cvt_pk_bf16_f32 v189, v26, v27
  v_cvt_pk_bf16_f32 v190, v28, v29
  v_cvt_pk_bf16_f32 v191, v30, v31
  v_mfma_f32_32x32x16_bf16 v[80:95], v[196:199], v[184:187], v[80:95]
  ds_read_b128 v[232:235], v3 offset:11200
  ds_read_b128 v[236:239], v4 offset:448
  v_exp_f32 v48, v48
  v_exp_f32 v49, v49
  v_mfma_f32_32x32x16_bf16 v[96:111], v[200:203], v[184:187], v[96:111]
  v_exp_f32 v50, v50
  v_exp_f32 v51, v51
  v_exp_f32_e64 v52, v52
  v_mfma_f32_32x32x16_bf16 v[64:79], v[204:207], v[188:191], v[64:79]
  v_exp_f32 v53, v53
  v_exp_f32 v54, v54
  v_exp_f32_e64 v55, v55
  v_mfma_f32_32x32x16_bf16 v[80:95], v[208:211], v[188:191], v[80:95]
  v_exp_f32 v56, v56
  v_exp_f32 v57, v57
  v_exp_f32_e64 v58, v58
  v_mfma_f32_32x32x16_bf16 v[96:111], v[212:215], v[188:191], v[96:111]
  s_waitcnt lgkmcnt(0)
  v_exp_f32 v59, v59
  v_exp_f32 v60, v60
  v_exp_f32 v61, v61
  v_exp_f32 v62, v62
  v_exp_f32 v63, v63
  v_pk_add_f32 v[12:13], v[12:13], v[124:125]
  v_pk_fma_f32 v[14:15], v[124:125], v[124:125], v[14:15]
  v_pk_add_f32 v[12:13], v[12:13], v[126:127]
  v_pk_fma_f32 v[14:15], v[126:127], v[126:127], v[14:15]
  v_pk_fma_f32 v[48:49], v[48:49], s[22:23], s[22:23]
  v_pk_fma_f32 v[50:51], v[50:51], s[22:23], s[22:23]
  v_pk_fma_f32 v[52:53], v[52:53], s[22:23], s[22:23]
  v_pk_fma_f32 v[54:55], v[54:55], s[22:23], s[22:23]
  v_pk_fma_f32 v[56:57], v[56:57], s[22:23], s[22:23]
  v_pk_fma_f32 v[58:59], v[58:59], s[22:23], s[22:23]
  v_pk_fma_f32 v[60:61], v[60:61], s[22:23], s[22:23]
  v_pk_fma_f32 v[62:63], v[62:63], s[22:23], s[22:23]
  v_mfma_f32_32x32x16_bf16 v[16:31], a[216:219], v[160:163], 0
  ds_read_b128 v[192:195], v0 offset:55296
  ds_read_b128 v[196:199], v0 offset:56320
  v_rcp_f32 v48, v48
  v_rcp_f32 v49, v49
  v_mfma_f32_16x16x32_bf16 v[128:131], v[216:219], v[220:223], 0
  ds_read_b128 v[216:219], v3 offset:2000
  ds_read_b128 v[220:223], v4 offset:80
  v_mfma_f32_32x32x16_bf16 v[16:31], a[220:223], v[164:167], v[16:31]
  ds_read_b128 v[200:203], v0 offset:57344
  ds_read_b128 v[204:207], v0 offset:58368
  v_rcp_f32 v50, v50
  v_rcp_f32 v51, v51
  v_mfma_f32_16x16x32_bf16 v[128:131], v[224:227], v[228:231], v[128:131]
  ds_read_b128 v[224:227], v3 offset:6800
  ds_read_b128 v[228:231], v4 offset:272
  v_mfma_f32_32x32x16_bf16 v[16:31], a[224:227], v[168:171], v[16:31]
  ds_read_b128 v[208:211], v0 offset:59392
  ds_read_b128 v[212:215], v0 offset:60416
  v_rcp_f32 v52, v52
  v_rcp_f32 v53, v53
  v_mfma_f32_16x16x32_bf16 v[128:131], v[232:235], v[236:239], v[128:131]
  ds_read_b128 v[232:235], v3 offset:11600
  ds_read_b128 v[236:239], v4 offset:464
  v_mfma_f32_32x32x16_bf16 v[16:31], a[228:231], v[172:175], v[16:31]
  v_rcp_f32 v54, v54
  v_rcp_f32 v55, v55
  v_rcp_f32_e64 v56, v56
  v_mfma_f32_32x32x16_bf16 v[16:31], a[232:235], v[176:179], v[16:31]
  v_rcp_f32 v57, v57
  v_rcp_f32 v58, v58
  v_rcp_f32_e64 v59, v59
  v_mfma_f32_32x32x16_bf16 v[16:31], a[236:239], v[180:183], v[16:31]
  s_waitcnt lgkmcnt(0)
  v_rcp_f32 v60, v60
  v_rcp_f32 v61, v61
  v_rcp_f32 v62, v62
  v_rcp_f32_e64 v63, v63
  v_pk_mul_f32 v[32:33], v[32:33], v[48:49]
  v_pk_mul_f32 v[34:35], v[34:35], v[50:51]
  v_pk_mul_f32 v[36:37], v[36:37], v[52:53]
  v_pk_mul_f32 v[38:39], v[38:39], v[54:55]
  v_pk_mul_f32 v[40:41], v[40:41], v[56:57]
  v_pk_mul_f32 v[42:43], v[42:43], v[58:59]
  v_pk_mul_f32 v[44:45], v[44:45], v[60:61]
  v_pk_mul_f32 v[46:47], v[46:47], v[62:63]
  v_pk_add_f32 v[12:13], v[12:13], v[128:129]
  v_pk_fma_f32 v[14:15], v[128:129], v[128:129], v[14:15]
  v_pk_add_f32 v[12:13], v[12:13], v[130:131]
  v_pk_fma_f32 v[14:15], v[130:131], v[130:131], v[14:15]
  v_pk_fma_f32 v[48:49], v[16:17], v[16:17], s[20:21] neg_lo:[1,0,1] neg_hi:[1,0,1]
  v_pk_fma_f32 v[50:51], v[18:19], v[18:19], s[20:21] neg_lo:[1,0,1] neg_hi:[1,0,1]
  v_pk_fma_f32 v[52:53], v[20:21], v[20:21], s[20:21] neg_lo:[1,0,1] neg_hi:[1,0,1]
  v_pk_fma_f32 v[54:55], v[22:23], v[22:23], s[20:21] neg_lo:[1,0,1] neg_hi:[1,0,1]
  v_pk_fma_f32 v[56:57], v[24:25], v[24:25], s[20:21] neg_lo:[1,0,1] neg_hi:[1,0,1]
  v_pk_fma_f32 v[58:59], v[26:27], v[26:27], s[20:21] neg_lo:[1,0,1] neg_hi:[1,0,1]
  v_pk_fma_f32 v[60:61], v[28:29], v[28:29], s[20:21] neg_lo:[1,0,1] neg_hi:[1,0,1]
  v_pk_fma_f32 v[62:63], v[30:31], v[30:31], s[20:21] neg_lo:[1,0,1] neg_hi:[1,0,1]
  v_pk_mul_f32 v[48:49], v[16:17], v[48:49]
  v_pk_mul_f32 v[50:51], v[18:19], v[50:51]
  v_pk_mul_f32 v[52:53], v[20:21], v[52:53]
  v_pk_mul_f32 v[54:55], v[22:23], v[54:55]
  v_pk_mul_f32 v[56:57], v[24:25], v[56:57]
  v_pk_mul_f32 v[58:59], v[26:27], v[58:59]
  v_pk_mul_f32 v[60:61], v[28:29], v[60:61]
  v_pk_mul_f32 v[62:63], v[30:31], v[62:63]
  v_mfma_f32_16x16x32_bf16 v[132:135], v[216:219], v[220:223], 0
  v_cvt_pk_bf16_f32 v184, v32, v33
  v_cvt_pk_bf16_f32 v185, v34, v35
  v_mfma_f32_16x16x32_bf16 v[132:135], v[224:227], v[228:231], v[132:135]
  v_cvt_pk_bf16_f32 v186, v36, v37
  v_cvt_pk_bf16_f32 v187, v38, v39
  v_mfma_f32_16x16x32_bf16 v[132:135], v[232:235], v[236:239], v[132:135]
  ds_read_b128 v[216:219], v0
  ds_read_b128 v[220:223], v0 offset:1024
  v_mfma_f32_32x32x16_bf16 v[64:79], v[192:195], v[184:187], v[64:79]
  ds_read_b128 v[224:227], v0 offset:4096
  ds_read_b128 v[228:231], v0 offset:5120
  v_cvt_pk_bf16_f32 v188, v40, v41
  v_cvt_pk_bf16_f32 v189, v42, v43
  v_cvt_pk_bf16_f32 v190, v44, v45
  v_cvt_pk_bf16_f32 v191, v46, v47
  v_mfma_f32_32x32x16_bf16 v[80:95], v[196:199], v[184:187], v[80:95]
  ds_read_b128 v[232:235], v0 offset:8192
  ds_read_b128 v[236:239], v0 offset:9216
  v_exp_f32 v48, v48
  v_exp_f32 v49, v49
  v_mfma_f32_32x32x16_bf16 v[96:111], v[200:203], v[184:187], v[96:111]
  v_exp_f32 v50, v50
  v_exp_f32 v51, v51
  v_exp_f32_e64 v52, v52
  v_mfma_f32_32x32x16_bf16 v[64:79], v[204:207], v[188:191], v[64:79]
  s_mov_b32 s28, s34
  v_exp_f32 v53, v53
  v_exp_f32 v54, v54
  v_exp_f32 v55, v55
  v_mfma_f32_32x32x16_bf16 v[80:95], v[208:211], v[188:191], v[80:95]
  s_add_u32 s34, s34, 0x60000
  v_exp_f32 v56, v56
  v_exp_f32 v57, v57
  v_exp_f32_e64 v58, v58
  v_mfma_f32_32x32x16_bf16 v[96:111], v[212:215], v[188:191], v[96:111]
  s_waitcnt lgkmcnt(0)
  v_exp_f32 v59, v59
  v_exp_f32 v60, v60
  v_exp_f32 v61, v61
  v_exp_f32 v62, v62
  v_exp_f32 v63, v63
  v_pk_add_f32 v[12:13], v[12:13], v[132:133]
  v_pk_fma_f32 v[14:15], v[132:133], v[132:133], v[14:15]
  v_pk_add_f32 v[12:13], v[12:13], v[134:135]
  v_pk_fma_f32 v[14:15], v[134:135], v[134:135], v[14:15]
  v_pk_fma_f32 v[48:49], v[48:49], s[22:23], s[22:23]
  v_pk_fma_f32 v[50:51], v[50:51], s[22:23], s[22:23]
  v_pk_fma_f32 v[52:53], v[52:53], s[22:23], s[22:23]
  v_pk_fma_f32 v[54:55], v[54:55], s[22:23], s[22:23]
  v_pk_fma_f32 v[56:57], v[56:57], s[22:23], s[22:23]
  v_pk_fma_f32 v[58:59], v[58:59], s[22:23], s[22:23]
  v_pk_fma_f32 v[60:61], v[60:61], s[22:23], s[22:23]
  v_pk_fma_f32 v[62:63], v[62:63], s[22:23], s[22:23]
  v_mfma_f32_32x32x16_bf16 v[32:47], v[216:219], v[160:163], 0
  ds_read_b128 v[192:195], v0 offset:61440
  ds_read_b128 v[196:199], v0 offset:62464
  v_rcp_f32 v48, v48
  v_rcp_f32 v49, v49
  v_add_f32_e64 v12, v12, v13
  v_mfma_f32_32x32x16_bf16 v[32:47], v[220:223], v[164:167], v[32:47]
  ds_read_b128 v[200:203], v0 offset:63488
  ds_read_b128 v[204:207], v0 offset:64512
  v_rcp_f32 v50, v50
  v_add_f32 v14, v14, v15
  v_rcp_f32_e64 v51, v51
  v_mfma_f32_32x32x16_bf16 v[32:47], v[224:227], v[168:171], v[32:47]
  ds_read_b128 v[208:211], v1
  ds_read_b128 v[212:215], v1 offset:1024
  v_permlane32_swap_b32 v12, v14
  v_rcp_f32 v52, v52
  v_add_f32 v12, v12, v14
  v_rcp_f32 v53, v53
  v_mfma_f32_32x32x16_bf16 v[32:47], v[228:231], v[172:175], v[32:47]
  v_mov_b32 v14, v12
  v_rcp_f32 v54, v54
  s_nop 0
  v_permlane32_swap_b32 v12, v14
  v_rcp_f32 v55, v55
  v_mul_f32 v12, s24, v12
  v_mfma_f32_32x32x16_bf16 v[32:47], v[232:235], v[176:179], v[32:47]
  v_rcp_f32 v56, v56
  v_rcp_f32 v57, v57
  v_mul_f32 v13, s24, v14
  v_rcp_f32 v58, v58
  v_fma_f32 v13, -v12, v12, v13
  v_mfma_f32_32x32x16_bf16 v[32:47], v[236:239], v[180:183], v[32:47]
  s_waitcnt lgkmcnt(0)
  v_rcp_f32 v59, v59
  v_max_f32 v13, 0, v13
  v_rcp_f32 v60, v60
  v_add_f32 v13, s25, v13
  v_rcp_f32 v61, v61
  v_rsq_f32 v13, v13
  v_rcp_f32 v62, v62
  v_mul_f32 v14, s22, v13
  v_rcp_f32 v63, v63
  v_mul_f32_e64 v12, -v12, v14
  v_pk_mul_f32 v[16:17], v[16:17], v[48:49]
  v_pk_mul_f32 v[18:19], v[18:19], v[50:51]
  v_pk_mul_f32 v[20:21], v[20:21], v[52:53]
  v_pk_mul_f32 v[22:23], v[22:23], v[54:55]
  v_pk_mul_f32 v[24:25], v[24:25], v[56:57]
  v_pk_mul_f32 v[26:27], v[26:27], v[58:59]
  v_pk_mul_f32 v[28:29], v[28:29], v[60:61]
  v_pk_mul_f32 v[30:31], v[30:31], v[62:63]
  v_pk_fma_f32 v[112:113], v[112:113], v[14:15], v[12:13] op_sel_hi:[1,0,0]
  v_pk_fma_f32 v[114:115], v[114:115], v[14:15], v[12:13] op_sel_hi:[1,0,0]
  v_pk_fma_f32 v[116:117], v[116:117], v[14:15], v[12:13] op_sel_hi:[1,0,0]
  v_pk_fma_f32 v[118:119], v[118:119], v[14:15], v[12:13] op_sel_hi:[1,0,0]
  v_pk_fma_f32 v[120:121], v[120:121], v[14:15], v[12:13] op_sel_hi:[1,0,0]
  v_pk_fma_f32 v[122:123], v[122:123], v[14:15], v[12:13] op_sel_hi:[1,0,0]
  v_pk_fma_f32 v[124:125], v[124:125], v[14:15], v[12:13] op_sel_hi:[1,0,0]
  v_pk_fma_f32 v[126:127], v[126:127], v[14:15], v[12:13] op_sel_hi:[1,0,0]
  v_pk_fma_f32 v[128:129], v[128:129], v[14:15], v[12:13] op_sel_hi:[1,0,0]
  v_pk_fma_f32 v[130:131], v[130:131], v[14:15], v[12:13] op_sel_hi:[1,0,0]
  v_pk_fma_f32 v[132:133], v[132:133], v[14:15], v[12:13] op_sel_hi:[1,0,0]
  v_pk_fma_f32 v[134:135], v[134:135], v[14:15], v[12:13] op_sel_hi:[1,0,0]
  v_pk_fma_f32 v[136:137], v[136:137], v[14:15], v[12:13] op_sel_hi:[1,0,0]
  v_pk_fma_f32 v[138:139], v[138:139], v[14:15], v[12:13] op_sel_hi:[1,0,0]
  v_pk_fma_f32 v[140:141], v[140:141], v[14:15], v[12:13] op_sel_hi:[1,0,0]
  v_pk_fma_f32 v[142:143], v[142:143], v[14:15], v[12:13] op_sel_hi:[1,0,0]
  v_pk_fma_f32 v[144:145], v[144:145], v[14:15], v[12:13] op_sel_hi:[1,0,0]
  v_pk_fma_f32 v[146:147], v[146:147], v[14:15], v[12:13] op_sel_hi:[1,0,0]
  v_pk_fma_f32 v[148:149], v[148:149], v[14:15], v[12:13] op_sel_hi:[1,0,0]
  v_pk_fma_f32 v[150:151], v[150:151], v[14:15], v[12:13] op_sel_hi:[1,0,0]
  v_pk_fma_f32 v[152:153], v[152:153], v[14:15], v[12:13] op_sel_hi:[1,0,0]
  v_pk_fma_f32 v[154:155], v[154:155], v[14:15], v[12:13] op_sel_hi:[1,0,0]
  v_pk_fma_f32 v[156:157], v[156:157], v[14:15], v[12:13] op_sel_hi:[1,0,0]
  v_pk_fma_f32 v[158:159], v[158:159], v[14:15], v[12:13] op_sel_hi:[1,0,0]
  v_pk_fma_f32 v[48:49], v[32:33], v[32:33], s[20:21] neg_lo:[1,0,1] neg_hi:[1,0,1]
  v_pk_fma_f32 v[50:51], v[34:35], v[34:35], s[20:21] neg_lo:[1,0,1] neg_hi:[1,0,1]
  v_pk_fma_f32 v[52:53], v[36:37], v[36:37], s[20:21] neg_lo:[1,0,1] neg_hi:[1,0,1]
  v_pk_fma_f32 v[54:55], v[38:39], v[38:39], s[20:21] neg_lo:[1,0,1] neg_hi:[1,0,1]
  v_pk_fma_f32 v[56:57], v[40:41], v[40:41], s[20:21] neg_lo:[1,0,1] neg_hi:[1,0,1]
  v_pk_fma_f32 v[58:59], v[42:43], v[42:43], s[20:21] neg_lo:[1,0,1] neg_hi:[1,0,1]
  v_pk_fma_f32 v[60:61], v[44:45], v[44:45], s[20:21] neg_lo:[1,0,1] neg_hi:[1,0,1]
  v_pk_fma_f32 v[62:63], v[46:47], v[46:47], s[20:21] neg_lo:[1,0,1] neg_hi:[1,0,1]
  v_pk_mul_f32 v[48:49], v[32:33], v[48:49]
  v_pk_mul_f32 v[50:51], v[34:35], v[50:51]
  v_pk_mul_f32 v[52:53], v[36:37], v[52:53]
  v_pk_mul_f32 v[54:55], v[38:39], v[54:55]
  v_pk_mul_f32 v[56:57], v[40:41], v[56:57]
  v_cvt_pk_bf16_f32 v184, v16, v17
  v_cvt_pk_bf16_f32 v185, v18, v19
  v_cvt_pk_bf16_f32 v186, v20, v21
  v_cvt_pk_bf16_f32 v187, v22, v23
  v_pk_mul_f32 v[58:59], v[42:43], v[58:59]
  v_pk_mul_f32 v[60:61], v[44:45], v[60:61]
  v_pk_mul_f32 v[62:63], v[46:47], v[62:63]
  v_mfma_f32_32x32x16_bf16 v[64:79], v[192:195], v[184:187], v[64:79]
  ds_read_b128 v[216:219], v0 offset:2048
  ds_read_b128 v[220:223], v0 offset:3072
  v_cvt_pk_bf16_f32 v188, v24, v25
  v_cvt_pk_bf16_f32 v189, v26, v27
  v_cvt_pk_bf16_f32 v190, v28, v29
  v_cvt_pk_bf16_f32 v191, v30, v31
  v_exp_f32_e64 v48, v48
  v_cndmask_b32 v159, v159, v250, s[12:13]
  v_mfma_f32_32x32x16_bf16 v[80:95], v[196:199], v[184:187], v[80:95]
  ds_read_b128 v[224:227], v0 offset:6144
  ds_read_b128 v[228:231], v0 offset:7168
  v_exp_f32_e64 v49, v49
  v_cvt_pk_bf16_f32 v160, v112, v113
  v_cvt_pk_bf16_f32 v161, v114, v115
  v_exp_f32_e64 v50, v50
  v_cvt_pk_bf16_f32 v162, v116, v117
  v_mfma_f32_32x32x16_bf16 v[96:111], v[200:203], v[184:187], v[96:111]
  ds_read_b128 v[232:235], v0 offset:10240
  ds_read_b128 v[236:239], v0 offset:11264
  v_exp_f32_e64 v51, v51
  v_cvt_pk_bf16_f32 v163, v118, v119
  v_cvt_pk_bf16_f32 v164, v120, v121
  v_exp_f32_e64 v52, v52
  v_cvt_pk_bf16_f32 v165, v122, v123
  v_mfma_f32_32x32x16_bf16 v[64:79], v[204:207], v[188:191], v[64:79]
  v_exp_f32_e64 v53, v53
  v_cvt_pk_bf16_f32 v166, v124, v125
  v_cvt_pk_bf16_f32 v167, v126, v127
  v_exp_f32_e64 v54, v54
  v_cvt_pk_bf16_f32 v168, v128, v129
  v_exp_f32_e64 v55, v55
  v_cvt_pk_bf16_f32 v169, v130, v131
  v_cvt_pk_bf16_f32 v170, v132, v133
  v_mfma_f32_32x32x16_bf16 v[80:95], v[208:211], v[188:191], v[80:95]
  v_exp_f32_e64 v56, v56
  v_cvt_pk_bf16_f32 v171, v134, v135
  v_cvt_pk_bf16_f32 v172, v136, v137
  v_exp_f32_e64 v57, v57
  v_cvt_pk_bf16_f32 v173, v138, v139
  v_exp_f32_e64 v58, v58
  v_cvt_pk_bf16_f32 v174, v140, v141
  v_cvt_pk_bf16_f32 v175, v142, v143
  v_mfma_f32_32x32x16_bf16 v[96:111], v[212:215], v[188:191], v[96:111]
  s_waitcnt lgkmcnt(0)
  v_exp_f32 v59, v59
  v_cvt_pk_bf16_f32 v176, v144, v145
  v_exp_f32_e64 v60, v60
  v_cvt_pk_bf16_f32 v177, v146, v147
  v_cvt_pk_bf16_f32 v178, v148, v149
  v_exp_f32_e64 v61, v61
  v_cvt_pk_bf16_f32 v179, v150, v151
  v_exp_f32_e64 v62, v62
  v_cvt_pk_bf16_f32 v180, v152, v153
  v_cvt_pk_bf16_f32 v181, v154, v155
  v_exp_f32_e64 v63, v63
  v_cvt_pk_bf16_f32 v182, v156, v157
  v_cvt_pk_bf16_f32 v183, v158, v159
  v_pk_fma_f32 v[48:49], v[48:49], s[22:23], s[22:23]
  v_pk_fma_f32 v[50:51], v[50:51], s[22:23], s[22:23]
  v_pk_fma_f32 v[52:53], v[52:53], s[22:23], s[22:23]
  v_pk_fma_f32 v[54:55], v[54:55], s[22:23], s[22:23]
  v_pk_fma_f32 v[56:57], v[56:57], s[22:23], s[22:23]
  v_pk_fma_f32 v[58:59], v[58:59], s[22:23], s[22:23]
  v_pk_fma_f32 v[60:61], v[60:61], s[22:23], s[22:23]
  v_pk_fma_f32 v[62:63], v[62:63], s[22:23], s[22:23]
  s_mov_b32 s26, 6
  .p2align 6
  s_nop 0
  s_waitcnt vmcnt(0)
L_loop:
  v_mfma_f32_32x32x16_bf16 v[16:31], v[216:219], v[160:163], 0
  ds_read_b128 v[192:195], v1 offset:2048
  ds_read_b128 v[196:199], v1 offset:3072
  ds_read_b128 v[200:203], v1 offset:4096
  v_rcp_f32 v48, v48
  v_rcp_f32 v49, v49
  v_mfma_f32_32x32x16_bf16 v[16:31], v[220:223], v[164:167], v[16:31]
  ds_read_b128 v[204:207], v1 offset:5120
  ds_read_b128 v[208:211], v1 offset:6144
  ds_read_b128 v[212:215], v1 offset:7168
  v_rcp_f32 v50, v50
  v_rcp_f32 v51, v51
  v_mfma_f32_32x32x16_bf16 v[16:31], v[224:227], v[168:171], v[16:31]
  ds_read_b128 v[136:139], v5
  ds_read_b128 v[140:143], v5 offset:32
  ds_read_b128 v[144:147], v5 offset:64
  v_rcp_f32 v52, v52
  v_rcp_f32 v53, v53
  v_mfma_f32_32x32x16_bf16 v[16:31], v[228:231], v[172:175], v[16:31]
  ds_read_b128 v[148:151], v5 offset:96
  ds_read_b128 v[152:155], v5 offset:128
  ds_read_b128 v[156:159], v5 offset:160
  v_rcp_f32 v54, v54
  v_rcp_f32 v55, v55
  v_mfma_f32_32x32x16_bf16 v[16:31], v[232:235], v[176:179], v[16:31]
  v_rcp_f32 v56, v56
  v_rcp_f32 v57, v57
  v_rcp_f32_e64 v58, v58
  v_mfma_f32_32x32x16_bf16 v[16:31], v[236:239], v[180:183], v[16:31]
  s_waitcnt lgkmcnt(0)
  v_rcp_f32 v59, v59
  v_rcp_f32 v60, v60
  v_rcp_f32 v61, v61
  v_rcp_f32 v62, v62
  v_rcp_f32 v63, v63
  v_pk_mul_f32 v[32:33], v[32:33], v[48:49]
  v_pk_mul_f32 v[34:35], v[34:35], v[50:51]
  v_pk_mul_f32 v[36:37], v[36:37], v[52:53]
  v_pk_mul_f32 v[38:39], v[38:39], v[54:55]
  v_pk_mul_f32 v[40:41], v[40:41], v[56:57]
  v_pk_mul_f32 v[42:43], v[42:43], v[58:59]
  v_pk_mul_f32 v[44:45], v[44:45], v[60:61]
  v_pk_mul_f32 v[46:47], v[46:47], v[62:63]
  v_pk_fma_f32 v[48:49], v[16:17], v[16:17], s[20:21] neg_lo:[1,0,1] neg_hi:[1,0,1]
  v_pk_fma_f32 v[50:51], v[18:19], v[18:19], s[20:21] neg_lo:[1,0,1] neg_hi:[1,0,1]
  v_pk_fma_f32 v[52:53], v[20:21], v[20:21], s[20:21] neg_lo:[1,0,1] neg_hi:[1,0,1]
  v_pk_fma_f32 v[54:55], v[22:23], v[22:23], s[20:21] neg_lo:[1,0,1] neg_hi:[1,0,1]
  v_pk_fma_f32 v[56:57], v[24:25], v[24:25], s[20:21] neg_lo:[1,0,1] neg_hi:[1,0,1]
  v_pk_fma_f32 v[58:59], v[26:27], v[26:27], s[20:21] neg_lo:[1,0,1] neg_hi:[1,0,1]
  v_pk_fma_f32 v[60:61], v[28:29], v[28:29], s[20:21] neg_lo:[1,0,1] neg_hi:[1,0,1]
  v_pk_fma_f32 v[62:63], v[30:31], v[30:31], s[20:21] neg_lo:[1,0,1] neg_hi:[1,0,1]
  v_pk_mul_f32 v[48:49], v[16:17], v[48:49]
  v_pk_mul_f32 v[50:51], v[18:19], v[50:51]
  v_pk_mul_f32 v[52:53], v[20:21], v[52:53]
  v_pk_mul_f32 v[54:55], v[22:23], v[54:55]
  v_pk_mul_f32 v[56:57], v[24:25], v[56:57]
  v_cvt_pk_bf16_f32 v184, v32, v33
  v_cvt_pk_bf16_f32 v185, v34, v35
  v_cvt_pk_bf16_f32 v186, v36, v37
  v_cvt_pk_bf16_f32 v187, v38, v39
  v_pk_mul_f32 v[58:59], v[26:27], v[58:59]
  v_pk_mul_f32 v[60:61], v[28:29], v[60:61]
  v_pk_mul_f32 v[62:63], v[30:31], v[62:63]
  v_mfma_f32_32x32x16_bf16 v[64:79], v[192:195], v[184:187], v[64:79]
  s_mov_b32 m0, s30
  v_cvt_pk_bf16_f32 v188, v40, v41
  v_cvt_pk_bf16_f32 v189, v42, v43
  v_cvt_pk_bf16_f32 v190, v44, v45
  v_cvt_pk_bf16_f32 v191, v46, v47
  v_exp_f32 v48, v48
  v_mfma_f32_32x32x16_bf16 v[80:95], v[196:199], v[184:187], v[80:95]
  buffer_load_dwordx4 v6, s[4:7], s29 offen lds
  v_exp_f32 v49, v49
  v_exp_f32 v50, v50
  v_exp_f32_e64 v51, v51
  v_mfma_f32_32x32x16_bf16 v[96:111], v[200:203], v[184:187], v[96:111]
  buffer_load_dwordx4 v7, s[4:7], s29 offen offset:1024 lds
  v_exp_f32 v52, v52
  v_exp_f32 v53, v53
  v_mfma_f32_32x32x16_bf16 v[64:79], v[204:207], v[188:191], v[64:79]
  buffer_load_dwordx4 v8, s[4:7], s29 offen offset:2048 lds
  v_exp_f32 v54, v54
  v_exp_f32 v55, v55
  v_exp_f32_e64 v56, v56
  v_mfma_f32_32x32x16_bf16 v[80:95], v[208:211], v[188:191], v[80:95]
  buffer_load_dwordx4 v9, s[4:7], s29 offen offset:3072 lds
  v_exp_f32 v57, v57
  v_exp_f32 v58, v58
  v_mfma_f32_32x32x16_bf16 v[96:111], v[212:215], v[188:191], v[96:111]
  v_exp_f32 v59, v59
  v_exp_f32 v60, v60
  v_exp_f32 v61, v61
  v_exp_f32 v62, v62
  v_exp_f32_e64 v63, v63
  v_pk_fma_f32 v[48:49], v[48:49], s[22:23], s[22:23]
  v_pk_fma_f32 v[50:51], v[50:51], s[22:23], s[22:23]
  v_pk_fma_f32 v[52:53], v[52:53], s[22:23], s[22:23]
  v_pk_fma_f32 v[54:55], v[54:55], s[22:23], s[22:23]
  v_pk_fma_f32 v[56:57], v[56:57], s[22:23], s[22:23]
  v_pk_fma_f32 v[58:59], v[58:59], s[22:23], s[22:23]
  v_pk_fma_f32 v[60:61], v[60:61], s[22:23], s[22:23]
  v_pk_fma_f32 v[62:63], v[62:63], s[22:23], s[22:23]
  v_mfma_f32_32x32x16_bf16 v[32:47], a[0:3], v[160:163], 0
  v_cvt_pk_bf16_f32 v112, v64, v65
  v_cvt_pk_bf16_f32 v113, v66, v67
  v_cvt_pk_bf16_f32 v114, v68, v69
  v_cvt_pk_bf16_f32 v115, v70, v71
  v_cvt_pk_bf16_f32 v116, v72, v73
  v_cvt_pk_bf16_f32 v117, v74, v75
  v_mfma_f32_32x32x16_bf16 v[32:47], a[4:7], v[164:167], v[32:47]
  v_cvt_pk_bf16_f32 v118, v76, v77
  v_cvt_pk_bf16_f32 v119, v78, v79
  v_cvt_pk_bf16_f32 v120, v80, v81
  v_cvt_pk_bf16_f32 v121, v82, v83
  v_cvt_pk_bf16_f32 v122, v84, v85
  v_cvt_pk_bf16_f32 v123, v86, v87
  v_mfma_f32_32x32x16_bf16 v[32:47], a[8:11], v[168:171], v[32:47]
  ds_read_b128 v[64:67], v2
  ds_read_b128 v[68:71], v2 offset:32
  ds_read_b128 v[72:75], v2 offset:64
  ds_read_b128 v[76:79], v2 offset:96
  v_cvt_pk_bf16_f32 v124, v88, v89
  v_cvt_pk_bf16_f32 v125, v90, v91
  v_mfma_f32_32x32x16_bf16 v[32:47], a[12:15], v[172:175], v[32:47]
  ds_read_b128 v[192:195], v1 offset:8192
  ds_read_b128 v[196:199], v1 offset:9216
  v_cvt_pk_bf16_f32 v126, v92, v93
  v_cvt_pk_bf16_f32 v127, v94, v95
  v_cvt_pk_bf16_f32 v128, v96, v97
  v_cvt_pk_bf16_f32 v129, v98, v99
  v_mfma_f32_32x32x16_bf16 v[32:47], a[16:19], v[176:179], v[32:47]
  ds_read_b128 v[80:83], v2 offset:128
  ds_read_b128 v[84:87], v2 offset:160
  ds_read_b128 v[88:91], v2 offset:192
  ds_read_b128 v[92:95], v2 offset:224
  v_cvt_pk_bf16_f32 v130, v100, v101
  v_cvt_pk_bf16_f32 v131, v102, v103
  v_mfma_f32_32x32x16_bf16 v[32:47], a[20:23], v[180:183], v[32:47]
  s_nop 0
  s_waitcnt lgkmcnt(6)
  ds_read_b128 v[200:203], v1 offset:10240
  ds_read_b128 v[204:207], v1 offset:11264
  v_cvt_pk_bf16_f32 v132, v104, v105
  v_cvt_pk_bf16_f32 v133, v106, v107
  v_cvt_pk_bf16_f32 v134, v108, v109
  v_cvt_pk_bf16_f32 v135, v110, v111
  v_mfma_f32_32x32x16_bf16 v[64:79], v[240:243], v[136:139], v[64:79]
  ds_read_b128 v[96:99], v2 offset:256
  ds_read_b128 v[100:103], v2 offset:288
  ds_read_b128 v[104:107], v2 offset:320
  ds_read_b128 v[108:111], v2 offset:352
  v_rcp_f32 v48, v48
  v_mfma_f32_32x32x16_bf16 v[64:79], v[244:247], v[140:143], v[64:79]
  s_waitcnt lgkmcnt(6)
  ds_read_b128 v[208:211], v1 offset:12288
  ds_read_b128 v[212:215], v1 offset:13312
  v_rcp_f32 v49, v49
  v_rcp_f32 v50, v50
  v_mfma_f32_32x32x16_bf16 v[80:95], v[240:243], v[144:147], v[80:95]
  v_rcp_f32 v51, v51
  v_rcp_f32 v52, v52
  v_rcp_f32_e64 v53, v53
  v_mfma_f32_32x32x16_bf16 v[80:95], v[244:247], v[148:151], v[80:95]
  s_waitcnt lgkmcnt(2)
  v_rcp_f32 v54, v54
  v_rcp_f32 v55, v55
  v_rcp_f32 v56, v56
  v_mfma_f32_32x32x16_bf16 v[96:111], v[240:243], v[152:155], v[96:111]
  v_rcp_f32 v57, v57
  v_rcp_f32 v58, v58
  v_rcp_f32_e64 v59, v59
  v_mfma_f32_32x32x16_bf16 v[96:111], v[244:247], v[156:159], v[96:111]
  s_waitcnt lgkmcnt(0)
  v_rcp_f32 v60, v60
  v_rcp_f32 v61, v61
  v_rcp_f32 v62, v62
  v_rcp_f32_e64 v63, v63
  v_pk_mul_f32 v[16:17], v[16:17], v[48:49]
  v_pk_mul_f32 v[18:19], v[18:19], v[50:51]
  v_pk_mul_f32 v[20:21], v[20:21], v[52:53]
  v_pk_mul_f32 v[22:23], v[22:23], v[54:55]
  v_pk_mul_f32 v[24:25], v[24:25], v[56:57]
  v_pk_mul_f32 v[26:27], v[26:27], v[58:59]
  v_pk_mul_f32 v[28:29], v[28:29], v[60:61]
  v_pk_mul_f32 v[30:31], v[30:31], v[62:63]
  v_pk_fma_f32 v[48:49], v[32:33], v[32:33], s[20:21] neg_lo:[1,0,1] neg_hi:[1,0,1]
  v_pk_fma_f32 v[50:51], v[34:35], v[34:35], s[20:21] neg_lo:[1,0,1] neg_hi:[1,0,1]
  v_pk_fma_f32 v[52:53], v[36:37], v[36:37], s[20:21] neg_lo:[1,0,1] neg_hi:[1,0,1]
  v_pk_fma_f32 v[54:55], v[38:39], v[38:39], s[20:21] neg_lo:[1,0,1] neg_hi:[1,0,1]
  v_pk_fma_f32 v[56:57], v[40:41], v[40:41], s[20:21] neg_lo:[1,0,1] neg_hi:[1,0,1]
  v_pk_fma_f32 v[58:59], v[42:43], v[42:43], s[20:21] neg_lo:[1,0,1] neg_hi:[1,0,1]
  v_pk_fma_f32 v[60:61], v[44:45], v[44:45], s[20:21] neg_lo:[1,0,1] neg_hi:[1,0,1]
  v_pk_fma_f32 v[62:63], v[46:47], v[46:47], s[20:21] neg_lo:[1,0,1] neg_hi:[1,0,1]
  v_pk_mul_f32 v[48:49], v[32:33], v[48:49]
  v_pk_mul_f32 v[50:51], v[34:35], v[50:51]
  v_pk_mul_f32 v[52:53], v[36:37], v[52:53]
  v_pk_mul_f32 v[54:55], v[38:39], v[54:55]
  v_pk_mul_f32 v[56:57], v[40:41], v[56:57]
  v_cvt_pk_bf16_f32 v184, v16, v17
  v_cvt_pk_bf16_f32 v185, v18, v19
  v_cvt_pk_bf16_f32 v186, v20, v21
  v_cvt_pk_bf16_f32 v187, v22, v23
  v_pk_mul_f32 v[58:59], v[42:43], v[58:59]
  v_pk_mul_f32 v[60:61], v[44:45], v[60:61]
  v_pk_mul_f32 v[62:63], v[46:47], v[62:63]
  v_mfma_f32_32x32x16_bf16 v[64:79], v[192:195], v[184:187], v[64:79]
  s_mov_b32 m0, s31
  v_cvt_pk_bf16_f32 v188, v24, v25
  v_cvt_pk_bf16_f32 v189, v26, v27
  v_cvt_pk_bf16_f32 v190, v28, v29
  v_cvt_pk_bf16_f32 v191, v30, v31
  v_exp_f32 v48, v48
  v_mfma_f32_32x32x16_bf16 v[80:95], v[196:199], v[184:187], v[80:95]
  buffer_load_dwordx4 v6, s[4:7], s52 offen lds
  v_exp_f32 v49, v49
  v_exp_f32 v50, v50
  v_exp_f32_e64 v51, v51
  v_mfma_f32_32x32x16_bf16 v[96:111], v[200:203], v[184:187], v[96:111]
  buffer_load_dwordx4 v7, s[4:7], s52 offen offset:1024 lds
  v_exp_f32 v52, v52
  v_exp_f32 v53, v53
  v_mfma_f32_32x32x16_bf16 v[64:79], v[204:207], v[188:191], v[64:79]
  buffer_load_dwordx4 v8, s[4:7], s52 offen offset:2048 lds
  v_exp_f32 v54, v54
  v_exp_f32 v55, v55
  v_exp_f32_e64 v56, v56
  v_mfma_f32_32x32x16_bf16 v[80:95], v[208:211], v[188:191], v[80:95]
  buffer_load_dwordx4 v9, s[4:7], s52 offen offset:3072 lds
  v_exp_f32 v57, v57
  v_exp_f32 v58, v58
  v_mfma_f32_32x32x16_bf16 v[96:111], v[212:215], v[188:191], v[96:111]
  v_exp_f32 v59, v59
  v_exp_f32 v60, v60
  v_exp_f32 v61, v61
  v_exp_f32 v62, v62
  v_exp_f32_e64 v63, v63
  v_pk_fma_f32 v[48:49], v[48:49], s[22:23], s[22:23]
  v_pk_fma_f32 v[50:51], v[50:51], s[22:23], s[22:23]
  v_pk_fma_f32 v[52:53], v[52:53], s[22:23], s[22:23]
  v_pk_fma_f32 v[54:55], v[54:55], s[22:23], s[22:23]
  v_pk_fma_f32 v[56:57], v[56:57], s[22:23], s[22:23]
  v_pk_fma_f32 v[58:59], v[58:59], s[22:23], s[22:23]
  v_pk_fma_f32 v[60:61], v[60:61], s[22:23], s[22:23]
  v_pk_fma_f32 v[62:63], v[62:63], s[22:23], s[22:23]
  v_mfma_f32_32x32x16_bf16 v[16:31], a[24:27], v[160:163], 0
  ds_read_b128 v[192:195], v1 offset:14336
  ds_read_b128 v[196:199], v1 offset:15360
  v_rcp_f32 v48, v48
  v_rcp_f32 v49, v49
  v_mfma_f32_32x32x16_bf16 v[16:31], a[28:31], v[164:167], v[16:31]
  ds_read_b128 v[200:203], v1 offset:16384
  ds_read_b128 v[204:207], v1 offset:17408
  v_rcp_f32 v50, v50
  v_rcp_f32 v51, v51
  v_mfma_f32_32x32x16_bf16 v[16:31], a[32:35], v[168:171], v[16:31]
  ds_read_b128 v[208:211], v1 offset:18432
  ds_read_b128 v[212:215], v1 offset:19456
  v_rcp_f32 v52, v52
  v_rcp_f32 v53, v53
  v_mfma_f32_32x32x16_bf16 v[16:31], a[36:39], v[172:175], v[16:31]
  buffer_store_dwordx4 v[112:115], v10, s[8:11], s28 offen
  v_rcp_f32 v54, v54
  v_rcp_f32 v55, v55
  v_mfma_f32_32x32x16_bf16 v[16:31], a[40:43], v[176:179], v[16:31]
  v_rcp_f32 v56, v56
  v_rcp_f32 v57, v57
  v_rcp_f32_e64 v58, v58
  v_mfma_f32_32x32x16_bf16 v[16:31], a[44:47], v[180:183], v[16:31]
  s_waitcnt lgkmcnt(0)
  v_rcp_f32 v59, v59
  v_rcp_f32 v60, v60
  v_rcp_f32 v61, v61
  v_rcp_f32 v62, v62
  v_rcp_f32 v63, v63
  v_pk_mul_f32 v[32:33], v[32:33], v[48:49]
  v_pk_mul_f32 v[34:35], v[34:35], v[50:51]
  v_pk_mul_f32 v[36:37], v[36:37], v[52:53]
  v_pk_mul_f32 v[38:39], v[38:39], v[54:55]
  v_pk_mul_f32 v[40:41], v[40:41], v[56:57]
  v_pk_mul_f32 v[42:43], v[42:43], v[58:59]
  v_pk_mul_f32 v[44:45], v[44:45], v[60:61]
  v_pk_mul_f32 v[46:47], v[46:47], v[62:63]
  v_pk_fma_f32 v[48:49], v[16:17], v[16:17], s[20:21] neg_lo:[1,0,1] neg_hi:[1,0,1]
  v_pk_fma_f32 v[50:51], v[18:19], v[18:19], s[20:21] neg_lo:[1,0,1] neg_hi:[1,0,1]
  v_pk_fma_f32 v[52:53], v[20:21], v[20:21], s[20:21] neg_lo:[1,0,1] neg_hi:[1,0,1]
  v_pk_fma_f32 v[54:55], v[22:23], v[22:23], s[20:21] neg_lo:[1,0,1] neg_hi:[1,0,1]
  v_pk_fma_f32 v[56:57], v[24:25], v[24:25], s[20:21] neg_lo:[1,0,1] neg_hi:[1,0,1]
  v_pk_fma_f32 v[58:59], v[26:27], v[26:27], s[20:21] neg_lo:[1,0,1] neg_hi:[1,0,1]
  v_pk_fma_f32 v[60:61], v[28:29], v[28:29], s[20:21] neg_lo:[1,0,1] neg_hi:[1,0,1]
  v_pk_fma_f32 v[62:63], v[30:31], v[30:31], s[20:21] neg_lo:[1,0,1] neg_hi:[1,0,1]
  v_pk_mul_f32 v[48:49], v[16:17], v[48:49]
  v_pk_mul_f32 v[50:51], v[18:19], v[50:51]
  v_pk_mul_f32 v[52:53], v[20:21], v[52:53]
  v_pk_mul_f32 v[54:55], v[22:23], v[54:55]
  v_pk_mul_f32 v[56:57], v[24:25], v[56:57]
  v_cvt_pk_bf16_f32 v184, v32, v33
  v_cvt_pk_bf16_f32 v185, v34, v35
  v_cvt_pk_bf16_f32 v186, v36, v37
  v_cvt_pk_bf16_f32 v187, v38, v39
  v_pk_mul_f32 v[58:59], v[26:27], v[58:59]
  v_pk_mul_f32 v[60:61], v[28:29], v[60:61]
  v_pk_mul_f32 v[62:63], v[30:31], v[62:63]
  v_mfma_f32_32x32x16_bf16 v[64:79], v[192:195], v[184:187], v[64:79]
  v_cvt_pk_bf16_f32 v188, v40, v41
  v_cvt_pk_bf16_f32 v189, v42, v43
  v_cvt_pk_bf16_f32 v190, v44, v45
  v_cvt_pk_bf16_f32 v191, v46, v47
  v_exp_f32_e64 v48, v48
  v_mfma_f32_32x32x16_bf16 v[80:95], v[196:199], v[184:187], v[80:95]
  v_exp_f32 v49, v49
  v_exp_f32 v50, v50
  v_exp_f32_e64 v51, v51
  v_mfma_f32_32x32x16_bf16 v[96:111], v[200:203], v[184:187], v[96:111]
  v_exp_f32 v52, v52
  v_exp_f32 v53, v53
  v_subrev_u32 v11, 0x4100, v5
  v_mfma_f32_32x32x16_bf16 v[64:79], v[204:207], v[188:191], v[64:79]
  v_exp_f32 v54, v54
  v_exp_f32 v55, v55
  v_exp_f32_e64 v56, v56
  v_mfma_f32_32x32x16_bf16 v[80:95], v[208:211], v[188:191], v[80:95]
  v_exp_f32 v57, v57
  v_exp_f32 v58, v58
  v_add_u32 v5, 0x8200, v5
  v_exp_f32_e64 v59, v59
  v_mfma_f32_32x32x16_bf16 v[96:111], v[212:215], v[188:191], v[96:111]
  v_exp_f32 v60, v60
  v_exp_f32 v61, v61
  v_exp_f32 v62, v62
  v_exp_f32 v63, v63
  v_min_u32_e64 v5, v11, v5
  v_pk_fma_f32 v[48:49], v[48:49], s[22:23], s[22:23]
  v_pk_fma_f32 v[50:51], v[50:51], s[22:23], s[22:23]
  v_pk_fma_f32 v[52:53], v[52:53], s[22:23], s[22:23]
  v_pk_fma_f32 v[54:55], v[54:55], s[22:23], s[22:23]
  v_pk_fma_f32 v[56:57], v[56:57], s[22:23], s[22:23]
  v_pk_fma_f32 v[58:59], v[58:59], s[22:23], s[22:23]
  v_pk_fma_f32 v[60:61], v[60:61], s[22:23], s[22:23]
  v_pk_fma_f32 v[62:63], v[62:63], s[22:23], s[22:23]
  v_mfma_f32_32x32x16_bf16 v[32:47], a[48:51], v[160:163], 0
  ds_read_b128 v[192:195], v1 offset:20480
  ds_read_b128 v[196:199], v1 offset:21504
  v_rcp_f32 v48, v48
  v_rcp_f32 v49, v49
  v_mfma_f32_32x32x16_bf16 v[32:47], a[52:55], v[164:167], v[32:47]
  ds_read_b128 v[200:203], v1 offset:22528
  ds_read_b128 v[204:207], v1 offset:23552
  v_rcp_f32 v50, v50
  v_rcp_f32 v51, v51
  v_mfma_f32_32x32x16_bf16 v[32:47], a[56:59], v[168:171], v[32:47]
  ds_read_b128 v[208:211], v1 offset:24576
  ds_read_b128 v[212:215], v1 offset:25600
  v_rcp_f32 v52, v52
  v_rcp_f32 v53, v53
  v_mfma_f32_32x32x16_bf16 v[32:47], a[60:63], v[172:175], v[32:47]
  buffer_store_dwordx4 v[116:119], v10, s[8:11], s28 offen offset:32
  v_rcp_f32 v54, v54
  v_rcp_f32 v55, v55
  v_mfma_f32_32x32x16_bf16 v[32:47], a[64:67], v[176:179], v[32:47]
  v_rcp_f32 v56, v56
  v_rcp_f32 v57, v57
  v_rcp_f32_e64 v58, v58
  v_mfma_f32_32x32x16_bf16 v[32:47], a[68:71], v[180:183], v[32:47]
  s_waitcnt lgkmcnt(0)
  v_rcp_f32 v59, v59
  v_rcp_f32 v60, v60
  v_rcp_f32 v61, v61
  v_rcp_f32 v62, v62
  v_rcp_f32 v63, v63
  v_pk_mul_f32 v[16:17], v[16:17], v[48:49]
  v_pk_mul_f32 v[18:19], v[18:19], v[50:51]
  v_pk_mul_f32 v[20:21], v[20:21], v[52:53]
  v_pk_mul_f32 v[22:23], v[22:23], v[54:55]
  v_pk_mul_f32 v[24:25], v[24:25], v[56:57]
  v_pk_mul_f32 v[26:27], v[26:27], v[58:59]
  v_pk_mul_f32 v[28:29], v[28:29], v[60:61]
  v_pk_mul_f32 v[30:31], v[30:31], v[62:63]
  v_pk_fma_f32 v[48:49], v[32:33], v[32:33], s[20:21] neg_lo:[1,0,1] neg_hi:[1,0,1]
  v_pk_fma_f32 v[50:51], v[34:35], v[34:35], s[20:21] neg_lo:[1,0,1] neg_hi:[1,0,1]
  v_pk_fma_f32 v[52:53], v[36:37], v[36:37], s[20:21] neg_lo:[1,0,1] neg_hi:[1,0,1]
  v_pk_fma_f32 v[54:55], v[38:39], v[38:39], s[20:21] neg_lo:[1,0,1] neg_hi:[1,0,1]
  v_pk_fma_f32 v[56:57], v[40:41], v[40:41], s[20:21] neg_lo:[1,0,1] neg_hi:[1,0,1]
  v_pk_fma_f32 v[58:59], v[42:43], v[42:43], s[20:21] neg_lo:[1,0,1] neg_hi:[1,0,1]
  v_pk_fma_f32 v[60:61], v[44:45], v[44:45], s[20:21] neg_lo:[1,0,1] neg_hi:[1,0,1]
  v_pk_fma_f32 v[62:63], v[46:47], v[46:47], s[20:21] neg_lo:[1,0,1] neg_hi:[1,0,1]
  v_pk_mul_f32 v[48:49], v[32:33], v[48:49]
  v_pk_mul_f32 v[50:51], v[34:35], v[50:51]
  v_pk_mul_f32 v[52:53], v[36:37], v[52:53]
  v_pk_mul_f32 v[54:55], v[38:39], v[54:55]
  v_pk_mul_f32 v[56:57], v[40:41], v[56:57]
  v_cvt_pk_bf16_f32 v184, v16, v17
  v_cvt_pk_bf16_f32 v185, v18, v19
  v_cvt_pk_bf16_f32 v186, v20, v21
  v_cvt_pk_bf16_f32 v187, v22, v23
  v_pk_mul_f32 v[58:59], v[42:43], v[58:59]
  v_pk_mul_f32 v[60:61], v[44:45], v[60:61]
  v_pk_mul_f32 v[62:63], v[46:47], v[62:63]
  v_mfma_f32_32x32x16_bf16 v[64:79], v[192:195], v[184:187], v[64:79]
  s_add_u32 s29, s29, 0x60000
  v_cvt_pk_bf16_f32 v188, v24, v25
  v_cvt_pk_bf16_f32 v189, v26, v27
  v_cvt_pk_bf16_f32 v190, v28, v29
  v_cvt_pk_bf16_f32 v191, v30, v31
  v_exp_f32_e64 v48, v48
  v_mfma_f32_32x32x16_bf16 v[80:95], v[196:199], v[184:187], v[80:95]
  s_add_u32 s52, s52, 0x60000
  v_exp_f32 v49, v49
  v_exp_f32 v50, v50
  v_exp_f32_e64 v51, v51
  v_mfma_f32_32x32x16_bf16 v[96:111], v[200:203], v[184:187], v[96:111]
  s_mov_b32 s32, s30
  v_exp_f32 v52, v52
  v_exp_f32_e64 v53, v53
  v_subrev_u32 v11, 0x4100, v4
  v_mfma_f32_32x32x16_bf16 v[64:79], v[204:207], v[188:191], v[64:79]
  s_add_u32 s30, s33, 32
  v_exp_f32 v54, v54
  v_exp_f32 v55, v55
  v_exp_f32 v56, v56
  v_mfma_f32_32x32x16_bf16 v[80:95], v[208:211], v[188:191], v[80:95]
  s_sub_u32 s33, s31, 0
  v_exp_f32 v57, v57
  v_exp_f32_e64 v58, v58
  v_add_u32 v4, 0x8200, v4
  v_exp_f32_e64 v59, v59
  v_mfma_f32_32x32x16_bf16 v[96:111], v[212:215], v[188:191], v[96:111]
  v_exp_f32 v60, v60
  v_exp_f32 v61, v61
  v_exp_f32 v62, v62
  v_exp_f32 v63, v63
  v_min_u32_e64 v4, v11, v4
  v_pk_fma_f32 v[48:49], v[48:49], s[22:23], s[22:23]
  v_pk_fma_f32 v[50:51], v[50:51], s[22:23], s[22:23]
  v_pk_fma_f32 v[52:53], v[52:53], s[22:23], s[22:23]
  v_pk_fma_f32 v[54:55], v[54:55], s[22:23], s[22:23]
  v_pk_fma_f32 v[56:57], v[56:57], s[22:23], s[22:23]
  v_pk_fma_f32 v[58:59], v[58:59], s[22:23], s[22:23]
  v_pk_fma_f32 v[60:61], v[60:61], s[22:23], s[22:23]
  v_pk_fma_f32 v[62:63], v[62:63], s[22:23], s[22:23]
  v_mfma_f32_32x32x16_bf16 v[16:31], a[72:75], v[160:163], 0
  ds_read_b128 v[192:195], v1 offset:26624
  ds_read_b128 v[196:199], v1 offset:27648
  v_rcp_f32 v48, v48
  v_rcp_f32 v49, v49
  v_mfma_f32_32x32x16_bf16 v[16:31], a[76:79], v[164:167], v[16:31]
  ds_read_b128 v[200:203], v1 offset:28672
  ds_read_b128 v[204:207], v1 offset:29696
  v_rcp_f32 v50, v50
  v_rcp_f32 v51, v51
  v_mfma_f32_32x32x16_bf16 v[16:31], a[80:83], v[168:171], v[16:31]
  ds_read_b128 v[208:211], v1 offset:30720
  ds_read_b128 v[212:215], v1 offset:31744
  v_rcp_f32 v52, v52
  v_rcp_f32 v53, v53
  v_mfma_f32_32x32x16_bf16 v[16:31], a[84:87], v[172:175], v[16:31]
  buffer_load_dword v249, v248, s[4:7], s29 offen
  v_rcp_f32 v54, v54
  v_rcp_f32 v55, v55
  v_mfma_f32_32x32x16_bf16 v[16:31], a[88:91], v[176:179], v[16:31]
  v_rcp_f32 v56, v56
  v_rcp_f32 v57, v57
  v_rcp_f32_e64 v58, v58
  v_mfma_f32_32x32x16_bf16 v[16:31], a[92:95], v[180:183], v[16:31]
  s_waitcnt lgkmcnt(0)
  v_rcp_f32 v59, v59
  v_rcp_f32 v60, v60
  v_rcp_f32 v61, v61
  v_rcp_f32 v62, v62
  v_rcp_f32 v63, v63
  v_pk_mul_f32 v[32:33], v[32:33], v[48:49]
  v_pk_mul_f32 v[34:35], v[34:35], v[50:51]
  v_pk_mul_f32 v[36:37], v[36:37], v[52:53]
  v_pk_mul_f32 v[38:39], v[38:39], v[54:55]
  v_pk_mul_f32 v[40:41], v[40:41], v[56:57]
  v_pk_mul_f32 v[42:43], v[42:43], v[58:59]
  v_pk_mul_f32 v[44:45], v[44:45], v[60:61]
  v_pk_mul_f32 v[46:47], v[46:47], v[62:63]
  v_pk_fma_f32 v[48:49], v[16:17], v[16:17], s[20:21] neg_lo:[1,0,1] neg_hi:[1,0,1]
  v_pk_fma_f32 v[50:51], v[18:19], v[18:19], s[20:21] neg_lo:[1,0,1] neg_hi:[1,0,1]
  v_pk_fma_f32 v[52:53], v[20:21], v[20:21], s[20:21] neg_lo:[1,0,1] neg_hi:[1,0,1]
  v_pk_fma_f32 v[54:55], v[22:23], v[22:23], s[20:21] neg_lo:[1,0,1] neg_hi:[1,0,1]
  v_pk_fma_f32 v[56:57], v[24:25], v[24:25], s[20:21] neg_lo:[1,0,1] neg_hi:[1,0,1]
  v_pk_fma_f32 v[58:59], v[26:27], v[26:27], s[20:21] neg_lo:[1,0,1] neg_hi:[1,0,1]
  v_pk_fma_f32 v[60:61], v[28:29], v[28:29], s[20:21] neg_lo:[1,0,1] neg_hi:[1,0,1]
  v_pk_fma_f32 v[62:63], v[30:31], v[30:31], s[20:21] neg_lo:[1,0,1] neg_hi:[1,0,1]
  v_pk_mul_f32 v[48:49], v[16:17], v[48:49]
  v_pk_mul_f32 v[50:51], v[18:19], v[50:51]
  v_pk_mul_f32 v[52:53], v[20:21], v[52:53]
  v_pk_mul_f32 v[54:55], v[22:23], v[54:55]
  v_pk_mul_f32 v[56:57], v[24:25], v[56:57]
  v_cvt_pk_bf16_f32 v184, v32, v33
  v_cvt_pk_bf16_f32 v185, v34, v35
  v_cvt_pk_bf16_f32 v186, v36, v37
  v_cvt_pk_bf16_f32 v187, v38, v39
  v_pk_mul_f32 v[58:59], v[26:27], v[58:59]
  v_pk_mul_f32 v[60:61], v[28:29], v[60:61]
  v_pk_mul_f32 v[62:63], v[30:31], v[62:63]
  v_mfma_f32_32x32x16_bf16 v[64:79], v[192:195], v[184:187], v[64:79]
  s_nop 0
  s_waitcnt vmcnt(3)
  ds_read_b128 v[220:223], v4 offset:96
  v_cvt_pk_bf16_f32 v188, v40, v41
  v_cvt_pk_bf16_f32 v189, v42, v43
  v_cvt_pk_bf16_f32 v190, v44, v45
  v_cvt_pk_bf16_f32 v191, v46, v47
  v_mfma_f32_32x32x16_bf16 v[80:95], v[196:199], v[184:187], v[80:95]
  ds_read_b128 v[228:231], v4 offset:288
  v_exp_f32 v48, v48
  v_exp_f32 v49, v49
  v_exp_f32_e64 v50, v50
  v_mfma_f32_32x32x16_bf16 v[96:111], v[200:203], v[184:187], v[96:111]
  ds_read_b128 v[236:239], v4 offset:480
  v_exp_f32 v51, v51
  v_exp_f32 v52, v52
  v_mfma_f32_32x32x16_bf16 v[64:79], v[204:207], v[188:191], v[64:79]
  v_exp_f32 v53, v53
  v_exp_f32 v54, v54
  v_exp_f32_e64 v55, v55
  v_mfma_f32_32x32x16_bf16 v[80:95], v[208:211], v[188:191], v[80:95]
  v_exp_f32 v56, v56
  v_exp_f32 v57, v57
  v_exp_f32_e64 v58, v58
  v_mfma_f32_32x32x16_bf16 v[96:111], v[212:215], v[188:191], v[96:111]
  s_waitcnt lgkmcnt(0)
  v_exp_f32 v59, v59
  v_exp_f32 v60, v60
  v_exp_f32 v61, v61
  v_exp_f32 v62, v62
  v_exp_f32 v63, v63
  v_pk_fma_f32 v[48:49], v[48:49], s[22:23], s[22:23]
  v_pk_fma_f32 v[50:51], v[50:51], s[22:23], s[22:23]
  v_pk_fma_f32 v[52:53], v[52:53], s[22:23], s[22:23]
  v_pk_fma_f32 v[54:55], v[54:55], s[22:23], s[22:23]
  v_pk_fma_f32 v[56:57], v[56:57], s[22:23], s[22:23]
  v_pk_fma_f32 v[58:59], v[58:59], s[22:23], s[22:23]
  v_pk_fma_f32 v[60:61], v[60:61], s[22:23], s[22:23]
  v_pk_fma_f32 v[62:63], v[62:63], s[22:23], s[22:23]
  v_mfma_f32_32x32x16_bf16 v[32:47], a[96:99], v[160:163], 0
  ds_read_b128 v[192:195], v0 offset:24576
  ds_read_b128 v[196:199], v0 offset:25600
  v_rcp_f32 v48, v48
  v_rcp_f32 v49, v49
  v_mfma_f32_16x16x32_bf16 v[136:139], a[240:243], v[220:223], 0
  ds_read_b128 v[216:219], v3 offset:2800
  ds_read_b128 v[220:223], v4 offset:112
  v_mfma_f32_32x32x16_bf16 v[32:47], a[100:103], v[164:167], v[32:47]
  ds_read_b128 v[200:203], v0 offset:26624
  ds_read_b128 v[204:207], v0 offset:27648
  v_rcp_f32 v50, v50
  v_rcp_f32 v51, v51
  v_mfma_f32_16x16x32_bf16 v[136:139], a[244:247], v[228:231], v[136:139]
  ds_read_b128 v[224:227], v3 offset:7600
  ds_read_b128 v[228:231], v4 offset:304
  v_mfma_f32_32x32x16_bf16 v[32:47], a[104:107], v[168:171], v[32:47]
  ds_read_b128 v[208:211], v0 offset:28672
  ds_read_b128 v[212:215], v0 offset:29696
  v_rcp_f32 v52, v52
  v_rcp_f32 v53, v53
  v_mfma_f32_16x16x32_bf16 v[136:139], a[248:251], v[236:239], v[136:139]
  ds_read_b128 v[232:235], v3 offset:12400
  ds_read_b128 v[236:239], v4 offset:496
  v_mfma_f32_32x32x16_bf16 v[32:47], a[108:111], v[172:175], v[32:47]
  buffer_store_dwordx4 v[120:123], v10, s[8:11], s28 offen offset:64
  v_rcp_f32 v54, v54
  v_rcp_f32 v55, v55
  v_mfma_f32_32x32x16_bf16 v[32:47], a[112:115], v[176:179], v[32:47]
  v_rcp_f32 v56, v56
  v_rcp_f32 v57, v57
  v_rcp_f32_e64 v58, v58
  v_mfma_f32_32x32x16_bf16 v[32:47], a[116:119], v[180:183], v[32:47]
  s_waitcnt lgkmcnt(0)
  v_rcp_f32 v59, v59
  v_rcp_f32 v60, v60
  v_rcp_f32 v61, v61
  v_rcp_f32 v62, v62
  v_rcp_f32 v63, v63
  v_pk_mul_f32 v[16:17], v[16:17], v[48:49]
  v_pk_mul_f32 v[18:19], v[18:19], v[50:51]
  v_pk_mul_f32 v[20:21], v[20:21], v[52:53]
  v_pk_mul_f32 v[22:23], v[22:23], v[54:55]
  v_pk_mul_f32 v[24:25], v[24:25], v[56:57]
  v_pk_mul_f32 v[26:27], v[26:27], v[58:59]
  v_pk_mul_f32 v[28:29], v[28:29], v[60:61]
  v_pk_mul_f32 v[30:31], v[30:31], v[62:63]
  v_pk_add_f32 v[12:13], v[136:137], v[138:139]
  v_pk_mul_f32 v[14:15], v[136:137], v[136:137]
  v_pk_fma_f32 v[14:15], v[138:139], v[138:139], v[14:15]
  v_pk_fma_f32 v[48:49], v[32:33], v[32:33], s[20:21] neg_lo:[1,0,1] neg_hi:[1,0,1]
  v_pk_fma_f32 v[50:51], v[34:35], v[34:35], s[20:21] neg_lo:[1,0,1] neg_hi:[1,0,1]
  v_pk_fma_f32 v[52:53], v[36:37], v[36:37], s[20:21] neg_lo:[1,0,1] neg_hi:[1,0,1]
  v_pk_fma_f32 v[54:55], v[38:39], v[38:39], s[20:21] neg_lo:[1,0,1] neg_hi:[1,0,1]
  v_pk_fma_f32 v[56:57], v[40:41], v[40:41], s[20:21] neg_lo:[1,0,1] neg_hi:[1,0,1]
  v_pk_fma_f32 v[58:59], v[42:43], v[42:43], s[20:21] neg_lo:[1,0,1] neg_hi:[1,0,1]
  v_pk_fma_f32 v[60:61], v[44:45], v[44:45], s[20:21] neg_lo:[1,0,1] neg_hi:[1,0,1]
  v_pk_fma_f32 v[62:63], v[46:47], v[46:47], s[20:21] neg_lo:[1,0,1] neg_hi:[1,0,1]
  v_pk_mul_f32 v[48:49], v[32:33], v[48:49]
  v_pk_mul_f32 v[50:51], v[34:35], v[50:51]
  v_pk_mul_f32 v[52:53], v[36:37], v[52:53]
  v_pk_mul_f32 v[54:55], v[38:39], v[54:55]
  v_pk_mul_f32 v[56:57], v[40:41], v[56:57]
  v_pk_mul_f32 v[58:59], v[42:43], v[58:59]
  v_pk_mul_f32 v[60:61], v[44:45], v[60:61]
  v_pk_mul_f32 v[62:63], v[46:47], v[62:63]
  v_mfma_f32_16x16x32_bf16 v[140:143], v[216:219], v[220:223], 0
  v_cvt_pk_bf16_f32 v184, v16, v17
  v_cvt_pk_bf16_f32 v185, v18, v19
  v_mfma_f32_16x16x32_bf16 v[140:143], v[224:227], v[228:231], v[140:143]
  v_cvt_pk_bf16_f32 v186, v20, v21
  v_cvt_pk_bf16_f32 v187, v22, v23
  v_mfma_f32_16x16x32_bf16 v[140:143], v[232:235], v[236:239], v[140:143]
  ds_read_b128 v[220:223], v4 offset:128
  v_mfma_f32_32x32x16_bf16 v[64:79], v[192:195], v[184:187], v[64:79]
  ds_read_b128 v[224:227], v3 offset:8000
  ds_read_b128 v[228:231], v4 offset:320
  v_cvt_pk_bf16_f32 v188, v24, v25
  v_cvt_pk_bf16_f32 v189, v26, v27
  v_cvt_pk_bf16_f32 v190, v28, v29
  v_cvt_pk_bf16_f32 v191, v30, v31
  v_mfma_f32_32x32x16_bf16 v[80:95], v[196:199], v[184:187], v[80:95]
  ds_read_b128 v[232:235], v3 offset:12800
  ds_read_b128 v[236:239], v4 offset:512
  v_exp_f32 v48, v48
  v_exp_f32 v49, v49
  v_mfma_f32_32x32x16_bf16 v[96:111], v[200:203], v[184:187], v[96:111]
  s_sub_u32 s31, s32, 32
  v_exp_f32 v50, v50
  v_exp_f32 v51, v51
  v_exp_f32 v52, v52
  v_mfma_f32_32x32x16_bf16 v[64:79], v[204:207], v[188:191], v[64:79]
  v_exp_f32 v53, v53
  v_exp_f32 v54, v54
  v_exp_f32_e64 v55, v55
  v_mfma_f32_32x32x16_bf16 v[80:95], v[208:211], v[188:191], v[80:95]
  v_exp_f32 v56, v56
  v_exp_f32 v57, v57
  v_exp_f32_e64 v58, v58
  v_mfma_f32_32x32x16_bf16 v[96:111], v[212:215], v[188:191], v[96:111]
  s_waitcnt lgkmcnt(0)
  v_exp_f32 v59, v59
  v_exp_f32 v60, v60
  v_exp_f32 v61, v61
  v_exp_f32 v62, v62
  v_exp_f32 v63, v63
  v_pk_add_f32 v[12:13], v[12:13], v[140:141]
  v_pk_fma_f32 v[14:15], v[140:141], v[140:141], v[14:15]
  v_pk_add_f32 v[12:13], v[12:13], v[142:143]
  v_pk_fma_f32 v[14:15], v[142:143], v[142:143], v[14:15]
  v_pk_fma_f32 v[48:49], v[48:49], s[22:23], s[22:23]
  v_pk_fma_f32 v[50:51], v[50:51], s[22:23], s[22:23]
  v_pk_fma_f32 v[52:53], v[52:53], s[22:23], s[22:23]
  v_pk_fma_f32 v[54:55], v[54:55], s[22:23], s[22:23]
  v_pk_fma_f32 v[56:57], v[56:57], s[22:23], s[22:23]
  v_pk_fma_f32 v[58:59], v[58:59], s[22:23], s[22:23]
  v_pk_fma_f32 v[60:61], v[60:61], s[22:23], s[22:23]
  v_pk_fma_f32 v[62:63], v[62:63], s[22:23], s[22:23]
  v_mfma_f32_32x32x16_bf16 v[16:31], a[120:123], v[160:163], 0
  ds_read_b128 v[192:195], v0 offset:30720
  ds_read_b128 v[196:199], v0 offset:31744
  v_rcp_f32 v48, v48
  v_rcp_f32 v49, v49
  v_mfma_f32_16x16x32_bf16 v[144:147], a[252:255], v[220:223], 0
  ds_read_b128 v[216:219], v3 offset:3600
  ds_read_b128 v[220:223], v4 offset:144
  v_mfma_f32_32x32x16_bf16 v[16:31], a[124:127], v[164:167], v[16:31]
  ds_read_b128 v[200:203], v0 offset:32768
  ds_read_b128 v[204:207], v0 offset:33792
  v_rcp_f32 v50, v50
  v_rcp_f32 v51, v51
  v_mfma_f32_16x16x32_bf16 v[144:147], v[224:227], v[228:231], v[144:147]
  ds_read_b128 v[224:227], v3 offset:8400
  ds_read_b128 v[228:231], v4 offset:336
  v_mfma_f32_32x32x16_bf16 v[16:31], a[128:131], v[168:171], v[16:31]
  ds_read_b128 v[208:211], v0 offset:34816
  ds_read_b128 v[212:215], v0 offset:35840
  v_rcp_f32 v52, v52
  v_rcp_f32 v53, v53
  v_mfma_f32_16x16x32_bf16 v[144:147], v[232:235], v[236:239], v[144:147]
  ds_read_b128 v[232:235], v3 offset:13200
  ds_read_b128 v[236:239], v4 offset:528
  v_mfma_f32_32x32x16_bf16 v[16:31], a[132:135], v[172:175], v[16:31]
  buffer_store_dwordx4 v[124:127], v10, s[8:11], s28 offen offset:96
  v_rcp_f32 v54, v54
  v_rcp_f32 v55, v55
  v_mfma_f32_32x32x16_bf16 v[16:31], a[136:139], v[176:179], v[16:31]
  v_rcp_f32 v56, v56
  v_rcp_f32 v57, v57
  v_rcp_f32_e64 v58, v58
  v_mfma_f32_32x32x16_bf16 v[16:31], a[140:143], v[180:183], v[16:31]
  s_waitcnt lgkmcnt(0)
  v_rcp_f32 v59, v59
  v_rcp_f32 v60, v60
  v_rcp_f32 v61, v61
  v_rcp_f32 v62, v62
  v_rcp_f32 v63, v63
  v_pk_mul_f32 v[32:33], v[32:33], v[48:49]
  v_pk_mul_f32 v[34:35], v[34:35], v[50:51]
  v_pk_mul_f32 v[36:37], v[36:37], v[52:53]
  v_pk_mul_f32 v[38:39], v[38:39], v[54:55]
  v_pk_mul_f32 v[40:41], v[40:41], v[56:57]
  v_pk_mul_f32 v[42:43], v[42:43], v[58:59]
  v_pk_mul_f32 v[44:45], v[44:45], v[60:61]
  v_pk_mul_f32 v[46:47], v[46:47], v[62:63]
  v_pk_add_f32 v[12:13], v[12:13], v[144:145]
  v_pk_fma_f32 v[14:15], v[144:145], v[144:145], v[14:15]
  v_pk_add_f32 v[12:13], v[12:13], v[146:147]
  v_pk_fma_f32 v[14:15], v[146:147], v[146:147], v[14:15]
  v_pk_fma_f32 v[48:49], v[16:17], v[16:17], s[20:21] neg_lo:[1,0,1] neg_hi:[1,0,1]
  v_pk_fma_f32 v[50:51], v[18:19], v[18:19], s[20:21] neg_lo:[1,0,1] neg_hi:[1,0,1]
  v_pk_fma_f32 v[52:53], v[20:21], v[20:21], s[20:21] neg_lo:[1,0,1] neg_hi:[1,0,1]
  v_pk_fma_f32 v[54:55], v[22:23], v[22:23], s[20:21] neg_lo:[1,0,1] neg_hi:[1,0,1]
  v_pk_fma_f32 v[56:57], v[24:25], v[24:25], s[20:21] neg_lo:[1,0,1] neg_hi:[1,0,1]
  v_pk_fma_f32 v[58:59], v[26:27], v[26:27], s[20:21] neg_lo:[1,0,1] neg_hi:[1,0,1]
  v_pk_fma_f32 v[60:61], v[28:29], v[28:29], s[20:21] neg_lo:[1,0,1] neg_hi:[1,0,1]
  v_pk_fma_f32 v[62:63], v[30:31], v[30:31], s[20:21] neg_lo:[1,0,1] neg_hi:[1,0,1]
  v_pk_mul_f32 v[48:49], v[16:17], v[48:49]
  v_pk_mul_f32 v[50:51], v[18:19], v[50:51]
  v_pk_mul_f32 v[52:53], v[20:21], v[52:53]
  v_pk_mul_f32 v[54:55], v[22:23], v[54:55]
  v_pk_mul_f32 v[56:57], v[24:25], v[56:57]
  v_pk_mul_f32 v[58:59], v[26:27], v[58:59]
  v_pk_mul_f32 v[60:61], v[28:29], v[60:61]
  v_pk_mul_f32 v[62:63], v[30:31], v[62:63]
  v_mfma_f32_16x16x32_bf16 v[148:151], v[216:219], v[220:223], 0
  v_cvt_pk_bf16_f32 v184, v32, v33
  v_cvt_pk_bf16_f32 v185, v34, v35
  v_mfma_f32_16x16x32_bf16 v[148:151], v[224:227], v[228:231], v[148:151]
  v_cvt_pk_bf16_f32 v186, v36, v37
  v_cvt_pk_bf16_f32 v187, v38, v39
  v_mfma_f32_16x16x32_bf16 v[148:151], v[232:235], v[236:239], v[148:151]
  ds_read_b128 v[216:219], v3 offset:4000
  ds_read_b128 v[220:223], v4 offset:160
  v_mfma_f32_32x32x16_bf16 v[64:79], v[192:195], v[184:187], v[64:79]
  ds_read_b128 v[224:227], v3 offset:8800
  ds_read_b128 v[228:231], v4 offset:352
  v_cvt_pk_bf16_f32 v188, v40, v41
  v_cvt_pk_bf16_f32 v189, v42, v43
  v_cvt_pk_bf16_f32 v190, v44, v45
  v_cvt_pk_bf16_f32 v191, v46, v47
  v_mfma_f32_32x32x16_bf16 v[80:95], v[196:199], v[184:187], v[80:95]
  ds_read_b128 v[232:235], v3 offset:13600
  ds_read_b128 v[236:239], v4 offset:544
  v_exp_f32 v48, v48
  v_exp_f32 v49, v49
  v_mfma_f32_32x32x16_bf16 v[96:111], v[200:203], v[184:187], v[96:111]
  v_exp_f32 v50, v50
  v_exp_f32 v51, v51
  v_exp_f32_e64 v52, v52
  v_mfma_f32_32x32x16_bf16 v[64:79], v[204:207], v[188:191], v[64:79]
  v_exp_f32 v53, v53
  v_exp_f32 v54, v54
  v_exp_f32_e64 v55, v55
  v_mfma_f32_32x32x16_bf16 v[80:95], v[208:211], v[188:191], v[80:95]
  v_exp_f32 v56, v56
  v_exp_f32 v57, v57
  v_exp_f32_e64 v58, v58
  v_mfma_f32_32x32x16_bf16 v[96:111], v[212:215], v[188:191], v[96:111]
  s_waitcnt lgkmcnt(0)
  v_exp_f32 v59, v59
  v_exp_f32 v60, v60
  v_exp_f32 v61, v61
  v_exp_f32 v62, v62
  v_exp_f32 v63, v63
  v_pk_add_f32 v[12:13], v[12:13], v[148:149]
  v_pk_fma_f32 v[14:15], v[148:149], v[148:149], v[14:15]
  v_pk_add_f32 v[12:13], v[12:13], v[150:151]
  v_pk_fma_f32 v[14:15], v[150:151], v[150:151], v[14:15]
  v_pk_fma_f32 v[48:49], v[48:49], s[22:23], s[22:23]
  v_pk_fma_f32 v[50:51], v[50:51], s[22:23], s[22:23]
  v_pk_fma_f32 v[52:53], v[52:53], s[22:23], s[22:23]
  v_pk_fma_f32 v[54:55], v[54:55], s[22:23], s[22:23]
  v_pk_fma_f32 v[56:57], v[56:57], s[22:23], s[22:23]
  v_pk_fma_f32 v[58:59], v[58:59], s[22:23], s[22:23]
  v_pk_fma_f32 v[60:61], v[60:61], s[22:23], s[22:23]
  v_pk_fma_f32 v[62:63], v[62:63], s[22:23], s[22:23]
  v_mfma_f32_32x32x16_bf16 v[32:47], a[144:147], v[160:163], 0
  ds_read_b128 v[192:195], v0 offset:36864
  ds_read_b128 v[196:199], v0 offset:37888
  v_rcp_f32 v48, v48
  v_rcp_f32 v49, v49
  v_mfma_f32_16x16x32_bf16 v[152:155], v[216:219], v[220:223], 0
  ds_read_b128 v[216:219], v3 offset:4400
  ds_read_b128 v[220:223], v4 offset:176
  v_mfma_f32_32x32x16_bf16 v[32:47], a[148:151], v[164:167], v[32:47]
  ds_read_b128 v[200:203], v0 offset:38912
  ds_read_b128 v[204:207], v0 offset:39936
  v_rcp_f32 v50, v50
  v_rcp_f32 v51, v51
  v_mfma_f32_16x16x32_bf16 v[152:155], v[224:227], v[228:231], v[152:155]
  ds_read_b128 v[224:227], v3 offset:9200
  ds_read_b128 v[228:231], v4 offset:368
  v_mfma_f32_32x32x16_bf16 v[32:47], a[152:155], v[168:171], v[32:47]
  ds_read_b128 v[208:211], v0 offset:40960
  ds_read_b128 v[212:215], v0 offset:41984
  v_rcp_f32 v52, v52
  v_rcp_f32 v53, v53
  v_mfma_f32_16x16x32_bf16 v[152:155], v[232:235], v[236:239], v[152:155]
  ds_read_b128 v[232:235], v3 offset:14000
  ds_read_b128 v[236:239], v4 offset:560
  v_mfma_f32_32x32x16_bf16 v[32:47], a[156:159], v[172:175], v[32:47]
  v_rcp_f32 v54, v54
  v_rcp_f32 v55, v55
  v_rcp_f32_e64 v56, v56
  v_mfma_f32_32x32x16_bf16 v[32:47], a[160:163], v[176:179], v[32:47]
  v_rcp_f32 v57, v57
  v_rcp_f32 v58, v58
  v_rcp_f32_e64 v59, v59
  v_mfma_f32_32x32x16_bf16 v[32:47], a[164:167], v[180:183], v[32:47]
  s_waitcnt lgkmcnt(0)
  v_rcp_f32 v60, v60
  v_rcp_f32 v61, v61
  v_rcp_f32 v62, v62
  v_rcp_f32_e64 v63, v63
  v_pk_mul_f32 v[16:17], v[16:17], v[48:49]
  v_pk_mul_f32 v[18:19], v[18:19], v[50:51]
  v_pk_mul_f32 v[20:21], v[20:21], v[52:53]
  v_pk_mul_f32 v[22:23], v[22:23], v[54:55]
  v_pk_mul_f32 v[24:25], v[24:25], v[56:57]
  v_pk_mul_f32 v[26:27], v[26:27], v[58:59]
  v_pk_mul_f32 v[28:29], v[28:29], v[60:61]
  v_pk_mul_f32 v[30:31], v[30:31], v[62:63]
  v_pk_add_f32 v[12:13], v[12:13], v[152:153]
  v_pk_fma_f32 v[14:15], v[152:153], v[152:153], v[14:15]
  v_pk_add_f32 v[12:13], v[12:13], v[154:155]
  v_pk_fma_f32 v[14:15], v[154:155], v[154:155], v[14:15]
  v_pk_fma_f32 v[48:49], v[32:33], v[32:33], s[20:21] neg_lo:[1,0,1] neg_hi:[1,0,1]
  v_pk_fma_f32 v[50:51], v[34:35], v[34:35], s[20:21] neg_lo:[1,0,1] neg_hi:[1,0,1]
  v_pk_fma_f32 v[52:53], v[36:37], v[36:37], s[20:21] neg_lo:[1,0,1] neg_hi:[1,0,1]
  v_pk_fma_f32 v[54:55], v[38:39], v[38:39], s[20:21] neg_lo:[1,0,1] neg_hi:[1,0,1]
  v_pk_fma_f32 v[56:57], v[40:41], v[40:41], s[20:21] neg_lo:[1,0,1] neg_hi:[1,0,1]
  v_pk_fma_f32 v[58:59], v[42:43], v[42:43], s[20:21] neg_lo:[1,0,1] neg_hi:[1,0,1]
  v_pk_fma_f32 v[60:61], v[44:45], v[44:45], s[20:21] neg_lo:[1,0,1] neg_hi:[1,0,1]
  v_pk_fma_f32 v[62:63], v[46:47], v[46:47], s[20:21] neg_lo:[1,0,1] neg_hi:[1,0,1]
  v_pk_mul_f32 v[48:49], v[32:33], v[48:49]
  v_pk_mul_f32 v[50:51], v[34:35], v[50:51]
  v_pk_mul_f32 v[52:53], v[36:37], v[52:53]
  v_pk_mul_f32 v[54:55], v[38:39], v[54:55]
  v_pk_mul_f32 v[56:57], v[40:41], v[56:57]
  v_pk_mul_f32 v[58:59], v[42:43], v[58:59]
  v_pk_mul_f32 v[60:61], v[44:45], v[60:61]
  v_pk_mul_f32 v[62:63], v[46:47], v[62:63]
  v_mfma_f32_16x16x32_bf16 v[156:159], v[216:219], v[220:223], 0
  v_cvt_pk_bf16_f32 v184, v16, v17
  v_cvt_pk_bf16_f32 v185, v18, v19
  v_mfma_f32_16x16x32_bf16 v[156:159], v[224:227], v[228:231], v[156:159]
  v_cvt_pk_bf16_f32 v186, v20, v21
  v_cvt_pk_bf16_f32 v187, v22, v23
  v_mfma_f32_16x16x32_bf16 v[156:159], v[232:235], v[236:239], v[156:159]
  ds_read_b128 v[216:219], v3
  ds_read_b128 v[220:223], v4
  v_mfma_f32_32x32x16_bf16 v[64:79], v[192:195], v[184:187], v[64:79]
  ds_read_b128 v[224:227], v3 offset:4800
  ds_read_b128 v[228:231], v4 offset:192
  v_cvt_pk_bf16_f32 v188, v24, v25
  v_cvt_pk_bf16_f32 v189, v26, v27
  v_cvt_pk_bf16_f32 v190, v28, v29
  v_cvt_pk_bf16_f32 v191, v30, v31
  v_mfma_f32_32x32x16_bf16 v[80:95], v[196:199], v[184:187], v[80:95]
  ds_read_b128 v[232:235], v3 offset:9600
  ds_read_b128 v[236:239], v4 offset:384
  v_exp_f32 v48, v48
  v_exp_f32 v49, v49
  v_mfma_f32_32x32x16_bf16 v[96:111], v[200:203], v[184:187], v[96:111]
  v_exp_f32 v50, v50
  v_exp_f32 v51, v51
  v_exp_f32_e64 v52, v52
  v_mfma_f32_32x32x16_bf16 v[64:79], v[204:207], v[188:191], v[64:79]
  v_exp_f32 v53, v53
  v_exp_f32 v54, v54
  v_exp_f32_e64 v55, v55
  v_mfma_f32_32x32x16_bf16 v[80:95], v[208:211], v[188:191], v[80:95]
  v_exp_f32 v56, v56
  v_exp_f32 v57, v57
  v_exp_f32_e64 v58, v58
  v_mfma_f32_32x32x16_bf16 v[96:111], v[212:215], v[188:191], v[96:111]
  s_waitcnt lgkmcnt(0)
  v_exp_f32 v59, v59
  v_exp_f32 v60, v60
  v_exp_f32 v61, v61
  v_exp_f32 v62, v62
  v_exp_f32 v63, v63
  v_pk_add_f32 v[12:13], v[12:13], v[156:157]
  v_pk_fma_f32 v[14:15], v[156:157], v[156:157], v[14:15]
  v_pk_add_f32 v[12:13], v[12:13], v[158:159]
  v_pk_fma_f32 v[14:15], v[158:159], v[158:159], v[14:15]
  v_pk_fma_f32 v[48:49], v[48:49], s[22:23], s[22:23]
  v_pk_fma_f32 v[50:51], v[50:51], s[22:23], s[22:23]
  v_pk_fma_f32 v[52:53], v[52:53], s[22:23], s[22:23]
  v_pk_fma_f32 v[54:55], v[54:55], s[22:23], s[22:23]
  v_pk_fma_f32 v[56:57], v[56:57], s[22:23], s[22:23]
  v_pk_fma_f32 v[58:59], v[58:59], s[22:23], s[22:23]
  v_pk_fma_f32 v[60:61], v[60:61], s[22:23], s[22:23]
  v_pk_fma_f32 v[62:63], v[62:63], s[22:23], s[22:23]
  v_mfma_f32_32x32x16_bf16 v[16:31], a[168:171], v[160:163], 0
  ds_read_b128 v[192:195], v0 offset:43008
  ds_read_b128 v[196:199], v0 offset:44032
  v_rcp_f32 v48, v48
  v_rcp_f32 v49, v49
  v_mfma_f32_16x16x32_bf16 v[112:115], v[216:219], v[220:223], 0
  ds_read_b128 v[216:219], v3 offset:400
  ds_read_b128 v[220:223], v4 offset:16
  v_mfma_f32_32x32x16_bf16 v[16:31], a[172:175], v[164:167], v[16:31]
  ds_read_b128 v[200:203], v0 offset:45056
  ds_read_b128 v[204:207], v0 offset:46080
  v_rcp_f32 v50, v50
  v_rcp_f32 v51, v51
  v_mfma_f32_16x16x32_bf16 v[112:115], v[224:227], v[228:231], v[112:115]
  ds_read_b128 v[224:227], v3 offset:5200
  ds_read_b128 v[228:231], v4 offset:208
  v_mfma_f32_32x32x16_bf16 v[16:31], a[176:179], v[168:171], v[16:31]
  ds_read_b128 v[208:211], v0 offset:47104
  ds_read_b128 v[212:215], v0 offset:48128
  v_rcp_f32 v52, v52
  v_rcp_f32 v53, v53
  v_mfma_f32_16x16x32_bf16 v[112:115], v[232:235], v[236:239], v[112:115]
  ds_read_b128 v[232:235], v3 offset:10000
  ds_read_b128 v[236:239], v4 offset:400
  v_mfma_f32_32x32x16_bf16 v[16:31], a[180:183], v[172:175], v[16:31]
  buffer_store_dwordx4 v[128:131], v10, s[8:11], s28 offen offset:128
  v_rcp_f32 v54, v54
  v_rcp_f32 v55, v55
  v_mfma_f32_32x32x16_bf16 v[16:31], a[184:187], v[176:179], v[16:31]
  v_rcp_f32 v56, v56
  v_rcp_f32 v57, v57
  v_rcp_f32_e64 v58, v58
  v_mfma_f32_32x32x16_bf16 v[16:31], a[188:191], v[180:183], v[16:31]
  s_waitcnt lgkmcnt(0)
  v_rcp_f32 v59, v59
  v_rcp_f32 v60, v60
  v_rcp_f32 v61, v61
  v_rcp_f32 v62, v62
  v_rcp_f32 v63, v63
  v_pk_mul_f32 v[32:33], v[32:33], v[48:49]
  v_pk_mul_f32 v[34:35], v[34:35], v[50:51]
  v_pk_mul_f32 v[36:37], v[36:37], v[52:53]
  v_pk_mul_f32 v[38:39], v[38:39], v[54:55]
  v_pk_mul_f32 v[40:41], v[40:41], v[56:57]
  v_pk_mul_f32 v[42:43], v[42:43], v[58:59]
  v_pk_mul_f32 v[44:45], v[44:45], v[60:61]
  v_pk_mul_f32 v[46:47], v[46:47], v[62:63]
  v_pk_add_f32 v[12:13], v[12:13], v[112:113]
  v_pk_fma_f32 v[14:15], v[112:113], v[112:113], v[14:15]
  v_pk_add_f32 v[12:13], v[12:13], v[114:115]
  v_pk_fma_f32 v[14:15], v[114:115], v[114:115], v[14:15]
  v_pk_fma_f32 v[48:49], v[16:17], v[16:17], s[20:21] neg_lo:[1,0,1] neg_hi:[1,0,1]
  v_pk_fma_f32 v[50:51], v[18:19], v[18:19], s[20:21] neg_lo:[1,0,1] neg_hi:[1,0,1]
  v_pk_fma_f32 v[52:53], v[20:21], v[20:21], s[20:21] neg_lo:[1,0,1] neg_hi:[1,0,1]
  v_pk_fma_f32 v[54:55], v[22:23], v[22:23], s[20:21] neg_lo:[1,0,1] neg_hi:[1,0,1]
  v_pk_fma_f32 v[56:57], v[24:25], v[24:25], s[20:21] neg_lo:[1,0,1] neg_hi:[1,0,1]
  v_pk_fma_f32 v[58:59], v[26:27], v[26:27], s[20:21] neg_lo:[1,0,1] neg_hi:[1,0,1]
  v_pk_fma_f32 v[60:61], v[28:29], v[28:29], s[20:21] neg_lo:[1,0,1] neg_hi:[1,0,1]
  v_pk_fma_f32 v[62:63], v[30:31], v[30:31], s[20:21] neg_lo:[1,0,1] neg_hi:[1,0,1]
  v_pk_mul_f32 v[48:49], v[16:17], v[48:49]
  v_pk_mul_f32 v[50:51], v[18:19], v[50:51]
  v_pk_mul_f32 v[52:53], v[20:21], v[52:53]
  v_pk_mul_f32 v[54:55], v[22:23], v[54:55]
  v_pk_mul_f32 v[56:57], v[24:25], v[56:57]
  v_pk_mul_f32 v[58:59], v[26:27], v[58:59]
  v_pk_mul_f32 v[60:61], v[28:29], v[60:61]
  v_pk_mul_f32 v[62:63], v[30:31], v[62:63]
  v_mfma_f32_16x16x32_bf16 v[116:119], v[216:219], v[220:223], 0
  v_cvt_pk_bf16_f32 v184, v32, v33
  v_cvt_pk_bf16_f32 v185, v34, v35
  v_mfma_f32_16x16x32_bf16 v[116:119], v[224:227], v[228:231], v[116:119]
  v_cvt_pk_bf16_f32 v186, v36, v37
  v_cvt_pk_bf16_f32 v187, v38, v39
  v_mfma_f32_16x16x32_bf16 v[116:119], v[232:235], v[236:239], v[116:119]
  ds_read_b128 v[216:219], v3 offset:800
  ds_read_b128 v[220:223], v4 offset:32
  v_mfma_f32_32x32x16_bf16 v[64:79], v[192:195], v[184:187], v[64:79]
  ds_read_b128 v[224:227], v3 offset:5600
  ds_read_b128 v[228:231], v4 offset:224
  v_cvt_pk_bf16_f32 v188, v40, v41
  v_cvt_pk_bf16_f32 v189, v42, v43
  v_cvt_pk_bf16_f32 v190, v44, v45
  v_cvt_pk_bf16_f32 v191, v46, v47
  v_mfma_f32_32x32x16_bf16 v[80:95], v[196:199], v[184:187], v[80:95]
  ds_read_b128 v[232:235], v3 offset:10400
  ds_read_b128 v[236:239], v4 offset:416
  v_exp_f32 v48, v48
  v_exp_f32 v49, v49
  v_mfma_f32_32x32x16_bf16 v[96:111], v[200:203], v[184:187], v[96:111]
  v_exp_f32 v50, v50
  v_exp_f32 v51, v51
  v_exp_f32_e64 v52, v52
  v_mfma_f32_32x32x16_bf16 v[64:79], v[204:207], v[188:191], v[64:79]
  v_exp_f32 v53, v53
  v_exp_f32 v54, v54
  v_exp_f32_e64 v55, v55
  v_mfma_f32_32x32x16_bf16 v[80:95], v[208:211], v[188:191], v[80:95]
  v_exp_f32 v56, v56
  v_exp_f32 v57, v57
  v_exp_f32_e64 v58, v58
  v_mfma_f32_32x32x16_bf16 v[96:111], v[212:215], v[188:191], v[96:111]
  s_waitcnt lgkmcnt(0)
  v_exp_f32 v59, v59
  v_exp_f32 v60, v60
  v_exp_f32 v61, v61
  v_exp_f32 v62, v62
  v_exp_f32 v63, v63
  v_pk_add_f32 v[12:13], v[12:13], v[116:117]
  v_pk_fma_f32 v[14:15], v[116:117], v[116:117], v[14:15]
  v_pk_add_f32 v[12:13], v[12:13], v[118:119]
  v_pk_fma_f32 v[14:15], v[118:119], v[118:119], v[14:15]
  v_pk_fma_f32 v[48:49], v[48:49], s[22:23], s[22:23]
  v_pk_fma_f32 v[50:51], v[50:51], s[22:23], s[22:23]
  v_pk_fma_f32 v[52:53], v[52:53], s[22:23], s[22:23]
  v_pk_fma_f32 v[54:55], v[54:55], s[22:23], s[22:23]
  v_pk_fma_f32 v[56:57], v[56:57], s[22:23], s[22:23]
  v_pk_fma_f32 v[58:59], v[58:59], s[22:23], s[22:23]
  v_pk_fma_f32 v[60:61], v[60:61], s[22:23], s[22:23]
  v_pk_fma_f32 v[62:63], v[62:63], s[22:23], s[22:23]
  v_mfma_f32_32x32x16_bf16 v[32:47], a[192:195], v[160:163], 0
  ds_read_b128 v[192:195], v0 offset:49152
  ds_read_b128 v[196:199], v0 offset:50176
  v_rcp_f32 v48, v48
  v_rcp_f32 v49, v49
  v_mfma_f32_16x16x32_bf16 v[120:123], v[216:219], v[220:223], 0
  ds_read_b128 v[216:219], v3 offset:1200
  ds_read_b128 v[220:223], v4 offset:48
  v_mfma_f32_32x32x16_bf16 v[32:47], a[196:199], v[164:167], v[32:47]
  ds_read_b128 v[200:203], v0 offset:51200
  ds_read_b128 v[204:207], v0 offset:52224
  v_rcp_f32 v50, v50
  v_rcp_f32 v51, v51
  v_mfma_f32_16x16x32_bf16 v[120:123], v[224:227], v[228:231], v[120:123]
  ds_read_b128 v[224:227], v3 offset:6000
  ds_read_b128 v[228:231], v4 offset:240
  v_mfma_f32_32x32x16_bf16 v[32:47], a[200:203], v[168:171], v[32:47]
  ds_read_b128 v[208:211], v0 offset:53248
  ds_read_b128 v[212:215], v0 offset:54272
  v_rcp_f32 v52, v52
  v_rcp_f32 v53, v53
  v_mfma_f32_16x16x32_bf16 v[120:123], v[232:235], v[236:239], v[120:123]
  ds_read_b128 v[232:235], v3 offset:10800
  ds_read_b128 v[236:239], v4 offset:432
  v_mfma_f32_32x32x16_bf16 v[32:47], a[204:207], v[172:175], v[32:47]
  buffer_store_dwordx4 v[132:135], v10, s[8:11], s28 offen offset:160
  v_rcp_f32 v54, v54
  v_rcp_f32 v55, v55
  v_mfma_f32_32x32x16_bf16 v[32:47], a[208:211], v[176:179], v[32:47]
  v_rcp_f32 v56, v56
  v_rcp_f32 v57, v57
  v_rcp_f32_e64 v58, v58
  v_mfma_f32_32x32x16_bf16 v[32:47], a[212:215], v[180:183], v[32:47]
  s_waitcnt lgkmcnt(0)
  v_rcp_f32 v59, v59
  v_rcp_f32 v60, v60
  v_rcp_f32 v61, v61
  v_rcp_f32 v62, v62
  v_rcp_f32 v63, v63
  v_pk_mul_f32 v[16:17], v[16:17], v[48:49]
  v_pk_mul_f32 v[18:19], v[18:19], v[50:51]
  v_pk_mul_f32 v[20:21], v[20:21], v[52:53]
  v_pk_mul_f32 v[22:23], v[22:23], v[54:55]
  v_pk_mul_f32 v[24:25], v[24:25], v[56:57]
  v_pk_mul_f32 v[26:27], v[26:27], v[58:59]
  v_pk_mul_f32 v[28:29], v[28:29], v[60:61]
  v_pk_mul_f32 v[30:31], v[30:31], v[62:63]
  v_pk_add_f32 v[12:13], v[12:13], v[120:121]
  v_pk_fma_f32 v[14:15], v[120:121], v[120:121], v[14:15]
  v_pk_add_f32 v[12:13], v[12:13], v[122:123]
  v_pk_fma_f32 v[14:15], v[122:123], v[122:123], v[14:15]
  v_pk_fma_f32 v[48:49], v[32:33], v[32:33], s[20:21] neg_lo:[1,0,1] neg_hi:[1,0,1]
  v_pk_fma_f32 v[50:51], v[34:35], v[34:35], s[20:21] neg_lo:[1,0,1] neg_hi:[1,0,1]
  v_pk_fma_f32 v[52:53], v[36:37], v[36:37], s[20:21] neg_lo:[1,0,1] neg_hi:[1,0,1]
  v_pk_fma_f32 v[54:55], v[38:39], v[38:39], s[20:21] neg_lo:[1,0,1] neg_hi:[1,0,1]
  v_pk_fma_f32 v[56:57], v[40:41], v[40:41], s[20:21] neg_lo:[1,0,1] neg_hi:[1,0,1]
  v_pk_fma_f32 v[58:59], v[42:43], v[42:43], s[20:21] neg_lo:[1,0,1] neg_hi:[1,0,1]
  v_pk_fma_f32 v[60:61], v[44:45], v[44:45], s[20:21] neg_lo:[1,0,1] neg_hi:[1,0,1]
  v_pk_fma_f32 v[62:63], v[46:47], v[46:47], s[20:21] neg_lo:[1,0,1] neg_hi:[1,0,1]
  v_pk_mul_f32 v[48:49], v[32:33], v[48:49]
  v_pk_mul_f32 v[50:51], v[34:35], v[50:51]
  v_pk_mul_f32 v[52:53], v[36:37], v[52:53]
  v_pk_mul_f32 v[54:55], v[38:39], v[54:55]
  v_pk_mul_f32 v[56:57], v[40:41], v[56:57]
  v_pk_mul_f32 v[58:59], v[42:43], v[58:59]
  v_pk_mul_f32 v[60:61], v[44:45], v[60:61]
  v_pk_mul_f32 v[62:63], v[46:47], v[62:63]
  v_mfma_f32_16x16x32_bf16 v[124:127], v[216:219], v[220:223], 0
  v_cvt_pk_bf16_f32 v184, v16, v17
  v_cvt_pk_bf16_f32 v185, v18, v19
  v_mfma_f32_16x16x32_bf16 v[124:127], v[224:227], v[228:231], v[124:127]
  v_cvt_pk_bf16_f32 v186, v20, v21
  v_cvt_pk_bf16_f32 v187, v22, v23
  v_mfma_f32_16x16x32_bf16 v[124:127], v[232:235], v[236:239], v[124:127]
  ds_read_b128 v[216:219], v3 offset:1600
  ds_read_b128 v[220:223], v4 offset:64
  v_mfma_f32_32x32x16_bf16 v[64:79], v[192:195], v[184:187], v[64:79]
  ds_read_b128 v[224:227], v3 offset:6400
  ds_read_b128 v[228:231], v4 offset:256
  v_cvt_pk_bf16_f32 v188, v24, v25
  v_cvt_pk_bf16_f32 v189, v26, v27
  v_cvt_pk_bf16_f32 v190, v28, v29
  v_cvt_pk_bf16_f32 v191, v30, v31
  v_mfma_f32_32x32x16_bf16 v[80:95], v[196:199], v[184:187], v[80:95]
  ds_read_b128 v[232:235], v3 offset:11200
  ds_read_b128 v[236:239], v4 offset:448
  v_exp_f32 v48, v48
  v_exp_f32 v49, v49
  v_mfma_f32_32x32x16_bf16 v[96:111], v[200:203], v[184:187], v[96:111]
  v_exp_f32 v50, v50
  v_exp_f32 v51, v51
  v_exp_f32_e64 v52, v52
  v_mfma_f32_32x32x16_bf16 v[64:79], v[204:207], v[188:191], v[64:79]
  v_exp_f32 v53, v53
  v_exp_f32 v54, v54
  v_exp_f32_e64 v55, v55
  v_mfma_f32_32x32x16_bf16 v[80:95], v[208:211], v[188:191], v[80:95]
  v_exp_f32 v56, v56
  v_exp_f32 v57, v57
  v_exp_f32_e64 v58, v58
  v_mfma_f32_32x32x16_bf16 v[96:111], v[212:215], v[188:191], v[96:111]
  s_waitcnt lgkmcnt(0)
  v_exp_f32 v59, v59
  v_exp_f32 v60, v60
  v_exp_f32 v61, v61
  v_exp_f32 v62, v62
  v_exp_f32 v63, v63
  v_pk_add_f32 v[12:13], v[12:13], v[124:125]
  v_pk_fma_f32 v[14:15], v[124:125], v[124:125], v[14:15]
  v_pk_add_f32 v[12:13], v[12:13], v[126:127]
  v_pk_fma_f32 v[14:15], v[126:127], v[126:127], v[14:15]
  v_pk_fma_f32 v[48:49], v[48:49], s[22:23], s[22:23]
  v_pk_fma_f32 v[50:51], v[50:51], s[22:23], s[22:23]
  v_pk_fma_f32 v[52:53], v[52:53], s[22:23], s[22:23]
  v_pk_fma_f32 v[54:55], v[54:55], s[22:23], s[22:23]
  v_pk_fma_f32 v[56:57], v[56:57], s[22:23], s[22:23]
  v_pk_fma_f32 v[58:59], v[58:59], s[22:23], s[22:23]
  v_pk_fma_f32 v[60:61], v[60:61], s[22:23], s[22:23]
  v_pk_fma_f32 v[62:63], v[62:63], s[22:23], s[22:23]
  v_mfma_f32_32x32x16_bf16 v[16:31], a[216:219], v[160:163], 0
  ds_read_b128 v[192:195], v0 offset:55296
  ds_read_b128 v[196:199], v0 offset:56320
  v_rcp_f32 v48, v48
  v_rcp_f32 v49, v49
  v_mfma_f32_16x16x32_bf16 v[128:131], v[216:219], v[220:223], 0
  ds_read_b128 v[216:219], v3 offset:2000
  ds_read_b128 v[220:223], v4 offset:80
  v_mfma_f32_32x32x16_bf16 v[16:31], a[220:223], v[164:167], v[16:31]
  ds_read_b128 v[200:203], v0 offset:57344
  ds_read_b128 v[204:207], v0 offset:58368
  v_rcp_f32 v50, v50
  v_rcp_f32 v51, v51
  v_mfma_f32_16x16x32_bf16 v[128:131], v[224:227], v[228:231], v[128:131]
  ds_read_b128 v[224:227], v3 offset:6800
  ds_read_b128 v[228:231], v4 offset:272
  v_mfma_f32_32x32x16_bf16 v[16:31], a[224:227], v[168:171], v[16:31]
  ds_read_b128 v[208:211], v0 offset:59392
  ds_read_b128 v[212:215], v0 offset:60416
  v_rcp_f32 v52, v52
  v_rcp_f32 v53, v53
  v_mfma_f32_16x16x32_bf16 v[128:131], v[232:235], v[236:239], v[128:131]
  ds_read_b128 v[232:235], v3 offset:11600
  ds_read_b128 v[236:239], v4 offset:464
  v_mfma_f32_32x32x16_bf16 v[16:31], a[228:231], v[172:175], v[16:31]
  v_rcp_f32 v54, v54
  v_rcp_f32 v55, v55
  v_rcp_f32_e64 v56, v56
  v_mfma_f32_32x32x16_bf16 v[16:31], a[232:235], v[176:179], v[16:31]
  v_rcp_f32 v57, v57
  v_rcp_f32 v58, v58
  v_rcp_f32_e64 v59, v59
  v_mfma_f32_32x32x16_bf16 v[16:31], a[236:239], v[180:183], v[16:31]
  s_waitcnt lgkmcnt(0)
  v_rcp_f32 v60, v60
  v_rcp_f32 v61, v61
  v_rcp_f32 v62, v62
  v_rcp_f32_e64 v63, v63
  v_pk_mul_f32 v[32:33], v[32:33], v[48:49]
  v_pk_mul_f32 v[34:35], v[34:35], v[50:51]
  v_pk_mul_f32 v[36:37], v[36:37], v[52:53]
  v_pk_mul_f32 v[38:39], v[38:39], v[54:55]
  v_pk_mul_f32 v[40:41], v[40:41], v[56:57]
  v_pk_mul_f32 v[42:43], v[42:43], v[58:59]
  v_pk_mul_f32 v[44:45], v[44:45], v[60:61]
  v_pk_mul_f32 v[46:47], v[46:47], v[62:63]
  v_pk_add_f32 v[12:13], v[12:13], v[128:129]
  v_pk_fma_f32 v[14:15], v[128:129], v[128:129], v[14:15]
  v_pk_add_f32 v[12:13], v[12:13], v[130:131]
  v_pk_fma_f32 v[14:15], v[130:131], v[130:131], v[14:15]
  v_pk_fma_f32 v[48:49], v[16:17], v[16:17], s[20:21] neg_lo:[1,0,1] neg_hi:[1,0,1]
  v_pk_fma_f32 v[50:51], v[18:19], v[18:19], s[20:21] neg_lo:[1,0,1] neg_hi:[1,0,1]
  v_pk_fma_f32 v[52:53], v[20:21], v[20:21], s[20:21] neg_lo:[1,0,1] neg_hi:[1,0,1]
  v_pk_fma_f32 v[54:55], v[22:23], v[22:23], s[20:21] neg_lo:[1,0,1] neg_hi:[1,0,1]
  v_pk_fma_f32 v[56:57], v[24:25], v[24:25], s[20:21] neg_lo:[1,0,1] neg_hi:[1,0,1]
  v_pk_fma_f32 v[58:59], v[26:27], v[26:27], s[20:21] neg_lo:[1,0,1] neg_hi:[1,0,1]
  v_pk_fma_f32 v[60:61], v[28:29], v[28:29], s[20:21] neg_lo:[1,0,1] neg_hi:[1,0,1]
  v_pk_fma_f32 v[62:63], v[30:31], v[30:31], s[20:21] neg_lo:[1,0,1] neg_hi:[1,0,1]
  v_pk_mul_f32 v[48:49], v[16:17], v[48:49]
  v_pk_mul_f32 v[50:51], v[18:19], v[50:51]
  v_pk_mul_f32 v[52:53], v[20:21], v[52:53]
  v_pk_mul_f32 v[54:55], v[22:23], v[54:55]
  v_pk_mul_f32 v[56:57], v[24:25], v[56:57]
  v_pk_mul_f32 v[58:59], v[26:27], v[58:59]
  v_pk_mul_f32 v[60:61], v[28:29], v[60:61]
  v_pk_mul_f32 v[62:63], v[30:31], v[62:63]
  v_mfma_f32_16x16x32_bf16 v[132:135], v[216:219], v[220:223], 0
  v_cvt_pk_bf16_f32 v184, v32, v33
  v_cvt_pk_bf16_f32 v185, v34, v35
  v_mfma_f32_16x16x32_bf16 v[132:135], v[224:227], v[228:231], v[132:135]
  v_cvt_pk_bf16_f32 v186, v36, v37
  v_cvt_pk_bf16_f32 v187, v38, v39
  v_mfma_f32_16x16x32_bf16 v[132:135], v[232:235], v[236:239], v[132:135]
  ds_read_b128 v[216:219], v0
  ds_read_b128 v[220:223], v0 offset:1024
  v_mfma_f32_32x32x16_bf16 v[64:79], v[192:195], v[184:187], v[64:79]
  ds_read_b128 v[224:227], v0 offset:4096
  ds_read_b128 v[228:231], v0 offset:5120
  v_cvt_pk_bf16_f32 v188, v40, v41
  v_cvt_pk_bf16_f32 v189, v42, v43
  v_cvt_pk_bf16_f32 v190, v44, v45
  v_cvt_pk_bf16_f32 v191, v46, v47
  v_mfma_f32_32x32x16_bf16 v[80:95], v[196:199], v[184:187], v[80:95]
  ds_read_b128 v[232:235], v0 offset:8192
  ds_read_b128 v[236:239], v0 offset:9216
  v_exp_f32 v48, v48
  v_exp_f32 v49, v49
  v_mfma_f32_32x32x16_bf16 v[96:111], v[200:203], v[184:187], v[96:111]
  v_exp_f32 v50, v50
  v_exp_f32 v51, v51
  v_exp_f32_e64 v52, v52
  v_mfma_f32_32x32x16_bf16 v[64:79], v[204:207], v[188:191], v[64:79]
  s_mov_b32 s28, s34
  v_exp_f32 v53, v53
  v_exp_f32 v54, v54
  v_exp_f32 v55, v55
  v_mfma_f32_32x32x16_bf16 v[80:95], v[208:211], v[188:191], v[80:95]
  s_add_u32 s34, s34, 0x60000
  v_exp_f32 v56, v56
  v_exp_f32 v57, v57
  v_exp_f32_e64 v58, v58
  v_mfma_f32_32x32x16_bf16 v[96:111], v[212:215], v[188:191], v[96:111]
  s_waitcnt lgkmcnt(0)
  v_exp_f32 v59, v59
  v_exp_f32 v60, v60
  v_exp_f32 v61, v61
  v_exp_f32 v62, v62
  v_exp_f32 v63, v63
  v_pk_add_f32 v[12:13], v[12:13], v[132:133]
  v_pk_fma_f32 v[14:15], v[132:133], v[132:133], v[14:15]
  v_pk_add_f32 v[12:13], v[12:13], v[134:135]
  v_pk_fma_f32 v[14:15], v[134:135], v[134:135], v[14:15]
  v_pk_fma_f32 v[48:49], v[48:49], s[22:23], s[22:23]
  v_pk_fma_f32 v[50:51], v[50:51], s[22:23], s[22:23]
  v_pk_fma_f32 v[52:53], v[52:53], s[22:23], s[22:23]
  v_pk_fma_f32 v[54:55], v[54:55], s[22:23], s[22:23]
  v_pk_fma_f32 v[56:57], v[56:57], s[22:23], s[22:23]
  v_pk_fma_f32 v[58:59], v[58:59], s[22:23], s[22:23]
  v_pk_fma_f32 v[60:61], v[60:61], s[22:23], s[22:23]
  v_pk_fma_f32 v[62:63], v[62:63], s[22:23], s[22:23]
  v_mfma_f32_32x32x16_bf16 v[32:47], v[216:219], v[160:163], 0
  ds_read_b128 v[192:195], v0 offset:61440
  ds_read_b128 v[196:199], v0 offset:62464
  v_rcp_f32 v48, v48
  v_rcp_f32 v49, v49
  v_add_f32_e64 v12, v12, v13
  v_mfma_f32_32x32x16_bf16 v[32:47], v[220:223], v[164:167], v[32:47]
  ds_read_b128 v[200:203], v0 offset:63488
  ds_read_b128 v[204:207], v0 offset:64512
  v_rcp_f32 v50, v50
  v_add_f32 v14, v14, v15
  v_rcp_f32_e64 v51, v51
  v_mfma_f32_32x32x16_bf16 v[32:47], v[224:227], v[168:171], v[32:47]
  ds_read_b128 v[208:211], v1
  ds_read_b128 v[212:215], v1 offset:1024
  v_permlane32_swap_b32 v12, v14
  v_rcp_f32 v52, v52
  v_add_f32 v12, v12, v14
  v_rcp_f32 v53, v53
  v_mfma_f32_32x32x16_bf16 v[32:47], v[228:231], v[172:175], v[32:47]
  v_mov_b32 v14, v12
  v_rcp_f32 v54, v54
  s_nop 0
  v_permlane32_swap_b32 v12, v14
  v_rcp_f32 v55, v55
  v_mul_f32 v12, s24, v12
  v_mfma_f32_32x32x16_bf16 v[32:47], v[232:235], v[176:179], v[32:47]
  v_rcp_f32 v56, v56
  v_rcp_f32 v57, v57
  v_mul_f32 v13, s24, v14
  v_rcp_f32 v58, v58
  v_fma_f32 v13, -v12, v12, v13
  v_mfma_f32_32x32x16_bf16 v[32:47], v[236:239], v[180:183], v[32:47]
  s_waitcnt lgkmcnt(0)
  v_rcp_f32 v59, v59
  v_max_f32 v13, 0, v13
  v_rcp_f32 v60, v60
  v_add_f32 v13, s25, v13
  v_rcp_f32 v61, v61
  v_rsq_f32 v13, v13
  v_rcp_f32 v62, v62
  v_mul_f32 v14, s22, v13
  v_rcp_f32 v63, v63
  v_mul_f32_e64 v12, -v12, v14
  v_pk_mul_f32 v[16:17], v[16:17], v[48:49]
  v_pk_mul_f32 v[18:19], v[18:19], v[50:51]
  v_pk_mul_f32 v[20:21], v[20:21], v[52:53]
  v_pk_mul_f32 v[22:23], v[22:23], v[54:55]
  v_pk_mul_f32 v[24:25], v[24:25], v[56:57]
  v_pk_mul_f32 v[26:27], v[26:27], v[58:59]
  v_pk_mul_f32 v[28:29], v[28:29], v[60:61]
  v_pk_mul_f32 v[30:31], v[30:31], v[62:63]
  v_pk_fma_f32 v[112:113], v[112:113], v[14:15], v[12:13] op_sel_hi:[1,0,0]
  v_pk_fma_f32 v[114:115], v[114:115], v[14:15], v[12:13] op_sel_hi:[1,0,0]
  v_pk_fma_f32 v[116:117], v[116:117], v[14:15], v[12:13] op_sel_hi:[1,0,0]
  v_pk_fma_f32 v[118:119], v[118:119], v[14:15], v[12:13] op_sel_hi:[1,0,0]
  v_pk_fma_f32 v[120:121], v[120:121], v[14:15], v[12:13] op_sel_hi:[1,0,0]
  v_pk_fma_f32 v[122:123], v[122:123], v[14:15], v[12:13] op_sel_hi:[1,0,0]
  v_pk_fma_f32 v[124:125], v[124:125], v[14:15], v[12:13] op_sel_hi:[1,0,0]
  v_pk_fma_f32 v[126:127], v[126:127], v[14:15], v[12:13] op_sel_hi:[1,0,0]
  v_pk_fma_f32 v[128:129], v[128:129], v[14:15], v[12:13] op_sel_hi:[1,0,0]
  v_pk_fma_f32 v[130:131], v[130:131], v[14:15], v[12:13] op_sel_hi:[1,0,0]
  v_pk_fma_f32 v[132:133], v[132:133], v[14:15], v[12:13] op_sel_hi:[1,0,0]
  v_pk_fma_f32 v[134:135], v[134:135], v[14:15], v[12:13] op_sel_hi:[1,0,0]
  v_pk_fma_f32 v[136:137], v[136:137], v[14:15], v[12:13] op_sel_hi:[1,0,0]
  v_pk_fma_f32 v[138:139], v[138:139], v[14:15], v[12:13] op_sel_hi:[1,0,0]
  v_pk_fma_f32 v[140:141], v[140:141], v[14:15], v[12:13] op_sel_hi:[1,0,0]
  v_pk_fma_f32 v[142:143], v[142:143], v[14:15], v[12:13] op_sel_hi:[1,0,0]
  v_pk_fma_f32 v[144:145], v[144:145], v[14:15], v[12:13] op_sel_hi:[1,0,0]
  v_pk_fma_f32 v[146:147], v[146:147], v[14:15], v[12:13] op_sel_hi:[1,0,0]
  v_pk_fma_f32 v[148:149], v[148:149], v[14:15], v[12:13] op_sel_hi:[1,0,0]
  v_pk_fma_f32 v[150:151], v[150:151], v[14:15], v[12:13] op_sel_hi:[1,0,0]
  v_pk_fma_f32 v[152:153], v[152:153], v[14:15], v[12:13] op_sel_hi:[1,0,0]
  v_pk_fma_f32 v[154:155], v[154:155], v[14:15], v[12:13] op_sel_hi:[1,0,0]
  v_pk_fma_f32 v[156:157], v[156:157], v[14:15], v[12:13] op_sel_hi:[1,0,0]
  v_pk_fma_f32 v[158:159], v[158:159], v[14:15], v[12:13] op_sel_hi:[1,0,0]
  v_pk_fma_f32 v[48:49], v[32:33], v[32:33], s[20:21] neg_lo:[1,0,1] neg_hi:[1,0,1]
  v_pk_fma_f32 v[50:51], v[34:35], v[34:35], s[20:21] neg_lo:[1,0,1] neg_hi:[1,0,1]
  v_pk_fma_f32 v[52:53], v[36:37], v[36:37], s[20:21] neg_lo:[1,0,1] neg_hi:[1,0,1]
  v_pk_fma_f32 v[54:55], v[38:39], v[38:39], s[20:21] neg_lo:[1,0,1] neg_hi:[1,0,1]
  v_pk_fma_f32 v[56:57], v[40:41], v[40:41], s[20:21] neg_lo:[1,0,1] neg_hi:[1,0,1]
  v_pk_fma_f32 v[58:59], v[42:43], v[42:43], s[20:21] neg_lo:[1,0,1] neg_hi:[1,0,1]
  v_pk_fma_f32 v[60:61], v[44:45], v[44:45], s[20:21] neg_lo:[1,0,1] neg_hi:[1,0,1]
  v_pk_fma_f32 v[62:63], v[46:47], v[46:47], s[20:21] neg_lo:[1,0,1] neg_hi:[1,0,1]
  v_pk_mul_f32 v[48:49], v[32:33], v[48:49]
  v_pk_mul_f32 v[50:51], v[34:35], v[50:51]
  v_pk_mul_f32 v[52:53], v[36:37], v[52:53]
  v_pk_mul_f32 v[54:55], v[38:39], v[54:55]
  v_pk_mul_f32 v[56:57], v[40:41], v[56:57]
  v_cvt_pk_bf16_f32 v184, v16, v17
  v_cvt_pk_bf16_f32 v185, v18, v19
  v_cvt_pk_bf16_f32 v186, v20, v21
  v_cvt_pk_bf16_f32 v187, v22, v23
  v_pk_mul_f32 v[58:59], v[42:43], v[58:59]
  v_pk_mul_f32 v[60:61], v[44:45], v[60:61]
  v_pk_mul_f32 v[62:63], v[46:47], v[62:63]
  v_mfma_f32_32x32x16_bf16 v[64:79], v[192:195], v[184:187], v[64:79]
  ds_read_b128 v[216:219], v0 offset:2048
  ds_read_b128 v[220:223], v0 offset:3072
  v_cvt_pk_bf16_f32 v188, v24, v25
  v_cvt_pk_bf16_f32 v189, v26, v27
  v_cvt_pk_bf16_f32 v190, v28, v29
  v_cvt_pk_bf16_f32 v191, v30, v31
  v_exp_f32_e64 v48, v48
  v_cndmask_b32 v159, v159, v250, s[12:13]
  v_mfma_f32_32x32x16_bf16 v[80:95], v[196:199], v[184:187], v[80:95]
  ds_read_b128 v[224:227], v0 offset:6144
  ds_read_b128 v[228:231], v0 offset:7168
  v_exp_f32_e64 v49, v49
  v_cvt_pk_bf16_f32 v160, v112, v113
  v_cvt_pk_bf16_f32 v161, v114, v115
  v_exp_f32_e64 v50, v50
  v_cvt_pk_bf16_f32 v162, v116, v117
  v_mfma_f32_32x32x16_bf16 v[96:111], v[200:203], v[184:187], v[96:111]
  ds_read_b128 v[232:235], v0 offset:10240
  ds_read_b128 v[236:239], v0 offset:11264
  v_exp_f32_e64 v51, v51
  v_cvt_pk_bf16_f32 v163, v118, v119
  v_cvt_pk_bf16_f32 v164, v120, v121
  v_exp_f32_e64 v52, v52
  v_cvt_pk_bf16_f32 v165, v122, v123
  v_mfma_f32_32x32x16_bf16 v[64:79], v[204:207], v[188:191], v[64:79]
  v_exp_f32_e64 v53, v53
  v_cvt_pk_bf16_f32 v166, v124, v125
  v_cvt_pk_bf16_f32 v167, v126, v127
  v_exp_f32_e64 v54, v54
  v_cvt_pk_bf16_f32 v168, v128, v129
  v_exp_f32_e64 v55, v55
  v_cvt_pk_bf16_f32 v169, v130, v131
  v_cvt_pk_bf16_f32 v170, v132, v133
  v_mfma_f32_32x32x16_bf16 v[80:95], v[208:211], v[188:191], v[80:95]
  v_exp_f32_e64 v56, v56
  v_cvt_pk_bf16_f32 v171, v134, v135
  v_cvt_pk_bf16_f32 v172, v136, v137
  v_exp_f32_e64 v57, v57
  v_cvt_pk_bf16_f32 v173, v138, v139
  v_exp_f32_e64 v58, v58
  v_cvt_pk_bf16_f32 v174, v140, v141
  v_cvt_pk_bf16_f32 v175, v142, v143
  v_mfma_f32_32x32x16_bf16 v[96:111], v[212:215], v[188:191], v[96:111]
  s_waitcnt lgkmcnt(0)
  v_exp_f32 v59, v59
  v_cvt_pk_bf16_f32 v176, v144, v145
  v_exp_f32_e64 v60, v60
  v_cvt_pk_bf16_f32 v177, v146, v147
  v_cvt_pk_bf16_f32 v178, v148, v149
  v_exp_f32_e64 v61, v61
  v_cvt_pk_bf16_f32 v179, v150, v151
  v_exp_f32_e64 v62, v62
  v_cvt_pk_bf16_f32 v180, v152, v153
  v_cvt_pk_bf16_f32 v181, v154, v155
  v_exp_f32_e64 v63, v63
  v_cvt_pk_bf16_f32 v182, v156, v157
  v_cvt_pk_bf16_f32 v183, v158, v159
  v_pk_fma_f32 v[48:49], v[48:49], s[22:23], s[22:23]
  v_pk_fma_f32 v[50:51], v[50:51], s[22:23], s[22:23]
  v_pk_fma_f32 v[52:53], v[52:53], s[22:23], s[22:23]
  v_pk_fma_f32 v[54:55], v[54:55], s[22:23], s[22:23]
  v_pk_fma_f32 v[56:57], v[56:57], s[22:23], s[22:23]
  v_pk_fma_f32 v[58:59], v[58:59], s[22:23], s[22:23]
  v_pk_fma_f32 v[60:61], v[60:61], s[22:23], s[22:23]
  v_pk_fma_f32 v[62:63], v[62:63], s[22:23], s[22:23]
  s_sub_u32 s26, s26, 1
  s_cmp_lg_u32 s26, 0
  s_waitcnt vmcnt(4)
  s_cbranch_scc1 L_loop
  v_mfma_f32_32x32x16_bf16 v[16:31], v[216:219], v[160:163], 0
  ds_read_b128 v[192:195], v1 offset:2048
  ds_read_b128 v[196:199], v1 offset:3072
  ds_read_b128 v[200:203], v1 offset:4096
  v_rcp_f32 v48, v48
  v_rcp_f32 v49, v49
  v_mfma_f32_32x32x16_bf16 v[16:31], v[220:223], v[164:167], v[16:31]
  ds_read_b128 v[204:207], v1 offset:5120
  ds_read_b128 v[208:211], v1 offset:6144
  ds_read_b128 v[212:215], v1 offset:7168
  v_rcp_f32 v50, v50
  v_rcp_f32 v51, v51
  v_mfma_f32_32x32x16_bf16 v[16:31], v[224:227], v[168:171], v[16:31]
  ds_read_b128 v[136:139], v5
  ds_read_b128 v[140:143], v5 offset:32
  ds_read_b128 v[144:147], v5 offset:64
  v_rcp_f32 v52, v52
  v_rcp_f32 v53, v53
  v_mfma_f32_32x32x16_bf16 v[16:31], v[228:231], v[172:175], v[16:31]
  ds_read_b128 v[148:151], v5 offset:96
  ds_read_b128 v[152:155], v5 offset:128
  ds_read_b128 v[156:159], v5 offset:160
  v_rcp_f32 v54, v54
  v_rcp_f32 v55, v55
  v_mfma_f32_32x32x16_bf16 v[16:31], v[232:235], v[176:179], v[16:31]
  v_rcp_f32 v56, v56
  v_rcp_f32 v57, v57
  v_rcp_f32_e64 v58, v58
  v_mfma_f32_32x32x16_bf16 v[16:31], v[236:239], v[180:183], v[16:31]
  s_waitcnt lgkmcnt(0)
  v_rcp_f32 v59, v59
  v_rcp_f32 v60, v60
  v_rcp_f32 v61, v61
  v_rcp_f32 v62, v62
  v_rcp_f32 v63, v63
  v_pk_mul_f32 v[32:33], v[32:33], v[48:49]
  v_pk_mul_f32 v[34:35], v[34:35], v[50:51]
  v_pk_mul_f32 v[36:37], v[36:37], v[52:53]
  v_pk_mul_f32 v[38:39], v[38:39], v[54:55]
  v_pk_mul_f32 v[40:41], v[40:41], v[56:57]
  v_pk_mul_f32 v[42:43], v[42:43], v[58:59]
  v_pk_mul_f32 v[44:45], v[44:45], v[60:61]
  v_pk_mul_f32 v[46:47], v[46:47], v[62:63]
  v_pk_fma_f32 v[48:49], v[16:17], v[16:17], s[20:21] neg_lo:[1,0,1] neg_hi:[1,0,1]
  v_pk_fma_f32 v[50:51], v[18:19], v[18:19], s[20:21] neg_lo:[1,0,1] neg_hi:[1,0,1]
  v_pk_fma_f32 v[52:53], v[20:21], v[20:21], s[20:21] neg_lo:[1,0,1] neg_hi:[1,0,1]
  v_pk_fma_f32 v[54:55], v[22:23], v[22:23], s[20:21] neg_lo:[1,0,1] neg_hi:[1,0,1]
  v_pk_fma_f32 v[56:57], v[24:25], v[24:25], s[20:21] neg_lo:[1,0,1] neg_hi:[1,0,1]
  v_pk_fma_f32 v[58:59], v[26:27], v[26:27], s[20:21] neg_lo:[1,0,1] neg_hi:[1,0,1]
  v_pk_fma_f32 v[60:61], v[28:29], v[28:29], s[20:21] neg_lo:[1,0,1] neg_hi:[1,0,1]
  v_pk_fma_f32 v[62:63], v[30:31], v[30:31], s[20:21] neg_lo:[1,0,1] neg_hi:[1,0,1]
  v_pk_mul_f32 v[48:49], v[16:17], v[48:49]
  v_pk_mul_f32 v[50:51], v[18:19], v[50:51]
  v_pk_mul_f32 v[52:53], v[20:21], v[52:53]
  v_pk_mul_f32 v[54:55], v[22:23], v[54:55]
  v_pk_mul_f32 v[56:57], v[24:25], v[56:57]
  v_cvt_pk_bf16_f32 v184, v32, v33
  v_cvt_pk_bf16_f32 v185, v34, v35
  v_cvt_pk_bf16_f32 v186, v36, v37
  v_cvt_pk_bf16_f32 v187, v38, v39
  v_pk_mul_f32 v[58:59], v[26:27], v[58:59]
  v_pk_mul_f32 v[60:61], v[28:29], v[60:61]
  v_pk_mul_f32 v[62:63], v[30:31], v[62:63]
  v_mfma_f32_32x32x16_bf16 v[64:79], v[192:195], v[184:187], v[64:79]
  v_cvt_pk_bf16_f32 v188, v40, v41
  v_cvt_pk_bf16_f32 v189, v42, v43
  v_cvt_pk_bf16_f32 v190, v44, v45
  v_cvt_pk_bf16_f32 v191, v46, v47
  v_exp_f32_e64 v48, v48
  v_mfma_f32_32x32x16_bf16 v[80:95], v[196:199], v[184:187], v[80:95]
  v_exp_f32 v49, v49
  v_exp_f32 v50, v50
  v_exp_f32_e64 v51, v51
  v_mfma_f32_32x32x16_bf16 v[96:111], v[200:203], v[184:187], v[96:111]
  v_exp_f32 v52, v52
  v_exp_f32 v53, v53
  v_exp_f32_e64 v54, v54
  v_mfma_f32_32x32x16_bf16 v[64:79], v[204:207], v[188:191], v[64:79]
  v_exp_f32 v55, v55
  v_exp_f32 v56, v56
  v_exp_f32_e64 v57, v57
  v_mfma_f32_32x32x16_bf16 v[80:95], v[208:211], v[188:191], v[80:95]
  v_exp_f32 v58, v58
  v_exp_f32 v59, v59
  v_exp_f32_e64 v60, v60
  v_mfma_f32_32x32x16_bf16 v[96:111], v[212:215], v[188:191], v[96:111]
  v_exp_f32 v61, v61
  v_exp_f32 v62, v62
  v_exp_f32_e64 v63, v63
  v_pk_fma_f32 v[48:49], v[48:49], s[22:23], s[22:23]
  v_pk_fma_f32 v[50:51], v[50:51], s[22:23], s[22:23]
  v_pk_fma_f32 v[52:53], v[52:53], s[22:23], s[22:23]
  v_pk_fma_f32 v[54:55], v[54:55], s[22:23], s[22:23]
  v_pk_fma_f32 v[56:57], v[56:57], s[22:23], s[22:23]
  v_pk_fma_f32 v[58:59], v[58:59], s[22:23], s[22:23]
  v_pk_fma_f32 v[60:61], v[60:61], s[22:23], s[22:23]
  v_pk_fma_f32 v[62:63], v[62:63], s[22:23], s[22:23]
  v_mfma_f32_32x32x16_bf16 v[32:47], a[0:3], v[160:163], 0
  v_cvt_pk_bf16_f32 v112, v64, v65
  v_cvt_pk_bf16_f32 v113, v66, v67
  v_cvt_pk_bf16_f32 v114, v68, v69
  v_cvt_pk_bf16_f32 v115, v70, v71
  v_cvt_pk_bf16_f32 v116, v72, v73
  v_cvt_pk_bf16_f32 v117, v74, v75
  v_mfma_f32_32x32x16_bf16 v[32:47], a[4:7], v[164:167], v[32:47]
  v_cvt_pk_bf16_f32 v118, v76, v77
  v_cvt_pk_bf16_f32 v119, v78, v79
  v_cvt_pk_bf16_f32 v120, v80, v81
  v_cvt_pk_bf16_f32 v121, v82, v83
  v_cvt_pk_bf16_f32 v122, v84, v85
  v_cvt_pk_bf16_f32 v123, v86, v87
  v_mfma_f32_32x32x16_bf16 v[32:47], a[8:11], v[168:171], v[32:47]
  ds_read_b128 v[64:67], v2
  ds_read_b128 v[68:71], v2 offset:32
  ds_read_b128 v[72:75], v2 offset:64
  ds_read_b128 v[76:79], v2 offset:96
  v_cvt_pk_bf16_f32 v124, v88, v89
  v_cvt_pk_bf16_f32 v125, v90, v91
  v_mfma_f32_32x32x16_bf16 v[32:47], a[12:15], v[172:175], v[32:47]
  ds_read_b128 v[192:195], v1 offset:8192
  ds_read_b128 v[196:199], v1 offset:9216
  v_cvt_pk_bf16_f32 v126, v92, v93
  v_cvt_pk_bf16_f32 v127, v94, v95
  v_cvt_pk_bf16_f32 v128, v96, v97
  v_cvt_pk_bf16_f32 v129, v98, v99
  v_mfma_f32_32x32x16_bf16 v[32:47], a[16:19], v[176:179], v[32:47]
  ds_read_b128 v[80:83], v2 offset:128
  ds_read_b128 v[84:87], v2 offset:160
  ds_read_b128 v[88:91], v2 offset:192
  ds_read_b128 v[92:95], v2 offset:224
  v_cvt_pk_bf16_f32 v130, v100, v101
  v_cvt_pk_bf16_f32 v131, v102, v103
  v_mfma_f32_32x32x16_bf16 v[32:47], a[20:23], v[180:183], v[32:47]
  s_nop 0
  s_waitcnt lgkmcnt(6)
  ds_read_b128 v[200:203], v1 offset:10240
  ds_read_b128 v[204:207], v1 offset:11264
  v_cvt_pk_bf16_f32 v132, v104, v105
  v_cvt_pk_bf16_f32 v133, v106, v107
  v_cvt_pk_bf16_f32 v134, v108, v109
  v_cvt_pk_bf16_f32 v135, v110, v111
  v_mfma_f32_32x32x16_bf16 v[64:79], v[240:243], v[136:139], v[64:79]
  ds_read_b128 v[96:99], v2 offset:256
  ds_read_b128 v[100:103], v2 offset:288
  ds_read_b128 v[104:107], v2 offset:320
  ds_read_b128 v[108:111], v2 offset:352
  v_rcp_f32 v48, v48
  v_mfma_f32_32x32x16_bf16 v[64:79], v[244:247], v[140:143], v[64:79]
  s_waitcnt lgkmcnt(6)
  ds_read_b128 v[208:211], v1 offset:12288
  ds_read_b128 v[212:215], v1 offset:13312
  v_rcp_f32 v49, v49
  v_rcp_f32 v50, v50
  v_mfma_f32_32x32x16_bf16 v[80:95], v[240:243], v[144:147], v[80:95]
  v_rcp_f32 v51, v51
  v_rcp_f32 v52, v52
  v_rcp_f32_e64 v53, v53
  v_mfma_f32_32x32x16_bf16 v[80:95], v[244:247], v[148:151], v[80:95]
  s_waitcnt lgkmcnt(2)
  v_rcp_f32 v54, v54
  v_rcp_f32 v55, v55
  v_rcp_f32 v56, v56
  v_mfma_f32_32x32x16_bf16 v[96:111], v[240:243], v[152:155], v[96:111]
  v_rcp_f32 v57, v57
  v_rcp_f32 v58, v58
  v_rcp_f32_e64 v59, v59
  v_mfma_f32_32x32x16_bf16 v[96:111], v[244:247], v[156:159], v[96:111]
  s_waitcnt lgkmcnt(0)
  v_rcp_f32 v60, v60
  v_rcp_f32 v61, v61
  v_rcp_f32 v62, v62
  v_rcp_f32_e64 v63, v63
  v_pk_mul_f32 v[16:17], v[16:17], v[48:49]
  v_pk_mul_f32 v[18:19], v[18:19], v[50:51]
  v_pk_mul_f32 v[20:21], v[20:21], v[52:53]
  v_pk_mul_f32 v[22:23], v[22:23], v[54:55]
  v_pk_mul_f32 v[24:25], v[24:25], v[56:57]
  v_pk_mul_f32 v[26:27], v[26:27], v[58:59]
  v_pk_mul_f32 v[28:29], v[28:29], v[60:61]
  v_pk_mul_f32 v[30:31], v[30:31], v[62:63]
  v_pk_fma_f32 v[48:49], v[32:33], v[32:33], s[20:21] neg_lo:[1,0,1] neg_hi:[1,0,1]
  v_pk_fma_f32 v[50:51], v[34:35], v[34:35], s[20:21] neg_lo:[1,0,1] neg_hi:[1,0,1]
  v_pk_fma_f32 v[52:53], v[36:37], v[36:37], s[20:21] neg_lo:[1,0,1] neg_hi:[1,0,1]
  v_pk_fma_f32 v[54:55], v[38:39], v[38:39], s[20:21] neg_lo:[1,0,1] neg_hi:[1,0,1]
  v_pk_fma_f32 v[56:57], v[40:41], v[40:41], s[20:21] neg_lo:[1,0,1] neg_hi:[1,0,1]
  v_pk_fma_f32 v[58:59], v[42:43], v[42:43], s[20:21] neg_lo:[1,0,1] neg_hi:[1,0,1]
  v_pk_fma_f32 v[60:61], v[44:45], v[44:45], s[20:21] neg_lo:[1,0,1] neg_hi:[1,0,1]
  v_pk_fma_f32 v[62:63], v[46:47], v[46:47], s[20:21] neg_lo:[1,0,1] neg_hi:[1,0,1]
  v_pk_mul_f32 v[48:49], v[32:33], v[48:49]
  v_pk_mul_f32 v[50:51], v[34:35], v[50:51]
  v_pk_mul_f32 v[52:53], v[36:37], v[52:53]
  v_pk_mul_f32 v[54:55], v[38:39], v[54:55]
  v_pk_mul_f32 v[56:57], v[40:41], v[56:57]
  v_cvt_pk_bf16_f32 v184, v16, v17
  v_cvt_pk_bf16_f32 v185, v18, v19
  v_cvt_pk_bf16_f32 v186, v20, v21
  v_cvt_pk_bf16_f32 v187, v22, v23
  v_pk_mul_f32 v[58:59], v[42:43], v[58:59]
  v_pk_mul_f32 v[60:61], v[44:45], v[60:61]
  v_pk_mul_f32 v[62:63], v[46:47], v[62:63]
  v_mfma_f32_32x32x16_bf16 v[64:79], v[192:195], v[184:187], v[64:79]
  v_cvt_pk_bf16_f32 v188, v24, v25
  v_cvt_pk_bf16_f32 v189, v26, v27
  v_cvt_pk_bf16_f32 v190, v28, v29
  v_cvt_pk_bf16_f32 v191, v30, v31
  v_exp_f32_e64 v48, v48
  v_mfma_f32_32x32x16_bf16 v[80:95], v[196:199], v[184:187], v[80:95]
  v_exp_f32 v49, v49
  v_exp_f32 v50, v50
  v_exp_f32_e64 v51, v51
  v_mfma_f32_32x32x16_bf16 v[96:111], v[200:203], v[184:187], v[96:111]
  v_exp_f32 v52, v52
  v_exp_f32 v53, v53
  v_exp_f32_e64 v54, v54
  v_mfma_f32_32x32x16_bf16 v[64:79], v[204:207], v[188:191], v[64:79]
  v_exp_f32 v55, v55
  v_exp_f32 v56, v56
  v_exp_f32_e64 v57, v57
  v_mfma_f32_32x32x16_bf16 v[80:95], v[208:211], v[188:191], v[80:95]
  v_exp_f32 v58, v58
  v_exp_f32 v59, v59
  v_exp_f32_e64 v60, v60
  v_mfma_f32_32x32x16_bf16 v[96:111], v[212:215], v[188:191], v[96:111]
  v_exp_f32 v61, v61
  v_exp_f32 v62, v62
  v_exp_f32_e64 v63, v63
  v_pk_fma_f32 v[48:49], v[48:49], s[22:23], s[22:23]
  v_pk_fma_f32 v[50:51], v[50:51], s[22:23], s[22:23]
  v_pk_fma_f32 v[52:53], v[52:53], s[22:23], s[22:23]
  v_pk_fma_f32 v[54:55], v[54:55], s[22:23], s[22:23]
  v_pk_fma_f32 v[56:57], v[56:57], s[22:23], s[22:23]
  v_pk_fma_f32 v[58:59], v[58:59], s[22:23], s[22:23]
  v_pk_fma_f32 v[60:61], v[60:61], s[22:23], s[22:23]
  v_pk_fma_f32 v[62:63], v[62:63], s[22:23], s[22:23]
  v_mfma_f32_32x32x16_bf16 v[16:31], a[24:27], v[160:163], 0
  ds_read_b128 v[192:195], v1 offset:14336
  ds_read_b128 v[196:199], v1 offset:15360
  v_rcp_f32 v48, v48
  v_rcp_f32 v49, v49
  v_mfma_f32_32x32x16_bf16 v[16:31], a[28:31], v[164:167], v[16:31]
  ds_read_b128 v[200:203], v1 offset:16384
  ds_read_b128 v[204:207], v1 offset:17408
  v_rcp_f32 v50, v50
  v_rcp_f32 v51, v51
  v_mfma_f32_32x32x16_bf16 v[16:31], a[32:35], v[168:171], v[16:31]
  ds_read_b128 v[208:211], v1 offset:18432
  ds_read_b128 v[212:215], v1 offset:19456
  v_rcp_f32 v52, v52
  v_rcp_f32 v53, v53
  v_mfma_f32_32x32x16_bf16 v[16:31], a[36:39], v[172:175], v[16:31]
  buffer_store_dwordx4 v[112:115], v10, s[8:11], s28 offen
  v_rcp_f32 v54, v54
  v_rcp_f32 v55, v55
  v_mfma_f32_32x32x16_bf16 v[16:31], a[40:43], v[176:179], v[16:31]
  v_rcp_f32 v56, v56
  v_rcp_f32 v57, v57
  v_rcp_f32_e64 v58, v58
  v_mfma_f32_32x32x16_bf16 v[16:31], a[44:47], v[180:183], v[16:31]
  s_waitcnt lgkmcnt(0)
  v_rcp_f32 v59, v59
  v_rcp_f32 v60, v60
  v_rcp_f32 v61, v61
  v_rcp_f32 v62, v62
  v_rcp_f32 v63, v63
  v_pk_mul_f32 v[32:33], v[32:33], v[48:49]
  v_pk_mul_f32 v[34:35], v[34:35], v[50:51]
  v_pk_mul_f32 v[36:37], v[36:37], v[52:53]
  v_pk_mul_f32 v[38:39], v[38:39], v[54:55]
  v_pk_mul_f32 v[40:41], v[40:41], v[56:57]
  v_pk_mul_f32 v[42:43], v[42:43], v[58:59]
  v_pk_mul_f32 v[44:45], v[44:45], v[60:61]
  v_pk_mul_f32 v[46:47], v[46:47], v[62:63]
  v_pk_fma_f32 v[48:49], v[16:17], v[16:17], s[20:21] neg_lo:[1,0,1] neg_hi:[1,0,1]
  v_pk_fma_f32 v[50:51], v[18:19], v[18:19], s[20:21] neg_lo:[1,0,1] neg_hi:[1,0,1]
  v_pk_fma_f32 v[52:53], v[20:21], v[20:21], s[20:21] neg_lo:[1,0,1] neg_hi:[1,0,1]
  v_pk_fma_f32 v[54:55], v[22:23], v[22:23], s[20:21] neg_lo:[1,0,1] neg_hi:[1,0,1]
  v_pk_fma_f32 v[56:57], v[24:25], v[24:25], s[20:21] neg_lo:[1,0,1] neg_hi:[1,0,1]
  v_pk_fma_f32 v[58:59], v[26:27], v[26:27], s[20:21] neg_lo:[1,0,1] neg_hi:[1,0,1]
  v_pk_fma_f32 v[60:61], v[28:29], v[28:29], s[20:21] neg_lo:[1,0,1] neg_hi:[1,0,1]
  v_pk_fma_f32 v[62:63], v[30:31], v[30:31], s[20:21] neg_lo:[1,0,1] neg_hi:[1,0,1]
  v_pk_mul_f32 v[48:49], v[16:17], v[48:49]
  v_pk_mul_f32 v[50:51], v[18:19], v[50:51]
  v_pk_mul_f32 v[52:53], v[20:21], v[52:53]
  v_pk_mul_f32 v[54:55], v[22:23], v[54:55]
  v_pk_mul_f32 v[56:57], v[24:25], v[56:57]
  v_cvt_pk_bf16_f32 v184, v32, v33
  v_cvt_pk_bf16_f32 v185, v34, v35
  v_cvt_pk_bf16_f32 v186, v36, v37
  v_cvt_pk_bf16_f32 v187, v38, v39
  v_pk_mul_f32 v[58:59], v[26:27], v[58:59]
  v_pk_mul_f32 v[60:61], v[28:29], v[60:61]
  v_pk_mul_f32 v[62:63], v[30:31], v[62:63]
  v_mfma_f32_32x32x16_bf16 v[64:79], v[192:195], v[184:187], v[64:79]
  v_cvt_pk_bf16_f32 v188, v40, v41
  v_cvt_pk_bf16_f32 v189, v42, v43
  v_cvt_pk_bf16_f32 v190, v44, v45
  v_cvt_pk_bf16_f32 v191, v46, v47
  v_exp_f32_e64 v48, v48
  v_mfma_f32_32x32x16_bf16 v[80:95], v[196:199], v[184:187], v[80:95]
  v_exp_f32 v49, v49
  v_exp_f32 v50, v50
  v_exp_f32_e64 v51, v51
  v_mfma_f32_32x32x16_bf16 v[96:111], v[200:203], v[184:187], v[96:111]
  v_exp_f32 v52, v52
  v_exp_f32 v53, v53
  v_exp_f32_e64 v54, v54
  v_mfma_f32_32x32x16_bf16 v[64:79], v[204:207], v[188:191], v[64:79]
  v_exp_f32 v55, v55
  v_exp_f32 v56, v56
  v_exp_f32_e64 v57, v57
  v_mfma_f32_32x32x16_bf16 v[80:95], v[208:211], v[188:191], v[80:95]
  v_exp_f32 v58, v58
  v_exp_f32 v59, v59
  v_exp_f32_e64 v60, v60
  v_mfma_f32_32x32x16_bf16 v[96:111], v[212:215], v[188:191], v[96:111]
  v_exp_f32 v61, v61
  v_exp_f32 v62, v62
  v_exp_f32_e64 v63, v63
  v_pk_fma_f32 v[48:49], v[48:49], s[22:23], s[22:23]
  v_pk_fma_f32 v[50:51], v[50:51], s[22:23], s[22:23]
  v_pk_fma_f32 v[52:53], v[52:53], s[22:23], s[22:23]
  v_pk_fma_f32 v[54:55], v[54:55], s[22:23], s[22:23]
  v_pk_fma_f32 v[56:57], v[56:57], s[22:23], s[22:23]
  v_pk_fma_f32 v[58:59], v[58:59], s[22:23], s[22:23]
  v_pk_fma_f32 v[60:61], v[60:61], s[22:23], s[22:23]
  v_pk_fma_f32 v[62:63], v[62:63], s[22:23], s[22:23]
  v_mfma_f32_32x32x16_bf16 v[32:47], a[48:51], v[160:163], 0
  ds_read_b128 v[192:195], v1 offset:20480
  ds_read_b128 v[196:199], v1 offset:21504
  v_rcp_f32 v48, v48
  v_rcp_f32 v49, v49
  v_mfma_f32_32x32x16_bf16 v[32:47], a[52:55], v[164:167], v[32:47]
  ds_read_b128 v[200:203], v1 offset:22528
  ds_read_b128 v[204:207], v1 offset:23552
  v_rcp_f32 v50, v50
  v_rcp_f32 v51, v51
  v_mfma_f32_32x32x16_bf16 v[32:47], a[56:59], v[168:171], v[32:47]
  ds_read_b128 v[208:211], v1 offset:24576
  ds_read_b128 v[212:215], v1 offset:25600
  v_rcp_f32 v52, v52
  v_rcp_f32 v53, v53
  v_mfma_f32_32x32x16_bf16 v[32:47], a[60:63], v[172:175], v[32:47]
  buffer_store_dwordx4 v[116:119], v10, s[8:11], s28 offen offset:32
  v_rcp_f32 v54, v54
  v_rcp_f32 v55, v55
  v_mfma_f32_32x32x16_bf16 v[32:47], a[64:67], v[176:179], v[32:47]
  v_rcp_f32 v56, v56
  v_rcp_f32 v57, v57
  v_rcp_f32_e64 v58, v58
  v_mfma_f32_32x32x16_bf16 v[32:47], a[68:71], v[180:183], v[32:47]
  s_waitcnt lgkmcnt(0)
  v_rcp_f32 v59, v59
  v_rcp_f32 v60, v60
  v_rcp_f32 v61, v61
  v_rcp_f32 v62, v62
  v_rcp_f32 v63, v63
  v_pk_mul_f32 v[16:17], v[16:17], v[48:49]
  v_pk_mul_f32 v[18:19], v[18:19], v[50:51]
  v_pk_mul_f32 v[20:21], v[20:21], v[52:53]
  v_pk_mul_f32 v[22:23], v[22:23], v[54:55]
  v_pk_mul_f32 v[24:25], v[24:25], v[56:57]
  v_pk_mul_f32 v[26:27], v[26:27], v[58:59]
  v_pk_mul_f32 v[28:29], v[28:29], v[60:61]
  v_pk_mul_f32 v[30:31], v[30:31], v[62:63]
  v_pk_fma_f32 v[48:49], v[32:33], v[32:33], s[20:21] neg_lo:[1,0,1] neg_hi:[1,0,1]
  v_pk_fma_f32 v[50:51], v[34:35], v[34:35], s[20:21] neg_lo:[1,0,1] neg_hi:[1,0,1]
  v_pk_fma_f32 v[52:53], v[36:37], v[36:37], s[20:21] neg_lo:[1,0,1] neg_hi:[1,0,1]
  v_pk_fma_f32 v[54:55], v[38:39], v[38:39], s[20:21] neg_lo:[1,0,1] neg_hi:[1,0,1]
  v_pk_fma_f32 v[56:57], v[40:41], v[40:41], s[20:21] neg_lo:[1,0,1] neg_hi:[1,0,1]
  v_pk_fma_f32 v[58:59], v[42:43], v[42:43], s[20:21] neg_lo:[1,0,1] neg_hi:[1,0,1]
  v_pk_fma_f32 v[60:61], v[44:45], v[44:45], s[20:21] neg_lo:[1,0,1] neg_hi:[1,0,1]
  v_pk_fma_f32 v[62:63], v[46:47], v[46:47], s[20:21] neg_lo:[1,0,1] neg_hi:[1,0,1]
  v_pk_mul_f32 v[48:49], v[32:33], v[48:49]
  v_pk_mul_f32 v[50:51], v[34:35], v[50:51]
  v_pk_mul_f32 v[52:53], v[36:37], v[52:53]
  v_pk_mul_f32 v[54:55], v[38:39], v[54:55]
  v_pk_mul_f32 v[56:57], v[40:41], v[56:57]
  v_cvt_pk_bf16_f32 v184, v16, v17
  v_cvt_pk_bf16_f32 v185, v18, v19
  v_cvt_pk_bf16_f32 v186, v20, v21
  v_cvt_pk_bf16_f32 v187, v22, v23
  v_pk_mul_f32 v[58:59], v[42:43], v[58:59]
  v_pk_mul_f32 v[60:61], v[44:45], v[60:61]
  v_pk_mul_f32 v[62:63], v[46:47], v[62:63]
  v_mfma_f32_32x32x16_bf16 v[64:79], v[192:195], v[184:187], v[64:79]
  v_cvt_pk_bf16_f32 v188, v24, v25
  v_cvt_pk_bf16_f32 v189, v26, v27
  v_cvt_pk_bf16_f32 v190, v28, v29
  v_cvt_pk_bf16_f32 v191, v30, v31
  v_exp_f32_e64 v48, v48
  v_mfma_f32_32x32x16_bf16 v[80:95], v[196:199], v[184:187], v[80:95]
  v_exp_f32 v49, v49
  v_exp_f32 v50, v50
  v_exp_f32_e64 v51, v51
  v_mfma_f32_32x32x16_bf16 v[96:111], v[200:203], v[184:187], v[96:111]
  v_exp_f32 v52, v52
  v_exp_f32 v53, v53
  v_exp_f32_e64 v54, v54
  v_mfma_f32_32x32x16_bf16 v[64:79], v[204:207], v[188:191], v[64:79]
  v_exp_f32 v55, v55
  v_exp_f32 v56, v56
  v_exp_f32_e64 v57, v57
  v_mfma_f32_32x32x16_bf16 v[80:95], v[208:211], v[188:191], v[80:95]
  v_exp_f32 v58, v58
  v_exp_f32 v59, v59
  v_exp_f32_e64 v60, v60
  v_mfma_f32_32x32x16_bf16 v[96:111], v[212:215], v[188:191], v[96:111]
  v_exp_f32 v61, v61
  v_exp_f32 v62, v62
  v_exp_f32_e64 v63, v63
  v_pk_fma_f32 v[48:49], v[48:49], s[22:23], s[22:23]
  v_pk_fma_f32 v[50:51], v[50:51], s[22:23], s[22:23]
  v_pk_fma_f32 v[52:53], v[52:53], s[22:23], s[22:23]
  v_pk_fma_f32 v[54:55], v[54:55], s[22:23], s[22:23]
  v_pk_fma_f32 v[56:57], v[56:57], s[22:23], s[22:23]
  v_pk_fma_f32 v[58:59], v[58:59], s[22:23], s[22:23]
  v_pk_fma_f32 v[60:61], v[60:61], s[22:23], s[22:23]
  v_pk_fma_f32 v[62:63], v[62:63], s[22:23], s[22:23]
  v_mfma_f32_32x32x16_bf16 v[16:31], a[72:75], v[160:163], 0
  ds_read_b128 v[192:195], v1 offset:26624
  ds_read_b128 v[196:199], v1 offset:27648
  v_rcp_f32 v48, v48
  v_rcp_f32 v49, v49
  v_mfma_f32_32x32x16_bf16 v[16:31], a[76:79], v[164:167], v[16:31]
  ds_read_b128 v[200:203], v1 offset:28672
  ds_read_b128 v[204:207], v1 offset:29696
  v_rcp_f32 v50, v50
  v_rcp_f32 v51, v51
  v_mfma_f32_32x32x16_bf16 v[16:31], a[80:83], v[168:171], v[16:31]
  ds_read_b128 v[208:211], v1 offset:30720
  ds_read_b128 v[212:215], v1 offset:31744
  v_rcp_f32 v52, v52
  v_rcp_f32 v53, v53
  v_mfma_f32_32x32x16_bf16 v[16:31], a[84:87], v[172:175], v[16:31]
  v_rcp_f32 v54, v54
  v_rcp_f32 v55, v55
  v_rcp_f32_e64 v56, v56
  v_mfma_f32_32x32x16_bf16 v[16:31], a[88:91], v[176:179], v[16:31]
  v_rcp_f32 v57, v57
  v_rcp_f32 v58, v58
  v_rcp_f32_e64 v59, v59
  v_mfma_f32_32x32x16_bf16 v[16:31], a[92:95], v[180:183], v[16:31]
  s_waitcnt lgkmcnt(0)
  v_rcp_f32 v60, v60
  v_rcp_f32 v61, v61
  v_rcp_f32 v62, v62
  v_rcp_f32_e64 v63, v63
  v_pk_mul_f32 v[32:33], v[32:33], v[48:49]
  v_pk_mul_f32 v[34:35], v[34:35], v[50:51]
  v_pk_mul_f32 v[36:37], v[36:37], v[52:53]
  v_pk_mul_f32 v[38:39], v[38:39], v[54:55]
  v_pk_mul_f32 v[40:41], v[40:41], v[56:57]
  v_pk_mul_f32 v[42:43], v[42:43], v[58:59]
  v_pk_mul_f32 v[44:45], v[44:45], v[60:61]
  v_pk_mul_f32 v[46:47], v[46:47], v[62:63]
  v_pk_fma_f32 v[48:49], v[16:17], v[16:17], s[20:21] neg_lo:[1,0,1] neg_hi:[1,0,1]
  v_pk_fma_f32 v[50:51], v[18:19], v[18:19], s[20:21] neg_lo:[1,0,1] neg_hi:[1,0,1]
  v_pk_fma_f32 v[52:53], v[20:21], v[20:21], s[20:21] neg_lo:[1,0,1] neg_hi:[1,0,1]
  v_pk_fma_f32 v[54:55], v[22:23], v[22:23], s[20:21] neg_lo:[1,0,1] neg_hi:[1,0,1]
  v_pk_fma_f32 v[56:57], v[24:25], v[24:25], s[20:21] neg_lo:[1,0,1] neg_hi:[1,0,1]
  v_pk_fma_f32 v[58:59], v[26:27], v[26:27], s[20:21] neg_lo:[1,0,1] neg_hi:[1,0,1]
  v_pk_fma_f32 v[60:61], v[28:29], v[28:29], s[20:21] neg_lo:[1,0,1] neg_hi:[1,0,1]
  v_pk_fma_f32 v[62:63], v[30:31], v[30:31], s[20:21] neg_lo:[1,0,1] neg_hi:[1,0,1]
  v_pk_mul_f32 v[48:49], v[16:17], v[48:49]
  v_pk_mul_f32 v[50:51], v[18:19], v[50:51]
  v_pk_mul_f32 v[52:53], v[20:21], v[52:53]
  v_pk_mul_f32 v[54:55], v[22:23], v[54:55]
  v_pk_mul_f32 v[56:57], v[24:25], v[56:57]
  v_cvt_pk_bf16_f32 v184, v32, v33
  v_cvt_pk_bf16_f32 v185, v34, v35
  v_cvt_pk_bf16_f32 v186, v36, v37
  v_cvt_pk_bf16_f32 v187, v38, v39
  v_pk_mul_f32 v[58:59], v[26:27], v[58:59]
  v_pk_mul_f32 v[60:61], v[28:29], v[60:61]
  v_pk_mul_f32 v[62:63], v[30:31], v[62:63]
  v_mfma_f32_32x32x16_bf16 v[64:79], v[192:195], v[184:187], v[64:79]
  v_cvt_pk_bf16_f32 v188, v40, v41
  v_cvt_pk_bf16_f32 v189, v42, v43
  v_cvt_pk_bf16_f32 v190, v44, v45
  v_cvt_pk_bf16_f32 v191, v46, v47
  v_exp_f32_e64 v48, v48
  v_mfma_f32_32x32x16_bf16 v[80:95], v[196:199], v[184:187], v[80:95]
  v_exp_f32 v49, v49
  v_exp_f32 v50, v50
  v_exp_f32_e64 v51, v51
  v_mfma_f32_32x32x16_bf16 v[96:111], v[200:203], v[184:187], v[96:111]
  v_exp_f32 v52, v52
  v_exp_f32 v53, v53
  v_exp_f32_e64 v54, v54
  v_mfma_f32_32x32x16_bf16 v[64:79], v[204:207], v[188:191], v[64:79]
  v_exp_f32 v55, v55
  v_exp_f32 v56, v56
  v_exp_f32_e64 v57, v57
  v_mfma_f32_32x32x16_bf16 v[80:95], v[208:211], v[188:191], v[80:95]
  v_exp_f32 v58, v58
  v_exp_f32 v59, v59
  v_exp_f32_e64 v60, v60
  v_mfma_f32_32x32x16_bf16 v[96:111], v[212:215], v[188:191], v[96:111]
  v_exp_f32 v61, v61
  v_exp_f32 v62, v62
  v_exp_f32_e64 v63, v63
  v_pk_fma_f32 v[48:49], v[48:49], s[22:23], s[22:23]
  v_pk_fma_f32 v[50:51], v[50:51], s[22:23], s[22:23]
  v_pk_fma_f32 v[52:53], v[52:53], s[22:23], s[22:23]
  v_pk_fma_f32 v[54:55], v[54:55], s[22:23], s[22:23]
  v_pk_fma_f32 v[56:57], v[56:57], s[22:23], s[22:23]
  v_pk_fma_f32 v[58:59], v[58:59], s[22:23], s[22:23]
  v_pk_fma_f32 v[60:61], v[60:61], s[22:23], s[22:23]
  v_pk_fma_f32 v[62:63], v[62:63], s[22:23], s[22:23]
  v_mfma_f32_32x32x16_bf16 v[32:47], a[96:99], v[160:163], 0
  ds_read_b128 v[192:195], v0 offset:24576
  ds_read_b128 v[196:199], v0 offset:25600
  v_rcp_f32 v48, v48
  v_rcp_f32 v49, v49
  v_mfma_f32_32x32x16_bf16 v[32:47], a[100:103], v[164:167], v[32:47]
  ds_read_b128 v[200:203], v0 offset:26624
  ds_read_b128 v[204:207], v0 offset:27648
  v_rcp_f32 v50, v50
  v_rcp_f32 v51, v51
  v_mfma_f32_32x32x16_bf16 v[32:47], a[104:107], v[168:171], v[32:47]
  ds_read_b128 v[208:211], v0 offset:28672
  ds_read_b128 v[212:215], v0 offset:29696
  v_rcp_f32 v52, v52
  v_rcp_f32 v53, v53
  v_mfma_f32_32x32x16_bf16 v[32:47], a[108:111], v[172:175], v[32:47]
  buffer_store_dwordx4 v[120:123], v10, s[8:11], s28 offen offset:64
  v_rcp_f32 v54, v54
  v_rcp_f32 v55, v55
  v_mfma_f32_32x32x16_bf16 v[32:47], a[112:115], v[176:179], v[32:47]
  v_rcp_f32 v56, v56
  v_rcp_f32 v57, v57
  v_rcp_f32_e64 v58, v58
  v_mfma_f32_32x32x16_bf16 v[32:47], a[116:119], v[180:183], v[32:47]
  s_waitcnt lgkmcnt(0)
  v_rcp_f32 v59, v59
  v_rcp_f32 v60, v60
  v_rcp_f32 v61, v61
  v_rcp_f32 v62, v62
  v_rcp_f32 v63, v63
  v_pk_mul_f32 v[16:17], v[16:17], v[48:49]
  v_pk_mul_f32 v[18:19], v[18:19], v[50:51]
  v_pk_mul_f32 v[20:21], v[20:21], v[52:53]
  v_pk_mul_f32 v[22:23], v[22:23], v[54:55]
  v_pk_mul_f32 v[24:25], v[24:25], v[56:57]
  v_pk_mul_f32 v[26:27], v[26:27], v[58:59]
  v_pk_mul_f32 v[28:29], v[28:29], v[60:61]
  v_pk_mul_f32 v[30:31], v[30:31], v[62:63]
  v_pk_fma_f32 v[48:49], v[32:33], v[32:33], s[20:21] neg_lo:[1,0,1] neg_hi:[1,0,1]
  v_pk_fma_f32 v[50:51], v[34:35], v[34:35], s[20:21] neg_lo:[1,0,1] neg_hi:[1,0,1]
  v_pk_fma_f32 v[52:53], v[36:37], v[36:37], s[20:21] neg_lo:[1,0,1] neg_hi:[1,0,1]
  v_pk_fma_f32 v[54:55], v[38:39], v[38:39], s[20:21] neg_lo:[1,0,1] neg_hi:[1,0,1]
  v_pk_fma_f32 v[56:57], v[40:41], v[40:41], s[20:21] neg_lo:[1,0,1] neg_hi:[1,0,1]
  v_pk_fma_f32 v[58:59], v[42:43], v[42:43], s[20:21] neg_lo:[1,0,1] neg_hi:[1,0,1]
  v_pk_fma_f32 v[60:61], v[44:45], v[44:45], s[20:21] neg_lo:[1,0,1] neg_hi:[1,0,1]
  v_pk_fma_f32 v[62:63], v[46:47], v[46:47], s[20:21] neg_lo:[1,0,1] neg_hi:[1,0,1]
  v_pk_mul_f32 v[48:49], v[32:33], v[48:49]
  v_pk_mul_f32 v[50:51], v[34:35], v[50:51]
  v_pk_mul_f32 v[52:53], v[36:37], v[52:53]
  v_pk_mul_f32 v[54:55], v[38:39], v[54:55]
  v_pk_mul_f32 v[56:57], v[40:41], v[56:57]
  v_cvt_pk_bf16_f32 v184, v16, v17
  v_cvt_pk_bf16_f32 v185, v18, v19
  v_cvt_pk_bf16_f32 v186, v20, v21
  v_cvt_pk_bf16_f32 v187, v22, v23
  v_pk_mul_f32 v[58:59], v[42:43], v[58:59]
  v_pk_mul_f32 v[60:61], v[44:45], v[60:61]
  v_pk_mul_f32 v[62:63], v[46:47], v[62:63]
  v_mfma_f32_32x32x16_bf16 v[64:79], v[192:195], v[184:187], v[64:79]
  v_cvt_pk_bf16_f32 v188, v24, v25
  v_cvt_pk_bf16_f32 v189, v26, v27
  v_cvt_pk_bf16_f32 v190, v28, v29
  v_cvt_pk_bf16_f32 v191, v30, v31
  v_exp_f32_e64 v48, v48
  v_mfma_f32_32x32x16_bf16 v[80:95], v[196:199], v[184:187], v[80:95]
  v_exp_f32 v49, v49
  v_exp_f32 v50, v50
  v_exp_f32_e64 v51, v51
  v_mfma_f32_32x32x16_bf16 v[96:111], v[200:203], v[184:187], v[96:111]
  v_exp_f32 v52, v52
  v_exp_f32 v53, v53
  v_exp_f32_e64 v54, v54
  v_mfma_f32_32x32x16_bf16 v[64:79], v[204:207], v[188:191], v[64:79]
  v_exp_f32 v55, v55
  v_exp_f32 v56, v56
  v_exp_f32_e64 v57, v57
  v_mfma_f32_32x32x16_bf16 v[80:95], v[208:211], v[188:191], v[80:95]
  v_exp_f32 v58, v58
  v_exp_f32 v59, v59
  v_exp_f32_e64 v60, v60
  v_mfma_f32_32x32x16_bf16 v[96:111], v[212:215], v[188:191], v[96:111]
  v_exp_f32 v61, v61
  v_exp_f32 v62, v62
  v_exp_f32_e64 v63, v63
  v_pk_fma_f32 v[48:49], v[48:49], s[22:23], s[22:23]
  v_pk_fma_f32 v[50:51], v[50:51], s[22:23], s[22:23]
  v_pk_fma_f32 v[52:53], v[52:53], s[22:23], s[22:23]
  v_pk_fma_f32 v[54:55], v[54:55], s[22:23], s[22:23]
  v_pk_fma_f32 v[56:57], v[56:57], s[22:23], s[22:23]
  v_pk_fma_f32 v[58:59], v[58:59], s[22:23], s[22:23]
  v_pk_fma_f32 v[60:61], v[60:61], s[22:23], s[22:23]
  v_pk_fma_f32 v[62:63], v[62:63], s[22:23], s[22:23]
  v_mfma_f32_32x32x16_bf16 v[16:31], a[120:123], v[160:163], 0
  ds_read_b128 v[192:195], v0 offset:30720
  ds_read_b128 v[196:199], v0 offset:31744
  v_rcp_f32 v48, v48
  v_rcp_f32 v49, v49
  v_mfma_f32_32x32x16_bf16 v[16:31], a[124:127], v[164:167], v[16:31]
  ds_read_b128 v[200:203], v0 offset:32768
  ds_read_b128 v[204:207], v0 offset:33792
  v_rcp_f32 v50, v50
  v_rcp_f32 v51, v51
  v_mfma_f32_32x32x16_bf16 v[16:31], a[128:131], v[168:171], v[16:31]
  ds_read_b128 v[208:211], v0 offset:34816
  ds_read_b128 v[212:215], v0 offset:35840
  v_rcp_f32 v52, v52
  v_rcp_f32 v53, v53
  v_mfma_f32_32x32x16_bf16 v[16:31], a[132:135], v[172:175], v[16:31]
  buffer_store_dwordx4 v[124:127], v10, s[8:11], s28 offen offset:96
  v_rcp_f32 v54, v54
  v_rcp_f32 v55, v55
  v_mfma_f32_32x32x16_bf16 v[16:31], a[136:139], v[176:179], v[16:31]
  v_rcp_f32 v56, v56
  v_rcp_f32 v57, v57
  v_rcp_f32_e64 v58, v58
  v_mfma_f32_32x32x16_bf16 v[16:31], a[140:143], v[180:183], v[16:31]
  s_waitcnt lgkmcnt(0)
  v_rcp_f32 v59, v59
  v_rcp_f32 v60, v60
  v_rcp_f32 v61, v61
  v_rcp_f32 v62, v62
  v_rcp_f32 v63, v63
  v_pk_mul_f32 v[32:33], v[32:33], v[48:49]
  v_pk_mul_f32 v[34:35], v[34:35], v[50:51]
  v_pk_mul_f32 v[36:37], v[36:37], v[52:53]
  v_pk_mul_f32 v[38:39], v[38:39], v[54:55]
  v_pk_mul_f32 v[40:41], v[40:41], v[56:57]
  v_pk_mul_f32 v[42:43], v[42:43], v[58:59]
  v_pk_mul_f32 v[44:45], v[44:45], v[60:61]
  v_pk_mul_f32 v[46:47], v[46:47], v[62:63]
  v_pk_fma_f32 v[48:49], v[16:17], v[16:17], s[20:21] neg_lo:[1,0,1] neg_hi:[1,0,1]
  v_pk_fma_f32 v[50:51], v[18:19], v[18:19], s[20:21] neg_lo:[1,0,1] neg_hi:[1,0,1]
  v_pk_fma_f32 v[52:53], v[20:21], v[20:21], s[20:21] neg_lo:[1,0,1] neg_hi:[1,0,1]
  v_pk_fma_f32 v[54:55], v[22:23], v[22:23], s[20:21] neg_lo:[1,0,1] neg_hi:[1,0,1]
  v_pk_fma_f32 v[56:57], v[24:25], v[24:25], s[20:21] neg_lo:[1,0,1] neg_hi:[1,0,1]
  v_pk_fma_f32 v[58:59], v[26:27], v[26:27], s[20:21] neg_lo:[1,0,1] neg_hi:[1,0,1]
  v_pk_fma_f32 v[60:61], v[28:29], v[28:29], s[20:21] neg_lo:[1,0,1] neg_hi:[1,0,1]
  v_pk_fma_f32 v[62:63], v[30:31], v[30:31], s[20:21] neg_lo:[1,0,1] neg_hi:[1,0,1]
  v_pk_mul_f32 v[48:49], v[16:17], v[48:49]
  v_pk_mul_f32 v[50:51], v[18:19], v[50:51]
  v_pk_mul_f32 v[52:53], v[20:21], v[52:53]
  v_pk_mul_f32 v[54:55], v[22:23], v[54:55]
  v_pk_mul_f32 v[56:57], v[24:25], v[56:57]
  v_cvt_pk_bf16_f32 v184, v32, v33
  v_cvt_pk_bf16_f32 v185, v34, v35
  v_cvt_pk_bf16_f32 v186, v36, v37
  v_cvt_pk_bf16_f32 v187, v38, v39
  v_pk_mul_f32 v[58:59], v[26:27], v[58:59]
  v_pk_mul_f32 v[60:61], v[28:29], v[60:61]
  v_pk_mul_f32 v[62:63], v[30:31], v[62:63]
  v_mfma_f32_32x32x16_bf16 v[64:79], v[192:195], v[184:187], v[64:79]
  v_cvt_pk_bf16_f32 v188, v40, v41
  v_cvt_pk_bf16_f32 v189, v42, v43
  v_cvt_pk_bf16_f32 v190, v44, v45
  v_cvt_pk_bf16_f32 v191, v46, v47
  v_exp_f32_e64 v48, v48
  v_mfma_f32_32x32x16_bf16 v[80:95], v[196:199], v[184:187], v[80:95]
  v_exp_f32 v49, v49
  v_exp_f32 v50, v50
  v_exp_f32_e64 v51, v51
  v_mfma_f32_32x32x16_bf16 v[96:111], v[200:203], v[184:187], v[96:111]
  v_exp_f32 v52, v52
  v_exp_f32 v53, v53
  v_exp_f32_e64 v54, v54
  v_mfma_f32_32x32x16_bf16 v[64:79], v[204:207], v[188:191], v[64:79]
  v_exp_f32 v55, v55
  v_exp_f32 v56, v56
  v_exp_f32_e64 v57, v57
  v_mfma_f32_32x32x16_bf16 v[80:95], v[208:211], v[188:191], v[80:95]
  v_exp_f32 v58, v58
  v_exp_f32 v59, v59
  v_exp_f32_e64 v60, v60
  v_mfma_f32_32x32x16_bf16 v[96:111], v[212:215], v[188:191], v[96:111]
  v_exp_f32 v61, v61
  v_exp_f32 v62, v62
  v_exp_f32_e64 v63, v63
  v_pk_fma_f32 v[48:49], v[48:49], s[22:23], s[22:23]
  v_pk_fma_f32 v[50:51], v[50:51], s[22:23], s[22:23]
  v_pk_fma_f32 v[52:53], v[52:53], s[22:23], s[22:23]
  v_pk_fma_f32 v[54:55], v[54:55], s[22:23], s[22:23]
  v_pk_fma_f32 v[56:57], v[56:57], s[22:23], s[22:23]
  v_pk_fma_f32 v[58:59], v[58:59], s[22:23], s[22:23]
  v_pk_fma_f32 v[60:61], v[60:61], s[22:23], s[22:23]
  v_pk_fma_f32 v[62:63], v[62:63], s[22:23], s[22:23]
  v_mfma_f32_32x32x16_bf16 v[32:47], a[144:147], v[160:163], 0
  ds_read_b128 v[192:195], v0 offset:36864
  ds_read_b128 v[196:199], v0 offset:37888
  v_rcp_f32 v48, v48
  v_rcp_f32 v49, v49
  v_mfma_f32_32x32x16_bf16 v[32:47], a[148:151], v[164:167], v[32:47]
  ds_read_b128 v[200:203], v0 offset:38912
  ds_read_b128 v[204:207], v0 offset:39936
  v_rcp_f32 v50, v50
  v_rcp_f32 v51, v51
  v_mfma_f32_32x32x16_bf16 v[32:47], a[152:155], v[168:171], v[32:47]
  ds_read_b128 v[208:211], v0 offset:40960
  ds_read_b128 v[212:215], v0 offset:41984
  v_rcp_f32 v52, v52
  v_rcp_f32 v53, v53
  v_mfma_f32_32x32x16_bf16 v[32:47], a[156:159], v[172:175], v[32:47]
  v_rcp_f32 v54, v54
  v_rcp_f32 v55, v55
  v_rcp_f32_e64 v56, v56
  v_mfma_f32_32x32x16_bf16 v[32:47], a[160:163], v[176:179], v[32:47]
  v_rcp_f32 v57, v57
  v_rcp_f32 v58, v58
  v_rcp_f32_e64 v59, v59
  v_mfma_f32_32x32x16_bf16 v[32:47], a[164:167], v[180:183], v[32:47]
  s_waitcnt lgkmcnt(0)
  v_rcp_f32 v60, v60
  v_rcp_f32 v61, v61
  v_rcp_f32 v62, v62
  v_rcp_f32_e64 v63, v63
  v_pk_mul_f32 v[16:17], v[16:17], v[48:49]
  v_pk_mul_f32 v[18:19], v[18:19], v[50:51]
  v_pk_mul_f32 v[20:21], v[20:21], v[52:53]
  v_pk_mul_f32 v[22:23], v[22:23], v[54:55]
  v_pk_mul_f32 v[24:25], v[24:25], v[56:57]
  v_pk_mul_f32 v[26:27], v[26:27], v[58:59]
  v_pk_mul_f32 v[28:29], v[28:29], v[60:61]
  v_pk_mul_f32 v[30:31], v[30:31], v[62:63]
  v_pk_fma_f32 v[48:49], v[32:33], v[32:33], s[20:21] neg_lo:[1,0,1] neg_hi:[1,0,1]
  v_pk_fma_f32 v[50:51], v[34:35], v[34:35], s[20:21] neg_lo:[1,0,1] neg_hi:[1,0,1]
  v_pk_fma_f32 v[52:53], v[36:37], v[36:37], s[20:21] neg_lo:[1,0,1] neg_hi:[1,0,1]
  v_pk_fma_f32 v[54:55], v[38:39], v[38:39], s[20:21] neg_lo:[1,0,1] neg_hi:[1,0,1]
  v_pk_fma_f32 v[56:57], v[40:41], v[40:41], s[20:21] neg_lo:[1,0,1] neg_hi:[1,0,1]
  v_pk_fma_f32 v[58:59], v[42:43], v[42:43], s[20:21] neg_lo:[1,0,1] neg_hi:[1,0,1]
  v_pk_fma_f32 v[60:61], v[44:45], v[44:45], s[20:21] neg_lo:[1,0,1] neg_hi:[1,0,1]
  v_pk_fma_f32 v[62:63], v[46:47], v[46:47], s[20:21] neg_lo:[1,0,1] neg_hi:[1,0,1]
  v_pk_mul_f32 v[48:49], v[32:33], v[48:49]
  v_pk_mul_f32 v[50:51], v[34:35], v[50:51]
  v_pk_mul_f32 v[52:53], v[36:37], v[52:53]
  v_pk_mul_f32 v[54:55], v[38:39], v[54:55]
  v_pk_mul_f32 v[56:57], v[40:41], v[56:57]
  v_cvt_pk_bf16_f32 v184, v16, v17
  v_cvt_pk_bf16_f32 v185, v18, v19
  v_cvt_pk_bf16_f32 v186, v20, v21
  v_cvt_pk_bf16_f32 v187, v22, v23
  v_pk_mul_f32 v[58:59], v[42:43], v[58:59]
  v_pk_mul_f32 v[60:61], v[44:45], v[60:61]
  v_pk_mul_f32 v[62:63], v[46:47], v[62:63]
  v_mfma_f32_32x32x16_bf16 v[64:79], v[192:195], v[184:187], v[64:79]
  v_cvt_pk_bf16_f32 v188, v24, v25
  v_cvt_pk_bf16_f32 v189, v26, v27
  v_cvt_pk_bf16_f32 v190, v28, v29
  v_cvt_pk_bf16_f32 v191, v30, v31
  v_exp_f32_e64 v48, v48
  v_mfma_f32_32x32x16_bf16 v[80:95], v[196:199], v[184:187], v[80:95]
  v_exp_f32 v49, v49
  v_exp_f32 v50, v50
  v_exp_f32_e64 v51, v51
  v_mfma_f32_32x32x16_bf16 v[96:111], v[200:203], v[184:187], v[96:111]
  v_exp_f32 v52, v52
  v_exp_f32 v53, v53
  v_exp_f32_e64 v54, v54
  v_mfma_f32_32x32x16_bf16 v[64:79], v[204:207], v[188:191], v[64:79]
  v_exp_f32 v55, v55
  v_exp_f32 v56, v56
  v_exp_f32_e64 v57, v57
  v_mfma_f32_32x32x16_bf16 v[80:95], v[208:211], v[188:191], v[80:95]
  v_exp_f32 v58, v58
  v_exp_f32 v59, v59
  v_exp_f32_e64 v60, v60
  v_mfma_f32_32x32x16_bf16 v[96:111], v[212:215], v[188:191], v[96:111]
  v_exp_f32 v61, v61
  v_exp_f32 v62, v62
  v_exp_f32_e64 v63, v63
  v_pk_fma_f32 v[48:49], v[48:49], s[22:23], s[22:23]
  v_pk_fma_f32 v[50:51], v[50:51], s[22:23], s[22:23]
  v_pk_fma_f32 v[52:53], v[52:53], s[22:23], s[22:23]
  v_pk_fma_f32 v[54:55], v[54:55], s[22:23], s[22:23]
  v_pk_fma_f32 v[56:57], v[56:57], s[22:23], s[22:23]
  v_pk_fma_f32 v[58:59], v[58:59], s[22:23], s[22:23]
  v_pk_fma_f32 v[60:61], v[60:61], s[22:23], s[22:23]
  v_pk_fma_f32 v[62:63], v[62:63], s[22:23], s[22:23]
  v_mfma_f32_32x32x16_bf16 v[16:31], a[168:171], v[160:163], 0
  ds_read_b128 v[192:195], v0 offset:43008
  ds_read_b128 v[196:199], v0 offset:44032
  v_rcp_f32 v48, v48
  v_rcp_f32 v49, v49
  v_mfma_f32_32x32x16_bf16 v[16:31], a[172:175], v[164:167], v[16:31]
  ds_read_b128 v[200:203], v0 offset:45056
  ds_read_b128 v[204:207], v0 offset:46080
  v_rcp_f32 v50, v50
  v_rcp_f32 v51, v51
  v_mfma_f32_32x32x16_bf16 v[16:31], a[176:179], v[168:171], v[16:31]
  ds_read_b128 v[208:211], v0 offset:47104
  ds_read_b128 v[212:215], v0 offset:48128
  v_rcp_f32 v52, v52
  v_rcp_f32 v53, v53
  v_mfma_f32_32x32x16_bf16 v[16:31], a[180:183], v[172:175], v[16:31]
  buffer_store_dwordx4 v[128:131], v10, s[8:11], s28 offen offset:128
  v_rcp_f32 v54, v54
  v_rcp_f32 v55, v55
  v_mfma_f32_32x32x16_bf16 v[16:31], a[184:187], v[176:179], v[16:31]
  v_rcp_f32 v56, v56
  v_rcp_f32 v57, v57
  v_rcp_f32_e64 v58, v58
  v_mfma_f32_32x32x16_bf16 v[16:31], a[188:191], v[180:183], v[16:31]
  s_waitcnt lgkmcnt(0)
  v_rcp_f32 v59, v59
  v_rcp_f32 v60, v60
  v_rcp_f32 v61, v61
  v_rcp_f32 v62, v62
  v_rcp_f32 v63, v63
  v_pk_mul_f32 v[32:33], v[32:33], v[48:49]
  v_pk_mul_f32 v[34:35], v[34:35], v[50:51]
  v_pk_mul_f32 v[36:37], v[36:37], v[52:53]
  v_pk_mul_f32 v[38:39], v[38:39], v[54:55]
  v_pk_mul_f32 v[40:41], v[40:41], v[56:57]
  v_pk_mul_f32 v[42:43], v[42:43], v[58:59]
  v_pk_mul_f32 v[44:45], v[44:45], v[60:61]
  v_pk_mul_f32 v[46:47], v[46:47], v[62:63]
  v_pk_fma_f32 v[48:49], v[16:17], v[16:17], s[20:21] neg_lo:[1,0,1] neg_hi:[1,0,1]
  v_pk_fma_f32 v[50:51], v[18:19], v[18:19], s[20:21] neg_lo:[1,0,1] neg_hi:[1,0,1]
  v_pk_fma_f32 v[52:53], v[20:21], v[20:21], s[20:21] neg_lo:[1,0,1] neg_hi:[1,0,1]
  v_pk_fma_f32 v[54:55], v[22:23], v[22:23], s[20:21] neg_lo:[1,0,1] neg_hi:[1,0,1]
  v_pk_fma_f32 v[56:57], v[24:25], v[24:25], s[20:21] neg_lo:[1,0,1] neg_hi:[1,0,1]
  v_pk_fma_f32 v[58:59], v[26:27], v[26:27], s[20:21] neg_lo:[1,0,1] neg_hi:[1,0,1]
  v_pk_fma_f32 v[60:61], v[28:29], v[28:29], s[20:21] neg_lo:[1,0,1] neg_hi:[1,0,1]
  v_pk_fma_f32 v[62:63], v[30:31], v[30:31], s[20:21] neg_lo:[1,0,1] neg_hi:[1,0,1]
  v_pk_mul_f32 v[48:49], v[16:17], v[48:49]
  v_pk_mul_f32 v[50:51], v[18:19], v[50:51]
  v_pk_mul_f32 v[52:53], v[20:21], v[52:53]
  v_pk_mul_f32 v[54:55], v[22:23], v[54:55]
  v_pk_mul_f32 v[56:57], v[24:25], v[56:57]
  v_cvt_pk_bf16_f32 v184, v32, v33
  v_cvt_pk_bf16_f32 v185, v34, v35
  v_cvt_pk_bf16_f32 v186, v36, v37
  v_cvt_pk_bf16_f32 v187, v38, v39
  v_pk_mul_f32 v[58:59], v[26:27], v[58:59]
  v_pk_mul_f32 v[60:61], v[28:29], v[60:61]
  v_pk_mul_f32 v[62:63], v[30:31], v[62:63]
  v_mfma_f32_32x32x16_bf16 v[64:79], v[192:195], v[184:187], v[64:79]
  v_cvt_pk_bf16_f32 v188, v40, v41
  v_cvt_pk_bf16_f32 v189, v42, v43
  v_cvt_pk_bf16_f32 v190, v44, v45
  v_cvt_pk_bf16_f32 v191, v46, v47
  v_exp_f32_e64 v48, v48
  v_mfma_f32_32x32x16_bf16 v[80:95], v[196:199], v[184:187], v[80:95]
  v_exp_f32 v49, v49
  v_exp_f32 v50, v50
  v_exp_f32_e64 v51, v51
  v_mfma_f32_32x32x16_bf16 v[96:111], v[200:203], v[184:187], v[96:111]
  v_exp_f32 v52, v52
  v_exp_f32 v53, v53
  v_exp_f32_e64 v54, v54
  v_mfma_f32_32x32x16_bf16 v[64:79], v[204:207], v[188:191], v[64:79]
  v_exp_f32 v55, v55
  v_exp_f32 v56, v56
  v_exp_f32_e64 v57, v57
  v_mfma_f32_32x32x16_bf16 v[80:95], v[208:211], v[188:191], v[80:95]
  v_exp_f32 v58, v58
  v_exp_f32 v59, v59
  v_exp_f32_e64 v60, v60
  v_mfma_f32_32x32x16_bf16 v[96:111], v[212:215], v[188:191], v[96:111]
  v_exp_f32 v61, v61
  v_exp_f32 v62, v62
  v_exp_f32_e64 v63, v63
  v_pk_fma_f32 v[48:49], v[48:49], s[22:23], s[22:23]
  v_pk_fma_f32 v[50:51], v[50:51], s[22:23], s[22:23]
  v_pk_fma_f32 v[52:53], v[52:53], s[22:23], s[22:23]
  v_pk_fma_f32 v[54:55], v[54:55], s[22:23], s[22:23]
  v_pk_fma_f32 v[56:57], v[56:57], s[22:23], s[22:23]
  v_pk_fma_f32 v[58:59], v[58:59], s[22:23], s[22:23]
  v_pk_fma_f32 v[60:61], v[60:61], s[22:23], s[22:23]
  v_pk_fma_f32 v[62:63], v[62:63], s[22:23], s[22:23]
  v_mfma_f32_32x32x16_bf16 v[32:47], a[192:195], v[160:163], 0
  ds_read_b128 v[192:195], v0 offset:49152
  ds_read_b128 v[196:199], v0 offset:50176
  v_rcp_f32 v48, v48
  v_rcp_f32 v49, v49
  v_mfma_f32_32x32x16_bf16 v[32:47], a[196:199], v[164:167], v[32:47]
  ds_read_b128 v[200:203], v0 offset:51200
  ds_read_b128 v[204:207], v0 offset:52224
  v_rcp_f32 v50, v50
  v_rcp_f32 v51, v51
  v_mfma_f32_32x32x16_bf16 v[32:47], a[200:203], v[168:171], v[32:47]
  ds_read_b128 v[208:211], v0 offset:53248
  ds_read_b128 v[212:215], v0 offset:54272
  v_rcp_f32 v52, v52
  v_rcp_f32 v53, v53
  v_mfma_f32_32x32x16_bf16 v[32:47], a[204:207], v[172:175], v[32:47]
  buffer_store_dwordx4 v[132:135], v10, s[8:11], s28 offen offset:160
  v_rcp_f32 v54, v54
  v_rcp_f32 v55, v55
  v_mfma_f32_32x32x16_bf16 v[32:47], a[208:211], v[176:179], v[32:47]
  v_rcp_f32 v56, v56
  v_rcp_f32 v57, v57
  v_rcp_f32_e64 v58, v58
  v_mfma_f32_32x32x16_bf16 v[32:47], a[212:215], v[180:183], v[32:47]
  s_waitcnt lgkmcnt(0)
  v_rcp_f32 v59, v59
  v_rcp_f32 v60, v60
  v_rcp_f32 v61, v61
  v_rcp_f32 v62, v62
  v_rcp_f32 v63, v63
  v_pk_mul_f32 v[16:17], v[16:17], v[48:49]
  v_pk_mul_f32 v[18:19], v[18:19], v[50:51]
  v_pk_mul_f32 v[20:21], v[20:21], v[52:53]
  v_pk_mul_f32 v[22:23], v[22:23], v[54:55]
  v_pk_mul_f32 v[24:25], v[24:25], v[56:57]
  v_pk_mul_f32 v[26:27], v[26:27], v[58:59]
  v_pk_mul_f32 v[28:29], v[28:29], v[60:61]
  v_pk_mul_f32 v[30:31], v[30:31], v[62:63]
  v_pk_fma_f32 v[48:49], v[32:33], v[32:33], s[20:21] neg_lo:[1,0,1] neg_hi:[1,0,1]
  v_pk_fma_f32 v[50:51], v[34:35], v[34:35], s[20:21] neg_lo:[1,0,1] neg_hi:[1,0,1]
  v_pk_fma_f32 v[52:53], v[36:37], v[36:37], s[20:21] neg_lo:[1,0,1] neg_hi:[1,0,1]
  v_pk_fma_f32 v[54:55], v[38:39], v[38:39], s[20:21] neg_lo:[1,0,1] neg_hi:[1,0,1]
  v_pk_fma_f32 v[56:57], v[40:41], v[40:41], s[20:21] neg_lo:[1,0,1] neg_hi:[1,0,1]
  v_pk_fma_f32 v[58:59], v[42:43], v[42:43], s[20:21] neg_lo:[1,0,1] neg_hi:[1,0,1]
  v_pk_fma_f32 v[60:61], v[44:45], v[44:45], s[20:21] neg_lo:[1,0,1] neg_hi:[1,0,1]
  v_pk_fma_f32 v[62:63], v[46:47], v[46:47], s[20:21] neg_lo:[1,0,1] neg_hi:[1,0,1]
  v_pk_mul_f32 v[48:49], v[32:33], v[48:49]
  v_pk_mul_f32 v[50:51], v[34:35], v[50:51]
  v_pk_mul_f32 v[52:53], v[36:37], v[52:53]
  v_pk_mul_f32 v[54:55], v[38:39], v[54:55]
  v_pk_mul_f32 v[56:57], v[40:41], v[56:57]
  v_cvt_pk_bf16_f32 v184, v16, v17
  v_cvt_pk_bf16_f32 v185, v18, v19
  v_cvt_pk_bf16_f32 v186, v20, v21
  v_cvt_pk_bf16_f32 v187, v22, v23
  v_pk_mul_f32 v[58:59], v[42:43], v[58:59]
  v_pk_mul_f32 v[60:61], v[44:45], v[60:61]
  v_pk_mul_f32 v[62:63], v[46:47], v[62:63]
  v_mfma_f32_32x32x16_bf16 v[64:79], v[192:195], v[184:187], v[64:79]
  v_cvt_pk_bf16_f32 v188, v24, v25
  v_cvt_pk_bf16_f32 v189, v26, v27
  v_cvt_pk_bf16_f32 v190, v28, v29
  v_cvt_pk_bf16_f32 v191, v30, v31
  v_exp_f32_e64 v48, v48
  v_mfma_f32_32x32x16_bf16 v[80:95], v[196:199], v[184:187], v[80:95]
  v_exp_f32 v49, v49
  v_exp_f32 v50, v50
  v_exp_f32_e64 v51, v51
  v_mfma_f32_32x32x16_bf16 v[96:111], v[200:203], v[184:187], v[96:111]
  v_exp_f32 v52, v52
  v_exp_f32 v53, v53
  v_exp_f32_e64 v54, v54
  v_mfma_f32_32x32x16_bf16 v[64:79], v[204:207], v[188:191], v[64:79]
  v_exp_f32 v55, v55
  v_exp_f32 v56, v56
  v_exp_f32_e64 v57, v57
  v_mfma_f32_32x32x16_bf16 v[80:95], v[208:211], v[188:191], v[80:95]
  v_exp_f32 v58, v58
  v_exp_f32 v59, v59
  v_exp_f32_e64 v60, v60
  v_mfma_f32_32x32x16_bf16 v[96:111], v[212:215], v[188:191], v[96:111]
  v_exp_f32 v61, v61
  v_exp_f32 v62, v62
  v_exp_f32_e64 v63, v63
  v_pk_fma_f32 v[48:49], v[48:49], s[22:23], s[22:23]
  v_pk_fma_f32 v[50:51], v[50:51], s[22:23], s[22:23]
  v_pk_fma_f32 v[52:53], v[52:53], s[22:23], s[22:23]
  v_pk_fma_f32 v[54:55], v[54:55], s[22:23], s[22:23]
  v_pk_fma_f32 v[56:57], v[56:57], s[22:23], s[22:23]
  v_pk_fma_f32 v[58:59], v[58:59], s[22:23], s[22:23]
  v_pk_fma_f32 v[60:61], v[60:61], s[22:23], s[22:23]
  v_pk_fma_f32 v[62:63], v[62:63], s[22:23], s[22:23]
  v_mfma_f32_32x32x16_bf16 v[16:31], a[216:219], v[160:163], 0
  ds_read_b128 v[192:195], v0 offset:55296
  ds_read_b128 v[196:199], v0 offset:56320
  v_rcp_f32 v48, v48
  v_rcp_f32 v49, v49
  v_mfma_f32_32x32x16_bf16 v[16:31], a[220:223], v[164:167], v[16:31]
  ds_read_b128 v[200:203], v0 offset:57344
  ds_read_b128 v[204:207], v0 offset:58368
  v_rcp_f32 v50, v50
  v_rcp_f32 v51, v51
  v_mfma_f32_32x32x16_bf16 v[16:31], a[224:227], v[168:171], v[16:31]
  ds_read_b128 v[208:211], v0 offset:59392
  ds_read_b128 v[212:215], v0 offset:60416
  v_rcp_f32 v52, v52
  v_rcp_f32 v53, v53
  v_mfma_f32_32x32x16_bf16 v[16:31], a[228:231], v[172:175], v[16:31]
  v_rcp_f32 v54, v54
  v_rcp_f32 v55, v55
  v_rcp_f32_e64 v56, v56
  v_mfma_f32_32x32x16_bf16 v[16:31], a[232:235], v[176:179], v[16:31]
  v_rcp_f32 v57, v57
  v_rcp_f32 v58, v58
  v_rcp_f32_e64 v59, v59
  v_mfma_f32_32x32x16_bf16 v[16:31], a[236:239], v[180:183], v[16:31]
  s_waitcnt lgkmcnt(0)
  v_rcp_f32 v60, v60
  v_rcp_f32 v61, v61
  v_rcp_f32 v62, v62
  v_rcp_f32_e64 v63, v63
  v_pk_mul_f32 v[32:33], v[32:33], v[48:49]
  v_pk_mul_f32 v[34:35], v[34:35], v[50:51]
  v_pk_mul_f32 v[36:37], v[36:37], v[52:53]
  v_pk_mul_f32 v[38:39], v[38:39], v[54:55]
  v_pk_mul_f32 v[40:41], v[40:41], v[56:57]
  v_pk_mul_f32 v[42:43], v[42:43], v[58:59]
  v_pk_mul_f32 v[44:45], v[44:45], v[60:61]
  v_pk_mul_f32 v[46:47], v[46:47], v[62:63]
  v_pk_fma_f32 v[48:49], v[16:17], v[16:17], s[20:21] neg_lo:[1,0,1] neg_hi:[1,0,1]
  v_pk_fma_f32 v[50:51], v[18:19], v[18:19], s[20:21] neg_lo:[1,0,1] neg_hi:[1,0,1]
  v_pk_fma_f32 v[52:53], v[20:21], v[20:21], s[20:21] neg_lo:[1,0,1] neg_hi:[1,0,1]
  v_pk_fma_f32 v[54:55], v[22:23], v[22:23], s[20:21] neg_lo:[1,0,1] neg_hi:[1,0,1]
  v_pk_fma_f32 v[56:57], v[24:25], v[24:25], s[20:21] neg_lo:[1,0,1] neg_hi:[1,0,1]
  v_pk_fma_f32 v[58:59], v[26:27], v[26:27], s[20:21] neg_lo:[1,0,1] neg_hi:[1,0,1]
  v_pk_fma_f32 v[60:61], v[28:29], v[28:29], s[20:21] neg_lo:[1,0,1] neg_hi:[1,0,1]
  v_pk_fma_f32 v[62:63], v[30:31], v[30:31], s[20:21] neg_lo:[1,0,1] neg_hi:[1,0,1]
  v_pk_mul_f32 v[48:49], v[16:17], v[48:49]
  v_pk_mul_f32 v[50:51], v[18:19], v[50:51]
  v_pk_mul_f32 v[52:53], v[20:21], v[52:53]
  v_pk_mul_f32 v[54:55], v[22:23], v[54:55]
  v_pk_mul_f32 v[56:57], v[24:25], v[56:57]
  v_cvt_pk_bf16_f32 v184, v32, v33
  v_cvt_pk_bf16_f32 v185, v34, v35
  v_cvt_pk_bf16_f32 v186, v36, v37
  v_cvt_pk_bf16_f32 v187, v38, v39
  v_pk_mul_f32 v[58:59], v[26:27], v[58:59]
  v_pk_mul_f32 v[60:61], v[28:29], v[60:61]
  v_pk_mul_f32 v[62:63], v[30:31], v[62:63]
  v_mfma_f32_32x32x16_bf16 v[64:79], v[192:195], v[184:187], v[64:79]
  ds_read_b128 v[216:219], v0
  ds_read_b128 v[220:223], v0 offset:1024
  v_cvt_pk_bf16_f32 v188, v40, v41
  v_cvt_pk_bf16_f32 v189, v42, v43
  v_cvt_pk_bf16_f32 v190, v44, v45
  v_cvt_pk_bf16_f32 v191, v46, v47
  v_mfma_f32_32x32x16_bf16 v[80:95], v[196:199], v[184:187], v[80:95]
  ds_read_b128 v[224:227], v0 offset:4096
  ds_read_b128 v[228:231], v0 offset:5120
  v_exp_f32 v48, v48
  v_exp_f32 v49, v49
  v_mfma_f32_32x32x16_bf16 v[96:111], v[200:203], v[184:187], v[96:111]
  ds_read_b128 v[232:235], v0 offset:8192
  ds_read_b128 v[236:239], v0 offset:9216
  v_exp_f32 v50, v50
  v_exp_f32 v51, v51
  v_mfma_f32_32x32x16_bf16 v[64:79], v[204:207], v[188:191], v[64:79]
  s_mov_b32 s28, s34
  v_exp_f32 v52, v52
  v_exp_f32 v53, v53
  v_exp_f32 v54, v54
  v_mfma_f32_32x32x16_bf16 v[80:95], v[208:211], v[188:191], v[80:95]
  s_add_u32 s34, s34, 0x60000
  v_exp_f32 v55, v55
  v_exp_f32 v56, v56
  v_exp_f32_e64 v57, v57
  v_mfma_f32_32x32x16_bf16 v[96:111], v[212:215], v[188:191], v[96:111]
  s_waitcnt lgkmcnt(0)
  v_exp_f32 v58, v58
  v_exp_f32 v59, v59
  v_exp_f32 v60, v60
  v_exp_f32 v61, v61
  v_exp_f32 v62, v62
  v_exp_f32_e64 v63, v63
  v_pk_fma_f32 v[48:49], v[48:49], s[22:23], s[22:23]
  v_pk_fma_f32 v[50:51], v[50:51], s[22:23], s[22:23]
  v_pk_fma_f32 v[52:53], v[52:53], s[22:23], s[22:23]
  v_pk_fma_f32 v[54:55], v[54:55], s[22:23], s[22:23]
  v_pk_fma_f32 v[56:57], v[56:57], s[22:23], s[22:23]
  v_pk_fma_f32 v[58:59], v[58:59], s[22:23], s[22:23]
  v_pk_fma_f32 v[60:61], v[60:61], s[22:23], s[22:23]
  v_pk_fma_f32 v[62:63], v[62:63], s[22:23], s[22:23]
  v_mfma_f32_32x32x16_bf16 v[32:47], v[216:219], v[160:163], 0
  ds_read_b128 v[192:195], v0 offset:61440
  ds_read_b128 v[196:199], v0 offset:62464
  v_rcp_f32 v48, v48
  v_rcp_f32 v49, v49
  v_mfma_f32_32x32x16_bf16 v[32:47], v[220:223], v[164:167], v[32:47]
  ds_read_b128 v[200:203], v0 offset:63488
  ds_read_b128 v[204:207], v0 offset:64512
  v_rcp_f32 v50, v50
  v_rcp_f32 v51, v51
  v_mfma_f32_32x32x16_bf16 v[32:47], v[224:227], v[168:171], v[32:47]
  ds_read_b128 v[208:211], v1
  ds_read_b128 v[212:215], v1 offset:1024
  v_rcp_f32 v52, v52
  v_rcp_f32 v53, v53
  v_mfma_f32_32x32x16_bf16 v[32:47], v[228:231], v[172:175], v[32:47]
  v_rcp_f32 v54, v54
  v_rcp_f32 v55, v55
  v_rcp_f32_e64 v56, v56
  v_mfma_f32_32x32x16_bf16 v[32:47], v[232:235], v[176:179], v[32:47]
  v_rcp_f32 v57, v57
  v_rcp_f32 v58, v58
  v_rcp_f32_e64 v59, v59
  v_mfma_f32_32x32x16_bf16 v[32:47], v[236:239], v[180:183], v[32:47]
  s_waitcnt lgkmcnt(0)
  v_rcp_f32 v60, v60
  v_rcp_f32 v61, v61
  v_rcp_f32 v62, v62
  v_rcp_f32_e64 v63, v63
  v_pk_mul_f32 v[16:17], v[16:17], v[48:49]
  v_pk_mul_f32 v[18:19], v[18:19], v[50:51]
  v_pk_mul_f32 v[20:21], v[20:21], v[52:53]
  v_pk_mul_f32 v[22:23], v[22:23], v[54:55]
  v_pk_mul_f32 v[24:25], v[24:25], v[56:57]
  v_pk_mul_f32 v[26:27], v[26:27], v[58:59]
  v_pk_mul_f32 v[28:29], v[28:29], v[60:61]
  v_pk_mul_f32 v[30:31], v[30:31], v[62:63]
  v_pk_fma_f32 v[48:49], v[32:33], v[32:33], s[20:21] neg_lo:[1,0,1] neg_hi:[1,0,1]
  v_pk_fma_f32 v[50:51], v[34:35], v[34:35], s[20:21] neg_lo:[1,0,1] neg_hi:[1,0,1]
  v_pk_fma_f32 v[52:53], v[36:37], v[36:37], s[20:21] neg_lo:[1,0,1] neg_hi:[1,0,1]
  v_pk_fma_f32 v[54:55], v[38:39], v[38:39], s[20:21] neg_lo:[1,0,1] neg_hi:[1,0,1]
  v_pk_fma_f32 v[56:57], v[40:41], v[40:41], s[20:21] neg_lo:[1,0,1] neg_hi:[1,0,1]
  v_pk_fma_f32 v[58:59], v[42:43], v[42:43], s[20:21] neg_lo:[1,0,1] neg_hi:[1,0,1]
  v_pk_fma_f32 v[60:61], v[44:45], v[44:45], s[20:21] neg_lo:[1,0,1] neg_hi:[1,0,1]
  v_pk_fma_f32 v[62:63], v[46:47], v[46:47], s[20:21] neg_lo:[1,0,1] neg_hi:[1,0,1]
  v_pk_mul_f32 v[48:49], v[32:33], v[48:49]
  v_pk_mul_f32 v[50:51], v[34:35], v[50:51]
  v_pk_mul_f32 v[52:53], v[36:37], v[52:53]
  v_pk_mul_f32 v[54:55], v[38:39], v[54:55]
  v_pk_mul_f32 v[56:57], v[40:41], v[56:57]
  v_cvt_pk_bf16_f32 v184, v16, v17
  v_cvt_pk_bf16_f32 v185, v18, v19
  v_cvt_pk_bf16_f32 v186, v20, v21
  v_cvt_pk_bf16_f32 v187, v22, v23
  v_pk_mul_f32 v[58:59], v[42:43], v[58:59]
  v_pk_mul_f32 v[60:61], v[44:45], v[60:61]
  v_pk_mul_f32 v[62:63], v[46:47], v[62:63]
  v_mfma_f32_32x32x16_bf16 v[64:79], v[192:195], v[184:187], v[64:79]
  v_cvt_pk_bf16_f32 v188, v24, v25
  v_cvt_pk_bf16_f32 v189, v26, v27
  v_cvt_pk_bf16_f32 v190, v28, v29
  v_cvt_pk_bf16_f32 v191, v30, v31
  v_exp_f32_e64 v48, v48
  v_mfma_f32_32x32x16_bf16 v[80:95], v[196:199], v[184:187], v[80:95]
  v_exp_f32 v49, v49
  v_exp_f32 v50, v50
  v_exp_f32_e64 v51, v51
  v_mfma_f32_32x32x16_bf16 v[96:111], v[200:203], v[184:187], v[96:111]
  v_exp_f32 v52, v52
  v_exp_f32 v53, v53
  v_exp_f32_e64 v54, v54
  v_mfma_f32_32x32x16_bf16 v[64:79], v[204:207], v[188:191], v[64:79]
  v_exp_f32 v55, v55
  v_exp_f32 v56, v56
  v_exp_f32_e64 v57, v57
  v_mfma_f32_32x32x16_bf16 v[80:95], v[208:211], v[188:191], v[80:95]
  v_exp_f32 v58, v58
  v_exp_f32 v59, v59
  v_exp_f32_e64 v60, v60
  v_mfma_f32_32x32x16_bf16 v[96:111], v[212:215], v[188:191], v[96:111]
  v_exp_f32 v61, v61
  v_exp_f32 v62, v62
  v_exp_f32_e64 v63, v63
  v_pk_fma_f32 v[48:49], v[48:49], s[22:23], s[22:23]
  v_pk_fma_f32 v[50:51], v[50:51], s[22:23], s[22:23]
  v_pk_fma_f32 v[52:53], v[52:53], s[22:23], s[22:23]
  v_pk_fma_f32 v[54:55], v[54:55], s[22:23], s[22:23]
  v_pk_fma_f32 v[56:57], v[56:57], s[22:23], s[22:23]
  v_pk_fma_f32 v[58:59], v[58:59], s[22:23], s[22:23]
  v_pk_fma_f32 v[60:61], v[60:61], s[22:23], s[22:23]
  v_pk_fma_f32 v[62:63], v[62:63], s[22:23], s[22:23]
  ds_read_b128 v[192:195], v1 offset:2048
  ds_read_b128 v[196:199], v1 offset:3072
  ds_read_b128 v[200:203], v1 offset:4096
  ds_read_b128 v[204:207], v1 offset:5120
  ds_read_b128 v[208:211], v1 offset:6144
  ds_read_b128 v[212:215], v1 offset:7168
  v_rcp_f32 v48, v48
  v_rcp_f32 v49, v49
  v_rcp_f32 v50, v50
  v_rcp_f32 v51, v51
  v_rcp_f32 v52, v52
  v_rcp_f32 v53, v53
  v_rcp_f32 v54, v54
  v_rcp_f32 v55, v55
  v_rcp_f32 v56, v56
  v_rcp_f32 v57, v57
  v_rcp_f32 v58, v58
  v_rcp_f32 v59, v59
  v_rcp_f32 v60, v60
  v_rcp_f32 v61, v61
  v_rcp_f32 v62, v62
  v_rcp_f32 v63, v63
  v_pk_mul_f32 v[32:33], v[32:33], v[48:49]
  v_pk_mul_f32 v[34:35], v[34:35], v[50:51]
  v_pk_mul_f32 v[36:37], v[36:37], v[52:53]
  v_pk_mul_f32 v[38:39], v[38:39], v[54:55]
  v_pk_mul_f32 v[40:41], v[40:41], v[56:57]
  v_pk_mul_f32 v[42:43], v[42:43], v[58:59]
  v_pk_mul_f32 v[44:45], v[44:45], v[60:61]
  v_pk_mul_f32 v[46:47], v[46:47], v[62:63]
  v_cvt_pk_bf16_f32 v184, v32, v33
  v_cvt_pk_bf16_f32 v185, v34, v35
  v_cvt_pk_bf16_f32 v186, v36, v37
  v_cvt_pk_bf16_f32 v187, v38, v39
  v_cvt_pk_bf16_f32 v188, v40, v41
  v_cvt_pk_bf16_f32 v189, v42, v43
  v_cvt_pk_bf16_f32 v190, v44, v45
  v_cvt_pk_bf16_f32 v191, v46, v47
  s_waitcnt lgkmcnt(5)
  v_mfma_f32_32x32x16_bf16 v[64:79], v[192:195], v[184:187], v[64:79]
  s_waitcnt lgkmcnt(2)
  v_mfma_f32_32x32x16_bf16 v[64:79], v[204:207], v[188:191], v[64:79]
  v_mfma_f32_32x32x16_bf16 v[80:95], v[196:199], v[184:187], v[80:95]
  s_nop 0
  s_waitcnt lgkmcnt(1)
  v_mfma_f32_32x32x16_bf16 v[80:95], v[208:211], v[188:191], v[80:95]
  v_mfma_f32_32x32x16_bf16 v[96:111], v[200:203], v[184:187], v[96:111]
  s_waitcnt lgkmcnt(0)
  v_mfma_f32_32x32x16_bf16 v[96:111], v[212:215], v[188:191], v[96:111]
  s_nop 5
  v_cvt_pk_bf16_f32 v112, v64, v65
  v_cvt_pk_bf16_f32 v113, v66, v67
  v_cvt_pk_bf16_f32 v114, v68, v69
  v_cvt_pk_bf16_f32 v115, v70, v71
  buffer_store_dwordx4 v[112:115], v10, s[8:11], s28 offen
  v_cvt_pk_bf16_f32 v116, v72, v73
  v_cvt_pk_bf16_f32 v117, v74, v75
  v_cvt_pk_bf16_f32 v118, v76, v77
  v_cvt_pk_bf16_f32 v119, v78, v79
  buffer_store_dwordx4 v[116:119], v10, s[8:11], s28 offen offset:32
  v_cvt_pk_bf16_f32 v120, v80, v81
  v_cvt_pk_bf16_f32 v121, v82, v83
  v_cvt_pk_bf16_f32 v122, v84, v85
  v_cvt_pk_bf16_f32 v123, v86, v87
  buffer_store_dwordx4 v[120:123], v10, s[8:11], s28 offen offset:64
  v_cvt_pk_bf16_f32 v124, v88, v89
  v_cvt_pk_bf16_f32 v125, v90, v91
  v_cvt_pk_bf16_f32 v126, v92, v93
  v_cvt_pk_bf16_f32 v127, v94, v95
  buffer_store_dwordx4 v[124:127], v10, s[8:11], s28 offen offset:96
  v_cvt_pk_bf16_f32 v128, v96, v97
  v_cvt_pk_bf16_f32 v129, v98, v99
  v_cvt_pk_bf16_f32 v130, v100, v101
  v_cvt_pk_bf16_f32 v131, v102, v103
  buffer_store_dwordx4 v[128:131], v10, s[8:11], s28 offen offset:128
  v_cvt_pk_bf16_f32 v132, v104, v105
  v_cvt_pk_bf16_f32 v133, v106, v107
  v_cvt_pk_bf16_f32 v134, v108, v109
  v_cvt_pk_bf16_f32 v135, v110, v111
  buffer_store_dwordx4 v[132:135], v10, s[8:11], s28 offen offset:160
L_end:
  s_endpgm
.section .rodata,"a"
.p2align 6
.amdhsa_kernel standalone__modern_conv_block_convnext__vision_kernel
  .amdhsa_next_free_vgpr 512
  .amdhsa_next_free_sgpr 102
  .amdhsa_accum_offset 256
  .amdhsa_group_segment_fixed_size 0
  .amdhsa_kernarg_size 80
  .amdhsa_user_sgpr_count 2
  .amdhsa_user_sgpr_kernarg_segment_ptr 1
  .amdhsa_system_sgpr_workgroup_id_x 1
.end_amdhsa_kernel
```

```asm
; @launch grid=(256,1,1) block=(256,1,1) lds=163840
.amdgcn_target "amdgcn-amd-amdhsa--gfx950"
.text
.globl standalone__modern_conv_block_convnext__vision_kernel
.p2align 8
.type standalone__modern_conv_block_convnext__vision_kernel,@function
standalone__modern_conv_block_convnext__vision_kernel:
  s_cmp_ge_u32 s2, 0x100
  s_nop 0
  s_cbranch_scc1 L_end
  s_load_dwordx2 s[4:5], s[0:1], 0
  s_load_dwordx2 s[60:61], s[0:1], 8
  s_load_dwordx2 s[64:65], s[0:1], 16
  s_load_dwordx2 s[68:69], s[0:1], 24
  s_load_dwordx2 s[72:73], s[0:1], 32
  s_load_dwordx2 s[76:77], s[0:1], 40
  s_load_dwordx2 s[80:81], s[0:1], 48
  s_load_dwordx2 s[8:9], s[0:1], 56
  s_getpc_b64 s[40:41]
L_pc:
  s_lshl_b32 s32, s2, 9
  s_and_b32 s32, s32, 0xf000
  v_lshl_add_u32 v249, v0, 4, s32
  v_lshrrev_b32_e64 v112, 6, v0
  v_min_u32 v249, L_end-L_pc-12, v249
  v_and_b32 v113, 63, v0
  global_load_dwordx4 v[108:111], v249, s[40:41]
  v_readfirstlane_b32 s27, v112
  s_mov_b32 s62, 0x6c0
  s_mov_b32 s63, 0x20000
  s_mov_b32 s82, 0xc0
  s_mov_b32 s83, 0x20000
  s_mov_b32 s78, 0xc0
  s_mov_b32 s79, 0x20000
  s_mov_b32 s66, 0x12000
  s_mov_b32 s67, 0x20000
  s_mov_b32 s74, 0x12000
  s_mov_b32 s75, 0x20000
  v_bfe_u32 v114, v113, 3, 1
  v_bfe_u32 v115, v113, 4, 1
  v_bfe_u32 v116, v113, 2, 1
  v_and_b32 v117, 3, v113
  v_lshlrev_b32 v118, 4, v113
  s_min_u32 s44, s27, 2
  s_lshl_b32 s45, s44, 6
  s_mul_i32 s46, s44, 0x240
  v_lshlrev_b32 v119, 1, v113
  v_and_b32 v120, 31, v113
  v_lshlrev_b32 v121, 1, v120
  v_lshlrev_b32 v122, 4, v115
  v_lshl_add_u32 v122, v116, 3, v122
  v_lshl_add_u32 v122, v114, 2, v122
  v_add_u32 v122, v122, v117
  v_lshlrev_b32 v123, 1, v122
  s_lshr_b32 s35, s2, 3
  s_lshl_b32 s35, s35, 2
  s_add_u32 s35, s35, s27
  s_sub_u32 s55, s35, 0x48
  s_min_u32 s35, s35, s55
  s_lshl_b32 s47, s35, 10
  s_and_b32 s54, s2, 6
  s_lshl_b32 s54, s54, 1
  s_lshr_b32 s32, s2, 6
  s_add_u32 s54, s54, s32
  s_mul_i32 s59, s54, 0x300000
  s_and_b32 s53, s2, 1
  s_lshl_b32 s53, s53, 8
  s_and_b32 s32, s2, 56
  s_lshl_b32 s32, s32, 2
  s_add_u32 s53, s53, s32
  s_lshl_b32 s32, s27, 3
  s_add_u32 s53, s53, s32
  s_mul_i32 s3, s53, 0xc0
  s_add_u32 s3, s3, 0xf40
  s_mov_b32 s6, 0x3000000
  s_mov_b32 s7, 0x20000
  s_cmp_eq_u32 s53, 0
  s_cselect_b32 s35, 12, 0
  s_sub_u32 s55, 0x78, s35
  s_cmp_eq_u32 s53, 0x1f8
  s_cselect_b32 s55, 0x6c, s55
  s_mul_i32 s15, s27, 0x1040
  s_add_u32 s48, s59, 0x17000
  s_add_u32 s49, s59, 0x47000
  s_waitcnt lgkmcnt(0)
  v_add_u32 v124, 64, v113
  buffer_load_dwordx4 v[108:111], v118, s[64:67], s47 offen
  v_subrev_u32 v127, 57, v113
  v_cmp_le_u32 vcc, 57, v113
  buffer_load_dwordx4 v[108:111], v118, s[72:75], s47 offen
  v_add_u32_e64 v125, 7, v113
  v_add_u32 v126, 0x47, v113
  buffer_load_ushort v129, v119, s[60:63], s46 offen
  v_mov_b32 v199, 0x17c00
  v_cndmask_b32_e64 v124, v124, v127, vcc
  buffer_load_ushort v130, v119, s[60:63], s46 offen offset:128
  v_mov_b32 v127, 0xfffffc00
  v_cndmask_b32 v199, v127, v199, vcc
  v_add_u32 v198, s3, v118
  buffer_load_ushort v131, v119, s[60:63], s46 offen offset:256
  v_lshl_add_u32 v199, v124, 4, v199
  v_add_u32_e64 v199, s3, v199
  buffer_load_ushort v132, v119, s[60:63], s46 offen offset:384
  v_add_u32 v200, 0x17870, v198
  v_add_u32 v201, 0x17870, v198
  buffer_load_ushort v133, v121, s[60:63], s46 offen offset:512
  v_mov_b32 v128, 0x80000000
  v_subrev_u32_e64 v6, s35, v113
  buffer_load_ushort v137, v123, s[80:83], s45 offen
  v_cmp_gt_u32 s[36:37], s55, v6
  v_subrev_u32_e64 v7, s35, v124
  v_cmp_gt_u32 s[38:39], s55, v7
  buffer_load_ushort v138, v123, s[76:79], s45 offen
  v_subrev_u32_e64 v8, s35, v125
  v_cmp_gt_u32 s[40:41], s55, v8
  buffer_load_ushort v134, v123, s[80:83], 0 offen
  v_subrev_u32_e64 v9, s35, v126
  v_cmp_gt_u32 s[42:43], s55, v9
  buffer_load_ushort v135, v123, s[80:83], 0 offen offset:64
  v_cndmask_b32 v6, v128, v198, s[36:37]
  v_cndmask_b32 v7, v128, v199, s[38:39]
  buffer_load_ushort v136, v123, s[80:83], 0 offen offset:128
  v_cndmask_b32 v8, v128, v200, s[40:41]
  v_cndmask_b32 v9, v128, v201, s[42:43]
  s_add_u32 m0, s15, 0x4120
  s_nop 0
  s_nop 0
  buffer_load_dwordx4 v6, s[4:7], s48 offen lds
  buffer_load_dwordx4 v7, s[4:7], s48 offen offset:1024 lds
  buffer_load_dwordx4 v8, s[4:7], s48 offen offset:2048 lds
  buffer_load_dwordx4 v9, s[4:7], s48 offen offset:3072 lds
  s_sub_u32 s56, s59, 0x19000
  v_add_u32_e64 v198, s56, v6
  s_add_u32 s56, s56, 0x400
  v_add_u32_e64 v199, s56, v7
  s_add_u32 s56, s56, 0x400
  v_add_u32_e64 v200, s56, v8
  s_add_u32 s56, s56, 0x400
  v_add_u32 v201, s56, v9
  v_lshrrev_b32 v139, 5, v113
  v_lshlrev_b32_e64 v202, 4, v117
  v_lshl_add_u32 v202, v139, 6, v202
  v_bfe_u32 v124, v113, 3, 2
  v_lshl_add_u32 v124, v116, 2, v124
  v_cmp_eq_u32_e64 vcc, 7, v124
  v_mul_u32_u24 v203, 0x300, v124
  v_add_u32 v203, v203, v202
  v_cndmask_b32 v204, v128, v202, vcc
  s_mov_b32 s70, 0x300
  s_mov_b32 s71, 0x20000
  s_mov_b32 s10, 0x3000000
  s_mov_b32 s11, 0x20000
  s_and_b32 s36, s27, 2
  s_add_u32 s37, s27, 1
  s_lshr_b32 s37, s37, 1
  s_and_b32 s38, s37, 1
  s_cmp_eq_u32 s27, 1
  s_cselect_b32 s39, 0, 3
  s_cselect_b32 s51, 0x1000, 0
  s_lshl_b32 s32, s36, 8
  s_lshl_b32 s33, s37, 8
  s_add_u32 s43, s32, 0x11d00
  s_add_u32 s50, s33, 0x11d00
  s_add_u32 s51, s51, s33
  s_mul_i32 s40, s38, 0x6000
  s_add_u32 s40, s40, s32
  s_mul_i32 s41, s38, 0x1800
  s_add_u32 s41, s41, s32
  s_add_u32 s41, s41, 0x3000
  s_mul_i32 s42, s39, 0x3000
  s_add_u32 s42, s42, s33
  s_mul_i32 s32, s36, 0x6000
  s_lshl_b32 s33, s38, 11
  s_add_u32 s33, s33, s32
  s_add_u32 s33, s33, 0x10000
  v_add_u32_e64 v195, s33, v118
  s_lshl_b32 s33, s38, 3
  s_add_u32 s33, s33, s32
  s_add_u32 s33, s33, 0x10400
  v_add_u32_e64 v196, s33, v118
  s_mul_i32 s32, s37, 0x6000
  s_lshl_b32 s33, s39, 10
  s_add_u32 s33, s33, s32
  s_add_u32 s33, s33, 0x10000
  v_add_u32 v197, s33, v118
  v_add_u32 v125, 16, v113
  v_lshrrev_b32_e64 v125, 6, v125
  buffer_load_dwordx4 a[72:75], v202, s[64:67], s43 offen
  v_lshlrev_b32 v125, 4, v125
  v_xor_b32 v254, v125, v118
  v_lshl_add_u32 v125, v139, 4, 16
  v_xor_b32_e64 v255, v125, v118
  v_mul_u32_u24 v125, 0x1200, v139
  v_add_u32_e64 v255, v125, v255
  v_add_u32 v125, 0xb0, v113
  v_lshrrev_b32 v125, 6, v125
  v_lshlrev_b32 v125, 4, v125
  v_xor_b32_e64 v194, v125, v118
  v_add_u32 v194, 0x1200, v194
  s_mul_i32 s14, s27, 0x1800
  s_add_u32 s32, s27, 3
  s_and_b32 s32, s32, 3
  s_mul_i32 s32, s32, 0x600
  s_cmp_eq_u32 s27, 0
  s_cselect_b32 s57, 0, 3
  s_cselect_b32 s53, 3, 6
  s_cselect_b32 s55, 6, 0
  s_lshl_b32 s57, s57, 13
  s_add_u32 s57, s57, s32
  s_add_u32 s58, s57, 0x3000
  s_lshl_b32 s53, s53, 13
  s_add_u32 s53, s53, s32
  s_add_u32 s54, s53, 0x3000
  s_lshl_b32 s55, s55, 13
  s_add_u32 s55, s55, s32
  s_add_u32 s56, s55, 0x3000
  v_and_b32_e64 v145, 7, v113
  buffer_load_dwordx4 a[76:79], v202, s[64:67], s43 offen offset:128
  v_lshrrev_b32 v146, 4, v113
  v_lshlrev_b32 v147, 4, v139
  v_and_b32 v141, 1, v113
  v_lshlrev_b32 v141, 4, v141
  v_mov_b32 v127, 0xffff
  v_lshlrev_b32_e64 v127, v141, v127
  v_bfe_u32 v125, v113, 1, 2
  buffer_load_dwordx4 a[80:83], v202, s[64:67], s50 offen
  v_lshlrev_b32 v125, v125, 1
  v_bfe_i32 v56, v125, 0, 1
  v_mov_b32 v60, 0
  v_and_b32 v56, v56, v127
  v_bfe_i32 v57, v125, 1, 1
  v_mov_b32 v61, 0
  v_and_b32 v57, v57, v127
  v_bfe_i32 v58, v125, 2, 1
  v_mov_b32 v62, 0
  v_and_b32 v58, v58, v127
  v_bfe_i32 v59, v125, 3, 1
  v_mov_b32 v63, 0
  v_and_b32 v59, v59, v127
  v_min_u32_e64 v125, 35, v113
  v_mul_u32_u24 v125, 0x190, v125
  ds_write_b128 v125, v[60:63] offset:50304
  s_lshl_b32 s32, s44, 7
  v_lshrrev_b32 v142, 3, v113
  buffer_load_dwordx4 a[84:87], v202, s[64:67], s50 offen offset:128
  v_mul_u32_u24 v142, 0x190, v142
  v_lshl_add_u32 v142, v145, 4, v142
  v_add_u32 v142, s32, v142
  v_lshrrev_b32 v143, 3, v120
  v_mul_u32_u24 v143, 0x190, v143
  v_lshl_add_u32 v143, v145, 4, v143
  v_add_u32_e64 v143, s32, v143
  v_lshl_add_u32 v144, v120, 2, s32
  v_sub_u32_e64 v125, v146, v116
  v_lshl_add_u32 v126, v114, 2, v117
  v_lshl_add_u32 v126, v125, 3, v126
  v_min_u32 v126, 24, v126
  v_lshlrev_b32 v126, 4, v126
  v_add_u32 v3, 0xc300, v126
  v_lshlrev_b32_e64 v148, 2, v115
  v_lshl_add_u32 v148, v114, 1, v148
  v_bfe_u32 v126, v113, 1, 1
  buffer_load_dwordx4 a[88:91], v204, s[68:71], s51 offen
  v_add_u32 v148, v148, v126
  v_xor_b32 v126, v116, v139
  v_lshl_add_u32 v148, v126, 3, v148
  v_lshlrev_b32 v148, v148, 1
  v_mov_b32 v126, 0x3f80
  v_lshlrev_b32_e64 v126, v141, v126
  v_mov_b32 v125, 0xbf80
  v_lshlrev_b32_e64 v125, v141, v125
  v_bfe_i32 v160, v148, 0, 1
  v_and_b32 v240, v160, v126
  v_and_b32 v184, v160, v125
  v_bfe_i32 v161, v148, 1, 1
  v_and_b32 v241, v161, v126
  v_and_b32 v185, v161, v125
  v_bfe_i32 v162, v148, 2, 1
  v_and_b32 v242, v162, v126
  v_and_b32 v186, v162, v125
  v_bfe_i32 v163, v148, 3, 1
  buffer_load_dwordx4 a[92:95], v204, s[68:71], s51 offen offset:128
  v_and_b32 v243, v163, v126
  v_and_b32 v187, v163, v125
  v_bfe_i32 v164, v148, 4, 1
  v_and_b32 v244, v164, v126
  v_and_b32 v188, v164, v125
  v_bfe_i32 v165, v148, 5, 1
  v_and_b32 v245, v165, v126
  v_and_b32 v189, v165, v125
  v_bfe_i32 v166, v148, 6, 1
  v_and_b32 v246, v166, v126
  v_and_b32 v190, v166, v125
  v_bfe_i32 v167, v148, 7, 1
  v_and_b32 v247, v167, v126
  v_and_b32 v191, v167, v125
  s_mov_b32 s20, 0x409d30fc
  s_mov_b32 s21, 0x409d30fc
  s_mov_b32 s22, 0x3eeff558
  s_mov_b32 s23, 0x3eeff558
  s_mov_b32 s24, 0x3c2aaaab
  s_mov_b32 s25, 0x3727c5ac
  s_mov_b32 s12, 0
  s_mov_b32 s13, -1
  s_add_u32 s29, s59, 0x77000
  s_add_u32 s52, s59, 0xa7000
  v_mul_u32_u24 v149, 0xc0, v145
  buffer_load_dwordx4 a[0:3], v203, s[64:67], s40 offen
  v_add_u32_e64 v127, s15, v149
  v_lshl_add_u32 v150, v114, 1, v146
  v_lshrrev_b32_e64 v125, 1, v150
  v_mul_u32_u24 v140, 0x4100, v125
  v_and_b32_e64 v125, 1, v125
  v_lshl_add_u32 v140, v125, 5, v140
  v_and_b32_e64 v125, 1, v150
  v_mul_u32_u24 v125, 0x790, v125
  v_add3_u32 v4, v140, v125, v127
  v_lshl_add_u32 v151, v114, 1, v115
  buffer_load_dwordx4 a[4:7], v203, s[64:67], s40 offen offset:128
  s_add_u32 s40, s40, 0x1800
  v_add_u32_e64 v150, 1, v151
  v_add_u32 v127, 0xc0, v127
  v_add_u32 v127, v127, v147
  v_lshrrev_b32 v125, 1, v150
  v_mul_u32_u24 v140, 0x4100, v125
  v_and_b32_e64 v125, 1, v125
  v_lshl_add_u32 v140, v125, 5, v140
  v_and_b32_e64 v125, 1, v150
  v_mul_u32_u24 v125, 0x790, v125
  v_add3_u32 v5, v140, v125, v127
  v_mul_u32_u24 v125, 0x18000, v151
  v_add3_u32 v10, v125, v147, v149
  s_sub_u32 s32, s3, 0xf40
  v_add_u32_e64 v10, s32, v10
  v_add_u32 v2, 0xfb40, v147
  v_add_u32 v0, 0x10000, v118
  v_add_u32 v1, 0x20000, v118
  v_and_b32_e64 v125, 15, v113
  buffer_load_dwordx4 a[8:11], v203, s[64:67], s40 offen
  v_lshlrev_b32 v125, 7, v125
  v_mul_u32_u24 v126, 0x18000, v146
  s_sub_u32 s32, s3, 64
  v_add3_u32 v248, v125, v126, s32
  v_mov_b32 v250, 0x3ef00000
  s_add_u32 s32, s14, 0x16000
  v_add_u32_e64 v253, s32, v118
  v_bfe_u32 v125, v122, 2, 2
  v_xor_b32_e64 v125, v125, v139
  v_lshl_add_u32 v125, v125, 4, s32
  v_mul_u32_u24 v126, 0xc0, v122
  v_add_u32 v251, v125, v126
  v_xor_b32 v252, 32, v251
  s_add_u32 s30, s15, 32
  s_add_u32 s31, s15, 0x4100
  s_mov_b32 s34, s59
  s_mov_b32 s28, 0x80000000
  s_add_u32 s33, s15, 0x8200
  buffer_load_dwordx4 a[12:15], v203, s[64:67], s40 offen offset:128
  buffer_load_dwordx4 a[16:19], v203, s[64:67], s41 offen
  buffer_load_dwordx4 a[20:23], v203, s[64:67], s41 offen offset:128
  s_waitcnt vmcnt(25)
  v_lshl_or_b32 v129, v129, 16, v129
  v_and_b32 v16, v56, v129
  v_and_b32 v17, v57, v129
  v_and_b32 v18, v58, v129
  v_and_b32 v19, v59, v129
  ds_write_b128 v142, v[16:19] offset:49920
  s_waitcnt vmcnt(24)
  v_lshl_or_b32 v130, v130, 16, v130
  v_and_b32 v20, v56, v130
  v_and_b32 v21, v57, v130
  v_and_b32 v22, v58, v130
  v_and_b32 v23, v59, v130
  ds_write_b128 v142, v[20:23] offset:53120
  s_waitcnt vmcnt(23)
  v_lshl_or_b32 v131, v131, 16, v131
  v_and_b32 v24, v56, v131
  v_and_b32 v25, v57, v131
  v_and_b32 v26, v58, v131
  v_and_b32 v27, v59, v131
  ds_write_b128 v142, v[24:27] offset:56320
  s_waitcnt vmcnt(22)
  v_lshl_or_b32 v132, v132, 16, v132
  v_and_b32 v28, v56, v132
  v_and_b32 v29, v57, v132
  v_and_b32 v30, v58, v132
  v_and_b32 v31, v59, v132
  ds_write_b128 v142, v[28:31] offset:59520
  s_waitcnt vmcnt(21)
  v_lshl_or_b32 v133, v133, 16, v133
  v_and_b32 v16, v56, v133
  v_and_b32 v17, v57, v133
  v_and_b32 v18, v58, v133
  v_and_b32_e64 v19, v59, v133
  ds_write_b128 v143, v[16:19] offset:62720
  s_waitcnt vmcnt(20)
  v_lshlrev_b32 v137, 16, v137
  s_waitcnt vmcnt(19)
  v_lshlrev_b32 v138, 16, v138
  v_mul_f32 v138, v137, v138
  s_waitcnt vmcnt(18)
  v_lshlrev_b32 v134, v141, v134
  s_waitcnt vmcnt(17)
  v_lshlrev_b32 v135, v141, v135
  s_waitcnt vmcnt(16)
  v_lshlrev_b32_e64 v136, v141, v136
  ds_write_b32 v144, v138 offset:64320
  s_waitcnt lgkmcnt(0)
  s_barrier
  ds_read_b128 a[96:99], v3
  ds_read_b128 a[100:103], v3 offset:4800
  ds_read_b128 a[104:107], v3 offset:9600
  ds_read_b128 a[108:111], v3 offset:400
  ds_read_b128 a[112:115], v3 offset:5200
  ds_read_b128 a[116:119], v3 offset:10000
  v_and_b32 v125, v160, v134
  v_and_b32 v126, v161, v134
  v_and_b32_e64 v127, v162, v134
  buffer_load_dwordx4 a[24:27], v203, s[64:67], s42 offen
  v_and_b32_e64 v140, v163, v134
  v_accvgpr_write_b32 a192, v125
  v_accvgpr_write_b32 a193, v126
  v_accvgpr_write_b32 a194, v127
  v_accvgpr_write_b32 a195, v140
  ds_read_b128 a[120:123], v3 offset:800
  ds_read_b128 a[124:127], v3 offset:5600
  ds_read_b128 a[128:131], v3 offset:10400
  ds_read_b128 a[132:135], v3 offset:1200
  ds_read_b128 a[136:139], v3 offset:6000
  ds_read_b128 a[140:143], v3 offset:10800
  buffer_load_dwordx4 a[28:31], v203, s[64:67], s42 offen offset:128
  s_add_u32 s42, s42, 0x1800
  v_and_b32 v125, v164, v134
  v_and_b32 v126, v165, v134
  v_and_b32 v127, v166, v134
  v_and_b32 v140, v167, v134
  v_accvgpr_write_b32 a196, v125
  v_accvgpr_write_b32 a197, v126
  v_accvgpr_write_b32 a198, v127
  v_accvgpr_write_b32 a199, v140
  ds_read_b128 a[144:147], v3 offset:1600
  ds_read_b128 a[148:151], v3 offset:6400
  buffer_load_dwordx4 a[32:35], v203, s[64:67], s42 offen
  ds_read_b128 a[152:155], v3 offset:11200
  ds_read_b128 a[156:159], v3 offset:2000
  ds_read_b128 a[160:163], v3 offset:6800
  ds_read_b128 a[164:167], v3 offset:11600
  v_and_b32 v125, v160, v135
  v_and_b32 v126, v161, v135
  v_and_b32 v127, v162, v135
  v_and_b32 v140, v163, v135
  v_accvgpr_write_b32 a200, v125
  v_accvgpr_write_b32 a201, v126
  v_accvgpr_write_b32 a202, v127
  buffer_load_dwordx4 a[36:39], v203, s[64:67], s42 offen offset:128
  s_add_u32 s42, s42, 0x1800
  v_accvgpr_write_b32 a203, v140
  ds_read_b128 a[240:243], v3 offset:2400
  ds_read_b128 a[244:247], v3 offset:7200
  ds_read_b128 a[248:251], v3 offset:12000
  ds_read_b128 a[168:171], v3 offset:2800
  ds_read_b128 a[172:175], v3 offset:7600
  ds_read_b128 a[176:179], v3 offset:12400
  v_and_b32 v125, v164, v135
  v_and_b32 v126, v165, v135
  v_and_b32 v127, v166, v135
  v_and_b32 v140, v167, v135
  buffer_load_dwordx4 a[40:43], v203, s[64:67], s42 offen
  v_accvgpr_write_b32 a204, v125
  v_accvgpr_write_b32 a205, v126
  v_accvgpr_write_b32 a206, v127
  v_accvgpr_write_b32 a207, v140
  ds_read_b128 a[252:255], v3 offset:3200
  ds_read_b128 a[180:183], v3 offset:8000
  ds_read_b128 a[184:187], v3 offset:12800
  ds_read_b128 a[188:191], v3 offset:3600
  ds_read_b128 a[216:219], v3 offset:8400
  ds_read_b128 a[220:223], v3 offset:13200
  buffer_load_dwordx4 a[44:47], v203, s[64:67], s42 offen offset:128
  s_add_u32 s42, s42, 0x1800
  v_and_b32 v125, v160, v136
  v_and_b32 v126, v161, v136
  v_and_b32 v127, v162, v136
  v_and_b32 v140, v163, v136
  v_accvgpr_write_b32 a208, v125
  v_accvgpr_write_b32 a209, v126
  v_accvgpr_write_b32 a210, v127
  v_accvgpr_write_b32 a211, v140
  ds_read_b128 a[224:227], v3 offset:4000
  ds_read_b128 a[228:231], v3 offset:8800
  ds_read_b128 a[232:235], v3 offset:13600
  buffer_load_dwordx4 a[48:51], v203, s[64:67], s42 offen
  ds_read_b128 a[236:239], v3 offset:4400
  ds_read_b128 v[208:211], v3 offset:9200
  ds_read_b128 v[212:215], v3 offset:14000
  v_and_b32 v125, v164, v136
  v_and_b32 v126, v165, v136
  v_and_b32 v127, v166, v136
  v_and_b32 v140, v167, v136
  v_accvgpr_write_b32 a212, v125
  v_accvgpr_write_b32 a213, v126
  v_accvgpr_write_b32 a214, v127
  buffer_load_dwordx4 a[52:55], v203, s[64:67], s42 offen offset:128
  s_add_u32 s42, s42, 0x1800
  v_accvgpr_write_b32 a215, v140
  s_waitcnt vmcnt(19)
  v_mfma_f32_32x32x16_bf16 v[16:31], a[72:75], v[184:187], 0
  buffer_load_dwordx4 a[56:59], v203, s[64:67], s42 offen
  s_waitcnt vmcnt(19)
  v_mfma_f32_32x32x16_bf16 v[16:31], a[76:79], v[188:191], v[16:31]
  s_waitcnt vmcnt(18)
  v_mfma_f32_32x32x16_bf16 v[32:47], a[80:83], v[184:187], 0
  buffer_load_dwordx4 a[60:63], v203, s[64:67], s42 offen offset:128
  s_add_u32 s42, s42, 0x1800
  s_waitcnt vmcnt(15)
  v_mfma_f32_32x32x16_bf16 v[48:63], a[0:3], v[240:243], v[16:31]
  buffer_load_dwordx4 a[64:67], v203, s[64:67], s42 offen
  v_mfma_f32_32x32x16_bf16 v[32:47], a[84:87], v[188:191], v[32:47]
  s_waitcnt vmcnt(15)
  v_mfma_f32_32x32x16_bf16 v[48:63], a[4:7], v[244:247], v[48:63]
  buffer_load_dwordx4 a[68:71], v203, s[64:67], s42 offen offset:128
  s_waitcnt vmcnt(15)
  v_mfma_f32_32x32x16_bf16 v[216:231], a[8:11], v[240:243], v[16:31]
  s_add_u32 m0, s15, 0x8200
  s_nop 0
  buffer_load_dwordx4 v6, s[4:7], s49 offen lds
  s_waitcnt vmcnt(15)
  v_mfma_f32_32x32x16_bf16 v[216:231], a[12:15], v[244:247], v[216:231]
  buffer_load_dwordx4 v7, s[4:7], s49 offen offset:1024 lds
  s_nop 2
  v_cvt_pk_bf16_f32 v64, v48, v52
  v_cvt_pk_bf16_f32 v65, v56, v60
  v_cvt_pk_bf16_f32 v68, v49, v53
  v_cvt_pk_bf16_f32 v69, v57, v61
  s_waitcnt vmcnt(15)
  v_mfma_f32_32x32x16_bf16 v[96:111], a[16:19], v[240:243], v[16:31]
  buffer_load_dwordx4 v8, s[4:7], s49 offen offset:2048 lds
  v_cvt_pk_bf16_f32 v72, v50, v54
  v_cvt_pk_bf16_f32 v73, v58, v62
  v_cvt_pk_bf16_f32 v76, v51, v55
  v_cvt_pk_bf16_f32 v77, v59, v63
  s_waitcnt vmcnt(15)
  v_mfma_f32_32x32x16_bf16 v[96:111], a[20:23], v[244:247], v[96:111]
  buffer_load_dwordx4 v9, s[4:7], s49 offen offset:3072 lds
  v_cvt_pk_bf16_f32 v66, v216, v220
  v_cvt_pk_bf16_f32 v67, v224, v228
  v_cvt_pk_bf16_f32 v70, v217, v221
  v_cvt_pk_bf16_f32 v71, v225, v229
  ds_write_b128 v195, v[64:67]
  s_waitcnt vmcnt(15)
  v_mfma_f32_32x32x16_bf16 v[48:63], a[24:27], v[240:243], v[32:47]
  s_add_u32 m0, s15, 0
  s_nop 0
  buffer_load_dwordx4 v198, s[4:7], 0 offen lds
  ds_write_b128 v195, v[68:71] offset:6144
  v_cvt_pk_bf16_f32 v74, v218, v222
  v_cvt_pk_bf16_f32 v75, v226, v230
  v_cvt_pk_bf16_f32 v78, v219, v223
  v_cvt_pk_bf16_f32 v79, v227, v231
  s_waitcnt vmcnt(15)
  v_mfma_f32_32x32x16_bf16 v[48:63], a[28:31], v[244:247], v[48:63]
  s_add_u32 m0, s15, 0x400
  s_nop 0
  buffer_load_dwordx4 v199, s[4:7], 0 offen lds
  ds_write_b128 v195, v[72:75] offset:12288
  v_cvt_pk_bf16_f32 v80, v96, v100
  v_cvt_pk_bf16_f32 v81, v104, v108
  v_cvt_pk_bf16_f32 v84, v97, v101
  v_cvt_pk_bf16_f32 v85, v105, v109
  s_waitcnt vmcnt(15)
  v_mfma_f32_32x32x16_bf16 v[216:231], a[32:35], v[240:243], v[32:47]
  s_add_u32 m0, s15, 0x800
  s_nop 0
  buffer_load_dwordx4 v200, s[4:7], 0 offen lds
  ds_write_b128 v195, v[76:79] offset:18432
  v_cvt_pk_bf16_f32 v88, v98, v102
  v_cvt_pk_bf16_f32 v89, v106, v110
  v_cvt_pk_bf16_f32 v92, v99, v103
  v_cvt_pk_bf16_f32 v93, v107, v111
  s_waitcnt vmcnt(15)
  v_mfma_f32_32x32x16_bf16 v[216:231], a[36:39], v[244:247], v[216:231]
  s_add_u32 m0, s15, 0xc00
  s_nop 0
  buffer_load_dwordx4 v201, s[4:7], 0 offen lds
  ds_write_b64 v196, v[80:81]
  ds_write_b64 v196, v[84:85] offset:6144
  v_cvt_pk_bf16_f32 v64, v48, v52
  v_cvt_pk_bf16_f32 v65, v56, v60
  v_cvt_pk_bf16_f32 v68, v49, v53
  v_cvt_pk_bf16_f32 v69, v57, v61
  s_waitcnt vmcnt(15)
  v_mfma_f32_32x32x16_bf16 v[96:111], a[40:43], v[240:243], v[32:47]
  s_add_u32 m0, s14, 0x22000
  s_nop 0
  buffer_load_dwordx4 v254, s[72:75], s57 offen lds
  ds_write_b64 v196, v[88:89] offset:12288
  ds_write_b64 v196, v[92:93] offset:18432
  v_cvt_pk_bf16_f32 v72, v50, v54
  v_cvt_pk_bf16_f32 v73, v58, v62
  v_cvt_pk_bf16_f32 v76, v51, v55
  v_cvt_pk_bf16_f32 v77, v59, v63
  s_waitcnt vmcnt(15)
  v_mfma_f32_32x32x16_bf16 v[96:111], a[44:47], v[244:247], v[96:111]
  buffer_load_dwordx4 v255, s[72:75], s57 offen offset:1024 lds
  v_cvt_pk_bf16_f32 v66, v216, v220
  v_cvt_pk_bf16_f32 v67, v224, v228
  v_cvt_pk_bf16_f32 v70, v217, v221
  v_cvt_pk_bf16_f32 v71, v225, v229
  ds_write_b128 v197, v[64:67]
  s_waitcnt vmcnt(15)
  v_mfma_f32_32x32x16_bf16 v[48:63], a[48:51], v[240:243], v[32:47]
  buffer_load_dwordx4 v194, s[72:75], s57 offen offset:2048 lds
  ds_write_b128 v197, v[68:71] offset:6144
  v_cvt_pk_bf16_f32 v74, v218, v222
  v_cvt_pk_bf16_f32 v75, v226, v230
  v_cvt_pk_bf16_f32 v78, v219, v223
  v_cvt_pk_bf16_f32 v79, v227, v231
  s_waitcnt vmcnt(15)
  v_mfma_f32_32x32x16_bf16 v[48:63], a[52:55], v[244:247], v[48:63]
  s_add_u32 m0, s14, 0x22c00
  s_nop 0
  buffer_load_dwordx4 v254, s[72:75], s58 offen lds
  ds_write_b128 v197, v[72:75] offset:12288
  v_cvt_pk_bf16_f32 v80, v96, v100
  v_cvt_pk_bf16_f32 v81, v104, v108
  v_cvt_pk_bf16_f32 v84, v97, v101
  v_cvt_pk_bf16_f32 v85, v105, v109
  s_nop 0
  s_waitcnt vmcnt(15)
  v_mfma_f32_32x32x16_bf16 v[216:231], a[56:59], v[240:243], v[32:47]
  buffer_load_dwordx4 v255, s[72:75], s58 offen offset:1024 lds
  ds_write_b128 v197, v[76:79] offset:18432
  v_cvt_pk_bf16_f32 v88, v98, v102
  v_cvt_pk_bf16_f32 v89, v106, v110
  v_cvt_pk_bf16_f32 v92, v99, v103
  v_cvt_pk_bf16_f32 v93, v107, v111
  v_mfma_f32_32x32x16_bf16 v[96:111], a[88:91], v[240:243], v[32:47]
  s_nop 0
  s_waitcnt vmcnt(15)
  v_mfma_f32_32x32x16_bf16 v[216:231], a[60:63], v[244:247], v[216:231]
  buffer_load_dwordx4 v194, s[72:75], s58 offen offset:2048 lds
  v_cvt_pk_bf16_f32 v82, v48, v52
  v_cvt_pk_bf16_f32 v83, v56, v60
  v_cvt_pk_bf16_f32 v86, v49, v53
  v_cvt_pk_bf16_f32 v87, v57, v61
  ds_write_b128 v197, v[80:83] offset:1024
  v_mfma_f32_32x32x16_bf16 v[96:111], a[92:95], v[244:247], v[96:111]
  s_waitcnt vmcnt(15)
  v_mfma_f32_32x32x16_bf16 v[96:111], a[64:67], v[240:243], v[96:111]
  ds_write_b128 v197, v[84:87] offset:7168
  v_cvt_pk_bf16_f32 v90, v50, v54
  v_cvt_pk_bf16_f32 v91, v58, v62
  v_cvt_pk_bf16_f32 v94, v51, v55
  v_cvt_pk_bf16_f32 v95, v59, v63
  s_waitcnt vmcnt(14)
  v_mfma_f32_32x32x16_bf16 v[96:111], a[68:71], v[244:247], v[96:111]
  ds_write_b128 v197, v[88:91] offset:13312
  v_cvt_pk_bf16_f32 v64, v216, v220
  v_cvt_pk_bf16_f32 v65, v224, v228
  v_cvt_pk_bf16_f32 v68, v217, v221
  v_cvt_pk_bf16_f32 v69, v225, v229
  ds_write_b128 v197, v[92:95] offset:19456
  v_cvt_pk_bf16_f32 v72, v218, v222
  v_cvt_pk_bf16_f32 v73, v226, v230
  v_cvt_pk_bf16_f32 v76, v219, v223
  v_cvt_pk_bf16_f32 v77, v227, v231
  s_nop 0
  s_nop 1
  v_cvt_pk_bf16_f32 v66, v96, v100
  v_cvt_pk_bf16_f32 v67, v104, v108
  v_cvt_pk_bf16_f32 v70, v97, v101
  v_cvt_pk_bf16_f32 v71, v105, v109
  ds_write_b128 v197, v[64:67] offset:2048
  ds_write_b128 v197, v[68:71] offset:8192
  v_cvt_pk_bf16_f32 v74, v98, v102
  v_cvt_pk_bf16_f32 v75, v106, v110
  v_cvt_pk_bf16_f32 v78, v99, v103
  v_cvt_pk_bf16_f32 v79, v107, v111
  ds_write_b128 v197, v[72:75] offset:14336
  ds_write_b128 v197, v[76:79] offset:20480
  s_waitcnt lgkmcnt(0)
  s_barrier
  ds_read_b128 a[0:3], v0 offset:24576
  ds_read_b128 a[4:7], v0 offset:25600
  ds_read_b128 a[8:11], v0 offset:26624
  ds_read_b128 a[12:15], v0 offset:27648
  ds_read_b128 a[16:19], v0 offset:28672
  ds_read_b128 a[20:23], v0 offset:29696
  ds_read_b128 a[24:27], v0 offset:30720
  ds_read_b128 a[28:31], v0 offset:31744
  ds_read_b128 a[32:35], v0 offset:32768
  ds_read_b128 a[36:39], v0 offset:33792
  ds_read_b128 a[40:43], v0 offset:34816
  ds_read_b128 a[44:47], v0 offset:35840
  ds_read_b128 a[48:51], v0 offset:36864
  ds_read_b128 a[52:55], v0 offset:37888
  ds_read_b128 a[56:59], v0 offset:38912
  ds_read_b128 a[60:63], v0 offset:39936
  ds_read_b128 a[64:67], v0 offset:40960
  ds_read_b128 a[68:71], v0 offset:41984
  ds_read_b128 a[72:75], v0 offset:43008
  ds_read_b128 a[76:79], v0 offset:44032
  ds_read_b128 a[80:83], v0 offset:45056
  ds_read_b128 a[84:87], v0 offset:46080
  ds_read_b128 a[88:91], v0 offset:47104
  ds_read_b128 a[92:95], v0 offset:48128
  s_nop 0
  s_waitcnt vmcnt(6)
  ds_read_b128 v[216:219], v4
  ds_read_b128 v[220:223], v4 offset:16
  ds_read_b128 v[224:227], v4 offset:192
  ds_read_b128 v[228:231], v4 offset:208
  ds_read_b128 v[232:235], v4 offset:384
  ds_read_b128 v[236:239], v4 offset:400
  ds_read_b128 v[160:163], v4 offset:32
  ds_read_b128 v[164:167], v4 offset:48
  ds_read_b128 v[168:171], v4 offset:224
  ds_read_b128 v[172:175], v4 offset:240
  ds_read_b128 v[176:179], v4 offset:416
  s_waitcnt lgkmcnt(10)
  v_mfma_f32_16x16x32_bf16 v[112:115], a[96:99], v[216:219], 0
  s_waitcnt lgkmcnt(9)
  ds_read_b128 v[180:183], v4 offset:432
  v_mfma_f32_16x16x32_bf16 v[116:119], a[108:111], v[220:223], 0
  s_waitcnt lgkmcnt(9)
  ds_read_b128 v[216:219], v4 offset:64
  v_mfma_f32_16x16x32_bf16 v[112:115], a[100:103], v[224:227], v[112:115]
  s_waitcnt lgkmcnt(9)
  ds_read_b128 v[220:223], v4 offset:80
  v_mfma_f32_16x16x32_bf16 v[116:119], a[112:115], v[228:231], v[116:119]
  s_waitcnt lgkmcnt(9)
  ds_read_b128 v[224:227], v4 offset:256
  v_mfma_f32_16x16x32_bf16 v[112:115], a[104:107], v[232:235], v[112:115]
  s_waitcnt lgkmcnt(9)
  ds_read_b128 v[228:231], v4 offset:272
  v_mfma_f32_16x16x32_bf16 v[116:119], a[116:119], v[236:239], v[116:119]
  s_waitcnt lgkmcnt(9)
  ds_read_b128 v[232:235], v4 offset:448
  v_mfma_f32_16x16x32_bf16 v[120:123], a[120:123], v[160:163], 0
  s_waitcnt lgkmcnt(9)
  ds_read_b128 v[236:239], v4 offset:464
  v_mfma_f32_16x16x32_bf16 v[124:127], a[132:135], v[164:167], 0
  s_waitcnt lgkmcnt(9)
  ds_read_b128 v[160:163], v4 offset:96
  v_mfma_f32_16x16x32_bf16 v[120:123], a[124:127], v[168:171], v[120:123]
  s_waitcnt lgkmcnt(9)
  ds_read_b128 v[164:167], v4 offset:112
  v_mfma_f32_16x16x32_bf16 v[124:127], a[136:139], v[172:175], v[124:127]
  s_waitcnt lgkmcnt(9)
  ds_read_b128 v[168:171], v4 offset:288
  v_mfma_f32_16x16x32_bf16 v[120:123], a[128:131], v[176:179], v[120:123]
  s_waitcnt lgkmcnt(9)
  ds_read_b128 v[172:175], v4 offset:304
  v_mfma_f32_16x16x32_bf16 v[124:127], a[140:143], v[180:183], v[124:127]
  s_waitcnt lgkmcnt(9)
  ds_read_b128 v[176:179], v4 offset:480
  v_mfma_f32_16x16x32_bf16 v[128:131], a[144:147], v[216:219], 0
  s_waitcnt lgkmcnt(9)
  ds_read_b128 v[180:183], v4 offset:496
  v_mfma_f32_16x16x32_bf16 v[132:135], a[156:159], v[220:223], 0
  s_waitcnt lgkmcnt(9)
  ds_read_b128 v[216:219], v4 offset:128
  v_mfma_f32_16x16x32_bf16 v[128:131], a[148:151], v[224:227], v[128:131]
  s_waitcnt lgkmcnt(9)
  ds_read_b128 v[220:223], v4 offset:144
  v_mfma_f32_16x16x32_bf16 v[132:135], a[160:163], v[228:231], v[132:135]
  s_waitcnt lgkmcnt(9)
  ds_read_b128 v[224:227], v4 offset:320
  v_mfma_f32_16x16x32_bf16 v[128:131], a[152:155], v[232:235], v[128:131]
  s_waitcnt lgkmcnt(9)
  ds_read_b128 v[228:231], v4 offset:336
  v_mfma_f32_16x16x32_bf16 v[132:135], a[164:167], v[236:239], v[132:135]
  s_waitcnt lgkmcnt(9)
  ds_read_b128 v[232:235], v4 offset:512
  v_mfma_f32_16x16x32_bf16 v[136:139], a[240:243], v[160:163], 0
  s_waitcnt lgkmcnt(9)
  ds_read_b128 v[236:239], v4 offset:528
  v_mfma_f32_16x16x32_bf16 v[140:143], a[168:171], v[164:167], 0
  s_waitcnt lgkmcnt(9)
  ds_read_b128 v[160:163], v4 offset:160
  v_mfma_f32_16x16x32_bf16 v[136:139], a[244:247], v[168:171], v[136:139]
  s_waitcnt lgkmcnt(9)
  ds_read_b128 v[164:167], v4 offset:176
  v_mfma_f32_16x16x32_bf16 v[140:143], a[172:175], v[172:175], v[140:143]
  s_waitcnt lgkmcnt(9)
  ds_read_b128 v[168:171], v4 offset:352
  v_mfma_f32_16x16x32_bf16 v[136:139], a[248:251], v[176:179], v[136:139]
  s_waitcnt lgkmcnt(9)
  ds_read_b128 v[172:175], v4 offset:368
  v_mfma_f32_16x16x32_bf16 v[140:143], a[176:179], v[180:183], v[140:143]
  s_waitcnt lgkmcnt(9)
  ds_read_b128 v[176:179], v4 offset:544
  v_mfma_f32_16x16x32_bf16 v[144:147], a[252:255], v[216:219], 0
  s_waitcnt lgkmcnt(9)
  ds_read_b128 v[180:183], v4 offset:560
  v_mfma_f32_16x16x32_bf16 v[148:151], a[188:191], v[220:223], 0
  s_waitcnt lgkmcnt(9)
  v_mfma_f32_16x16x32_bf16 v[144:147], a[180:183], v[224:227], v[144:147]
  s_waitcnt lgkmcnt(8)
  v_mfma_f32_16x16x32_bf16 v[148:151], a[216:219], v[228:231], v[148:151]
  s_waitcnt lgkmcnt(7)
  v_mfma_f32_16x16x32_bf16 v[144:147], a[184:187], v[232:235], v[144:147]
  s_waitcnt lgkmcnt(6)
  v_mfma_f32_16x16x32_bf16 v[148:151], a[220:223], v[236:239], v[148:151]
  s_waitcnt lgkmcnt(5)
  v_mfma_f32_16x16x32_bf16 v[152:155], a[224:227], v[160:163], 0
  s_waitcnt lgkmcnt(4)
  v_mfma_f32_16x16x32_bf16 v[156:159], a[236:239], v[164:167], 0
  s_waitcnt lgkmcnt(3)
  v_mfma_f32_16x16x32_bf16 v[152:155], a[228:231], v[168:171], v[152:155]
  s_waitcnt lgkmcnt(2)
  v_mfma_f32_16x16x32_bf16 v[156:159], v[208:211], v[172:175], v[156:159]
  s_waitcnt lgkmcnt(1)
  v_mfma_f32_16x16x32_bf16 v[152:155], a[232:235], v[176:179], v[152:155]
  s_waitcnt lgkmcnt(0)
  v_mfma_f32_16x16x32_bf16 v[156:159], v[212:215], v[180:183], v[156:159]
  buffer_load_dword v249, v248, s[4:7], s29 offen
  v_pk_add_f32 v[12:13], v[112:113], v[114:115]
  v_pk_mul_f32 v[14:15], v[112:113], v[112:113]
  v_pk_fma_f32 v[14:15], v[114:115], v[114:115], v[14:15]
  v_pk_add_f32 v[12:13], v[12:13], v[116:117]
  v_pk_fma_f32 v[14:15], v[116:117], v[116:117], v[14:15]
  v_pk_add_f32 v[12:13], v[12:13], v[118:119]
  v_pk_fma_f32 v[14:15], v[118:119], v[118:119], v[14:15]
  v_pk_add_f32 v[12:13], v[12:13], v[120:121]
  v_pk_fma_f32 v[14:15], v[120:121], v[120:121], v[14:15]
  v_pk_add_f32 v[12:13], v[12:13], v[122:123]
  v_pk_fma_f32 v[14:15], v[122:123], v[122:123], v[14:15]
  v_pk_add_f32 v[12:13], v[12:13], v[124:125]
  ds_read_b128 v[216:219], v0 offset:18432
  ds_read_b128 v[220:223], v0 offset:19456
  ds_read_b128 v[224:227], v0 offset:20480
  ds_read_b128 v[228:231], v0 offset:21504
  v_pk_fma_f32 v[14:15], v[124:125], v[124:125], v[14:15]
  v_pk_add_f32 v[12:13], v[12:13], v[126:127]
  v_pk_fma_f32 v[14:15], v[126:127], v[126:127], v[14:15]
  v_pk_add_f32 v[12:13], v[12:13], v[128:129]
  v_pk_fma_f32 v[14:15], v[128:129], v[128:129], v[14:15]
  v_pk_add_f32 v[12:13], v[12:13], v[130:131]
  v_pk_fma_f32 v[14:15], v[130:131], v[130:131], v[14:15]
  v_pk_add_f32 v[12:13], v[12:13], v[132:133]
  v_pk_fma_f32 v[14:15], v[132:133], v[132:133], v[14:15]
  v_pk_add_f32 v[12:13], v[12:13], v[134:135]
  v_pk_fma_f32 v[14:15], v[134:135], v[134:135], v[14:15]
  v_pk_add_f32 v[12:13], v[12:13], v[136:137]
  ds_read_b128 v[232:235], v0 offset:22528
  ds_read_b128 v[236:239], v0 offset:23552
  ds_read_b128 a[96:99], v0 offset:49152
  ds_read_b128 a[100:103], v0 offset:50176
  v_pk_fma_f32 v[14:15], v[136:137], v[136:137], v[14:15]
  v_pk_add_f32 v[12:13], v[12:13], v[138:139]
  v_pk_fma_f32 v[14:15], v[138:139], v[138:139], v[14:15]
  v_pk_add_f32 v[12:13], v[12:13], v[140:141]
  v_pk_fma_f32 v[14:15], v[140:141], v[140:141], v[14:15]
  v_pk_add_f32 v[12:13], v[12:13], v[142:143]
  v_pk_fma_f32 v[14:15], v[142:143], v[142:143], v[14:15]
  v_pk_add_f32 v[12:13], v[12:13], v[144:145]
  v_pk_fma_f32 v[14:15], v[144:145], v[144:145], v[14:15]
  v_pk_add_f32 v[12:13], v[12:13], v[146:147]
  v_pk_fma_f32 v[14:15], v[146:147], v[146:147], v[14:15]
  v_pk_add_f32 v[12:13], v[12:13], v[148:149]
  ds_read_b128 a[104:107], v0 offset:51200
  ds_read_b128 a[108:111], v0 offset:52224
  ds_read_b128 a[112:115], v0 offset:53248
  ds_read_b128 a[116:119], v0 offset:54272
  v_pk_fma_f32 v[14:15], v[148:149], v[148:149], v[14:15]
  v_pk_add_f32 v[12:13], v[12:13], v[150:151]
  v_pk_fma_f32 v[14:15], v[150:151], v[150:151], v[14:15]
  v_pk_add_f32 v[12:13], v[12:13], v[152:153]
  v_pk_fma_f32 v[14:15], v[152:153], v[152:153], v[14:15]
  v_pk_add_f32 v[12:13], v[12:13], v[154:155]
  v_pk_fma_f32 v[14:15], v[154:155], v[154:155], v[14:15]
  v_pk_add_f32 v[12:13], v[12:13], v[156:157]
  v_pk_fma_f32 v[14:15], v[156:157], v[156:157], v[14:15]
  v_pk_add_f32 v[12:13], v[12:13], v[158:159]
  v_pk_fma_f32 v[14:15], v[158:159], v[158:159], v[14:15]
  v_add_f32_e64 v12, v12, v13
  ds_read_b128 a[120:123], v0 offset:55296
  ds_read_b128 a[124:127], v0 offset:56320
  ds_read_b128 a[128:131], v0 offset:57344
  ds_read_b128 a[132:135], v0 offset:58368
  v_add_f32 v14, v14, v15
  s_nop 1
  v_permlane32_swap_b32 v12, v14
  v_add_f32 v12, v12, v14
  v_mov_b32 v14, v12
  s_nop 1
  v_permlane32_swap_b32 v12, v14
  v_mul_f32 v12, s24, v12
  v_mul_f32_e64 v13, s24, v14
  v_fma_f32 v13, -v12, v12, v13
  v_max_f32 v13, 0, v13
  v_add_f32 v13, s25, v13
  v_rsq_f32 v13, v13
  s_nop 0
  v_mul_f32_e64 v14, s22, v13
  ds_read_b128 a[136:139], v0 offset:59392
  ds_read_b128 a[140:143], v0 offset:60416
  ds_read_b128 a[144:147], v0 offset:61440
  ds_read_b128 a[148:151], v0 offset:62464
  v_mul_f32_e64 v12, -v12, v14
  v_pk_fma_f32 v[112:113], v[112:113], v[14:15], v[12:13] op_sel_hi:[1,0,0]
  v_pk_fma_f32 v[114:115], v[114:115], v[14:15], v[12:13] op_sel_hi:[1,0,0]
  v_pk_fma_f32 v[116:117], v[116:117], v[14:15], v[12:13] op_sel_hi:[1,0,0]
  v_pk_fma_f32 v[118:119], v[118:119], v[14:15], v[12:13] op_sel_hi:[1,0,0]
  v_pk_fma_f32 v[120:121], v[120:121], v[14:15], v[12:13] op_sel_hi:[1,0,0]
  v_pk_fma_f32 v[122:123], v[122:123], v[14:15], v[12:13] op_sel_hi:[1,0,0]
  v_pk_fma_f32 v[124:125], v[124:125], v[14:15], v[12:13] op_sel_hi:[1,0,0]
  v_pk_fma_f32 v[126:127], v[126:127], v[14:15], v[12:13] op_sel_hi:[1,0,0]
  v_pk_fma_f32 v[128:129], v[128:129], v[14:15], v[12:13] op_sel_hi:[1,0,0]
  v_pk_fma_f32 v[130:131], v[130:131], v[14:15], v[12:13] op_sel_hi:[1,0,0]
  v_pk_fma_f32 v[132:133], v[132:133], v[14:15], v[12:13] op_sel_hi:[1,0,0]
  ds_read_b128 a[152:155], v0 offset:63488
  ds_read_b128 a[156:159], v0 offset:64512
  ds_read_b128 a[160:163], v1
  ds_read_b128 a[164:167], v1 offset:1024
  v_pk_fma_f32 v[134:135], v[134:135], v[14:15], v[12:13] op_sel_hi:[1,0,0]
  v_pk_fma_f32 v[136:137], v[136:137], v[14:15], v[12:13] op_sel_hi:[1,0,0]
  v_pk_fma_f32 v[138:139], v[138:139], v[14:15], v[12:13] op_sel_hi:[1,0,0]
  v_pk_fma_f32 v[140:141], v[140:141], v[14:15], v[12:13] op_sel_hi:[1,0,0]
  v_pk_fma_f32 v[142:143], v[142:143], v[14:15], v[12:13] op_sel_hi:[1,0,0]
  v_pk_fma_f32 v[144:145], v[144:145], v[14:15], v[12:13] op_sel_hi:[1,0,0]
  v_pk_fma_f32 v[146:147], v[146:147], v[14:15], v[12:13] op_sel_hi:[1,0,0]
  v_pk_fma_f32 v[148:149], v[148:149], v[14:15], v[12:13] op_sel_hi:[1,0,0]
  v_pk_fma_f32 v[150:151], v[150:151], v[14:15], v[12:13] op_sel_hi:[1,0,0]
  v_pk_fma_f32 v[152:153], v[152:153], v[14:15], v[12:13] op_sel_hi:[1,0,0]
  v_pk_fma_f32 v[154:155], v[154:155], v[14:15], v[12:13] op_sel_hi:[1,0,0]
  v_pk_fma_f32 v[156:157], v[156:157], v[14:15], v[12:13] op_sel_hi:[1,0,0]
  ds_read_b128 a[168:171], v1 offset:2048
  ds_read_b128 a[172:175], v1 offset:3072
  ds_read_b128 a[176:179], v1 offset:4096
  ds_read_b128 a[180:183], v1 offset:5120
  v_pk_fma_f32 v[158:159], v[158:159], v[14:15], v[12:13] op_sel_hi:[1,0,0]
  v_cndmask_b32 v159, v159, v250, s[12:13]
  v_cvt_pk_bf16_f32 v160, v112, v113
  v_cvt_pk_bf16_f32 v161, v114, v115
  v_cvt_pk_bf16_f32 v162, v116, v117
  v_cvt_pk_bf16_f32 v163, v118, v119
  v_cvt_pk_bf16_f32 v164, v120, v121
  v_cvt_pk_bf16_f32 v165, v122, v123
  v_cvt_pk_bf16_f32 v166, v124, v125
  v_cvt_pk_bf16_f32 v167, v126, v127
  v_cvt_pk_bf16_f32 v168, v128, v129
  v_cvt_pk_bf16_f32 v169, v130, v131
  ds_read_b128 a[184:187], v1 offset:6144
  ds_read_b128 a[188:191], v1 offset:7168
  v_cvt_pk_bf16_f32 v170, v132, v133
  v_cvt_pk_bf16_f32 v171, v134, v135
  v_cvt_pk_bf16_f32 v172, v136, v137
  v_cvt_pk_bf16_f32 v173, v138, v139
  v_cvt_pk_bf16_f32 v174, v140, v141
  v_cvt_pk_bf16_f32 v175, v142, v143
  v_cvt_pk_bf16_f32 v176, v144, v145
  v_cvt_pk_bf16_f32 v177, v146, v147
  v_cvt_pk_bf16_f32 v178, v148, v149
  v_cvt_pk_bf16_f32 v179, v150, v151
  v_cvt_pk_bf16_f32 v180, v152, v153
  v_cvt_pk_bf16_f32 v181, v154, v155
  v_cvt_pk_bf16_f32 v182, v156, v157
  v_cvt_pk_bf16_f32 v183, v158, v159
  s_nop 0
  s_waitcnt lgkmcnt(15)
  v_mfma_f32_32x32x16_bf16 v[16:31], v[216:219], v[160:163], 0
  ds_read_b128 v[136:139], v5
  ds_read_b128 v[140:143], v5 offset:32
  ds_read_b128 v[144:147], v5 offset:64
  v_mfma_f32_32x32x16_bf16 v[16:31], v[220:223], v[164:167], v[16:31]
  ds_read_b128 v[148:151], v5 offset:96
  ds_read_b128 v[152:155], v5 offset:128
  ds_read_b128 v[156:159], v5 offset:160
  v_mfma_f32_32x32x16_bf16 v[16:31], v[224:227], v[168:171], v[16:31]
  s_nop 0
  s_waitcnt vmcnt(1)
  ds_read_b128 a[216:219], v251 offset:49152
  ds_read_b128 a[220:223], v252 offset:49152
  v_mfma_f32_32x32x16_bf16 v[16:31], v[228:231], v[172:175], v[16:31]
  ds_read_b128 a[224:227], v251 offset:49216
  ds_read_b128 a[228:231], v252 offset:49216
  ds_read_b128 a[232:235], v251 offset:49280
  v_mfma_f32_32x32x16_bf16 v[16:31], v[232:235], v[176:179], v[16:31]
  ds_read_b128 a[236:239], v252 offset:49280
  v_mfma_f32_32x32x16_bf16 v[16:31], v[236:239], v[180:183], v[16:31]
  s_nop 0
  s_nop 11
  v_pk_fma_f32 v[48:49], v[16:17], v[16:17], s[20:21] neg_lo:[1,0,1] neg_hi:[1,0,1]
  v_pk_fma_f32 v[50:51], v[18:19], v[18:19], s[20:21] neg_lo:[1,0,1] neg_hi:[1,0,1]
  v_pk_fma_f32 v[52:53], v[20:21], v[20:21], s[20:21] neg_lo:[1,0,1] neg_hi:[1,0,1]
  v_pk_fma_f32 v[54:55], v[22:23], v[22:23], s[20:21] neg_lo:[1,0,1] neg_hi:[1,0,1]
  v_pk_fma_f32 v[56:57], v[24:25], v[24:25], s[20:21] neg_lo:[1,0,1] neg_hi:[1,0,1]
  v_pk_fma_f32 v[58:59], v[26:27], v[26:27], s[20:21] neg_lo:[1,0,1] neg_hi:[1,0,1]
  v_pk_fma_f32 v[60:61], v[28:29], v[28:29], s[20:21] neg_lo:[1,0,1] neg_hi:[1,0,1]
  v_pk_fma_f32 v[62:63], v[30:31], v[30:31], s[20:21] neg_lo:[1,0,1] neg_hi:[1,0,1]
  v_pk_mul_f32 v[48:49], v[16:17], v[48:49]
  v_pk_mul_f32 v[50:51], v[18:19], v[50:51]
  v_pk_mul_f32 v[52:53], v[20:21], v[52:53]
  v_pk_mul_f32 v[54:55], v[22:23], v[54:55]
  v_pk_mul_f32 v[56:57], v[24:25], v[56:57]
  v_pk_mul_f32 v[58:59], v[26:27], v[58:59]
  v_pk_mul_f32 v[60:61], v[28:29], v[60:61]
  v_pk_mul_f32 v[62:63], v[30:31], v[62:63]
  s_waitcnt lgkmcnt(5)
  v_mfma_f32_32x32x16_bf16 v[64:79], a[216:219], a[192:195], 0
  s_mov_b32 m0, s30
  v_exp_f32 v48, v48
  v_exp_f32 v49, v49
  v_exp_f32 v50, v50
  v_exp_f32 v51, v51
  v_exp_f32 v52, v52
  s_waitcnt lgkmcnt(4)
  v_mfma_f32_32x32x16_bf16 v[64:79], a[220:223], a[196:199], v[64:79]
  buffer_load_dwordx4 v6, s[4:7], s29 offen lds
  v_exp_f32 v53, v53
  s_waitcnt lgkmcnt(3)
  v_mfma_f32_32x32x16_bf16 v[80:95], a[224:227], a[200:203], 0
  buffer_load_dwordx4 v7, s[4:7], s29 offen offset:1024 lds
  s_waitcnt lgkmcnt(2)
  v_mfma_f32_32x32x16_bf16 v[80:95], a[228:231], a[204:207], v[80:95]
  buffer_load_dwordx4 v8, s[4:7], s29 offen offset:2048 lds
  s_nop 3
  v_cvt_pk_bf16_f32 v64, v64, v65
  v_cvt_pk_bf16_f32 v65, v66, v67
  v_cvt_pk_bf16_f32 v66, v68, v69
  v_cvt_pk_bf16_f32 v67, v70, v71
  ds_write_b128 v253, v[64:67] offset:49152
  v_exp_f32 v54, v54
  v_exp_f32 v55, v55
  v_cvt_pk_bf16_f32 v68, v72, v73
  v_cvt_pk_bf16_f32 v69, v74, v75
  v_cvt_pk_bf16_f32 v70, v76, v77
  s_waitcnt lgkmcnt(2)
  v_mfma_f32_32x32x16_bf16 v[96:111], a[232:235], a[208:211], 0
  buffer_load_dwordx4 v9, s[4:7], s29 offen offset:3072 lds
  v_cvt_pk_bf16_f32 v71, v78, v79
  v_exp_f32 v56, v56
  v_exp_f32 v57, v57
  ds_write_b128 v253, v[68:71] offset:52224
  s_waitcnt lgkmcnt(2)
  v_mfma_f32_32x32x16_bf16 v[96:111], a[236:239], a[212:215], v[96:111]
  v_cvt_pk_bf16_f32 v80, v80, v81
  v_cvt_pk_bf16_f32 v81, v82, v83
  v_cvt_pk_bf16_f32 v82, v84, v85
  v_cvt_pk_bf16_f32 v83, v86, v87
  v_exp_f32 v58, v58
  v_exp_f32 v59, v59
  ds_write_b128 v253, v[80:83] offset:50176
  v_cvt_pk_bf16_f32 v84, v88, v89
  v_cvt_pk_bf16_f32 v85, v90, v91
  v_cvt_pk_bf16_f32 v86, v92, v93
  v_cvt_pk_bf16_f32 v87, v94, v95
  v_exp_f32 v60, v60
  v_exp_f32 v61, v61
  ds_write_b128 v253, v[84:87] offset:53248
  v_cvt_pk_bf16_f32 v96, v96, v97
  v_cvt_pk_bf16_f32 v97, v98, v99
  v_cvt_pk_bf16_f32 v98, v100, v101
  v_cvt_pk_bf16_f32 v99, v102, v103
  v_exp_f32 v62, v62
  v_exp_f32 v63, v63
  v_cvt_pk_bf16_f32 v100, v104, v105
  v_cvt_pk_bf16_f32 v101, v106, v107
  v_cvt_pk_bf16_f32 v102, v108, v109
  v_cvt_pk_bf16_f32 v103, v110, v111
  ds_write_b128 v253, v[96:99] offset:51200
  v_pk_fma_f32 v[48:49], v[48:49], s[22:23], s[22:23]
  v_pk_fma_f32 v[50:51], v[50:51], s[22:23], s[22:23]
  v_pk_fma_f32 v[52:53], v[52:53], s[22:23], s[22:23]
  v_pk_fma_f32 v[54:55], v[54:55], s[22:23], s[22:23]
  v_pk_fma_f32 v[56:57], v[56:57], s[22:23], s[22:23]
  v_pk_fma_f32 v[58:59], v[58:59], s[22:23], s[22:23]
  v_pk_fma_f32 v[60:61], v[60:61], s[22:23], s[22:23]
  v_pk_fma_f32 v[62:63], v[62:63], s[22:23], s[22:23]
  ds_write_b128 v253, v[100:103] offset:54272
  s_waitcnt lgkmcnt(0)
  s_barrier
  v_mfma_f32_32x32x16_bf16 v[32:47], a[0:3], v[160:163], 0
  ds_read_b128 v[64:67], v2
  ds_read_b128 v[68:71], v2 offset:32
  ds_read_b128 v[72:75], v2 offset:64
  s_add_u32 m0, s14, 0x16000
  v_rcp_f32_e64 v48, v48
  v_mfma_f32_32x32x16_bf16 v[32:47], a[4:7], v[164:167], v[32:47]
  ds_read_b128 v[76:79], v2 offset:96
  ds_read_b128 v[80:83], v2 offset:128
  ds_read_b128 v[84:87], v2 offset:160
  buffer_load_dwordx4 v254, s[72:75], s53 offen lds
  v_rcp_f32_e64 v49, v49
  v_mfma_f32_32x32x16_bf16 v[32:47], a[8:11], v[168:171], v[32:47]
  ds_read_b128 v[88:91], v2 offset:192
  ds_read_b128 v[92:95], v2 offset:224
  ds_read_b128 v[96:99], v2 offset:256
  buffer_load_dwordx4 v255, s[72:75], s53 offen offset:1024 lds
  v_rcp_f32_e64 v50, v50
  v_mfma_f32_32x32x16_bf16 v[32:47], a[12:15], v[172:175], v[32:47]
  ds_read_b128 v[100:103], v2 offset:288
  ds_read_b128 v[104:107], v2 offset:320
  ds_read_b128 v[108:111], v2 offset:352
  v_rcp_f32_e64 v51, v51
  v_mfma_f32_32x32x16_bf16 v[32:47], a[16:19], v[176:179], v[32:47]
  buffer_load_dwordx4 v194, s[72:75], s53 offen offset:2048 lds
  s_add_u32 m0, s14, 0x16c00
  v_rcp_f32 v52, v52
  v_rcp_f32 v53, v53
  v_mfma_f32_32x32x16_bf16 v[32:47], a[20:23], v[180:183], v[32:47]
  s_waitcnt lgkmcnt(0)
  buffer_load_dwordx4 v254, s[72:75], s54 offen lds
  v_rcp_f32 v54, v54
  v_rcp_f32_e64 v55, v55
  v_mfma_f32_32x32x16_bf16 v[64:79], v[240:243], v[136:139], v[64:79]
  v_mov_b32 v112, v194
  v_rcp_f32 v56, v56
  v_rcp_f32_e64 v57, v57
  v_mfma_f32_32x32x16_bf16 v[64:79], v[244:247], v[140:143], v[64:79]
  buffer_load_dwordx4 v255, s[72:75], s54 offen offset:1024 lds
  v_rcp_f32 v58, v58
  v_rcp_f32 v59, v59
  v_mfma_f32_32x32x16_bf16 v[80:95], v[240:243], v[144:147], v[80:95]
  buffer_load_dwordx4 v194, s[72:75], s54 offen offset:2048 lds
  v_rcp_f32 v60, v60
  v_rcp_f32 v61, v61
  v_mfma_f32_32x32x16_bf16 v[80:95], v[244:247], v[148:151], v[80:95]
  ds_read_b128 v[192:195], v1 offset:8192
  ds_read_b128 v[196:199], v1 offset:9216
  v_rcp_f32 v62, v62
  v_rcp_f32 v63, v63
  v_mfma_f32_32x32x16_bf16 v[96:111], v[240:243], v[152:155], v[96:111]
  ds_read_b128 v[200:203], v1 offset:10240
  ds_read_b128 v[204:207], v1 offset:11264
  v_mfma_f32_32x32x16_bf16 v[96:111], v[244:247], v[156:159], v[96:111]
  s_nop 0
  s_waitcnt lgkmcnt(0)
  ds_read_b128 v[208:211], v1 offset:12288
  ds_read_b128 v[212:215], v1 offset:13312
  v_pk_mul_f32 v[16:17], v[16:17], v[48:49]
  v_pk_mul_f32 v[18:19], v[18:19], v[50:51]
  v_pk_mul_f32 v[20:21], v[20:21], v[52:53]
  v_pk_mul_f32 v[22:23], v[22:23], v[54:55]
  v_pk_mul_f32 v[24:25], v[24:25], v[56:57]
  v_pk_mul_f32 v[26:27], v[26:27], v[58:59]
  v_pk_mul_f32 v[28:29], v[28:29], v[60:61]
  v_pk_mul_f32 v[30:31], v[30:31], v[62:63]
  v_pk_fma_f32 v[48:49], v[32:33], v[32:33], s[20:21] neg_lo:[1,0,1] neg_hi:[1,0,1]
  v_pk_fma_f32 v[50:51], v[34:35], v[34:35], s[20:21] neg_lo:[1,0,1] neg_hi:[1,0,1]
  v_pk_fma_f32 v[52:53], v[36:37], v[36:37], s[20:21] neg_lo:[1,0,1] neg_hi:[1,0,1]
  v_pk_fma_f32 v[54:55], v[38:39], v[38:39], s[20:21] neg_lo:[1,0,1] neg_hi:[1,0,1]
  v_pk_fma_f32 v[56:57], v[40:41], v[40:41], s[20:21] neg_lo:[1,0,1] neg_hi:[1,0,1]
  v_pk_fma_f32 v[58:59], v[42:43], v[42:43], s[20:21] neg_lo:[1,0,1] neg_hi:[1,0,1]
  v_pk_fma_f32 v[60:61], v[44:45], v[44:45], s[20:21] neg_lo:[1,0,1] neg_hi:[1,0,1]
  v_pk_fma_f32 v[62:63], v[46:47], v[46:47], s[20:21] neg_lo:[1,0,1] neg_hi:[1,0,1]
  v_pk_mul_f32 v[48:49], v[32:33], v[48:49]
  v_pk_mul_f32 v[50:51], v[34:35], v[50:51]
  v_pk_mul_f32 v[52:53], v[36:37], v[52:53]
  v_pk_mul_f32 v[54:55], v[38:39], v[54:55]
  v_pk_mul_f32 v[56:57], v[40:41], v[56:57]
  v_cvt_pk_bf16_f32 v184, v16, v17
  v_cvt_pk_bf16_f32 v185, v18, v19
  v_cvt_pk_bf16_f32 v186, v20, v21
  v_cvt_pk_bf16_f32 v187, v22, v23
  v_pk_mul_f32 v[58:59], v[42:43], v[58:59]
  v_pk_mul_f32 v[60:61], v[44:45], v[60:61]
  v_pk_mul_f32 v[62:63], v[46:47], v[62:63]
  v_mfma_f32_32x32x16_bf16 v[64:79], v[192:195], v[184:187], v[64:79]
  s_mov_b32 m0, s31
  v_cvt_pk_bf16_f32 v188, v24, v25
  v_cvt_pk_bf16_f32 v189, v26, v27
  v_cvt_pk_bf16_f32 v190, v28, v29
  v_cvt_pk_bf16_f32 v191, v30, v31
  v_exp_f32 v48, v48
  v_mfma_f32_32x32x16_bf16 v[80:95], v[196:199], v[184:187], v[80:95]
  buffer_load_dwordx4 v6, s[4:7], s52 offen lds
  v_exp_f32 v49, v49
  v_exp_f32 v50, v50
  v_exp_f32_e64 v51, v51
  v_mfma_f32_32x32x16_bf16 v[96:111], v[200:203], v[184:187], v[96:111]
  buffer_load_dwordx4 v7, s[4:7], s52 offen offset:1024 lds
  v_exp_f32 v52, v52
  v_exp_f32 v53, v53
  v_mfma_f32_32x32x16_bf16 v[64:79], v[204:207], v[188:191], v[64:79]
  buffer_load_dwordx4 v8, s[4:7], s52 offen offset:2048 lds
  v_exp_f32 v54, v54
  v_exp_f32 v55, v55
  v_exp_f32 v56, v56
  s_waitcnt lgkmcnt(1)
  v_mfma_f32_32x32x16_bf16 v[80:95], v[208:211], v[188:191], v[80:95]
  buffer_load_dwordx4 v9, s[4:7], s52 offen offset:3072 lds
  v_exp_f32_e64 v57, v57
  v_exp_f32 v58, v58
  s_waitcnt lgkmcnt(0)
  v_mfma_f32_32x32x16_bf16 v[96:111], v[212:215], v[188:191], v[96:111]
  v_exp_f32 v59, v59
  v_exp_f32 v60, v60
  v_exp_f32 v61, v61
  v_exp_f32 v62, v62
  v_exp_f32_e64 v63, v63
  v_pk_fma_f32 v[48:49], v[48:49], s[22:23], s[22:23]
  v_pk_fma_f32 v[50:51], v[50:51], s[22:23], s[22:23]
  v_pk_fma_f32 v[52:53], v[52:53], s[22:23], s[22:23]
  v_pk_fma_f32 v[54:55], v[54:55], s[22:23], s[22:23]
  v_pk_fma_f32 v[56:57], v[56:57], s[22:23], s[22:23]
  v_pk_fma_f32 v[58:59], v[58:59], s[22:23], s[22:23]
  v_pk_fma_f32 v[60:61], v[60:61], s[22:23], s[22:23]
  v_pk_fma_f32 v[62:63], v[62:63], s[22:23], s[22:23]
  v_mfma_f32_32x32x16_bf16 v[16:31], a[24:27], v[160:163], 0
  ds_read_b128 v[192:195], v1 offset:14336
  ds_read_b128 v[196:199], v1 offset:15360
  s_add_u32 m0, s14, 0x1c000
  v_rcp_f32 v48, v48
  v_rcp_f32 v49, v49
  v_mfma_f32_32x32x16_bf16 v[16:31], a[28:31], v[164:167], v[16:31]
  ds_read_b128 v[200:203], v1 offset:16384
  ds_read_b128 v[204:207], v1 offset:17408
  buffer_load_dwordx4 v254, s[72:75], s55 offen lds
  v_rcp_f32 v50, v50
  v_rcp_f32 v51, v51
  v_mfma_f32_32x32x16_bf16 v[16:31], a[32:35], v[168:171], v[16:31]
  ds_read_b128 v[208:211], v1 offset:18432
  ds_read_b128 v[212:215], v1 offset:19456
  v_rcp_f32 v52, v52
  v_rcp_f32 v53, v53
  v_mfma_f32_32x32x16_bf16 v[16:31], a[36:39], v[172:175], v[16:31]
  buffer_load_dwordx4 v255, s[72:75], s55 offen offset:1024 lds
  v_rcp_f32 v54, v54
  v_rcp_f32 v55, v55
  v_rcp_f32_e64 v56, v56
  v_mfma_f32_32x32x16_bf16 v[16:31], a[40:43], v[176:179], v[16:31]
  v_rcp_f32 v57, v57
  v_rcp_f32 v58, v58
  v_rcp_f32 v59, v59
  v_mfma_f32_32x32x16_bf16 v[16:31], a[44:47], v[180:183], v[16:31]
  s_waitcnt lgkmcnt(0)
  buffer_load_dwordx4 v112, s[72:75], s55 offen offset:2048 lds
  v_rcp_f32 v60, v60
  v_rcp_f32 v61, v61
  v_rcp_f32 v62, v62
  v_rcp_f32 v63, v63
  v_pk_mul_f32 v[32:33], v[32:33], v[48:49]
  v_pk_mul_f32 v[34:35], v[34:35], v[50:51]
  v_pk_mul_f32 v[36:37], v[36:37], v[52:53]
  v_pk_mul_f32 v[38:39], v[38:39], v[54:55]
  v_pk_mul_f32 v[40:41], v[40:41], v[56:57]
  v_pk_mul_f32 v[42:43], v[42:43], v[58:59]
  v_pk_mul_f32 v[44:45], v[44:45], v[60:61]
  v_pk_mul_f32 v[46:47], v[46:47], v[62:63]
  v_pk_fma_f32 v[48:49], v[16:17], v[16:17], s[20:21] neg_lo:[1,0,1] neg_hi:[1,0,1]
  v_pk_fma_f32 v[50:51], v[18:19], v[18:19], s[20:21] neg_lo:[1,0,1] neg_hi:[1,0,1]
  v_pk_fma_f32 v[52:53], v[20:21], v[20:21], s[20:21] neg_lo:[1,0,1] neg_hi:[1,0,1]
  v_pk_fma_f32 v[54:55], v[22:23], v[22:23], s[20:21] neg_lo:[1,0,1] neg_hi:[1,0,1]
  v_pk_fma_f32 v[56:57], v[24:25], v[24:25], s[20:21] neg_lo:[1,0,1] neg_hi:[1,0,1]
  v_pk_fma_f32 v[58:59], v[26:27], v[26:27], s[20:21] neg_lo:[1,0,1] neg_hi:[1,0,1]
  v_pk_fma_f32 v[60:61], v[28:29], v[28:29], s[20:21] neg_lo:[1,0,1] neg_hi:[1,0,1]
  v_pk_fma_f32 v[62:63], v[30:31], v[30:31], s[20:21] neg_lo:[1,0,1] neg_hi:[1,0,1]
  v_pk_mul_f32 v[48:49], v[16:17], v[48:49]
  v_pk_mul_f32 v[50:51], v[18:19], v[50:51]
  v_pk_mul_f32 v[52:53], v[20:21], v[52:53]
  v_pk_mul_f32 v[54:55], v[22:23], v[54:55]
  v_pk_mul_f32 v[56:57], v[24:25], v[56:57]
  v_cvt_pk_bf16_f32 v184, v32, v33
  v_cvt_pk_bf16_f32 v185, v34, v35
  v_cvt_pk_bf16_f32 v186, v36, v37
  v_cvt_pk_bf16_f32 v187, v38, v39
  v_pk_mul_f32 v[58:59], v[26:27], v[58:59]
  v_pk_mul_f32 v[60:61], v[28:29], v[60:61]
  v_pk_mul_f32 v[62:63], v[30:31], v[62:63]
  v_mfma_f32_32x32x16_bf16 v[64:79], v[192:195], v[184:187], v[64:79]
  s_add_u32 m0, s14, 0x1cc00
  v_cvt_pk_bf16_f32 v188, v40, v41
  v_cvt_pk_bf16_f32 v189, v42, v43
  v_cvt_pk_bf16_f32 v190, v44, v45
  v_cvt_pk_bf16_f32 v191, v46, v47
  v_exp_f32_e64 v48, v48
  v_mfma_f32_32x32x16_bf16 v[80:95], v[196:199], v[184:187], v[80:95]
  buffer_load_dwordx4 v254, s[72:75], s56 offen lds
  v_exp_f32 v49, v49
  v_exp_f32 v50, v50
  v_exp_f32 v51, v51
  v_mfma_f32_32x32x16_bf16 v[96:111], v[200:203], v[184:187], v[96:111]
  s_waitcnt vmcnt(8)
  ds_read_b128 a[216:219], v251
  ds_read_b128 a[220:223], v252
  ds_read_b128 a[224:227], v251 offset:64
  v_exp_f32 v52, v52
  v_exp_f32 v53, v53
  v_mfma_f32_32x32x16_bf16 v[64:79], v[204:207], v[188:191], v[64:79]
  ds_read_b128 a[228:231], v252 offset:64
  ds_read_b128 a[232:235], v251 offset:128
  ds_read_b128 a[236:239], v252 offset:128
  buffer_load_dwordx4 v255, s[72:75], s56 offen offset:1024 lds
  v_subrev_u32 v11, 0x4100, v5
  v_exp_f32_e64 v54, v54
  v_mfma_f32_32x32x16_bf16 v[80:95], v[208:211], v[188:191], v[80:95]
  v_exp_f32 v55, v55
  v_exp_f32 v56, v56
  v_exp_f32_e64 v57, v57
  v_exp_f32 v58, v58
  v_mfma_f32_32x32x16_bf16 v[96:111], v[212:215], v[188:191], v[96:111]
  s_waitcnt lgkmcnt(0)
  buffer_load_dwordx4 v112, s[72:75], s56 offen offset:2048 lds
  v_add_u32 v5, 0x8200, v5
  v_exp_f32 v59, v59
  v_exp_f32 v60, v60
  v_exp_f32 v61, v61
  v_exp_f32 v62, v62
  v_exp_f32 v63, v63
  v_min_u32 v5, v11, v5
  v_pk_fma_f32 v[48:49], v[48:49], s[22:23], s[22:23]
  v_pk_fma_f32 v[50:51], v[50:51], s[22:23], s[22:23]
  v_pk_fma_f32 v[52:53], v[52:53], s[22:23], s[22:23]
  v_pk_fma_f32 v[54:55], v[54:55], s[22:23], s[22:23]
  v_pk_fma_f32 v[56:57], v[56:57], s[22:23], s[22:23]
  v_pk_fma_f32 v[58:59], v[58:59], s[22:23], s[22:23]
  v_pk_fma_f32 v[60:61], v[60:61], s[22:23], s[22:23]
  v_pk_fma_f32 v[62:63], v[62:63], s[22:23], s[22:23]
  v_mfma_f32_32x32x16_bf16 v[112:127], a[216:219], a[192:195], 0
  ds_read_b128 v[192:195], v1 offset:20480
  ds_read_b128 v[196:199], v1 offset:21504
  v_rcp_f32 v48, v48
  v_rcp_f32 v49, v49
  v_mfma_f32_32x32x16_bf16 v[112:127], a[220:223], a[196:199], v[112:127]
  ds_read_b128 v[200:203], v1 offset:22528
  ds_read_b128 v[204:207], v1 offset:23552
  v_rcp_f32 v50, v50
  v_rcp_f32 v51, v51
  v_mfma_f32_32x32x16_bf16 v[128:143], a[224:227], a[200:203], 0
  ds_read_b128 v[208:211], v1 offset:24576
  ds_read_b128 v[212:215], v1 offset:25600
  v_rcp_f32_e64 v52, v52
  v_rcp_f32 v53, v53
  v_mfma_f32_32x32x16_bf16 v[128:143], a[228:231], a[204:207], v[128:143]
  s_nop 1
  v_cvt_pk_bf16_f32 v112, v112, v113
  v_cvt_pk_bf16_f32 v113, v114, v115
  v_cvt_pk_bf16_f32 v114, v116, v117
  v_cvt_pk_bf16_f32 v115, v118, v119
  v_rcp_f32_e64 v54, v54
  v_mfma_f32_32x32x16_bf16 v[144:159], a[232:235], a[208:211], 0
  ds_write_b128 v253, v[112:115]
  v_cvt_pk_bf16_f32 v116, v120, v121
  v_cvt_pk_bf16_f32 v117, v122, v123
  v_cvt_pk_bf16_f32 v118, v124, v125
  v_cvt_pk_bf16_f32 v119, v126, v127
  v_mfma_f32_32x32x16_bf16 v[144:159], a[236:239], a[212:215], v[144:159]
  ds_write_b128 v253, v[116:119] offset:3072
  v_cvt_pk_bf16_f32 v128, v128, v129
  v_cvt_pk_bf16_f32 v129, v130, v131
  v_cvt_pk_bf16_f32 v130, v132, v133
  v_cvt_pk_bf16_f32 v131, v134, v135
  v_mfma_f32_32x32x16_bf16 v[32:47], a[48:51], v[160:163], 0
  ds_write_b128 v253, v[128:131] offset:1024
  v_cvt_pk_bf16_f32 v132, v136, v137
  v_cvt_pk_bf16_f32 v133, v138, v139
  v_cvt_pk_bf16_f32 v134, v140, v141
  v_cvt_pk_bf16_f32 v135, v142, v143
  v_mfma_f32_32x32x16_bf16 v[32:47], a[52:55], v[164:167], v[32:47]
  ds_write_b128 v253, v[132:135] offset:4096
  v_cvt_pk_bf16_f32 v144, v144, v145
  v_cvt_pk_bf16_f32 v145, v146, v147
  v_cvt_pk_bf16_f32 v146, v148, v149
  v_cvt_pk_bf16_f32 v147, v150, v151
  v_mfma_f32_32x32x16_bf16 v[32:47], a[56:59], v[168:171], v[32:47]
  ds_write_b128 v253, v[144:147] offset:2048
  v_cvt_pk_bf16_f32 v148, v152, v153
  v_cvt_pk_bf16_f32 v149, v154, v155
  v_cvt_pk_bf16_f32 v150, v156, v157
  v_cvt_pk_bf16_f32 v151, v158, v159
  v_mfma_f32_32x32x16_bf16 v[32:47], a[60:63], v[172:175], v[32:47]
  ds_write_b128 v253, v[148:151] offset:5120
  v_rcp_f32 v55, v55
  v_rcp_f32 v56, v56
  v_mfma_f32_32x32x16_bf16 v[32:47], a[64:67], v[176:179], v[32:47]
  v_rcp_f32 v57, v57
  v_rcp_f32 v58, v58
  v_rcp_f32_e64 v59, v59
  v_mfma_f32_32x32x16_bf16 v[32:47], a[68:71], v[180:183], v[32:47]
  s_waitcnt lgkmcnt(6)
  v_rcp_f32 v60, v60
  v_rcp_f32 v61, v61
  v_rcp_f32 v62, v62
  v_rcp_f32_e64 v63, v63
  v_pk_mul_f32 v[16:17], v[16:17], v[48:49]
  v_pk_mul_f32 v[18:19], v[18:19], v[50:51]
  v_pk_mul_f32 v[20:21], v[20:21], v[52:53]
  v_pk_mul_f32 v[22:23], v[22:23], v[54:55]
  v_pk_mul_f32 v[24:25], v[24:25], v[56:57]
  v_pk_mul_f32 v[26:27], v[26:27], v[58:59]
  v_pk_mul_f32 v[28:29], v[28:29], v[60:61]
  v_pk_mul_f32 v[30:31], v[30:31], v[62:63]
  v_pk_fma_f32 v[48:49], v[32:33], v[32:33], s[20:21] neg_lo:[1,0,1] neg_hi:[1,0,1]
  v_pk_fma_f32 v[50:51], v[34:35], v[34:35], s[20:21] neg_lo:[1,0,1] neg_hi:[1,0,1]
  v_pk_fma_f32 v[52:53], v[36:37], v[36:37], s[20:21] neg_lo:[1,0,1] neg_hi:[1,0,1]
  v_pk_fma_f32 v[54:55], v[38:39], v[38:39], s[20:21] neg_lo:[1,0,1] neg_hi:[1,0,1]
  v_pk_fma_f32 v[56:57], v[40:41], v[40:41], s[20:21] neg_lo:[1,0,1] neg_hi:[1,0,1]
  v_pk_fma_f32 v[58:59], v[42:43], v[42:43], s[20:21] neg_lo:[1,0,1] neg_hi:[1,0,1]
  v_pk_fma_f32 v[60:61], v[44:45], v[44:45], s[20:21] neg_lo:[1,0,1] neg_hi:[1,0,1]
  v_pk_fma_f32 v[62:63], v[46:47], v[46:47], s[20:21] neg_lo:[1,0,1] neg_hi:[1,0,1]
  v_pk_mul_f32 v[48:49], v[32:33], v[48:49]
  v_pk_mul_f32 v[50:51], v[34:35], v[50:51]
  v_pk_mul_f32 v[52:53], v[36:37], v[52:53]
  v_pk_mul_f32 v[54:55], v[38:39], v[54:55]
  v_pk_mul_f32 v[56:57], v[40:41], v[56:57]
  v_cvt_pk_bf16_f32 v184, v16, v17
  v_cvt_pk_bf16_f32 v185, v18, v19
  v_cvt_pk_bf16_f32 v186, v20, v21
  v_cvt_pk_bf16_f32 v187, v22, v23
  v_pk_mul_f32 v[58:59], v[42:43], v[58:59]
  v_pk_mul_f32 v[60:61], v[44:45], v[60:61]
  v_pk_mul_f32 v[62:63], v[46:47], v[62:63]
  v_mfma_f32_32x32x16_bf16 v[64:79], v[192:195], v[184:187], v[64:79]
  s_add_u32 s29, s29, 0x60000
  v_cvt_pk_bf16_f32 v188, v24, v25
  v_cvt_pk_bf16_f32 v189, v26, v27
  v_cvt_pk_bf16_f32 v190, v28, v29
  v_cvt_pk_bf16_f32 v191, v30, v31
  v_exp_f32_e64 v48, v48
  v_mfma_f32_32x32x16_bf16 v[80:95], v[196:199], v[184:187], v[80:95]
  s_add_u32 s52, s52, 0x60000
  v_exp_f32 v49, v49
  v_exp_f32 v50, v50
  v_exp_f32_e64 v51, v51
  v_mfma_f32_32x32x16_bf16 v[96:111], v[200:203], v[184:187], v[96:111]
  s_mov_b32 s32, s30
  s_waitcnt vmcnt(0)
  ds_read_b128 a[216:219], v251 offset:24576
  ds_read_b128 a[220:223], v252 offset:24576
  ds_read_b128 a[224:227], v251 offset:24640
  v_exp_f32_e64 v52, v52
  v_exp_f32 v53, v53
  v_mfma_f32_32x32x16_bf16 v[64:79], v[204:207], v[188:191], v[64:79]
  s_add_u32 s30, s33, 32
  ds_read_b128 a[228:231], v252 offset:24640
  ds_read_b128 a[232:235], v251 offset:24704
  ds_read_b128 a[236:239], v252 offset:24704
  v_subrev_u32 v11, 0x4100, v4
  v_exp_f32_e64 v54, v54
  v_mfma_f32_32x32x16_bf16 v[80:95], v[208:211], v[188:191], v[80:95]
  s_sub_u32 s33, s31, 0
  v_exp_f32 v55, v55
  v_exp_f32 v56, v56
  v_exp_f32 v57, v57
  v_exp_f32 v58, v58
  v_mfma_f32_32x32x16_bf16 v[96:111], v[212:215], v[188:191], v[96:111]
  s_waitcnt lgkmcnt(0)
  v_add_u32 v4, 0x8200, v4
  v_exp_f32 v59, v59
  v_exp_f32 v60, v60
  v_exp_f32 v61, v61
  v_exp_f32 v62, v62
  v_exp_f32 v63, v63
  v_min_u32 v4, v11, v4
  v_pk_fma_f32 v[48:49], v[48:49], s[22:23], s[22:23]
  v_pk_fma_f32 v[50:51], v[50:51], s[22:23], s[22:23]
  v_pk_fma_f32 v[52:53], v[52:53], s[22:23], s[22:23]
  v_pk_fma_f32 v[54:55], v[54:55], s[22:23], s[22:23]
  v_pk_fma_f32 v[56:57], v[56:57], s[22:23], s[22:23]
  v_pk_fma_f32 v[58:59], v[58:59], s[22:23], s[22:23]
  v_pk_fma_f32 v[60:61], v[60:61], s[22:23], s[22:23]
  v_pk_fma_f32 v[62:63], v[62:63], s[22:23], s[22:23]
  v_mfma_f32_32x32x16_bf16 v[112:127], a[216:219], a[192:195], 0
  ds_read_b128 v[192:195], v1 offset:26624
  ds_read_b128 v[196:199], v1 offset:27648
  v_rcp_f32 v48, v48
  v_rcp_f32 v49, v49
  v_mfma_f32_32x32x16_bf16 v[112:127], a[220:223], a[196:199], v[112:127]
  ds_read_b128 v[200:203], v1 offset:28672
  ds_read_b128 v[204:207], v1 offset:29696
  v_rcp_f32 v50, v50
  v_rcp_f32 v51, v51
  v_mfma_f32_32x32x16_bf16 v[128:143], a[224:227], a[200:203], 0
  ds_read_b128 v[208:211], v1 offset:30720
  ds_read_b128 v[212:215], v1 offset:31744
  v_rcp_f32_e64 v52, v52
  v_rcp_f32 v53, v53
  v_mfma_f32_32x32x16_bf16 v[128:143], a[228:231], a[204:207], v[128:143]
  s_nop 1
  v_cvt_pk_bf16_f32 v112, v112, v113
  v_cvt_pk_bf16_f32 v113, v114, v115
  v_cvt_pk_bf16_f32 v114, v116, v117
  v_cvt_pk_bf16_f32 v115, v118, v119
  v_rcp_f32_e64 v54, v54
  v_mfma_f32_32x32x16_bf16 v[144:159], a[232:235], a[208:211], 0
  ds_write_b128 v253, v[112:115] offset:24576
  v_cvt_pk_bf16_f32 v116, v120, v121
  v_cvt_pk_bf16_f32 v117, v122, v123
  v_cvt_pk_bf16_f32 v118, v124, v125
  v_cvt_pk_bf16_f32 v119, v126, v127
  v_mfma_f32_32x32x16_bf16 v[144:159], a[236:239], a[212:215], v[144:159]
  ds_write_b128 v253, v[116:119] offset:27648
  v_cvt_pk_bf16_f32 v128, v128, v129
  v_cvt_pk_bf16_f32 v129, v130, v131
  v_cvt_pk_bf16_f32 v130, v132, v133
  v_cvt_pk_bf16_f32 v131, v134, v135
  v_mfma_f32_32x32x16_bf16 v[16:31], a[72:75], v[160:163], 0
  ds_write_b128 v253, v[128:131] offset:25600
  v_cvt_pk_bf16_f32 v132, v136, v137
  v_cvt_pk_bf16_f32 v133, v138, v139
  v_cvt_pk_bf16_f32 v134, v140, v141
  v_cvt_pk_bf16_f32 v135, v142, v143
  v_mfma_f32_32x32x16_bf16 v[16:31], a[76:79], v[164:167], v[16:31]
  ds_write_b128 v253, v[132:135] offset:28672
  v_cvt_pk_bf16_f32 v144, v144, v145
  v_cvt_pk_bf16_f32 v145, v146, v147
  v_cvt_pk_bf16_f32 v146, v148, v149
  v_cvt_pk_bf16_f32 v147, v150, v151
  v_mfma_f32_32x32x16_bf16 v[16:31], a[80:83], v[168:171], v[16:31]
  ds_write_b128 v253, v[144:147] offset:26624
  v_cvt_pk_bf16_f32 v148, v152, v153
  v_cvt_pk_bf16_f32 v149, v154, v155
  v_cvt_pk_bf16_f32 v150, v156, v157
  v_cvt_pk_bf16_f32 v151, v158, v159
  v_mfma_f32_32x32x16_bf16 v[16:31], a[84:87], v[172:175], v[16:31]
  ds_write_b128 v253, v[148:151] offset:29696
  buffer_load_dword v249, v248, s[4:7], s29 offen
  v_rcp_f32_e64 v55, v55
  v_mfma_f32_32x32x16_bf16 v[16:31], a[88:91], v[176:179], v[16:31]
  v_rcp_f32 v56, v56
  v_rcp_f32 v57, v57
  v_rcp_f32_e64 v58, v58
  v_mfma_f32_32x32x16_bf16 v[16:31], a[92:95], v[180:183], v[16:31]
  s_waitcnt lgkmcnt(6)
  v_rcp_f32 v59, v59
  v_rcp_f32 v60, v60
  v_rcp_f32 v61, v61
  v_rcp_f32 v62, v62
  v_rcp_f32 v63, v63
  v_pk_mul_f32 v[32:33], v[32:33], v[48:49]
  v_pk_mul_f32 v[34:35], v[34:35], v[50:51]
  v_pk_mul_f32 v[36:37], v[36:37], v[52:53]
  v_pk_mul_f32 v[38:39], v[38:39], v[54:55]
  v_pk_mul_f32 v[40:41], v[40:41], v[56:57]
  v_pk_mul_f32 v[42:43], v[42:43], v[58:59]
  v_pk_mul_f32 v[44:45], v[44:45], v[60:61]
  v_pk_mul_f32 v[46:47], v[46:47], v[62:63]
  v_pk_fma_f32 v[48:49], v[16:17], v[16:17], s[20:21] neg_lo:[1,0,1] neg_hi:[1,0,1]
  v_pk_fma_f32 v[50:51], v[18:19], v[18:19], s[20:21] neg_lo:[1,0,1] neg_hi:[1,0,1]
  v_pk_fma_f32 v[52:53], v[20:21], v[20:21], s[20:21] neg_lo:[1,0,1] neg_hi:[1,0,1]
  v_pk_fma_f32 v[54:55], v[22:23], v[22:23], s[20:21] neg_lo:[1,0,1] neg_hi:[1,0,1]
  v_pk_fma_f32 v[56:57], v[24:25], v[24:25], s[20:21] neg_lo:[1,0,1] neg_hi:[1,0,1]
  v_pk_fma_f32 v[58:59], v[26:27], v[26:27], s[20:21] neg_lo:[1,0,1] neg_hi:[1,0,1]
  v_pk_fma_f32 v[60:61], v[28:29], v[28:29], s[20:21] neg_lo:[1,0,1] neg_hi:[1,0,1]
  v_pk_fma_f32 v[62:63], v[30:31], v[30:31], s[20:21] neg_lo:[1,0,1] neg_hi:[1,0,1]
  v_pk_mul_f32 v[48:49], v[16:17], v[48:49]
  v_pk_mul_f32 v[50:51], v[18:19], v[50:51]
  v_pk_mul_f32 v[52:53], v[20:21], v[52:53]
  v_pk_mul_f32 v[54:55], v[22:23], v[54:55]
  v_pk_mul_f32 v[56:57], v[24:25], v[56:57]
  v_cvt_pk_bf16_f32 v184, v32, v33
  v_cvt_pk_bf16_f32 v185, v34, v35
  v_cvt_pk_bf16_f32 v186, v36, v37
  v_cvt_pk_bf16_f32 v187, v38, v39
  v_pk_mul_f32 v[58:59], v[26:27], v[58:59]
  v_pk_mul_f32 v[60:61], v[28:29], v[60:61]
  v_pk_mul_f32 v[62:63], v[30:31], v[62:63]
  v_mfma_f32_32x32x16_bf16 v[64:79], v[192:195], v[184:187], v[64:79]
  ds_read_b128 v[220:223], v4 offset:96
  v_cvt_pk_bf16_f32 v188, v40, v41
  v_cvt_pk_bf16_f32 v189, v42, v43
  v_cvt_pk_bf16_f32 v190, v44, v45
  v_cvt_pk_bf16_f32 v191, v46, v47
  v_mfma_f32_32x32x16_bf16 v[80:95], v[196:199], v[184:187], v[80:95]
  ds_read_b128 v[228:231], v4 offset:288
  v_exp_f32 v48, v48
  v_exp_f32 v49, v49
  v_exp_f32_e64 v50, v50
  v_mfma_f32_32x32x16_bf16 v[96:111], v[200:203], v[184:187], v[96:111]
  ds_read_b128 v[236:239], v4 offset:480
  v_exp_f32 v51, v51
  v_exp_f32 v52, v52
  v_mfma_f32_32x32x16_bf16 v[64:79], v[204:207], v[188:191], v[64:79]
  v_exp_f32 v53, v53
  v_exp_f32 v54, v54
  v_exp_f32_e64 v55, v55
  v_mfma_f32_32x32x16_bf16 v[80:95], v[208:211], v[188:191], v[80:95]
  v_exp_f32 v56, v56
  v_exp_f32 v57, v57
  v_exp_f32_e64 v58, v58
  v_mfma_f32_32x32x16_bf16 v[96:111], v[212:215], v[188:191], v[96:111]
  s_waitcnt lgkmcnt(0)
  v_exp_f32 v59, v59
  v_exp_f32 v60, v60
  v_exp_f32 v61, v61
  v_exp_f32 v62, v62
  v_exp_f32 v63, v63
  v_pk_fma_f32 v[48:49], v[48:49], s[22:23], s[22:23]
  v_pk_fma_f32 v[50:51], v[50:51], s[22:23], s[22:23]
  v_pk_fma_f32 v[52:53], v[52:53], s[22:23], s[22:23]
  v_pk_fma_f32 v[54:55], v[54:55], s[22:23], s[22:23]
  v_pk_fma_f32 v[56:57], v[56:57], s[22:23], s[22:23]
  v_pk_fma_f32 v[58:59], v[58:59], s[22:23], s[22:23]
  v_pk_fma_f32 v[60:61], v[60:61], s[22:23], s[22:23]
  v_pk_fma_f32 v[62:63], v[62:63], s[22:23], s[22:23]
  s_barrier
  v_mfma_f32_32x32x16_bf16 v[32:47], a[96:99], v[160:163], 0
  ds_read_b128 v[192:195], v0 offset:24576
  ds_read_b128 v[196:199], v0 offset:25600
  v_rcp_f32 v48, v48
  v_rcp_f32_e64 v49, v49
  v_mfma_f32_16x16x32_bf16 v[136:139], a[240:243], v[220:223], 0
  ds_read_b128 v[216:219], v3 offset:2800
  ds_read_b128 v[220:223], v4 offset:112
  v_mfma_f32_32x32x16_bf16 v[32:47], a[100:103], v[164:167], v[32:47]
  ds_read_b128 v[200:203], v0 offset:26624
  ds_read_b128 v[204:207], v0 offset:27648
  v_rcp_f32 v50, v50
  v_rcp_f32 v51, v51
  v_mfma_f32_16x16x32_bf16 v[136:139], a[244:247], v[228:231], v[136:139]
  ds_read_b128 v[224:227], v3 offset:7600
  ds_read_b128 v[228:231], v4 offset:304
  v_mfma_f32_32x32x16_bf16 v[32:47], a[104:107], v[168:171], v[32:47]
  ds_read_b128 v[208:211], v0 offset:28672
  ds_read_b128 v[212:215], v0 offset:29696
  v_rcp_f32 v52, v52
  v_rcp_f32 v53, v53
  v_mfma_f32_16x16x32_bf16 v[136:139], a[248:251], v[236:239], v[136:139]
  ds_read_b128 v[232:235], v3 offset:12400
  ds_read_b128 v[236:239], v4 offset:496
  v_mfma_f32_32x32x16_bf16 v[32:47], a[108:111], v[172:175], v[32:47]
  v_rcp_f32 v54, v54
  v_rcp_f32 v55, v55
  v_rcp_f32_e64 v56, v56
  v_mfma_f32_32x32x16_bf16 v[32:47], a[112:115], v[176:179], v[32:47]
  v_rcp_f32 v57, v57
  v_rcp_f32 v58, v58
  v_rcp_f32_e64 v59, v59
  v_mfma_f32_32x32x16_bf16 v[32:47], a[116:119], v[180:183], v[32:47]
  s_waitcnt lgkmcnt(0)
  v_rcp_f32 v60, v60
  v_rcp_f32 v61, v61
  v_rcp_f32 v62, v62
  v_rcp_f32_e64 v63, v63
  v_pk_mul_f32 v[16:17], v[16:17], v[48:49]
  v_pk_mul_f32 v[18:19], v[18:19], v[50:51]
  v_pk_mul_f32 v[20:21], v[20:21], v[52:53]
  v_pk_mul_f32 v[22:23], v[22:23], v[54:55]
  v_pk_mul_f32 v[24:25], v[24:25], v[56:57]
  v_pk_mul_f32 v[26:27], v[26:27], v[58:59]
  v_pk_mul_f32 v[28:29], v[28:29], v[60:61]
  v_pk_mul_f32 v[30:31], v[30:31], v[62:63]
  v_pk_add_f32 v[12:13], v[136:137], v[138:139]
  v_pk_mul_f32 v[14:15], v[136:137], v[136:137]
  v_pk_fma_f32 v[14:15], v[138:139], v[138:139], v[14:15]
  v_pk_fma_f32 v[48:49], v[32:33], v[32:33], s[20:21] neg_lo:[1,0,1] neg_hi:[1,0,1]
  v_pk_fma_f32 v[50:51], v[34:35], v[34:35], s[20:21] neg_lo:[1,0,1] neg_hi:[1,0,1]
  v_pk_fma_f32 v[52:53], v[36:37], v[36:37], s[20:21] neg_lo:[1,0,1] neg_hi:[1,0,1]
  v_pk_fma_f32 v[54:55], v[38:39], v[38:39], s[20:21] neg_lo:[1,0,1] neg_hi:[1,0,1]
  v_pk_fma_f32 v[56:57], v[40:41], v[40:41], s[20:21] neg_lo:[1,0,1] neg_hi:[1,0,1]
  v_pk_fma_f32 v[58:59], v[42:43], v[42:43], s[20:21] neg_lo:[1,0,1] neg_hi:[1,0,1]
  v_pk_fma_f32 v[60:61], v[44:45], v[44:45], s[20:21] neg_lo:[1,0,1] neg_hi:[1,0,1]
  v_pk_fma_f32 v[62:63], v[46:47], v[46:47], s[20:21] neg_lo:[1,0,1] neg_hi:[1,0,1]
  v_pk_mul_f32 v[48:49], v[32:33], v[48:49]
  v_pk_mul_f32 v[50:51], v[34:35], v[50:51]
  v_pk_mul_f32 v[52:53], v[36:37], v[52:53]
  v_pk_mul_f32 v[54:55], v[38:39], v[54:55]
  v_pk_mul_f32 v[56:57], v[40:41], v[56:57]
  v_pk_mul_f32 v[58:59], v[42:43], v[58:59]
  v_pk_mul_f32 v[60:61], v[44:45], v[60:61]
  v_pk_mul_f32 v[62:63], v[46:47], v[62:63]
  v_mfma_f32_16x16x32_bf16 v[140:143], v[216:219], v[220:223], 0
  v_cvt_pk_bf16_f32 v184, v16, v17
  v_cvt_pk_bf16_f32 v185, v18, v19
  v_mfma_f32_16x16x32_bf16 v[140:143], v[224:227], v[228:231], v[140:143]
  v_cvt_pk_bf16_f32 v186, v20, v21
  v_cvt_pk_bf16_f32 v187, v22, v23
  v_mfma_f32_16x16x32_bf16 v[140:143], v[232:235], v[236:239], v[140:143]
  ds_read_b128 v[220:223], v4 offset:128
  v_mfma_f32_32x32x16_bf16 v[64:79], v[192:195], v[184:187], v[64:79]
  ds_read_b128 v[224:227], v3 offset:8000
  ds_read_b128 v[228:231], v4 offset:320
  v_cvt_pk_bf16_f32 v188, v24, v25
  v_cvt_pk_bf16_f32 v189, v26, v27
  v_cvt_pk_bf16_f32 v190, v28, v29
  v_cvt_pk_bf16_f32 v191, v30, v31
  v_mfma_f32_32x32x16_bf16 v[80:95], v[196:199], v[184:187], v[80:95]
  ds_read_b128 v[232:235], v3 offset:12800
  ds_read_b128 v[236:239], v4 offset:512
  v_exp_f32 v48, v48
  v_exp_f32 v49, v49
  v_mfma_f32_32x32x16_bf16 v[96:111], v[200:203], v[184:187], v[96:111]
  s_sub_u32 s31, s32, 32
  v_exp_f32 v50, v50
  v_exp_f32 v51, v51
  v_exp_f32 v52, v52
  v_mfma_f32_32x32x16_bf16 v[64:79], v[204:207], v[188:191], v[64:79]
  v_exp_f32 v53, v53
  v_exp_f32 v54, v54
  v_exp_f32_e64 v55, v55
  v_mfma_f32_32x32x16_bf16 v[80:95], v[208:211], v[188:191], v[80:95]
  v_exp_f32 v56, v56
  v_exp_f32 v57, v57
  v_exp_f32_e64 v58, v58
  v_mfma_f32_32x32x16_bf16 v[96:111], v[212:215], v[188:191], v[96:111]
  s_waitcnt lgkmcnt(0)
  v_exp_f32 v59, v59
  v_exp_f32 v60, v60
  v_exp_f32 v61, v61
  v_exp_f32 v62, v62
  v_exp_f32 v63, v63
  v_pk_add_f32 v[12:13], v[12:13], v[140:141]
  v_pk_fma_f32 v[14:15], v[140:141], v[140:141], v[14:15]
  v_pk_add_f32 v[12:13], v[12:13], v[142:143]
  v_pk_fma_f32 v[14:15], v[142:143], v[142:143], v[14:15]
  v_pk_fma_f32 v[48:49], v[48:49], s[22:23], s[22:23]
  v_pk_fma_f32 v[50:51], v[50:51], s[22:23], s[22:23]
  v_pk_fma_f32 v[52:53], v[52:53], s[22:23], s[22:23]
  v_pk_fma_f32 v[54:55], v[54:55], s[22:23], s[22:23]
  v_pk_fma_f32 v[56:57], v[56:57], s[22:23], s[22:23]
  v_pk_fma_f32 v[58:59], v[58:59], s[22:23], s[22:23]
  v_pk_fma_f32 v[60:61], v[60:61], s[22:23], s[22:23]
  v_pk_fma_f32 v[62:63], v[62:63], s[22:23], s[22:23]
  v_mfma_f32_32x32x16_bf16 v[16:31], a[120:123], v[160:163], 0
  ds_read_b128 v[192:195], v0 offset:30720
  ds_read_b128 v[196:199], v0 offset:31744
  v_rcp_f32 v48, v48
  v_rcp_f32 v49, v49
  v_mfma_f32_16x16x32_bf16 v[144:147], a[252:255], v[220:223], 0
  ds_read_b128 v[216:219], v3 offset:3600
  ds_read_b128 v[220:223], v4 offset:144
  v_mfma_f32_32x32x16_bf16 v[16:31], a[124:127], v[164:167], v[16:31]
  ds_read_b128 v[200:203], v0 offset:32768
  ds_read_b128 v[204:207], v0 offset:33792
  v_rcp_f32 v50, v50
  v_rcp_f32 v51, v51
  v_mfma_f32_16x16x32_bf16 v[144:147], v[224:227], v[228:231], v[144:147]
  ds_read_b128 v[224:227], v3 offset:8400
  ds_read_b128 v[228:231], v4 offset:336
  v_mfma_f32_32x32x16_bf16 v[16:31], a[128:131], v[168:171], v[16:31]
  ds_read_b128 v[208:211], v0 offset:34816
  ds_read_b128 v[212:215], v0 offset:35840
  v_rcp_f32 v52, v52
  v_rcp_f32 v53, v53
  v_mfma_f32_16x16x32_bf16 v[144:147], v[232:235], v[236:239], v[144:147]
  ds_read_b128 v[232:235], v3 offset:13200
  ds_read_b128 v[236:239], v4 offset:528
  v_mfma_f32_32x32x16_bf16 v[16:31], a[132:135], v[172:175], v[16:31]
  v_rcp_f32 v54, v54
  v_rcp_f32 v55, v55
  v_rcp_f32_e64 v56, v56
  v_mfma_f32_32x32x16_bf16 v[16:31], a[136:139], v[176:179], v[16:31]
  ds_read_b128 a[192:195], v0
  ds_read_b128 a[196:199], v0 offset:1024
  ds_read_b128 a[200:203], v0 offset:2048
  v_rcp_f32 v57, v57
  v_rcp_f32 v58, v58
  v_mfma_f32_32x32x16_bf16 v[16:31], a[140:143], v[180:183], v[16:31]
  s_waitcnt lgkmcnt(3)
  v_rcp_f32 v59, v59
  v_rcp_f32 v60, v60
  v_rcp_f32 v61, v61
  v_rcp_f32 v62, v62
  v_rcp_f32 v63, v63
  v_pk_mul_f32 v[32:33], v[32:33], v[48:49]
  v_pk_mul_f32 v[34:35], v[34:35], v[50:51]
  v_pk_mul_f32 v[36:37], v[36:37], v[52:53]
  v_pk_mul_f32 v[38:39], v[38:39], v[54:55]
  v_pk_mul_f32 v[40:41], v[40:41], v[56:57]
  v_pk_mul_f32 v[42:43], v[42:43], v[58:59]
  v_pk_mul_f32 v[44:45], v[44:45], v[60:61]
  v_pk_mul_f32 v[46:47], v[46:47], v[62:63]
  v_pk_add_f32 v[12:13], v[12:13], v[144:145]
  v_pk_fma_f32 v[14:15], v[144:145], v[144:145], v[14:15]
  v_pk_add_f32 v[12:13], v[12:13], v[146:147]
  v_pk_fma_f32 v[14:15], v[146:147], v[146:147], v[14:15]
  v_pk_fma_f32 v[48:49], v[16:17], v[16:17], s[20:21] neg_lo:[1,0,1] neg_hi:[1,0,1]
  v_pk_fma_f32 v[50:51], v[18:19], v[18:19], s[20:21] neg_lo:[1,0,1] neg_hi:[1,0,1]
  v_pk_fma_f32 v[52:53], v[20:21], v[20:21], s[20:21] neg_lo:[1,0,1] neg_hi:[1,0,1]
  v_pk_fma_f32 v[54:55], v[22:23], v[22:23], s[20:21] neg_lo:[1,0,1] neg_hi:[1,0,1]
  v_pk_fma_f32 v[56:57], v[24:25], v[24:25], s[20:21] neg_lo:[1,0,1] neg_hi:[1,0,1]
  v_pk_fma_f32 v[58:59], v[26:27], v[26:27], s[20:21] neg_lo:[1,0,1] neg_hi:[1,0,1]
  v_pk_fma_f32 v[60:61], v[28:29], v[28:29], s[20:21] neg_lo:[1,0,1] neg_hi:[1,0,1]
  v_pk_fma_f32 v[62:63], v[30:31], v[30:31], s[20:21] neg_lo:[1,0,1] neg_hi:[1,0,1]
  v_pk_mul_f32 v[48:49], v[16:17], v[48:49]
  v_pk_mul_f32 v[50:51], v[18:19], v[50:51]
  v_pk_mul_f32 v[52:53], v[20:21], v[52:53]
  v_pk_mul_f32 v[54:55], v[22:23], v[54:55]
  v_pk_mul_f32 v[56:57], v[24:25], v[56:57]
  v_pk_mul_f32 v[58:59], v[26:27], v[58:59]
  v_pk_mul_f32 v[60:61], v[28:29], v[60:61]
  v_pk_mul_f32 v[62:63], v[30:31], v[62:63]
  v_mfma_f32_16x16x32_bf16 v[148:151], v[216:219], v[220:223], 0
  v_cvt_pk_bf16_f32 v184, v32, v33
  v_cvt_pk_bf16_f32 v185, v34, v35
  v_mfma_f32_16x16x32_bf16 v[148:151], v[224:227], v[228:231], v[148:151]
  v_cvt_pk_bf16_f32 v186, v36, v37
  v_cvt_pk_bf16_f32 v187, v38, v39
  v_mfma_f32_16x16x32_bf16 v[148:151], v[232:235], v[236:239], v[148:151]
  ds_read_b128 v[216:219], v3 offset:4000
  ds_read_b128 v[220:223], v4 offset:160
  v_mfma_f32_32x32x16_bf16 v[64:79], v[192:195], v[184:187], v[64:79]
  ds_read_b128 v[224:227], v3 offset:8800
  ds_read_b128 v[228:231], v4 offset:352
  v_cvt_pk_bf16_f32 v188, v40, v41
  v_cvt_pk_bf16_f32 v189, v42, v43
  v_cvt_pk_bf16_f32 v190, v44, v45
  v_cvt_pk_bf16_f32 v191, v46, v47
  v_mfma_f32_32x32x16_bf16 v[80:95], v[196:199], v[184:187], v[80:95]
  ds_read_b128 v[232:235], v3 offset:13600
  ds_read_b128 v[236:239], v4 offset:544
  v_exp_f32 v48, v48
  v_exp_f32 v49, v49
  v_mfma_f32_32x32x16_bf16 v[96:111], v[200:203], v[184:187], v[96:111]
  v_exp_f32 v50, v50
  v_exp_f32 v51, v51
  v_exp_f32_e64 v52, v52
  v_mfma_f32_32x32x16_bf16 v[64:79], v[204:207], v[188:191], v[64:79]
  v_exp_f32 v53, v53
  v_exp_f32 v54, v54
  v_exp_f32_e64 v55, v55
  v_mfma_f32_32x32x16_bf16 v[80:95], v[208:211], v[188:191], v[80:95]
  ds_read_b128 a[204:207], v0 offset:3072
  ds_read_b128 a[208:211], v0 offset:4096
  ds_read_b128 a[212:215], v0 offset:5120
  v_exp_f32 v56, v56
  v_exp_f32 v57, v57
  v_mfma_f32_32x32x16_bf16 v[96:111], v[212:215], v[188:191], v[96:111]
  s_waitcnt lgkmcnt(3)
  v_exp_f32 v58, v58
  v_exp_f32 v59, v59
  v_exp_f32 v60, v60
  v_exp_f32 v61, v61
  v_exp_f32 v62, v62
  v_exp_f32_e64 v63, v63
  v_pk_add_f32 v[12:13], v[12:13], v[148:149]
  v_pk_fma_f32 v[14:15], v[148:149], v[148:149], v[14:15]
  v_pk_add_f32 v[12:13], v[12:13], v[150:151]
  v_pk_fma_f32 v[14:15], v[150:151], v[150:151], v[14:15]
  v_pk_fma_f32 v[48:49], v[48:49], s[22:23], s[22:23]
  v_pk_fma_f32 v[50:51], v[50:51], s[22:23], s[22:23]
  v_pk_fma_f32 v[52:53], v[52:53], s[22:23], s[22:23]
  v_pk_fma_f32 v[54:55], v[54:55], s[22:23], s[22:23]
  v_pk_fma_f32 v[56:57], v[56:57], s[22:23], s[22:23]
  v_pk_fma_f32 v[58:59], v[58:59], s[22:23], s[22:23]
  v_pk_fma_f32 v[60:61], v[60:61], s[22:23], s[22:23]
  v_pk_fma_f32 v[62:63], v[62:63], s[22:23], s[22:23]
  v_mfma_f32_32x32x16_bf16 v[32:47], a[144:147], v[160:163], 0
  ds_read_b128 v[192:195], v0 offset:36864
  ds_read_b128 v[196:199], v0 offset:37888
  v_rcp_f32 v48, v48
  v_rcp_f32 v49, v49
  v_mfma_f32_16x16x32_bf16 v[152:155], v[216:219], v[220:223], 0
  ds_read_b128 v[216:219], v3 offset:4400
  ds_read_b128 v[220:223], v4 offset:176
  v_mfma_f32_32x32x16_bf16 v[32:47], a[148:151], v[164:167], v[32:47]
  ds_read_b128 v[200:203], v0 offset:38912
  ds_read_b128 v[204:207], v0 offset:39936
  v_rcp_f32 v50, v50
  v_rcp_f32 v51, v51
  v_mfma_f32_16x16x32_bf16 v[152:155], v[224:227], v[228:231], v[152:155]
  ds_read_b128 v[224:227], v3 offset:9200
  ds_read_b128 v[228:231], v4 offset:368
  v_mfma_f32_32x32x16_bf16 v[32:47], a[152:155], v[168:171], v[32:47]
  ds_read_b128 v[208:211], v0 offset:40960
  ds_read_b128 v[212:215], v0 offset:41984
  v_rcp_f32 v52, v52
  v_rcp_f32 v53, v53
  v_mfma_f32_16x16x32_bf16 v[152:155], v[232:235], v[236:239], v[152:155]
  ds_read_b128 v[232:235], v3 offset:14000
  ds_read_b128 v[236:239], v4 offset:560
  v_mfma_f32_32x32x16_bf16 v[32:47], a[156:159], v[172:175], v[32:47]
  v_rcp_f32 v54, v54
  v_rcp_f32 v55, v55
  v_rcp_f32_e64 v56, v56
  v_mfma_f32_32x32x16_bf16 v[32:47], a[160:163], v[176:179], v[32:47]
  ds_read_b128 a[216:219], v0 offset:6144
  ds_read_b128 a[220:223], v0 offset:7168
  ds_read_b128 a[224:227], v0 offset:8192
  v_rcp_f32 v57, v57
  v_rcp_f32 v58, v58
  v_mfma_f32_32x32x16_bf16 v[32:47], a[164:167], v[180:183], v[32:47]
  s_waitcnt lgkmcnt(3)
  v_rcp_f32 v59, v59
  v_rcp_f32 v60, v60
  v_rcp_f32 v61, v61
  v_rcp_f32 v62, v62
  v_rcp_f32 v63, v63
  v_pk_mul_f32 v[16:17], v[16:17], v[48:49]
  v_pk_mul_f32 v[18:19], v[18:19], v[50:51]
  v_pk_mul_f32 v[20:21], v[20:21], v[52:53]
  v_pk_mul_f32 v[22:23], v[22:23], v[54:55]
  v_pk_mul_f32 v[24:25], v[24:25], v[56:57]
  v_pk_mul_f32 v[26:27], v[26:27], v[58:59]
  v_pk_mul_f32 v[28:29], v[28:29], v[60:61]
  v_pk_mul_f32 v[30:31], v[30:31], v[62:63]
  v_pk_add_f32 v[12:13], v[12:13], v[152:153]
  v_pk_fma_f32 v[14:15], v[152:153], v[152:153], v[14:15]
  v_pk_add_f32 v[12:13], v[12:13], v[154:155]
  v_pk_fma_f32 v[14:15], v[154:155], v[154:155], v[14:15]
  v_pk_fma_f32 v[48:49], v[32:33], v[32:33], s[20:21] neg_lo:[1,0,1] neg_hi:[1,0,1]
  v_pk_fma_f32 v[50:51], v[34:35], v[34:35], s[20:21] neg_lo:[1,0,1] neg_hi:[1,0,1]
  v_pk_fma_f32 v[52:53], v[36:37], v[36:37], s[20:21] neg_lo:[1,0,1] neg_hi:[1,0,1]
  v_pk_fma_f32 v[54:55], v[38:39], v[38:39], s[20:21] neg_lo:[1,0,1] neg_hi:[1,0,1]
  v_pk_fma_f32 v[56:57], v[40:41], v[40:41], s[20:21] neg_lo:[1,0,1] neg_hi:[1,0,1]
  v_pk_fma_f32 v[58:59], v[42:43], v[42:43], s[20:21] neg_lo:[1,0,1] neg_hi:[1,0,1]
  v_pk_fma_f32 v[60:61], v[44:45], v[44:45], s[20:21] neg_lo:[1,0,1] neg_hi:[1,0,1]
  v_pk_fma_f32 v[62:63], v[46:47], v[46:47], s[20:21] neg_lo:[1,0,1] neg_hi:[1,0,1]
  v_pk_mul_f32 v[48:49], v[32:33], v[48:49]
  v_pk_mul_f32 v[50:51], v[34:35], v[50:51]
  v_pk_mul_f32 v[52:53], v[36:37], v[52:53]
  v_pk_mul_f32 v[54:55], v[38:39], v[54:55]
  v_pk_mul_f32 v[56:57], v[40:41], v[56:57]
  v_pk_mul_f32 v[58:59], v[42:43], v[58:59]
  v_pk_mul_f32 v[60:61], v[44:45], v[60:61]
  v_pk_mul_f32 v[62:63], v[46:47], v[62:63]
  v_mfma_f32_16x16x32_bf16 v[156:159], v[216:219], v[220:223], 0
  v_cvt_pk_bf16_f32 v184, v16, v17
  v_cvt_pk_bf16_f32 v185, v18, v19
  v_mfma_f32_16x16x32_bf16 v[156:159], v[224:227], v[228:231], v[156:159]
  v_cvt_pk_bf16_f32 v186, v20, v21
  v_cvt_pk_bf16_f32 v187, v22, v23
  v_mfma_f32_16x16x32_bf16 v[156:159], v[232:235], v[236:239], v[156:159]
  ds_read_b128 v[216:219], v3
  ds_read_b128 v[220:223], v4
  v_mfma_f32_32x32x16_bf16 v[64:79], v[192:195], v[184:187], v[64:79]
  ds_read_b128 v[224:227], v3 offset:4800
  ds_read_b128 v[228:231], v4 offset:192
  v_cvt_pk_bf16_f32 v188, v24, v25
  v_cvt_pk_bf16_f32 v189, v26, v27
  v_cvt_pk_bf16_f32 v190, v28, v29
  v_cvt_pk_bf16_f32 v191, v30, v31
  v_mfma_f32_32x32x16_bf16 v[80:95], v[196:199], v[184:187], v[80:95]
  ds_read_b128 v[232:235], v3 offset:9600
  ds_read_b128 v[236:239], v4 offset:384
  v_exp_f32 v48, v48
  v_exp_f32 v49, v49
  v_mfma_f32_32x32x16_bf16 v[96:111], v[200:203], v[184:187], v[96:111]
  v_exp_f32 v50, v50
  v_exp_f32 v51, v51
  v_exp_f32_e64 v52, v52
  v_mfma_f32_32x32x16_bf16 v[64:79], v[204:207], v[188:191], v[64:79]
  v_exp_f32 v53, v53
  v_exp_f32 v54, v54
  v_exp_f32_e64 v55, v55
  v_mfma_f32_32x32x16_bf16 v[80:95], v[208:211], v[188:191], v[80:95]
  ds_read_b128 a[228:231], v0 offset:9216
  ds_read_b128 a[232:235], v0 offset:10240
  ds_read_b128 a[236:239], v0 offset:11264
  v_exp_f32 v56, v56
  v_exp_f32 v57, v57
  v_mfma_f32_32x32x16_bf16 v[96:111], v[212:215], v[188:191], v[96:111]
  s_waitcnt lgkmcnt(3)
  v_exp_f32 v58, v58
  v_exp_f32 v59, v59
  v_exp_f32 v60, v60
  v_exp_f32 v61, v61
  v_exp_f32 v62, v62
  v_exp_f32_e64 v63, v63
  v_pk_add_f32 v[12:13], v[12:13], v[156:157]
  v_pk_fma_f32 v[14:15], v[156:157], v[156:157], v[14:15]
  v_pk_add_f32 v[12:13], v[12:13], v[158:159]
  v_pk_fma_f32 v[14:15], v[158:159], v[158:159], v[14:15]
  v_pk_fma_f32 v[48:49], v[48:49], s[22:23], s[22:23]
  v_pk_fma_f32 v[50:51], v[50:51], s[22:23], s[22:23]
  v_pk_fma_f32 v[52:53], v[52:53], s[22:23], s[22:23]
  v_pk_fma_f32 v[54:55], v[54:55], s[22:23], s[22:23]
  v_pk_fma_f32 v[56:57], v[56:57], s[22:23], s[22:23]
  v_pk_fma_f32 v[58:59], v[58:59], s[22:23], s[22:23]
  v_pk_fma_f32 v[60:61], v[60:61], s[22:23], s[22:23]
  v_pk_fma_f32 v[62:63], v[62:63], s[22:23], s[22:23]
  v_mfma_f32_32x32x16_bf16 v[16:31], a[168:171], v[160:163], 0
  ds_read_b128 v[192:195], v0 offset:43008
  ds_read_b128 v[196:199], v0 offset:44032
  v_rcp_f32 v48, v48
  v_rcp_f32 v49, v49
  v_mfma_f32_16x16x32_bf16 v[112:115], v[216:219], v[220:223], 0
  ds_read_b128 v[216:219], v3 offset:400
  ds_read_b128 v[220:223], v4 offset:16
  v_mfma_f32_32x32x16_bf16 v[16:31], a[172:175], v[164:167], v[16:31]
  ds_read_b128 v[200:203], v0 offset:45056
  ds_read_b128 v[204:207], v0 offset:46080
  v_rcp_f32 v50, v50
  v_rcp_f32 v51, v51
  v_mfma_f32_16x16x32_bf16 v[112:115], v[224:227], v[228:231], v[112:115]
  ds_read_b128 v[224:227], v3 offset:5200
  ds_read_b128 v[228:231], v4 offset:208
  v_mfma_f32_32x32x16_bf16 v[16:31], a[176:179], v[168:171], v[16:31]
  ds_read_b128 v[208:211], v0 offset:47104
  ds_read_b128 v[212:215], v0 offset:48128
  v_rcp_f32 v52, v52
  v_rcp_f32 v53, v53
  v_mfma_f32_16x16x32_bf16 v[112:115], v[232:235], v[236:239], v[112:115]
  ds_read_b128 v[232:235], v3 offset:10000
  ds_read_b128 v[236:239], v4 offset:400
  v_mfma_f32_32x32x16_bf16 v[16:31], a[180:183], v[172:175], v[16:31]
  v_rcp_f32 v54, v54
  v_rcp_f32 v55, v55
  v_rcp_f32_e64 v56, v56
  v_mfma_f32_32x32x16_bf16 v[16:31], a[184:187], v[176:179], v[16:31]
  v_rcp_f32 v57, v57
  v_rcp_f32 v58, v58
  v_rcp_f32_e64 v59, v59
  v_mfma_f32_32x32x16_bf16 v[16:31], a[188:191], v[180:183], v[16:31]
  s_waitcnt lgkmcnt(0)
  v_rcp_f32 v60, v60
  v_rcp_f32 v61, v61
  v_rcp_f32 v62, v62
  v_rcp_f32_e64 v63, v63
  v_pk_mul_f32 v[32:33], v[32:33], v[48:49]
  v_pk_mul_f32 v[34:35], v[34:35], v[50:51]
  v_pk_mul_f32 v[36:37], v[36:37], v[52:53]
  v_pk_mul_f32 v[38:39], v[38:39], v[54:55]
  v_pk_mul_f32 v[40:41], v[40:41], v[56:57]
  v_pk_mul_f32 v[42:43], v[42:43], v[58:59]
  v_pk_mul_f32 v[44:45], v[44:45], v[60:61]
  v_pk_mul_f32 v[46:47], v[46:47], v[62:63]
  v_pk_add_f32 v[12:13], v[12:13], v[112:113]
  v_pk_fma_f32 v[14:15], v[112:113], v[112:113], v[14:15]
  v_pk_add_f32 v[12:13], v[12:13], v[114:115]
  v_pk_fma_f32 v[14:15], v[114:115], v[114:115], v[14:15]
  v_pk_fma_f32 v[48:49], v[16:17], v[16:17], s[20:21] neg_lo:[1,0,1] neg_hi:[1,0,1]
  v_pk_fma_f32 v[50:51], v[18:19], v[18:19], s[20:21] neg_lo:[1,0,1] neg_hi:[1,0,1]
  v_pk_fma_f32 v[52:53], v[20:21], v[20:21], s[20:21] neg_lo:[1,0,1] neg_hi:[1,0,1]
  v_pk_fma_f32 v[54:55], v[22:23], v[22:23], s[20:21] neg_lo:[1,0,1] neg_hi:[1,0,1]
  v_pk_fma_f32 v[56:57], v[24:25], v[24:25], s[20:21] neg_lo:[1,0,1] neg_hi:[1,0,1]
  v_pk_fma_f32 v[58:59], v[26:27], v[26:27], s[20:21] neg_lo:[1,0,1] neg_hi:[1,0,1]
  v_pk_fma_f32 v[60:61], v[28:29], v[28:29], s[20:21] neg_lo:[1,0,1] neg_hi:[1,0,1]
  v_pk_fma_f32 v[62:63], v[30:31], v[30:31], s[20:21] neg_lo:[1,0,1] neg_hi:[1,0,1]
  v_pk_mul_f32 v[48:49], v[16:17], v[48:49]
  v_pk_mul_f32 v[50:51], v[18:19], v[50:51]
  v_pk_mul_f32 v[52:53], v[20:21], v[52:53]
  v_pk_mul_f32 v[54:55], v[22:23], v[54:55]
  v_pk_mul_f32 v[56:57], v[24:25], v[56:57]
  v_pk_mul_f32 v[58:59], v[26:27], v[58:59]
  v_pk_mul_f32 v[60:61], v[28:29], v[60:61]
  v_pk_mul_f32 v[62:63], v[30:31], v[62:63]
  v_mfma_f32_16x16x32_bf16 v[116:119], v[216:219], v[220:223], 0
  v_cvt_pk_bf16_f32 v184, v32, v33
  v_cvt_pk_bf16_f32 v185, v34, v35
  v_mfma_f32_16x16x32_bf16 v[116:119], v[224:227], v[228:231], v[116:119]
  v_cvt_pk_bf16_f32 v186, v36, v37
  v_cvt_pk_bf16_f32 v187, v38, v39
  v_mfma_f32_16x16x32_bf16 v[116:119], v[232:235], v[236:239], v[116:119]
  ds_read_b128 v[216:219], v3 offset:800
  ds_read_b128 v[220:223], v4 offset:32
  v_mfma_f32_32x32x16_bf16 v[64:79], v[192:195], v[184:187], v[64:79]
  ds_read_b128 v[224:227], v3 offset:5600
  ds_read_b128 v[228:231], v4 offset:224
  v_cvt_pk_bf16_f32 v188, v40, v41
  v_cvt_pk_bf16_f32 v189, v42, v43
  v_cvt_pk_bf16_f32 v190, v44, v45
  v_cvt_pk_bf16_f32 v191, v46, v47
  v_mfma_f32_32x32x16_bf16 v[80:95], v[196:199], v[184:187], v[80:95]
  ds_read_b128 v[232:235], v3 offset:10400
  ds_read_b128 v[236:239], v4 offset:416
  v_exp_f32 v48, v48
  v_exp_f32 v49, v49
  v_mfma_f32_32x32x16_bf16 v[96:111], v[200:203], v[184:187], v[96:111]
  v_exp_f32 v50, v50
  v_exp_f32 v51, v51
  v_exp_f32_e64 v52, v52
  v_mfma_f32_32x32x16_bf16 v[64:79], v[204:207], v[188:191], v[64:79]
  v_exp_f32 v53, v53
  v_exp_f32 v54, v54
  v_exp_f32_e64 v55, v55
  v_mfma_f32_32x32x16_bf16 v[80:95], v[208:211], v[188:191], v[80:95]
  v_exp_f32 v56, v56
  v_exp_f32 v57, v57
  v_exp_f32_e64 v58, v58
  v_mfma_f32_32x32x16_bf16 v[96:111], v[212:215], v[188:191], v[96:111]
  s_waitcnt lgkmcnt(0)
  v_exp_f32 v59, v59
  v_exp_f32 v60, v60
  v_exp_f32 v61, v61
  v_exp_f32 v62, v62
  v_exp_f32 v63, v63
  v_pk_add_f32 v[12:13], v[12:13], v[116:117]
  v_pk_fma_f32 v[14:15], v[116:117], v[116:117], v[14:15]
  v_pk_add_f32 v[12:13], v[12:13], v[118:119]
  v_pk_fma_f32 v[14:15], v[118:119], v[118:119], v[14:15]
  v_pk_fma_f32 v[48:49], v[48:49], s[22:23], s[22:23]
  v_pk_fma_f32 v[50:51], v[50:51], s[22:23], s[22:23]
  v_pk_fma_f32 v[52:53], v[52:53], s[22:23], s[22:23]
  v_pk_fma_f32 v[54:55], v[54:55], s[22:23], s[22:23]
  v_pk_fma_f32 v[56:57], v[56:57], s[22:23], s[22:23]
  v_pk_fma_f32 v[58:59], v[58:59], s[22:23], s[22:23]
  v_pk_fma_f32 v[60:61], v[60:61], s[22:23], s[22:23]
  v_pk_fma_f32 v[62:63], v[62:63], s[22:23], s[22:23]
  v_mfma_f32_32x32x16_bf16 v[32:47], a[192:195], v[160:163], 0
  ds_read_b128 v[192:195], v0 offset:49152
  ds_read_b128 v[196:199], v0 offset:50176
  v_rcp_f32 v48, v48
  v_rcp_f32 v49, v49
  v_mfma_f32_16x16x32_bf16 v[120:123], v[216:219], v[220:223], 0
  ds_read_b128 v[216:219], v3 offset:1200
  ds_read_b128 v[220:223], v4 offset:48
  v_mfma_f32_32x32x16_bf16 v[32:47], a[196:199], v[164:167], v[32:47]
  ds_read_b128 v[200:203], v0 offset:51200
  ds_read_b128 v[204:207], v0 offset:52224
  v_rcp_f32 v50, v50
  v_rcp_f32 v51, v51
  v_mfma_f32_16x16x32_bf16 v[120:123], v[224:227], v[228:231], v[120:123]
  ds_read_b128 v[224:227], v3 offset:6000
  ds_read_b128 v[228:231], v4 offset:240
  v_mfma_f32_32x32x16_bf16 v[32:47], a[200:203], v[168:171], v[32:47]
  ds_read_b128 v[208:211], v0 offset:53248
  ds_read_b128 v[212:215], v0 offset:54272
  v_rcp_f32 v52, v52
  v_rcp_f32 v53, v53
  v_mfma_f32_16x16x32_bf16 v[120:123], v[232:235], v[236:239], v[120:123]
  ds_read_b128 v[232:235], v3 offset:10800
  ds_read_b128 v[236:239], v4 offset:432
  v_mfma_f32_32x32x16_bf16 v[32:47], a[204:207], v[172:175], v[32:47]
  v_rcp_f32 v54, v54
  v_rcp_f32 v55, v55
  v_rcp_f32_e64 v56, v56
  v_mfma_f32_32x32x16_bf16 v[32:47], a[208:211], v[176:179], v[32:47]
  v_rcp_f32 v57, v57
  v_rcp_f32 v58, v58
  v_rcp_f32_e64 v59, v59
  v_mfma_f32_32x32x16_bf16 v[32:47], a[212:215], v[180:183], v[32:47]
  s_waitcnt lgkmcnt(0)
  v_rcp_f32 v60, v60
  v_rcp_f32 v61, v61
  v_rcp_f32 v62, v62
  v_rcp_f32_e64 v63, v63
  v_pk_mul_f32 v[16:17], v[16:17], v[48:49]
  v_pk_mul_f32 v[18:19], v[18:19], v[50:51]
  v_pk_mul_f32 v[20:21], v[20:21], v[52:53]
  v_pk_mul_f32 v[22:23], v[22:23], v[54:55]
  v_pk_mul_f32 v[24:25], v[24:25], v[56:57]
  v_pk_mul_f32 v[26:27], v[26:27], v[58:59]
  v_pk_mul_f32 v[28:29], v[28:29], v[60:61]
  v_pk_mul_f32 v[30:31], v[30:31], v[62:63]
  v_pk_add_f32 v[12:13], v[12:13], v[120:121]
  v_pk_fma_f32 v[14:15], v[120:121], v[120:121], v[14:15]
  v_pk_add_f32 v[12:13], v[12:13], v[122:123]
  v_pk_fma_f32 v[14:15], v[122:123], v[122:123], v[14:15]
  v_pk_fma_f32 v[48:49], v[32:33], v[32:33], s[20:21] neg_lo:[1,0,1] neg_hi:[1,0,1]
  v_pk_fma_f32 v[50:51], v[34:35], v[34:35], s[20:21] neg_lo:[1,0,1] neg_hi:[1,0,1]
  v_pk_fma_f32 v[52:53], v[36:37], v[36:37], s[20:21] neg_lo:[1,0,1] neg_hi:[1,0,1]
  v_pk_fma_f32 v[54:55], v[38:39], v[38:39], s[20:21] neg_lo:[1,0,1] neg_hi:[1,0,1]
  v_pk_fma_f32 v[56:57], v[40:41], v[40:41], s[20:21] neg_lo:[1,0,1] neg_hi:[1,0,1]
  v_pk_fma_f32 v[58:59], v[42:43], v[42:43], s[20:21] neg_lo:[1,0,1] neg_hi:[1,0,1]
  v_pk_fma_f32 v[60:61], v[44:45], v[44:45], s[20:21] neg_lo:[1,0,1] neg_hi:[1,0,1]
  v_pk_fma_f32 v[62:63], v[46:47], v[46:47], s[20:21] neg_lo:[1,0,1] neg_hi:[1,0,1]
  v_pk_mul_f32 v[48:49], v[32:33], v[48:49]
  v_pk_mul_f32 v[50:51], v[34:35], v[50:51]
  v_pk_mul_f32 v[52:53], v[36:37], v[52:53]
  v_pk_mul_f32 v[54:55], v[38:39], v[54:55]
  v_pk_mul_f32 v[56:57], v[40:41], v[56:57]
  v_pk_mul_f32 v[58:59], v[42:43], v[58:59]
  v_pk_mul_f32 v[60:61], v[44:45], v[60:61]
  v_pk_mul_f32 v[62:63], v[46:47], v[62:63]
  v_mfma_f32_16x16x32_bf16 v[124:127], v[216:219], v[220:223], 0
  v_cvt_pk_bf16_f32 v184, v16, v17
  v_cvt_pk_bf16_f32 v185, v18, v19
  v_mfma_f32_16x16x32_bf16 v[124:127], v[224:227], v[228:231], v[124:127]
  v_cvt_pk_bf16_f32 v186, v20, v21
  v_cvt_pk_bf16_f32 v187, v22, v23
  v_mfma_f32_16x16x32_bf16 v[124:127], v[232:235], v[236:239], v[124:127]
  ds_read_b128 v[216:219], v3 offset:1600
  ds_read_b128 v[220:223], v4 offset:64
  v_mfma_f32_32x32x16_bf16 v[64:79], v[192:195], v[184:187], v[64:79]
  ds_read_b128 v[224:227], v3 offset:6400
  ds_read_b128 v[228:231], v4 offset:256
  v_cvt_pk_bf16_f32 v188, v24, v25
  v_cvt_pk_bf16_f32 v189, v26, v27
  v_cvt_pk_bf16_f32 v190, v28, v29
  v_cvt_pk_bf16_f32 v191, v30, v31
  v_mfma_f32_32x32x16_bf16 v[80:95], v[196:199], v[184:187], v[80:95]
  ds_read_b128 v[232:235], v3 offset:11200
  ds_read_b128 v[236:239], v4 offset:448
  v_exp_f32 v48, v48
  v_exp_f32 v49, v49
  v_mfma_f32_32x32x16_bf16 v[96:111], v[200:203], v[184:187], v[96:111]
  v_exp_f32 v50, v50
  v_exp_f32 v51, v51
  v_exp_f32_e64 v52, v52
  v_mfma_f32_32x32x16_bf16 v[64:79], v[204:207], v[188:191], v[64:79]
  v_exp_f32 v53, v53
  v_exp_f32 v54, v54
  v_exp_f32_e64 v55, v55
  v_mfma_f32_32x32x16_bf16 v[80:95], v[208:211], v[188:191], v[80:95]
  v_exp_f32 v56, v56
  v_exp_f32 v57, v57
  v_exp_f32_e64 v58, v58
  v_mfma_f32_32x32x16_bf16 v[96:111], v[212:215], v[188:191], v[96:111]
  s_waitcnt lgkmcnt(0)
  v_exp_f32 v59, v59
  v_exp_f32 v60, v60
  v_exp_f32 v61, v61
  v_exp_f32 v62, v62
  v_exp_f32 v63, v63
  v_pk_add_f32 v[12:13], v[12:13], v[124:125]
  v_pk_fma_f32 v[14:15], v[124:125], v[124:125], v[14:15]
  v_pk_add_f32 v[12:13], v[12:13], v[126:127]
  v_pk_fma_f32 v[14:15], v[126:127], v[126:127], v[14:15]
  v_pk_fma_f32 v[48:49], v[48:49], s[22:23], s[22:23]
  v_pk_fma_f32 v[50:51], v[50:51], s[22:23], s[22:23]
  v_pk_fma_f32 v[52:53], v[52:53], s[22:23], s[22:23]
  v_pk_fma_f32 v[54:55], v[54:55], s[22:23], s[22:23]
  v_pk_fma_f32 v[56:57], v[56:57], s[22:23], s[22:23]
  v_pk_fma_f32 v[58:59], v[58:59], s[22:23], s[22:23]
  v_pk_fma_f32 v[60:61], v[60:61], s[22:23], s[22:23]
  v_pk_fma_f32 v[62:63], v[62:63], s[22:23], s[22:23]
  v_mfma_f32_32x32x16_bf16 v[16:31], a[216:219], v[160:163], 0
  ds_read_b128 v[192:195], v0 offset:55296
  ds_read_b128 v[196:199], v0 offset:56320
  v_rcp_f32 v48, v48
  v_rcp_f32 v49, v49
  v_mfma_f32_16x16x32_bf16 v[128:131], v[216:219], v[220:223], 0
  ds_read_b128 v[216:219], v3 offset:2000
  ds_read_b128 v[220:223], v4 offset:80
  v_mfma_f32_32x32x16_bf16 v[16:31], a[220:223], v[164:167], v[16:31]
  ds_read_b128 v[200:203], v0 offset:57344
  ds_read_b128 v[204:207], v0 offset:58368
  v_rcp_f32 v50, v50
  v_rcp_f32 v51, v51
  v_mfma_f32_16x16x32_bf16 v[128:131], v[224:227], v[228:231], v[128:131]
  ds_read_b128 v[224:227], v3 offset:6800
  ds_read_b128 v[228:231], v4 offset:272
  v_mfma_f32_32x32x16_bf16 v[16:31], a[224:227], v[168:171], v[16:31]
  ds_read_b128 v[208:211], v0 offset:59392
  ds_read_b128 v[212:215], v0 offset:60416
  v_rcp_f32 v52, v52
  v_rcp_f32 v53, v53
  v_mfma_f32_16x16x32_bf16 v[128:131], v[232:235], v[236:239], v[128:131]
  ds_read_b128 v[232:235], v3 offset:11600
  ds_read_b128 v[236:239], v4 offset:464
  v_mfma_f32_32x32x16_bf16 v[16:31], a[228:231], v[172:175], v[16:31]
  v_rcp_f32 v54, v54
  v_rcp_f32 v55, v55
  v_rcp_f32_e64 v56, v56
  v_mfma_f32_32x32x16_bf16 v[16:31], a[232:235], v[176:179], v[16:31]
  v_rcp_f32 v57, v57
  v_rcp_f32 v58, v58
  v_rcp_f32_e64 v59, v59
  v_mfma_f32_32x32x16_bf16 v[16:31], a[236:239], v[180:183], v[16:31]
  s_waitcnt lgkmcnt(0)
  v_rcp_f32 v60, v60
  v_rcp_f32 v61, v61
  v_rcp_f32 v62, v62
  v_rcp_f32_e64 v63, v63
  v_pk_mul_f32 v[32:33], v[32:33], v[48:49]
  v_pk_mul_f32 v[34:35], v[34:35], v[50:51]
  v_pk_mul_f32 v[36:37], v[36:37], v[52:53]
  v_pk_mul_f32 v[38:39], v[38:39], v[54:55]
  v_pk_mul_f32 v[40:41], v[40:41], v[56:57]
  v_pk_mul_f32 v[42:43], v[42:43], v[58:59]
  v_pk_mul_f32 v[44:45], v[44:45], v[60:61]
  v_pk_mul_f32 v[46:47], v[46:47], v[62:63]
  v_pk_add_f32 v[12:13], v[12:13], v[128:129]
  v_pk_fma_f32 v[14:15], v[128:129], v[128:129], v[14:15]
  v_pk_add_f32 v[12:13], v[12:13], v[130:131]
  v_pk_fma_f32 v[14:15], v[130:131], v[130:131], v[14:15]
  v_pk_fma_f32 v[48:49], v[16:17], v[16:17], s[20:21] neg_lo:[1,0,1] neg_hi:[1,0,1]
  v_pk_fma_f32 v[50:51], v[18:19], v[18:19], s[20:21] neg_lo:[1,0,1] neg_hi:[1,0,1]
  v_pk_fma_f32 v[52:53], v[20:21], v[20:21], s[20:21] neg_lo:[1,0,1] neg_hi:[1,0,1]
  v_pk_fma_f32 v[54:55], v[22:23], v[22:23], s[20:21] neg_lo:[1,0,1] neg_hi:[1,0,1]
  v_pk_fma_f32 v[56:57], v[24:25], v[24:25], s[20:21] neg_lo:[1,0,1] neg_hi:[1,0,1]
  v_pk_fma_f32 v[58:59], v[26:27], v[26:27], s[20:21] neg_lo:[1,0,1] neg_hi:[1,0,1]
  v_pk_fma_f32 v[60:61], v[28:29], v[28:29], s[20:21] neg_lo:[1,0,1] neg_hi:[1,0,1]
  v_pk_fma_f32 v[62:63], v[30:31], v[30:31], s[20:21] neg_lo:[1,0,1] neg_hi:[1,0,1]
  v_pk_mul_f32 v[48:49], v[16:17], v[48:49]
  v_pk_mul_f32 v[50:51], v[18:19], v[50:51]
  v_pk_mul_f32 v[52:53], v[20:21], v[52:53]
  v_pk_mul_f32 v[54:55], v[22:23], v[54:55]
  v_pk_mul_f32 v[56:57], v[24:25], v[56:57]
  v_pk_mul_f32 v[58:59], v[26:27], v[58:59]
  v_pk_mul_f32 v[60:61], v[28:29], v[60:61]
  v_pk_mul_f32 v[62:63], v[30:31], v[62:63]
  v_mfma_f32_16x16x32_bf16 v[132:135], v[216:219], v[220:223], 0
  v_cvt_pk_bf16_f32 v184, v32, v33
  v_cvt_pk_bf16_f32 v185, v34, v35
  v_mfma_f32_16x16x32_bf16 v[132:135], v[224:227], v[228:231], v[132:135]
  v_cvt_pk_bf16_f32 v186, v36, v37
  v_cvt_pk_bf16_f32 v187, v38, v39
  v_mfma_f32_16x16x32_bf16 v[132:135], v[232:235], v[236:239], v[132:135]
  ds_read_b128 v[216:219], v0 offset:12288
  ds_read_b128 v[220:223], v0 offset:13312
  v_mfma_f32_32x32x16_bf16 v[64:79], v[192:195], v[184:187], v[64:79]
  ds_read_b128 v[224:227], v0 offset:14336
  ds_read_b128 v[228:231], v0 offset:15360
  v_cvt_pk_bf16_f32 v188, v40, v41
  v_cvt_pk_bf16_f32 v189, v42, v43
  v_cvt_pk_bf16_f32 v190, v44, v45
  v_cvt_pk_bf16_f32 v191, v46, v47
  v_mfma_f32_32x32x16_bf16 v[80:95], v[196:199], v[184:187], v[80:95]
  ds_read_b128 v[232:235], v0 offset:16384
  ds_read_b128 v[236:239], v0 offset:17408
  v_exp_f32 v48, v48
  v_exp_f32 v49, v49
  v_mfma_f32_32x32x16_bf16 v[96:111], v[200:203], v[184:187], v[96:111]
  v_exp_f32 v50, v50
  v_exp_f32 v51, v51
  v_exp_f32_e64 v52, v52
  v_mfma_f32_32x32x16_bf16 v[64:79], v[204:207], v[188:191], v[64:79]
  s_mov_b32 s28, s34
  v_exp_f32 v53, v53
  v_exp_f32 v54, v54
  v_exp_f32 v55, v55
  v_mfma_f32_32x32x16_bf16 v[80:95], v[208:211], v[188:191], v[80:95]
  s_add_u32 s34, s34, 0x60000
  v_exp_f32 v56, v56
  v_exp_f32 v57, v57
  v_exp_f32_e64 v58, v58
  v_mfma_f32_32x32x16_bf16 v[96:111], v[212:215], v[188:191], v[96:111]
  s_waitcnt lgkmcnt(0)
  v_exp_f32 v59, v59
  v_exp_f32 v60, v60
  v_exp_f32 v61, v61
  v_exp_f32 v62, v62
  v_exp_f32 v63, v63
  v_pk_add_f32 v[12:13], v[12:13], v[132:133]
  v_pk_fma_f32 v[14:15], v[132:133], v[132:133], v[14:15]
  v_pk_add_f32 v[12:13], v[12:13], v[134:135]
  v_pk_fma_f32 v[14:15], v[134:135], v[134:135], v[14:15]
  v_pk_fma_f32 v[48:49], v[48:49], s[22:23], s[22:23]
  v_pk_fma_f32 v[50:51], v[50:51], s[22:23], s[22:23]
  v_pk_fma_f32 v[52:53], v[52:53], s[22:23], s[22:23]
  v_pk_fma_f32 v[54:55], v[54:55], s[22:23], s[22:23]
  v_pk_fma_f32 v[56:57], v[56:57], s[22:23], s[22:23]
  v_pk_fma_f32 v[58:59], v[58:59], s[22:23], s[22:23]
  v_pk_fma_f32 v[60:61], v[60:61], s[22:23], s[22:23]
  v_pk_fma_f32 v[62:63], v[62:63], s[22:23], s[22:23]
  v_mfma_f32_32x32x16_bf16 v[32:47], v[216:219], v[160:163], 0
  ds_read_b128 v[192:195], v0 offset:61440
  ds_read_b128 v[196:199], v0 offset:62464
  v_rcp_f32 v48, v48
  v_rcp_f32 v49, v49
  v_add_f32_e64 v12, v12, v13
  v_mfma_f32_32x32x16_bf16 v[32:47], v[220:223], v[164:167], v[32:47]
  ds_read_b128 v[200:203], v0 offset:63488
  ds_read_b128 v[204:207], v0 offset:64512
  v_rcp_f32 v50, v50
  v_add_f32 v14, v14, v15
  v_rcp_f32_e64 v51, v51
  v_mfma_f32_32x32x16_bf16 v[32:47], v[224:227], v[168:171], v[32:47]
  ds_read_b128 v[208:211], v1
  ds_read_b128 v[212:215], v1 offset:1024
  v_permlane32_swap_b32 v12, v14
  v_rcp_f32 v52, v52
  v_add_f32 v12, v12, v14
  v_rcp_f32 v53, v53
  v_mfma_f32_32x32x16_bf16 v[32:47], v[228:231], v[172:175], v[32:47]
  v_mov_b32 v14, v12
  v_rcp_f32 v54, v54
  s_nop 0
  v_permlane32_swap_b32 v12, v14
  v_rcp_f32 v55, v55
  v_mul_f32 v12, s24, v12
  v_mfma_f32_32x32x16_bf16 v[32:47], v[232:235], v[176:179], v[32:47]
  v_rcp_f32 v56, v56
  v_rcp_f32 v57, v57
  v_mul_f32 v13, s24, v14
  v_rcp_f32 v58, v58
  v_fma_f32 v13, -v12, v12, v13
  v_mfma_f32_32x32x16_bf16 v[32:47], v[236:239], v[180:183], v[32:47]
  s_waitcnt lgkmcnt(0)
  v_rcp_f32 v59, v59
  v_max_f32 v13, 0, v13
  v_rcp_f32 v60, v60
  v_add_f32 v13, s25, v13
  v_rcp_f32 v61, v61
  v_rsq_f32 v13, v13
  v_rcp_f32 v62, v62
  v_mul_f32 v14, s22, v13
  v_rcp_f32 v63, v63
  v_mul_f32_e64 v12, -v12, v14
  v_pk_mul_f32 v[16:17], v[16:17], v[48:49]
  v_pk_mul_f32 v[18:19], v[18:19], v[50:51]
  v_pk_mul_f32 v[20:21], v[20:21], v[52:53]
  v_pk_mul_f32 v[22:23], v[22:23], v[54:55]
  v_pk_mul_f32 v[24:25], v[24:25], v[56:57]
  v_pk_mul_f32 v[26:27], v[26:27], v[58:59]
  v_pk_mul_f32 v[28:29], v[28:29], v[60:61]
  v_pk_mul_f32 v[30:31], v[30:31], v[62:63]
  v_pk_fma_f32 v[112:113], v[112:113], v[14:15], v[12:13] op_sel_hi:[1,0,0]
  v_pk_fma_f32 v[114:115], v[114:115], v[14:15], v[12:13] op_sel_hi:[1,0,0]
  v_pk_fma_f32 v[116:117], v[116:117], v[14:15], v[12:13] op_sel_hi:[1,0,0]
  v_pk_fma_f32 v[118:119], v[118:119], v[14:15], v[12:13] op_sel_hi:[1,0,0]
  v_pk_fma_f32 v[120:121], v[120:121], v[14:15], v[12:13] op_sel_hi:[1,0,0]
  v_pk_fma_f32 v[122:123], v[122:123], v[14:15], v[12:13] op_sel_hi:[1,0,0]
  v_pk_fma_f32 v[124:125], v[124:125], v[14:15], v[12:13] op_sel_hi:[1,0,0]
  v_pk_fma_f32 v[126:127], v[126:127], v[14:15], v[12:13] op_sel_hi:[1,0,0]
  v_pk_fma_f32 v[128:129], v[128:129], v[14:15], v[12:13] op_sel_hi:[1,0,0]
  v_pk_fma_f32 v[130:131], v[130:131], v[14:15], v[12:13] op_sel_hi:[1,0,0]
  v_pk_fma_f32 v[132:133], v[132:133], v[14:15], v[12:13] op_sel_hi:[1,0,0]
  v_pk_fma_f32 v[134:135], v[134:135], v[14:15], v[12:13] op_sel_hi:[1,0,0]
  v_pk_fma_f32 v[136:137], v[136:137], v[14:15], v[12:13] op_sel_hi:[1,0,0]
  v_pk_fma_f32 v[138:139], v[138:139], v[14:15], v[12:13] op_sel_hi:[1,0,0]
  v_pk_fma_f32 v[140:141], v[140:141], v[14:15], v[12:13] op_sel_hi:[1,0,0]
  v_pk_fma_f32 v[142:143], v[142:143], v[14:15], v[12:13] op_sel_hi:[1,0,0]
  v_pk_fma_f32 v[144:145], v[144:145], v[14:15], v[12:13] op_sel_hi:[1,0,0]
  v_pk_fma_f32 v[146:147], v[146:147], v[14:15], v[12:13] op_sel_hi:[1,0,0]
  v_pk_fma_f32 v[148:149], v[148:149], v[14:15], v[12:13] op_sel_hi:[1,0,0]
  v_pk_fma_f32 v[150:151], v[150:151], v[14:15], v[12:13] op_sel_hi:[1,0,0]
  v_pk_fma_f32 v[152:153], v[152:153], v[14:15], v[12:13] op_sel_hi:[1,0,0]
  v_pk_fma_f32 v[154:155], v[154:155], v[14:15], v[12:13] op_sel_hi:[1,0,0]
  v_pk_fma_f32 v[156:157], v[156:157], v[14:15], v[12:13] op_sel_hi:[1,0,0]
  v_pk_fma_f32 v[158:159], v[158:159], v[14:15], v[12:13] op_sel_hi:[1,0,0]
  v_pk_fma_f32 v[48:49], v[32:33], v[32:33], s[20:21] neg_lo:[1,0,1] neg_hi:[1,0,1]
  v_pk_fma_f32 v[50:51], v[34:35], v[34:35], s[20:21] neg_lo:[1,0,1] neg_hi:[1,0,1]
  v_pk_fma_f32 v[52:53], v[36:37], v[36:37], s[20:21] neg_lo:[1,0,1] neg_hi:[1,0,1]
  v_pk_fma_f32 v[54:55], v[38:39], v[38:39], s[20:21] neg_lo:[1,0,1] neg_hi:[1,0,1]
  v_pk_fma_f32 v[56:57], v[40:41], v[40:41], s[20:21] neg_lo:[1,0,1] neg_hi:[1,0,1]
  v_pk_fma_f32 v[58:59], v[42:43], v[42:43], s[20:21] neg_lo:[1,0,1] neg_hi:[1,0,1]
  v_pk_fma_f32 v[60:61], v[44:45], v[44:45], s[20:21] neg_lo:[1,0,1] neg_hi:[1,0,1]
  v_pk_fma_f32 v[62:63], v[46:47], v[46:47], s[20:21] neg_lo:[1,0,1] neg_hi:[1,0,1]
  v_pk_mul_f32 v[48:49], v[32:33], v[48:49]
  v_pk_mul_f32 v[50:51], v[34:35], v[50:51]
  v_pk_mul_f32 v[52:53], v[36:37], v[52:53]
  v_pk_mul_f32 v[54:55], v[38:39], v[54:55]
  v_pk_mul_f32 v[56:57], v[40:41], v[56:57]
  v_cvt_pk_bf16_f32 v184, v16, v17
  v_cvt_pk_bf16_f32 v185, v18, v19
  v_cvt_pk_bf16_f32 v186, v20, v21
  v_cvt_pk_bf16_f32 v187, v22, v23
  v_pk_mul_f32 v[58:59], v[42:43], v[58:59]
  v_pk_mul_f32 v[60:61], v[44:45], v[60:61]
  v_pk_mul_f32 v[62:63], v[46:47], v[62:63]
  v_mfma_f32_32x32x16_bf16 v[64:79], v[192:195], v[184:187], v[64:79]
  ds_read_b128 v[216:219], v0 offset:18432
  ds_read_b128 v[220:223], v0 offset:19456
  v_cvt_pk_bf16_f32 v188, v24, v25
  v_cvt_pk_bf16_f32 v189, v26, v27
  v_cvt_pk_bf16_f32 v190, v28, v29
  v_cvt_pk_bf16_f32 v191, v30, v31
  v_exp_f32_e64 v48, v48
  v_cndmask_b32 v159, v159, v250, s[12:13]
  v_mfma_f32_32x32x16_bf16 v[80:95], v[196:199], v[184:187], v[80:95]
  ds_read_b128 v[224:227], v0 offset:20480
  ds_read_b128 v[228:231], v0 offset:21504
  v_exp_f32_e64 v49, v49
  v_cvt_pk_bf16_f32 v160, v112, v113
  v_cvt_pk_bf16_f32 v161, v114, v115
  v_exp_f32_e64 v50, v50
  v_cvt_pk_bf16_f32 v162, v116, v117
  v_mfma_f32_32x32x16_bf16 v[96:111], v[200:203], v[184:187], v[96:111]
  ds_read_b128 v[232:235], v0 offset:22528
  ds_read_b128 v[236:239], v0 offset:23552
  v_exp_f32_e64 v51, v51
  v_cvt_pk_bf16_f32 v163, v118, v119
  v_cvt_pk_bf16_f32 v164, v120, v121
  v_exp_f32_e64 v52, v52
  v_cvt_pk_bf16_f32 v165, v122, v123
  v_mfma_f32_32x32x16_bf16 v[64:79], v[204:207], v[188:191], v[64:79]
  v_exp_f32_e64 v53, v53
  v_cvt_pk_bf16_f32 v166, v124, v125
  v_cvt_pk_bf16_f32 v167, v126, v127
  v_exp_f32_e64 v54, v54
  v_cvt_pk_bf16_f32 v168, v128, v129
  v_exp_f32_e64 v55, v55
  v_cvt_pk_bf16_f32 v169, v130, v131
  v_cvt_pk_bf16_f32 v170, v132, v133
  v_mfma_f32_32x32x16_bf16 v[80:95], v[208:211], v[188:191], v[80:95]
  v_exp_f32_e64 v56, v56
  v_cvt_pk_bf16_f32 v171, v134, v135
  v_cvt_pk_bf16_f32 v172, v136, v137
  v_exp_f32_e64 v57, v57
  v_cvt_pk_bf16_f32 v173, v138, v139
  v_exp_f32_e64 v58, v58
  v_cvt_pk_bf16_f32 v174, v140, v141
  v_cvt_pk_bf16_f32 v175, v142, v143
  v_mfma_f32_32x32x16_bf16 v[96:111], v[212:215], v[188:191], v[96:111]
  s_waitcnt lgkmcnt(0)
  v_exp_f32 v59, v59
  v_cvt_pk_bf16_f32 v176, v144, v145
  v_exp_f32_e64 v60, v60
  v_cvt_pk_bf16_f32 v177, v146, v147
  v_cvt_pk_bf16_f32 v178, v148, v149
  v_exp_f32_e64 v61, v61
  v_cvt_pk_bf16_f32 v179, v150, v151
  v_exp_f32_e64 v62, v62
  v_cvt_pk_bf16_f32 v180, v152, v153
  v_cvt_pk_bf16_f32 v181, v154, v155
  v_exp_f32_e64 v63, v63
  v_cvt_pk_bf16_f32 v182, v156, v157
  v_cvt_pk_bf16_f32 v183, v158, v159
  v_pk_fma_f32 v[48:49], v[48:49], s[22:23], s[22:23]
  v_pk_fma_f32 v[50:51], v[50:51], s[22:23], s[22:23]
  v_pk_fma_f32 v[52:53], v[52:53], s[22:23], s[22:23]
  v_pk_fma_f32 v[54:55], v[54:55], s[22:23], s[22:23]
  v_pk_fma_f32 v[56:57], v[56:57], s[22:23], s[22:23]
  v_pk_fma_f32 v[58:59], v[58:59], s[22:23], s[22:23]
  v_pk_fma_f32 v[60:61], v[60:61], s[22:23], s[22:23]
  v_pk_fma_f32 v[62:63], v[62:63], s[22:23], s[22:23]
  s_mov_b32 s26, 6
  .p2align 6
  s_nop 0
  s_waitcnt vmcnt(0)
L_loop:
  v_mfma_f32_32x32x16_bf16 v[16:31], v[216:219], v[160:163], 0
  ds_read_b128 v[192:195], v1 offset:2048
  ds_read_b128 v[196:199], v1 offset:3072
  ds_read_b128 v[200:203], v1 offset:4096
  v_rcp_f32 v48, v48
  v_rcp_f32 v49, v49
  v_mfma_f32_32x32x16_bf16 v[16:31], v[220:223], v[164:167], v[16:31]
  ds_read_b128 v[204:207], v1 offset:5120
  ds_read_b128 v[208:211], v1 offset:6144
  ds_read_b128 v[212:215], v1 offset:7168
  v_rcp_f32 v50, v50
  v_rcp_f32 v51, v51
  v_mfma_f32_32x32x16_bf16 v[16:31], v[224:227], v[168:171], v[16:31]
  ds_read_b128 v[136:139], v5
  ds_read_b128 v[140:143], v5 offset:32
  ds_read_b128 v[144:147], v5 offset:64
  v_rcp_f32 v52, v52
  v_rcp_f32 v53, v53
  v_mfma_f32_32x32x16_bf16 v[16:31], v[228:231], v[172:175], v[16:31]
  ds_read_b128 v[148:151], v5 offset:96
  ds_read_b128 v[152:155], v5 offset:128
  ds_read_b128 v[156:159], v5 offset:160
  v_rcp_f32 v54, v54
  v_rcp_f32 v55, v55
  v_mfma_f32_32x32x16_bf16 v[16:31], v[232:235], v[176:179], v[16:31]
  v_rcp_f32 v56, v56
  v_rcp_f32 v57, v57
  v_rcp_f32_e64 v58, v58
  v_mfma_f32_32x32x16_bf16 v[16:31], v[236:239], v[180:183], v[16:31]
  s_waitcnt lgkmcnt(0)
  v_rcp_f32 v59, v59
  v_rcp_f32 v60, v60
  v_rcp_f32 v61, v61
  v_rcp_f32 v62, v62
  v_rcp_f32 v63, v63
  v_pk_mul_f32 v[32:33], v[32:33], v[48:49]
  v_pk_mul_f32 v[34:35], v[34:35], v[50:51]
  v_pk_mul_f32 v[36:37], v[36:37], v[52:53]
  v_pk_mul_f32 v[38:39], v[38:39], v[54:55]
  v_pk_mul_f32 v[40:41], v[40:41], v[56:57]
  v_pk_mul_f32 v[42:43], v[42:43], v[58:59]
  v_pk_mul_f32 v[44:45], v[44:45], v[60:61]
  v_pk_mul_f32 v[46:47], v[46:47], v[62:63]
  v_pk_fma_f32 v[48:49], v[16:17], v[16:17], s[20:21] neg_lo:[1,0,1] neg_hi:[1,0,1]
  v_pk_fma_f32 v[50:51], v[18:19], v[18:19], s[20:21] neg_lo:[1,0,1] neg_hi:[1,0,1]
  v_pk_fma_f32 v[52:53], v[20:21], v[20:21], s[20:21] neg_lo:[1,0,1] neg_hi:[1,0,1]
  v_pk_fma_f32 v[54:55], v[22:23], v[22:23], s[20:21] neg_lo:[1,0,1] neg_hi:[1,0,1]
  v_pk_fma_f32 v[56:57], v[24:25], v[24:25], s[20:21] neg_lo:[1,0,1] neg_hi:[1,0,1]
  v_pk_fma_f32 v[58:59], v[26:27], v[26:27], s[20:21] neg_lo:[1,0,1] neg_hi:[1,0,1]
  v_pk_fma_f32 v[60:61], v[28:29], v[28:29], s[20:21] neg_lo:[1,0,1] neg_hi:[1,0,1]
  v_pk_fma_f32 v[62:63], v[30:31], v[30:31], s[20:21] neg_lo:[1,0,1] neg_hi:[1,0,1]
  v_pk_mul_f32 v[48:49], v[16:17], v[48:49]
  v_pk_mul_f32 v[50:51], v[18:19], v[50:51]
  v_pk_mul_f32 v[52:53], v[20:21], v[52:53]
  v_pk_mul_f32 v[54:55], v[22:23], v[54:55]
  v_pk_mul_f32 v[56:57], v[24:25], v[56:57]
  v_cvt_pk_bf16_f32 v184, v32, v33
  v_cvt_pk_bf16_f32 v185, v34, v35
  v_cvt_pk_bf16_f32 v186, v36, v37
  v_cvt_pk_bf16_f32 v187, v38, v39
  v_pk_mul_f32 v[58:59], v[26:27], v[58:59]
  v_pk_mul_f32 v[60:61], v[28:29], v[60:61]
  v_pk_mul_f32 v[62:63], v[30:31], v[62:63]
  v_mfma_f32_32x32x16_bf16 v[64:79], v[192:195], v[184:187], v[64:79]
  s_mov_b32 m0, s30
  v_cvt_pk_bf16_f32 v188, v40, v41
  v_cvt_pk_bf16_f32 v189, v42, v43
  v_cvt_pk_bf16_f32 v190, v44, v45
  v_cvt_pk_bf16_f32 v191, v46, v47
  v_exp_f32 v48, v48
  v_mfma_f32_32x32x16_bf16 v[80:95], v[196:199], v[184:187], v[80:95]
  buffer_load_dwordx4 v6, s[4:7], s29 offen lds
  v_exp_f32 v49, v49
  v_exp_f32 v50, v50
  v_exp_f32_e64 v51, v51
  v_mfma_f32_32x32x16_bf16 v[96:111], v[200:203], v[184:187], v[96:111]
  buffer_load_dwordx4 v7, s[4:7], s29 offen offset:1024 lds
  v_exp_f32 v52, v52
  v_exp_f32 v53, v53
  v_mfma_f32_32x32x16_bf16 v[64:79], v[204:207], v[188:191], v[64:79]
  buffer_load_dwordx4 v8, s[4:7], s29 offen offset:2048 lds
  v_exp_f32 v54, v54
  v_exp_f32 v55, v55
  v_exp_f32_e64 v56, v56
  v_mfma_f32_32x32x16_bf16 v[80:95], v[208:211], v[188:191], v[80:95]
  buffer_load_dwordx4 v9, s[4:7], s29 offen offset:3072 lds
  v_exp_f32 v57, v57
  v_exp_f32 v58, v58
  v_mfma_f32_32x32x16_bf16 v[96:111], v[212:215], v[188:191], v[96:111]
  v_exp_f32 v59, v59
  v_exp_f32 v60, v60
  v_exp_f32 v61, v61
  v_exp_f32 v62, v62
  v_exp_f32_e64 v63, v63
  v_pk_fma_f32 v[48:49], v[48:49], s[22:23], s[22:23]
  v_pk_fma_f32 v[50:51], v[50:51], s[22:23], s[22:23]
  v_pk_fma_f32 v[52:53], v[52:53], s[22:23], s[22:23]
  v_pk_fma_f32 v[54:55], v[54:55], s[22:23], s[22:23]
  v_pk_fma_f32 v[56:57], v[56:57], s[22:23], s[22:23]
  v_pk_fma_f32 v[58:59], v[58:59], s[22:23], s[22:23]
  v_pk_fma_f32 v[60:61], v[60:61], s[22:23], s[22:23]
  v_pk_fma_f32 v[62:63], v[62:63], s[22:23], s[22:23]
  v_mfma_f32_32x32x16_bf16 v[32:47], a[0:3], v[160:163], 0
  v_cvt_pk_bf16_f32 v112, v64, v65
  v_cvt_pk_bf16_f32 v113, v66, v67
  v_cvt_pk_bf16_f32 v114, v68, v69
  v_cvt_pk_bf16_f32 v115, v70, v71
  v_cvt_pk_bf16_f32 v116, v72, v73
  v_cvt_pk_bf16_f32 v117, v74, v75
  v_mfma_f32_32x32x16_bf16 v[32:47], a[4:7], v[164:167], v[32:47]
  v_cvt_pk_bf16_f32 v118, v76, v77
  v_cvt_pk_bf16_f32 v119, v78, v79
  v_cvt_pk_bf16_f32 v120, v80, v81
  v_cvt_pk_bf16_f32 v121, v82, v83
  v_cvt_pk_bf16_f32 v122, v84, v85
  v_cvt_pk_bf16_f32 v123, v86, v87
  v_mfma_f32_32x32x16_bf16 v[32:47], a[8:11], v[168:171], v[32:47]
  ds_read_b128 v[64:67], v2
  ds_read_b128 v[68:71], v2 offset:32
  ds_read_b128 v[72:75], v2 offset:64
  ds_read_b128 v[76:79], v2 offset:96
  v_cvt_pk_bf16_f32 v124, v88, v89
  v_cvt_pk_bf16_f32 v125, v90, v91
  v_mfma_f32_32x32x16_bf16 v[32:47], a[12:15], v[172:175], v[32:47]
  ds_read_b128 v[192:195], v1 offset:8192
  ds_read_b128 v[196:199], v1 offset:9216
  v_cvt_pk_bf16_f32 v126, v92, v93
  v_cvt_pk_bf16_f32 v127, v94, v95
  v_cvt_pk_bf16_f32 v128, v96, v97
  v_cvt_pk_bf16_f32 v129, v98, v99
  v_mfma_f32_32x32x16_bf16 v[32:47], a[16:19], v[176:179], v[32:47]
  ds_read_b128 v[80:83], v2 offset:128
  ds_read_b128 v[84:87], v2 offset:160
  ds_read_b128 v[88:91], v2 offset:192
  ds_read_b128 v[92:95], v2 offset:224
  v_cvt_pk_bf16_f32 v130, v100, v101
  v_cvt_pk_bf16_f32 v131, v102, v103
  v_mfma_f32_32x32x16_bf16 v[32:47], a[20:23], v[180:183], v[32:47]
  s_nop 0
  s_waitcnt lgkmcnt(6)
  ds_read_b128 v[200:203], v1 offset:10240
  ds_read_b128 v[204:207], v1 offset:11264
  v_cvt_pk_bf16_f32 v132, v104, v105
  v_cvt_pk_bf16_f32 v133, v106, v107
  v_cvt_pk_bf16_f32 v134, v108, v109
  v_cvt_pk_bf16_f32 v135, v110, v111
  v_mfma_f32_32x32x16_bf16 v[64:79], v[240:243], v[136:139], v[64:79]
  ds_read_b128 v[96:99], v2 offset:256
  ds_read_b128 v[100:103], v2 offset:288
  ds_read_b128 v[104:107], v2 offset:320
  ds_read_b128 v[108:111], v2 offset:352
  v_rcp_f32 v48, v48
  v_mfma_f32_32x32x16_bf16 v[64:79], v[244:247], v[140:143], v[64:79]
  s_waitcnt lgkmcnt(6)
  ds_read_b128 v[208:211], v1 offset:12288
  ds_read_b128 v[212:215], v1 offset:13312
  v_rcp_f32 v49, v49
  v_rcp_f32 v50, v50
  v_mfma_f32_32x32x16_bf16 v[80:95], v[240:243], v[144:147], v[80:95]
  v_rcp_f32 v51, v51
  v_rcp_f32 v52, v52
  v_rcp_f32_e64 v53, v53
  v_mfma_f32_32x32x16_bf16 v[80:95], v[244:247], v[148:151], v[80:95]
  s_waitcnt lgkmcnt(2)
  v_rcp_f32 v54, v54
  v_rcp_f32 v55, v55
  v_rcp_f32 v56, v56
  v_mfma_f32_32x32x16_bf16 v[96:111], v[240:243], v[152:155], v[96:111]
  v_rcp_f32 v57, v57
  v_rcp_f32 v58, v58
  v_rcp_f32_e64 v59, v59
  v_mfma_f32_32x32x16_bf16 v[96:111], v[244:247], v[156:159], v[96:111]
  s_waitcnt lgkmcnt(0)
  v_rcp_f32 v60, v60
  v_rcp_f32 v61, v61
  v_rcp_f32 v62, v62
  v_rcp_f32_e64 v63, v63
  v_pk_mul_f32 v[16:17], v[16:17], v[48:49]
  v_pk_mul_f32 v[18:19], v[18:19], v[50:51]
  v_pk_mul_f32 v[20:21], v[20:21], v[52:53]
  v_pk_mul_f32 v[22:23], v[22:23], v[54:55]
  v_pk_mul_f32 v[24:25], v[24:25], v[56:57]
  v_pk_mul_f32 v[26:27], v[26:27], v[58:59]
  v_pk_mul_f32 v[28:29], v[28:29], v[60:61]
  v_pk_mul_f32 v[30:31], v[30:31], v[62:63]
  v_pk_fma_f32 v[48:49], v[32:33], v[32:33], s[20:21] neg_lo:[1,0,1] neg_hi:[1,0,1]
  v_pk_fma_f32 v[50:51], v[34:35], v[34:35], s[20:21] neg_lo:[1,0,1] neg_hi:[1,0,1]
  v_pk_fma_f32 v[52:53], v[36:37], v[36:37], s[20:21] neg_lo:[1,0,1] neg_hi:[1,0,1]
  v_pk_fma_f32 v[54:55], v[38:39], v[38:39], s[20:21] neg_lo:[1,0,1] neg_hi:[1,0,1]
  v_pk_fma_f32 v[56:57], v[40:41], v[40:41], s[20:21] neg_lo:[1,0,1] neg_hi:[1,0,1]
  v_pk_fma_f32 v[58:59], v[42:43], v[42:43], s[20:21] neg_lo:[1,0,1] neg_hi:[1,0,1]
  v_pk_fma_f32 v[60:61], v[44:45], v[44:45], s[20:21] neg_lo:[1,0,1] neg_hi:[1,0,1]
  v_pk_fma_f32 v[62:63], v[46:47], v[46:47], s[20:21] neg_lo:[1,0,1] neg_hi:[1,0,1]
  v_pk_mul_f32 v[48:49], v[32:33], v[48:49]
  v_pk_mul_f32 v[50:51], v[34:35], v[50:51]
  v_pk_mul_f32 v[52:53], v[36:37], v[52:53]
  v_pk_mul_f32 v[54:55], v[38:39], v[54:55]
  v_pk_mul_f32 v[56:57], v[40:41], v[56:57]
  v_cvt_pk_bf16_f32 v184, v16, v17
  v_cvt_pk_bf16_f32 v185, v18, v19
  v_cvt_pk_bf16_f32 v186, v20, v21
  v_cvt_pk_bf16_f32 v187, v22, v23
  v_pk_mul_f32 v[58:59], v[42:43], v[58:59]
  v_pk_mul_f32 v[60:61], v[44:45], v[60:61]
  v_pk_mul_f32 v[62:63], v[46:47], v[62:63]
  v_mfma_f32_32x32x16_bf16 v[64:79], v[192:195], v[184:187], v[64:79]
  s_mov_b32 m0, s31
  v_cvt_pk_bf16_f32 v188, v24, v25
  v_cvt_pk_bf16_f32 v189, v26, v27
  v_cvt_pk_bf16_f32 v190, v28, v29
  v_cvt_pk_bf16_f32 v191, v30, v31
  v_exp_f32 v48, v48
  v_mfma_f32_32x32x16_bf16 v[80:95], v[196:199], v[184:187], v[80:95]
  buffer_load_dwordx4 v6, s[4:7], s52 offen lds
  v_exp_f32 v49, v49
  v_exp_f32 v50, v50
  v_exp_f32_e64 v51, v51
  v_mfma_f32_32x32x16_bf16 v[96:111], v[200:203], v[184:187], v[96:111]
  buffer_load_dwordx4 v7, s[4:7], s52 offen offset:1024 lds
  v_exp_f32 v52, v52
  v_exp_f32 v53, v53
  v_mfma_f32_32x32x16_bf16 v[64:79], v[204:207], v[188:191], v[64:79]
  buffer_load_dwordx4 v8, s[4:7], s52 offen offset:2048 lds
  v_exp_f32 v54, v54
  v_exp_f32 v55, v55
  v_exp_f32_e64 v56, v56
  v_mfma_f32_32x32x16_bf16 v[80:95], v[208:211], v[188:191], v[80:95]
  buffer_load_dwordx4 v9, s[4:7], s52 offen offset:3072 lds
  v_exp_f32 v57, v57
  v_exp_f32 v58, v58
  v_mfma_f32_32x32x16_bf16 v[96:111], v[212:215], v[188:191], v[96:111]
  v_exp_f32 v59, v59
  v_exp_f32 v60, v60
  v_exp_f32 v61, v61
  v_exp_f32 v62, v62
  v_exp_f32_e64 v63, v63
  v_pk_fma_f32 v[48:49], v[48:49], s[22:23], s[22:23]
  v_pk_fma_f32 v[50:51], v[50:51], s[22:23], s[22:23]
  v_pk_fma_f32 v[52:53], v[52:53], s[22:23], s[22:23]
  v_pk_fma_f32 v[54:55], v[54:55], s[22:23], s[22:23]
  v_pk_fma_f32 v[56:57], v[56:57], s[22:23], s[22:23]
  v_pk_fma_f32 v[58:59], v[58:59], s[22:23], s[22:23]
  v_pk_fma_f32 v[60:61], v[60:61], s[22:23], s[22:23]
  v_pk_fma_f32 v[62:63], v[62:63], s[22:23], s[22:23]
  v_mfma_f32_32x32x16_bf16 v[16:31], a[24:27], v[160:163], 0
  ds_read_b128 v[192:195], v1 offset:14336
  ds_read_b128 v[196:199], v1 offset:15360
  v_rcp_f32 v48, v48
  v_rcp_f32 v49, v49
  v_mfma_f32_32x32x16_bf16 v[16:31], a[28:31], v[164:167], v[16:31]
  ds_read_b128 v[200:203], v1 offset:16384
  ds_read_b128 v[204:207], v1 offset:17408
  v_rcp_f32 v50, v50
  v_rcp_f32 v51, v51
  v_mfma_f32_32x32x16_bf16 v[16:31], a[32:35], v[168:171], v[16:31]
  ds_read_b128 v[208:211], v1 offset:18432
  ds_read_b128 v[212:215], v1 offset:19456
  v_rcp_f32 v52, v52
  v_rcp_f32 v53, v53
  v_mfma_f32_32x32x16_bf16 v[16:31], a[36:39], v[172:175], v[16:31]
  buffer_store_dwordx4 v[112:115], v10, s[8:11], s28 offen
  v_rcp_f32 v54, v54
  v_rcp_f32 v55, v55
  v_mfma_f32_32x32x16_bf16 v[16:31], a[40:43], v[176:179], v[16:31]
  v_rcp_f32 v56, v56
  v_rcp_f32 v57, v57
  v_rcp_f32_e64 v58, v58
  v_mfma_f32_32x32x16_bf16 v[16:31], a[44:47], v[180:183], v[16:31]
  s_waitcnt lgkmcnt(0)
  v_rcp_f32 v59, v59
  v_rcp_f32 v60, v60
  v_rcp_f32 v61, v61
  v_rcp_f32 v62, v62
  v_rcp_f32 v63, v63
  v_pk_mul_f32 v[32:33], v[32:33], v[48:49]
  v_pk_mul_f32 v[34:35], v[34:35], v[50:51]
  v_pk_mul_f32 v[36:37], v[36:37], v[52:53]
  v_pk_mul_f32 v[38:39], v[38:39], v[54:55]
  v_pk_mul_f32 v[40:41], v[40:41], v[56:57]
  v_pk_mul_f32 v[42:43], v[42:43], v[58:59]
  v_pk_mul_f32 v[44:45], v[44:45], v[60:61]
  v_pk_mul_f32 v[46:47], v[46:47], v[62:63]
  v_pk_fma_f32 v[48:49], v[16:17], v[16:17], s[20:21] neg_lo:[1,0,1] neg_hi:[1,0,1]
  v_pk_fma_f32 v[50:51], v[18:19], v[18:19], s[20:21] neg_lo:[1,0,1] neg_hi:[1,0,1]
  v_pk_fma_f32 v[52:53], v[20:21], v[20:21], s[20:21] neg_lo:[1,0,1] neg_hi:[1,0,1]
  v_pk_fma_f32 v[54:55], v[22:23], v[22:23], s[20:21] neg_lo:[1,0,1] neg_hi:[1,0,1]
  v_pk_fma_f32 v[56:57], v[24:25], v[24:25], s[20:21] neg_lo:[1,0,1] neg_hi:[1,0,1]
  v_pk_fma_f32 v[58:59], v[26:27], v[26:27], s[20:21] neg_lo:[1,0,1] neg_hi:[1,0,1]
  v_pk_fma_f32 v[60:61], v[28:29], v[28:29], s[20:21] neg_lo:[1,0,1] neg_hi:[1,0,1]
  v_pk_fma_f32 v[62:63], v[30:31], v[30:31], s[20:21] neg_lo:[1,0,1] neg_hi:[1,0,1]
  v_pk_mul_f32 v[48:49], v[16:17], v[48:49]
  v_pk_mul_f32 v[50:51], v[18:19], v[50:51]
  v_pk_mul_f32 v[52:53], v[20:21], v[52:53]
  v_pk_mul_f32 v[54:55], v[22:23], v[54:55]
  v_pk_mul_f32 v[56:57], v[24:25], v[56:57]
  v_cvt_pk_bf16_f32 v184, v32, v33
  v_cvt_pk_bf16_f32 v185, v34, v35
  v_cvt_pk_bf16_f32 v186, v36, v37
  v_cvt_pk_bf16_f32 v187, v38, v39
  v_pk_mul_f32 v[58:59], v[26:27], v[58:59]
  v_pk_mul_f32 v[60:61], v[28:29], v[60:61]
  v_pk_mul_f32 v[62:63], v[30:31], v[62:63]
  v_mfma_f32_32x32x16_bf16 v[64:79], v[192:195], v[184:187], v[64:79]
  v_cvt_pk_bf16_f32 v188, v40, v41
  v_cvt_pk_bf16_f32 v189, v42, v43
  v_cvt_pk_bf16_f32 v190, v44, v45
  v_cvt_pk_bf16_f32 v191, v46, v47
  v_exp_f32_e64 v48, v48
  v_mfma_f32_32x32x16_bf16 v[80:95], v[196:199], v[184:187], v[80:95]
  v_exp_f32 v49, v49
  v_exp_f32 v50, v50
  v_exp_f32_e64 v51, v51
  v_mfma_f32_32x32x16_bf16 v[96:111], v[200:203], v[184:187], v[96:111]
  v_exp_f32 v52, v52
  v_exp_f32 v53, v53
  v_subrev_u32 v11, 0x4100, v5
  v_mfma_f32_32x32x16_bf16 v[64:79], v[204:207], v[188:191], v[64:79]
  v_exp_f32 v54, v54
  v_exp_f32 v55, v55
  v_exp_f32_e64 v56, v56
  v_mfma_f32_32x32x16_bf16 v[80:95], v[208:211], v[188:191], v[80:95]
  v_exp_f32 v57, v57
  v_exp_f32 v58, v58
  v_add_u32 v5, 0x8200, v5
  v_exp_f32_e64 v59, v59
  v_mfma_f32_32x32x16_bf16 v[96:111], v[212:215], v[188:191], v[96:111]
  v_exp_f32 v60, v60
  v_exp_f32 v61, v61
  v_exp_f32 v62, v62
  v_exp_f32 v63, v63
  v_min_u32_e64 v5, v11, v5
  v_pk_fma_f32 v[48:49], v[48:49], s[22:23], s[22:23]
  v_pk_fma_f32 v[50:51], v[50:51], s[22:23], s[22:23]
  v_pk_fma_f32 v[52:53], v[52:53], s[22:23], s[22:23]
  v_pk_fma_f32 v[54:55], v[54:55], s[22:23], s[22:23]
  v_pk_fma_f32 v[56:57], v[56:57], s[22:23], s[22:23]
  v_pk_fma_f32 v[58:59], v[58:59], s[22:23], s[22:23]
  v_pk_fma_f32 v[60:61], v[60:61], s[22:23], s[22:23]
  v_pk_fma_f32 v[62:63], v[62:63], s[22:23], s[22:23]
  v_mfma_f32_32x32x16_bf16 v[32:47], a[48:51], v[160:163], 0
  ds_read_b128 v[192:195], v1 offset:20480
  ds_read_b128 v[196:199], v1 offset:21504
  v_rcp_f32 v48, v48
  v_rcp_f32 v49, v49
  v_mfma_f32_32x32x16_bf16 v[32:47], a[52:55], v[164:167], v[32:47]
  ds_read_b128 v[200:203], v1 offset:22528
  ds_read_b128 v[204:207], v1 offset:23552
  v_rcp_f32 v50, v50
  v_rcp_f32 v51, v51
  v_mfma_f32_32x32x16_bf16 v[32:47], a[56:59], v[168:171], v[32:47]
  ds_read_b128 v[208:211], v1 offset:24576
  ds_read_b128 v[212:215], v1 offset:25600
  v_rcp_f32 v52, v52
  v_rcp_f32 v53, v53
  v_mfma_f32_32x32x16_bf16 v[32:47], a[60:63], v[172:175], v[32:47]
  buffer_store_dwordx4 v[116:119], v10, s[8:11], s28 offen offset:32
  v_rcp_f32 v54, v54
  v_rcp_f32 v55, v55
  v_mfma_f32_32x32x16_bf16 v[32:47], a[64:67], v[176:179], v[32:47]
  v_rcp_f32 v56, v56
  v_rcp_f32 v57, v57
  v_rcp_f32_e64 v58, v58
  v_mfma_f32_32x32x16_bf16 v[32:47], a[68:71], v[180:183], v[32:47]
  s_waitcnt lgkmcnt(0)
  v_rcp_f32 v59, v59
  v_rcp_f32 v60, v60
  v_rcp_f32 v61, v61
  v_rcp_f32 v62, v62
  v_rcp_f32 v63, v63
  v_pk_mul_f32 v[16:17], v[16:17], v[48:49]
  v_pk_mul_f32 v[18:19], v[18:19], v[50:51]
  v_pk_mul_f32 v[20:21], v[20:21], v[52:53]
  v_pk_mul_f32 v[22:23], v[22:23], v[54:55]
  v_pk_mul_f32 v[24:25], v[24:25], v[56:57]
  v_pk_mul_f32 v[26:27], v[26:27], v[58:59]
  v_pk_mul_f32 v[28:29], v[28:29], v[60:61]
  v_pk_mul_f32 v[30:31], v[30:31], v[62:63]
  v_pk_fma_f32 v[48:49], v[32:33], v[32:33], s[20:21] neg_lo:[1,0,1] neg_hi:[1,0,1]
  v_pk_fma_f32 v[50:51], v[34:35], v[34:35], s[20:21] neg_lo:[1,0,1] neg_hi:[1,0,1]
  v_pk_fma_f32 v[52:53], v[36:37], v[36:37], s[20:21] neg_lo:[1,0,1] neg_hi:[1,0,1]
  v_pk_fma_f32 v[54:55], v[38:39], v[38:39], s[20:21] neg_lo:[1,0,1] neg_hi:[1,0,1]
  v_pk_fma_f32 v[56:57], v[40:41], v[40:41], s[20:21] neg_lo:[1,0,1] neg_hi:[1,0,1]
  v_pk_fma_f32 v[58:59], v[42:43], v[42:43], s[20:21] neg_lo:[1,0,1] neg_hi:[1,0,1]
  v_pk_fma_f32 v[60:61], v[44:45], v[44:45], s[20:21] neg_lo:[1,0,1] neg_hi:[1,0,1]
  v_pk_fma_f32 v[62:63], v[46:47], v[46:47], s[20:21] neg_lo:[1,0,1] neg_hi:[1,0,1]
  v_pk_mul_f32 v[48:49], v[32:33], v[48:49]
  v_pk_mul_f32 v[50:51], v[34:35], v[50:51]
  v_pk_mul_f32 v[52:53], v[36:37], v[52:53]
  v_pk_mul_f32 v[54:55], v[38:39], v[54:55]
  v_pk_mul_f32 v[56:57], v[40:41], v[56:57]
  v_cvt_pk_bf16_f32 v184, v16, v17
  v_cvt_pk_bf16_f32 v185, v18, v19
  v_cvt_pk_bf16_f32 v186, v20, v21
  v_cvt_pk_bf16_f32 v187, v22, v23
  v_pk_mul_f32 v[58:59], v[42:43], v[58:59]
  v_pk_mul_f32 v[60:61], v[44:45], v[60:61]
  v_pk_mul_f32 v[62:63], v[46:47], v[62:63]
  v_mfma_f32_32x32x16_bf16 v[64:79], v[192:195], v[184:187], v[64:79]
  s_add_u32 s29, s29, 0x60000
  v_cvt_pk_bf16_f32 v188, v24, v25
  v_cvt_pk_bf16_f32 v189, v26, v27
  v_cvt_pk_bf16_f32 v190, v28, v29
  v_cvt_pk_bf16_f32 v191, v30, v31
  v_exp_f32_e64 v48, v48
  v_mfma_f32_32x32x16_bf16 v[80:95], v[196:199], v[184:187], v[80:95]
  s_add_u32 s52, s52, 0x60000
  v_exp_f32 v49, v49
  v_exp_f32 v50, v50
  v_exp_f32_e64 v51, v51
  v_mfma_f32_32x32x16_bf16 v[96:111], v[200:203], v[184:187], v[96:111]
  s_mov_b32 s32, s30
  v_exp_f32 v52, v52
  v_exp_f32_e64 v53, v53
  v_subrev_u32 v11, 0x4100, v4
  v_mfma_f32_32x32x16_bf16 v[64:79], v[204:207], v[188:191], v[64:79]
  s_add_u32 s30, s33, 32
  v_exp_f32 v54, v54
  v_exp_f32 v55, v55
  v_exp_f32 v56, v56
  v_mfma_f32_32x32x16_bf16 v[80:95], v[208:211], v[188:191], v[80:95]
  s_sub_u32 s33, s31, 0
  v_exp_f32 v57, v57
  v_exp_f32_e64 v58, v58
  v_add_u32 v4, 0x8200, v4
  v_exp_f32_e64 v59, v59
  v_mfma_f32_32x32x16_bf16 v[96:111], v[212:215], v[188:191], v[96:111]
  v_exp_f32 v60, v60
  v_exp_f32 v61, v61
  v_exp_f32 v62, v62
  v_exp_f32 v63, v63
  v_min_u32_e64 v4, v11, v4
  v_pk_fma_f32 v[48:49], v[48:49], s[22:23], s[22:23]
  v_pk_fma_f32 v[50:51], v[50:51], s[22:23], s[22:23]
  v_pk_fma_f32 v[52:53], v[52:53], s[22:23], s[22:23]
  v_pk_fma_f32 v[54:55], v[54:55], s[22:23], s[22:23]
  v_pk_fma_f32 v[56:57], v[56:57], s[22:23], s[22:23]
  v_pk_fma_f32 v[58:59], v[58:59], s[22:23], s[22:23]
  v_pk_fma_f32 v[60:61], v[60:61], s[22:23], s[22:23]
  v_pk_fma_f32 v[62:63], v[62:63], s[22:23], s[22:23]
  v_mfma_f32_32x32x16_bf16 v[16:31], a[72:75], v[160:163], 0
  ds_read_b128 v[192:195], v1 offset:26624
  ds_read_b128 v[196:199], v1 offset:27648
  v_rcp_f32 v48, v48
  v_rcp_f32 v49, v49
  v_mfma_f32_32x32x16_bf16 v[16:31], a[76:79], v[164:167], v[16:31]
  ds_read_b128 v[200:203], v1 offset:28672
  ds_read_b128 v[204:207], v1 offset:29696
  v_rcp_f32 v50, v50
  v_rcp_f32 v51, v51
  v_mfma_f32_32x32x16_bf16 v[16:31], a[80:83], v[168:171], v[16:31]
  ds_read_b128 v[208:211], v1 offset:30720
  ds_read_b128 v[212:215], v1 offset:31744
  v_rcp_f32 v52, v52
  v_rcp_f32 v53, v53
  v_mfma_f32_32x32x16_bf16 v[16:31], a[84:87], v[172:175], v[16:31]
  buffer_load_dword v249, v248, s[4:7], s29 offen
  v_rcp_f32 v54, v54
  v_rcp_f32 v55, v55
  v_mfma_f32_32x32x16_bf16 v[16:31], a[88:91], v[176:179], v[16:31]
  v_rcp_f32 v56, v56
  v_rcp_f32 v57, v57
  v_rcp_f32_e64 v58, v58
  v_mfma_f32_32x32x16_bf16 v[16:31], a[92:95], v[180:183], v[16:31]
  s_waitcnt lgkmcnt(0)
  v_rcp_f32 v59, v59
  v_rcp_f32 v60, v60
  v_rcp_f32 v61, v61
  v_rcp_f32 v62, v62
  v_rcp_f32 v63, v63
  v_pk_mul_f32 v[32:33], v[32:33], v[48:49]
  v_pk_mul_f32 v[34:35], v[34:35], v[50:51]
  v_pk_mul_f32 v[36:37], v[36:37], v[52:53]
  v_pk_mul_f32 v[38:39], v[38:39], v[54:55]
  v_pk_mul_f32 v[40:41], v[40:41], v[56:57]
  v_pk_mul_f32 v[42:43], v[42:43], v[58:59]
  v_pk_mul_f32 v[44:45], v[44:45], v[60:61]
  v_pk_mul_f32 v[46:47], v[46:47], v[62:63]
  v_pk_fma_f32 v[48:49], v[16:17], v[16:17], s[20:21] neg_lo:[1,0,1] neg_hi:[1,0,1]
  v_pk_fma_f32 v[50:51], v[18:19], v[18:19], s[20:21] neg_lo:[1,0,1] neg_hi:[1,0,1]
  v_pk_fma_f32 v[52:53], v[20:21], v[20:21], s[20:21] neg_lo:[1,0,1] neg_hi:[1,0,1]
  v_pk_fma_f32 v[54:55], v[22:23], v[22:23], s[20:21] neg_lo:[1,0,1] neg_hi:[1,0,1]
  v_pk_fma_f32 v[56:57], v[24:25], v[24:25], s[20:21] neg_lo:[1,0,1] neg_hi:[1,0,1]
  v_pk_fma_f32 v[58:59], v[26:27], v[26:27], s[20:21] neg_lo:[1,0,1] neg_hi:[1,0,1]
  v_pk_fma_f32 v[60:61], v[28:29], v[28:29], s[20:21] neg_lo:[1,0,1] neg_hi:[1,0,1]
  v_pk_fma_f32 v[62:63], v[30:31], v[30:31], s[20:21] neg_lo:[1,0,1] neg_hi:[1,0,1]
  v_pk_mul_f32 v[48:49], v[16:17], v[48:49]
  v_pk_mul_f32 v[50:51], v[18:19], v[50:51]
  v_pk_mul_f32 v[52:53], v[20:21], v[52:53]
  v_pk_mul_f32 v[54:55], v[22:23], v[54:55]
  v_pk_mul_f32 v[56:57], v[24:25], v[56:57]
  v_cvt_pk_bf16_f32 v184, v32, v33
  v_cvt_pk_bf16_f32 v185, v34, v35
  v_cvt_pk_bf16_f32 v186, v36, v37
  v_cvt_pk_bf16_f32 v187, v38, v39
  v_pk_mul_f32 v[58:59], v[26:27], v[58:59]
  v_pk_mul_f32 v[60:61], v[28:29], v[60:61]
  v_pk_mul_f32 v[62:63], v[30:31], v[62:63]
  v_mfma_f32_32x32x16_bf16 v[64:79], v[192:195], v[184:187], v[64:79]
  s_nop 0
  s_waitcnt vmcnt(3)
  ds_read_b128 v[220:223], v4 offset:96
  v_cvt_pk_bf16_f32 v188, v40, v41
  v_cvt_pk_bf16_f32 v189, v42, v43
  v_cvt_pk_bf16_f32 v190, v44, v45
  v_cvt_pk_bf16_f32 v191, v46, v47
  v_mfma_f32_32x32x16_bf16 v[80:95], v[196:199], v[184:187], v[80:95]
  ds_read_b128 v[228:231], v4 offset:288
  v_exp_f32 v48, v48
  v_exp_f32 v49, v49
  v_exp_f32_e64 v50, v50
  v_mfma_f32_32x32x16_bf16 v[96:111], v[200:203], v[184:187], v[96:111]
  ds_read_b128 v[236:239], v4 offset:480
  v_exp_f32 v51, v51
  v_exp_f32 v52, v52
  v_mfma_f32_32x32x16_bf16 v[64:79], v[204:207], v[188:191], v[64:79]
  v_exp_f32 v53, v53
  v_exp_f32 v54, v54
  v_exp_f32_e64 v55, v55
  v_mfma_f32_32x32x16_bf16 v[80:95], v[208:211], v[188:191], v[80:95]
  v_exp_f32 v56, v56
  v_exp_f32 v57, v57
  v_exp_f32_e64 v58, v58
  v_mfma_f32_32x32x16_bf16 v[96:111], v[212:215], v[188:191], v[96:111]
  s_waitcnt lgkmcnt(0)
  v_exp_f32 v59, v59
  v_exp_f32 v60, v60
  v_exp_f32 v61, v61
  v_exp_f32 v62, v62
  v_exp_f32 v63, v63
  v_pk_fma_f32 v[48:49], v[48:49], s[22:23], s[22:23]
  v_pk_fma_f32 v[50:51], v[50:51], s[22:23], s[22:23]
  v_pk_fma_f32 v[52:53], v[52:53], s[22:23], s[22:23]
  v_pk_fma_f32 v[54:55], v[54:55], s[22:23], s[22:23]
  v_pk_fma_f32 v[56:57], v[56:57], s[22:23], s[22:23]
  v_pk_fma_f32 v[58:59], v[58:59], s[22:23], s[22:23]
  v_pk_fma_f32 v[60:61], v[60:61], s[22:23], s[22:23]
  v_pk_fma_f32 v[62:63], v[62:63], s[22:23], s[22:23]
  v_mfma_f32_32x32x16_bf16 v[32:47], a[96:99], v[160:163], 0
  ds_read_b128 v[192:195], v0 offset:24576
  ds_read_b128 v[196:199], v0 offset:25600
  v_rcp_f32 v48, v48
  v_rcp_f32 v49, v49
  v_mfma_f32_16x16x32_bf16 v[136:139], a[240:243], v[220:223], 0
  ds_read_b128 v[216:219], v3 offset:2800
  ds_read_b128 v[220:223], v4 offset:112
  v_mfma_f32_32x32x16_bf16 v[32:47], a[100:103], v[164:167], v[32:47]
  ds_read_b128 v[200:203], v0 offset:26624
  ds_read_b128 v[204:207], v0 offset:27648
  v_rcp_f32 v50, v50
  v_rcp_f32 v51, v51
  v_mfma_f32_16x16x32_bf16 v[136:139], a[244:247], v[228:231], v[136:139]
  ds_read_b128 v[224:227], v3 offset:7600
  ds_read_b128 v[228:231], v4 offset:304
  v_mfma_f32_32x32x16_bf16 v[32:47], a[104:107], v[168:171], v[32:47]
  ds_read_b128 v[208:211], v0 offset:28672
  ds_read_b128 v[212:215], v0 offset:29696
  v_rcp_f32 v52, v52
  v_rcp_f32 v53, v53
  v_mfma_f32_16x16x32_bf16 v[136:139], a[248:251], v[236:239], v[136:139]
  ds_read_b128 v[232:235], v3 offset:12400
  ds_read_b128 v[236:239], v4 offset:496
  v_mfma_f32_32x32x16_bf16 v[32:47], a[108:111], v[172:175], v[32:47]
  buffer_store_dwordx4 v[120:123], v10, s[8:11], s28 offen offset:64
  v_rcp_f32 v54, v54
  v_rcp_f32 v55, v55
  v_mfma_f32_32x32x16_bf16 v[32:47], a[112:115], v[176:179], v[32:47]
  v_rcp_f32 v56, v56
  v_rcp_f32 v57, v57
  v_rcp_f32_e64 v58, v58
  v_mfma_f32_32x32x16_bf16 v[32:47], a[116:119], v[180:183], v[32:47]
  s_waitcnt lgkmcnt(0)
  v_rcp_f32 v59, v59
  v_rcp_f32 v60, v60
  v_rcp_f32 v61, v61
  v_rcp_f32 v62, v62
  v_rcp_f32 v63, v63
  v_pk_mul_f32 v[16:17], v[16:17], v[48:49]
  v_pk_mul_f32 v[18:19], v[18:19], v[50:51]
  v_pk_mul_f32 v[20:21], v[20:21], v[52:53]
  v_pk_mul_f32 v[22:23], v[22:23], v[54:55]
  v_pk_mul_f32 v[24:25], v[24:25], v[56:57]
  v_pk_mul_f32 v[26:27], v[26:27], v[58:59]
  v_pk_mul_f32 v[28:29], v[28:29], v[60:61]
  v_pk_mul_f32 v[30:31], v[30:31], v[62:63]
  v_pk_add_f32 v[12:13], v[136:137], v[138:139]
  v_pk_mul_f32 v[14:15], v[136:137], v[136:137]
  v_pk_fma_f32 v[14:15], v[138:139], v[138:139], v[14:15]
  v_pk_fma_f32 v[48:49], v[32:33], v[32:33], s[20:21] neg_lo:[1,0,1] neg_hi:[1,0,1]
  v_pk_fma_f32 v[50:51], v[34:35], v[34:35], s[20:21] neg_lo:[1,0,1] neg_hi:[1,0,1]
  v_pk_fma_f32 v[52:53], v[36:37], v[36:37], s[20:21] neg_lo:[1,0,1] neg_hi:[1,0,1]
  v_pk_fma_f32 v[54:55], v[38:39], v[38:39], s[20:21] neg_lo:[1,0,1] neg_hi:[1,0,1]
  v_pk_fma_f32 v[56:57], v[40:41], v[40:41], s[20:21] neg_lo:[1,0,1] neg_hi:[1,0,1]
  v_pk_fma_f32 v[58:59], v[42:43], v[42:43], s[20:21] neg_lo:[1,0,1] neg_hi:[1,0,1]
  v_pk_fma_f32 v[60:61], v[44:45], v[44:45], s[20:21] neg_lo:[1,0,1] neg_hi:[1,0,1]
  v_pk_fma_f32 v[62:63], v[46:47], v[46:47], s[20:21] neg_lo:[1,0,1] neg_hi:[1,0,1]
  v_pk_mul_f32 v[48:49], v[32:33], v[48:49]
  v_pk_mul_f32 v[50:51], v[34:35], v[50:51]
  v_pk_mul_f32 v[52:53], v[36:37], v[52:53]
  v_pk_mul_f32 v[54:55], v[38:39], v[54:55]
  v_pk_mul_f32 v[56:57], v[40:41], v[56:57]
  v_pk_mul_f32 v[58:59], v[42:43], v[58:59]
  v_pk_mul_f32 v[60:61], v[44:45], v[60:61]
  v_pk_mul_f32 v[62:63], v[46:47], v[62:63]
  v_mfma_f32_16x16x32_bf16 v[140:143], v[216:219], v[220:223], 0
  v_cvt_pk_bf16_f32 v184, v16, v17
  v_cvt_pk_bf16_f32 v185, v18, v19
  v_mfma_f32_16x16x32_bf16 v[140:143], v[224:227], v[228:231], v[140:143]
  v_cvt_pk_bf16_f32 v186, v20, v21
  v_cvt_pk_bf16_f32 v187, v22, v23
  v_mfma_f32_16x16x32_bf16 v[140:143], v[232:235], v[236:239], v[140:143]
  ds_read_b128 v[220:223], v4 offset:128
  v_mfma_f32_32x32x16_bf16 v[64:79], v[192:195], v[184:187], v[64:79]
  ds_read_b128 v[224:227], v3 offset:8000
  ds_read_b128 v[228:231], v4 offset:320
  v_cvt_pk_bf16_f32 v188, v24, v25
  v_cvt_pk_bf16_f32 v189, v26, v27
  v_cvt_pk_bf16_f32 v190, v28, v29
  v_cvt_pk_bf16_f32 v191, v30, v31
  v_mfma_f32_32x32x16_bf16 v[80:95], v[196:199], v[184:187], v[80:95]
  ds_read_b128 v[232:235], v3 offset:12800
  ds_read_b128 v[236:239], v4 offset:512
  v_exp_f32 v48, v48
  v_exp_f32 v49, v49
  v_mfma_f32_32x32x16_bf16 v[96:111], v[200:203], v[184:187], v[96:111]
  s_sub_u32 s31, s32, 32
  v_exp_f32 v50, v50
  v_exp_f32 v51, v51
  v_exp_f32 v52, v52
  v_mfma_f32_32x32x16_bf16 v[64:79], v[204:207], v[188:191], v[64:79]
  v_exp_f32 v53, v53
  v_exp_f32 v54, v54
  v_exp_f32_e64 v55, v55
  v_mfma_f32_32x32x16_bf16 v[80:95], v[208:211], v[188:191], v[80:95]
  v_exp_f32 v56, v56
  v_exp_f32 v57, v57
  v_exp_f32_e64 v58, v58
  v_mfma_f32_32x32x16_bf16 v[96:111], v[212:215], v[188:191], v[96:111]
  s_waitcnt lgkmcnt(0)
  v_exp_f32 v59, v59
  v_exp_f32 v60, v60
  v_exp_f32 v61, v61
  v_exp_f32 v62, v62
  v_exp_f32 v63, v63
  v_pk_add_f32 v[12:13], v[12:13], v[140:141]
  v_pk_fma_f32 v[14:15], v[140:141], v[140:141], v[14:15]
  v_pk_add_f32 v[12:13], v[12:13], v[142:143]
  v_pk_fma_f32 v[14:15], v[142:143], v[142:143], v[14:15]
  v_pk_fma_f32 v[48:49], v[48:49], s[22:23], s[22:23]
  v_pk_fma_f32 v[50:51], v[50:51], s[22:23], s[22:23]
  v_pk_fma_f32 v[52:53], v[52:53], s[22:23], s[22:23]
  v_pk_fma_f32 v[54:55], v[54:55], s[22:23], s[22:23]
  v_pk_fma_f32 v[56:57], v[56:57], s[22:23], s[22:23]
  v_pk_fma_f32 v[58:59], v[58:59], s[22:23], s[22:23]
  v_pk_fma_f32 v[60:61], v[60:61], s[22:23], s[22:23]
  v_pk_fma_f32 v[62:63], v[62:63], s[22:23], s[22:23]
  v_mfma_f32_32x32x16_bf16 v[16:31], a[120:123], v[160:163], 0
  ds_read_b128 v[192:195], v0 offset:30720
  ds_read_b128 v[196:199], v0 offset:31744
  v_rcp_f32 v48, v48
  v_rcp_f32 v49, v49
  v_mfma_f32_16x16x32_bf16 v[144:147], a[252:255], v[220:223], 0
  ds_read_b128 v[216:219], v3 offset:3600
  ds_read_b128 v[220:223], v4 offset:144
  v_mfma_f32_32x32x16_bf16 v[16:31], a[124:127], v[164:167], v[16:31]
  ds_read_b128 v[200:203], v0 offset:32768
  ds_read_b128 v[204:207], v0 offset:33792
  v_rcp_f32 v50, v50
  v_rcp_f32 v51, v51
  v_mfma_f32_16x16x32_bf16 v[144:147], v[224:227], v[228:231], v[144:147]
  ds_read_b128 v[224:227], v3 offset:8400
  ds_read_b128 v[228:231], v4 offset:336
  v_mfma_f32_32x32x16_bf16 v[16:31], a[128:131], v[168:171], v[16:31]
  ds_read_b128 v[208:211], v0 offset:34816
  ds_read_b128 v[212:215], v0 offset:35840
  v_rcp_f32 v52, v52
  v_rcp_f32 v53, v53
  v_mfma_f32_16x16x32_bf16 v[144:147], v[232:235], v[236:239], v[144:147]
  ds_read_b128 v[232:235], v3 offset:13200
  ds_read_b128 v[236:239], v4 offset:528
  v_mfma_f32_32x32x16_bf16 v[16:31], a[132:135], v[172:175], v[16:31]
  buffer_store_dwordx4 v[124:127], v10, s[8:11], s28 offen offset:96
  v_rcp_f32 v54, v54
  v_rcp_f32 v55, v55
  v_mfma_f32_32x32x16_bf16 v[16:31], a[136:139], v[176:179], v[16:31]
  v_rcp_f32 v56, v56
  v_rcp_f32 v57, v57
  v_rcp_f32_e64 v58, v58
  v_mfma_f32_32x32x16_bf16 v[16:31], a[140:143], v[180:183], v[16:31]
  s_waitcnt lgkmcnt(0)
  v_rcp_f32 v59, v59
  v_rcp_f32 v60, v60
  v_rcp_f32 v61, v61
  v_rcp_f32 v62, v62
  v_rcp_f32 v63, v63
  v_pk_mul_f32 v[32:33], v[32:33], v[48:49]
  v_pk_mul_f32 v[34:35], v[34:35], v[50:51]
  v_pk_mul_f32 v[36:37], v[36:37], v[52:53]
  v_pk_mul_f32 v[38:39], v[38:39], v[54:55]
  v_pk_mul_f32 v[40:41], v[40:41], v[56:57]
  v_pk_mul_f32 v[42:43], v[42:43], v[58:59]
  v_pk_mul_f32 v[44:45], v[44:45], v[60:61]
  v_pk_mul_f32 v[46:47], v[46:47], v[62:63]
  v_pk_add_f32 v[12:13], v[12:13], v[144:145]
  v_pk_fma_f32 v[14:15], v[144:145], v[144:145], v[14:15]
  v_pk_add_f32 v[12:13], v[12:13], v[146:147]
  v_pk_fma_f32 v[14:15], v[146:147], v[146:147], v[14:15]
  v_pk_fma_f32 v[48:49], v[16:17], v[16:17], s[20:21] neg_lo:[1,0,1] neg_hi:[1,0,1]
  v_pk_fma_f32 v[50:51], v[18:19], v[18:19], s[20:21] neg_lo:[1,0,1] neg_hi:[1,0,1]
  v_pk_fma_f32 v[52:53], v[20:21], v[20:21], s[20:21] neg_lo:[1,0,1] neg_hi:[1,0,1]
  v_pk_fma_f32 v[54:55], v[22:23], v[22:23], s[20:21] neg_lo:[1,0,1] neg_hi:[1,0,1]
  v_pk_fma_f32 v[56:57], v[24:25], v[24:25], s[20:21] neg_lo:[1,0,1] neg_hi:[1,0,1]
  v_pk_fma_f32 v[58:59], v[26:27], v[26:27], s[20:21] neg_lo:[1,0,1] neg_hi:[1,0,1]
  v_pk_fma_f32 v[60:61], v[28:29], v[28:29], s[20:21] neg_lo:[1,0,1] neg_hi:[1,0,1]
  v_pk_fma_f32 v[62:63], v[30:31], v[30:31], s[20:21] neg_lo:[1,0,1] neg_hi:[1,0,1]
  v_pk_mul_f32 v[48:49], v[16:17], v[48:49]
  v_pk_mul_f32 v[50:51], v[18:19], v[50:51]
  v_pk_mul_f32 v[52:53], v[20:21], v[52:53]
  v_pk_mul_f32 v[54:55], v[22:23], v[54:55]
  v_pk_mul_f32 v[56:57], v[24:25], v[56:57]
  v_pk_mul_f32 v[58:59], v[26:27], v[58:59]
  v_pk_mul_f32 v[60:61], v[28:29], v[60:61]
  v_pk_mul_f32 v[62:63], v[30:31], v[62:63]
  v_mfma_f32_16x16x32_bf16 v[148:151], v[216:219], v[220:223], 0
  v_cvt_pk_bf16_f32 v184, v32, v33
  v_cvt_pk_bf16_f32 v185, v34, v35
  v_mfma_f32_16x16x32_bf16 v[148:151], v[224:227], v[228:231], v[148:151]
  v_cvt_pk_bf16_f32 v186, v36, v37
  v_cvt_pk_bf16_f32 v187, v38, v39
  v_mfma_f32_16x16x32_bf16 v[148:151], v[232:235], v[236:239], v[148:151]
  ds_read_b128 v[216:219], v3 offset:4000
  ds_read_b128 v[220:223], v4 offset:160
  v_mfma_f32_32x32x16_bf16 v[64:79], v[192:195], v[184:187], v[64:79]
  ds_read_b128 v[224:227], v3 offset:8800
  ds_read_b128 v[228:231], v4 offset:352
  v_cvt_pk_bf16_f32 v188, v40, v41
  v_cvt_pk_bf16_f32 v189, v42, v43
  v_cvt_pk_bf16_f32 v190, v44, v45
  v_cvt_pk_bf16_f32 v191, v46, v47
  v_mfma_f32_32x32x16_bf16 v[80:95], v[196:199], v[184:187], v[80:95]
  ds_read_b128 v[232:235], v3 offset:13600
  ds_read_b128 v[236:239], v4 offset:544
  v_exp_f32 v48, v48
  v_exp_f32 v49, v49
  v_mfma_f32_32x32x16_bf16 v[96:111], v[200:203], v[184:187], v[96:111]
  v_exp_f32 v50, v50
  v_exp_f32 v51, v51
  v_exp_f32_e64 v52, v52
  v_mfma_f32_32x32x16_bf16 v[64:79], v[204:207], v[188:191], v[64:79]
  v_exp_f32 v53, v53
  v_exp_f32 v54, v54
  v_exp_f32_e64 v55, v55
  v_mfma_f32_32x32x16_bf16 v[80:95], v[208:211], v[188:191], v[80:95]
  v_exp_f32 v56, v56
  v_exp_f32 v57, v57
  v_exp_f32_e64 v58, v58
  v_mfma_f32_32x32x16_bf16 v[96:111], v[212:215], v[188:191], v[96:111]
  s_waitcnt lgkmcnt(0)
  v_exp_f32 v59, v59
  v_exp_f32 v60, v60
  v_exp_f32 v61, v61
  v_exp_f32 v62, v62
  v_exp_f32 v63, v63
  v_pk_add_f32 v[12:13], v[12:13], v[148:149]
  v_pk_fma_f32 v[14:15], v[148:149], v[148:149], v[14:15]
  v_pk_add_f32 v[12:13], v[12:13], v[150:151]
  v_pk_fma_f32 v[14:15], v[150:151], v[150:151], v[14:15]
  v_pk_fma_f32 v[48:49], v[48:49], s[22:23], s[22:23]
  v_pk_fma_f32 v[50:51], v[50:51], s[22:23], s[22:23]
  v_pk_fma_f32 v[52:53], v[52:53], s[22:23], s[22:23]
  v_pk_fma_f32 v[54:55], v[54:55], s[22:23], s[22:23]
  v_pk_fma_f32 v[56:57], v[56:57], s[22:23], s[22:23]
  v_pk_fma_f32 v[58:59], v[58:59], s[22:23], s[22:23]
  v_pk_fma_f32 v[60:61], v[60:61], s[22:23], s[22:23]
  v_pk_fma_f32 v[62:63], v[62:63], s[22:23], s[22:23]
  v_mfma_f32_32x32x16_bf16 v[32:47], a[144:147], v[160:163], 0
  ds_read_b128 v[192:195], v0 offset:36864
  ds_read_b128 v[196:199], v0 offset:37888
  v_rcp_f32 v48, v48
  v_rcp_f32 v49, v49
  v_mfma_f32_16x16x32_bf16 v[152:155], v[216:219], v[220:223], 0
  ds_read_b128 v[216:219], v3 offset:4400
  ds_read_b128 v[220:223], v4 offset:176
  v_mfma_f32_32x32x16_bf16 v[32:47], a[148:151], v[164:167], v[32:47]
  ds_read_b128 v[200:203], v0 offset:38912
  ds_read_b128 v[204:207], v0 offset:39936
  v_rcp_f32 v50, v50
  v_rcp_f32 v51, v51
  v_mfma_f32_16x16x32_bf16 v[152:155], v[224:227], v[228:231], v[152:155]
  ds_read_b128 v[224:227], v3 offset:9200
  ds_read_b128 v[228:231], v4 offset:368
  v_mfma_f32_32x32x16_bf16 v[32:47], a[152:155], v[168:171], v[32:47]
  ds_read_b128 v[208:211], v0 offset:40960
  ds_read_b128 v[212:215], v0 offset:41984
  v_rcp_f32 v52, v52
  v_rcp_f32 v53, v53
  v_mfma_f32_16x16x32_bf16 v[152:155], v[232:235], v[236:239], v[152:155]
  ds_read_b128 v[232:235], v3 offset:14000
  ds_read_b128 v[236:239], v4 offset:560
  v_mfma_f32_32x32x16_bf16 v[32:47], a[156:159], v[172:175], v[32:47]
  v_rcp_f32 v54, v54
  v_rcp_f32 v55, v55
  v_rcp_f32_e64 v56, v56
  v_mfma_f32_32x32x16_bf16 v[32:47], a[160:163], v[176:179], v[32:47]
  v_rcp_f32 v57, v57
  v_rcp_f32 v58, v58
  v_rcp_f32_e64 v59, v59
  v_mfma_f32_32x32x16_bf16 v[32:47], a[164:167], v[180:183], v[32:47]
  s_waitcnt lgkmcnt(0)
  v_rcp_f32 v60, v60
  v_rcp_f32 v61, v61
  v_rcp_f32 v62, v62
  v_rcp_f32_e64 v63, v63
  v_pk_mul_f32 v[16:17], v[16:17], v[48:49]
  v_pk_mul_f32 v[18:19], v[18:19], v[50:51]
  v_pk_mul_f32 v[20:21], v[20:21], v[52:53]
  v_pk_mul_f32 v[22:23], v[22:23], v[54:55]
  v_pk_mul_f32 v[24:25], v[24:25], v[56:57]
  v_pk_mul_f32 v[26:27], v[26:27], v[58:59]
  v_pk_mul_f32 v[28:29], v[28:29], v[60:61]
  v_pk_mul_f32 v[30:31], v[30:31], v[62:63]
  v_pk_add_f32 v[12:13], v[12:13], v[152:153]
  v_pk_fma_f32 v[14:15], v[152:153], v[152:153], v[14:15]
  v_pk_add_f32 v[12:13], v[12:13], v[154:155]
  v_pk_fma_f32 v[14:15], v[154:155], v[154:155], v[14:15]
  v_pk_fma_f32 v[48:49], v[32:33], v[32:33], s[20:21] neg_lo:[1,0,1] neg_hi:[1,0,1]
  v_pk_fma_f32 v[50:51], v[34:35], v[34:35], s[20:21] neg_lo:[1,0,1] neg_hi:[1,0,1]
  v_pk_fma_f32 v[52:53], v[36:37], v[36:37], s[20:21] neg_lo:[1,0,1] neg_hi:[1,0,1]
  v_pk_fma_f32 v[54:55], v[38:39], v[38:39], s[20:21] neg_lo:[1,0,1] neg_hi:[1,0,1]
  v_pk_fma_f32 v[56:57], v[40:41], v[40:41], s[20:21] neg_lo:[1,0,1] neg_hi:[1,0,1]
  v_pk_fma_f32 v[58:59], v[42:43], v[42:43], s[20:21] neg_lo:[1,0,1] neg_hi:[1,0,1]
  v_pk_fma_f32 v[60:61], v[44:45], v[44:45], s[20:21] neg_lo:[1,0,1] neg_hi:[1,0,1]
  v_pk_fma_f32 v[62:63], v[46:47], v[46:47], s[20:21] neg_lo:[1,0,1] neg_hi:[1,0,1]
  v_pk_mul_f32 v[48:49], v[32:33], v[48:49]
  v_pk_mul_f32 v[50:51], v[34:35], v[50:51]
  v_pk_mul_f32 v[52:53], v[36:37], v[52:53]
  v_pk_mul_f32 v[54:55], v[38:39], v[54:55]
  v_pk_mul_f32 v[56:57], v[40:41], v[56:57]
  v_pk_mul_f32 v[58:59], v[42:43], v[58:59]
  v_pk_mul_f32 v[60:61], v[44:45], v[60:61]
  v_pk_mul_f32 v[62:63], v[46:47], v[62:63]
  v_mfma_f32_16x16x32_bf16 v[156:159], v[216:219], v[220:223], 0
  v_cvt_pk_bf16_f32 v184, v16, v17
  v_cvt_pk_bf16_f32 v185, v18, v19
  v_mfma_f32_16x16x32_bf16 v[156:159], v[224:227], v[228:231], v[156:159]
  v_cvt_pk_bf16_f32 v186, v20, v21
  v_cvt_pk_bf16_f32 v187, v22, v23
  v_mfma_f32_16x16x32_bf16 v[156:159], v[232:235], v[236:239], v[156:159]
  ds_read_b128 v[216:219], v3
  ds_read_b128 v[220:223], v4
  v_mfma_f32_32x32x16_bf16 v[64:79], v[192:195], v[184:187], v[64:79]
  ds_read_b128 v[224:227], v3 offset:4800
  ds_read_b128 v[228:231], v4 offset:192
  v_cvt_pk_bf16_f32 v188, v24, v25
  v_cvt_pk_bf16_f32 v189, v26, v27
  v_cvt_pk_bf16_f32 v190, v28, v29
  v_cvt_pk_bf16_f32 v191, v30, v31
  v_mfma_f32_32x32x16_bf16 v[80:95], v[196:199], v[184:187], v[80:95]
  ds_read_b128 v[232:235], v3 offset:9600
  ds_read_b128 v[236:239], v4 offset:384
  v_exp_f32 v48, v48
  v_exp_f32 v49, v49
  v_mfma_f32_32x32x16_bf16 v[96:111], v[200:203], v[184:187], v[96:111]
  v_exp_f32 v50, v50
  v_exp_f32 v51, v51
  v_exp_f32_e64 v52, v52
  v_mfma_f32_32x32x16_bf16 v[64:79], v[204:207], v[188:191], v[64:79]
  v_exp_f32 v53, v53
  v_exp_f32 v54, v54
  v_exp_f32_e64 v55, v55
  v_mfma_f32_32x32x16_bf16 v[80:95], v[208:211], v[188:191], v[80:95]
  v_exp_f32 v56, v56
  v_exp_f32 v57, v57
  v_exp_f32_e64 v58, v58
  v_mfma_f32_32x32x16_bf16 v[96:111], v[212:215], v[188:191], v[96:111]
  s_waitcnt lgkmcnt(0)
  v_exp_f32 v59, v59
  v_exp_f32 v60, v60
  v_exp_f32 v61, v61
  v_exp_f32 v62, v62
  v_exp_f32 v63, v63
  v_pk_add_f32 v[12:13], v[12:13], v[156:157]
  v_pk_fma_f32 v[14:15], v[156:157], v[156:157], v[14:15]
  v_pk_add_f32 v[12:13], v[12:13], v[158:159]
  v_pk_fma_f32 v[14:15], v[158:159], v[158:159], v[14:15]
  v_pk_fma_f32 v[48:49], v[48:49], s[22:23], s[22:23]
  v_pk_fma_f32 v[50:51], v[50:51], s[22:23], s[22:23]
  v_pk_fma_f32 v[52:53], v[52:53], s[22:23], s[22:23]
  v_pk_fma_f32 v[54:55], v[54:55], s[22:23], s[22:23]
  v_pk_fma_f32 v[56:57], v[56:57], s[22:23], s[22:23]
  v_pk_fma_f32 v[58:59], v[58:59], s[22:23], s[22:23]
  v_pk_fma_f32 v[60:61], v[60:61], s[22:23], s[22:23]
  v_pk_fma_f32 v[62:63], v[62:63], s[22:23], s[22:23]
  v_mfma_f32_32x32x16_bf16 v[16:31], a[168:171], v[160:163], 0
  ds_read_b128 v[192:195], v0 offset:43008
  ds_read_b128 v[196:199], v0 offset:44032
  v_rcp_f32 v48, v48
  v_rcp_f32 v49, v49
  v_mfma_f32_16x16x32_bf16 v[112:115], v[216:219], v[220:223], 0
  ds_read_b128 v[216:219], v3 offset:400
  ds_read_b128 v[220:223], v4 offset:16
  v_mfma_f32_32x32x16_bf16 v[16:31], a[172:175], v[164:167], v[16:31]
  ds_read_b128 v[200:203], v0 offset:45056
  ds_read_b128 v[204:207], v0 offset:46080
  v_rcp_f32 v50, v50
  v_rcp_f32 v51, v51
  v_mfma_f32_16x16x32_bf16 v[112:115], v[224:227], v[228:231], v[112:115]
  ds_read_b128 v[224:227], v3 offset:5200
  ds_read_b128 v[228:231], v4 offset:208
  v_mfma_f32_32x32x16_bf16 v[16:31], a[176:179], v[168:171], v[16:31]
  ds_read_b128 v[208:211], v0 offset:47104
  ds_read_b128 v[212:215], v0 offset:48128
  v_rcp_f32 v52, v52
  v_rcp_f32 v53, v53
  v_mfma_f32_16x16x32_bf16 v[112:115], v[232:235], v[236:239], v[112:115]
  ds_read_b128 v[232:235], v3 offset:10000
  ds_read_b128 v[236:239], v4 offset:400
  v_mfma_f32_32x32x16_bf16 v[16:31], a[180:183], v[172:175], v[16:31]
  buffer_store_dwordx4 v[128:131], v10, s[8:11], s28 offen offset:128
  v_rcp_f32 v54, v54
  v_rcp_f32 v55, v55
  v_mfma_f32_32x32x16_bf16 v[16:31], a[184:187], v[176:179], v[16:31]
  v_rcp_f32 v56, v56
  v_rcp_f32 v57, v57
  v_rcp_f32_e64 v58, v58
  v_mfma_f32_32x32x16_bf16 v[16:31], a[188:191], v[180:183], v[16:31]
  s_waitcnt lgkmcnt(0)
  v_rcp_f32 v59, v59
  v_rcp_f32 v60, v60
  v_rcp_f32 v61, v61
  v_rcp_f32 v62, v62
  v_rcp_f32 v63, v63
  v_pk_mul_f32 v[32:33], v[32:33], v[48:49]
  v_pk_mul_f32 v[34:35], v[34:35], v[50:51]
  v_pk_mul_f32 v[36:37], v[36:37], v[52:53]
  v_pk_mul_f32 v[38:39], v[38:39], v[54:55]
  v_pk_mul_f32 v[40:41], v[40:41], v[56:57]
  v_pk_mul_f32 v[42:43], v[42:43], v[58:59]
  v_pk_mul_f32 v[44:45], v[44:45], v[60:61]
  v_pk_mul_f32 v[46:47], v[46:47], v[62:63]
  v_pk_add_f32 v[12:13], v[12:13], v[112:113]
  v_pk_fma_f32 v[14:15], v[112:113], v[112:113], v[14:15]
  v_pk_add_f32 v[12:13], v[12:13], v[114:115]
  v_pk_fma_f32 v[14:15], v[114:115], v[114:115], v[14:15]
  v_pk_fma_f32 v[48:49], v[16:17], v[16:17], s[20:21] neg_lo:[1,0,1] neg_hi:[1,0,1]
  v_pk_fma_f32 v[50:51], v[18:19], v[18:19], s[20:21] neg_lo:[1,0,1] neg_hi:[1,0,1]
  v_pk_fma_f32 v[52:53], v[20:21], v[20:21], s[20:21] neg_lo:[1,0,1] neg_hi:[1,0,1]
  v_pk_fma_f32 v[54:55], v[22:23], v[22:23], s[20:21] neg_lo:[1,0,1] neg_hi:[1,0,1]
  v_pk_fma_f32 v[56:57], v[24:25], v[24:25], s[20:21] neg_lo:[1,0,1] neg_hi:[1,0,1]
  v_pk_fma_f32 v[58:59], v[26:27], v[26:27], s[20:21] neg_lo:[1,0,1] neg_hi:[1,0,1]
  v_pk_fma_f32 v[60:61], v[28:29], v[28:29], s[20:21] neg_lo:[1,0,1] neg_hi:[1,0,1]
  v_pk_fma_f32 v[62:63], v[30:31], v[30:31], s[20:21] neg_lo:[1,0,1] neg_hi:[1,0,1]
  v_pk_mul_f32 v[48:49], v[16:17], v[48:49]
  v_pk_mul_f32 v[50:51], v[18:19], v[50:51]
  v_pk_mul_f32 v[52:53], v[20:21], v[52:53]
  v_pk_mul_f32 v[54:55], v[22:23], v[54:55]
  v_pk_mul_f32 v[56:57], v[24:25], v[56:57]
  v_pk_mul_f32 v[58:59], v[26:27], v[58:59]
  v_pk_mul_f32 v[60:61], v[28:29], v[60:61]
  v_pk_mul_f32 v[62:63], v[30:31], v[62:63]
  v_mfma_f32_16x16x32_bf16 v[116:119], v[216:219], v[220:223], 0
  v_cvt_pk_bf16_f32 v184, v32, v33
  v_cvt_pk_bf16_f32 v185, v34, v35
  v_mfma_f32_16x16x32_bf16 v[116:119], v[224:227], v[228:231], v[116:119]
  v_cvt_pk_bf16_f32 v186, v36, v37
  v_cvt_pk_bf16_f32 v187, v38, v39
  v_mfma_f32_16x16x32_bf16 v[116:119], v[232:235], v[236:239], v[116:119]
  ds_read_b128 v[216:219], v3 offset:800
  ds_read_b128 v[220:223], v4 offset:32
  v_mfma_f32_32x32x16_bf16 v[64:79], v[192:195], v[184:187], v[64:79]
  ds_read_b128 v[224:227], v3 offset:5600
  ds_read_b128 v[228:231], v4 offset:224
  v_cvt_pk_bf16_f32 v188, v40, v41
  v_cvt_pk_bf16_f32 v189, v42, v43
  v_cvt_pk_bf16_f32 v190, v44, v45
  v_cvt_pk_bf16_f32 v191, v46, v47
  v_mfma_f32_32x32x16_bf16 v[80:95], v[196:199], v[184:187], v[80:95]
  ds_read_b128 v[232:235], v3 offset:10400
  ds_read_b128 v[236:239], v4 offset:416
  v_exp_f32 v48, v48
  v_exp_f32 v49, v49
  v_mfma_f32_32x32x16_bf16 v[96:111], v[200:203], v[184:187], v[96:111]
  v_exp_f32 v50, v50
  v_exp_f32 v51, v51
  v_exp_f32_e64 v52, v52
  v_mfma_f32_32x32x16_bf16 v[64:79], v[204:207], v[188:191], v[64:79]
  v_exp_f32 v53, v53
  v_exp_f32 v54, v54
  v_exp_f32_e64 v55, v55
  v_mfma_f32_32x32x16_bf16 v[80:95], v[208:211], v[188:191], v[80:95]
  v_exp_f32 v56, v56
  v_exp_f32 v57, v57
  v_exp_f32_e64 v58, v58
  v_mfma_f32_32x32x16_bf16 v[96:111], v[212:215], v[188:191], v[96:111]
  s_waitcnt lgkmcnt(0)
  v_exp_f32 v59, v59
  v_exp_f32 v60, v60
  v_exp_f32 v61, v61
  v_exp_f32 v62, v62
  v_exp_f32 v63, v63
  v_pk_add_f32 v[12:13], v[12:13], v[116:117]
  v_pk_fma_f32 v[14:15], v[116:117], v[116:117], v[14:15]
  v_pk_add_f32 v[12:13], v[12:13], v[118:119]
  v_pk_fma_f32 v[14:15], v[118:119], v[118:119], v[14:15]
  v_pk_fma_f32 v[48:49], v[48:49], s[22:23], s[22:23]
  v_pk_fma_f32 v[50:51], v[50:51], s[22:23], s[22:23]
  v_pk_fma_f32 v[52:53], v[52:53], s[22:23], s[22:23]
  v_pk_fma_f32 v[54:55], v[54:55], s[22:23], s[22:23]
  v_pk_fma_f32 v[56:57], v[56:57], s[22:23], s[22:23]
  v_pk_fma_f32 v[58:59], v[58:59], s[22:23], s[22:23]
  v_pk_fma_f32 v[60:61], v[60:61], s[22:23], s[22:23]
  v_pk_fma_f32 v[62:63], v[62:63], s[22:23], s[22:23]
  v_mfma_f32_32x32x16_bf16 v[32:47], a[192:195], v[160:163], 0
  ds_read_b128 v[192:195], v0 offset:49152
  ds_read_b128 v[196:199], v0 offset:50176
  v_rcp_f32 v48, v48
  v_rcp_f32 v49, v49
  v_mfma_f32_16x16x32_bf16 v[120:123], v[216:219], v[220:223], 0
  ds_read_b128 v[216:219], v3 offset:1200
  ds_read_b128 v[220:223], v4 offset:48
  v_mfma_f32_32x32x16_bf16 v[32:47], a[196:199], v[164:167], v[32:47]
  ds_read_b128 v[200:203], v0 offset:51200
  ds_read_b128 v[204:207], v0 offset:52224
  v_rcp_f32 v50, v50
  v_rcp_f32 v51, v51
  v_mfma_f32_16x16x32_bf16 v[120:123], v[224:227], v[228:231], v[120:123]
  ds_read_b128 v[224:227], v3 offset:6000
  ds_read_b128 v[228:231], v4 offset:240
  v_mfma_f32_32x32x16_bf16 v[32:47], a[200:203], v[168:171], v[32:47]
  ds_read_b128 v[208:211], v0 offset:53248
  ds_read_b128 v[212:215], v0 offset:54272
  v_rcp_f32 v52, v52
  v_rcp_f32 v53, v53
  v_mfma_f32_16x16x32_bf16 v[120:123], v[232:235], v[236:239], v[120:123]
  ds_read_b128 v[232:235], v3 offset:10800
  ds_read_b128 v[236:239], v4 offset:432
  v_mfma_f32_32x32x16_bf16 v[32:47], a[204:207], v[172:175], v[32:47]
  buffer_store_dwordx4 v[132:135], v10, s[8:11], s28 offen offset:160
  v_rcp_f32 v54, v54
  v_rcp_f32 v55, v55
  v_mfma_f32_32x32x16_bf16 v[32:47], a[208:211], v[176:179], v[32:47]
  v_rcp_f32 v56, v56
  v_rcp_f32 v57, v57
  v_rcp_f32_e64 v58, v58
  v_mfma_f32_32x32x16_bf16 v[32:47], a[212:215], v[180:183], v[32:47]
  s_waitcnt lgkmcnt(0)
  v_rcp_f32 v59, v59
  v_rcp_f32 v60, v60
  v_rcp_f32 v61, v61
  v_rcp_f32 v62, v62
  v_rcp_f32 v63, v63
  v_pk_mul_f32 v[16:17], v[16:17], v[48:49]
  v_pk_mul_f32 v[18:19], v[18:19], v[50:51]
  v_pk_mul_f32 v[20:21], v[20:21], v[52:53]
  v_pk_mul_f32 v[22:23], v[22:23], v[54:55]
  v_pk_mul_f32 v[24:25], v[24:25], v[56:57]
  v_pk_mul_f32 v[26:27], v[26:27], v[58:59]
  v_pk_mul_f32 v[28:29], v[28:29], v[60:61]
  v_pk_mul_f32 v[30:31], v[30:31], v[62:63]
  v_pk_add_f32 v[12:13], v[12:13], v[120:121]
  v_pk_fma_f32 v[14:15], v[120:121], v[120:121], v[14:15]
  v_pk_add_f32 v[12:13], v[12:13], v[122:123]
  v_pk_fma_f32 v[14:15], v[122:123], v[122:123], v[14:15]
  v_pk_fma_f32 v[48:49], v[32:33], v[32:33], s[20:21] neg_lo:[1,0,1] neg_hi:[1,0,1]
  v_pk_fma_f32 v[50:51], v[34:35], v[34:35], s[20:21] neg_lo:[1,0,1] neg_hi:[1,0,1]
  v_pk_fma_f32 v[52:53], v[36:37], v[36:37], s[20:21] neg_lo:[1,0,1] neg_hi:[1,0,1]
  v_pk_fma_f32 v[54:55], v[38:39], v[38:39], s[20:21] neg_lo:[1,0,1] neg_hi:[1,0,1]
  v_pk_fma_f32 v[56:57], v[40:41], v[40:41], s[20:21] neg_lo:[1,0,1] neg_hi:[1,0,1]
  v_pk_fma_f32 v[58:59], v[42:43], v[42:43], s[20:21] neg_lo:[1,0,1] neg_hi:[1,0,1]
  v_pk_fma_f32 v[60:61], v[44:45], v[44:45], s[20:21] neg_lo:[1,0,1] neg_hi:[1,0,1]
  v_pk_fma_f32 v[62:63], v[46:47], v[46:47], s[20:21] neg_lo:[1,0,1] neg_hi:[1,0,1]
  v_pk_mul_f32 v[48:49], v[32:33], v[48:49]
  v_pk_mul_f32 v[50:51], v[34:35], v[50:51]
  v_pk_mul_f32 v[52:53], v[36:37], v[52:53]
  v_pk_mul_f32 v[54:55], v[38:39], v[54:55]
  v_pk_mul_f32 v[56:57], v[40:41], v[56:57]
  v_pk_mul_f32 v[58:59], v[42:43], v[58:59]
  v_pk_mul_f32 v[60:61], v[44:45], v[60:61]
  v_pk_mul_f32 v[62:63], v[46:47], v[62:63]
  v_mfma_f32_16x16x32_bf16 v[124:127], v[216:219], v[220:223], 0
  v_cvt_pk_bf16_f32 v184, v16, v17
  v_cvt_pk_bf16_f32 v185, v18, v19
  v_mfma_f32_16x16x32_bf16 v[124:127], v[224:227], v[228:231], v[124:127]
  v_cvt_pk_bf16_f32 v186, v20, v21
  v_cvt_pk_bf16_f32 v187, v22, v23
  v_mfma_f32_16x16x32_bf16 v[124:127], v[232:235], v[236:239], v[124:127]
  ds_read_b128 v[216:219], v3 offset:1600
  ds_read_b128 v[220:223], v4 offset:64
  v_mfma_f32_32x32x16_bf16 v[64:79], v[192:195], v[184:187], v[64:79]
  ds_read_b128 v[224:227], v3 offset:6400
  ds_read_b128 v[228:231], v4 offset:256
  v_cvt_pk_bf16_f32 v188, v24, v25
  v_cvt_pk_bf16_f32 v189, v26, v27
  v_cvt_pk_bf16_f32 v190, v28, v29
  v_cvt_pk_bf16_f32 v191, v30, v31
  v_mfma_f32_32x32x16_bf16 v[80:95], v[196:199], v[184:187], v[80:95]
  ds_read_b128 v[232:235], v3 offset:11200
  ds_read_b128 v[236:239], v4 offset:448
  v_exp_f32 v48, v48
  v_exp_f32 v49, v49
  v_mfma_f32_32x32x16_bf16 v[96:111], v[200:203], v[184:187], v[96:111]
  v_exp_f32 v50, v50
  v_exp_f32 v51, v51
  v_exp_f32_e64 v52, v52
  v_mfma_f32_32x32x16_bf16 v[64:79], v[204:207], v[188:191], v[64:79]
  v_exp_f32 v53, v53
  v_exp_f32 v54, v54
  v_exp_f32_e64 v55, v55
  v_mfma_f32_32x32x16_bf16 v[80:95], v[208:211], v[188:191], v[80:95]
  v_exp_f32 v56, v56
  v_exp_f32 v57, v57
  v_exp_f32_e64 v58, v58
  v_mfma_f32_32x32x16_bf16 v[96:111], v[212:215], v[188:191], v[96:111]
  s_waitcnt lgkmcnt(0)
  v_exp_f32 v59, v59
  v_exp_f32 v60, v60
  v_exp_f32 v61, v61
  v_exp_f32 v62, v62
  v_exp_f32 v63, v63
  v_pk_add_f32 v[12:13], v[12:13], v[124:125]
  v_pk_fma_f32 v[14:15], v[124:125], v[124:125], v[14:15]
  v_pk_add_f32 v[12:13], v[12:13], v[126:127]
  v_pk_fma_f32 v[14:15], v[126:127], v[126:127], v[14:15]
  v_pk_fma_f32 v[48:49], v[48:49], s[22:23], s[22:23]
  v_pk_fma_f32 v[50:51], v[50:51], s[22:23], s[22:23]
  v_pk_fma_f32 v[52:53], v[52:53], s[22:23], s[22:23]
  v_pk_fma_f32 v[54:55], v[54:55], s[22:23], s[22:23]
  v_pk_fma_f32 v[56:57], v[56:57], s[22:23], s[22:23]
  v_pk_fma_f32 v[58:59], v[58:59], s[22:23], s[22:23]
  v_pk_fma_f32 v[60:61], v[60:61], s[22:23], s[22:23]
  v_pk_fma_f32 v[62:63], v[62:63], s[22:23], s[22:23]
  v_mfma_f32_32x32x16_bf16 v[16:31], a[216:219], v[160:163], 0
  ds_read_b128 v[192:195], v0 offset:55296
  ds_read_b128 v[196:199], v0 offset:56320
  v_rcp_f32 v48, v48
  v_rcp_f32 v49, v49
  v_mfma_f32_16x16x32_bf16 v[128:131], v[216:219], v[220:223], 0
  ds_read_b128 v[216:219], v3 offset:2000
  ds_read_b128 v[220:223], v4 offset:80
  v_mfma_f32_32x32x16_bf16 v[16:31], a[220:223], v[164:167], v[16:31]
  ds_read_b128 v[200:203], v0 offset:57344
  ds_read_b128 v[204:207], v0 offset:58368
  v_rcp_f32 v50, v50
  v_rcp_f32 v51, v51
  v_mfma_f32_16x16x32_bf16 v[128:131], v[224:227], v[228:231], v[128:131]
  ds_read_b128 v[224:227], v3 offset:6800
  ds_read_b128 v[228:231], v4 offset:272
  v_mfma_f32_32x32x16_bf16 v[16:31], a[224:227], v[168:171], v[16:31]
  ds_read_b128 v[208:211], v0 offset:59392
  ds_read_b128 v[212:215], v0 offset:60416
  v_rcp_f32 v52, v52
  v_rcp_f32 v53, v53
  v_mfma_f32_16x16x32_bf16 v[128:131], v[232:235], v[236:239], v[128:131]
  ds_read_b128 v[232:235], v3 offset:11600
  ds_read_b128 v[236:239], v4 offset:464
  v_mfma_f32_32x32x16_bf16 v[16:31], a[228:231], v[172:175], v[16:31]
  v_rcp_f32 v54, v54
  v_rcp_f32 v55, v55
  v_rcp_f32_e64 v56, v56
  v_mfma_f32_32x32x16_bf16 v[16:31], a[232:235], v[176:179], v[16:31]
  v_rcp_f32 v57, v57
  v_rcp_f32 v58, v58
  v_rcp_f32_e64 v59, v59
  v_mfma_f32_32x32x16_bf16 v[16:31], a[236:239], v[180:183], v[16:31]
  s_waitcnt lgkmcnt(0)
  v_rcp_f32 v60, v60
  v_rcp_f32 v61, v61
  v_rcp_f32 v62, v62
  v_rcp_f32_e64 v63, v63
  v_pk_mul_f32 v[32:33], v[32:33], v[48:49]
  v_pk_mul_f32 v[34:35], v[34:35], v[50:51]
  v_pk_mul_f32 v[36:37], v[36:37], v[52:53]
  v_pk_mul_f32 v[38:39], v[38:39], v[54:55]
  v_pk_mul_f32 v[40:41], v[40:41], v[56:57]
  v_pk_mul_f32 v[42:43], v[42:43], v[58:59]
  v_pk_mul_f32 v[44:45], v[44:45], v[60:61]
  v_pk_mul_f32 v[46:47], v[46:47], v[62:63]
  v_pk_add_f32 v[12:13], v[12:13], v[128:129]
  v_pk_fma_f32 v[14:15], v[128:129], v[128:129], v[14:15]
  v_pk_add_f32 v[12:13], v[12:13], v[130:131]
  v_pk_fma_f32 v[14:15], v[130:131], v[130:131], v[14:15]
  v_pk_fma_f32 v[48:49], v[16:17], v[16:17], s[20:21] neg_lo:[1,0,1] neg_hi:[1,0,1]
  v_pk_fma_f32 v[50:51], v[18:19], v[18:19], s[20:21] neg_lo:[1,0,1] neg_hi:[1,0,1]
  v_pk_fma_f32 v[52:53], v[20:21], v[20:21], s[20:21] neg_lo:[1,0,1] neg_hi:[1,0,1]
  v_pk_fma_f32 v[54:55], v[22:23], v[22:23], s[20:21] neg_lo:[1,0,1] neg_hi:[1,0,1]
  v_pk_fma_f32 v[56:57], v[24:25], v[24:25], s[20:21] neg_lo:[1,0,1] neg_hi:[1,0,1]
  v_pk_fma_f32 v[58:59], v[26:27], v[26:27], s[20:21] neg_lo:[1,0,1] neg_hi:[1,0,1]
  v_pk_fma_f32 v[60:61], v[28:29], v[28:29], s[20:21] neg_lo:[1,0,1] neg_hi:[1,0,1]
  v_pk_fma_f32 v[62:63], v[30:31], v[30:31], s[20:21] neg_lo:[1,0,1] neg_hi:[1,0,1]
  v_pk_mul_f32 v[48:49], v[16:17], v[48:49]
  v_pk_mul_f32 v[50:51], v[18:19], v[50:51]
  v_pk_mul_f32 v[52:53], v[20:21], v[52:53]
  v_pk_mul_f32 v[54:55], v[22:23], v[54:55]
  v_pk_mul_f32 v[56:57], v[24:25], v[56:57]
  v_pk_mul_f32 v[58:59], v[26:27], v[58:59]
  v_pk_mul_f32 v[60:61], v[28:29], v[60:61]
  v_pk_mul_f32 v[62:63], v[30:31], v[62:63]
  v_mfma_f32_16x16x32_bf16 v[132:135], v[216:219], v[220:223], 0
  v_cvt_pk_bf16_f32 v184, v32, v33
  v_cvt_pk_bf16_f32 v185, v34, v35
  v_mfma_f32_16x16x32_bf16 v[132:135], v[224:227], v[228:231], v[132:135]
  v_cvt_pk_bf16_f32 v186, v36, v37
  v_cvt_pk_bf16_f32 v187, v38, v39
  v_mfma_f32_16x16x32_bf16 v[132:135], v[232:235], v[236:239], v[132:135]
  ds_read_b128 v[216:219], v0 offset:12288
  ds_read_b128 v[220:223], v0 offset:13312
  v_mfma_f32_32x32x16_bf16 v[64:79], v[192:195], v[184:187], v[64:79]
  ds_read_b128 v[224:227], v0 offset:14336
  ds_read_b128 v[228:231], v0 offset:15360
  v_cvt_pk_bf16_f32 v188, v40, v41
  v_cvt_pk_bf16_f32 v189, v42, v43
  v_cvt_pk_bf16_f32 v190, v44, v45
  v_cvt_pk_bf16_f32 v191, v46, v47
  v_mfma_f32_32x32x16_bf16 v[80:95], v[196:199], v[184:187], v[80:95]
  ds_read_b128 v[232:235], v0 offset:16384
  ds_read_b128 v[236:239], v0 offset:17408
  v_exp_f32 v48, v48
  v_exp_f32 v49, v49
  v_mfma_f32_32x32x16_bf16 v[96:111], v[200:203], v[184:187], v[96:111]
  v_exp_f32 v50, v50
  v_exp_f32 v51, v51
  v_exp_f32_e64 v52, v52
  v_mfma_f32_32x32x16_bf16 v[64:79], v[204:207], v[188:191], v[64:79]
  s_mov_b32 s28, s34
  v_exp_f32 v53, v53
  v_exp_f32 v54, v54
  v_exp_f32 v55, v55
  v_mfma_f32_32x32x16_bf16 v[80:95], v[208:211], v[188:191], v[80:95]
  s_add_u32 s34, s34, 0x60000
  v_exp_f32 v56, v56
  v_exp_f32 v57, v57
  v_exp_f32_e64 v58, v58
  v_mfma_f32_32x32x16_bf16 v[96:111], v[212:215], v[188:191], v[96:111]
  s_waitcnt lgkmcnt(0)
  v_exp_f32 v59, v59
  v_exp_f32 v60, v60
  v_exp_f32 v61, v61
  v_exp_f32 v62, v62
  v_exp_f32 v63, v63
  v_pk_add_f32 v[12:13], v[12:13], v[132:133]
  v_pk_fma_f32 v[14:15], v[132:133], v[132:133], v[14:15]
  v_pk_add_f32 v[12:13], v[12:13], v[134:135]
  v_pk_fma_f32 v[14:15], v[134:135], v[134:135], v[14:15]
  v_pk_fma_f32 v[48:49], v[48:49], s[22:23], s[22:23]
  v_pk_fma_f32 v[50:51], v[50:51], s[22:23], s[22:23]
  v_pk_fma_f32 v[52:53], v[52:53], s[22:23], s[22:23]
  v_pk_fma_f32 v[54:55], v[54:55], s[22:23], s[22:23]
  v_pk_fma_f32 v[56:57], v[56:57], s[22:23], s[22:23]
  v_pk_fma_f32 v[58:59], v[58:59], s[22:23], s[22:23]
  v_pk_fma_f32 v[60:61], v[60:61], s[22:23], s[22:23]
  v_pk_fma_f32 v[62:63], v[62:63], s[22:23], s[22:23]
  v_mfma_f32_32x32x16_bf16 v[32:47], v[216:219], v[160:163], 0
  ds_read_b128 v[192:195], v0 offset:61440
  ds_read_b128 v[196:199], v0 offset:62464
  v_rcp_f32 v48, v48
  v_rcp_f32 v49, v49
  v_add_f32_e64 v12, v12, v13
  v_mfma_f32_32x32x16_bf16 v[32:47], v[220:223], v[164:167], v[32:47]
  ds_read_b128 v[200:203], v0 offset:63488
  ds_read_b128 v[204:207], v0 offset:64512
  v_rcp_f32 v50, v50
  v_add_f32 v14, v14, v15
  v_rcp_f32_e64 v51, v51
  v_mfma_f32_32x32x16_bf16 v[32:47], v[224:227], v[168:171], v[32:47]
  ds_read_b128 v[208:211], v1
  ds_read_b128 v[212:215], v1 offset:1024
  v_permlane32_swap_b32 v12, v14
  v_rcp_f32 v52, v52
  v_add_f32 v12, v12, v14
  v_rcp_f32 v53, v53
  v_mfma_f32_32x32x16_bf16 v[32:47], v[228:231], v[172:175], v[32:47]
  v_mov_b32 v14, v12
  v_rcp_f32 v54, v54
  s_nop 0
  v_permlane32_swap_b32 v12, v14
  v_rcp_f32 v55, v55
  v_mul_f32 v12, s24, v12
  v_mfma_f32_32x32x16_bf16 v[32:47], v[232:235], v[176:179], v[32:47]
  v_rcp_f32 v56, v56
  v_rcp_f32 v57, v57
  v_mul_f32 v13, s24, v14
  v_rcp_f32 v58, v58
  v_fma_f32 v13, -v12, v12, v13
  v_mfma_f32_32x32x16_bf16 v[32:47], v[236:239], v[180:183], v[32:47]
  s_waitcnt lgkmcnt(0)
  v_rcp_f32 v59, v59
  v_max_f32 v13, 0, v13
  v_rcp_f32 v60, v60
  v_add_f32 v13, s25, v13
  v_rcp_f32 v61, v61
  v_rsq_f32 v13, v13
  v_rcp_f32 v62, v62
  v_mul_f32 v14, s22, v13
  v_rcp_f32 v63, v63
  v_mul_f32_e64 v12, -v12, v14
  v_pk_mul_f32 v[16:17], v[16:17], v[48:49]
  v_pk_mul_f32 v[18:19], v[18:19], v[50:51]
  v_pk_mul_f32 v[20:21], v[20:21], v[52:53]
  v_pk_mul_f32 v[22:23], v[22:23], v[54:55]
  v_pk_mul_f32 v[24:25], v[24:25], v[56:57]
  v_pk_mul_f32 v[26:27], v[26:27], v[58:59]
  v_pk_mul_f32 v[28:29], v[28:29], v[60:61]
  v_pk_mul_f32 v[30:31], v[30:31], v[62:63]
  v_pk_fma_f32 v[112:113], v[112:113], v[14:15], v[12:13] op_sel_hi:[1,0,0]
  v_pk_fma_f32 v[114:115], v[114:115], v[14:15], v[12:13] op_sel_hi:[1,0,0]
  v_pk_fma_f32 v[116:117], v[116:117], v[14:15], v[12:13] op_sel_hi:[1,0,0]
  v_pk_fma_f32 v[118:119], v[118:119], v[14:15], v[12:13] op_sel_hi:[1,0,0]
  v_pk_fma_f32 v[120:121], v[120:121], v[14:15], v[12:13] op_sel_hi:[1,0,0]
  v_pk_fma_f32 v[122:123], v[122:123], v[14:15], v[12:13] op_sel_hi:[1,0,0]
  v_pk_fma_f32 v[124:125], v[124:125], v[14:15], v[12:13] op_sel_hi:[1,0,0]
  v_pk_fma_f32 v[126:127], v[126:127], v[14:15], v[12:13] op_sel_hi:[1,0,0]
  v_pk_fma_f32 v[128:129], v[128:129], v[14:15], v[12:13] op_sel_hi:[1,0,0]
  v_pk_fma_f32 v[130:131], v[130:131], v[14:15], v[12:13] op_sel_hi:[1,0,0]
  v_pk_fma_f32 v[132:133], v[132:133], v[14:15], v[12:13] op_sel_hi:[1,0,0]
  v_pk_fma_f32 v[134:135], v[134:135], v[14:15], v[12:13] op_sel_hi:[1,0,0]
  v_pk_fma_f32 v[136:137], v[136:137], v[14:15], v[12:13] op_sel_hi:[1,0,0]
  v_pk_fma_f32 v[138:139], v[138:139], v[14:15], v[12:13] op_sel_hi:[1,0,0]
  v_pk_fma_f32 v[140:141], v[140:141], v[14:15], v[12:13] op_sel_hi:[1,0,0]
  v_pk_fma_f32 v[142:143], v[142:143], v[14:15], v[12:13] op_sel_hi:[1,0,0]
  v_pk_fma_f32 v[144:145], v[144:145], v[14:15], v[12:13] op_sel_hi:[1,0,0]
  v_pk_fma_f32 v[146:147], v[146:147], v[14:15], v[12:13] op_sel_hi:[1,0,0]
  v_pk_fma_f32 v[148:149], v[148:149], v[14:15], v[12:13] op_sel_hi:[1,0,0]
  v_pk_fma_f32 v[150:151], v[150:151], v[14:15], v[12:13] op_sel_hi:[1,0,0]
  v_pk_fma_f32 v[152:153], v[152:153], v[14:15], v[12:13] op_sel_hi:[1,0,0]
  v_pk_fma_f32 v[154:155], v[154:155], v[14:15], v[12:13] op_sel_hi:[1,0,0]
  v_pk_fma_f32 v[156:157], v[156:157], v[14:15], v[12:13] op_sel_hi:[1,0,0]
  v_pk_fma_f32 v[158:159], v[158:159], v[14:15], v[12:13] op_sel_hi:[1,0,0]
  v_pk_fma_f32 v[48:49], v[32:33], v[32:33], s[20:21] neg_lo:[1,0,1] neg_hi:[1,0,1]
  v_pk_fma_f32 v[50:51], v[34:35], v[34:35], s[20:21] neg_lo:[1,0,1] neg_hi:[1,0,1]
  v_pk_fma_f32 v[52:53], v[36:37], v[36:37], s[20:21] neg_lo:[1,0,1] neg_hi:[1,0,1]
  v_pk_fma_f32 v[54:55], v[38:39], v[38:39], s[20:21] neg_lo:[1,0,1] neg_hi:[1,0,1]
  v_pk_fma_f32 v[56:57], v[40:41], v[40:41], s[20:21] neg_lo:[1,0,1] neg_hi:[1,0,1]
  v_pk_fma_f32 v[58:59], v[42:43], v[42:43], s[20:21] neg_lo:[1,0,1] neg_hi:[1,0,1]
  v_pk_fma_f32 v[60:61], v[44:45], v[44:45], s[20:21] neg_lo:[1,0,1] neg_hi:[1,0,1]
  v_pk_fma_f32 v[62:63], v[46:47], v[46:47], s[20:21] neg_lo:[1,0,1] neg_hi:[1,0,1]
  v_pk_mul_f32 v[48:49], v[32:33], v[48:49]
  v_pk_mul_f32 v[50:51], v[34:35], v[50:51]
  v_pk_mul_f32 v[52:53], v[36:37], v[52:53]
  v_pk_mul_f32 v[54:55], v[38:39], v[54:55]
  v_pk_mul_f32 v[56:57], v[40:41], v[56:57]
  v_cvt_pk_bf16_f32 v184, v16, v17
  v_cvt_pk_bf16_f32 v185, v18, v19
  v_cvt_pk_bf16_f32 v186, v20, v21
  v_cvt_pk_bf16_f32 v187, v22, v23
  v_pk_mul_f32 v[58:59], v[42:43], v[58:59]
  v_pk_mul_f32 v[60:61], v[44:45], v[60:61]
  v_pk_mul_f32 v[62:63], v[46:47], v[62:63]
  v_mfma_f32_32x32x16_bf16 v[64:79], v[192:195], v[184:187], v[64:79]
  ds_read_b128 v[216:219], v0 offset:18432
  ds_read_b128 v[220:223], v0 offset:19456
  v_cvt_pk_bf16_f32 v188, v24, v25
  v_cvt_pk_bf16_f32 v189, v26, v27
  v_cvt_pk_bf16_f32 v190, v28, v29
  v_cvt_pk_bf16_f32 v191, v30, v31
  v_exp_f32_e64 v48, v48
  v_cndmask_b32 v159, v159, v250, s[12:13]
  v_mfma_f32_32x32x16_bf16 v[80:95], v[196:199], v[184:187], v[80:95]
  ds_read_b128 v[224:227], v0 offset:20480
  ds_read_b128 v[228:231], v0 offset:21504
  v_exp_f32_e64 v49, v49
  v_cvt_pk_bf16_f32 v160, v112, v113
  v_cvt_pk_bf16_f32 v161, v114, v115
  v_exp_f32_e64 v50, v50
  v_cvt_pk_bf16_f32 v162, v116, v117
  v_mfma_f32_32x32x16_bf16 v[96:111], v[200:203], v[184:187], v[96:111]
  ds_read_b128 v[232:235], v0 offset:22528
  ds_read_b128 v[236:239], v0 offset:23552
  v_exp_f32_e64 v51, v51
  v_cvt_pk_bf16_f32 v163, v118, v119
  v_cvt_pk_bf16_f32 v164, v120, v121
  v_exp_f32_e64 v52, v52
  v_cvt_pk_bf16_f32 v165, v122, v123
  v_mfma_f32_32x32x16_bf16 v[64:79], v[204:207], v[188:191], v[64:79]
  v_exp_f32_e64 v53, v53
  v_cvt_pk_bf16_f32 v166, v124, v125
  v_cvt_pk_bf16_f32 v167, v126, v127
  v_exp_f32_e64 v54, v54
  v_cvt_pk_bf16_f32 v168, v128, v129
  v_exp_f32_e64 v55, v55
  v_cvt_pk_bf16_f32 v169, v130, v131
  v_cvt_pk_bf16_f32 v170, v132, v133
  v_mfma_f32_32x32x16_bf16 v[80:95], v[208:211], v[188:191], v[80:95]
  v_exp_f32_e64 v56, v56
  v_cvt_pk_bf16_f32 v171, v134, v135
  v_cvt_pk_bf16_f32 v172, v136, v137
  v_exp_f32_e64 v57, v57
  v_cvt_pk_bf16_f32 v173, v138, v139
  v_exp_f32_e64 v58, v58
  v_cvt_pk_bf16_f32 v174, v140, v141
  v_cvt_pk_bf16_f32 v175, v142, v143
  v_mfma_f32_32x32x16_bf16 v[96:111], v[212:215], v[188:191], v[96:111]
  s_waitcnt lgkmcnt(0)
  v_exp_f32 v59, v59
  v_cvt_pk_bf16_f32 v176, v144, v145
  v_exp_f32_e64 v60, v60
  v_cvt_pk_bf16_f32 v177, v146, v147
  v_cvt_pk_bf16_f32 v178, v148, v149
  v_exp_f32_e64 v61, v61
  v_cvt_pk_bf16_f32 v179, v150, v151
  v_exp_f32_e64 v62, v62
  v_cvt_pk_bf16_f32 v180, v152, v153
  v_cvt_pk_bf16_f32 v181, v154, v155
  v_exp_f32_e64 v63, v63
  v_cvt_pk_bf16_f32 v182, v156, v157
  v_cvt_pk_bf16_f32 v183, v158, v159
  v_pk_fma_f32 v[48:49], v[48:49], s[22:23], s[22:23]
  v_pk_fma_f32 v[50:51], v[50:51], s[22:23], s[22:23]
  v_pk_fma_f32 v[52:53], v[52:53], s[22:23], s[22:23]
  v_pk_fma_f32 v[54:55], v[54:55], s[22:23], s[22:23]
  v_pk_fma_f32 v[56:57], v[56:57], s[22:23], s[22:23]
  v_pk_fma_f32 v[58:59], v[58:59], s[22:23], s[22:23]
  v_pk_fma_f32 v[60:61], v[60:61], s[22:23], s[22:23]
  v_pk_fma_f32 v[62:63], v[62:63], s[22:23], s[22:23]
  s_sub_u32 s26, s26, 1
  s_cmp_lg_u32 s26, 0
  s_waitcnt vmcnt(4)
  s_cbranch_scc1 L_loop
  v_mfma_f32_32x32x16_bf16 v[16:31], v[216:219], v[160:163], 0
  ds_read_b128 v[192:195], v1 offset:2048
  ds_read_b128 v[196:199], v1 offset:3072
  ds_read_b128 v[200:203], v1 offset:4096
  v_rcp_f32 v48, v48
  v_rcp_f32 v49, v49
  v_mfma_f32_32x32x16_bf16 v[16:31], v[220:223], v[164:167], v[16:31]
  ds_read_b128 v[204:207], v1 offset:5120
  ds_read_b128 v[208:211], v1 offset:6144
  ds_read_b128 v[212:215], v1 offset:7168
  v_rcp_f32 v50, v50
  v_rcp_f32 v51, v51
  v_mfma_f32_32x32x16_bf16 v[16:31], v[224:227], v[168:171], v[16:31]
  ds_read_b128 v[136:139], v5
  ds_read_b128 v[140:143], v5 offset:32
  ds_read_b128 v[144:147], v5 offset:64
  v_rcp_f32 v52, v52
  v_rcp_f32 v53, v53
  v_mfma_f32_32x32x16_bf16 v[16:31], v[228:231], v[172:175], v[16:31]
  ds_read_b128 v[148:151], v5 offset:96
  ds_read_b128 v[152:155], v5 offset:128
  ds_read_b128 v[156:159], v5 offset:160
  v_rcp_f32 v54, v54
  v_rcp_f32 v55, v55
  v_mfma_f32_32x32x16_bf16 v[16:31], v[232:235], v[176:179], v[16:31]
  v_rcp_f32 v56, v56
  v_rcp_f32 v57, v57
  v_rcp_f32_e64 v58, v58
  v_mfma_f32_32x32x16_bf16 v[16:31], v[236:239], v[180:183], v[16:31]
  s_waitcnt lgkmcnt(0)
  v_rcp_f32 v59, v59
  v_rcp_f32 v60, v60
  v_rcp_f32 v61, v61
  v_rcp_f32 v62, v62
  v_rcp_f32 v63, v63
  v_pk_mul_f32 v[32:33], v[32:33], v[48:49]
  v_pk_mul_f32 v[34:35], v[34:35], v[50:51]
  v_pk_mul_f32 v[36:37], v[36:37], v[52:53]
  v_pk_mul_f32 v[38:39], v[38:39], v[54:55]
  v_pk_mul_f32 v[40:41], v[40:41], v[56:57]
  v_pk_mul_f32 v[42:43], v[42:43], v[58:59]
  v_pk_mul_f32 v[44:45], v[44:45], v[60:61]
  v_pk_mul_f32 v[46:47], v[46:47], v[62:63]
  v_pk_fma_f32 v[48:49], v[16:17], v[16:17], s[20:21] neg_lo:[1,0,1] neg_hi:[1,0,1]
  v_pk_fma_f32 v[50:51], v[18:19], v[18:19], s[20:21] neg_lo:[1,0,1] neg_hi:[1,0,1]
  v_pk_fma_f32 v[52:53], v[20:21], v[20:21], s[20:21] neg_lo:[1,0,1] neg_hi:[1,0,1]
  v_pk_fma_f32 v[54:55], v[22:23], v[22:23], s[20:21] neg_lo:[1,0,1] neg_hi:[1,0,1]
  v_pk_fma_f32 v[56:57], v[24:25], v[24:25], s[20:21] neg_lo:[1,0,1] neg_hi:[1,0,1]
  v_pk_fma_f32 v[58:59], v[26:27], v[26:27], s[20:21] neg_lo:[1,0,1] neg_hi:[1,0,1]
  v_pk_fma_f32 v[60:61], v[28:29], v[28:29], s[20:21] neg_lo:[1,0,1] neg_hi:[1,0,1]
  v_pk_fma_f32 v[62:63], v[30:31], v[30:31], s[20:21] neg_lo:[1,0,1] neg_hi:[1,0,1]
  v_pk_mul_f32 v[48:49], v[16:17], v[48:49]
  v_pk_mul_f32 v[50:51], v[18:19], v[50:51]
  v_pk_mul_f32 v[52:53], v[20:21], v[52:53]
  v_pk_mul_f32 v[54:55], v[22:23], v[54:55]
  v_pk_mul_f32 v[56:57], v[24:25], v[56:57]
  v_cvt_pk_bf16_f32 v184, v32, v33
  v_cvt_pk_bf16_f32 v185, v34, v35
  v_cvt_pk_bf16_f32 v186, v36, v37
  v_cvt_pk_bf16_f32 v187, v38, v39
  v_pk_mul_f32 v[58:59], v[26:27], v[58:59]
  v_pk_mul_f32 v[60:61], v[28:29], v[60:61]
  v_pk_mul_f32 v[62:63], v[30:31], v[62:63]
  v_mfma_f32_32x32x16_bf16 v[64:79], v[192:195], v[184:187], v[64:79]
  v_cvt_pk_bf16_f32 v188, v40, v41
  v_cvt_pk_bf16_f32 v189, v42, v43
  v_cvt_pk_bf16_f32 v190, v44, v45
  v_cvt_pk_bf16_f32 v191, v46, v47
  v_exp_f32_e64 v48, v48
  v_mfma_f32_32x32x16_bf16 v[80:95], v[196:199], v[184:187], v[80:95]
  v_exp_f32 v49, v49
  v_exp_f32 v50, v50
  v_exp_f32_e64 v51, v51
  v_mfma_f32_32x32x16_bf16 v[96:111], v[200:203], v[184:187], v[96:111]
  v_exp_f32 v52, v52
  v_exp_f32 v53, v53
  v_exp_f32_e64 v54, v54
  v_mfma_f32_32x32x16_bf16 v[64:79], v[204:207], v[188:191], v[64:79]
  v_exp_f32 v55, v55
  v_exp_f32 v56, v56
  v_exp_f32_e64 v57, v57
  v_mfma_f32_32x32x16_bf16 v[80:95], v[208:211], v[188:191], v[80:95]
  v_exp_f32 v58, v58
  v_exp_f32 v59, v59
  v_exp_f32_e64 v60, v60
  v_mfma_f32_32x32x16_bf16 v[96:111], v[212:215], v[188:191], v[96:111]
  v_exp_f32 v61, v61
  v_exp_f32 v62, v62
  v_exp_f32_e64 v63, v63
  v_pk_fma_f32 v[48:49], v[48:49], s[22:23], s[22:23]
  v_pk_fma_f32 v[50:51], v[50:51], s[22:23], s[22:23]
  v_pk_fma_f32 v[52:53], v[52:53], s[22:23], s[22:23]
  v_pk_fma_f32 v[54:55], v[54:55], s[22:23], s[22:23]
  v_pk_fma_f32 v[56:57], v[56:57], s[22:23], s[22:23]
  v_pk_fma_f32 v[58:59], v[58:59], s[22:23], s[22:23]
  v_pk_fma_f32 v[60:61], v[60:61], s[22:23], s[22:23]
  v_pk_fma_f32 v[62:63], v[62:63], s[22:23], s[22:23]
  v_mfma_f32_32x32x16_bf16 v[32:47], a[0:3], v[160:163], 0
  v_cvt_pk_bf16_f32 v112, v64, v65
  v_cvt_pk_bf16_f32 v113, v66, v67
  v_cvt_pk_bf16_f32 v114, v68, v69
  v_cvt_pk_bf16_f32 v115, v70, v71
  v_cvt_pk_bf16_f32 v116, v72, v73
  v_cvt_pk_bf16_f32 v117, v74, v75
  v_mfma_f32_32x32x16_bf16 v[32:47], a[4:7], v[164:167], v[32:47]
  v_cvt_pk_bf16_f32 v118, v76, v77
  v_cvt_pk_bf16_f32 v119, v78, v79
  v_cvt_pk_bf16_f32 v120, v80, v81
  v_cvt_pk_bf16_f32 v121, v82, v83
  v_cvt_pk_bf16_f32 v122, v84, v85
  v_cvt_pk_bf16_f32 v123, v86, v87
  v_mfma_f32_32x32x16_bf16 v[32:47], a[8:11], v[168:171], v[32:47]
  ds_read_b128 v[64:67], v2
  ds_read_b128 v[68:71], v2 offset:32
  ds_read_b128 v[72:75], v2 offset:64
  ds_read_b128 v[76:79], v2 offset:96
  v_cvt_pk_bf16_f32 v124, v88, v89
  v_cvt_pk_bf16_f32 v125, v90, v91
  v_mfma_f32_32x32x16_bf16 v[32:47], a[12:15], v[172:175], v[32:47]
  ds_read_b128 v[192:195], v1 offset:8192
  ds_read_b128 v[196:199], v1 offset:9216
  v_cvt_pk_bf16_f32 v126, v92, v93
  v_cvt_pk_bf16_f32 v127, v94, v95
  v_cvt_pk_bf16_f32 v128, v96, v97
  v_cvt_pk_bf16_f32 v129, v98, v99
  v_mfma_f32_32x32x16_bf16 v[32:47], a[16:19], v[176:179], v[32:47]
  ds_read_b128 v[80:83], v2 offset:128
  ds_read_b128 v[84:87], v2 offset:160
  ds_read_b128 v[88:91], v2 offset:192
  ds_read_b128 v[92:95], v2 offset:224
  v_cvt_pk_bf16_f32 v130, v100, v101
  v_cvt_pk_bf16_f32 v131, v102, v103
  v_mfma_f32_32x32x16_bf16 v[32:47], a[20:23], v[180:183], v[32:47]
  s_nop 0
  s_waitcnt lgkmcnt(6)
  ds_read_b128 v[200:203], v1 offset:10240
  ds_read_b128 v[204:207], v1 offset:11264
  v_cvt_pk_bf16_f32 v132, v104, v105
  v_cvt_pk_bf16_f32 v133, v106, v107
  v_cvt_pk_bf16_f32 v134, v108, v109
  v_cvt_pk_bf16_f32 v135, v110, v111
  v_mfma_f32_32x32x16_bf16 v[64:79], v[240:243], v[136:139], v[64:79]
  ds_read_b128 v[96:99], v2 offset:256
  ds_read_b128 v[100:103], v2 offset:288
  ds_read_b128 v[104:107], v2 offset:320
  ds_read_b128 v[108:111], v2 offset:352
  v_rcp_f32 v48, v48
  v_mfma_f32_32x32x16_bf16 v[64:79], v[244:247], v[140:143], v[64:79]
  s_waitcnt lgkmcnt(6)
  ds_read_b128 v[208:211], v1 offset:12288
  ds_read_b128 v[212:215], v1 offset:13312
  v_rcp_f32 v49, v49
  v_rcp_f32 v50, v50
  v_mfma_f32_32x32x16_bf16 v[80:95], v[240:243], v[144:147], v[80:95]
  v_rcp_f32 v51, v51
  v_rcp_f32 v52, v52
  v_rcp_f32_e64 v53, v53
  v_mfma_f32_32x32x16_bf16 v[80:95], v[244:247], v[148:151], v[80:95]
  s_waitcnt lgkmcnt(2)
  v_rcp_f32 v54, v54
  v_rcp_f32 v55, v55
  v_rcp_f32 v56, v56
  v_mfma_f32_32x32x16_bf16 v[96:111], v[240:243], v[152:155], v[96:111]
  v_rcp_f32 v57, v57
  v_rcp_f32 v58, v58
  v_rcp_f32_e64 v59, v59
  v_mfma_f32_32x32x16_bf16 v[96:111], v[244:247], v[156:159], v[96:111]
  s_waitcnt lgkmcnt(0)
  v_rcp_f32 v60, v60
  v_rcp_f32 v61, v61
  v_rcp_f32 v62, v62
  v_rcp_f32_e64 v63, v63
  v_pk_mul_f32 v[16:17], v[16:17], v[48:49]
  v_pk_mul_f32 v[18:19], v[18:19], v[50:51]
  v_pk_mul_f32 v[20:21], v[20:21], v[52:53]
  v_pk_mul_f32 v[22:23], v[22:23], v[54:55]
  v_pk_mul_f32 v[24:25], v[24:25], v[56:57]
  v_pk_mul_f32 v[26:27], v[26:27], v[58:59]
  v_pk_mul_f32 v[28:29], v[28:29], v[60:61]
  v_pk_mul_f32 v[30:31], v[30:31], v[62:63]
  v_pk_fma_f32 v[48:49], v[32:33], v[32:33], s[20:21] neg_lo:[1,0,1] neg_hi:[1,0,1]
  v_pk_fma_f32 v[50:51], v[34:35], v[34:35], s[20:21] neg_lo:[1,0,1] neg_hi:[1,0,1]
  v_pk_fma_f32 v[52:53], v[36:37], v[36:37], s[20:21] neg_lo:[1,0,1] neg_hi:[1,0,1]
  v_pk_fma_f32 v[54:55], v[38:39], v[38:39], s[20:21] neg_lo:[1,0,1] neg_hi:[1,0,1]
  v_pk_fma_f32 v[56:57], v[40:41], v[40:41], s[20:21] neg_lo:[1,0,1] neg_hi:[1,0,1]
  v_pk_fma_f32 v[58:59], v[42:43], v[42:43], s[20:21] neg_lo:[1,0,1] neg_hi:[1,0,1]
  v_pk_fma_f32 v[60:61], v[44:45], v[44:45], s[20:21] neg_lo:[1,0,1] neg_hi:[1,0,1]
  v_pk_fma_f32 v[62:63], v[46:47], v[46:47], s[20:21] neg_lo:[1,0,1] neg_hi:[1,0,1]
  v_pk_mul_f32 v[48:49], v[32:33], v[48:49]
  v_pk_mul_f32 v[50:51], v[34:35], v[50:51]
  v_pk_mul_f32 v[52:53], v[36:37], v[52:53]
  v_pk_mul_f32 v[54:55], v[38:39], v[54:55]
  v_pk_mul_f32 v[56:57], v[40:41], v[56:57]
  v_cvt_pk_bf16_f32 v184, v16, v17
  v_cvt_pk_bf16_f32 v185, v18, v19
  v_cvt_pk_bf16_f32 v186, v20, v21
  v_cvt_pk_bf16_f32 v187, v22, v23
  v_pk_mul_f32 v[58:59], v[42:43], v[58:59]
  v_pk_mul_f32 v[60:61], v[44:45], v[60:61]
  v_pk_mul_f32 v[62:63], v[46:47], v[62:63]
  v_mfma_f32_32x32x16_bf16 v[64:79], v[192:195], v[184:187], v[64:79]
  v_cvt_pk_bf16_f32 v188, v24, v25
  v_cvt_pk_bf16_f32 v189, v26, v27
  v_cvt_pk_bf16_f32 v190, v28, v29
  v_cvt_pk_bf16_f32 v191, v30, v31
  v_exp_f32_e64 v48, v48
  v_mfma_f32_32x32x16_bf16 v[80:95], v[196:199], v[184:187], v[80:95]
  v_exp_f32 v49, v49
  v_exp_f32 v50, v50
  v_exp_f32_e64 v51, v51
  v_mfma_f32_32x32x16_bf16 v[96:111], v[200:203], v[184:187], v[96:111]
  v_exp_f32 v52, v52
  v_exp_f32 v53, v53
  v_exp_f32_e64 v54, v54
  v_mfma_f32_32x32x16_bf16 v[64:79], v[204:207], v[188:191], v[64:79]
  v_exp_f32 v55, v55
  v_exp_f32 v56, v56
  v_exp_f32_e64 v57, v57
  v_mfma_f32_32x32x16_bf16 v[80:95], v[208:211], v[188:191], v[80:95]
  v_exp_f32 v58, v58
  v_exp_f32 v59, v59
  v_exp_f32_e64 v60, v60
  v_mfma_f32_32x32x16_bf16 v[96:111], v[212:215], v[188:191], v[96:111]
  v_exp_f32 v61, v61
  v_exp_f32 v62, v62
  v_exp_f32_e64 v63, v63
  v_pk_fma_f32 v[48:49], v[48:49], s[22:23], s[22:23]
  v_pk_fma_f32 v[50:51], v[50:51], s[22:23], s[22:23]
  v_pk_fma_f32 v[52:53], v[52:53], s[22:23], s[22:23]
  v_pk_fma_f32 v[54:55], v[54:55], s[22:23], s[22:23]
  v_pk_fma_f32 v[56:57], v[56:57], s[22:23], s[22:23]
  v_pk_fma_f32 v[58:59], v[58:59], s[22:23], s[22:23]
  v_pk_fma_f32 v[60:61], v[60:61], s[22:23], s[22:23]
  v_pk_fma_f32 v[62:63], v[62:63], s[22:23], s[22:23]
  v_mfma_f32_32x32x16_bf16 v[16:31], a[24:27], v[160:163], 0
  ds_read_b128 v[192:195], v1 offset:14336
  ds_read_b128 v[196:199], v1 offset:15360
  v_rcp_f32 v48, v48
  v_rcp_f32 v49, v49
  v_mfma_f32_32x32x16_bf16 v[16:31], a[28:31], v[164:167], v[16:31]
  ds_read_b128 v[200:203], v1 offset:16384
  ds_read_b128 v[204:207], v1 offset:17408
  v_rcp_f32 v50, v50
  v_rcp_f32 v51, v51
  v_mfma_f32_32x32x16_bf16 v[16:31], a[32:35], v[168:171], v[16:31]
  ds_read_b128 v[208:211], v1 offset:18432
  ds_read_b128 v[212:215], v1 offset:19456
  v_rcp_f32 v52, v52
  v_rcp_f32 v53, v53
  v_mfma_f32_32x32x16_bf16 v[16:31], a[36:39], v[172:175], v[16:31]
  buffer_store_dwordx4 v[112:115], v10, s[8:11], s28 offen
  v_rcp_f32 v54, v54
  v_rcp_f32 v55, v55
  v_mfma_f32_32x32x16_bf16 v[16:31], a[40:43], v[176:179], v[16:31]
  v_rcp_f32 v56, v56
  v_rcp_f32 v57, v57
  v_rcp_f32_e64 v58, v58
  v_mfma_f32_32x32x16_bf16 v[16:31], a[44:47], v[180:183], v[16:31]
  s_waitcnt lgkmcnt(0)
  v_rcp_f32 v59, v59
  v_rcp_f32 v60, v60
  v_rcp_f32 v61, v61
  v_rcp_f32 v62, v62
  v_rcp_f32 v63, v63
  v_pk_mul_f32 v[32:33], v[32:33], v[48:49]
  v_pk_mul_f32 v[34:35], v[34:35], v[50:51]
  v_pk_mul_f32 v[36:37], v[36:37], v[52:53]
  v_pk_mul_f32 v[38:39], v[38:39], v[54:55]
  v_pk_mul_f32 v[40:41], v[40:41], v[56:57]
  v_pk_mul_f32 v[42:43], v[42:43], v[58:59]
  v_pk_mul_f32 v[44:45], v[44:45], v[60:61]
  v_pk_mul_f32 v[46:47], v[46:47], v[62:63]
  v_pk_fma_f32 v[48:49], v[16:17], v[16:17], s[20:21] neg_lo:[1,0,1] neg_hi:[1,0,1]
  v_pk_fma_f32 v[50:51], v[18:19], v[18:19], s[20:21] neg_lo:[1,0,1] neg_hi:[1,0,1]
  v_pk_fma_f32 v[52:53], v[20:21], v[20:21], s[20:21] neg_lo:[1,0,1] neg_hi:[1,0,1]
  v_pk_fma_f32 v[54:55], v[22:23], v[22:23], s[20:21] neg_lo:[1,0,1] neg_hi:[1,0,1]
  v_pk_fma_f32 v[56:57], v[24:25], v[24:25], s[20:21] neg_lo:[1,0,1] neg_hi:[1,0,1]
  v_pk_fma_f32 v[58:59], v[26:27], v[26:27], s[20:21] neg_lo:[1,0,1] neg_hi:[1,0,1]
  v_pk_fma_f32 v[60:61], v[28:29], v[28:29], s[20:21] neg_lo:[1,0,1] neg_hi:[1,0,1]
  v_pk_fma_f32 v[62:63], v[30:31], v[30:31], s[20:21] neg_lo:[1,0,1] neg_hi:[1,0,1]
  v_pk_mul_f32 v[48:49], v[16:17], v[48:49]
  v_pk_mul_f32 v[50:51], v[18:19], v[50:51]
  v_pk_mul_f32 v[52:53], v[20:21], v[52:53]
  v_pk_mul_f32 v[54:55], v[22:23], v[54:55]
  v_pk_mul_f32 v[56:57], v[24:25], v[56:57]
  v_cvt_pk_bf16_f32 v184, v32, v33
  v_cvt_pk_bf16_f32 v185, v34, v35
  v_cvt_pk_bf16_f32 v186, v36, v37
  v_cvt_pk_bf16_f32 v187, v38, v39
  v_pk_mul_f32 v[58:59], v[26:27], v[58:59]
  v_pk_mul_f32 v[60:61], v[28:29], v[60:61]
  v_pk_mul_f32 v[62:63], v[30:31], v[62:63]
  v_mfma_f32_32x32x16_bf16 v[64:79], v[192:195], v[184:187], v[64:79]
  v_cvt_pk_bf16_f32 v188, v40, v41
  v_cvt_pk_bf16_f32 v189, v42, v43
  v_cvt_pk_bf16_f32 v190, v44, v45
  v_cvt_pk_bf16_f32 v191, v46, v47
  v_exp_f32_e64 v48, v48
  v_mfma_f32_32x32x16_bf16 v[80:95], v[196:199], v[184:187], v[80:95]
  v_exp_f32 v49, v49
  v_exp_f32 v50, v50
  v_exp_f32_e64 v51, v51
  v_mfma_f32_32x32x16_bf16 v[96:111], v[200:203], v[184:187], v[96:111]
  v_exp_f32 v52, v52
  v_exp_f32 v53, v53
  v_exp_f32_e64 v54, v54
  v_mfma_f32_32x32x16_bf16 v[64:79], v[204:207], v[188:191], v[64:79]
  v_exp_f32 v55, v55
  v_exp_f32 v56, v56
  v_exp_f32_e64 v57, v57
  v_mfma_f32_32x32x16_bf16 v[80:95], v[208:211], v[188:191], v[80:95]
  v_exp_f32 v58, v58
  v_exp_f32 v59, v59
  v_exp_f32_e64 v60, v60
  v_mfma_f32_32x32x16_bf16 v[96:111], v[212:215], v[188:191], v[96:111]
  v_exp_f32 v61, v61
  v_exp_f32 v62, v62
  v_exp_f32_e64 v63, v63
  v_pk_fma_f32 v[48:49], v[48:49], s[22:23], s[22:23]
  v_pk_fma_f32 v[50:51], v[50:51], s[22:23], s[22:23]
  v_pk_fma_f32 v[52:53], v[52:53], s[22:23], s[22:23]
  v_pk_fma_f32 v[54:55], v[54:55], s[22:23], s[22:23]
  v_pk_fma_f32 v[56:57], v[56:57], s[22:23], s[22:23]
  v_pk_fma_f32 v[58:59], v[58:59], s[22:23], s[22:23]
  v_pk_fma_f32 v[60:61], v[60:61], s[22:23], s[22:23]
  v_pk_fma_f32 v[62:63], v[62:63], s[22:23], s[22:23]
  v_mfma_f32_32x32x16_bf16 v[32:47], a[48:51], v[160:163], 0
  ds_read_b128 v[192:195], v1 offset:20480
  ds_read_b128 v[196:199], v1 offset:21504
  v_rcp_f32 v48, v48
  v_rcp_f32 v49, v49
  v_mfma_f32_32x32x16_bf16 v[32:47], a[52:55], v[164:167], v[32:47]
  ds_read_b128 v[200:203], v1 offset:22528
  ds_read_b128 v[204:207], v1 offset:23552
  v_rcp_f32 v50, v50
  v_rcp_f32 v51, v51
  v_mfma_f32_32x32x16_bf16 v[32:47], a[56:59], v[168:171], v[32:47]
  ds_read_b128 v[208:211], v1 offset:24576
  ds_read_b128 v[212:215], v1 offset:25600
  v_rcp_f32 v52, v52
  v_rcp_f32 v53, v53
  v_mfma_f32_32x32x16_bf16 v[32:47], a[60:63], v[172:175], v[32:47]
  buffer_store_dwordx4 v[116:119], v10, s[8:11], s28 offen offset:32
  v_rcp_f32 v54, v54
  v_rcp_f32 v55, v55
  v_mfma_f32_32x32x16_bf16 v[32:47], a[64:67], v[176:179], v[32:47]
  v_rcp_f32 v56, v56
  v_rcp_f32 v57, v57
  v_rcp_f32_e64 v58, v58
  v_mfma_f32_32x32x16_bf16 v[32:47], a[68:71], v[180:183], v[32:47]
  s_waitcnt lgkmcnt(0)
  v_rcp_f32 v59, v59
  v_rcp_f32 v60, v60
  v_rcp_f32 v61, v61
  v_rcp_f32 v62, v62
  v_rcp_f32 v63, v63
  v_pk_mul_f32 v[16:17], v[16:17], v[48:49]
  v_pk_mul_f32 v[18:19], v[18:19], v[50:51]
  v_pk_mul_f32 v[20:21], v[20:21], v[52:53]
  v_pk_mul_f32 v[22:23], v[22:23], v[54:55]
  v_pk_mul_f32 v[24:25], v[24:25], v[56:57]
  v_pk_mul_f32 v[26:27], v[26:27], v[58:59]
  v_pk_mul_f32 v[28:29], v[28:29], v[60:61]
  v_pk_mul_f32 v[30:31], v[30:31], v[62:63]
  v_pk_fma_f32 v[48:49], v[32:33], v[32:33], s[20:21] neg_lo:[1,0,1] neg_hi:[1,0,1]
  v_pk_fma_f32 v[50:51], v[34:35], v[34:35], s[20:21] neg_lo:[1,0,1] neg_hi:[1,0,1]
  v_pk_fma_f32 v[52:53], v[36:37], v[36:37], s[20:21] neg_lo:[1,0,1] neg_hi:[1,0,1]
  v_pk_fma_f32 v[54:55], v[38:39], v[38:39], s[20:21] neg_lo:[1,0,1] neg_hi:[1,0,1]
  v_pk_fma_f32 v[56:57], v[40:41], v[40:41], s[20:21] neg_lo:[1,0,1] neg_hi:[1,0,1]
  v_pk_fma_f32 v[58:59], v[42:43], v[42:43], s[20:21] neg_lo:[1,0,1] neg_hi:[1,0,1]
  v_pk_fma_f32 v[60:61], v[44:45], v[44:45], s[20:21] neg_lo:[1,0,1] neg_hi:[1,0,1]
  v_pk_fma_f32 v[62:63], v[46:47], v[46:47], s[20:21] neg_lo:[1,0,1] neg_hi:[1,0,1]
  v_pk_mul_f32 v[48:49], v[32:33], v[48:49]
  v_pk_mul_f32 v[50:51], v[34:35], v[50:51]
  v_pk_mul_f32 v[52:53], v[36:37], v[52:53]
  v_pk_mul_f32 v[54:55], v[38:39], v[54:55]
  v_pk_mul_f32 v[56:57], v[40:41], v[56:57]
  v_cvt_pk_bf16_f32 v184, v16, v17
  v_cvt_pk_bf16_f32 v185, v18, v19
  v_cvt_pk_bf16_f32 v186, v20, v21
  v_cvt_pk_bf16_f32 v187, v22, v23
  v_pk_mul_f32 v[58:59], v[42:43], v[58:59]
  v_pk_mul_f32 v[60:61], v[44:45], v[60:61]
  v_pk_mul_f32 v[62:63], v[46:47], v[62:63]
  v_mfma_f32_32x32x16_bf16 v[64:79], v[192:195], v[184:187], v[64:79]
  v_cvt_pk_bf16_f32 v188, v24, v25
  v_cvt_pk_bf16_f32 v189, v26, v27
  v_cvt_pk_bf16_f32 v190, v28, v29
  v_cvt_pk_bf16_f32 v191, v30, v31
  v_exp_f32_e64 v48, v48
  v_mfma_f32_32x32x16_bf16 v[80:95], v[196:199], v[184:187], v[80:95]
  v_exp_f32 v49, v49
  v_exp_f32 v50, v50
  v_exp_f32_e64 v51, v51
  v_mfma_f32_32x32x16_bf16 v[96:111], v[200:203], v[184:187], v[96:111]
  v_exp_f32 v52, v52
  v_exp_f32 v53, v53
  v_exp_f32_e64 v54, v54
  v_mfma_f32_32x32x16_bf16 v[64:79], v[204:207], v[188:191], v[64:79]
  v_exp_f32 v55, v55
  v_exp_f32 v56, v56
  v_exp_f32_e64 v57, v57
  v_mfma_f32_32x32x16_bf16 v[80:95], v[208:211], v[188:191], v[80:95]
  v_exp_f32 v58, v58
  v_exp_f32 v59, v59
  v_exp_f32_e64 v60, v60
  v_mfma_f32_32x32x16_bf16 v[96:111], v[212:215], v[188:191], v[96:111]
  v_exp_f32 v61, v61
  v_exp_f32 v62, v62
  v_exp_f32_e64 v63, v63
  v_pk_fma_f32 v[48:49], v[48:49], s[22:23], s[22:23]
  v_pk_fma_f32 v[50:51], v[50:51], s[22:23], s[22:23]
  v_pk_fma_f32 v[52:53], v[52:53], s[22:23], s[22:23]
  v_pk_fma_f32 v[54:55], v[54:55], s[22:23], s[22:23]
  v_pk_fma_f32 v[56:57], v[56:57], s[22:23], s[22:23]
  v_pk_fma_f32 v[58:59], v[58:59], s[22:23], s[22:23]
  v_pk_fma_f32 v[60:61], v[60:61], s[22:23], s[22:23]
  v_pk_fma_f32 v[62:63], v[62:63], s[22:23], s[22:23]
  v_mfma_f32_32x32x16_bf16 v[16:31], a[72:75], v[160:163], 0
  ds_read_b128 v[192:195], v1 offset:26624
  ds_read_b128 v[196:199], v1 offset:27648
  v_rcp_f32 v48, v48
  v_rcp_f32 v49, v49
  v_mfma_f32_32x32x16_bf16 v[16:31], a[76:79], v[164:167], v[16:31]
  ds_read_b128 v[200:203], v1 offset:28672
  ds_read_b128 v[204:207], v1 offset:29696
  v_rcp_f32 v50, v50
  v_rcp_f32 v51, v51
  v_mfma_f32_32x32x16_bf16 v[16:31], a[80:83], v[168:171], v[16:31]
  ds_read_b128 v[208:211], v1 offset:30720
  ds_read_b128 v[212:215], v1 offset:31744
  v_rcp_f32 v52, v52
  v_rcp_f32 v53, v53
  v_mfma_f32_32x32x16_bf16 v[16:31], a[84:87], v[172:175], v[16:31]
  v_rcp_f32 v54, v54
  v_rcp_f32 v55, v55
  v_rcp_f32_e64 v56, v56
  v_mfma_f32_32x32x16_bf16 v[16:31], a[88:91], v[176:179], v[16:31]
  v_rcp_f32 v57, v57
  v_rcp_f32 v58, v58
  v_rcp_f32_e64 v59, v59
  v_mfma_f32_32x32x16_bf16 v[16:31], a[92:95], v[180:183], v[16:31]
  s_waitcnt lgkmcnt(0)
  v_rcp_f32 v60, v60
  v_rcp_f32 v61, v61
  v_rcp_f32 v62, v62
  v_rcp_f32_e64 v63, v63
  v_pk_mul_f32 v[32:33], v[32:33], v[48:49]
  v_pk_mul_f32 v[34:35], v[34:35], v[50:51]
  v_pk_mul_f32 v[36:37], v[36:37], v[52:53]
  v_pk_mul_f32 v[38:39], v[38:39], v[54:55]
  v_pk_mul_f32 v[40:41], v[40:41], v[56:57]
  v_pk_mul_f32 v[42:43], v[42:43], v[58:59]
  v_pk_mul_f32 v[44:45], v[44:45], v[60:61]
  v_pk_mul_f32 v[46:47], v[46:47], v[62:63]
  v_pk_fma_f32 v[48:49], v[16:17], v[16:17], s[20:21] neg_lo:[1,0,1] neg_hi:[1,0,1]
  v_pk_fma_f32 v[50:51], v[18:19], v[18:19], s[20:21] neg_lo:[1,0,1] neg_hi:[1,0,1]
  v_pk_fma_f32 v[52:53], v[20:21], v[20:21], s[20:21] neg_lo:[1,0,1] neg_hi:[1,0,1]
  v_pk_fma_f32 v[54:55], v[22:23], v[22:23], s[20:21] neg_lo:[1,0,1] neg_hi:[1,0,1]
  v_pk_fma_f32 v[56:57], v[24:25], v[24:25], s[20:21] neg_lo:[1,0,1] neg_hi:[1,0,1]
  v_pk_fma_f32 v[58:59], v[26:27], v[26:27], s[20:21] neg_lo:[1,0,1] neg_hi:[1,0,1]
  v_pk_fma_f32 v[60:61], v[28:29], v[28:29], s[20:21] neg_lo:[1,0,1] neg_hi:[1,0,1]
  v_pk_fma_f32 v[62:63], v[30:31], v[30:31], s[20:21] neg_lo:[1,0,1] neg_hi:[1,0,1]
  v_pk_mul_f32 v[48:49], v[16:17], v[48:49]
  v_pk_mul_f32 v[50:51], v[18:19], v[50:51]
  v_pk_mul_f32 v[52:53], v[20:21], v[52:53]
  v_pk_mul_f32 v[54:55], v[22:23], v[54:55]
  v_pk_mul_f32 v[56:57], v[24:25], v[56:57]
  v_cvt_pk_bf16_f32 v184, v32, v33
  v_cvt_pk_bf16_f32 v185, v34, v35
  v_cvt_pk_bf16_f32 v186, v36, v37
  v_cvt_pk_bf16_f32 v187, v38, v39
  v_pk_mul_f32 v[58:59], v[26:27], v[58:59]
  v_pk_mul_f32 v[60:61], v[28:29], v[60:61]
  v_pk_mul_f32 v[62:63], v[30:31], v[62:63]
  v_mfma_f32_32x32x16_bf16 v[64:79], v[192:195], v[184:187], v[64:79]
  v_cvt_pk_bf16_f32 v188, v40, v41
  v_cvt_pk_bf16_f32 v189, v42, v43
  v_cvt_pk_bf16_f32 v190, v44, v45
  v_cvt_pk_bf16_f32 v191, v46, v47
  v_exp_f32_e64 v48, v48
  v_mfma_f32_32x32x16_bf16 v[80:95], v[196:199], v[184:187], v[80:95]
  v_exp_f32 v49, v49
  v_exp_f32 v50, v50
  v_exp_f32_e64 v51, v51
  v_mfma_f32_32x32x16_bf16 v[96:111], v[200:203], v[184:187], v[96:111]
  v_exp_f32 v52, v52
  v_exp_f32 v53, v53
  v_exp_f32_e64 v54, v54
  v_mfma_f32_32x32x16_bf16 v[64:79], v[204:207], v[188:191], v[64:79]
  v_exp_f32 v55, v55
  v_exp_f32 v56, v56
  v_exp_f32_e64 v57, v57
  v_mfma_f32_32x32x16_bf16 v[80:95], v[208:211], v[188:191], v[80:95]
  v_exp_f32 v58, v58
  v_exp_f32 v59, v59
  v_exp_f32_e64 v60, v60
  v_mfma_f32_32x32x16_bf16 v[96:111], v[212:215], v[188:191], v[96:111]
  v_exp_f32 v61, v61
  v_exp_f32 v62, v62
  v_exp_f32_e64 v63, v63
  v_pk_fma_f32 v[48:49], v[48:49], s[22:23], s[22:23]
  v_pk_fma_f32 v[50:51], v[50:51], s[22:23], s[22:23]
  v_pk_fma_f32 v[52:53], v[52:53], s[22:23], s[22:23]
  v_pk_fma_f32 v[54:55], v[54:55], s[22:23], s[22:23]
  v_pk_fma_f32 v[56:57], v[56:57], s[22:23], s[22:23]
  v_pk_fma_f32 v[58:59], v[58:59], s[22:23], s[22:23]
  v_pk_fma_f32 v[60:61], v[60:61], s[22:23], s[22:23]
  v_pk_fma_f32 v[62:63], v[62:63], s[22:23], s[22:23]
  v_mfma_f32_32x32x16_bf16 v[32:47], a[96:99], v[160:163], 0
  ds_read_b128 v[192:195], v0 offset:24576
  ds_read_b128 v[196:199], v0 offset:25600
  v_rcp_f32 v48, v48
  v_rcp_f32 v49, v49
  v_mfma_f32_32x32x16_bf16 v[32:47], a[100:103], v[164:167], v[32:47]
  ds_read_b128 v[200:203], v0 offset:26624
  ds_read_b128 v[204:207], v0 offset:27648
  v_rcp_f32 v50, v50
  v_rcp_f32 v51, v51
  v_mfma_f32_32x32x16_bf16 v[32:47], a[104:107], v[168:171], v[32:47]
  ds_read_b128 v[208:211], v0 offset:28672
  ds_read_b128 v[212:215], v0 offset:29696
  v_rcp_f32 v52, v52
  v_rcp_f32 v53, v53
  v_mfma_f32_32x32x16_bf16 v[32:47], a[108:111], v[172:175], v[32:47]
  buffer_store_dwordx4 v[120:123], v10, s[8:11], s28 offen offset:64
  v_rcp_f32 v54, v54
  v_rcp_f32 v55, v55
  v_mfma_f32_32x32x16_bf16 v[32:47], a[112:115], v[176:179], v[32:47]
  v_rcp_f32 v56, v56
  v_rcp_f32 v57, v57
  v_rcp_f32_e64 v58, v58
  v_mfma_f32_32x32x16_bf16 v[32:47], a[116:119], v[180:183], v[32:47]
  s_waitcnt lgkmcnt(0)
  v_rcp_f32 v59, v59
  v_rcp_f32 v60, v60
  v_rcp_f32 v61, v61
  v_rcp_f32 v62, v62
  v_rcp_f32 v63, v63
  v_pk_mul_f32 v[16:17], v[16:17], v[48:49]
  v_pk_mul_f32 v[18:19], v[18:19], v[50:51]
  v_pk_mul_f32 v[20:21], v[20:21], v[52:53]
  v_pk_mul_f32 v[22:23], v[22:23], v[54:55]
  v_pk_mul_f32 v[24:25], v[24:25], v[56:57]
  v_pk_mul_f32 v[26:27], v[26:27], v[58:59]
  v_pk_mul_f32 v[28:29], v[28:29], v[60:61]
  v_pk_mul_f32 v[30:31], v[30:31], v[62:63]
  v_pk_fma_f32 v[48:49], v[32:33], v[32:33], s[20:21] neg_lo:[1,0,1] neg_hi:[1,0,1]
  v_pk_fma_f32 v[50:51], v[34:35], v[34:35], s[20:21] neg_lo:[1,0,1] neg_hi:[1,0,1]
  v_pk_fma_f32 v[52:53], v[36:37], v[36:37], s[20:21] neg_lo:[1,0,1] neg_hi:[1,0,1]
  v_pk_fma_f32 v[54:55], v[38:39], v[38:39], s[20:21] neg_lo:[1,0,1] neg_hi:[1,0,1]
  v_pk_fma_f32 v[56:57], v[40:41], v[40:41], s[20:21] neg_lo:[1,0,1] neg_hi:[1,0,1]
  v_pk_fma_f32 v[58:59], v[42:43], v[42:43], s[20:21] neg_lo:[1,0,1] neg_hi:[1,0,1]
  v_pk_fma_f32 v[60:61], v[44:45], v[44:45], s[20:21] neg_lo:[1,0,1] neg_hi:[1,0,1]
  v_pk_fma_f32 v[62:63], v[46:47], v[46:47], s[20:21] neg_lo:[1,0,1] neg_hi:[1,0,1]
  v_pk_mul_f32 v[48:49], v[32:33], v[48:49]
  v_pk_mul_f32 v[50:51], v[34:35], v[50:51]
  v_pk_mul_f32 v[52:53], v[36:37], v[52:53]
  v_pk_mul_f32 v[54:55], v[38:39], v[54:55]
  v_pk_mul_f32 v[56:57], v[40:41], v[56:57]
  v_cvt_pk_bf16_f32 v184, v16, v17
  v_cvt_pk_bf16_f32 v185, v18, v19
  v_cvt_pk_bf16_f32 v186, v20, v21
  v_cvt_pk_bf16_f32 v187, v22, v23
  v_pk_mul_f32 v[58:59], v[42:43], v[58:59]
  v_pk_mul_f32 v[60:61], v[44:45], v[60:61]
  v_pk_mul_f32 v[62:63], v[46:47], v[62:63]
  v_mfma_f32_32x32x16_bf16 v[64:79], v[192:195], v[184:187], v[64:79]
  v_cvt_pk_bf16_f32 v188, v24, v25
  v_cvt_pk_bf16_f32 v189, v26, v27
  v_cvt_pk_bf16_f32 v190, v28, v29
  v_cvt_pk_bf16_f32 v191, v30, v31
  v_exp_f32_e64 v48, v48
  v_mfma_f32_32x32x16_bf16 v[80:95], v[196:199], v[184:187], v[80:95]
  v_exp_f32 v49, v49
  v_exp_f32 v50, v50
  v_exp_f32_e64 v51, v51
  v_mfma_f32_32x32x16_bf16 v[96:111], v[200:203], v[184:187], v[96:111]
  v_exp_f32 v52, v52
  v_exp_f32 v53, v53
  v_exp_f32_e64 v54, v54
  v_mfma_f32_32x32x16_bf16 v[64:79], v[204:207], v[188:191], v[64:79]
  v_exp_f32 v55, v55
  v_exp_f32 v56, v56
  v_exp_f32_e64 v57, v57
  v_mfma_f32_32x32x16_bf16 v[80:95], v[208:211], v[188:191], v[80:95]
  v_exp_f32 v58, v58
  v_exp_f32 v59, v59
  v_exp_f32_e64 v60, v60
  v_mfma_f32_32x32x16_bf16 v[96:111], v[212:215], v[188:191], v[96:111]
  v_exp_f32 v61, v61
  v_exp_f32 v62, v62
  v_exp_f32_e64 v63, v63
  v_pk_fma_f32 v[48:49], v[48:49], s[22:23], s[22:23]
  v_pk_fma_f32 v[50:51], v[50:51], s[22:23], s[22:23]
  v_pk_fma_f32 v[52:53], v[52:53], s[22:23], s[22:23]
  v_pk_fma_f32 v[54:55], v[54:55], s[22:23], s[22:23]
  v_pk_fma_f32 v[56:57], v[56:57], s[22:23], s[22:23]
  v_pk_fma_f32 v[58:59], v[58:59], s[22:23], s[22:23]
  v_pk_fma_f32 v[60:61], v[60:61], s[22:23], s[22:23]
  v_pk_fma_f32 v[62:63], v[62:63], s[22:23], s[22:23]
  v_mfma_f32_32x32x16_bf16 v[16:31], a[120:123], v[160:163], 0
  ds_read_b128 v[192:195], v0 offset:30720
  ds_read_b128 v[196:199], v0 offset:31744
  v_rcp_f32 v48, v48
  v_rcp_f32 v49, v49
  v_mfma_f32_32x32x16_bf16 v[16:31], a[124:127], v[164:167], v[16:31]
  ds_read_b128 v[200:203], v0 offset:32768
  ds_read_b128 v[204:207], v0 offset:33792
  v_rcp_f32 v50, v50
  v_rcp_f32 v51, v51
  v_mfma_f32_32x32x16_bf16 v[16:31], a[128:131], v[168:171], v[16:31]
  ds_read_b128 v[208:211], v0 offset:34816
  ds_read_b128 v[212:215], v0 offset:35840
  v_rcp_f32 v52, v52
  v_rcp_f32 v53, v53
  v_mfma_f32_32x32x16_bf16 v[16:31], a[132:135], v[172:175], v[16:31]
  buffer_store_dwordx4 v[124:127], v10, s[8:11], s28 offen offset:96
  v_rcp_f32 v54, v54
  v_rcp_f32 v55, v55
  v_mfma_f32_32x32x16_bf16 v[16:31], a[136:139], v[176:179], v[16:31]
  v_rcp_f32 v56, v56
  v_rcp_f32 v57, v57
  v_rcp_f32_e64 v58, v58
  v_mfma_f32_32x32x16_bf16 v[16:31], a[140:143], v[180:183], v[16:31]
  s_waitcnt lgkmcnt(0)
  v_rcp_f32 v59, v59
  v_rcp_f32 v60, v60
  v_rcp_f32 v61, v61
  v_rcp_f32 v62, v62
  v_rcp_f32 v63, v63
  v_pk_mul_f32 v[32:33], v[32:33], v[48:49]
  v_pk_mul_f32 v[34:35], v[34:35], v[50:51]
  v_pk_mul_f32 v[36:37], v[36:37], v[52:53]
  v_pk_mul_f32 v[38:39], v[38:39], v[54:55]
  v_pk_mul_f32 v[40:41], v[40:41], v[56:57]
  v_pk_mul_f32 v[42:43], v[42:43], v[58:59]
  v_pk_mul_f32 v[44:45], v[44:45], v[60:61]
  v_pk_mul_f32 v[46:47], v[46:47], v[62:63]
  v_pk_fma_f32 v[48:49], v[16:17], v[16:17], s[20:21] neg_lo:[1,0,1] neg_hi:[1,0,1]
  v_pk_fma_f32 v[50:51], v[18:19], v[18:19], s[20:21] neg_lo:[1,0,1] neg_hi:[1,0,1]
  v_pk_fma_f32 v[52:53], v[20:21], v[20:21], s[20:21] neg_lo:[1,0,1] neg_hi:[1,0,1]
  v_pk_fma_f32 v[54:55], v[22:23], v[22:23], s[20:21] neg_lo:[1,0,1] neg_hi:[1,0,1]
  v_pk_fma_f32 v[56:57], v[24:25], v[24:25], s[20:21] neg_lo:[1,0,1] neg_hi:[1,0,1]
  v_pk_fma_f32 v[58:59], v[26:27], v[26:27], s[20:21] neg_lo:[1,0,1] neg_hi:[1,0,1]
  v_pk_fma_f32 v[60:61], v[28:29], v[28:29], s[20:21] neg_lo:[1,0,1] neg_hi:[1,0,1]
  v_pk_fma_f32 v[62:63], v[30:31], v[30:31], s[20:21] neg_lo:[1,0,1] neg_hi:[1,0,1]
  v_pk_mul_f32 v[48:49], v[16:17], v[48:49]
  v_pk_mul_f32 v[50:51], v[18:19], v[50:51]
  v_pk_mul_f32 v[52:53], v[20:21], v[52:53]
  v_pk_mul_f32 v[54:55], v[22:23], v[54:55]
  v_pk_mul_f32 v[56:57], v[24:25], v[56:57]
  v_cvt_pk_bf16_f32 v184, v32, v33
  v_cvt_pk_bf16_f32 v185, v34, v35
  v_cvt_pk_bf16_f32 v186, v36, v37
  v_cvt_pk_bf16_f32 v187, v38, v39
  v_pk_mul_f32 v[58:59], v[26:27], v[58:59]
  v_pk_mul_f32 v[60:61], v[28:29], v[60:61]
  v_pk_mul_f32 v[62:63], v[30:31], v[62:63]
  v_mfma_f32_32x32x16_bf16 v[64:79], v[192:195], v[184:187], v[64:79]
  v_cvt_pk_bf16_f32 v188, v40, v41
  v_cvt_pk_bf16_f32 v189, v42, v43
  v_cvt_pk_bf16_f32 v190, v44, v45
  v_cvt_pk_bf16_f32 v191, v46, v47
  v_exp_f32_e64 v48, v48
  v_mfma_f32_32x32x16_bf16 v[80:95], v[196:199], v[184:187], v[80:95]
  v_exp_f32 v49, v49
  v_exp_f32 v50, v50
  v_exp_f32_e64 v51, v51
  v_mfma_f32_32x32x16_bf16 v[96:111], v[200:203], v[184:187], v[96:111]
  v_exp_f32 v52, v52
  v_exp_f32 v53, v53
  v_exp_f32_e64 v54, v54
  v_mfma_f32_32x32x16_bf16 v[64:79], v[204:207], v[188:191], v[64:79]
  v_exp_f32 v55, v55
  v_exp_f32 v56, v56
  v_exp_f32_e64 v57, v57
  v_mfma_f32_32x32x16_bf16 v[80:95], v[208:211], v[188:191], v[80:95]
  v_exp_f32 v58, v58
  v_exp_f32 v59, v59
  v_exp_f32_e64 v60, v60
  v_mfma_f32_32x32x16_bf16 v[96:111], v[212:215], v[188:191], v[96:111]
  v_exp_f32 v61, v61
  v_exp_f32 v62, v62
  v_exp_f32_e64 v63, v63
  v_pk_fma_f32 v[48:49], v[48:49], s[22:23], s[22:23]
  v_pk_fma_f32 v[50:51], v[50:51], s[22:23], s[22:23]
  v_pk_fma_f32 v[52:53], v[52:53], s[22:23], s[22:23]
  v_pk_fma_f32 v[54:55], v[54:55], s[22:23], s[22:23]
  v_pk_fma_f32 v[56:57], v[56:57], s[22:23], s[22:23]
  v_pk_fma_f32 v[58:59], v[58:59], s[22:23], s[22:23]
  v_pk_fma_f32 v[60:61], v[60:61], s[22:23], s[22:23]
  v_pk_fma_f32 v[62:63], v[62:63], s[22:23], s[22:23]
  v_mfma_f32_32x32x16_bf16 v[32:47], a[144:147], v[160:163], 0
  ds_read_b128 v[192:195], v0 offset:36864
  ds_read_b128 v[196:199], v0 offset:37888
  v_rcp_f32 v48, v48
  v_rcp_f32 v49, v49
  v_mfma_f32_32x32x16_bf16 v[32:47], a[148:151], v[164:167], v[32:47]
  ds_read_b128 v[200:203], v0 offset:38912
  ds_read_b128 v[204:207], v0 offset:39936
  v_rcp_f32 v50, v50
  v_rcp_f32 v51, v51
  v_mfma_f32_32x32x16_bf16 v[32:47], a[152:155], v[168:171], v[32:47]
  ds_read_b128 v[208:211], v0 offset:40960
  ds_read_b128 v[212:215], v0 offset:41984
  v_rcp_f32 v52, v52
  v_rcp_f32 v53, v53
  v_mfma_f32_32x32x16_bf16 v[32:47], a[156:159], v[172:175], v[32:47]
  v_rcp_f32 v54, v54
  v_rcp_f32 v55, v55
  v_rcp_f32_e64 v56, v56
  v_mfma_f32_32x32x16_bf16 v[32:47], a[160:163], v[176:179], v[32:47]
  v_rcp_f32 v57, v57
  v_rcp_f32 v58, v58
  v_rcp_f32_e64 v59, v59
  v_mfma_f32_32x32x16_bf16 v[32:47], a[164:167], v[180:183], v[32:47]
  s_waitcnt lgkmcnt(0)
  v_rcp_f32 v60, v60
  v_rcp_f32 v61, v61
  v_rcp_f32 v62, v62
  v_rcp_f32_e64 v63, v63
  v_pk_mul_f32 v[16:17], v[16:17], v[48:49]
  v_pk_mul_f32 v[18:19], v[18:19], v[50:51]
  v_pk_mul_f32 v[20:21], v[20:21], v[52:53]
  v_pk_mul_f32 v[22:23], v[22:23], v[54:55]
  v_pk_mul_f32 v[24:25], v[24:25], v[56:57]
  v_pk_mul_f32 v[26:27], v[26:27], v[58:59]
  v_pk_mul_f32 v[28:29], v[28:29], v[60:61]
  v_pk_mul_f32 v[30:31], v[30:31], v[62:63]
  v_pk_fma_f32 v[48:49], v[32:33], v[32:33], s[20:21] neg_lo:[1,0,1] neg_hi:[1,0,1]
  v_pk_fma_f32 v[50:51], v[34:35], v[34:35], s[20:21] neg_lo:[1,0,1] neg_hi:[1,0,1]
  v_pk_fma_f32 v[52:53], v[36:37], v[36:37], s[20:21] neg_lo:[1,0,1] neg_hi:[1,0,1]
  v_pk_fma_f32 v[54:55], v[38:39], v[38:39], s[20:21] neg_lo:[1,0,1] neg_hi:[1,0,1]
  v_pk_fma_f32 v[56:57], v[40:41], v[40:41], s[20:21] neg_lo:[1,0,1] neg_hi:[1,0,1]
  v_pk_fma_f32 v[58:59], v[42:43], v[42:43], s[20:21] neg_lo:[1,0,1] neg_hi:[1,0,1]
  v_pk_fma_f32 v[60:61], v[44:45], v[44:45], s[20:21] neg_lo:[1,0,1] neg_hi:[1,0,1]
  v_pk_fma_f32 v[62:63], v[46:47], v[46:47], s[20:21] neg_lo:[1,0,1] neg_hi:[1,0,1]
  v_pk_mul_f32 v[48:49], v[32:33], v[48:49]
  v_pk_mul_f32 v[50:51], v[34:35], v[50:51]
  v_pk_mul_f32 v[52:53], v[36:37], v[52:53]
  v_pk_mul_f32 v[54:55], v[38:39], v[54:55]
  v_pk_mul_f32 v[56:57], v[40:41], v[56:57]
  v_cvt_pk_bf16_f32 v184, v16, v17
  v_cvt_pk_bf16_f32 v185, v18, v19
  v_cvt_pk_bf16_f32 v186, v20, v21
  v_cvt_pk_bf16_f32 v187, v22, v23
  v_pk_mul_f32 v[58:59], v[42:43], v[58:59]
  v_pk_mul_f32 v[60:61], v[44:45], v[60:61]
  v_pk_mul_f32 v[62:63], v[46:47], v[62:63]
  v_mfma_f32_32x32x16_bf16 v[64:79], v[192:195], v[184:187], v[64:79]
  v_cvt_pk_bf16_f32 v188, v24, v25
  v_cvt_pk_bf16_f32 v189, v26, v27
  v_cvt_pk_bf16_f32 v190, v28, v29
  v_cvt_pk_bf16_f32 v191, v30, v31
  v_exp_f32_e64 v48, v48
  v_mfma_f32_32x32x16_bf16 v[80:95], v[196:199], v[184:187], v[80:95]
  v_exp_f32 v49, v49
  v_exp_f32 v50, v50
  v_exp_f32_e64 v51, v51
  v_mfma_f32_32x32x16_bf16 v[96:111], v[200:203], v[184:187], v[96:111]
  v_exp_f32 v52, v52
  v_exp_f32 v53, v53
  v_exp_f32_e64 v54, v54
  v_mfma_f32_32x32x16_bf16 v[64:79], v[204:207], v[188:191], v[64:79]
  v_exp_f32 v55, v55
  v_exp_f32 v56, v56
  v_exp_f32_e64 v57, v57
  v_mfma_f32_32x32x16_bf16 v[80:95], v[208:211], v[188:191], v[80:95]
  v_exp_f32 v58, v58
  v_exp_f32 v59, v59
  v_exp_f32_e64 v60, v60
  v_mfma_f32_32x32x16_bf16 v[96:111], v[212:215], v[188:191], v[96:111]
  v_exp_f32 v61, v61
  v_exp_f32 v62, v62
  v_exp_f32_e64 v63, v63
  v_pk_fma_f32 v[48:49], v[48:49], s[22:23], s[22:23]
  v_pk_fma_f32 v[50:51], v[50:51], s[22:23], s[22:23]
  v_pk_fma_f32 v[52:53], v[52:53], s[22:23], s[22:23]
  v_pk_fma_f32 v[54:55], v[54:55], s[22:23], s[22:23]
  v_pk_fma_f32 v[56:57], v[56:57], s[22:23], s[22:23]
  v_pk_fma_f32 v[58:59], v[58:59], s[22:23], s[22:23]
  v_pk_fma_f32 v[60:61], v[60:61], s[22:23], s[22:23]
  v_pk_fma_f32 v[62:63], v[62:63], s[22:23], s[22:23]
  v_mfma_f32_32x32x16_bf16 v[16:31], a[168:171], v[160:163], 0
  ds_read_b128 v[192:195], v0 offset:43008
  ds_read_b128 v[196:199], v0 offset:44032
  v_rcp_f32 v48, v48
  v_rcp_f32 v49, v49
  v_mfma_f32_32x32x16_bf16 v[16:31], a[172:175], v[164:167], v[16:31]
  ds_read_b128 v[200:203], v0 offset:45056
  ds_read_b128 v[204:207], v0 offset:46080
  v_rcp_f32 v50, v50
  v_rcp_f32 v51, v51
  v_mfma_f32_32x32x16_bf16 v[16:31], a[176:179], v[168:171], v[16:31]
  ds_read_b128 v[208:211], v0 offset:47104
  ds_read_b128 v[212:215], v0 offset:48128
  v_rcp_f32 v52, v52
  v_rcp_f32 v53, v53
  v_mfma_f32_32x32x16_bf16 v[16:31], a[180:183], v[172:175], v[16:31]
  buffer_store_dwordx4 v[128:131], v10, s[8:11], s28 offen offset:128
  v_rcp_f32 v54, v54
  v_rcp_f32 v55, v55
  v_mfma_f32_32x32x16_bf16 v[16:31], a[184:187], v[176:179], v[16:31]
  v_rcp_f32 v56, v56
  v_rcp_f32 v57, v57
  v_rcp_f32_e64 v58, v58
  v_mfma_f32_32x32x16_bf16 v[16:31], a[188:191], v[180:183], v[16:31]
  s_waitcnt lgkmcnt(0)
  v_rcp_f32 v59, v59
  v_rcp_f32 v60, v60
  v_rcp_f32 v61, v61
  v_rcp_f32 v62, v62
  v_rcp_f32 v63, v63
  v_pk_mul_f32 v[32:33], v[32:33], v[48:49]
  v_pk_mul_f32 v[34:35], v[34:35], v[50:51]
  v_pk_mul_f32 v[36:37], v[36:37], v[52:53]
  v_pk_mul_f32 v[38:39], v[38:39], v[54:55]
  v_pk_mul_f32 v[40:41], v[40:41], v[56:57]
  v_pk_mul_f32 v[42:43], v[42:43], v[58:59]
  v_pk_mul_f32 v[44:45], v[44:45], v[60:61]
  v_pk_mul_f32 v[46:47], v[46:47], v[62:63]
  v_pk_fma_f32 v[48:49], v[16:17], v[16:17], s[20:21] neg_lo:[1,0,1] neg_hi:[1,0,1]
  v_pk_fma_f32 v[50:51], v[18:19], v[18:19], s[20:21] neg_lo:[1,0,1] neg_hi:[1,0,1]
  v_pk_fma_f32 v[52:53], v[20:21], v[20:21], s[20:21] neg_lo:[1,0,1] neg_hi:[1,0,1]
  v_pk_fma_f32 v[54:55], v[22:23], v[22:23], s[20:21] neg_lo:[1,0,1] neg_hi:[1,0,1]
  v_pk_fma_f32 v[56:57], v[24:25], v[24:25], s[20:21] neg_lo:[1,0,1] neg_hi:[1,0,1]
  v_pk_fma_f32 v[58:59], v[26:27], v[26:27], s[20:21] neg_lo:[1,0,1] neg_hi:[1,0,1]
  v_pk_fma_f32 v[60:61], v[28:29], v[28:29], s[20:21] neg_lo:[1,0,1] neg_hi:[1,0,1]
  v_pk_fma_f32 v[62:63], v[30:31], v[30:31], s[20:21] neg_lo:[1,0,1] neg_hi:[1,0,1]
  v_pk_mul_f32 v[48:49], v[16:17], v[48:49]
  v_pk_mul_f32 v[50:51], v[18:19], v[50:51]
  v_pk_mul_f32 v[52:53], v[20:21], v[52:53]
  v_pk_mul_f32 v[54:55], v[22:23], v[54:55]
  v_pk_mul_f32 v[56:57], v[24:25], v[56:57]
  v_cvt_pk_bf16_f32 v184, v32, v33
  v_cvt_pk_bf16_f32 v185, v34, v35
  v_cvt_pk_bf16_f32 v186, v36, v37
  v_cvt_pk_bf16_f32 v187, v38, v39
  v_pk_mul_f32 v[58:59], v[26:27], v[58:59]
  v_pk_mul_f32 v[60:61], v[28:29], v[60:61]
  v_pk_mul_f32 v[62:63], v[30:31], v[62:63]
  v_mfma_f32_32x32x16_bf16 v[64:79], v[192:195], v[184:187], v[64:79]
  v_cvt_pk_bf16_f32 v188, v40, v41
  v_cvt_pk_bf16_f32 v189, v42, v43
  v_cvt_pk_bf16_f32 v190, v44, v45
  v_cvt_pk_bf16_f32 v191, v46, v47
  v_exp_f32_e64 v48, v48
  v_mfma_f32_32x32x16_bf16 v[80:95], v[196:199], v[184:187], v[80:95]
  v_exp_f32 v49, v49
  v_exp_f32 v50, v50
  v_exp_f32_e64 v51, v51
  v_mfma_f32_32x32x16_bf16 v[96:111], v[200:203], v[184:187], v[96:111]
  v_exp_f32 v52, v52
  v_exp_f32 v53, v53
  v_exp_f32_e64 v54, v54
  v_mfma_f32_32x32x16_bf16 v[64:79], v[204:207], v[188:191], v[64:79]
  v_exp_f32 v55, v55
  v_exp_f32 v56, v56
  v_exp_f32_e64 v57, v57
  v_mfma_f32_32x32x16_bf16 v[80:95], v[208:211], v[188:191], v[80:95]
  v_exp_f32 v58, v58
  v_exp_f32 v59, v59
  v_exp_f32_e64 v60, v60
  v_mfma_f32_32x32x16_bf16 v[96:111], v[212:215], v[188:191], v[96:111]
  v_exp_f32 v61, v61
  v_exp_f32 v62, v62
  v_exp_f32_e64 v63, v63
  v_pk_fma_f32 v[48:49], v[48:49], s[22:23], s[22:23]
  v_pk_fma_f32 v[50:51], v[50:51], s[22:23], s[22:23]
  v_pk_fma_f32 v[52:53], v[52:53], s[22:23], s[22:23]
  v_pk_fma_f32 v[54:55], v[54:55], s[22:23], s[22:23]
  v_pk_fma_f32 v[56:57], v[56:57], s[22:23], s[22:23]
  v_pk_fma_f32 v[58:59], v[58:59], s[22:23], s[22:23]
  v_pk_fma_f32 v[60:61], v[60:61], s[22:23], s[22:23]
  v_pk_fma_f32 v[62:63], v[62:63], s[22:23], s[22:23]
  v_mfma_f32_32x32x16_bf16 v[32:47], a[192:195], v[160:163], 0
  ds_read_b128 v[192:195], v0 offset:49152
  ds_read_b128 v[196:199], v0 offset:50176
  v_rcp_f32 v48, v48
  v_rcp_f32 v49, v49
  v_mfma_f32_32x32x16_bf16 v[32:47], a[196:199], v[164:167], v[32:47]
  ds_read_b128 v[200:203], v0 offset:51200
  ds_read_b128 v[204:207], v0 offset:52224
  v_rcp_f32 v50, v50
  v_rcp_f32 v51, v51
  v_mfma_f32_32x32x16_bf16 v[32:47], a[200:203], v[168:171], v[32:47]
  ds_read_b128 v[208:211], v0 offset:53248
  ds_read_b128 v[212:215], v0 offset:54272
  v_rcp_f32 v52, v52
  v_rcp_f32 v53, v53
  v_mfma_f32_32x32x16_bf16 v[32:47], a[204:207], v[172:175], v[32:47]
  buffer_store_dwordx4 v[132:135], v10, s[8:11], s28 offen offset:160
  v_rcp_f32 v54, v54
  v_rcp_f32 v55, v55
  v_mfma_f32_32x32x16_bf16 v[32:47], a[208:211], v[176:179], v[32:47]
  v_rcp_f32 v56, v56
  v_rcp_f32 v57, v57
  v_rcp_f32_e64 v58, v58
  v_mfma_f32_32x32x16_bf16 v[32:47], a[212:215], v[180:183], v[32:47]
  s_waitcnt lgkmcnt(0)
  v_rcp_f32 v59, v59
  v_rcp_f32 v60, v60
  v_rcp_f32 v61, v61
  v_rcp_f32 v62, v62
  v_rcp_f32 v63, v63
  v_pk_mul_f32 v[16:17], v[16:17], v[48:49]
  v_pk_mul_f32 v[18:19], v[18:19], v[50:51]
  v_pk_mul_f32 v[20:21], v[20:21], v[52:53]
  v_pk_mul_f32 v[22:23], v[22:23], v[54:55]
  v_pk_mul_f32 v[24:25], v[24:25], v[56:57]
  v_pk_mul_f32 v[26:27], v[26:27], v[58:59]
  v_pk_mul_f32 v[28:29], v[28:29], v[60:61]
  v_pk_mul_f32 v[30:31], v[30:31], v[62:63]
  v_pk_fma_f32 v[48:49], v[32:33], v[32:33], s[20:21] neg_lo:[1,0,1] neg_hi:[1,0,1]
  v_pk_fma_f32 v[50:51], v[34:35], v[34:35], s[20:21] neg_lo:[1,0,1] neg_hi:[1,0,1]
  v_pk_fma_f32 v[52:53], v[36:37], v[36:37], s[20:21] neg_lo:[1,0,1] neg_hi:[1,0,1]
  v_pk_fma_f32 v[54:55], v[38:39], v[38:39], s[20:21] neg_lo:[1,0,1] neg_hi:[1,0,1]
  v_pk_fma_f32 v[56:57], v[40:41], v[40:41], s[20:21] neg_lo:[1,0,1] neg_hi:[1,0,1]
  v_pk_fma_f32 v[58:59], v[42:43], v[42:43], s[20:21] neg_lo:[1,0,1] neg_hi:[1,0,1]
  v_pk_fma_f32 v[60:61], v[44:45], v[44:45], s[20:21] neg_lo:[1,0,1] neg_hi:[1,0,1]
  v_pk_fma_f32 v[62:63], v[46:47], v[46:47], s[20:21] neg_lo:[1,0,1] neg_hi:[1,0,1]
  v_pk_mul_f32 v[48:49], v[32:33], v[48:49]
  v_pk_mul_f32 v[50:51], v[34:35], v[50:51]
  v_pk_mul_f32 v[52:53], v[36:37], v[52:53]
  v_pk_mul_f32 v[54:55], v[38:39], v[54:55]
  v_pk_mul_f32 v[56:57], v[40:41], v[56:57]
  v_cvt_pk_bf16_f32 v184, v16, v17
  v_cvt_pk_bf16_f32 v185, v18, v19
  v_cvt_pk_bf16_f32 v186, v20, v21
  v_cvt_pk_bf16_f32 v187, v22, v23
  v_pk_mul_f32 v[58:59], v[42:43], v[58:59]
  v_pk_mul_f32 v[60:61], v[44:45], v[60:61]
  v_pk_mul_f32 v[62:63], v[46:47], v[62:63]
  v_mfma_f32_32x32x16_bf16 v[64:79], v[192:195], v[184:187], v[64:79]
  v_cvt_pk_bf16_f32 v188, v24, v25
  v_cvt_pk_bf16_f32 v189, v26, v27
  v_cvt_pk_bf16_f32 v190, v28, v29
  v_cvt_pk_bf16_f32 v191, v30, v31
  v_exp_f32_e64 v48, v48
  v_mfma_f32_32x32x16_bf16 v[80:95], v[196:199], v[184:187], v[80:95]
  v_exp_f32 v49, v49
  v_exp_f32 v50, v50
  v_exp_f32_e64 v51, v51
  v_mfma_f32_32x32x16_bf16 v[96:111], v[200:203], v[184:187], v[96:111]
  v_exp_f32 v52, v52
  v_exp_f32 v53, v53
  v_exp_f32_e64 v54, v54
  v_mfma_f32_32x32x16_bf16 v[64:79], v[204:207], v[188:191], v[64:79]
  v_exp_f32 v55, v55
  v_exp_f32 v56, v56
  v_exp_f32_e64 v57, v57
  v_mfma_f32_32x32x16_bf16 v[80:95], v[208:211], v[188:191], v[80:95]
  v_exp_f32 v58, v58
  v_exp_f32 v59, v59
  v_exp_f32_e64 v60, v60
  v_mfma_f32_32x32x16_bf16 v[96:111], v[212:215], v[188:191], v[96:111]
  v_exp_f32 v61, v61
  v_exp_f32 v62, v62
  v_exp_f32_e64 v63, v63
  v_pk_fma_f32 v[48:49], v[48:49], s[22:23], s[22:23]
  v_pk_fma_f32 v[50:51], v[50:51], s[22:23], s[22:23]
  v_pk_fma_f32 v[52:53], v[52:53], s[22:23], s[22:23]
  v_pk_fma_f32 v[54:55], v[54:55], s[22:23], s[22:23]
  v_pk_fma_f32 v[56:57], v[56:57], s[22:23], s[22:23]
  v_pk_fma_f32 v[58:59], v[58:59], s[22:23], s[22:23]
  v_pk_fma_f32 v[60:61], v[60:61], s[22:23], s[22:23]
  v_pk_fma_f32 v[62:63], v[62:63], s[22:23], s[22:23]
  v_mfma_f32_32x32x16_bf16 v[16:31], a[216:219], v[160:163], 0
  ds_read_b128 v[192:195], v0 offset:55296
  ds_read_b128 v[196:199], v0 offset:56320
  v_rcp_f32 v48, v48
  v_rcp_f32 v49, v49
  v_mfma_f32_32x32x16_bf16 v[16:31], a[220:223], v[164:167], v[16:31]
  ds_read_b128 v[200:203], v0 offset:57344
  ds_read_b128 v[204:207], v0 offset:58368
  v_rcp_f32 v50, v50
  v_rcp_f32 v51, v51
  v_mfma_f32_32x32x16_bf16 v[16:31], a[224:227], v[168:171], v[16:31]
  ds_read_b128 v[208:211], v0 offset:59392
  ds_read_b128 v[212:215], v0 offset:60416
  v_rcp_f32 v52, v52
  v_rcp_f32 v53, v53
  v_mfma_f32_32x32x16_bf16 v[16:31], a[228:231], v[172:175], v[16:31]
  v_rcp_f32 v54, v54
  v_rcp_f32 v55, v55
  v_rcp_f32_e64 v56, v56
  v_mfma_f32_32x32x16_bf16 v[16:31], a[232:235], v[176:179], v[16:31]
  v_rcp_f32 v57, v57
  v_rcp_f32 v58, v58
  v_rcp_f32_e64 v59, v59
  v_mfma_f32_32x32x16_bf16 v[16:31], a[236:239], v[180:183], v[16:31]
  s_waitcnt lgkmcnt(0)
  v_rcp_f32 v60, v60
  v_rcp_f32 v61, v61
  v_rcp_f32 v62, v62
  v_rcp_f32_e64 v63, v63
  v_pk_mul_f32 v[32:33], v[32:33], v[48:49]
  v_pk_mul_f32 v[34:35], v[34:35], v[50:51]
  v_pk_mul_f32 v[36:37], v[36:37], v[52:53]
  v_pk_mul_f32 v[38:39], v[38:39], v[54:55]
  v_pk_mul_f32 v[40:41], v[40:41], v[56:57]
  v_pk_mul_f32 v[42:43], v[42:43], v[58:59]
  v_pk_mul_f32 v[44:45], v[44:45], v[60:61]
  v_pk_mul_f32 v[46:47], v[46:47], v[62:63]
  v_pk_fma_f32 v[48:49], v[16:17], v[16:17], s[20:21] neg_lo:[1,0,1] neg_hi:[1,0,1]
  v_pk_fma_f32 v[50:51], v[18:19], v[18:19], s[20:21] neg_lo:[1,0,1] neg_hi:[1,0,1]
  v_pk_fma_f32 v[52:53], v[20:21], v[20:21], s[20:21] neg_lo:[1,0,1] neg_hi:[1,0,1]
  v_pk_fma_f32 v[54:55], v[22:23], v[22:23], s[20:21] neg_lo:[1,0,1] neg_hi:[1,0,1]
  v_pk_fma_f32 v[56:57], v[24:25], v[24:25], s[20:21] neg_lo:[1,0,1] neg_hi:[1,0,1]
  v_pk_fma_f32 v[58:59], v[26:27], v[26:27], s[20:21] neg_lo:[1,0,1] neg_hi:[1,0,1]
  v_pk_fma_f32 v[60:61], v[28:29], v[28:29], s[20:21] neg_lo:[1,0,1] neg_hi:[1,0,1]
  v_pk_fma_f32 v[62:63], v[30:31], v[30:31], s[20:21] neg_lo:[1,0,1] neg_hi:[1,0,1]
  v_pk_mul_f32 v[48:49], v[16:17], v[48:49]
  v_pk_mul_f32 v[50:51], v[18:19], v[50:51]
  v_pk_mul_f32 v[52:53], v[20:21], v[52:53]
  v_pk_mul_f32 v[54:55], v[22:23], v[54:55]
  v_pk_mul_f32 v[56:57], v[24:25], v[56:57]
  v_cvt_pk_bf16_f32 v184, v32, v33
  v_cvt_pk_bf16_f32 v185, v34, v35
  v_cvt_pk_bf16_f32 v186, v36, v37
  v_cvt_pk_bf16_f32 v187, v38, v39
  v_pk_mul_f32 v[58:59], v[26:27], v[58:59]
  v_pk_mul_f32 v[60:61], v[28:29], v[60:61]
  v_pk_mul_f32 v[62:63], v[30:31], v[62:63]
  v_mfma_f32_32x32x16_bf16 v[64:79], v[192:195], v[184:187], v[64:79]
  ds_read_b128 v[216:219], v0 offset:12288
  ds_read_b128 v[220:223], v0 offset:13312
  v_cvt_pk_bf16_f32 v188, v40, v41
  v_cvt_pk_bf16_f32 v189, v42, v43
  v_cvt_pk_bf16_f32 v190, v44, v45
  v_cvt_pk_bf16_f32 v191, v46, v47
  v_mfma_f32_32x32x16_bf16 v[80:95], v[196:199], v[184:187], v[80:95]
  ds_read_b128 v[224:227], v0 offset:14336
  ds_read_b128 v[228:231], v0 offset:15360
  v_exp_f32 v48, v48
  v_exp_f32 v49, v49
  v_mfma_f32_32x32x16_bf16 v[96:111], v[200:203], v[184:187], v[96:111]
  ds_read_b128 v[232:235], v0 offset:16384
  ds_read_b128 v[236:239], v0 offset:17408
  v_exp_f32 v50, v50
  v_exp_f32 v51, v51
  v_mfma_f32_32x32x16_bf16 v[64:79], v[204:207], v[188:191], v[64:79]
  s_mov_b32 s28, s34
  v_exp_f32 v52, v52
  v_exp_f32 v53, v53
  v_exp_f32 v54, v54
  v_mfma_f32_32x32x16_bf16 v[80:95], v[208:211], v[188:191], v[80:95]
  s_add_u32 s34, s34, 0x60000
  v_exp_f32 v55, v55
  v_exp_f32 v56, v56
  v_exp_f32_e64 v57, v57
  v_mfma_f32_32x32x16_bf16 v[96:111], v[212:215], v[188:191], v[96:111]
  s_waitcnt lgkmcnt(0)
  v_exp_f32 v58, v58
  v_exp_f32 v59, v59
  v_exp_f32 v60, v60
  v_exp_f32 v61, v61
  v_exp_f32 v62, v62
  v_exp_f32_e64 v63, v63
  v_pk_fma_f32 v[48:49], v[48:49], s[22:23], s[22:23]
  v_pk_fma_f32 v[50:51], v[50:51], s[22:23], s[22:23]
  v_pk_fma_f32 v[52:53], v[52:53], s[22:23], s[22:23]
  v_pk_fma_f32 v[54:55], v[54:55], s[22:23], s[22:23]
  v_pk_fma_f32 v[56:57], v[56:57], s[22:23], s[22:23]
  v_pk_fma_f32 v[58:59], v[58:59], s[22:23], s[22:23]
  v_pk_fma_f32 v[60:61], v[60:61], s[22:23], s[22:23]
  v_pk_fma_f32 v[62:63], v[62:63], s[22:23], s[22:23]
  v_mfma_f32_32x32x16_bf16 v[32:47], v[216:219], v[160:163], 0
  ds_read_b128 v[192:195], v0 offset:61440
  ds_read_b128 v[196:199], v0 offset:62464
  v_rcp_f32 v48, v48
  v_rcp_f32 v49, v49
  v_mfma_f32_32x32x16_bf16 v[32:47], v[220:223], v[164:167], v[32:47]
  ds_read_b128 v[200:203], v0 offset:63488
  ds_read_b128 v[204:207], v0 offset:64512
  v_rcp_f32 v50, v50
  v_rcp_f32 v51, v51
  v_mfma_f32_32x32x16_bf16 v[32:47], v[224:227], v[168:171], v[32:47]
  ds_read_b128 v[208:211], v1
  ds_read_b128 v[212:215], v1 offset:1024
  v_rcp_f32 v52, v52
  v_rcp_f32 v53, v53
  v_mfma_f32_32x32x16_bf16 v[32:47], v[228:231], v[172:175], v[32:47]
  v_rcp_f32 v54, v54
  v_rcp_f32 v55, v55
  v_rcp_f32_e64 v56, v56
  v_mfma_f32_32x32x16_bf16 v[32:47], v[232:235], v[176:179], v[32:47]
  v_rcp_f32 v57, v57
  v_rcp_f32 v58, v58
  v_rcp_f32_e64 v59, v59
  v_mfma_f32_32x32x16_bf16 v[32:47], v[236:239], v[180:183], v[32:47]
  s_waitcnt lgkmcnt(0)
  v_rcp_f32 v60, v60
  v_rcp_f32 v61, v61
  v_rcp_f32 v62, v62
  v_rcp_f32_e64 v63, v63
  v_pk_mul_f32 v[16:17], v[16:17], v[48:49]
  v_pk_mul_f32 v[18:19], v[18:19], v[50:51]
  v_pk_mul_f32 v[20:21], v[20:21], v[52:53]
  v_pk_mul_f32 v[22:23], v[22:23], v[54:55]
  v_pk_mul_f32 v[24:25], v[24:25], v[56:57]
  v_pk_mul_f32 v[26:27], v[26:27], v[58:59]
  v_pk_mul_f32 v[28:29], v[28:29], v[60:61]
  v_pk_mul_f32 v[30:31], v[30:31], v[62:63]
  v_pk_fma_f32 v[48:49], v[32:33], v[32:33], s[20:21] neg_lo:[1,0,1] neg_hi:[1,0,1]
  v_pk_fma_f32 v[50:51], v[34:35], v[34:35], s[20:21] neg_lo:[1,0,1] neg_hi:[1,0,1]
  v_pk_fma_f32 v[52:53], v[36:37], v[36:37], s[20:21] neg_lo:[1,0,1] neg_hi:[1,0,1]
  v_pk_fma_f32 v[54:55], v[38:39], v[38:39], s[20:21] neg_lo:[1,0,1] neg_hi:[1,0,1]
  v_pk_fma_f32 v[56:57], v[40:41], v[40:41], s[20:21] neg_lo:[1,0,1] neg_hi:[1,0,1]
  v_pk_fma_f32 v[58:59], v[42:43], v[42:43], s[20:21] neg_lo:[1,0,1] neg_hi:[1,0,1]
  v_pk_fma_f32 v[60:61], v[44:45], v[44:45], s[20:21] neg_lo:[1,0,1] neg_hi:[1,0,1]
  v_pk_fma_f32 v[62:63], v[46:47], v[46:47], s[20:21] neg_lo:[1,0,1] neg_hi:[1,0,1]
  v_pk_mul_f32 v[48:49], v[32:33], v[48:49]
  v_pk_mul_f32 v[50:51], v[34:35], v[50:51]
  v_pk_mul_f32 v[52:53], v[36:37], v[52:53]
  v_pk_mul_f32 v[54:55], v[38:39], v[54:55]
  v_pk_mul_f32 v[56:57], v[40:41], v[56:57]
  v_cvt_pk_bf16_f32 v184, v16, v17
  v_cvt_pk_bf16_f32 v185, v18, v19
  v_cvt_pk_bf16_f32 v186, v20, v21
  v_cvt_pk_bf16_f32 v187, v22, v23
  v_pk_mul_f32 v[58:59], v[42:43], v[58:59]
  v_pk_mul_f32 v[60:61], v[44:45], v[60:61]
  v_pk_mul_f32 v[62:63], v[46:47], v[62:63]
  v_mfma_f32_32x32x16_bf16 v[64:79], v[192:195], v[184:187], v[64:79]
  v_cvt_pk_bf16_f32 v188, v24, v25
  v_cvt_pk_bf16_f32 v189, v26, v27
  v_cvt_pk_bf16_f32 v190, v28, v29
  v_cvt_pk_bf16_f32 v191, v30, v31
  v_exp_f32_e64 v48, v48
  v_mfma_f32_32x32x16_bf16 v[80:95], v[196:199], v[184:187], v[80:95]
  v_exp_f32 v49, v49
  v_exp_f32 v50, v50
  v_exp_f32_e64 v51, v51
  v_mfma_f32_32x32x16_bf16 v[96:111], v[200:203], v[184:187], v[96:111]
  v_exp_f32 v52, v52
  v_exp_f32 v53, v53
  v_exp_f32_e64 v54, v54
  v_mfma_f32_32x32x16_bf16 v[64:79], v[204:207], v[188:191], v[64:79]
  v_exp_f32 v55, v55
  v_exp_f32 v56, v56
  v_exp_f32_e64 v57, v57
  v_mfma_f32_32x32x16_bf16 v[80:95], v[208:211], v[188:191], v[80:95]
  v_exp_f32 v58, v58
  v_exp_f32 v59, v59
  v_exp_f32_e64 v60, v60
  v_mfma_f32_32x32x16_bf16 v[96:111], v[212:215], v[188:191], v[96:111]
  v_exp_f32 v61, v61
  v_exp_f32 v62, v62
  v_exp_f32_e64 v63, v63
  v_pk_fma_f32 v[48:49], v[48:49], s[22:23], s[22:23]
  v_pk_fma_f32 v[50:51], v[50:51], s[22:23], s[22:23]
  v_pk_fma_f32 v[52:53], v[52:53], s[22:23], s[22:23]
  v_pk_fma_f32 v[54:55], v[54:55], s[22:23], s[22:23]
  v_pk_fma_f32 v[56:57], v[56:57], s[22:23], s[22:23]
  v_pk_fma_f32 v[58:59], v[58:59], s[22:23], s[22:23]
  v_pk_fma_f32 v[60:61], v[60:61], s[22:23], s[22:23]
  v_pk_fma_f32 v[62:63], v[62:63], s[22:23], s[22:23]
  ds_read_b128 v[192:195], v1 offset:2048
  ds_read_b128 v[196:199], v1 offset:3072
  ds_read_b128 v[200:203], v1 offset:4096
  ds_read_b128 v[204:207], v1 offset:5120
  ds_read_b128 v[208:211], v1 offset:6144
  ds_read_b128 v[212:215], v1 offset:7168
  v_rcp_f32 v48, v48
  v_rcp_f32 v49, v49
  v_rcp_f32 v50, v50
  v_rcp_f32 v51, v51
  v_rcp_f32 v52, v52
  v_rcp_f32 v53, v53
  v_rcp_f32 v54, v54
  v_rcp_f32 v55, v55
  v_rcp_f32 v56, v56
  v_rcp_f32 v57, v57
  v_rcp_f32 v58, v58
  v_rcp_f32 v59, v59
  v_rcp_f32 v60, v60
  v_rcp_f32 v61, v61
  v_rcp_f32 v62, v62
  v_rcp_f32 v63, v63
  v_pk_mul_f32 v[32:33], v[32:33], v[48:49]
  v_pk_mul_f32 v[34:35], v[34:35], v[50:51]
  v_pk_mul_f32 v[36:37], v[36:37], v[52:53]
  v_pk_mul_f32 v[38:39], v[38:39], v[54:55]
  v_pk_mul_f32 v[40:41], v[40:41], v[56:57]
  v_pk_mul_f32 v[42:43], v[42:43], v[58:59]
  v_pk_mul_f32 v[44:45], v[44:45], v[60:61]
  v_pk_mul_f32 v[46:47], v[46:47], v[62:63]
  v_cvt_pk_bf16_f32 v184, v32, v33
  v_cvt_pk_bf16_f32 v185, v34, v35
  v_cvt_pk_bf16_f32 v186, v36, v37
  v_cvt_pk_bf16_f32 v187, v38, v39
  v_cvt_pk_bf16_f32 v188, v40, v41
  v_cvt_pk_bf16_f32 v189, v42, v43
  v_cvt_pk_bf16_f32 v190, v44, v45
  v_cvt_pk_bf16_f32 v191, v46, v47
  s_waitcnt lgkmcnt(5)
  v_mfma_f32_32x32x16_bf16 v[64:79], v[192:195], v[184:187], v[64:79]
  s_waitcnt lgkmcnt(2)
  v_mfma_f32_32x32x16_bf16 v[64:79], v[204:207], v[188:191], v[64:79]
  v_mfma_f32_32x32x16_bf16 v[80:95], v[196:199], v[184:187], v[80:95]
  s_nop 0
  s_waitcnt lgkmcnt(1)
  v_mfma_f32_32x32x16_bf16 v[80:95], v[208:211], v[188:191], v[80:95]
  v_mfma_f32_32x32x16_bf16 v[96:111], v[200:203], v[184:187], v[96:111]
  s_waitcnt lgkmcnt(0)
  v_mfma_f32_32x32x16_bf16 v[96:111], v[212:215], v[188:191], v[96:111]
  s_nop 5
  v_cvt_pk_bf16_f32 v112, v64, v65
  v_cvt_pk_bf16_f32 v113, v66, v67
  v_cvt_pk_bf16_f32 v114, v68, v69
  v_cvt_pk_bf16_f32 v115, v70, v71
  buffer_store_dwordx4 v[112:115], v10, s[8:11], s28 offen
  v_cvt_pk_bf16_f32 v116, v72, v73
  v_cvt_pk_bf16_f32 v117, v74, v75
  v_cvt_pk_bf16_f32 v118, v76, v77
  v_cvt_pk_bf16_f32 v119, v78, v79
  buffer_store_dwordx4 v[116:119], v10, s[8:11], s28 offen offset:32
  v_cvt_pk_bf16_f32 v120, v80, v81
  v_cvt_pk_bf16_f32 v121, v82, v83
  v_cvt_pk_bf16_f32 v122, v84, v85
  v_cvt_pk_bf16_f32 v123, v86, v87
  buffer_store_dwordx4 v[120:123], v10, s[8:11], s28 offen offset:64
  v_cvt_pk_bf16_f32 v124, v88, v89
  v_cvt_pk_bf16_f32 v125, v90, v91
  v_cvt_pk_bf16_f32 v126, v92, v93
  v_cvt_pk_bf16_f32 v127, v94, v95
  buffer_store_dwordx4 v[124:127], v10, s[8:11], s28 offen offset:96
  v_cvt_pk_bf16_f32 v128, v96, v97
  v_cvt_pk_bf16_f32 v129, v98, v99
  v_cvt_pk_bf16_f32 v130, v100, v101
  v_cvt_pk_bf16_f32 v131, v102, v103
  buffer_store_dwordx4 v[128:131], v10, s[8:11], s28 offen offset:128
  v_cvt_pk_bf16_f32 v132, v104, v105
  v_cvt_pk_bf16_f32 v133, v106, v107
  v_cvt_pk_bf16_f32 v134, v108, v109
  v_cvt_pk_bf16_f32 v135, v110, v111
  buffer_store_dwordx4 v[132:135], v10, s[8:11], s28 offen offset:160
L_end:
  s_endpgm
.section .rodata,"a"
.p2align 6
.amdhsa_kernel standalone__modern_conv_block_convnext__vision_kernel
  .amdhsa_next_free_vgpr 512
  .amdhsa_next_free_sgpr 102
  .amdhsa_accum_offset 256
  .amdhsa_group_segment_fixed_size 0
  .amdhsa_kernarg_size 80
  .amdhsa_user_sgpr_count 2
  .amdhsa_user_sgpr_kernarg_segment_ptr 1
  .amdhsa_system_sgpr_workgroup_id_x 1
.end_amdhsa_kernel
```

```asm
; @launch grid=(256,1,1) block=(256,1,1) lds=163840
.amdgcn_target "amdgcn-amd-amdhsa--gfx950"
.text
.globl standalone__modern_conv_block_convnext__vision_kernel
.p2align 8
.type standalone__modern_conv_block_convnext__vision_kernel,@function
standalone__modern_conv_block_convnext__vision_kernel:
  s_cmp_ge_u32 s2, 0x100
  s_nop 0
  s_cbranch_scc1 L_end
  s_load_dwordx2 s[4:5], s[0:1], 0
  s_load_dwordx2 s[60:61], s[0:1], 8
  s_load_dwordx2 s[64:65], s[0:1], 16
  s_load_dwordx2 s[68:69], s[0:1], 24
  s_load_dwordx2 s[72:73], s[0:1], 32
  s_load_dwordx2 s[76:77], s[0:1], 40
  s_load_dwordx2 s[80:81], s[0:1], 48
  s_load_dwordx2 s[8:9], s[0:1], 56
  s_getpc_b64 s[40:41]
L_pc:
  s_lshl_b32 s32, s2, 9
  s_and_b32 s32, s32, 0xf000
  v_lshl_add_u32 v249, v0, 4, s32
  v_lshrrev_b32_e64 v112, 6, v0
  v_min_u32 v249, L_end-L_pc-12, v249
  v_and_b32 v113, 63, v0
  global_load_dwordx4 v[108:111], v249, s[40:41]
  v_readfirstlane_b32 s27, v112
  s_mov_b32 s62, 0x6c0
  s_mov_b32 s63, 0x20000
  s_mov_b32 s82, 0xc0
  s_mov_b32 s83, 0x20000
  s_mov_b32 s78, 0xc0
  s_mov_b32 s79, 0x20000
  s_mov_b32 s66, 0x12000
  s_mov_b32 s67, 0x20000
  s_mov_b32 s74, 0x12000
  s_mov_b32 s75, 0x20000
  v_bfe_u32 v114, v113, 3, 1
  v_bfe_u32 v115, v113, 4, 1
  v_bfe_u32 v116, v113, 2, 1
  v_and_b32 v117, 3, v113
  v_lshlrev_b32 v118, 4, v113
  s_min_u32 s44, s27, 2
  s_lshl_b32 s45, s44, 6
  s_mul_i32 s46, s44, 0x240
  v_lshlrev_b32 v119, 1, v113
  v_and_b32 v120, 31, v113
  v_lshlrev_b32 v121, 1, v120
  v_lshlrev_b32 v122, 4, v115
  v_lshl_add_u32 v122, v116, 3, v122
  v_lshl_add_u32 v122, v114, 2, v122
  v_add_u32 v122, v122, v117
  v_lshlrev_b32 v123, 1, v122
  s_lshr_b32 s35, s2, 3
  s_lshl_b32 s35, s35, 2
  s_add_u32 s35, s35, s27
  s_sub_u32 s55, s35, 0x48
  s_min_u32 s35, s35, s55
  s_lshl_b32 s47, s35, 10
  s_and_b32 s54, s2, 6
  s_lshl_b32 s54, s54, 1
  s_lshr_b32 s32, s2, 6
  s_add_u32 s54, s54, s32
  s_mul_i32 s59, s54, 0x300000
  s_and_b32 s53, s2, 1
  s_lshl_b32 s53, s53, 8
  s_and_b32 s32, s2, 56
  s_lshl_b32 s32, s32, 2
  s_add_u32 s53, s53, s32
  s_lshl_b32 s32, s27, 3
  s_add_u32 s53, s53, s32
  s_mul_i32 s3, s53, 0xc0
  s_add_u32 s3, s3, 0xf40
  s_mov_b32 s6, 0x3000000
  s_mov_b32 s7, 0x20000
  s_cmp_eq_u32 s53, 0
  s_cselect_b32 s35, 12, 0
  s_sub_u32 s55, 0x78, s35
  s_cmp_eq_u32 s53, 0x1f8
  s_cselect_b32 s55, 0x6c, s55
  s_mul_i32 s15, s27, 0x1040
  s_add_u32 s48, s59, 0x17000
  s_add_u32 s49, s59, 0x47000
  s_waitcnt lgkmcnt(0)
  v_add_u32 v124, 64, v113
  buffer_load_dwordx4 v[108:111], v118, s[64:67], s47 offen
  v_subrev_u32 v127, 57, v113
  v_cmp_le_u32 vcc, 57, v113
  buffer_load_dwordx4 v[108:111], v118, s[72:75], s47 offen
  v_add_u32_e64 v125, 7, v113
  v_add_u32 v126, 0x47, v113
  buffer_load_ushort v129, v119, s[60:63], s46 offen
  v_mov_b32 v199, 0x17c00
  v_cndmask_b32_e64 v124, v124, v127, vcc
  buffer_load_ushort v130, v119, s[60:63], s46 offen offset:128
  v_mov_b32 v127, 0xfffffc00
  v_cndmask_b32 v199, v127, v199, vcc
  v_add_u32 v198, s3, v118
  buffer_load_ushort v131, v119, s[60:63], s46 offen offset:256
  v_lshl_add_u32 v199, v124, 4, v199
  v_add_u32_e64 v199, s3, v199
  buffer_load_ushort v132, v119, s[60:63], s46 offen offset:384
  v_add_u32 v200, 0x17870, v198
  v_add_u32 v201, 0x17870, v198
  buffer_load_ushort v133, v121, s[60:63], s46 offen offset:512
  v_mov_b32 v128, 0x80000000
  v_subrev_u32_e64 v6, s35, v113
  buffer_load_ushort v137, v123, s[80:83], s45 offen
  v_cmp_gt_u32 s[36:37], s55, v6
  v_subrev_u32_e64 v7, s35, v124
  v_cmp_gt_u32 s[38:39], s55, v7
  buffer_load_ushort v138, v123, s[76:79], s45 offen
  v_subrev_u32_e64 v8, s35, v125
  v_cmp_gt_u32 s[40:41], s55, v8
  buffer_load_ushort v134, v123, s[80:83], 0 offen
  v_subrev_u32_e64 v9, s35, v126
  v_cmp_gt_u32 s[42:43], s55, v9
  buffer_load_ushort v135, v123, s[80:83], 0 offen offset:64
  v_cndmask_b32 v6, v128, v198, s[36:37]
  v_cndmask_b32 v7, v128, v199, s[38:39]
  buffer_load_ushort v136, v123, s[80:83], 0 offen offset:128
  v_cndmask_b32 v8, v128, v200, s[40:41]
  v_cndmask_b32 v9, v128, v201, s[42:43]
  s_add_u32 m0, s15, 0x4120
  s_nop 0
  s_nop 0
  buffer_load_dwordx4 v6, s[4:7], s48 offen lds
  buffer_load_dwordx4 v7, s[4:7], s48 offen offset:1024 lds
  buffer_load_dwordx4 v8, s[4:7], s48 offen offset:2048 lds
  buffer_load_dwordx4 v9, s[4:7], s48 offen offset:3072 lds
  s_sub_u32 s56, s59, 0x19000
  v_add_u32_e64 v198, s56, v6
  s_add_u32 s56, s56, 0x400
  v_add_u32_e64 v199, s56, v7
  s_add_u32 s56, s56, 0x400
  v_add_u32_e64 v200, s56, v8
  s_add_u32 s56, s56, 0x400
  v_add_u32 v201, s56, v9
  v_lshrrev_b32 v139, 5, v113
  v_lshlrev_b32_e64 v202, 4, v117
  v_lshl_add_u32 v202, v139, 6, v202
  v_bfe_u32 v124, v113, 3, 2
  v_lshl_add_u32 v124, v116, 2, v124
  v_cmp_eq_u32_e64 vcc, 7, v124
  v_mul_u32_u24 v203, 0x300, v124
  v_add_u32 v203, v203, v202
  v_cndmask_b32 v204, v128, v202, vcc
  s_mov_b32 s70, 0x300
  s_mov_b32 s71, 0x20000
  s_mov_b32 s10, 0x3000000
  s_mov_b32 s11, 0x20000
  s_and_b32 s36, s27, 2
  s_add_u32 s37, s27, 1
  s_lshr_b32 s37, s37, 1
  s_and_b32 s38, s37, 1
  s_cmp_eq_u32 s27, 1
  s_cselect_b32 s39, 0, 3
  s_cselect_b32 s51, 0x1000, 0
  s_lshl_b32 s32, s36, 8
  s_lshl_b32 s33, s37, 8
  s_add_u32 s43, s32, 0x11d00
  s_add_u32 s50, s33, 0x11d00
  s_add_u32 s51, s51, s33
  s_mul_i32 s40, s38, 0x6000
  s_add_u32 s40, s40, s32
  s_mul_i32 s41, s38, 0x1800
  s_add_u32 s41, s41, s32
  s_add_u32 s41, s41, 0x3000
  s_mul_i32 s42, s39, 0x3000
  s_add_u32 s42, s42, s33
  s_mul_i32 s32, s36, 0x6000
  s_lshl_b32 s33, s38, 11
  s_add_u32 s33, s33, s32
  s_add_u32 s33, s33, 0x10000
  v_add_u32_e64 v195, s33, v118
  s_lshl_b32 s33, s38, 3
  s_add_u32 s33, s33, s32
  s_add_u32 s33, s33, 0x10400
  v_add_u32_e64 v196, s33, v118
  s_mul_i32 s32, s37, 0x6000
  s_lshl_b32 s33, s39, 10
  s_add_u32 s33, s33, s32
  s_add_u32 s33, s33, 0x10000
  v_add_u32 v197, s33, v118
  v_add_u32 v125, 16, v113
  v_lshrrev_b32_e64 v125, 6, v125
  buffer_load_dwordx4 a[72:75], v202, s[64:67], s43 offen
  v_lshlrev_b32 v125, 4, v125
  v_xor_b32 v254, v125, v118
  v_lshl_add_u32 v125, v139, 4, 16
  v_xor_b32_e64 v255, v125, v118
  v_mul_u32_u24 v125, 0x1200, v139
  v_add_u32_e64 v255, v125, v255
  v_add_u32 v125, 0xb0, v113
  v_lshrrev_b32 v125, 6, v125
  v_lshlrev_b32 v125, 4, v125
  v_xor_b32_e64 v194, v125, v118
  v_add_u32 v194, 0x1200, v194
  s_mul_i32 s14, s27, 0x1800
  s_add_u32 s32, s27, 3
  s_and_b32 s32, s32, 3
  s_mul_i32 s32, s32, 0x600
  s_cmp_eq_u32 s27, 0
  s_cselect_b32 s57, 0, 3
  s_cselect_b32 s53, 3, 6
  s_cselect_b32 s55, 6, 0
  s_lshl_b32 s57, s57, 13
  s_add_u32 s57, s57, s32
  s_add_u32 s58, s57, 0x3000
  s_lshl_b32 s53, s53, 13
  s_add_u32 s53, s53, s32
  s_add_u32 s54, s53, 0x3000
  s_lshl_b32 s55, s55, 13
  s_add_u32 s55, s55, s32
  s_add_u32 s56, s55, 0x3000
  v_and_b32_e64 v145, 7, v113
  buffer_load_dwordx4 a[76:79], v202, s[64:67], s43 offen offset:128
  v_lshrrev_b32 v146, 4, v113
  v_lshlrev_b32 v147, 4, v139
  v_and_b32 v141, 1, v113
  v_lshlrev_b32 v141, 4, v141
  v_mov_b32 v127, 0xffff
  v_lshlrev_b32_e64 v127, v141, v127
  v_bfe_u32 v125, v113, 1, 2
  buffer_load_dwordx4 a[80:83], v202, s[64:67], s50 offen
  v_lshlrev_b32 v125, v125, 1
  v_bfe_i32 v56, v125, 0, 1
  v_mov_b32 v60, 0
  v_and_b32 v56, v56, v127
  v_bfe_i32 v57, v125, 1, 1
  v_mov_b32 v61, 0
  v_and_b32 v57, v57, v127
  v_bfe_i32 v58, v125, 2, 1
  v_mov_b32 v62, 0
  v_and_b32 v58, v58, v127
  v_bfe_i32 v59, v125, 3, 1
  v_mov_b32 v63, 0
  v_and_b32 v59, v59, v127
  v_min_u32_e64 v125, 35, v113
  v_mul_u32_u24 v125, 0x190, v125
  ds_write_b128 v125, v[60:63] offset:50304
  s_lshl_b32 s32, s44, 7
  v_lshrrev_b32 v142, 3, v113
  buffer_load_dwordx4 a[84:87], v202, s[64:67], s50 offen offset:128
  v_mul_u32_u24 v142, 0x190, v142
  v_lshl_add_u32 v142, v145, 4, v142
  v_add_u32 v142, s32, v142
  v_lshrrev_b32 v143, 3, v120
  v_mul_u32_u24 v143, 0x190, v143
  v_lshl_add_u32 v143, v145, 4, v143
  v_add_u32_e64 v143, s32, v143
  v_lshl_add_u32 v144, v120, 2, s32
  v_sub_u32_e64 v125, v146, v116
  v_lshl_add_u32 v126, v114, 2, v117
  v_lshl_add_u32 v126, v125, 3, v126
  v_min_u32 v126, 24, v126
  v_lshlrev_b32 v126, 4, v126
  v_add_u32 v3, 0xc300, v126
  v_lshlrev_b32_e64 v148, 2, v115
  v_lshl_add_u32 v148, v114, 1, v148
  v_bfe_u32 v126, v113, 1, 1
  buffer_load_dwordx4 a[88:91], v204, s[68:71], s51 offen
  v_add_u32 v148, v148, v126
  v_xor_b32 v126, v116, v139
  v_lshl_add_u32 v148, v126, 3, v148
  v_lshlrev_b32 v148, v148, 1
  v_mov_b32 v126, 0x3f80
  v_lshlrev_b32_e64 v126, v141, v126
  v_mov_b32 v125, 0xbf80
  v_lshlrev_b32_e64 v125, v141, v125
  v_bfe_i32 v160, v148, 0, 1
  v_and_b32 v240, v160, v126
  v_and_b32 v184, v160, v125
  v_bfe_i32 v161, v148, 1, 1
  v_and_b32 v241, v161, v126
  v_and_b32 v185, v161, v125
  v_bfe_i32 v162, v148, 2, 1
  v_and_b32 v242, v162, v126
  v_and_b32 v186, v162, v125
  v_bfe_i32 v163, v148, 3, 1
  buffer_load_dwordx4 a[92:95], v204, s[68:71], s51 offen offset:128
  v_and_b32 v243, v163, v126
  v_and_b32 v187, v163, v125
  v_bfe_i32 v164, v148, 4, 1
  v_and_b32 v244, v164, v126
  v_and_b32 v188, v164, v125
  v_bfe_i32 v165, v148, 5, 1
  v_and_b32 v245, v165, v126
  v_and_b32 v189, v165, v125
  v_bfe_i32 v166, v148, 6, 1
  v_and_b32 v246, v166, v126
  v_and_b32 v190, v166, v125
  v_bfe_i32 v167, v148, 7, 1
  v_and_b32 v247, v167, v126
  v_and_b32 v191, v167, v125
  s_mov_b32 s22, 0x3e800000
  s_mov_b32 s24, 0x3c2aaaab
  s_mov_b32 s25, 0x3727c5ac
  s_mov_b32 s20, 0x4438bfc7
  s_mov_b32 s21, 0x3ca2bacd
  s_mov_b32 s23, 0x3a26b6a8
  s_mov_b32 s12, 0
  s_mov_b32 s13, -1
  s_add_u32 s29, s59, 0x77000
  s_add_u32 s52, s59, 0xa7000
  v_mul_u32_u24 v149, 0xc0, v145
  buffer_load_dwordx4 a[0:3], v203, s[64:67], s40 offen
  v_add_u32_e64 v127, s15, v149
  v_lshl_add_u32 v150, v114, 1, v146
  v_lshrrev_b32_e64 v125, 1, v150
  v_mul_u32_u24 v140, 0x4100, v125
  v_and_b32_e64 v125, 1, v125
  v_lshl_add_u32 v140, v125, 5, v140
  v_and_b32_e64 v125, 1, v150
  v_mul_u32_u24 v125, 0x790, v125
  v_add3_u32 v4, v140, v125, v127
  v_lshl_add_u32 v151, v114, 1, v115
  buffer_load_dwordx4 a[4:7], v203, s[64:67], s40 offen offset:128
  s_add_u32 s40, s40, 0x1800
  v_add_u32_e64 v150, 1, v151
  v_add_u32 v127, 0xc0, v127
  v_add_u32 v127, v127, v147
  v_lshrrev_b32 v125, 1, v150
  v_mul_u32_u24 v140, 0x4100, v125
  v_and_b32_e64 v125, 1, v125
  v_lshl_add_u32 v140, v125, 5, v140
  v_and_b32_e64 v125, 1, v150
  v_mul_u32_u24 v125, 0x790, v125
  v_add3_u32 v5, v140, v125, v127
  v_mul_u32_u24 v125, 0x18000, v151
  v_add3_u32 v10, v125, v147, v149
  s_sub_u32 s32, s3, 0xf40
  v_add_u32_e64 v10, s32, v10
  v_add_u32 v2, 0xfb40, v147
  v_add_u32 v0, 0x10000, v118
  v_add_u32 v1, 0x20000, v118
  v_and_b32_e64 v125, 15, v113
  buffer_load_dwordx4 a[8:11], v203, s[64:67], s40 offen
  v_lshlrev_b32 v125, 7, v125
  v_mul_u32_u24 v126, 0x18000, v146
  s_sub_u32 s32, s3, 64
  v_add3_u32 v248, v125, v126, s32
  v_mov_b32 v250, 0x3e800000
  s_add_u32 s32, s14, 0x16000
  v_add_u32_e64 v253, s32, v118
  v_bfe_u32 v125, v122, 2, 2
  v_xor_b32_e64 v125, v125, v139
  v_lshl_add_u32 v125, v125, 4, s32
  v_mul_u32_u24 v126, 0xc0, v122
  v_add_u32 v251, v125, v126
  v_xor_b32 v252, 32, v251
  s_add_u32 s30, s15, 32
  s_add_u32 s31, s15, 0x4100
  s_mov_b32 s34, s59
  s_mov_b32 s28, 0x80000000
  s_add_u32 s33, s15, 0x8200
  buffer_load_dwordx4 a[12:15], v203, s[64:67], s40 offen offset:128
  buffer_load_dwordx4 a[16:19], v203, s[64:67], s41 offen
  buffer_load_dwordx4 a[20:23], v203, s[64:67], s41 offen offset:128
  s_waitcnt vmcnt(25)
  v_lshl_or_b32 v129, v129, 16, v129
  v_and_b32 v16, v56, v129
  v_and_b32 v17, v57, v129
  v_and_b32 v18, v58, v129
  v_and_b32 v19, v59, v129
  ds_write_b128 v142, v[16:19] offset:49920
  s_waitcnt vmcnt(24)
  v_lshl_or_b32 v130, v130, 16, v130
  v_and_b32 v20, v56, v130
  v_and_b32 v21, v57, v130
  v_and_b32 v22, v58, v130
  v_and_b32 v23, v59, v130
  ds_write_b128 v142, v[20:23] offset:53120
  s_waitcnt vmcnt(23)
  v_lshl_or_b32 v131, v131, 16, v131
  v_and_b32 v24, v56, v131
  v_and_b32 v25, v57, v131
  v_and_b32 v26, v58, v131
  v_and_b32 v27, v59, v131
  ds_write_b128 v142, v[24:27] offset:56320
  s_waitcnt vmcnt(22)
  v_lshl_or_b32 v132, v132, 16, v132
  v_and_b32 v28, v56, v132
  v_and_b32 v29, v57, v132
  v_and_b32 v30, v58, v132
  v_and_b32 v31, v59, v132
  ds_write_b128 v142, v[28:31] offset:59520
  s_waitcnt vmcnt(21)
  v_lshl_or_b32 v133, v133, 16, v133
  v_and_b32 v16, v56, v133
  v_and_b32 v17, v57, v133
  v_and_b32 v18, v58, v133
  v_and_b32_e64 v19, v59, v133
  ds_write_b128 v143, v[16:19] offset:62720
  s_waitcnt vmcnt(20)
  v_lshlrev_b32 v137, 16, v137
  s_waitcnt vmcnt(19)
  v_lshlrev_b32 v138, 16, v138
  v_mul_f32 v138, v137, v138
  s_waitcnt vmcnt(18)
  v_lshlrev_b32 v134, 16, v134
  s_waitcnt vmcnt(17)
  v_lshlrev_b32 v135, 16, v135
  s_waitcnt vmcnt(16)
  v_lshlrev_b32 v136, 16, v136
  v_xor_b32 v141, 16, v141
  v_mul_f32 v134, 4.0, v134
  v_mul_f32 v135, 4.0, v135
  v_mul_f32 v136, 4.0, v136
  v_lshrrev_b32 v134, v141, v134
  v_lshrrev_b32 v135, v141, v135
  v_lshrrev_b32 v136, v141, v136
  ds_write_b32 v144, v138 offset:64320
  s_waitcnt lgkmcnt(0)
  s_barrier
  ds_read_b128 a[96:99], v3
  ds_read_b128 a[100:103], v3 offset:4800
  ds_read_b128 a[104:107], v3 offset:9600
  ds_read_b128 a[108:111], v3 offset:400
  ds_read_b128 a[112:115], v3 offset:5200
  ds_read_b128 a[116:119], v3 offset:10000
  v_and_b32 v125, v160, v134
  v_and_b32 v126, v161, v134
  v_and_b32_e64 v127, v162, v134
  buffer_load_dwordx4 a[24:27], v203, s[64:67], s42 offen
  v_and_b32_e64 v140, v163, v134
  v_accvgpr_write_b32 a192, v125
  v_accvgpr_write_b32 a193, v126
  v_accvgpr_write_b32 a194, v127
  v_accvgpr_write_b32 a195, v140
  ds_read_b128 a[120:123], v3 offset:800
  ds_read_b128 a[124:127], v3 offset:5600
  ds_read_b128 a[128:131], v3 offset:10400
  ds_read_b128 a[132:135], v3 offset:1200
  ds_read_b128 a[136:139], v3 offset:6000
  ds_read_b128 a[140:143], v3 offset:10800
  buffer_load_dwordx4 a[28:31], v203, s[64:67], s42 offen offset:128
  s_add_u32 s42, s42, 0x1800
  v_and_b32 v125, v164, v134
  v_and_b32 v126, v165, v134
  v_and_b32 v127, v166, v134
  v_and_b32 v140, v167, v134
  v_accvgpr_write_b32 a196, v125
  v_accvgpr_write_b32 a197, v126
  v_accvgpr_write_b32 a198, v127
  v_accvgpr_write_b32 a199, v140
  ds_read_b128 a[144:147], v3 offset:1600
  ds_read_b128 a[148:151], v3 offset:6400
  buffer_load_dwordx4 a[32:35], v203, s[64:67], s42 offen
  ds_read_b128 a[152:155], v3 offset:11200
  ds_read_b128 a[156:159], v3 offset:2000
  ds_read_b128 a[160:163], v3 offset:6800
  ds_read_b128 a[164:167], v3 offset:11600
  v_and_b32 v125, v160, v135
  v_and_b32 v126, v161, v135
  v_and_b32 v127, v162, v135
  v_and_b32 v140, v163, v135
  v_accvgpr_write_b32 a200, v125
  v_accvgpr_write_b32 a201, v126
  v_accvgpr_write_b32 a202, v127
  buffer_load_dwordx4 a[36:39], v203, s[64:67], s42 offen offset:128
  s_add_u32 s42, s42, 0x1800
  v_accvgpr_write_b32 a203, v140
  ds_read_b128 a[240:243], v3 offset:2400
  ds_read_b128 a[244:247], v3 offset:7200
  ds_read_b128 a[248:251], v3 offset:12000
  ds_read_b128 a[168:171], v3 offset:2800
  ds_read_b128 a[172:175], v3 offset:7600
  ds_read_b128 a[176:179], v3 offset:12400
  v_and_b32 v125, v164, v135
  v_and_b32 v126, v165, v135
  v_and_b32 v127, v166, v135
  v_and_b32 v140, v167, v135
  buffer_load_dwordx4 a[40:43], v203, s[64:67], s42 offen
  v_accvgpr_write_b32 a204, v125
  v_accvgpr_write_b32 a205, v126
  v_accvgpr_write_b32 a206, v127
  v_accvgpr_write_b32 a207, v140
  ds_read_b128 a[252:255], v3 offset:3200
  ds_read_b128 a[180:183], v3 offset:8000
  ds_read_b128 a[184:187], v3 offset:12800
  ds_read_b128 a[188:191], v3 offset:3600
  ds_read_b128 a[216:219], v3 offset:8400
  ds_read_b128 a[220:223], v3 offset:13200
  buffer_load_dwordx4 a[44:47], v203, s[64:67], s42 offen offset:128
  s_add_u32 s42, s42, 0x1800
  v_and_b32 v125, v160, v136
  v_and_b32 v126, v161, v136
  v_and_b32 v127, v162, v136
  v_and_b32 v140, v163, v136
  v_accvgpr_write_b32 a208, v125
  v_accvgpr_write_b32 a209, v126
  v_accvgpr_write_b32 a210, v127
  v_accvgpr_write_b32 a211, v140
  ds_read_b128 a[224:227], v3 offset:4000
  ds_read_b128 a[228:231], v3 offset:8800
  ds_read_b128 a[232:235], v3 offset:13600
  buffer_load_dwordx4 a[48:51], v203, s[64:67], s42 offen
  ds_read_b128 a[236:239], v3 offset:4400
  ds_read_b128 v[208:211], v3 offset:9200
  ds_read_b128 v[212:215], v3 offset:14000
  v_and_b32 v125, v164, v136
  v_and_b32 v126, v165, v136
  v_and_b32 v127, v166, v136
  v_and_b32 v140, v167, v136
  v_accvgpr_write_b32 a212, v125
  v_accvgpr_write_b32 a213, v126
  v_accvgpr_write_b32 a214, v127
  buffer_load_dwordx4 a[52:55], v203, s[64:67], s42 offen offset:128
  s_add_u32 s42, s42, 0x1800
  v_accvgpr_write_b32 a215, v140
  s_waitcnt vmcnt(19)
  v_mfma_f32_32x32x16_bf16 v[16:31], a[72:75], v[184:187], 0
  buffer_load_dwordx4 a[56:59], v203, s[64:67], s42 offen
  s_waitcnt vmcnt(19)
  v_mfma_f32_32x32x16_bf16 v[16:31], a[76:79], v[188:191], v[16:31]
  s_waitcnt vmcnt(18)
  v_mfma_f32_32x32x16_bf16 v[32:47], a[80:83], v[184:187], 0
  buffer_load_dwordx4 a[60:63], v203, s[64:67], s42 offen offset:128
  s_add_u32 s42, s42, 0x1800
  s_waitcnt vmcnt(15)
  v_mfma_f32_32x32x16_bf16 v[48:63], a[0:3], v[240:243], v[16:31]
  buffer_load_dwordx4 a[64:67], v203, s[64:67], s42 offen
  v_mfma_f32_32x32x16_bf16 v[32:47], a[84:87], v[188:191], v[32:47]
  s_waitcnt vmcnt(15)
  v_mfma_f32_32x32x16_bf16 v[48:63], a[4:7], v[244:247], v[48:63]
  buffer_load_dwordx4 a[68:71], v203, s[64:67], s42 offen offset:128
  s_waitcnt vmcnt(15)
  v_mfma_f32_32x32x16_bf16 v[216:231], a[8:11], v[240:243], v[16:31]
  s_add_u32 m0, s15, 0x8200
  s_nop 0
  buffer_load_dwordx4 v6, s[4:7], s49 offen lds
  s_waitcnt vmcnt(15)
  v_mfma_f32_32x32x16_bf16 v[216:231], a[12:15], v[244:247], v[216:231]
  buffer_load_dwordx4 v7, s[4:7], s49 offen offset:1024 lds
  s_nop 0
  s_nop 2
  v_cvt_pk_bf16_f32 v64, v48, v52
  v_cvt_pk_bf16_f32 v65, v56, v60
  v_cvt_pk_bf16_f32 v68, v49, v53
  v_cvt_pk_bf16_f32 v69, v57, v61
  v_max3_f32 v236, |v48|, |v52|, |v56|
  v_max_f32_e64 v236, |v60|, v236
  v_max3_f32 v236, |v49|, |v53|, v236
  v_max3_f32 v236, |v57|, |v61|, v236
  s_nop 0
  s_waitcnt vmcnt(15)
  v_mfma_f32_32x32x16_bf16 v[96:111], a[16:19], v[240:243], v[16:31]
  buffer_load_dwordx4 v8, s[4:7], s49 offen offset:2048 lds
  v_cvt_pk_bf16_f32 v72, v50, v54
  v_cvt_pk_bf16_f32 v73, v58, v62
  v_cvt_pk_bf16_f32 v76, v51, v55
  v_cvt_pk_bf16_f32 v77, v59, v63
  v_max3_f32 v236, |v50|, |v54|, v236
  v_max3_f32 v236, |v58|, |v62|, v236
  v_max3_f32 v236, |v51|, |v55|, v236
  v_max3_f32 v236, |v59|, |v63|, v236
  s_nop 0
  s_waitcnt vmcnt(15)
  v_mfma_f32_32x32x16_bf16 v[96:111], a[20:23], v[244:247], v[96:111]
  buffer_load_dwordx4 v9, s[4:7], s49 offen offset:3072 lds
  v_cvt_pk_bf16_f32 v66, v216, v220
  v_cvt_pk_bf16_f32 v67, v224, v228
  v_cvt_pk_bf16_f32 v70, v217, v221
  v_cvt_pk_bf16_f32 v71, v225, v229
  v_max3_f32 v236, |v216|, |v220|, v236
  v_max3_f32 v236, |v224|, |v228|, v236
  v_max3_f32 v236, |v217|, |v221|, v236
  v_max3_f32 v236, |v225|, |v229|, v236
  ds_write_b128 v195, v[64:67]
  s_nop 0
  s_waitcnt vmcnt(15)
  v_mfma_f32_32x32x16_bf16 v[48:63], a[24:27], v[240:243], v[32:47]
  s_add_u32 m0, s15, 0
  s_nop 0
  buffer_load_dwordx4 v198, s[4:7], 0 offen lds
  ds_write_b128 v195, v[68:71] offset:6144
  v_cvt_pk_bf16_f32 v74, v218, v222
  v_cvt_pk_bf16_f32 v75, v226, v230
  v_cvt_pk_bf16_f32 v78, v219, v223
  v_cvt_pk_bf16_f32 v79, v227, v231
  v_max3_f32 v236, |v218|, |v222|, v236
  v_max3_f32 v236, |v226|, |v230|, v236
  v_max3_f32 v236, |v219|, |v223|, v236
  v_max3_f32 v236, |v227|, |v231|, v236
  s_waitcnt vmcnt(15)
  v_mfma_f32_32x32x16_bf16 v[48:63], a[28:31], v[244:247], v[48:63]
  s_add_u32 m0, s15, 0x400
  s_nop 0
  buffer_load_dwordx4 v199, s[4:7], 0 offen lds
  ds_write_b128 v195, v[72:75] offset:12288
  v_cvt_pk_bf16_f32 v80, v96, v100
  v_cvt_pk_bf16_f32 v81, v104, v108
  v_cvt_pk_bf16_f32 v84, v97, v101
  v_cvt_pk_bf16_f32 v85, v105, v109
  v_max3_f32 v236, |v96|, |v100|, v236
  v_max3_f32 v236, |v104|, |v108|, v236
  v_max3_f32 v236, |v97|, |v101|, v236
  v_max3_f32 v236, |v105|, |v109|, v236
  s_waitcnt vmcnt(15)
  v_mfma_f32_32x32x16_bf16 v[216:231], a[32:35], v[240:243], v[32:47]
  s_add_u32 m0, s15, 0x800
  s_nop 0
  buffer_load_dwordx4 v200, s[4:7], 0 offen lds
  ds_write_b128 v195, v[76:79] offset:18432
  v_cvt_pk_bf16_f32 v88, v98, v102
  v_cvt_pk_bf16_f32 v89, v106, v110
  v_cvt_pk_bf16_f32 v92, v99, v103
  v_cvt_pk_bf16_f32 v93, v107, v111
  v_max3_f32 v236, |v98|, |v102|, v236
  v_max3_f32 v236, |v106|, |v110|, v236
  v_max3_f32 v236, |v99|, |v103|, v236
  v_max3_f32 v236, |v107|, |v111|, v236
  s_waitcnt vmcnt(15)
  v_mfma_f32_32x32x16_bf16 v[216:231], a[36:39], v[244:247], v[216:231]
  s_add_u32 m0, s15, 0xc00
  s_nop 0
  buffer_load_dwordx4 v201, s[4:7], 0 offen lds
  ds_write_b64 v196, v[80:81]
  ds_write_b64 v196, v[84:85] offset:6144
  v_cvt_pk_bf16_f32 v64, v48, v52
  v_cvt_pk_bf16_f32 v65, v56, v60
  v_cvt_pk_bf16_f32 v68, v49, v53
  v_cvt_pk_bf16_f32 v69, v57, v61
  v_max3_f32 v232, |v48|, |v52|, |v56|
  v_max_f32_e64 v232, |v60|, v232
  v_max3_f32 v233, |v49|, |v53|, |v57|
  v_max_f32_e64 v233, |v61|, v233
  s_waitcnt vmcnt(15)
  v_mfma_f32_32x32x16_bf16 v[96:111], a[40:43], v[240:243], v[32:47]
  s_add_u32 m0, s14, 0x22000
  s_nop 0
  buffer_load_dwordx4 v254, s[72:75], s57 offen lds
  ds_write_b64 v196, v[88:89] offset:12288
  ds_write_b64 v196, v[92:93] offset:18432
  v_cvt_pk_bf16_f32 v72, v50, v54
  v_cvt_pk_bf16_f32 v73, v58, v62
  v_cvt_pk_bf16_f32 v76, v51, v55
  v_cvt_pk_bf16_f32 v77, v59, v63
  v_max3_f32 v234, |v50|, |v54|, |v58|
  v_max_f32_e64 v234, |v62|, v234
  v_max3_f32 v235, |v51|, |v55|, |v59|
  v_max_f32_e64 v235, |v63|, v235
  s_nop 0
  s_waitcnt vmcnt(15)
  v_mfma_f32_32x32x16_bf16 v[96:111], a[44:47], v[244:247], v[96:111]
  buffer_load_dwordx4 v255, s[72:75], s57 offen offset:1024 lds
  v_cvt_pk_bf16_f32 v66, v216, v220
  v_cvt_pk_bf16_f32 v67, v224, v228
  v_cvt_pk_bf16_f32 v70, v217, v221
  v_cvt_pk_bf16_f32 v71, v225, v229
  v_max3_f32 v232, |v216|, |v220|, v232
  v_max3_f32 v232, |v224|, |v228|, v232
  v_max3_f32 v233, |v217|, |v221|, v233
  v_max3_f32 v233, |v225|, |v229|, v233
  ds_write_b128 v197, v[64:67]
  s_nop 0
  s_waitcnt vmcnt(15)
  v_mfma_f32_32x32x16_bf16 v[48:63], a[48:51], v[240:243], v[32:47]
  buffer_load_dwordx4 v194, s[72:75], s57 offen offset:2048 lds
  ds_write_b128 v197, v[68:71] offset:6144
  v_cvt_pk_bf16_f32 v74, v218, v222
  v_cvt_pk_bf16_f32 v75, v226, v230
  v_cvt_pk_bf16_f32 v78, v219, v223
  v_cvt_pk_bf16_f32 v79, v227, v231
  v_max3_f32 v234, |v218|, |v222|, v234
  v_max3_f32 v234, |v226|, |v230|, v234
  v_max3_f32 v235, |v219|, |v223|, v235
  v_max3_f32 v235, |v227|, |v231|, v235
  s_waitcnt vmcnt(15)
  v_mfma_f32_32x32x16_bf16 v[48:63], a[52:55], v[244:247], v[48:63]
  s_add_u32 m0, s14, 0x22c00
  s_nop 0
  buffer_load_dwordx4 v254, s[72:75], s58 offen lds
  ds_write_b128 v197, v[72:75] offset:12288
  v_cvt_pk_bf16_f32 v80, v96, v100
  v_cvt_pk_bf16_f32 v81, v104, v108
  v_cvt_pk_bf16_f32 v84, v97, v101
  v_cvt_pk_bf16_f32 v85, v105, v109
  v_max3_f32 v232, |v96|, |v100|, v232
  v_max3_f32 v232, |v104|, |v108|, v232
  v_max3_f32 v233, |v97|, |v101|, v233
  v_max3_f32 v233, |v105|, |v109|, v233
  s_nop 0
  s_waitcnt vmcnt(15)
  v_mfma_f32_32x32x16_bf16 v[216:231], a[56:59], v[240:243], v[32:47]
  buffer_load_dwordx4 v255, s[72:75], s58 offen offset:1024 lds
  ds_write_b128 v197, v[76:79] offset:18432
  v_cvt_pk_bf16_f32 v88, v98, v102
  v_cvt_pk_bf16_f32 v89, v106, v110
  v_cvt_pk_bf16_f32 v92, v99, v103
  v_cvt_pk_bf16_f32 v93, v107, v111
  v_max3_f32 v234, |v98|, |v102|, v234
  v_max3_f32 v234, |v106|, |v110|, v234
  v_max3_f32 v235, |v99|, |v103|, v235
  v_max3_f32 v235, |v107|, |v111|, v235
  v_mfma_f32_32x32x16_bf16 v[96:111], a[88:91], v[240:243], v[32:47]
  s_nop 0
  s_waitcnt vmcnt(15)
  v_mfma_f32_32x32x16_bf16 v[216:231], a[60:63], v[244:247], v[216:231]
  buffer_load_dwordx4 v194, s[72:75], s58 offen offset:2048 lds
  v_cvt_pk_bf16_f32 v82, v48, v52
  v_cvt_pk_bf16_f32 v83, v56, v60
  v_cvt_pk_bf16_f32 v86, v49, v53
  v_cvt_pk_bf16_f32 v87, v57, v61
  v_max3_f32 v232, |v48|, |v52|, v232
  v_max3_f32 v232, |v56|, |v60|, v232
  v_max3_f32 v233, |v49|, |v53|, v233
  v_max3_f32 v233, |v57|, |v61|, v233
  ds_write_b128 v197, v[80:83] offset:1024
  v_mfma_f32_32x32x16_bf16 v[96:111], a[92:95], v[244:247], v[96:111]
  s_nop 0
  s_waitcnt vmcnt(15)
  v_mfma_f32_32x32x16_bf16 v[96:111], a[64:67], v[240:243], v[96:111]
  ds_write_b128 v197, v[84:87] offset:7168
  v_cvt_pk_bf16_f32 v90, v50, v54
  v_cvt_pk_bf16_f32 v91, v58, v62
  v_cvt_pk_bf16_f32 v94, v51, v55
  v_cvt_pk_bf16_f32 v95, v59, v63
  v_max3_f32 v234, |v50|, |v54|, v234
  v_max3_f32 v234, |v58|, |v62|, v234
  v_max3_f32 v235, |v51|, |v55|, v235
  v_max3_f32 v235, |v59|, |v63|, v235
  s_nop 0
  s_waitcnt vmcnt(14)
  v_mfma_f32_32x32x16_bf16 v[96:111], a[68:71], v[244:247], v[96:111]
  ds_write_b128 v197, v[88:91] offset:13312
  v_cvt_pk_bf16_f32 v64, v216, v220
  v_cvt_pk_bf16_f32 v65, v224, v228
  v_cvt_pk_bf16_f32 v68, v217, v221
  v_cvt_pk_bf16_f32 v69, v225, v229
  v_max3_f32 v232, |v216|, |v220|, v232
  v_max3_f32 v232, |v224|, |v228|, v232
  v_max3_f32 v233, |v217|, |v221|, v233
  v_max3_f32 v233, |v225|, |v229|, v233
  ds_write_b128 v197, v[92:95] offset:19456
  v_cvt_pk_bf16_f32 v72, v218, v222
  v_cvt_pk_bf16_f32 v73, v226, v230
  v_cvt_pk_bf16_f32 v76, v219, v223
  v_cvt_pk_bf16_f32 v77, v227, v231
  v_max3_f32 v234, |v218|, |v222|, v234
  v_max3_f32 v234, |v226|, |v230|, v234
  v_max3_f32 v235, |v219|, |v223|, v235
  v_max3_f32 v235, |v227|, |v231|, v235
  v_cvt_pk_bf16_f32 v66, v96, v100
  v_cvt_pk_bf16_f32 v67, v104, v108
  v_cvt_pk_bf16_f32 v70, v97, v101
  v_cvt_pk_bf16_f32 v71, v105, v109
  v_max3_f32 v232, |v96|, |v100|, v232
  v_max3_f32 v232, |v104|, |v108|, v232
  v_max3_f32 v233, |v97|, |v101|, v233
  v_max3_f32 v233, |v105|, |v109|, v233
  ds_write_b128 v197, v[64:67] offset:2048
  ds_write_b128 v197, v[68:71] offset:8192
  v_cvt_pk_bf16_f32 v74, v98, v102
  v_cvt_pk_bf16_f32 v75, v106, v110
  v_cvt_pk_bf16_f32 v78, v99, v103
  v_cvt_pk_bf16_f32 v79, v107, v111
  v_max3_f32 v234, |v98|, |v102|, v234
  v_max3_f32 v234, |v106|, |v110|, v234
  v_max3_f32 v235, |v99|, |v103|, v235
  v_max3_f32 v235, |v107|, |v111|, v235
  ds_write_b128 v197, v[72:75] offset:14336
  ds_write_b128 v197, v[76:79] offset:20480
  s_waitcnt lgkmcnt(0)
  s_barrier
  v_max3_f32 v236, v236, v232, v233
  v_min3_f32 v232, v232, v233, v234
  v_max3_f32 v236, v236, v234, v235
  v_min_f32_e64 v232, v232, v235
  v_cmp_le_u32 vcc, 0x43800000, v236
  s_nop 0
  s_cmp_lg_u64 vcc, 0
  s_cselect_b32 s3, 1, 0
  v_cmp_gt_u32 vcc, 0x3a000000, v232
  s_nop 0
  s_cmp_lg_u64 vcc, 0
  s_cselect_b32 s3, 1, s3
  ds_read_b128 a[0:3], v0 offset:24576
  ds_read_b128 a[4:7], v0 offset:25600
  ds_read_b128 a[8:11], v0 offset:26624
  ds_read_b128 a[12:15], v0 offset:27648
  ds_read_b128 a[16:19], v0 offset:28672
  ds_read_b128 a[20:23], v0 offset:29696
  ds_read_b128 a[24:27], v0 offset:30720
  ds_read_b128 a[28:31], v0 offset:31744
  ds_read_b128 a[32:35], v0 offset:32768
  ds_read_b128 a[36:39], v0 offset:33792
  ds_read_b128 a[40:43], v0 offset:34816
  ds_read_b128 a[44:47], v0 offset:35840
  ds_read_b128 a[48:51], v0 offset:36864
  ds_read_b128 a[52:55], v0 offset:37888
  ds_read_b128 a[56:59], v0 offset:38912
  ds_read_b128 a[60:63], v0 offset:39936
  ds_read_b128 a[64:67], v0 offset:40960
  ds_read_b128 a[68:71], v0 offset:41984
  ds_read_b128 a[72:75], v0 offset:43008
  ds_read_b128 a[76:79], v0 offset:44032
  ds_read_b128 a[80:83], v0 offset:45056
  ds_read_b128 a[84:87], v0 offset:46080
  ds_read_b128 a[88:91], v0 offset:47104
  ds_read_b128 a[92:95], v0 offset:48128
  s_nop 0
  s_waitcnt vmcnt(6)
  ds_read_b128 v[216:219], v4
  ds_read_b128 v[220:223], v4 offset:16
  ds_read_b128 v[224:227], v4 offset:192
  ds_read_b128 v[228:231], v4 offset:208
  ds_read_b128 v[232:235], v4 offset:384
  ds_read_b128 v[236:239], v4 offset:400
  ds_read_b128 v[160:163], v4 offset:32
  ds_read_b128 v[164:167], v4 offset:48
  ds_read_b128 v[168:171], v4 offset:224
  ds_read_b128 v[172:175], v4 offset:240
  ds_read_b128 v[176:179], v4 offset:416
  s_waitcnt lgkmcnt(10)
  v_mfma_f32_16x16x32_bf16 v[112:115], a[96:99], v[216:219], 0
  s_waitcnt lgkmcnt(9)
  ds_read_b128 v[180:183], v4 offset:432
  v_mfma_f32_16x16x32_bf16 v[116:119], a[108:111], v[220:223], 0
  s_waitcnt lgkmcnt(9)
  ds_read_b128 v[216:219], v4 offset:64
  v_mfma_f32_16x16x32_bf16 v[112:115], a[100:103], v[224:227], v[112:115]
  s_waitcnt lgkmcnt(9)
  ds_read_b128 v[220:223], v4 offset:80
  v_mfma_f32_16x16x32_bf16 v[116:119], a[112:115], v[228:231], v[116:119]
  s_waitcnt lgkmcnt(9)
  ds_read_b128 v[224:227], v4 offset:256
  v_mfma_f32_16x16x32_bf16 v[112:115], a[104:107], v[232:235], v[112:115]
  s_waitcnt lgkmcnt(9)
  ds_read_b128 v[228:231], v4 offset:272
  v_mfma_f32_16x16x32_bf16 v[116:119], a[116:119], v[236:239], v[116:119]
  s_waitcnt lgkmcnt(9)
  ds_read_b128 v[232:235], v4 offset:448
  v_mfma_f32_16x16x32_bf16 v[120:123], a[120:123], v[160:163], 0
  s_waitcnt lgkmcnt(9)
  ds_read_b128 v[236:239], v4 offset:464
  v_mfma_f32_16x16x32_bf16 v[124:127], a[132:135], v[164:167], 0
  s_waitcnt lgkmcnt(9)
  ds_read_b128 v[160:163], v4 offset:96
  v_mfma_f32_16x16x32_bf16 v[120:123], a[124:127], v[168:171], v[120:123]
  s_waitcnt lgkmcnt(9)
  ds_read_b128 v[164:167], v4 offset:112
  v_mfma_f32_16x16x32_bf16 v[124:127], a[136:139], v[172:175], v[124:127]
  s_waitcnt lgkmcnt(9)
  ds_read_b128 v[168:171], v4 offset:288
  v_mfma_f32_16x16x32_bf16 v[120:123], a[128:131], v[176:179], v[120:123]
  s_waitcnt lgkmcnt(9)
  ds_read_b128 v[172:175], v4 offset:304
  v_mfma_f32_16x16x32_bf16 v[124:127], a[140:143], v[180:183], v[124:127]
  s_waitcnt lgkmcnt(9)
  ds_read_b128 v[176:179], v4 offset:480
  v_mfma_f32_16x16x32_bf16 v[128:131], a[144:147], v[216:219], 0
  s_waitcnt lgkmcnt(9)
  ds_read_b128 v[180:183], v4 offset:496
  v_mfma_f32_16x16x32_bf16 v[132:135], a[156:159], v[220:223], 0
  s_waitcnt lgkmcnt(9)
  ds_read_b128 v[216:219], v4 offset:128
  v_mfma_f32_16x16x32_bf16 v[128:131], a[148:151], v[224:227], v[128:131]
  s_waitcnt lgkmcnt(9)
  ds_read_b128 v[220:223], v4 offset:144
  v_mfma_f32_16x16x32_bf16 v[132:135], a[160:163], v[228:231], v[132:135]
  s_waitcnt lgkmcnt(9)
  ds_read_b128 v[224:227], v4 offset:320
  v_mfma_f32_16x16x32_bf16 v[128:131], a[152:155], v[232:235], v[128:131]
  s_waitcnt lgkmcnt(9)
  ds_read_b128 v[228:231], v4 offset:336
  v_mfma_f32_16x16x32_bf16 v[132:135], a[164:167], v[236:239], v[132:135]
  s_waitcnt lgkmcnt(9)
  ds_read_b128 v[232:235], v4 offset:512
  v_mfma_f32_16x16x32_bf16 v[136:139], a[240:243], v[160:163], 0
  s_waitcnt lgkmcnt(9)
  ds_read_b128 v[236:239], v4 offset:528
  v_mfma_f32_16x16x32_bf16 v[140:143], a[168:171], v[164:167], 0
  s_waitcnt lgkmcnt(9)
  ds_read_b128 v[160:163], v4 offset:160
  v_mfma_f32_16x16x32_bf16 v[136:139], a[244:247], v[168:171], v[136:139]
  s_waitcnt lgkmcnt(9)
  ds_read_b128 v[164:167], v4 offset:176
  v_mfma_f32_16x16x32_bf16 v[140:143], a[172:175], v[172:175], v[140:143]
  s_waitcnt lgkmcnt(9)
  ds_read_b128 v[168:171], v4 offset:352
  v_mfma_f32_16x16x32_bf16 v[136:139], a[248:251], v[176:179], v[136:139]
  s_waitcnt lgkmcnt(9)
  ds_read_b128 v[172:175], v4 offset:368
  v_mfma_f32_16x16x32_bf16 v[140:143], a[176:179], v[180:183], v[140:143]
  s_waitcnt lgkmcnt(9)
  ds_read_b128 v[176:179], v4 offset:544
  v_mfma_f32_16x16x32_bf16 v[144:147], a[252:255], v[216:219], 0
  s_waitcnt lgkmcnt(9)
  ds_read_b128 v[180:183], v4 offset:560
  v_mfma_f32_16x16x32_bf16 v[148:151], a[188:191], v[220:223], 0
  s_waitcnt lgkmcnt(9)
  v_mfma_f32_16x16x32_bf16 v[144:147], a[180:183], v[224:227], v[144:147]
  s_waitcnt lgkmcnt(8)
  v_mfma_f32_16x16x32_bf16 v[148:151], a[216:219], v[228:231], v[148:151]
  s_waitcnt lgkmcnt(7)
  v_mfma_f32_16x16x32_bf16 v[144:147], a[184:187], v[232:235], v[144:147]
  s_waitcnt lgkmcnt(6)
  v_mfma_f32_16x16x32_bf16 v[148:151], a[220:223], v[236:239], v[148:151]
  s_waitcnt lgkmcnt(5)
  v_mfma_f32_16x16x32_bf16 v[152:155], a[224:227], v[160:163], 0
  s_waitcnt lgkmcnt(4)
  v_mfma_f32_16x16x32_bf16 v[156:159], a[236:239], v[164:167], 0
  s_waitcnt lgkmcnt(3)
  v_mfma_f32_16x16x32_bf16 v[152:155], a[228:231], v[168:171], v[152:155]
  s_waitcnt lgkmcnt(2)
  v_mfma_f32_16x16x32_bf16 v[156:159], v[208:211], v[172:175], v[156:159]
  s_waitcnt lgkmcnt(1)
  v_mfma_f32_16x16x32_bf16 v[152:155], a[232:235], v[176:179], v[152:155]
  s_waitcnt lgkmcnt(0)
  v_mfma_f32_16x16x32_bf16 v[156:159], v[212:215], v[180:183], v[156:159]
  buffer_load_dword v249, v248, s[4:7], s29 offen
  v_pk_add_f32 v[12:13], v[112:113], v[114:115]
  v_pk_mul_f32 v[14:15], v[112:113], v[112:113]
  v_pk_fma_f32 v[14:15], v[114:115], v[114:115], v[14:15]
  v_pk_add_f32 v[12:13], v[12:13], v[116:117]
  v_pk_fma_f32 v[14:15], v[116:117], v[116:117], v[14:15]
  v_pk_add_f32 v[12:13], v[12:13], v[118:119]
  v_pk_fma_f32 v[14:15], v[118:119], v[118:119], v[14:15]
  v_pk_add_f32 v[12:13], v[12:13], v[120:121]
  v_pk_fma_f32 v[14:15], v[120:121], v[120:121], v[14:15]
  v_pk_add_f32 v[12:13], v[12:13], v[122:123]
  v_pk_fma_f32 v[14:15], v[122:123], v[122:123], v[14:15]
  v_pk_add_f32 v[12:13], v[12:13], v[124:125]
  ds_read_b128 v[216:219], v0 offset:18432
  ds_read_b128 v[220:223], v0 offset:19456
  ds_read_b128 v[224:227], v0 offset:20480
  ds_read_b128 v[228:231], v0 offset:21504
  v_pk_fma_f32 v[14:15], v[124:125], v[124:125], v[14:15]
  v_pk_add_f32 v[12:13], v[12:13], v[126:127]
  v_pk_fma_f32 v[14:15], v[126:127], v[126:127], v[14:15]
  v_pk_add_f32 v[12:13], v[12:13], v[128:129]
  v_pk_fma_f32 v[14:15], v[128:129], v[128:129], v[14:15]
  v_pk_add_f32 v[12:13], v[12:13], v[130:131]
  v_pk_fma_f32 v[14:15], v[130:131], v[130:131], v[14:15]
  v_pk_add_f32 v[12:13], v[12:13], v[132:133]
  v_pk_fma_f32 v[14:15], v[132:133], v[132:133], v[14:15]
  v_pk_add_f32 v[12:13], v[12:13], v[134:135]
  v_pk_fma_f32 v[14:15], v[134:135], v[134:135], v[14:15]
  v_pk_add_f32 v[12:13], v[12:13], v[136:137]
  ds_read_b128 v[232:235], v0 offset:22528
  ds_read_b128 v[236:239], v0 offset:23552
  ds_read_b128 a[96:99], v0 offset:49152
  ds_read_b128 a[100:103], v0 offset:50176
  v_pk_fma_f32 v[14:15], v[136:137], v[136:137], v[14:15]
  v_pk_add_f32 v[12:13], v[12:13], v[138:139]
  v_pk_fma_f32 v[14:15], v[138:139], v[138:139], v[14:15]
  v_pk_add_f32 v[12:13], v[12:13], v[140:141]
  v_pk_fma_f32 v[14:15], v[140:141], v[140:141], v[14:15]
  v_pk_add_f32 v[12:13], v[12:13], v[142:143]
  v_pk_fma_f32 v[14:15], v[142:143], v[142:143], v[14:15]
  v_pk_add_f32 v[12:13], v[12:13], v[144:145]
  v_pk_fma_f32 v[14:15], v[144:145], v[144:145], v[14:15]
  v_pk_add_f32 v[12:13], v[12:13], v[146:147]
  v_pk_fma_f32 v[14:15], v[146:147], v[146:147], v[14:15]
  v_pk_add_f32 v[12:13], v[12:13], v[148:149]
  ds_read_b128 a[104:107], v0 offset:51200
  ds_read_b128 a[108:111], v0 offset:52224
  ds_read_b128 a[112:115], v0 offset:53248
  ds_read_b128 a[116:119], v0 offset:54272
  v_pk_fma_f32 v[14:15], v[148:149], v[148:149], v[14:15]
  v_pk_add_f32 v[12:13], v[12:13], v[150:151]
  v_pk_fma_f32 v[14:15], v[150:151], v[150:151], v[14:15]
  v_pk_add_f32 v[12:13], v[12:13], v[152:153]
  v_pk_fma_f32 v[14:15], v[152:153], v[152:153], v[14:15]
  v_pk_add_f32 v[12:13], v[12:13], v[154:155]
  v_pk_fma_f32 v[14:15], v[154:155], v[154:155], v[14:15]
  v_pk_add_f32 v[12:13], v[12:13], v[156:157]
  v_pk_fma_f32 v[14:15], v[156:157], v[156:157], v[14:15]
  v_pk_add_f32 v[12:13], v[12:13], v[158:159]
  v_pk_fma_f32 v[14:15], v[158:159], v[158:159], v[14:15]
  v_add_f32_e64 v12, v12, v13
  ds_read_b128 a[120:123], v0 offset:55296
  ds_read_b128 a[124:127], v0 offset:56320
  ds_read_b128 a[128:131], v0 offset:57344
  ds_read_b128 a[132:135], v0 offset:58368
  v_add_f32 v14, v14, v15
  s_nop 1
  v_permlane32_swap_b32 v12, v14
  v_add_f32 v12, v12, v14
  v_mov_b32 v14, v12
  s_nop 1
  v_permlane32_swap_b32 v12, v14
  v_mul_f32 v12, s24, v12
  v_mul_f32_e64 v13, s24, v14
  v_fma_f32 v13, -v12, v12, v13
  v_max_f32 v13, 0, v13
  v_add_f32 v13, s25, v13
  v_rsq_f32 v13, v13
  s_nop 0
  v_mul_f32_e64 v14, s22, v13
  ds_read_b128 a[136:139], v0 offset:59392
  ds_read_b128 a[140:143], v0 offset:60416
  ds_read_b128 a[144:147], v0 offset:61440
  ds_read_b128 a[148:151], v0 offset:62464
  v_mul_f32_e64 v12, -v12, v14
  v_pk_fma_f32 v[112:113], v[112:113], v[14:15], v[12:13] op_sel_hi:[1,0,0]
  v_pk_fma_f32 v[114:115], v[114:115], v[14:15], v[12:13] op_sel_hi:[1,0,0]
  v_pk_fma_f32 v[116:117], v[116:117], v[14:15], v[12:13] op_sel_hi:[1,0,0]
  v_pk_fma_f32 v[118:119], v[118:119], v[14:15], v[12:13] op_sel_hi:[1,0,0]
  v_pk_fma_f32 v[120:121], v[120:121], v[14:15], v[12:13] op_sel_hi:[1,0,0]
  v_pk_fma_f32 v[122:123], v[122:123], v[14:15], v[12:13] op_sel_hi:[1,0,0]
  v_pk_fma_f32 v[124:125], v[124:125], v[14:15], v[12:13] op_sel_hi:[1,0,0]
  v_pk_fma_f32 v[126:127], v[126:127], v[14:15], v[12:13] op_sel_hi:[1,0,0]
  v_pk_fma_f32 v[128:129], v[128:129], v[14:15], v[12:13] op_sel_hi:[1,0,0]
  v_pk_fma_f32 v[130:131], v[130:131], v[14:15], v[12:13] op_sel_hi:[1,0,0]
  v_pk_fma_f32 v[132:133], v[132:133], v[14:15], v[12:13] op_sel_hi:[1,0,0]
  ds_read_b128 a[152:155], v0 offset:63488
  ds_read_b128 a[156:159], v0 offset:64512
  ds_read_b128 a[160:163], v1
  ds_read_b128 a[164:167], v1 offset:1024
  v_pk_fma_f32 v[134:135], v[134:135], v[14:15], v[12:13] op_sel_hi:[1,0,0]
  v_pk_fma_f32 v[136:137], v[136:137], v[14:15], v[12:13] op_sel_hi:[1,0,0]
  v_pk_fma_f32 v[138:139], v[138:139], v[14:15], v[12:13] op_sel_hi:[1,0,0]
  v_pk_fma_f32 v[140:141], v[140:141], v[14:15], v[12:13] op_sel_hi:[1,0,0]
  v_pk_fma_f32 v[142:143], v[142:143], v[14:15], v[12:13] op_sel_hi:[1,0,0]
  v_pk_fma_f32 v[144:145], v[144:145], v[14:15], v[12:13] op_sel_hi:[1,0,0]
  v_pk_fma_f32 v[146:147], v[146:147], v[14:15], v[12:13] op_sel_hi:[1,0,0]
  v_pk_fma_f32 v[148:149], v[148:149], v[14:15], v[12:13] op_sel_hi:[1,0,0]
  v_pk_fma_f32 v[150:151], v[150:151], v[14:15], v[12:13] op_sel_hi:[1,0,0]
  v_pk_fma_f32 v[152:153], v[152:153], v[14:15], v[12:13] op_sel_hi:[1,0,0]
  v_pk_fma_f32 v[154:155], v[154:155], v[14:15], v[12:13] op_sel_hi:[1,0,0]
  v_pk_fma_f32 v[156:157], v[156:157], v[14:15], v[12:13] op_sel_hi:[1,0,0]
  ds_read_b128 a[168:171], v1 offset:2048
  ds_read_b128 a[172:175], v1 offset:3072
  ds_read_b128 a[176:179], v1 offset:4096
  ds_read_b128 a[180:183], v1 offset:5120
  v_pk_fma_f32 v[158:159], v[158:159], v[14:15], v[12:13] op_sel_hi:[1,0,0]
  v_cndmask_b32 v159, v159, v250, s[12:13]
  v_cvt_pk_bf16_f32 v160, v112, v113
  v_cvt_pk_bf16_f32 v161, v114, v115
  v_cvt_pk_bf16_f32 v162, v116, v117
  v_cvt_pk_bf16_f32 v163, v118, v119
  v_cvt_pk_bf16_f32 v164, v120, v121
  v_cvt_pk_bf16_f32 v165, v122, v123
  v_cvt_pk_bf16_f32 v166, v124, v125
  v_cvt_pk_bf16_f32 v167, v126, v127
  v_cvt_pk_bf16_f32 v168, v128, v129
  v_cvt_pk_bf16_f32 v169, v130, v131
  ds_read_b128 a[184:187], v1 offset:6144
  ds_read_b128 a[188:191], v1 offset:7168
  v_cvt_pk_bf16_f32 v170, v132, v133
  v_cvt_pk_bf16_f32 v171, v134, v135
  v_cvt_pk_bf16_f32 v172, v136, v137
  v_cvt_pk_bf16_f32 v173, v138, v139
  v_cvt_pk_bf16_f32 v174, v140, v141
  v_cvt_pk_bf16_f32 v175, v142, v143
  v_cvt_pk_bf16_f32 v176, v144, v145
  v_cvt_pk_bf16_f32 v177, v146, v147
  v_cvt_pk_bf16_f32 v178, v148, v149
  v_cvt_pk_bf16_f32 v179, v150, v151
  v_cvt_pk_bf16_f32 v180, v152, v153
  v_cvt_pk_bf16_f32 v181, v154, v155
  v_cvt_pk_bf16_f32 v182, v156, v157
  v_cvt_pk_bf16_f32 v183, v158, v159
  s_nop 0
  s_waitcnt lgkmcnt(15)
  v_mfma_f32_32x32x16_bf16 v[16:31], v[216:219], v[160:163], 0
  ds_read_b128 v[136:139], v5
  ds_read_b128 v[140:143], v5 offset:32
  ds_read_b128 v[144:147], v5 offset:64
  v_mfma_f32_32x32x16_bf16 v[16:31], v[220:223], v[164:167], v[16:31]
  ds_read_b128 v[148:151], v5 offset:96
  ds_read_b128 v[152:155], v5 offset:128
  ds_read_b128 v[156:159], v5 offset:160
  v_mfma_f32_32x32x16_bf16 v[16:31], v[224:227], v[168:171], v[16:31]
  s_nop 0
  s_waitcnt vmcnt(1)
  ds_read_b128 a[216:219], v251 offset:49152
  ds_read_b128 a[220:223], v252 offset:49152
  v_mfma_f32_32x32x16_bf16 v[16:31], v[228:231], v[172:175], v[16:31]
  ds_read_b128 a[224:227], v251 offset:49216
  ds_read_b128 a[228:231], v252 offset:49216
  ds_read_b128 a[232:235], v251 offset:49280
  v_mfma_f32_32x32x16_bf16 v[16:31], v[232:235], v[176:179], v[16:31]
  ds_read_b128 a[236:239], v252 offset:49280
  v_mfma_f32_32x32x16_bf16 v[16:31], v[236:239], v[180:183], v[16:31]
  s_waitcnt lgkmcnt(5)
  v_mfma_f32_32x32x16_bf16 v[64:79], a[216:219], a[192:195], 0
  s_mov_b32 m0, s30
  s_waitcnt lgkmcnt(4)
  v_mfma_f32_32x32x16_bf16 v[64:79], a[220:223], a[196:199], v[64:79]
  buffer_load_dwordx4 v6, s[4:7], s29 offen lds
  s_nop 5
  v_cvt_pk_f16_f32 v48, v16, v17
  v_cvt_pk_f16_f32 v49, v18, v19
  v_cvt_pk_f16_f32 v50, v20, v21
  v_cvt_pk_f16_f32 v51, v22, v23
  v_cvt_pk_f16_f32 v52, v24, v25
  v_cvt_pk_f16_f32 v53, v26, v27
  v_cvt_pk_f16_f32 v54, v28, v29
  s_nop 0
  s_waitcnt lgkmcnt(3)
  v_mfma_f32_32x32x16_bf16 v[80:95], a[224:227], a[200:203], 0
  buffer_load_dwordx4 v7, s[4:7], s29 offen offset:1024 lds
  v_cvt_pk_f16_f32 v55, v30, v31
  v_pk_fma_f16 v56, v48, v48, s23 op_sel_hi:[1,1,0]
  v_pk_fma_f16 v57, v49, v49, s23 op_sel_hi:[1,1,0]
  v_pk_fma_f16 v58, v50, v50, s23 op_sel_hi:[1,1,0]
  v_pk_fma_f16 v59, v51, v51, s23 op_sel_hi:[1,1,0]
  v_pk_fma_f16 v184, v56, s20, s20 op_sel:[0,1,0] op_sel_hi:[1,1,0]
  v_pk_fma_f16 v185, v57, s20, s20 op_sel:[0,1,0] op_sel_hi:[1,1,0]
  s_nop 0
  s_waitcnt lgkmcnt(2)
  v_mfma_f32_32x32x16_bf16 v[80:95], a[228:231], a[204:207], v[80:95]
  buffer_load_dwordx4 v8, s[4:7], s29 offen offset:2048 lds
  v_cvt_pk_f16_f32 v112, v64, v65
  v_cvt_pk_f16_f32 v113, v66, v67
  v_pk_fma_f16 v186, v58, s20, s20 op_sel:[0,1,0] op_sel_hi:[1,1,0]
  v_cvt_pk_f16_f32 v114, v68, v69
  v_pk_fma_f16 v187, v59, s20, s20 op_sel:[0,1,0] op_sel_hi:[1,1,0]
  v_cvt_pk_f16_f32 v115, v70, v71
  v_pk_fma_f16 v184, v184, v56, s21 op_sel:[0,0,1]
  s_nop 0
  s_waitcnt lgkmcnt(1)
  v_mfma_f32_32x32x16_bf16 v[96:111], a[232:235], a[208:211], 0
  buffer_load_dwordx4 v9, s[4:7], s29 offen offset:3072 lds
  ds_write_b128 v253, v[112:115] offset:49152
  v_cvt_pk_f16_f32 v116, v72, v73
  v_cvt_pk_f16_f32 v117, v74, v75
  v_cvt_pk_f16_f32 v118, v76, v77
  v_cvt_pk_f16_f32 v119, v78, v79
  v_pk_fma_f16 v185, v185, v57, s21 op_sel:[0,0,1]
  s_nop 0
  s_waitcnt lgkmcnt(1)
  v_mfma_f32_32x32x16_bf16 v[96:111], a[236:239], a[212:215], v[96:111]
  ds_write_b128 v253, v[116:119] offset:52224
  v_cvt_pk_f16_f32 v120, v80, v81
  v_cvt_pk_f16_f32 v121, v82, v83
  v_cvt_pk_f16_f32 v122, v84, v85
  v_cvt_pk_f16_f32 v123, v86, v87
  ds_write_b128 v253, v[120:123] offset:50176
  v_cvt_pk_f16_f32 v124, v88, v89
  v_cvt_pk_f16_f32 v125, v90, v91
  v_cvt_pk_f16_f32 v126, v92, v93
  v_cvt_pk_f16_f32 v127, v94, v95
  ds_write_b128 v253, v[124:127] offset:53248
  s_nop 0
  s_nop 0
  v_cvt_pk_f16_f32 v128, v96, v97
  v_cvt_pk_f16_f32 v129, v98, v99
  v_cvt_pk_f16_f32 v130, v100, v101
  v_cvt_pk_f16_f32 v131, v102, v103
  ds_write_b128 v253, v[128:131] offset:51200
  v_cvt_pk_f16_f32 v132, v104, v105
  v_cvt_pk_f16_f32 v133, v106, v107
  v_cvt_pk_f16_f32 v134, v108, v109
  v_cvt_pk_f16_f32 v135, v110, v111
  ds_write_b128 v253, v[132:135] offset:54272
  s_waitcnt lgkmcnt(0)
  s_barrier
  v_mfma_f32_32x32x16_bf16 v[16:31], a[0:3], v[160:163], 0
  ds_read_b128 v[64:67], v2
  ds_read_b128 v[68:71], v2 offset:32
  ds_read_b128 v[72:75], v2 offset:64
  s_add_u32 m0, s14, 0x16000
  v_pk_fma_f16 v186, v186, v58, s21 op_sel:[0,0,1]
  v_pk_fma_f16 v187, v187, v59, s21 op_sel:[0,0,1]
  v_pk_fma_f16 v184, v184, v56, s21 op_sel_hi:[1,1,0]
  v_pk_fma_f16 v185, v185, v57, s21 op_sel_hi:[1,1,0]
  v_pk_fma_f16 v186, v186, v58, s21 op_sel_hi:[1,1,0]
  v_mfma_f32_32x32x16_bf16 v[16:31], a[4:7], v[164:167], v[16:31]
  ds_read_b128 v[76:79], v2 offset:96
  ds_read_b128 v[80:83], v2 offset:128
  ds_read_b128 v[84:87], v2 offset:160
  buffer_load_dwordx4 v254, s[72:75], s53 offen lds
  v_pk_fma_f16 v187, v187, v59, s21 op_sel_hi:[1,1,0]
  v_pk_fma_f16 v184, v184, v56, s23 op_sel:[0,0,1]
  v_pk_fma_f16 v185, v185, v57, s23 op_sel:[0,0,1]
  v_pk_fma_f16 v186, v186, v58, s23 op_sel:[0,0,1]
  v_pk_fma_f16 v187, v187, v59, s23 op_sel:[0,0,1]
  v_mfma_f32_32x32x16_bf16 v[16:31], a[8:11], v[168:171], v[16:31]
  ds_read_b128 v[88:91], v2 offset:192
  ds_read_b128 v[92:95], v2 offset:224
  ds_read_b128 v[96:99], v2 offset:256
  buffer_load_dwordx4 v255, s[72:75], s53 offen offset:1024 lds
  v_pk_fma_f16 v184, v184, v48, 0.5 op_sel_hi:[1,1,0] clamp
  v_pk_fma_f16 v185, v185, v49, 0.5 op_sel_hi:[1,1,0] clamp
  v_pk_fma_f16 v186, v186, v50, 0.5 op_sel_hi:[1,1,0] clamp
  v_pk_fma_f16 v187, v187, v51, 0.5 op_sel_hi:[1,1,0] clamp
  v_pk_mul_f16 v184, v184, v48
  v_mfma_f32_32x32x16_bf16 v[16:31], a[12:15], v[172:175], v[16:31]
  ds_read_b128 v[100:103], v2 offset:288
  ds_read_b128 v[104:107], v2 offset:320
  ds_read_b128 v[108:111], v2 offset:352
  v_pk_mul_f16 v185, v185, v49
  v_pk_mul_f16 v186, v186, v50
  v_pk_mul_f16 v187, v187, v51
  v_pk_fma_f16 v56, v52, v52, s23 op_sel_hi:[1,1,0]
  v_pk_fma_f16 v57, v53, v53, s23 op_sel_hi:[1,1,0]
  v_pk_fma_f16 v58, v54, v54, s23 op_sel_hi:[1,1,0]
  v_mfma_f32_32x32x16_bf16 v[16:31], a[16:19], v[176:179], v[16:31]
  buffer_load_dwordx4 v194, s[72:75], s53 offen offset:2048 lds
  s_add_u32 m0, s14, 0x16c00
  v_pk_fma_f16 v59, v55, v55, s23 op_sel_hi:[1,1,0]
  v_pk_fma_f16 v188, v56, s20, s20 op_sel:[0,1,0] op_sel_hi:[1,1,0]
  v_pk_fma_f16 v189, v57, s20, s20 op_sel:[0,1,0] op_sel_hi:[1,1,0]
  v_pk_fma_f16 v190, v58, s20, s20 op_sel:[0,1,0] op_sel_hi:[1,1,0]
  v_pk_fma_f16 v191, v59, s20, s20 op_sel:[0,1,0] op_sel_hi:[1,1,0]
  v_pk_fma_f16 v188, v188, v56, s21 op_sel:[0,0,1]
  v_pk_fma_f16 v189, v189, v57, s21 op_sel:[0,0,1]
  v_mfma_f32_32x32x16_bf16 v[16:31], a[20:23], v[180:183], v[16:31]
  s_nop 0
  s_waitcnt lgkmcnt(0)
  buffer_load_dwordx4 v254, s[72:75], s54 offen lds
  v_pk_fma_f16 v190, v190, v58, s21 op_sel:[0,0,1]
  v_pk_fma_f16 v191, v191, v59, s21 op_sel:[0,0,1]
  v_pk_fma_f16 v188, v188, v56, s21 op_sel_hi:[1,1,0]
  v_pk_fma_f16 v189, v189, v57, s21 op_sel_hi:[1,1,0]
  v_pk_fma_f16 v190, v190, v58, s21 op_sel_hi:[1,1,0]
  v_pk_fma_f16 v191, v191, v59, s21 op_sel_hi:[1,1,0]
  v_pk_fma_f16 v188, v188, v56, s23 op_sel:[0,0,1]
  v_pk_fma_f16 v189, v189, v57, s23 op_sel:[0,0,1]
  v_mfma_f32_32x32x16_bf16 v[64:79], v[240:243], v[136:139], v[64:79]
  v_pk_fma_f16 v190, v190, v58, s23 op_sel:[0,0,1]
  v_pk_fma_f16 v191, v191, v59, s23 op_sel:[0,0,1]
  v_pk_fma_f16 v188, v188, v52, 0.5 op_sel_hi:[1,1,0] clamp
  v_pk_fma_f16 v189, v189, v53, 0.5 op_sel_hi:[1,1,0] clamp
  v_pk_fma_f16 v190, v190, v54, 0.5 op_sel_hi:[1,1,0] clamp
  v_pk_fma_f16 v191, v191, v55, 0.5 op_sel_hi:[1,1,0] clamp
  v_pk_mul_f16 v188, v188, v52
  v_pk_mul_f16 v189, v189, v53
  v_pk_mul_f16 v190, v190, v54
  v_pk_mul_f16 v191, v191, v55
  v_mov_b32_e64 v15, v194
  v_mfma_f32_32x32x16_bf16 v[64:79], v[244:247], v[140:143], v[64:79]
  buffer_load_dwordx4 v255, s[72:75], s54 offen offset:1024 lds
  v_cvt_pk_f16_f32 v48, v16, v17
  v_cvt_pk_f16_f32 v49, v18, v19
  v_cvt_pk_f16_f32 v50, v20, v21
  v_cvt_pk_f16_f32 v51, v22, v23
  v_cvt_pk_f16_f32 v52, v24, v25
  v_mfma_f32_32x32x16_bf16 v[80:95], v[240:243], v[144:147], v[80:95]
  buffer_load_dwordx4 v194, s[72:75], s54 offen offset:2048 lds
  v_or_b32_e64 v12, v112, v113
  v_or3_b32 v12, v114, v115, v12
  v_or3_b32 v12, v116, v117, v12
  v_or3_b32 v12, v118, v119, v12
  v_cvt_pk_f16_f32 v53, v26, v27
  v_mfma_f32_32x32x16_bf16 v[80:95], v[244:247], v[148:151], v[80:95]
  ds_read_b128 v[192:195], v1 offset:8192
  ds_read_b128 v[196:199], v1 offset:9216
  v_or3_b32 v12, v120, v121, v12
  v_or3_b32 v12, v122, v123, v12
  v_or3_b32 v12, v124, v125, v12
  v_or3_b32 v12, v126, v127, v12
  v_mfma_f32_32x32x16_bf16 v[96:111], v[240:243], v[152:155], v[96:111]
  ds_read_b128 v[200:203], v1 offset:10240
  ds_read_b128 v[204:207], v1 offset:11264
  v_or3_b32 v12, v128, v129, v12
  v_or3_b32 v12, v130, v131, v12
  v_or3_b32 v12, v132, v133, v12
  v_or3_b32 v12, v134, v135, v12
  v_mfma_f32_32x32x16_bf16 v[96:111], v[244:247], v[156:159], v[96:111]
  s_waitcnt lgkmcnt(0)
  ds_read_b128 v[208:211], v1 offset:12288
  ds_read_b128 v[212:215], v1 offset:13312
  v_cvt_pk_f16_f32 v54, v28, v29
  v_cvt_pk_f16_f32 v55, v30, v31
  v_pk_fma_f16 v56, v48, v48, s23 op_sel_hi:[1,1,0]
  v_pk_fma_f16 v57, v49, v49, s23 op_sel_hi:[1,1,0]
  v_mfma_f32_32x32x16_f16 v[64:79], v[192:195], v[184:187], v[64:79]
  s_mov_b32 m0, s31
  v_pk_fma_f16 v58, v50, v50, s23 op_sel_hi:[1,1,0]
  v_pk_fma_f16 v59, v51, v51, s23 op_sel_hi:[1,1,0]
  v_mfma_f32_32x32x16_f16 v[80:95], v[196:199], v[184:187], v[80:95]
  buffer_load_dwordx4 v6, s[4:7], s52 offen lds
  v_mfma_f32_32x32x16_f16 v[96:111], v[200:203], v[184:187], v[96:111]
  buffer_load_dwordx4 v7, s[4:7], s52 offen offset:1024 lds
  v_pk_fma_f16 v184, v56, s20, s20 op_sel:[0,1,0] op_sel_hi:[1,1,0]
  v_pk_fma_f16 v185, v57, s20, s20 op_sel:[0,1,0] op_sel_hi:[1,1,0]
  v_pk_fma_f16 v186, v58, s20, s20 op_sel:[0,1,0] op_sel_hi:[1,1,0]
  v_pk_fma_f16 v187, v59, s20, s20 op_sel:[0,1,0] op_sel_hi:[1,1,0]
  v_pk_fma_f16 v184, v184, v56, s21 op_sel:[0,0,1]
  v_mfma_f32_32x32x16_f16 v[64:79], v[204:207], v[188:191], v[64:79]
  buffer_load_dwordx4 v8, s[4:7], s52 offen offset:2048 lds
  v_pk_fma_f16 v185, v185, v57, s21 op_sel:[0,0,1]
  v_pk_fma_f16 v186, v186, v58, s21 op_sel:[0,0,1]
  v_pk_fma_f16 v187, v187, v59, s21 op_sel:[0,0,1]
  v_pk_fma_f16 v184, v184, v56, s21 op_sel_hi:[1,1,0]
  v_pk_fma_f16 v185, v185, v57, s21 op_sel_hi:[1,1,0]
  s_waitcnt lgkmcnt(1)
  v_mfma_f32_32x32x16_f16 v[80:95], v[208:211], v[188:191], v[80:95]
  buffer_load_dwordx4 v9, s[4:7], s52 offen offset:3072 lds
  v_pk_fma_f16 v186, v186, v58, s21 op_sel_hi:[1,1,0]
  v_pk_fma_f16 v187, v187, v59, s21 op_sel_hi:[1,1,0]
  v_pk_fma_f16 v184, v184, v56, s23 op_sel:[0,0,1]
  v_pk_fma_f16 v185, v185, v57, s23 op_sel:[0,0,1]
  v_pk_fma_f16 v186, v186, v58, s23 op_sel:[0,0,1]
  s_waitcnt lgkmcnt(0)
  v_mfma_f32_32x32x16_f16 v[96:111], v[212:215], v[188:191], v[96:111]
  v_pk_fma_f16 v187, v187, v59, s23 op_sel:[0,0,1]
  v_pk_fma_f16 v184, v184, v48, 0.5 op_sel_hi:[1,1,0] clamp
  v_pk_fma_f16 v185, v185, v49, 0.5 op_sel_hi:[1,1,0] clamp
  v_pk_fma_f16 v186, v186, v50, 0.5 op_sel_hi:[1,1,0] clamp
  v_pk_fma_f16 v187, v187, v51, 0.5 op_sel_hi:[1,1,0] clamp
  v_pk_mul_f16 v184, v184, v48
  v_mfma_f32_32x32x16_bf16 v[16:31], a[24:27], v[160:163], 0
  ds_read_b128 v[192:195], v1 offset:14336
  ds_read_b128 v[196:199], v1 offset:15360
  s_add_u32 m0, s14, 0x1c000
  v_pk_mul_f16 v185, v185, v49
  v_pk_mul_f16 v186, v186, v50
  v_pk_mul_f16 v187, v187, v51
  v_mfma_f32_32x32x16_bf16 v[16:31], a[28:31], v[164:167], v[16:31]
  ds_read_b128 v[200:203], v1 offset:16384
  ds_read_b128 v[204:207], v1 offset:17408
  buffer_load_dwordx4 v254, s[72:75], s55 offen lds
  v_pk_fma_f16 v56, v52, v52, s23 op_sel_hi:[1,1,0]
  v_pk_fma_f16 v57, v53, v53, s23 op_sel_hi:[1,1,0]
  v_pk_fma_f16 v58, v54, v54, s23 op_sel_hi:[1,1,0]
  v_mfma_f32_32x32x16_bf16 v[16:31], a[32:35], v[168:171], v[16:31]
  ds_read_b128 v[208:211], v1 offset:18432
  ds_read_b128 v[212:215], v1 offset:19456
  v_pk_fma_f16 v59, v55, v55, s23 op_sel_hi:[1,1,0]
  v_pk_fma_f16 v188, v56, s20, s20 op_sel:[0,1,0] op_sel_hi:[1,1,0]
  v_pk_fma_f16 v189, v57, s20, s20 op_sel:[0,1,0] op_sel_hi:[1,1,0]
  v_pk_fma_f16 v190, v58, s20, s20 op_sel:[0,1,0] op_sel_hi:[1,1,0]
  v_mfma_f32_32x32x16_bf16 v[16:31], a[36:39], v[172:175], v[16:31]
  buffer_load_dwordx4 v255, s[72:75], s55 offen offset:1024 lds
  v_pk_fma_f16 v191, v59, s20, s20 op_sel:[0,1,0] op_sel_hi:[1,1,0]
  v_pk_fma_f16 v188, v188, v56, s21 op_sel:[0,0,1]
  v_pk_fma_f16 v189, v189, v57, s21 op_sel:[0,0,1]
  v_pk_fma_f16 v190, v190, v58, s21 op_sel:[0,0,1]
  v_pk_fma_f16 v191, v191, v59, s21 op_sel:[0,0,1]
  v_mfma_f32_32x32x16_bf16 v[16:31], a[40:43], v[176:179], v[16:31]
  v_pk_fma_f16 v188, v188, v56, s21 op_sel_hi:[1,1,0]
  v_pk_fma_f16 v189, v189, v57, s21 op_sel_hi:[1,1,0]
  v_pk_fma_f16 v190, v190, v58, s21 op_sel_hi:[1,1,0]
  v_pk_fma_f16 v191, v191, v59, s21 op_sel_hi:[1,1,0]
  v_pk_fma_f16 v188, v188, v56, s23 op_sel:[0,0,1]
  v_pk_fma_f16 v189, v189, v57, s23 op_sel:[0,0,1]
  v_mfma_f32_32x32x16_bf16 v[16:31], a[44:47], v[180:183], v[16:31]
  s_nop 0
  s_waitcnt lgkmcnt(0)
  buffer_load_dwordx4 v15, s[72:75], s55 offen offset:2048 lds
  v_pk_fma_f16 v190, v190, v58, s23 op_sel:[0,0,1]
  v_pk_fma_f16 v191, v191, v59, s23 op_sel:[0,0,1]
  v_pk_fma_f16 v188, v188, v52, 0.5 op_sel_hi:[1,1,0] clamp
  v_pk_fma_f16 v189, v189, v53, 0.5 op_sel_hi:[1,1,0] clamp
  v_pk_fma_f16 v190, v190, v54, 0.5 op_sel_hi:[1,1,0] clamp
  v_mfma_f32_32x32x16_f16 v[64:79], v[192:195], v[184:187], v[64:79]
  s_add_u32 m0, s14, 0x1cc00
  v_pk_fma_f16 v191, v191, v55, 0.5 op_sel_hi:[1,1,0] clamp
  v_pk_mul_f16 v188, v188, v52
  v_pk_mul_f16 v189, v189, v53
  v_pk_mul_f16 v190, v190, v54
  v_pk_mul_f16 v191, v191, v55
  v_mfma_f32_32x32x16_f16 v[80:95], v[196:199], v[184:187], v[80:95]
  buffer_load_dwordx4 v254, s[72:75], s56 offen lds
  v_cvt_pk_f16_f32 v48, v16, v17
  v_cvt_pk_f16_f32 v49, v18, v19
  v_cvt_pk_f16_f32 v50, v20, v21
  v_cvt_pk_f16_f32 v51, v22, v23
  v_cvt_pk_f16_f32 v52, v24, v25
  v_cvt_pk_f16_f32 v53, v26, v27
  v_mfma_f32_32x32x16_f16 v[96:111], v[200:203], v[184:187], v[96:111]
  s_nop 0
  s_waitcnt vmcnt(8)
  ds_read_b128 a[216:219], v251
  ds_read_b128 a[220:223], v252
  ds_read_b128 a[224:227], v251 offset:64
  v_cvt_pk_f16_f32 v54, v28, v29
  v_cvt_pk_f16_f32 v55, v30, v31
  v_pk_fma_f16 v56, v48, v48, s23 op_sel_hi:[1,1,0]
  v_subrev_u32 v11, 0x4100, v5
  v_mfma_f32_32x32x16_f16 v[64:79], v[204:207], v[188:191], v[64:79]
  ds_read_b128 a[228:231], v252 offset:64
  ds_read_b128 a[232:235], v251 offset:128
  ds_read_b128 a[236:239], v252 offset:128
  buffer_load_dwordx4 v255, s[72:75], s56 offen offset:1024 lds
  v_pk_fma_f16 v57, v49, v49, s23 op_sel_hi:[1,1,0]
  v_pk_fma_f16 v58, v50, v50, s23 op_sel_hi:[1,1,0]
  v_add_u32 v5, 0x8200, v5
  v_mfma_f32_32x32x16_f16 v[80:95], v[208:211], v[188:191], v[80:95]
  v_pk_fma_f16 v59, v51, v51, s23 op_sel_hi:[1,1,0]
  v_pk_fma_f16 v184, v56, s20, s20 op_sel:[0,1,0] op_sel_hi:[1,1,0]
  v_pk_fma_f16 v185, v57, s20, s20 op_sel:[0,1,0] op_sel_hi:[1,1,0]
  v_pk_fma_f16 v186, v58, s20, s20 op_sel:[0,1,0] op_sel_hi:[1,1,0]
  v_pk_fma_f16 v187, v59, s20, s20 op_sel:[0,1,0] op_sel_hi:[1,1,0]
  v_pk_fma_f16 v184, v184, v56, s21 op_sel:[0,0,1]
  v_min_u32 v5, v11, v5
  v_mfma_f32_32x32x16_f16 v[96:111], v[212:215], v[188:191], v[96:111]
  s_waitcnt lgkmcnt(0)
  buffer_load_dwordx4 v15, s[72:75], s56 offen offset:2048 lds
  v_pk_fma_f16 v185, v185, v57, s21 op_sel:[0,0,1]
  v_pk_fma_f16 v186, v186, v58, s21 op_sel:[0,0,1]
  v_pk_fma_f16 v187, v187, v59, s21 op_sel:[0,0,1]
  v_pk_fma_f16 v184, v184, v56, s21 op_sel_hi:[1,1,0]
  v_pk_fma_f16 v185, v185, v57, s21 op_sel_hi:[1,1,0]
  v_pk_fma_f16 v186, v186, v58, s21 op_sel_hi:[1,1,0]
  v_mfma_f32_32x32x16_bf16 v[112:127], a[216:219], a[192:195], 0
  ds_read_b128 v[192:195], v1 offset:20480
  ds_read_b128 v[196:199], v1 offset:21504
  v_pk_fma_f16 v187, v187, v59, s21 op_sel_hi:[1,1,0]
  v_pk_fma_f16 v184, v184, v56, s23 op_sel:[0,0,1]
  v_pk_fma_f16 v185, v185, v57, s23 op_sel:[0,0,1]
  v_pk_fma_f16 v186, v186, v58, s23 op_sel:[0,0,1]
  v_pk_fma_f16 v187, v187, v59, s23 op_sel:[0,0,1]
  v_mfma_f32_32x32x16_bf16 v[112:127], a[220:223], a[196:199], v[112:127]
  ds_read_b128 v[200:203], v1 offset:22528
  ds_read_b128 v[204:207], v1 offset:23552
  v_pk_fma_f16 v184, v184, v48, 0.5 op_sel_hi:[1,1,0] clamp
  v_pk_fma_f16 v185, v185, v49, 0.5 op_sel_hi:[1,1,0] clamp
  v_pk_fma_f16 v186, v186, v50, 0.5 op_sel_hi:[1,1,0] clamp
  v_pk_fma_f16 v187, v187, v51, 0.5 op_sel_hi:[1,1,0] clamp
  v_pk_mul_f16 v184, v184, v48
  v_mfma_f32_32x32x16_bf16 v[128:143], a[224:227], a[200:203], 0
  ds_read_b128 v[208:211], v1 offset:24576
  ds_read_b128 v[212:215], v1 offset:25600
  v_pk_mul_f16 v185, v185, v49
  v_pk_mul_f16 v186, v186, v50
  v_pk_mul_f16 v187, v187, v51
  v_pk_fma_f16 v56, v52, v52, s23 op_sel_hi:[1,1,0]
  v_pk_fma_f16 v57, v53, v53, s23 op_sel_hi:[1,1,0]
  v_mfma_f32_32x32x16_bf16 v[128:143], a[228:231], a[204:207], v[128:143]
  v_cvt_pk_f16_f32 v112, v112, v113
  v_cvt_pk_f16_f32 v113, v114, v115
  v_pk_fma_f16 v58, v54, v54, s23 op_sel_hi:[1,1,0]
  v_cvt_pk_f16_f32 v114, v116, v117
  v_pk_fma_f16 v59, v55, v55, s23 op_sel_hi:[1,1,0]
  v_cvt_pk_f16_f32 v115, v118, v119
  v_pk_fma_f16 v188, v56, s20, s20 op_sel:[0,1,0] op_sel_hi:[1,1,0]
  v_mfma_f32_32x32x16_bf16 v[144:159], a[232:235], a[208:211], 0
  ds_write_b128 v253, v[112:115]
  v_cvt_pk_f16_f32 v116, v120, v121
  v_cvt_pk_f16_f32 v117, v122, v123
  v_cvt_pk_f16_f32 v118, v124, v125
  v_cvt_pk_f16_f32 v119, v126, v127
  v_pk_fma_f16 v189, v57, s20, s20 op_sel:[0,1,0] op_sel_hi:[1,1,0]
  v_mfma_f32_32x32x16_bf16 v[144:159], a[236:239], a[212:215], v[144:159]
  ds_write_b128 v253, v[116:119] offset:3072
  v_cvt_pk_f16_f32 v128, v128, v129
  v_cvt_pk_f16_f32 v129, v130, v131
  v_cvt_pk_f16_f32 v130, v132, v133
  v_cvt_pk_f16_f32 v131, v134, v135
  v_pk_fma_f16 v190, v58, s20, s20 op_sel:[0,1,0] op_sel_hi:[1,1,0]
  v_mfma_f32_32x32x16_bf16 v[16:31], a[48:51], v[160:163], 0
  ds_write_b128 v253, v[128:131] offset:1024
  v_cvt_pk_f16_f32 v132, v136, v137
  v_cvt_pk_f16_f32 v133, v138, v139
  v_cvt_pk_f16_f32 v134, v140, v141
  v_cvt_pk_f16_f32 v135, v142, v143
  v_pk_fma_f16 v191, v59, s20, s20 op_sel:[0,1,0] op_sel_hi:[1,1,0]
  v_mfma_f32_32x32x16_bf16 v[16:31], a[52:55], v[164:167], v[16:31]
  ds_write_b128 v253, v[132:135] offset:4096
  v_cvt_pk_f16_f32 v144, v144, v145
  v_cvt_pk_f16_f32 v145, v146, v147
  v_cvt_pk_f16_f32 v146, v148, v149
  v_cvt_pk_f16_f32 v147, v150, v151
  v_pk_fma_f16 v188, v188, v56, s21 op_sel:[0,0,1]
  v_mfma_f32_32x32x16_bf16 v[16:31], a[56:59], v[168:171], v[16:31]
  ds_write_b128 v253, v[144:147] offset:2048
  v_cvt_pk_f16_f32 v148, v152, v153
  v_cvt_pk_f16_f32 v149, v154, v155
  v_cvt_pk_f16_f32 v150, v156, v157
  v_cvt_pk_f16_f32 v151, v158, v159
  v_pk_fma_f16 v189, v189, v57, s21 op_sel:[0,0,1]
  v_mfma_f32_32x32x16_bf16 v[16:31], a[60:63], v[172:175], v[16:31]
  ds_write_b128 v253, v[148:151] offset:5120
  v_or3_b32 v12, v112, v113, v12
  v_or3_b32 v12, v114, v115, v12
  v_or3_b32 v12, v116, v117, v12
  v_or3_b32 v12, v118, v119, v12
  v_pk_fma_f16 v190, v190, v58, s21 op_sel:[0,0,1]
  v_mfma_f32_32x32x16_bf16 v[16:31], a[64:67], v[176:179], v[16:31]
  v_or3_b32 v12, v128, v129, v12
  v_pk_fma_f16 v191, v191, v59, s21 op_sel:[0,0,1]
  v_or3_b32 v12, v130, v131, v12
  v_pk_fma_f16 v188, v188, v56, s21 op_sel_hi:[1,1,0]
  v_or3_b32 v12, v132, v133, v12
  v_pk_fma_f16 v189, v189, v57, s21 op_sel_hi:[1,1,0]
  v_or3_b32 v12, v134, v135, v12
  v_pk_fma_f16 v190, v190, v58, s21 op_sel_hi:[1,1,0]
  v_mfma_f32_32x32x16_bf16 v[16:31], a[68:71], v[180:183], v[16:31]
  s_nop 0
  s_waitcnt lgkmcnt(6)
  v_or3_b32 v12, v144, v145, v12
  v_pk_fma_f16 v191, v191, v59, s21 op_sel_hi:[1,1,0]
  v_or3_b32 v12, v146, v147, v12
  v_pk_fma_f16 v188, v188, v56, s23 op_sel:[0,0,1]
  v_or3_b32 v12, v148, v149, v12
  v_pk_fma_f16 v189, v189, v57, s23 op_sel:[0,0,1]
  v_or3_b32 v12, v150, v151, v12
  v_pk_fma_f16 v190, v190, v58, s23 op_sel:[0,0,1]
  v_mfma_f32_32x32x16_f16 v[64:79], v[192:195], v[184:187], v[64:79]
  s_add_u32 s29, s29, 0x60000
  v_pk_fma_f16 v191, v191, v59, s23 op_sel:[0,0,1]
  v_pk_fma_f16 v188, v188, v52, 0.5 op_sel_hi:[1,1,0] clamp
  v_pk_fma_f16 v189, v189, v53, 0.5 op_sel_hi:[1,1,0] clamp
  v_pk_fma_f16 v190, v190, v54, 0.5 op_sel_hi:[1,1,0] clamp
  v_pk_fma_f16 v191, v191, v55, 0.5 op_sel_hi:[1,1,0] clamp
  v_pk_mul_f16 v188, v188, v52
  v_pk_mul_f16 v189, v189, v53
  v_pk_mul_f16 v190, v190, v54
  v_pk_mul_f16 v191, v191, v55
  v_mfma_f32_32x32x16_f16 v[80:95], v[196:199], v[184:187], v[80:95]
  s_add_u32 s52, s52, 0x60000
  v_cvt_pk_f16_f32 v48, v16, v17
  v_cvt_pk_f16_f32 v49, v18, v19
  v_cvt_pk_f16_f32 v50, v20, v21
  v_cvt_pk_f16_f32 v51, v22, v23
  v_cvt_pk_f16_f32 v52, v24, v25
  v_cvt_pk_f16_f32 v53, v26, v27
  v_cvt_pk_f16_f32 v54, v28, v29
  v_mfma_f32_32x32x16_f16 v[96:111], v[200:203], v[184:187], v[96:111]
  s_mov_b32 s32, s30
  s_waitcnt vmcnt(0)
  ds_read_b128 a[216:219], v251 offset:24576
  ds_read_b128 a[220:223], v252 offset:24576
  ds_read_b128 a[224:227], v251 offset:24640
  v_cvt_pk_f16_f32 v55, v30, v31
  v_pk_fma_f16 v56, v48, v48, s23 op_sel_hi:[1,1,0]
  v_pk_fma_f16 v57, v49, v49, s23 op_sel_hi:[1,1,0]
  v_subrev_u32 v11, 0x4100, v4
  v_mfma_f32_32x32x16_f16 v[64:79], v[204:207], v[188:191], v[64:79]
  s_nop 0
  s_add_u32 s30, s33, 32
  ds_read_b128 a[228:231], v252 offset:24640
  ds_read_b128 a[232:235], v251 offset:24704
  ds_read_b128 a[236:239], v252 offset:24704
  v_pk_fma_f16 v58, v50, v50, s23 op_sel_hi:[1,1,0]
  v_pk_fma_f16 v59, v51, v51, s23 op_sel_hi:[1,1,0]
  v_pk_fma_f16 v184, v56, s20, s20 op_sel:[0,1,0] op_sel_hi:[1,1,0]
  v_add_u32 v4, 0x8200, v4
  v_mfma_f32_32x32x16_f16 v[80:95], v[208:211], v[188:191], v[80:95]
  s_nop 0
  s_sub_u32 s33, s31, 0
  v_pk_fma_f16 v185, v57, s20, s20 op_sel:[0,1,0] op_sel_hi:[1,1,0]
  v_pk_fma_f16 v186, v58, s20, s20 op_sel:[0,1,0] op_sel_hi:[1,1,0]
  v_pk_fma_f16 v187, v59, s20, s20 op_sel:[0,1,0] op_sel_hi:[1,1,0]
  v_pk_fma_f16 v184, v184, v56, s21 op_sel:[0,0,1]
  v_pk_fma_f16 v185, v185, v57, s21 op_sel:[0,0,1]
  v_pk_fma_f16 v186, v186, v58, s21 op_sel:[0,0,1]
  v_min_u32 v4, v11, v4
  v_mfma_f32_32x32x16_f16 v[96:111], v[212:215], v[188:191], v[96:111]
  s_waitcnt lgkmcnt(0)
  v_pk_fma_f16 v187, v187, v59, s21 op_sel:[0,0,1]
  v_pk_fma_f16 v184, v184, v56, s21 op_sel_hi:[1,1,0]
  v_pk_fma_f16 v185, v185, v57, s21 op_sel_hi:[1,1,0]
  v_pk_fma_f16 v186, v186, v58, s21 op_sel_hi:[1,1,0]
  v_pk_fma_f16 v187, v187, v59, s21 op_sel_hi:[1,1,0]
  v_pk_fma_f16 v184, v184, v56, s23 op_sel:[0,0,1]
  v_pk_fma_f16 v185, v185, v57, s23 op_sel:[0,0,1]
  v_mfma_f32_32x32x16_bf16 v[112:127], a[216:219], a[192:195], 0
  ds_read_b128 v[192:195], v1 offset:26624
  ds_read_b128 v[196:199], v1 offset:27648
  v_pk_fma_f16 v186, v186, v58, s23 op_sel:[0,0,1]
  v_pk_fma_f16 v187, v187, v59, s23 op_sel:[0,0,1]
  v_pk_fma_f16 v184, v184, v48, 0.5 op_sel_hi:[1,1,0] clamp
  v_pk_fma_f16 v185, v185, v49, 0.5 op_sel_hi:[1,1,0] clamp
  v_pk_fma_f16 v186, v186, v50, 0.5 op_sel_hi:[1,1,0] clamp
  v_mfma_f32_32x32x16_bf16 v[112:127], a[220:223], a[196:199], v[112:127]
  ds_read_b128 v[200:203], v1 offset:28672
  ds_read_b128 v[204:207], v1 offset:29696
  v_pk_fma_f16 v187, v187, v51, 0.5 op_sel_hi:[1,1,0] clamp
  v_pk_mul_f16 v184, v184, v48
  v_pk_mul_f16 v185, v185, v49
  v_pk_mul_f16 v186, v186, v50
  v_pk_mul_f16 v187, v187, v51
  v_mfma_f32_32x32x16_bf16 v[128:143], a[224:227], a[200:203], 0
  ds_read_b128 v[208:211], v1 offset:30720
  ds_read_b128 v[212:215], v1 offset:31744
  v_pk_fma_f16 v56, v52, v52, s23 op_sel_hi:[1,1,0]
  v_pk_fma_f16 v57, v53, v53, s23 op_sel_hi:[1,1,0]
  v_pk_fma_f16 v58, v54, v54, s23 op_sel_hi:[1,1,0]
  v_pk_fma_f16 v59, v55, v55, s23 op_sel_hi:[1,1,0]
  v_pk_fma_f16 v188, v56, s20, s20 op_sel:[0,1,0] op_sel_hi:[1,1,0]
  v_mfma_f32_32x32x16_bf16 v[128:143], a[228:231], a[204:207], v[128:143]
  v_cvt_pk_f16_f32 v112, v112, v113
  v_cvt_pk_f16_f32 v113, v114, v115
  v_pk_fma_f16 v189, v57, s20, s20 op_sel:[0,1,0] op_sel_hi:[1,1,0]
  v_cvt_pk_f16_f32 v114, v116, v117
  v_pk_fma_f16 v190, v58, s20, s20 op_sel:[0,1,0] op_sel_hi:[1,1,0]
  v_cvt_pk_f16_f32 v115, v118, v119
  v_pk_fma_f16 v191, v59, s20, s20 op_sel:[0,1,0] op_sel_hi:[1,1,0]
  v_mfma_f32_32x32x16_bf16 v[144:159], a[232:235], a[208:211], 0
  ds_write_b128 v253, v[112:115] offset:24576
  v_cvt_pk_f16_f32 v116, v120, v121
  v_cvt_pk_f16_f32 v117, v122, v123
  v_cvt_pk_f16_f32 v118, v124, v125
  v_cvt_pk_f16_f32 v119, v126, v127
  v_pk_fma_f16 v188, v188, v56, s21 op_sel:[0,0,1]
  v_mfma_f32_32x32x16_bf16 v[144:159], a[236:239], a[212:215], v[144:159]
  ds_write_b128 v253, v[116:119] offset:27648
  v_cvt_pk_f16_f32 v128, v128, v129
  v_cvt_pk_f16_f32 v129, v130, v131
  v_cvt_pk_f16_f32 v130, v132, v133
  v_cvt_pk_f16_f32 v131, v134, v135
  v_pk_fma_f16 v189, v189, v57, s21 op_sel:[0,0,1]
  v_mfma_f32_32x32x16_bf16 v[16:31], a[72:75], v[160:163], 0
  ds_write_b128 v253, v[128:131] offset:25600
  v_cvt_pk_f16_f32 v132, v136, v137
  v_cvt_pk_f16_f32 v133, v138, v139
  v_cvt_pk_f16_f32 v134, v140, v141
  v_cvt_pk_f16_f32 v135, v142, v143
  v_pk_fma_f16 v190, v190, v58, s21 op_sel:[0,0,1]
  v_mfma_f32_32x32x16_bf16 v[16:31], a[76:79], v[164:167], v[16:31]
  ds_write_b128 v253, v[132:135] offset:28672
  v_cvt_pk_f16_f32 v144, v144, v145
  v_cvt_pk_f16_f32 v145, v146, v147
  v_cvt_pk_f16_f32 v146, v148, v149
  v_cvt_pk_f16_f32 v147, v150, v151
  v_pk_fma_f16 v191, v191, v59, s21 op_sel:[0,0,1]
  v_mfma_f32_32x32x16_bf16 v[16:31], a[80:83], v[168:171], v[16:31]
  ds_write_b128 v253, v[144:147] offset:26624
  v_cvt_pk_f16_f32 v148, v152, v153
  v_cvt_pk_f16_f32 v149, v154, v155
  v_cvt_pk_f16_f32 v150, v156, v157
  v_cvt_pk_f16_f32 v151, v158, v159
  v_pk_fma_f16 v188, v188, v56, s21 op_sel_hi:[1,1,0]
  v_mfma_f32_32x32x16_bf16 v[16:31], a[84:87], v[172:175], v[16:31]
  ds_write_b128 v253, v[148:151] offset:29696
  buffer_load_dword v249, v248, s[4:7], s29 offen
  v_or3_b32 v12, v112, v113, v12
  v_or3_b32 v12, v114, v115, v12
  v_or3_b32 v12, v116, v117, v12
  v_or3_b32 v12, v118, v119, v12
  v_pk_fma_f16 v189, v189, v57, s21 op_sel_hi:[1,1,0]
  v_mfma_f32_32x32x16_bf16 v[16:31], a[88:91], v[176:179], v[16:31]
  v_or3_b32 v12, v128, v129, v12
  v_pk_fma_f16 v190, v190, v58, s21 op_sel_hi:[1,1,0]
  v_or3_b32 v12, v130, v131, v12
  v_pk_fma_f16 v191, v191, v59, s21 op_sel_hi:[1,1,0]
  v_or3_b32 v12, v132, v133, v12
  v_pk_fma_f16 v188, v188, v56, s23 op_sel:[0,0,1]
  v_or3_b32 v12, v134, v135, v12
  v_pk_fma_f16 v189, v189, v57, s23 op_sel:[0,0,1]
  v_mfma_f32_32x32x16_bf16 v[16:31], a[92:95], v[180:183], v[16:31]
  s_nop 0
  s_waitcnt lgkmcnt(6)
  v_or3_b32 v12, v144, v145, v12
  v_pk_fma_f16 v190, v190, v58, s23 op_sel:[0,0,1]
  v_or3_b32 v12, v146, v147, v12
  v_pk_fma_f16 v191, v191, v59, s23 op_sel:[0,0,1]
  v_or3_b32 v12, v148, v149, v12
  v_pk_fma_f16 v188, v188, v52, 0.5 op_sel_hi:[1,1,0] clamp
  v_or3_b32 v12, v150, v151, v12
  v_pk_fma_f16 v189, v189, v53, 0.5 op_sel_hi:[1,1,0] clamp
  v_mfma_f32_32x32x16_f16 v[64:79], v[192:195], v[184:187], v[64:79]
  ds_read_b128 v[220:223], v4 offset:96
  v_pk_fma_f16 v190, v190, v54, 0.5 op_sel_hi:[1,1,0] clamp
  v_pk_fma_f16 v191, v191, v55, 0.5 op_sel_hi:[1,1,0] clamp
  v_and_b32 v13, 0x40004000, v12
  v_pk_mul_f16 v188, v188, v52
  v_pk_mul_f16 v189, v189, v53
  v_and_b32 v12, 0x30003000, v12
  v_pk_mul_f16 v190, v190, v54
  v_pk_mul_f16 v191, v191, v55
  v_cmp_ne_u32_e64 vcc, 0, v13
  v_mfma_f32_32x32x16_f16 v[80:95], v[196:199], v[184:187], v[80:95]
  s_cmp_lg_u64 vcc, 0
  s_cselect_b32 s3, 1, s3
  ds_read_b128 v[228:231], v4 offset:288
  v_cmp_ne_u32_e64 vcc, 0, v12
  v_cvt_pk_f16_f32 v48, v16, v17
  v_lshl_add_u32 v13, s27, 2, v2
  v_cvt_pk_f16_f32 v49, v18, v19
  v_mfma_f32_32x32x16_f16 v[96:111], v[200:203], v[184:187], v[96:111]
  s_cmp_eq_u64 vcc, 0
  s_cselect_b32 s3, 1, s3
  ds_read_b128 v[236:239], v4 offset:480
  v_cvt_pk_f16_f32 v50, v20, v21
  v_cvt_pk_f16_f32 v51, v22, v23
  v_cvt_pk_f16_f32 v52, v24, v25
  v_mov_b32_e64 v12, s3
  v_mfma_f32_32x32x16_f16 v[64:79], v[204:207], v[188:191], v[64:79]
  ds_write_b32 v13, v12 offset:384
  v_cvt_pk_f16_f32 v53, v26, v27
  v_cvt_pk_f16_f32 v54, v28, v29
  v_cvt_pk_f16_f32 v55, v30, v31
  v_pk_fma_f16 v56, v48, v48, s23 op_sel_hi:[1,1,0]
  v_mfma_f32_32x32x16_f16 v[80:95], v[208:211], v[188:191], v[80:95]
  v_pk_fma_f16 v57, v49, v49, s23 op_sel_hi:[1,1,0]
  v_pk_fma_f16 v58, v50, v50, s23 op_sel_hi:[1,1,0]
  v_pk_fma_f16 v59, v51, v51, s23 op_sel_hi:[1,1,0]
  v_pk_fma_f16 v184, v56, s20, s20 op_sel:[0,1,0] op_sel_hi:[1,1,0]
  v_pk_fma_f16 v185, v57, s20, s20 op_sel:[0,1,0] op_sel_hi:[1,1,0]
  v_pk_fma_f16 v186, v58, s20, s20 op_sel:[0,1,0] op_sel_hi:[1,1,0]
  v_mfma_f32_32x32x16_f16 v[96:111], v[212:215], v[188:191], v[96:111]
  s_nop 0
  s_waitcnt lgkmcnt(1)
  v_pk_fma_f16 v187, v59, s20, s20 op_sel:[0,1,0] op_sel_hi:[1,1,0]
  v_pk_fma_f16 v184, v184, v56, s21 op_sel:[0,0,1]
  v_pk_fma_f16 v185, v185, v57, s21 op_sel:[0,0,1]
  v_pk_fma_f16 v186, v186, v58, s21 op_sel:[0,0,1]
  v_pk_fma_f16 v187, v187, v59, s21 op_sel:[0,0,1]
  s_waitcnt lgkmcnt(0)
  s_barrier
  v_mfma_f32_32x32x16_bf16 v[16:31], a[96:99], v[160:163], 0
  ds_read_b128 v[192:195], v0 offset:24576
  ds_read_b128 v[196:199], v0 offset:25600
  v_pk_fma_f16 v184, v184, v56, s21 op_sel_hi:[1,1,0]
  v_pk_fma_f16 v185, v185, v57, s21 op_sel_hi:[1,1,0]
  v_pk_fma_f16 v186, v186, v58, s21 op_sel_hi:[1,1,0]
  v_pk_fma_f16 v187, v187, v59, s21 op_sel_hi:[1,1,0]
  v_mfma_f32_16x16x32_bf16 v[136:139], a[240:243], v[220:223], 0
  ds_read_b128 v[216:219], v3 offset:2800
  ds_read_b128 v[220:223], v4 offset:112
  v_pk_fma_f16 v184, v184, v56, s23 op_sel:[0,0,1]
  v_mfma_f32_32x32x16_bf16 v[16:31], a[100:103], v[164:167], v[16:31]
  ds_read_b128 v[200:203], v0 offset:26624
  ds_read_b128 v[204:207], v0 offset:27648
  v_pk_fma_f16 v185, v185, v57, s23 op_sel:[0,0,1]
  v_pk_fma_f16 v186, v186, v58, s23 op_sel:[0,0,1]
  v_pk_fma_f16 v187, v187, v59, s23 op_sel:[0,0,1]
  v_pk_fma_f16 v184, v184, v48, 0.5 op_sel_hi:[1,1,0] clamp
  v_pk_fma_f16 v185, v185, v49, 0.5 op_sel_hi:[1,1,0] clamp
  v_mfma_f32_16x16x32_bf16 v[136:139], a[244:247], v[228:231], v[136:139]
  ds_read_b128 v[224:227], v3 offset:7600
  ds_read_b128 v[228:231], v4 offset:304
  v_pk_fma_f16 v186, v186, v50, 0.5 op_sel_hi:[1,1,0] clamp
  v_mfma_f32_32x32x16_bf16 v[16:31], a[104:107], v[168:171], v[16:31]
  ds_read_b128 v[208:211], v0 offset:28672
  ds_read_b128 v[212:215], v0 offset:29696
  v_pk_fma_f16 v187, v187, v51, 0.5 op_sel_hi:[1,1,0] clamp
  v_pk_mul_f16 v184, v184, v48
  v_pk_mul_f16 v185, v185, v49
  v_pk_mul_f16 v186, v186, v50
  v_pk_mul_f16 v187, v187, v51
  v_mfma_f32_16x16x32_bf16 v[136:139], a[248:251], v[236:239], v[136:139]
  ds_read_b128 v[232:235], v3 offset:12400
  ds_read_b128 v[236:239], v4 offset:496
  v_pk_fma_f16 v56, v52, v52, s23 op_sel_hi:[1,1,0]
  v_mfma_f32_32x32x16_bf16 v[16:31], a[108:111], v[172:175], v[16:31]
  v_pk_fma_f16 v57, v53, v53, s23 op_sel_hi:[1,1,0]
  v_pk_fma_f16 v58, v54, v54, s23 op_sel_hi:[1,1,0]
  v_pk_fma_f16 v59, v55, v55, s23 op_sel_hi:[1,1,0]
  v_pk_fma_f16 v188, v56, s20, s20 op_sel:[0,1,0] op_sel_hi:[1,1,0]
  v_pk_fma_f16 v189, v57, s20, s20 op_sel:[0,1,0] op_sel_hi:[1,1,0]
  v_pk_fma_f16 v190, v58, s20, s20 op_sel:[0,1,0] op_sel_hi:[1,1,0]
  v_pk_fma_f16 v191, v59, s20, s20 op_sel:[0,1,0] op_sel_hi:[1,1,0]
  v_mfma_f32_32x32x16_bf16 v[16:31], a[112:115], v[176:179], v[16:31]
  ds_read_b128 v[12:15], v2 offset:384
  v_pk_fma_f16 v188, v188, v56, s21 op_sel:[0,0,1]
  v_pk_fma_f16 v189, v189, v57, s21 op_sel:[0,0,1]
  v_pk_fma_f16 v190, v190, v58, s21 op_sel:[0,0,1]
  v_pk_fma_f16 v191, v191, v59, s21 op_sel:[0,0,1]
  v_pk_fma_f16 v188, v188, v56, s21 op_sel_hi:[1,1,0]
  v_pk_fma_f16 v189, v189, v57, s21 op_sel_hi:[1,1,0]
  v_mfma_f32_32x32x16_bf16 v[16:31], a[116:119], v[180:183], v[16:31]
  s_nop 0
  s_waitcnt lgkmcnt(1)
  v_pk_fma_f16 v190, v190, v58, s21 op_sel_hi:[1,1,0]
  v_pk_fma_f16 v191, v191, v59, s21 op_sel_hi:[1,1,0]
  v_pk_fma_f16 v188, v188, v56, s23 op_sel:[0,0,1]
  v_pk_fma_f16 v189, v189, v57, s23 op_sel:[0,0,1]
  v_pk_fma_f16 v190, v190, v58, s23 op_sel:[0,0,1]
  v_pk_fma_f16 v191, v191, v59, s23 op_sel:[0,0,1]
  v_pk_fma_f16 v188, v188, v52, 0.5 op_sel_hi:[1,1,0] clamp
  v_mfma_f32_32x32x16_f16 v[64:79], v[192:195], v[184:187], v[64:79]
  v_pk_fma_f16 v189, v189, v53, 0.5 op_sel_hi:[1,1,0] clamp
  v_pk_fma_f16 v190, v190, v54, 0.5 op_sel_hi:[1,1,0] clamp
  v_pk_fma_f16 v191, v191, v55, 0.5 op_sel_hi:[1,1,0] clamp
  v_pk_mul_f16 v188, v188, v52
  v_pk_mul_f16 v189, v189, v53
  v_pk_mul_f16 v190, v190, v54
  v_pk_mul_f16 v191, v191, v55
  v_mfma_f32_16x16x32_bf16 v[140:143], v[216:219], v[220:223], 0
  ds_read_b128 v[220:223], v4 offset:128
  v_cvt_pk_f16_f32 v48, v16, v17
  v_mfma_f32_32x32x16_f16 v[80:95], v[196:199], v[184:187], v[80:95]
  v_cvt_pk_f16_f32 v49, v18, v19
  v_cvt_pk_f16_f32 v50, v20, v21
  v_cvt_pk_f16_f32 v51, v22, v23
  v_cvt_pk_f16_f32 v52, v24, v25
  v_cvt_pk_f16_f32 v53, v26, v27
  v_cvt_pk_f16_f32 v54, v28, v29
  v_mfma_f32_16x16x32_bf16 v[140:143], v[224:227], v[228:231], v[140:143]
  ds_read_b128 v[224:227], v3 offset:8000
  ds_read_b128 v[228:231], v4 offset:320
  v_mfma_f32_32x32x16_f16 v[96:111], v[200:203], v[184:187], v[96:111]
  s_nop 0
  s_sub_u32 s31, s32, 32
  v_cvt_pk_f16_f32 v55, v30, v31
  v_pk_fma_f16 v56, v48, v48, s23 op_sel_hi:[1,1,0]
  v_pk_fma_f16 v57, v49, v49, s23 op_sel_hi:[1,1,0]
  v_pk_fma_f16 v58, v50, v50, s23 op_sel_hi:[1,1,0]
  v_pk_fma_f16 v59, v51, v51, s23 op_sel_hi:[1,1,0]
  v_pk_fma_f16 v184, v56, s20, s20 op_sel:[0,1,0] op_sel_hi:[1,1,0]
  v_mfma_f32_16x16x32_bf16 v[140:143], v[232:235], v[236:239], v[140:143]
  ds_read_b128 v[232:235], v3 offset:12800
  ds_read_b128 v[236:239], v4 offset:512
  v_mfma_f32_32x32x16_f16 v[64:79], v[204:207], v[188:191], v[64:79]
  s_waitcnt lgkmcnt(5)
  v_or3_b32 v12, v12, v13, v14
  v_pk_fma_f16 v185, v57, s20, s20 op_sel:[0,1,0] op_sel_hi:[1,1,0]
  v_or_b32 v12, v12, v15
  v_pk_fma_f16 v186, v58, s20, s20 op_sel:[0,1,0] op_sel_hi:[1,1,0]
  v_cmp_ne_u32 vcc, 0, v12
  v_pk_fma_f16 v187, v59, s20, s20 op_sel:[0,1,0] op_sel_hi:[1,1,0]
  v_mfma_f32_32x32x16_f16 v[80:95], v[208:211], v[188:191], v[80:95]
  s_cbranch_vccnz L_slow
  v_pk_fma_f16 v184, v184, v56, s21 op_sel:[0,0,1]
  v_pk_fma_f16 v185, v185, v57, s21 op_sel:[0,0,1]
  v_pk_fma_f16 v186, v186, v58, s21 op_sel:[0,0,1]
  v_pk_fma_f16 v187, v187, v59, s21 op_sel:[0,0,1]
  v_pk_fma_f16 v184, v184, v56, s21 op_sel_hi:[1,1,0]
  v_mfma_f32_32x32x16_f16 v[96:111], v[212:215], v[188:191], v[96:111]
  s_nop 0
  s_waitcnt lgkmcnt(0)
  v_pk_fma_f16 v185, v185, v57, s21 op_sel_hi:[1,1,0]
  v_pk_fma_f16 v186, v186, v58, s21 op_sel_hi:[1,1,0]
  v_pk_fma_f16 v187, v187, v59, s21 op_sel_hi:[1,1,0]
  v_pk_fma_f16 v184, v184, v56, s23 op_sel:[0,0,1]
  v_pk_fma_f16 v185, v185, v57, s23 op_sel:[0,0,1]
  v_pk_fma_f16 v186, v186, v58, s23 op_sel:[0,0,1]
  v_mfma_f32_32x32x16_bf16 v[16:31], a[120:123], v[160:163], 0
  ds_read_b128 v[192:195], v0 offset:30720
  ds_read_b128 v[196:199], v0 offset:31744
  v_pk_fma_f16 v187, v187, v59, s23 op_sel:[0,0,1]
  v_pk_fma_f16 v184, v184, v48, 0.5 op_sel_hi:[1,1,0] clamp
  v_pk_fma_f16 v185, v185, v49, 0.5 op_sel_hi:[1,1,0] clamp
  v_pk_fma_f16 v186, v186, v50, 0.5 op_sel_hi:[1,1,0] clamp
  v_mfma_f32_16x16x32_bf16 v[144:147], a[252:255], v[220:223], 0
  ds_read_b128 v[216:219], v3 offset:3600
  ds_read_b128 v[220:223], v4 offset:144
  v_mfma_f32_32x32x16_bf16 v[16:31], a[124:127], v[164:167], v[16:31]
  ds_read_b128 v[200:203], v0 offset:32768
  ds_read_b128 v[204:207], v0 offset:33792
  v_pk_fma_f16 v187, v187, v51, 0.5 op_sel_hi:[1,1,0] clamp
  v_pk_mul_f16 v184, v184, v48
  v_pk_mul_f16 v185, v185, v49
  v_pk_mul_f16 v186, v186, v50
  v_mfma_f32_16x16x32_bf16 v[144:147], v[224:227], v[228:231], v[144:147]
  ds_read_b128 v[224:227], v3 offset:8400
  ds_read_b128 v[228:231], v4 offset:336
  v_mfma_f32_32x32x16_bf16 v[16:31], a[128:131], v[168:171], v[16:31]
  ds_read_b128 v[208:211], v0 offset:34816
  ds_read_b128 v[212:215], v0 offset:35840
  v_pk_mul_f16 v187, v187, v51
  v_pk_fma_f16 v56, v52, v52, s23 op_sel_hi:[1,1,0]
  v_pk_fma_f16 v57, v53, v53, s23 op_sel_hi:[1,1,0]
  v_pk_fma_f16 v58, v54, v54, s23 op_sel_hi:[1,1,0]
  v_mfma_f32_16x16x32_bf16 v[144:147], v[232:235], v[236:239], v[144:147]
  ds_read_b128 v[232:235], v3 offset:13200
  ds_read_b128 v[236:239], v4 offset:528
  v_mfma_f32_32x32x16_bf16 v[16:31], a[132:135], v[172:175], v[16:31]
  v_pk_fma_f16 v59, v55, v55, s23 op_sel_hi:[1,1,0]
  v_pk_fma_f16 v188, v56, s20, s20 op_sel:[0,1,0] op_sel_hi:[1,1,0]
  v_pk_fma_f16 v189, v57, s20, s20 op_sel:[0,1,0] op_sel_hi:[1,1,0]
  v_pk_fma_f16 v190, v58, s20, s20 op_sel:[0,1,0] op_sel_hi:[1,1,0]
  v_pk_fma_f16 v191, v59, s20, s20 op_sel:[0,1,0] op_sel_hi:[1,1,0]
  v_pk_fma_f16 v188, v188, v56, s21 op_sel:[0,0,1]
  v_pk_fma_f16 v189, v189, v57, s21 op_sel:[0,0,1]
  v_mfma_f32_32x32x16_bf16 v[16:31], a[136:139], v[176:179], v[16:31]
  ds_read_b128 a[192:195], v0
  ds_read_b128 a[196:199], v0 offset:1024
  ds_read_b128 a[200:203], v0 offset:2048
  v_pk_fma_f16 v190, v190, v58, s21 op_sel:[0,0,1]
  v_pk_fma_f16 v191, v191, v59, s21 op_sel:[0,0,1]
  v_pk_fma_f16 v188, v188, v56, s21 op_sel_hi:[1,1,0]
  v_pk_fma_f16 v189, v189, v57, s21 op_sel_hi:[1,1,0]
  v_mfma_f32_32x32x16_bf16 v[16:31], a[140:143], v[180:183], v[16:31]
  s_nop 0
  s_waitcnt lgkmcnt(3)
  v_pk_fma_f16 v190, v190, v58, s21 op_sel_hi:[1,1,0]
  v_pk_fma_f16 v191, v191, v59, s21 op_sel_hi:[1,1,0]
  v_pk_fma_f16 v188, v188, v56, s23 op_sel:[0,0,1]
  v_pk_fma_f16 v189, v189, v57, s23 op_sel:[0,0,1]
  v_pk_fma_f16 v190, v190, v58, s23 op_sel:[0,0,1]
  v_pk_fma_f16 v191, v191, v59, s23 op_sel:[0,0,1]
  v_pk_fma_f16 v188, v188, v52, 0.5 op_sel_hi:[1,1,0] clamp
  v_mfma_f32_32x32x16_f16 v[64:79], v[192:195], v[184:187], v[64:79]
  v_pk_fma_f16 v189, v189, v53, 0.5 op_sel_hi:[1,1,0] clamp
  v_pk_fma_f16 v190, v190, v54, 0.5 op_sel_hi:[1,1,0] clamp
  v_pk_fma_f16 v191, v191, v55, 0.5 op_sel_hi:[1,1,0] clamp
  v_pk_mul_f16 v188, v188, v52
  v_pk_mul_f16 v189, v189, v53
  v_pk_mul_f16 v190, v190, v54
  v_pk_mul_f16 v191, v191, v55
  v_mfma_f32_16x16x32_bf16 v[148:151], v[216:219], v[220:223], 0
  ds_read_b128 v[216:219], v3 offset:4000
  ds_read_b128 v[220:223], v4 offset:160
  v_mfma_f32_32x32x16_f16 v[80:95], v[196:199], v[184:187], v[80:95]
  v_cvt_pk_f16_f32 v48, v16, v17
  v_cvt_pk_f16_f32 v49, v18, v19
  v_cvt_pk_f16_f32 v50, v20, v21
  v_cvt_pk_f16_f32 v51, v22, v23
  v_cvt_pk_f16_f32 v52, v24, v25
  v_cvt_pk_f16_f32 v53, v26, v27
  v_mfma_f32_16x16x32_bf16 v[148:151], v[224:227], v[228:231], v[148:151]
  ds_read_b128 v[224:227], v3 offset:8800
  ds_read_b128 v[228:231], v4 offset:352
  v_mfma_f32_32x32x16_f16 v[96:111], v[200:203], v[184:187], v[96:111]
  v_cvt_pk_f16_f32 v54, v28, v29
  v_cvt_pk_f16_f32 v55, v30, v31
  v_pk_fma_f16 v56, v48, v48, s23 op_sel_hi:[1,1,0]
  v_pk_fma_f16 v57, v49, v49, s23 op_sel_hi:[1,1,0]
  v_pk_fma_f16 v58, v50, v50, s23 op_sel_hi:[1,1,0]
  v_pk_fma_f16 v59, v51, v51, s23 op_sel_hi:[1,1,0]
  v_mfma_f32_16x16x32_bf16 v[148:151], v[232:235], v[236:239], v[148:151]
  ds_read_b128 v[232:235], v3 offset:13600
  ds_read_b128 v[236:239], v4 offset:544
  v_mfma_f32_32x32x16_f16 v[64:79], v[204:207], v[188:191], v[64:79]
  v_pk_fma_f16 v184, v56, s20, s20 op_sel:[0,1,0] op_sel_hi:[1,1,0]
  v_pk_fma_f16 v185, v57, s20, s20 op_sel:[0,1,0] op_sel_hi:[1,1,0]
  v_pk_fma_f16 v186, v58, s20, s20 op_sel:[0,1,0] op_sel_hi:[1,1,0]
  v_pk_fma_f16 v187, v59, s20, s20 op_sel:[0,1,0] op_sel_hi:[1,1,0]
  v_pk_fma_f16 v184, v184, v56, s21 op_sel:[0,0,1]
  v_pk_fma_f16 v185, v185, v57, s21 op_sel:[0,0,1]
  v_mfma_f32_32x32x16_f16 v[80:95], v[208:211], v[188:191], v[80:95]
  ds_read_b128 a[204:207], v0 offset:3072
  ds_read_b128 a[208:211], v0 offset:4096
  ds_read_b128 a[212:215], v0 offset:5120
  v_pk_fma_f16 v186, v186, v58, s21 op_sel:[0,0,1]
  v_pk_fma_f16 v187, v187, v59, s21 op_sel:[0,0,1]
  v_pk_fma_f16 v184, v184, v56, s21 op_sel_hi:[1,1,0]
  v_mfma_f32_32x32x16_f16 v[96:111], v[212:215], v[188:191], v[96:111]
  s_nop 0
  s_waitcnt lgkmcnt(3)
  v_pk_fma_f16 v185, v185, v57, s21 op_sel_hi:[1,1,0]
  v_pk_fma_f16 v186, v186, v58, s21 op_sel_hi:[1,1,0]
  v_pk_fma_f16 v187, v187, v59, s21 op_sel_hi:[1,1,0]
  v_pk_fma_f16 v184, v184, v56, s23 op_sel:[0,0,1]
  v_pk_fma_f16 v185, v185, v57, s23 op_sel:[0,0,1]
  v_pk_fma_f16 v186, v186, v58, s23 op_sel:[0,0,1]
  v_mfma_f32_32x32x16_bf16 v[16:31], a[144:147], v[160:163], 0
  ds_read_b128 v[192:195], v0 offset:36864
  ds_read_b128 v[196:199], v0 offset:37888
  v_pk_fma_f16 v187, v187, v59, s23 op_sel:[0,0,1]
  v_pk_fma_f16 v184, v184, v48, 0.5 op_sel_hi:[1,1,0] clamp
  v_pk_fma_f16 v185, v185, v49, 0.5 op_sel_hi:[1,1,0] clamp
  v_pk_fma_f16 v186, v186, v50, 0.5 op_sel_hi:[1,1,0] clamp
  v_mfma_f32_16x16x32_bf16 v[152:155], v[216:219], v[220:223], 0
  ds_read_b128 v[216:219], v3 offset:4400
  ds_read_b128 v[220:223], v4 offset:176
  v_mfma_f32_32x32x16_bf16 v[16:31], a[148:151], v[164:167], v[16:31]
  ds_read_b128 v[200:203], v0 offset:38912
  ds_read_b128 v[204:207], v0 offset:39936
  v_pk_fma_f16 v187, v187, v51, 0.5 op_sel_hi:[1,1,0] clamp
  v_pk_mul_f16 v184, v184, v48
  v_pk_mul_f16 v185, v185, v49
  v_pk_mul_f16 v186, v186, v50
  v_mfma_f32_16x16x32_bf16 v[152:155], v[224:227], v[228:231], v[152:155]
  ds_read_b128 v[224:227], v3 offset:9200
  ds_read_b128 v[228:231], v4 offset:368
  v_mfma_f32_32x32x16_bf16 v[16:31], a[152:155], v[168:171], v[16:31]
  ds_read_b128 v[208:211], v0 offset:40960
  ds_read_b128 v[212:215], v0 offset:41984
  v_pk_mul_f16 v187, v187, v51
  v_pk_fma_f16 v56, v52, v52, s23 op_sel_hi:[1,1,0]
  v_pk_fma_f16 v57, v53, v53, s23 op_sel_hi:[1,1,0]
  v_pk_fma_f16 v58, v54, v54, s23 op_sel_hi:[1,1,0]
  v_mfma_f32_16x16x32_bf16 v[152:155], v[232:235], v[236:239], v[152:155]
  ds_read_b128 v[232:235], v3 offset:14000
  ds_read_b128 v[236:239], v4 offset:560
  v_mfma_f32_32x32x16_bf16 v[16:31], a[156:159], v[172:175], v[16:31]
  v_pk_fma_f16 v59, v55, v55, s23 op_sel_hi:[1,1,0]
  v_pk_fma_f16 v188, v56, s20, s20 op_sel:[0,1,0] op_sel_hi:[1,1,0]
  v_pk_fma_f16 v189, v57, s20, s20 op_sel:[0,1,0] op_sel_hi:[1,1,0]
  v_pk_fma_f16 v190, v58, s20, s20 op_sel:[0,1,0] op_sel_hi:[1,1,0]
  v_pk_fma_f16 v191, v59, s20, s20 op_sel:[0,1,0] op_sel_hi:[1,1,0]
  v_pk_fma_f16 v188, v188, v56, s21 op_sel:[0,0,1]
  v_pk_fma_f16 v189, v189, v57, s21 op_sel:[0,0,1]
  v_mfma_f32_32x32x16_bf16 v[16:31], a[160:163], v[176:179], v[16:31]
  ds_read_b128 a[216:219], v0 offset:6144
  ds_read_b128 a[220:223], v0 offset:7168
  ds_read_b128 a[224:227], v0 offset:8192
  v_pk_fma_f16 v190, v190, v58, s21 op_sel:[0,0,1]
  v_pk_fma_f16 v191, v191, v59, s21 op_sel:[0,0,1]
  v_pk_fma_f16 v188, v188, v56, s21 op_sel_hi:[1,1,0]
  v_pk_fma_f16 v189, v189, v57, s21 op_sel_hi:[1,1,0]
  v_mfma_f32_32x32x16_bf16 v[16:31], a[164:167], v[180:183], v[16:31]
  s_nop 0
  s_waitcnt lgkmcnt(3)
  v_pk_fma_f16 v190, v190, v58, s21 op_sel_hi:[1,1,0]
  v_pk_fma_f16 v191, v191, v59, s21 op_sel_hi:[1,1,0]
  v_pk_fma_f16 v188, v188, v56, s23 op_sel:[0,0,1]
  v_pk_fma_f16 v189, v189, v57, s23 op_sel:[0,0,1]
  v_pk_fma_f16 v190, v190, v58, s23 op_sel:[0,0,1]
  v_pk_fma_f16 v191, v191, v59, s23 op_sel:[0,0,1]
  v_pk_fma_f16 v188, v188, v52, 0.5 op_sel_hi:[1,1,0] clamp
  v_mfma_f32_32x32x16_f16 v[64:79], v[192:195], v[184:187], v[64:79]
  v_pk_fma_f16 v189, v189, v53, 0.5 op_sel_hi:[1,1,0] clamp
  v_pk_fma_f16 v190, v190, v54, 0.5 op_sel_hi:[1,1,0] clamp
  v_pk_fma_f16 v191, v191, v55, 0.5 op_sel_hi:[1,1,0] clamp
  v_pk_mul_f16 v188, v188, v52
  v_pk_mul_f16 v189, v189, v53
  v_pk_mul_f16 v190, v190, v54
  v_pk_mul_f16 v191, v191, v55
  v_mfma_f32_16x16x32_bf16 v[156:159], v[216:219], v[220:223], 0
  ds_read_b128 v[216:219], v3
  ds_read_b128 v[220:223], v4
  v_mfma_f32_32x32x16_f16 v[80:95], v[196:199], v[184:187], v[80:95]
  v_cvt_pk_f16_f32 v48, v16, v17
  v_cvt_pk_f16_f32 v49, v18, v19
  v_cvt_pk_f16_f32 v50, v20, v21
  v_cvt_pk_f16_f32 v51, v22, v23
  v_cvt_pk_f16_f32 v52, v24, v25
  v_cvt_pk_f16_f32 v53, v26, v27
  v_mfma_f32_16x16x32_bf16 v[156:159], v[224:227], v[228:231], v[156:159]
  ds_read_b128 v[224:227], v3 offset:4800
  ds_read_b128 v[228:231], v4 offset:192
  v_mfma_f32_32x32x16_f16 v[96:111], v[200:203], v[184:187], v[96:111]
  v_cvt_pk_f16_f32 v54, v28, v29
  v_cvt_pk_f16_f32 v55, v30, v31
  v_pk_fma_f16 v56, v48, v48, s23 op_sel_hi:[1,1,0]
  v_pk_fma_f16 v57, v49, v49, s23 op_sel_hi:[1,1,0]
  v_pk_fma_f16 v58, v50, v50, s23 op_sel_hi:[1,1,0]
  v_pk_fma_f16 v59, v51, v51, s23 op_sel_hi:[1,1,0]
  v_mfma_f32_16x16x32_bf16 v[156:159], v[232:235], v[236:239], v[156:159]
  ds_read_b128 v[232:235], v3 offset:9600
  ds_read_b128 v[236:239], v4 offset:384
  v_mfma_f32_32x32x16_f16 v[64:79], v[204:207], v[188:191], v[64:79]
  v_pk_fma_f16 v184, v56, s20, s20 op_sel:[0,1,0] op_sel_hi:[1,1,0]
  v_pk_fma_f16 v185, v57, s20, s20 op_sel:[0,1,0] op_sel_hi:[1,1,0]
  v_pk_fma_f16 v186, v58, s20, s20 op_sel:[0,1,0] op_sel_hi:[1,1,0]
  v_pk_fma_f16 v187, v59, s20, s20 op_sel:[0,1,0] op_sel_hi:[1,1,0]
  v_pk_fma_f16 v184, v184, v56, s21 op_sel:[0,0,1]
  v_pk_fma_f16 v185, v185, v57, s21 op_sel:[0,0,1]
  v_mfma_f32_32x32x16_f16 v[80:95], v[208:211], v[188:191], v[80:95]
  ds_read_b128 a[228:231], v0 offset:9216
  ds_read_b128 a[232:235], v0 offset:10240
  ds_read_b128 a[236:239], v0 offset:11264
  v_pk_fma_f16 v186, v186, v58, s21 op_sel:[0,0,1]
  v_pk_fma_f16 v187, v187, v59, s21 op_sel:[0,0,1]
  v_pk_fma_f16 v184, v184, v56, s21 op_sel_hi:[1,1,0]
  v_mfma_f32_32x32x16_f16 v[96:111], v[212:215], v[188:191], v[96:111]
  s_nop 0
  s_waitcnt lgkmcnt(3)
  v_pk_fma_f16 v185, v185, v57, s21 op_sel_hi:[1,1,0]
  v_pk_fma_f16 v186, v186, v58, s21 op_sel_hi:[1,1,0]
  v_pk_fma_f16 v187, v187, v59, s21 op_sel_hi:[1,1,0]
  v_pk_fma_f16 v184, v184, v56, s23 op_sel:[0,0,1]
  v_pk_fma_f16 v185, v185, v57, s23 op_sel:[0,0,1]
  v_pk_fma_f16 v186, v186, v58, s23 op_sel:[0,0,1]
  v_mfma_f32_32x32x16_bf16 v[16:31], a[168:171], v[160:163], 0
  ds_read_b128 v[192:195], v0 offset:43008
  ds_read_b128 v[196:199], v0 offset:44032
  v_pk_fma_f16 v187, v187, v59, s23 op_sel:[0,0,1]
  v_pk_fma_f16 v184, v184, v48, 0.5 op_sel_hi:[1,1,0] clamp
  v_pk_fma_f16 v185, v185, v49, 0.5 op_sel_hi:[1,1,0] clamp
  v_pk_fma_f16 v186, v186, v50, 0.5 op_sel_hi:[1,1,0] clamp
  v_mfma_f32_16x16x32_bf16 v[112:115], v[216:219], v[220:223], 0
  ds_read_b128 v[216:219], v3 offset:400
  ds_read_b128 v[220:223], v4 offset:16
  v_mfma_f32_32x32x16_bf16 v[16:31], a[172:175], v[164:167], v[16:31]
  ds_read_b128 v[200:203], v0 offset:45056
  ds_read_b128 v[204:207], v0 offset:46080
  v_pk_fma_f16 v187, v187, v51, 0.5 op_sel_hi:[1,1,0] clamp
  v_pk_mul_f16 v184, v184, v48
  v_pk_mul_f16 v185, v185, v49
  v_pk_mul_f16 v186, v186, v50
  v_mfma_f32_16x16x32_bf16 v[112:115], v[224:227], v[228:231], v[112:115]
  ds_read_b128 v[224:227], v3 offset:5200
  ds_read_b128 v[228:231], v4 offset:208
  v_mfma_f32_32x32x16_bf16 v[16:31], a[176:179], v[168:171], v[16:31]
  ds_read_b128 v[208:211], v0 offset:47104
  ds_read_b128 v[212:215], v0 offset:48128
  v_pk_mul_f16 v187, v187, v51
  v_pk_fma_f16 v56, v52, v52, s23 op_sel_hi:[1,1,0]
  v_pk_fma_f16 v57, v53, v53, s23 op_sel_hi:[1,1,0]
  v_pk_fma_f16 v58, v54, v54, s23 op_sel_hi:[1,1,0]
  v_mfma_f32_16x16x32_bf16 v[112:115], v[232:235], v[236:239], v[112:115]
  ds_read_b128 v[232:235], v3 offset:10000
  ds_read_b128 v[236:239], v4 offset:400
  v_mfma_f32_32x32x16_bf16 v[16:31], a[180:183], v[172:175], v[16:31]
  v_pk_fma_f16 v59, v55, v55, s23 op_sel_hi:[1,1,0]
  v_pk_fma_f16 v188, v56, s20, s20 op_sel:[0,1,0] op_sel_hi:[1,1,0]
  v_pk_fma_f16 v189, v57, s20, s20 op_sel:[0,1,0] op_sel_hi:[1,1,0]
  v_pk_fma_f16 v190, v58, s20, s20 op_sel:[0,1,0] op_sel_hi:[1,1,0]
  v_pk_fma_f16 v191, v59, s20, s20 op_sel:[0,1,0] op_sel_hi:[1,1,0]
  v_pk_fma_f16 v188, v188, v56, s21 op_sel:[0,0,1]
  v_pk_fma_f16 v189, v189, v57, s21 op_sel:[0,0,1]
  v_mfma_f32_32x32x16_bf16 v[16:31], a[184:187], v[176:179], v[16:31]
  ds_read_b128 v[32:35], v0 offset:12288
  ds_read_b128 v[36:39], v0 offset:13312
  ds_read_b128 v[40:43], v0 offset:14336
  v_pk_fma_f16 v190, v190, v58, s21 op_sel:[0,0,1]
  v_pk_fma_f16 v191, v191, v59, s21 op_sel:[0,0,1]
  v_pk_fma_f16 v188, v188, v56, s21 op_sel_hi:[1,1,0]
  v_pk_fma_f16 v189, v189, v57, s21 op_sel_hi:[1,1,0]
  v_mfma_f32_32x32x16_bf16 v[16:31], a[188:191], v[180:183], v[16:31]
  s_nop 0
  s_waitcnt lgkmcnt(3)
  v_pk_fma_f16 v190, v190, v58, s21 op_sel_hi:[1,1,0]
  v_pk_fma_f16 v191, v191, v59, s21 op_sel_hi:[1,1,0]
  v_pk_fma_f16 v188, v188, v56, s23 op_sel:[0,0,1]
  v_pk_fma_f16 v189, v189, v57, s23 op_sel:[0,0,1]
  v_pk_fma_f16 v190, v190, v58, s23 op_sel:[0,0,1]
  v_pk_fma_f16 v191, v191, v59, s23 op_sel:[0,0,1]
  v_pk_fma_f16 v188, v188, v52, 0.5 op_sel_hi:[1,1,0] clamp
  v_mfma_f32_32x32x16_f16 v[64:79], v[192:195], v[184:187], v[64:79]
  v_pk_fma_f16 v189, v189, v53, 0.5 op_sel_hi:[1,1,0] clamp
  v_pk_fma_f16 v190, v190, v54, 0.5 op_sel_hi:[1,1,0] clamp
  v_pk_fma_f16 v191, v191, v55, 0.5 op_sel_hi:[1,1,0] clamp
  v_pk_mul_f16 v188, v188, v52
  v_pk_mul_f16 v189, v189, v53
  v_pk_mul_f16 v190, v190, v54
  v_pk_mul_f16 v191, v191, v55
  v_mfma_f32_16x16x32_bf16 v[116:119], v[216:219], v[220:223], 0
  ds_read_b128 v[216:219], v3 offset:800
  ds_read_b128 v[220:223], v4 offset:32
  v_mfma_f32_32x32x16_f16 v[80:95], v[196:199], v[184:187], v[80:95]
  v_cvt_pk_f16_f32 v48, v16, v17
  v_cvt_pk_f16_f32 v49, v18, v19
  v_cvt_pk_f16_f32 v50, v20, v21
  v_cvt_pk_f16_f32 v51, v22, v23
  v_cvt_pk_f16_f32 v52, v24, v25
  v_cvt_pk_f16_f32 v53, v26, v27
  v_mfma_f32_16x16x32_bf16 v[116:119], v[224:227], v[228:231], v[116:119]
  ds_read_b128 v[224:227], v3 offset:5600
  ds_read_b128 v[228:231], v4 offset:224
  v_mfma_f32_32x32x16_f16 v[96:111], v[200:203], v[184:187], v[96:111]
  v_cvt_pk_f16_f32 v54, v28, v29
  v_cvt_pk_f16_f32 v55, v30, v31
  v_pk_fma_f16 v56, v48, v48, s23 op_sel_hi:[1,1,0]
  v_pk_fma_f16 v57, v49, v49, s23 op_sel_hi:[1,1,0]
  v_pk_fma_f16 v58, v50, v50, s23 op_sel_hi:[1,1,0]
  v_pk_fma_f16 v59, v51, v51, s23 op_sel_hi:[1,1,0]
  v_mfma_f32_16x16x32_bf16 v[116:119], v[232:235], v[236:239], v[116:119]
  ds_read_b128 v[232:235], v3 offset:10400
  ds_read_b128 v[236:239], v4 offset:416
  v_mfma_f32_32x32x16_f16 v[64:79], v[204:207], v[188:191], v[64:79]
  v_pk_fma_f16 v184, v56, s20, s20 op_sel:[0,1,0] op_sel_hi:[1,1,0]
  v_pk_fma_f16 v185, v57, s20, s20 op_sel:[0,1,0] op_sel_hi:[1,1,0]
  v_pk_fma_f16 v186, v58, s20, s20 op_sel:[0,1,0] op_sel_hi:[1,1,0]
  v_pk_fma_f16 v187, v59, s20, s20 op_sel:[0,1,0] op_sel_hi:[1,1,0]
  v_pk_fma_f16 v184, v184, v56, s21 op_sel:[0,0,1]
  v_pk_fma_f16 v185, v185, v57, s21 op_sel:[0,0,1]
  v_mfma_f32_32x32x16_f16 v[80:95], v[208:211], v[188:191], v[80:95]
  ds_read_b128 v[44:47], v0 offset:15360
  ds_read_b128 v[60:63], v0 offset:16384
  v_pk_fma_f16 v186, v186, v58, s21 op_sel:[0,0,1]
  v_pk_fma_f16 v187, v187, v59, s21 op_sel:[0,0,1]
  v_pk_fma_f16 v184, v184, v56, s21 op_sel_hi:[1,1,0]
  v_pk_fma_f16 v185, v185, v57, s21 op_sel_hi:[1,1,0]
  v_mfma_f32_32x32x16_f16 v[96:111], v[212:215], v[188:191], v[96:111]
  s_nop 0
  s_waitcnt lgkmcnt(2)
  v_pk_fma_f16 v186, v186, v58, s21 op_sel_hi:[1,1,0]
  v_pk_fma_f16 v187, v187, v59, s21 op_sel_hi:[1,1,0]
  v_pk_fma_f16 v184, v184, v56, s23 op_sel:[0,0,1]
  v_pk_fma_f16 v185, v185, v57, s23 op_sel:[0,0,1]
  v_pk_fma_f16 v186, v186, v58, s23 op_sel:[0,0,1]
  v_pk_fma_f16 v187, v187, v59, s23 op_sel:[0,0,1]
  v_mfma_f32_32x32x16_bf16 v[16:31], a[192:195], v[160:163], 0
  ds_read_b128 v[192:195], v0 offset:49152
  ds_read_b128 v[196:199], v0 offset:50176
  v_pk_fma_f16 v184, v184, v48, 0.5 op_sel_hi:[1,1,0] clamp
  v_pk_fma_f16 v185, v185, v49, 0.5 op_sel_hi:[1,1,0] clamp
  v_pk_fma_f16 v186, v186, v50, 0.5 op_sel_hi:[1,1,0] clamp
  v_pk_fma_f16 v187, v187, v51, 0.5 op_sel_hi:[1,1,0] clamp
  v_mfma_f32_16x16x32_bf16 v[120:123], v[216:219], v[220:223], 0
  ds_read_b128 v[216:219], v3 offset:1200
  ds_read_b128 v[220:223], v4 offset:48
  v_mfma_f32_32x32x16_bf16 v[16:31], a[196:199], v[164:167], v[16:31]
  ds_read_b128 v[200:203], v0 offset:51200
  ds_read_b128 v[204:207], v0 offset:52224
  v_pk_mul_f16 v184, v184, v48
  v_pk_mul_f16 v185, v185, v49
  v_pk_mul_f16 v186, v186, v50
  v_pk_mul_f16 v187, v187, v51
  v_mfma_f32_16x16x32_bf16 v[120:123], v[224:227], v[228:231], v[120:123]
  ds_read_b128 v[224:227], v3 offset:6000
  ds_read_b128 v[228:231], v4 offset:240
  v_mfma_f32_32x32x16_bf16 v[16:31], a[200:203], v[168:171], v[16:31]
  ds_read_b128 v[208:211], v0 offset:53248
  ds_read_b128 v[212:215], v0 offset:54272
  v_pk_fma_f16 v56, v52, v52, s23 op_sel_hi:[1,1,0]
  v_pk_fma_f16 v57, v53, v53, s23 op_sel_hi:[1,1,0]
  v_pk_fma_f16 v58, v54, v54, s23 op_sel_hi:[1,1,0]
  v_pk_fma_f16 v59, v55, v55, s23 op_sel_hi:[1,1,0]
  v_mfma_f32_16x16x32_bf16 v[120:123], v[232:235], v[236:239], v[120:123]
  ds_read_b128 v[232:235], v3 offset:10800
  ds_read_b128 v[236:239], v4 offset:432
  v_mfma_f32_32x32x16_bf16 v[16:31], a[204:207], v[172:175], v[16:31]
  v_pk_fma_f16 v188, v56, s20, s20 op_sel:[0,1,0] op_sel_hi:[1,1,0]
  v_pk_fma_f16 v189, v57, s20, s20 op_sel:[0,1,0] op_sel_hi:[1,1,0]
  v_pk_fma_f16 v190, v58, s20, s20 op_sel:[0,1,0] op_sel_hi:[1,1,0]
  v_pk_fma_f16 v191, v59, s20, s20 op_sel:[0,1,0] op_sel_hi:[1,1,0]
  v_pk_fma_f16 v188, v188, v56, s21 op_sel:[0,0,1]
  v_pk_fma_f16 v189, v189, v57, s21 op_sel:[0,0,1]
  v_mfma_f32_32x32x16_bf16 v[16:31], a[208:211], v[176:179], v[16:31]
  v_pk_fma_f16 v190, v190, v58, s21 op_sel:[0,0,1]
  v_pk_fma_f16 v191, v191, v59, s21 op_sel:[0,0,1]
  v_pk_fma_f16 v188, v188, v56, s21 op_sel_hi:[1,1,0]
  v_pk_fma_f16 v189, v189, v57, s21 op_sel_hi:[1,1,0]
  v_pk_fma_f16 v190, v190, v58, s21 op_sel_hi:[1,1,0]
  v_pk_fma_f16 v191, v191, v59, s21 op_sel_hi:[1,1,0]
  v_mfma_f32_32x32x16_bf16 v[16:31], a[212:215], v[180:183], v[16:31]
  s_nop 0
  s_waitcnt lgkmcnt(0)
  v_pk_fma_f16 v188, v188, v56, s23 op_sel:[0,0,1]
  v_pk_fma_f16 v189, v189, v57, s23 op_sel:[0,0,1]
  v_pk_fma_f16 v190, v190, v58, s23 op_sel:[0,0,1]
  v_pk_fma_f16 v191, v191, v59, s23 op_sel:[0,0,1]
  v_pk_fma_f16 v188, v188, v52, 0.5 op_sel_hi:[1,1,0] clamp
  v_pk_fma_f16 v189, v189, v53, 0.5 op_sel_hi:[1,1,0] clamp
  v_mfma_f32_32x32x16_f16 v[64:79], v[192:195], v[184:187], v[64:79]
  v_pk_fma_f16 v190, v190, v54, 0.5 op_sel_hi:[1,1,0] clamp
  v_pk_fma_f16 v191, v191, v55, 0.5 op_sel_hi:[1,1,0] clamp
  v_pk_mul_f16 v188, v188, v52
  v_pk_mul_f16 v189, v189, v53
  v_pk_mul_f16 v190, v190, v54
  v_pk_mul_f16 v191, v191, v55
  v_mfma_f32_16x16x32_bf16 v[124:127], v[216:219], v[220:223], 0
  ds_read_b128 v[216:219], v3 offset:1600
  ds_read_b128 v[220:223], v4 offset:64
  v_mfma_f32_32x32x16_f16 v[80:95], v[196:199], v[184:187], v[80:95]
  v_cvt_pk_f16_f32 v48, v16, v17
  v_cvt_pk_f16_f32 v49, v18, v19
  v_cvt_pk_f16_f32 v50, v20, v21
  v_cvt_pk_f16_f32 v51, v22, v23
  v_cvt_pk_f16_f32 v52, v24, v25
  v_cvt_pk_f16_f32 v53, v26, v27
  v_mfma_f32_16x16x32_bf16 v[124:127], v[224:227], v[228:231], v[124:127]
  ds_read_b128 v[224:227], v3 offset:6400
  ds_read_b128 v[228:231], v4 offset:256
  v_mfma_f32_32x32x16_f16 v[96:111], v[200:203], v[184:187], v[96:111]
  v_cvt_pk_f16_f32 v54, v28, v29
  v_cvt_pk_f16_f32 v55, v30, v31
  v_pk_fma_f16 v56, v48, v48, s23 op_sel_hi:[1,1,0]
  v_pk_fma_f16 v57, v49, v49, s23 op_sel_hi:[1,1,0]
  v_pk_fma_f16 v58, v50, v50, s23 op_sel_hi:[1,1,0]
  v_pk_fma_f16 v59, v51, v51, s23 op_sel_hi:[1,1,0]
  v_mfma_f32_16x16x32_bf16 v[124:127], v[232:235], v[236:239], v[124:127]
  ds_read_b128 v[232:235], v3 offset:11200
  ds_read_b128 v[236:239], v4 offset:448
  v_mfma_f32_32x32x16_f16 v[64:79], v[204:207], v[188:191], v[64:79]
  v_pk_fma_f16 v184, v56, s20, s20 op_sel:[0,1,0] op_sel_hi:[1,1,0]
  v_pk_fma_f16 v185, v57, s20, s20 op_sel:[0,1,0] op_sel_hi:[1,1,0]
  v_pk_fma_f16 v186, v58, s20, s20 op_sel:[0,1,0] op_sel_hi:[1,1,0]
  v_pk_fma_f16 v187, v59, s20, s20 op_sel:[0,1,0] op_sel_hi:[1,1,0]
  v_pk_fma_f16 v184, v184, v56, s21 op_sel:[0,0,1]
  v_pk_fma_f16 v185, v185, v57, s21 op_sel:[0,0,1]
  v_mfma_f32_32x32x16_f16 v[80:95], v[208:211], v[188:191], v[80:95]
  v_pk_fma_f16 v186, v186, v58, s21 op_sel:[0,0,1]
  v_pk_fma_f16 v187, v187, v59, s21 op_sel:[0,0,1]
  v_pk_fma_f16 v184, v184, v56, s21 op_sel_hi:[1,1,0]
  v_pk_fma_f16 v185, v185, v57, s21 op_sel_hi:[1,1,0]
  v_pk_fma_f16 v186, v186, v58, s21 op_sel_hi:[1,1,0]
  v_pk_fma_f16 v187, v187, v59, s21 op_sel_hi:[1,1,0]
  v_mfma_f32_32x32x16_f16 v[96:111], v[212:215], v[188:191], v[96:111]
  s_nop 0
  s_waitcnt lgkmcnt(0)
  v_pk_fma_f16 v184, v184, v56, s23 op_sel:[0,0,1]
  v_pk_fma_f16 v185, v185, v57, s23 op_sel:[0,0,1]
  v_pk_fma_f16 v186, v186, v58, s23 op_sel:[0,0,1]
  v_pk_fma_f16 v187, v187, v59, s23 op_sel:[0,0,1]
  v_pk_fma_f16 v184, v184, v48, 0.5 op_sel_hi:[1,1,0] clamp
  v_pk_fma_f16 v185, v185, v49, 0.5 op_sel_hi:[1,1,0] clamp
  v_mfma_f32_32x32x16_bf16 v[16:31], a[216:219], v[160:163], 0
  ds_read_b128 v[192:195], v0 offset:55296
  ds_read_b128 v[196:199], v0 offset:56320
  v_pk_fma_f16 v186, v186, v50, 0.5 op_sel_hi:[1,1,0] clamp
  v_pk_fma_f16 v187, v187, v51, 0.5 op_sel_hi:[1,1,0] clamp
  v_pk_mul_f16 v184, v184, v48
  v_pk_mul_f16 v185, v185, v49
  v_mfma_f32_16x16x32_bf16 v[128:131], v[216:219], v[220:223], 0
  ds_read_b128 v[216:219], v3 offset:2000
  ds_read_b128 v[220:223], v4 offset:80
  v_mfma_f32_32x32x16_bf16 v[16:31], a[220:223], v[164:167], v[16:31]
  ds_read_b128 v[200:203], v0 offset:57344
  ds_read_b128 v[204:207], v0 offset:58368
  v_pk_mul_f16 v186, v186, v50
  v_pk_mul_f16 v187, v187, v51
  v_pk_fma_f16 v56, v52, v52, s23 op_sel_hi:[1,1,0]
  v_pk_fma_f16 v57, v53, v53, s23 op_sel_hi:[1,1,0]
  v_mfma_f32_16x16x32_bf16 v[128:131], v[224:227], v[228:231], v[128:131]
  ds_read_b128 v[224:227], v3 offset:6800
  ds_read_b128 v[228:231], v4 offset:272
  v_mfma_f32_32x32x16_bf16 v[16:31], a[224:227], v[168:171], v[16:31]
  ds_read_b128 v[208:211], v0 offset:59392
  ds_read_b128 v[212:215], v0 offset:60416
  v_pk_fma_f16 v58, v54, v54, s23 op_sel_hi:[1,1,0]
  v_pk_fma_f16 v59, v55, v55, s23 op_sel_hi:[1,1,0]
  v_pk_fma_f16 v188, v56, s20, s20 op_sel:[0,1,0] op_sel_hi:[1,1,0]
  v_pk_fma_f16 v189, v57, s20, s20 op_sel:[0,1,0] op_sel_hi:[1,1,0]
  v_mfma_f32_16x16x32_bf16 v[128:131], v[232:235], v[236:239], v[128:131]
  ds_read_b128 v[232:235], v3 offset:11600
  ds_read_b128 v[236:239], v4 offset:464
  v_mfma_f32_32x32x16_bf16 v[16:31], a[228:231], v[172:175], v[16:31]
  v_pk_fma_f16 v190, v58, s20, s20 op_sel:[0,1,0] op_sel_hi:[1,1,0]
  v_pk_fma_f16 v191, v59, s20, s20 op_sel:[0,1,0] op_sel_hi:[1,1,0]
  v_pk_fma_f16 v188, v188, v56, s21 op_sel:[0,0,1]
  v_pk_fma_f16 v189, v189, v57, s21 op_sel:[0,0,1]
  v_pk_fma_f16 v190, v190, v58, s21 op_sel:[0,0,1]
  v_pk_fma_f16 v191, v191, v59, s21 op_sel:[0,0,1]
  v_mfma_f32_32x32x16_bf16 v[16:31], a[232:235], v[176:179], v[16:31]
  v_pk_fma_f16 v188, v188, v56, s21 op_sel_hi:[1,1,0]
  v_pk_fma_f16 v189, v189, v57, s21 op_sel_hi:[1,1,0]
  v_pk_fma_f16 v190, v190, v58, s21 op_sel_hi:[1,1,0]
  v_pk_fma_f16 v191, v191, v59, s21 op_sel_hi:[1,1,0]
  v_pk_fma_f16 v188, v188, v56, s23 op_sel:[0,0,1]
  v_pk_fma_f16 v189, v189, v57, s23 op_sel:[0,0,1]
  v_mfma_f32_32x32x16_bf16 v[16:31], a[236:239], v[180:183], v[16:31]
  s_nop 0
  s_waitcnt lgkmcnt(0)
  v_pk_fma_f16 v190, v190, v58, s23 op_sel:[0,0,1]
  v_pk_fma_f16 v191, v191, v59, s23 op_sel:[0,0,1]
  v_pk_fma_f16 v188, v188, v52, 0.5 op_sel_hi:[1,1,0] clamp
  v_pk_fma_f16 v189, v189, v53, 0.5 op_sel_hi:[1,1,0] clamp
  v_pk_fma_f16 v190, v190, v54, 0.5 op_sel_hi:[1,1,0] clamp
  v_pk_fma_f16 v191, v191, v55, 0.5 op_sel_hi:[1,1,0] clamp
  v_mfma_f32_32x32x16_f16 v[64:79], v[192:195], v[184:187], v[64:79]
  v_pk_mul_f16 v188, v188, v52
  v_pk_mul_f16 v189, v189, v53
  v_pk_mul_f16 v190, v190, v54
  v_pk_mul_f16 v191, v191, v55
  v_mfma_f32_16x16x32_bf16 v[132:135], v[216:219], v[220:223], 0
  v_cvt_pk_f16_f32 v48, v16, v17
  v_cvt_pk_f16_f32 v49, v18, v19
  v_mfma_f32_32x32x16_f16 v[80:95], v[196:199], v[184:187], v[80:95]
  v_cvt_pk_f16_f32 v50, v20, v21
  v_cvt_pk_f16_f32 v51, v22, v23
  v_cvt_pk_f16_f32 v52, v24, v25
  v_cvt_pk_f16_f32 v53, v26, v27
  v_cvt_pk_f16_f32 v54, v28, v29
  v_cvt_pk_f16_f32 v55, v30, v31
  v_mfma_f32_16x16x32_bf16 v[132:135], v[224:227], v[228:231], v[132:135]
  v_pk_fma_f16 v56, v48, v48, s23 op_sel_hi:[1,1,0]
  v_pk_fma_f16 v57, v49, v49, s23 op_sel_hi:[1,1,0]
  v_mfma_f32_32x32x16_f16 v[96:111], v[200:203], v[184:187], v[96:111]
  v_pk_fma_f16 v58, v50, v50, s23 op_sel_hi:[1,1,0]
  v_pk_fma_f16 v59, v51, v51, s23 op_sel_hi:[1,1,0]
  v_pk_fma_f16 v184, v56, s20, s20 op_sel:[0,1,0] op_sel_hi:[1,1,0]
  v_pk_fma_f16 v185, v57, s20, s20 op_sel:[0,1,0] op_sel_hi:[1,1,0]
  v_pk_fma_f16 v186, v58, s20, s20 op_sel:[0,1,0] op_sel_hi:[1,1,0]
  v_pk_fma_f16 v187, v59, s20, s20 op_sel:[0,1,0] op_sel_hi:[1,1,0]
  v_mfma_f32_16x16x32_bf16 v[132:135], v[232:235], v[236:239], v[132:135]
  ds_read_b128 v[236:239], v0 offset:17408
  v_pk_fma_f16 v184, v184, v56, s21 op_sel:[0,0,1]
  v_mfma_f32_32x32x16_f16 v[64:79], v[204:207], v[188:191], v[64:79]
  s_nop 0
  s_mov_b32 s28, s34
  v_pk_fma_f16 v185, v185, v57, s21 op_sel:[0,0,1]
  v_pk_fma_f16 v186, v186, v58, s21 op_sel:[0,0,1]
  v_pk_fma_f16 v187, v187, v59, s21 op_sel:[0,0,1]
  v_pk_fma_f16 v184, v184, v56, s21 op_sel_hi:[1,1,0]
  v_pk_fma_f16 v185, v185, v57, s21 op_sel_hi:[1,1,0]
  v_pk_fma_f16 v186, v186, v58, s21 op_sel_hi:[1,1,0]
  v_pk_fma_f16 v187, v187, v59, s21 op_sel_hi:[1,1,0]
  v_mfma_f32_32x32x16_f16 v[80:95], v[208:211], v[188:191], v[80:95]
  s_add_u32 s34, s34, 0x60000
  v_pk_fma_f16 v184, v184, v56, s23 op_sel:[0,0,1]
  v_pk_fma_f16 v185, v185, v57, s23 op_sel:[0,0,1]
  v_pk_fma_f16 v186, v186, v58, s23 op_sel:[0,0,1]
  v_pk_fma_f16 v187, v187, v59, s23 op_sel:[0,0,1]
  v_pk_fma_f16 v184, v184, v48, 0.5 op_sel_hi:[1,1,0] clamp
  v_pk_fma_f16 v185, v185, v49, 0.5 op_sel_hi:[1,1,0] clamp
  v_pk_fma_f16 v186, v186, v50, 0.5 op_sel_hi:[1,1,0] clamp
  v_mfma_f32_32x32x16_f16 v[96:111], v[212:215], v[188:191], v[96:111]
  s_nop 0
  s_waitcnt lgkmcnt(0)
  v_pk_fma_f16 v187, v187, v51, 0.5 op_sel_hi:[1,1,0] clamp
  v_pk_mul_f16 v184, v184, v48
  v_pk_mul_f16 v185, v185, v49
  v_pk_mul_f16 v186, v186, v50
  v_pk_mul_f16 v187, v187, v51
  v_pk_fma_f16 v56, v52, v52, s23 op_sel_hi:[1,1,0]
  v_pk_fma_f16 v57, v53, v53, s23 op_sel_hi:[1,1,0]
  v_mfma_f32_32x32x16_bf16 v[16:31], v[32:35], v[160:163], 0
  ds_read_b128 v[192:195], v0 offset:61440
  ds_read_b128 v[196:199], v0 offset:62464
  v_pk_fma_f16 v58, v54, v54, s23 op_sel_hi:[1,1,0]
  v_pk_fma_f16 v59, v55, v55, s23 op_sel_hi:[1,1,0]
  v_pk_fma_f16 v188, v56, s20, s20 op_sel:[0,1,0] op_sel_hi:[1,1,0]
  v_pk_fma_f16 v189, v57, s20, s20 op_sel:[0,1,0] op_sel_hi:[1,1,0]
  v_pk_fma_f16 v190, v58, s20, s20 op_sel:[0,1,0] op_sel_hi:[1,1,0]
  v_pk_fma_f16 v191, v59, s20, s20 op_sel:[0,1,0] op_sel_hi:[1,1,0]
  v_pk_fma_f16 v188, v188, v56, s21 op_sel:[0,0,1]
  v_pk_fma_f16 v189, v189, v57, s21 op_sel:[0,0,1]
  v_pk_add_f32 v[12:13], v[112:113], v[114:115]
  v_pk_mul_f32 v[14:15], v[112:113], v[112:113]
  v_pk_fma_f32 v[14:15], v[114:115], v[114:115], v[14:15]
  v_pk_add_f32 v[12:13], v[12:13], v[116:117]
  v_pk_fma_f32 v[14:15], v[116:117], v[116:117], v[14:15]
  v_pk_add_f32 v[12:13], v[12:13], v[118:119]
  v_pk_fma_f32 v[14:15], v[118:119], v[118:119], v[14:15]
  v_pk_add_f32 v[12:13], v[12:13], v[120:121]
  v_pk_fma_f32 v[14:15], v[120:121], v[120:121], v[14:15]
  v_pk_add_f32 v[12:13], v[12:13], v[122:123]
  v_pk_fma_f32 v[14:15], v[122:123], v[122:123], v[14:15]
  v_pk_add_f32 v[12:13], v[12:13], v[124:125]
  v_pk_fma_f32 v[14:15], v[124:125], v[124:125], v[14:15]
  v_pk_add_f32 v[12:13], v[12:13], v[126:127]
  v_pk_fma_f32 v[14:15], v[126:127], v[126:127], v[14:15]
  v_pk_add_f32 v[12:13], v[12:13], v[128:129]
  v_pk_fma_f32 v[14:15], v[128:129], v[128:129], v[14:15]
  v_pk_add_f32 v[12:13], v[12:13], v[130:131]
  v_pk_fma_f32 v[14:15], v[130:131], v[130:131], v[14:15]
  v_pk_add_f32 v[12:13], v[12:13], v[132:133]
  v_pk_fma_f32 v[14:15], v[132:133], v[132:133], v[14:15]
  v_pk_add_f32 v[12:13], v[12:13], v[134:135]
  v_pk_fma_f32 v[14:15], v[134:135], v[134:135], v[14:15]
  v_pk_add_f32 v[12:13], v[12:13], v[136:137]
  v_pk_fma_f32 v[14:15], v[136:137], v[136:137], v[14:15]
  v_pk_add_f32 v[12:13], v[12:13], v[138:139]
  v_pk_fma_f32 v[14:15], v[138:139], v[138:139], v[14:15]
  v_pk_add_f32 v[12:13], v[12:13], v[140:141]
  v_pk_fma_f32 v[14:15], v[140:141], v[140:141], v[14:15]
  v_pk_add_f32 v[12:13], v[12:13], v[142:143]
  v_pk_fma_f32 v[14:15], v[142:143], v[142:143], v[14:15]
  v_pk_add_f32 v[12:13], v[12:13], v[144:145]
  v_pk_fma_f32 v[14:15], v[144:145], v[144:145], v[14:15]
  v_pk_add_f32 v[12:13], v[12:13], v[146:147]
  v_pk_fma_f32 v[14:15], v[146:147], v[146:147], v[14:15]
  v_pk_add_f32 v[12:13], v[12:13], v[148:149]
  v_pk_fma_f32 v[14:15], v[148:149], v[148:149], v[14:15]
  v_pk_add_f32 v[12:13], v[12:13], v[150:151]
  v_pk_fma_f32 v[14:15], v[150:151], v[150:151], v[14:15]
  v_pk_add_f32 v[12:13], v[12:13], v[152:153]
  v_pk_fma_f32 v[14:15], v[152:153], v[152:153], v[14:15]
  v_pk_add_f32 v[12:13], v[12:13], v[154:155]
  v_pk_fma_f32 v[14:15], v[154:155], v[154:155], v[14:15]
  v_pk_add_f32 v[12:13], v[12:13], v[156:157]
  v_pk_fma_f32 v[14:15], v[156:157], v[156:157], v[14:15]
  v_pk_add_f32 v[12:13], v[12:13], v[158:159]
  v_pk_fma_f32 v[14:15], v[158:159], v[158:159], v[14:15]
  v_mfma_f32_32x32x16_bf16 v[16:31], v[36:39], v[164:167], v[16:31]
  ds_read_b128 v[200:203], v0 offset:63488
  ds_read_b128 v[204:207], v0 offset:64512
  v_add_f32 v12, v12, v13
  v_add_f32 v14, v14, v15
  s_nop 1
  v_permlane32_swap_b32 v12, v14
  v_pk_fma_f16 v190, v190, v58, s21 op_sel:[0,0,1]
  v_mfma_f32_32x32x16_bf16 v[16:31], v[40:43], v[168:171], v[16:31]
  ds_read_b128 v[208:211], v1
  ds_read_b128 v[212:215], v1 offset:1024
  v_add_f32 v12, v12, v14
  v_mov_b32 v14, v12
  s_nop 1
  v_permlane32_swap_b32 v12, v14
  v_mul_f32_e64 v12, s24, v12
  v_mfma_f32_32x32x16_bf16 v[16:31], v[44:47], v[172:175], v[16:31]
  v_pk_fma_f16 v191, v191, v59, s21 op_sel:[0,0,1]
  v_pk_fma_f16 v188, v188, v56, s21 op_sel_hi:[1,1,0]
  v_mul_f32_e64 v13, s24, v14
  v_pk_fma_f16 v189, v189, v57, s21 op_sel_hi:[1,1,0]
  v_fma_f32 v13, -v12, v12, v13
  v_pk_fma_f16 v190, v190, v58, s21 op_sel_hi:[1,1,0]
  v_max_f32_e64 v13, 0, v13
  v_mfma_f32_32x32x16_bf16 v[16:31], v[60:63], v[176:179], v[16:31]
  v_add_f32 v13, s25, v13
  v_rsq_f32 v13, v13
  v_pk_fma_f16 v191, v191, v59, s21 op_sel_hi:[1,1,0]
  v_mul_f32 v14, s22, v13
  v_mul_f32_e64 v12, -v12, v14
  v_pk_fma_f16 v188, v188, v56, s23 op_sel:[0,0,1]
  v_mfma_f32_32x32x16_bf16 v[16:31], v[236:239], v[180:183], v[16:31]
  s_waitcnt lgkmcnt(0)
  v_pk_fma_f16 v189, v189, v57, s23 op_sel:[0,0,1]
  v_pk_fma_f16 v190, v190, v58, s23 op_sel:[0,0,1]
  v_pk_fma_f16 v191, v191, v59, s23 op_sel:[0,0,1]
  v_pk_fma_f16 v188, v188, v52, 0.5 op_sel_hi:[1,1,0] clamp
  v_pk_fma_f16 v189, v189, v53, 0.5 op_sel_hi:[1,1,0] clamp
  v_pk_fma_f16 v190, v190, v54, 0.5 op_sel_hi:[1,1,0] clamp
  v_pk_fma_f16 v191, v191, v55, 0.5 op_sel_hi:[1,1,0] clamp
  v_pk_mul_f16 v188, v188, v52
  v_pk_mul_f16 v189, v189, v53
  v_pk_mul_f16 v190, v190, v54
  v_pk_mul_f16 v191, v191, v55
  v_pk_fma_f32 v[112:113], v[112:113], v[14:15], v[12:13] op_sel_hi:[1,0,0]
  v_pk_fma_f32 v[114:115], v[114:115], v[14:15], v[12:13] op_sel_hi:[1,0,0]
  v_pk_fma_f32 v[116:117], v[116:117], v[14:15], v[12:13] op_sel_hi:[1,0,0]
  v_pk_fma_f32 v[118:119], v[118:119], v[14:15], v[12:13] op_sel_hi:[1,0,0]
  v_pk_fma_f32 v[120:121], v[120:121], v[14:15], v[12:13] op_sel_hi:[1,0,0]
  v_pk_fma_f32 v[122:123], v[122:123], v[14:15], v[12:13] op_sel_hi:[1,0,0]
  v_pk_fma_f32 v[124:125], v[124:125], v[14:15], v[12:13] op_sel_hi:[1,0,0]
  v_pk_fma_f32 v[126:127], v[126:127], v[14:15], v[12:13] op_sel_hi:[1,0,0]
  v_pk_fma_f32 v[128:129], v[128:129], v[14:15], v[12:13] op_sel_hi:[1,0,0]
  v_pk_fma_f32 v[130:131], v[130:131], v[14:15], v[12:13] op_sel_hi:[1,0,0]
  v_pk_fma_f32 v[132:133], v[132:133], v[14:15], v[12:13] op_sel_hi:[1,0,0]
  v_pk_fma_f32 v[134:135], v[134:135], v[14:15], v[12:13] op_sel_hi:[1,0,0]
  v_pk_fma_f32 v[136:137], v[136:137], v[14:15], v[12:13] op_sel_hi:[1,0,0]
  v_pk_fma_f32 v[138:139], v[138:139], v[14:15], v[12:13] op_sel_hi:[1,0,0]
  v_pk_fma_f32 v[140:141], v[140:141], v[14:15], v[12:13] op_sel_hi:[1,0,0]
  v_pk_fma_f32 v[142:143], v[142:143], v[14:15], v[12:13] op_sel_hi:[1,0,0]
  v_pk_fma_f32 v[144:145], v[144:145], v[14:15], v[12:13] op_sel_hi:[1,0,0]
  v_pk_fma_f32 v[146:147], v[146:147], v[14:15], v[12:13] op_sel_hi:[1,0,0]
  v_pk_fma_f32 v[148:149], v[148:149], v[14:15], v[12:13] op_sel_hi:[1,0,0]
  v_pk_fma_f32 v[150:151], v[150:151], v[14:15], v[12:13] op_sel_hi:[1,0,0]
  v_pk_fma_f32 v[152:153], v[152:153], v[14:15], v[12:13] op_sel_hi:[1,0,0]
  v_pk_fma_f32 v[154:155], v[154:155], v[14:15], v[12:13] op_sel_hi:[1,0,0]
  v_pk_fma_f32 v[156:157], v[156:157], v[14:15], v[12:13] op_sel_hi:[1,0,0]
  v_pk_fma_f32 v[158:159], v[158:159], v[14:15], v[12:13] op_sel_hi:[1,0,0]
  v_mfma_f32_32x32x16_f16 v[64:79], v[192:195], v[184:187], v[64:79]
  ds_read_b128 v[216:219], v0 offset:18432
  ds_read_b128 v[220:223], v0 offset:19456
  v_cndmask_b32 v159, v159, v250, s[12:13]
  v_cvt_pk_bf16_f32 v160, v112, v113
  v_cvt_pk_bf16_f32 v161, v114, v115
  v_cvt_pk_bf16_f32 v162, v116, v117
  v_cvt_pk_f16_f32 v48, v16, v17
  v_mfma_f32_32x32x16_f16 v[80:95], v[196:199], v[184:187], v[80:95]
  ds_read_b128 v[224:227], v0 offset:20480
  ds_read_b128 v[228:231], v0 offset:21504
  v_cvt_pk_bf16_f32 v163, v118, v119
  v_cvt_pk_bf16_f32 v164, v120, v121
  v_cvt_pk_bf16_f32 v165, v122, v123
  v_cvt_pk_bf16_f32 v166, v124, v125
  v_cvt_pk_f16_f32 v49, v18, v19
  v_mfma_f32_32x32x16_f16 v[96:111], v[200:203], v[184:187], v[96:111]
  ds_read_b128 v[232:235], v0 offset:22528
  ds_read_b128 v[236:239], v0 offset:23552
  v_cvt_pk_bf16_f32 v167, v126, v127
  v_cvt_pk_bf16_f32 v168, v128, v129
  v_cvt_pk_bf16_f32 v169, v130, v131
  v_cvt_pk_bf16_f32 v170, v132, v133
  v_cvt_pk_f16_f32 v50, v20, v21
  v_mfma_f32_32x32x16_f16 v[64:79], v[204:207], v[188:191], v[64:79]
  v_cvt_pk_bf16_f32 v171, v134, v135
  v_cvt_pk_bf16_f32 v172, v136, v137
  v_cvt_pk_f16_f32 v51, v22, v23
  v_cvt_pk_bf16_f32 v173, v138, v139
  v_cvt_pk_f16_f32 v52, v24, v25
  v_cvt_pk_bf16_f32 v174, v140, v141
  v_cvt_pk_f16_f32 v53, v26, v27
  v_mfma_f32_32x32x16_f16 v[80:95], v[208:211], v[188:191], v[80:95]
  v_cvt_pk_bf16_f32 v175, v142, v143
  v_cvt_pk_bf16_f32 v176, v144, v145
  v_cvt_pk_f16_f32 v54, v28, v29
  v_cvt_pk_bf16_f32 v177, v146, v147
  v_cvt_pk_f16_f32 v55, v30, v31
  v_cvt_pk_bf16_f32 v178, v148, v149
  v_pk_fma_f16 v56, v48, v48, s23 op_sel_hi:[1,1,0]
  v_mfma_f32_32x32x16_f16 v[96:111], v[212:215], v[188:191], v[96:111]
  s_nop 0
  s_waitcnt lgkmcnt(0)
  v_cvt_pk_bf16_f32 v179, v150, v151
  v_cvt_pk_bf16_f32 v180, v152, v153
  v_pk_fma_f16 v57, v49, v49, s23 op_sel_hi:[1,1,0]
  v_cvt_pk_bf16_f32 v181, v154, v155
  v_cvt_pk_bf16_f32 v182, v156, v157
  v_pk_fma_f16 v58, v50, v50, s23 op_sel_hi:[1,1,0]
  v_cvt_pk_bf16_f32 v183, v158, v159
  v_pk_fma_f16 v59, v51, v51, s23 op_sel_hi:[1,1,0]
  s_mov_b32 s26, 6
  .p2align 6
  s_nop 0
  s_waitcnt vmcnt(0)
L_loop:
  v_mfma_f32_32x32x16_bf16 v[16:31], v[216:219], v[160:163], 0
  ds_read_b128 v[192:195], v1 offset:2048
  ds_read_b128 v[196:199], v1 offset:3072
  ds_read_b128 v[200:203], v1 offset:4096
  v_pk_fma_f16 v184, v56, s20, s20 op_sel:[0,1,0] op_sel_hi:[1,1,0]
  v_pk_fma_f16 v185, v57, s20, s20 op_sel:[0,1,0] op_sel_hi:[1,1,0]
  v_pk_fma_f16 v186, v58, s20, s20 op_sel:[0,1,0] op_sel_hi:[1,1,0]
  v_pk_fma_f16 v187, v59, s20, s20 op_sel:[0,1,0] op_sel_hi:[1,1,0]
  v_pk_fma_f16 v184, v184, v56, s21 op_sel:[0,0,1]
  v_mfma_f32_32x32x16_bf16 v[16:31], v[220:223], v[164:167], v[16:31]
  ds_read_b128 v[204:207], v1 offset:5120
  ds_read_b128 v[208:211], v1 offset:6144
  ds_read_b128 v[212:215], v1 offset:7168
  v_pk_fma_f16 v185, v185, v57, s21 op_sel:[0,0,1]
  v_pk_fma_f16 v186, v186, v58, s21 op_sel:[0,0,1]
  v_pk_fma_f16 v187, v187, v59, s21 op_sel:[0,0,1]
  v_pk_fma_f16 v184, v184, v56, s21 op_sel_hi:[1,1,0]
  v_pk_fma_f16 v185, v185, v57, s21 op_sel_hi:[1,1,0]
  v_pk_fma_f16 v186, v186, v58, s21 op_sel_hi:[1,1,0]
  v_mfma_f32_32x32x16_bf16 v[16:31], v[224:227], v[168:171], v[16:31]
  ds_read_b128 v[136:139], v5
  ds_read_b128 v[140:143], v5 offset:32
  ds_read_b128 v[144:147], v5 offset:64
  v_pk_fma_f16 v187, v187, v59, s21 op_sel_hi:[1,1,0]
  v_pk_fma_f16 v184, v184, v56, s23 op_sel:[0,0,1]
  v_pk_fma_f16 v185, v185, v57, s23 op_sel:[0,0,1]
  v_pk_fma_f16 v186, v186, v58, s23 op_sel:[0,0,1]
  v_pk_fma_f16 v187, v187, v59, s23 op_sel:[0,0,1]
  v_pk_fma_f16 v184, v184, v48, 0.5 op_sel_hi:[1,1,0] clamp
  v_mfma_f32_32x32x16_bf16 v[16:31], v[228:231], v[172:175], v[16:31]
  ds_read_b128 v[148:151], v5 offset:96
  ds_read_b128 v[152:155], v5 offset:128
  ds_read_b128 v[156:159], v5 offset:160
  v_pk_fma_f16 v185, v185, v49, 0.5 op_sel_hi:[1,1,0] clamp
  v_pk_fma_f16 v186, v186, v50, 0.5 op_sel_hi:[1,1,0] clamp
  v_pk_fma_f16 v187, v187, v51, 0.5 op_sel_hi:[1,1,0] clamp
  v_pk_mul_f16 v184, v184, v48
  v_pk_mul_f16 v185, v185, v49
  v_pk_mul_f16 v186, v186, v50
  v_mfma_f32_32x32x16_bf16 v[16:31], v[232:235], v[176:179], v[16:31]
  v_pk_mul_f16 v187, v187, v51
  v_pk_fma_f16 v56, v52, v52, s23 op_sel_hi:[1,1,0]
  v_pk_fma_f16 v57, v53, v53, s23 op_sel_hi:[1,1,0]
  v_pk_fma_f16 v58, v54, v54, s23 op_sel_hi:[1,1,0]
  v_pk_fma_f16 v59, v55, v55, s23 op_sel_hi:[1,1,0]
  v_pk_fma_f16 v188, v56, s20, s20 op_sel:[0,1,0] op_sel_hi:[1,1,0]
  v_pk_fma_f16 v189, v57, s20, s20 op_sel:[0,1,0] op_sel_hi:[1,1,0]
  v_pk_fma_f16 v190, v58, s20, s20 op_sel:[0,1,0] op_sel_hi:[1,1,0]
  v_pk_fma_f16 v191, v59, s20, s20 op_sel:[0,1,0] op_sel_hi:[1,1,0]
  v_mfma_f32_32x32x16_bf16 v[16:31], v[236:239], v[180:183], v[16:31]
  s_nop 0
  s_waitcnt lgkmcnt(0)
  v_pk_fma_f16 v188, v188, v56, s21 op_sel:[0,0,1]
  v_pk_fma_f16 v189, v189, v57, s21 op_sel:[0,0,1]
  v_pk_fma_f16 v190, v190, v58, s21 op_sel:[0,0,1]
  v_pk_fma_f16 v191, v191, v59, s21 op_sel:[0,0,1]
  v_pk_fma_f16 v188, v188, v56, s21 op_sel_hi:[1,1,0]
  v_pk_fma_f16 v189, v189, v57, s21 op_sel_hi:[1,1,0]
  v_pk_fma_f16 v190, v190, v58, s21 op_sel_hi:[1,1,0]
  v_pk_fma_f16 v191, v191, v59, s21 op_sel_hi:[1,1,0]
  v_pk_fma_f16 v188, v188, v56, s23 op_sel:[0,0,1]
  v_mfma_f32_32x32x16_f16 v[64:79], v[192:195], v[184:187], v[64:79]
  s_nop 0
  s_mov_b32 m0, s30
  v_pk_fma_f16 v189, v189, v57, s23 op_sel:[0,0,1]
  v_pk_fma_f16 v190, v190, v58, s23 op_sel:[0,0,1]
  v_pk_fma_f16 v191, v191, v59, s23 op_sel:[0,0,1]
  v_pk_fma_f16 v188, v188, v52, 0.5 op_sel_hi:[1,1,0] clamp
  v_pk_fma_f16 v189, v189, v53, 0.5 op_sel_hi:[1,1,0] clamp
  v_pk_fma_f16 v190, v190, v54, 0.5 op_sel_hi:[1,1,0] clamp
  v_pk_fma_f16 v191, v191, v55, 0.5 op_sel_hi:[1,1,0] clamp
  v_pk_mul_f16 v188, v188, v52
  v_pk_mul_f16 v189, v189, v53
  v_pk_mul_f16 v190, v190, v54
  v_pk_mul_f16 v191, v191, v55
  v_mfma_f32_32x32x16_f16 v[80:95], v[196:199], v[184:187], v[80:95]
  buffer_load_dwordx4 v6, s[4:7], s29 offen lds
  v_cvt_pk_f16_f32 v48, v16, v17
  v_cvt_pk_f16_f32 v49, v18, v19
  v_cvt_pk_f16_f32 v50, v20, v21
  v_cvt_pk_f16_f32 v51, v22, v23
  v_cvt_pk_f16_f32 v52, v24, v25
  v_cvt_pk_f16_f32 v53, v26, v27
  v_cvt_pk_f16_f32 v54, v28, v29
  v_mfma_f32_32x32x16_f16 v[96:111], v[200:203], v[184:187], v[96:111]
  buffer_load_dwordx4 v7, s[4:7], s29 offen offset:1024 lds
  v_cvt_pk_f16_f32 v55, v30, v31
  v_pk_fma_f16 v56, v48, v48, s23 op_sel_hi:[1,1,0]
  v_pk_fma_f16 v57, v49, v49, s23 op_sel_hi:[1,1,0]
  v_pk_fma_f16 v58, v50, v50, s23 op_sel_hi:[1,1,0]
  v_pk_fma_f16 v59, v51, v51, s23 op_sel_hi:[1,1,0]
  v_pk_fma_f16 v184, v56, s20, s20 op_sel:[0,1,0] op_sel_hi:[1,1,0]
  v_pk_fma_f16 v185, v57, s20, s20 op_sel:[0,1,0] op_sel_hi:[1,1,0]
  v_mfma_f32_32x32x16_f16 v[64:79], v[204:207], v[188:191], v[64:79]
  buffer_load_dwordx4 v8, s[4:7], s29 offen offset:2048 lds
  v_pk_fma_f16 v186, v58, s20, s20 op_sel:[0,1,0] op_sel_hi:[1,1,0]
  v_pk_fma_f16 v187, v59, s20, s20 op_sel:[0,1,0] op_sel_hi:[1,1,0]
  v_pk_fma_f16 v184, v184, v56, s21 op_sel:[0,0,1]
  v_pk_fma_f16 v185, v185, v57, s21 op_sel:[0,0,1]
  v_pk_fma_f16 v186, v186, v58, s21 op_sel:[0,0,1]
  v_pk_fma_f16 v187, v187, v59, s21 op_sel:[0,0,1]
  v_pk_fma_f16 v184, v184, v56, s21 op_sel_hi:[1,1,0]
  v_pk_fma_f16 v185, v185, v57, s21 op_sel_hi:[1,1,0]
  v_mfma_f32_32x32x16_f16 v[80:95], v[208:211], v[188:191], v[80:95]
  buffer_load_dwordx4 v9, s[4:7], s29 offen offset:3072 lds
  v_pk_fma_f16 v186, v186, v58, s21 op_sel_hi:[1,1,0]
  v_pk_fma_f16 v187, v187, v59, s21 op_sel_hi:[1,1,0]
  v_pk_fma_f16 v184, v184, v56, s23 op_sel:[0,0,1]
  v_pk_fma_f16 v185, v185, v57, s23 op_sel:[0,0,1]
  v_pk_fma_f16 v186, v186, v58, s23 op_sel:[0,0,1]
  v_pk_fma_f16 v187, v187, v59, s23 op_sel:[0,0,1]
  v_pk_fma_f16 v184, v184, v48, 0.5 op_sel_hi:[1,1,0] clamp
  v_pk_fma_f16 v185, v185, v49, 0.5 op_sel_hi:[1,1,0] clamp
  v_mfma_f32_32x32x16_f16 v[96:111], v[212:215], v[188:191], v[96:111]
  v_pk_fma_f16 v186, v186, v50, 0.5 op_sel_hi:[1,1,0] clamp
  v_pk_fma_f16 v187, v187, v51, 0.5 op_sel_hi:[1,1,0] clamp
  v_pk_mul_f16 v184, v184, v48
  v_pk_mul_f16 v185, v185, v49
  v_pk_mul_f16 v186, v186, v50
  v_pk_mul_f16 v187, v187, v51
  v_pk_fma_f16 v56, v52, v52, s23 op_sel_hi:[1,1,0]
  v_pk_fma_f16 v57, v53, v53, s23 op_sel_hi:[1,1,0]
  v_pk_fma_f16 v58, v54, v54, s23 op_sel_hi:[1,1,0]
  v_mfma_f32_32x32x16_bf16 v[16:31], a[0:3], v[160:163], 0
  v_cvt_pk_bf16_f32 v112, v64, v65
  v_cvt_pk_bf16_f32 v113, v66, v67
  v_pk_fma_f16 v59, v55, v55, s23 op_sel_hi:[1,1,0]
  v_cvt_pk_bf16_f32 v114, v68, v69
  v_cvt_pk_bf16_f32 v115, v70, v71
  v_pk_fma_f16 v188, v56, s20, s20 op_sel:[0,1,0] op_sel_hi:[1,1,0]
  v_cvt_pk_bf16_f32 v116, v72, v73
  v_cvt_pk_bf16_f32 v117, v74, v75
  v_pk_fma_f16 v189, v57, s20, s20 op_sel:[0,1,0] op_sel_hi:[1,1,0]
  v_mfma_f32_32x32x16_bf16 v[16:31], a[4:7], v[164:167], v[16:31]
  v_cvt_pk_bf16_f32 v118, v76, v77
  v_cvt_pk_bf16_f32 v119, v78, v79
  v_pk_fma_f16 v190, v58, s20, s20 op_sel:[0,1,0] op_sel_hi:[1,1,0]
  v_cvt_pk_bf16_f32 v120, v80, v81
  v_cvt_pk_bf16_f32 v121, v82, v83
  v_pk_fma_f16 v191, v59, s20, s20 op_sel:[0,1,0] op_sel_hi:[1,1,0]
  v_cvt_pk_bf16_f32 v122, v84, v85
  v_cvt_pk_bf16_f32 v123, v86, v87
  v_pk_fma_f16 v188, v188, v56, s21 op_sel:[0,0,1]
  v_mfma_f32_32x32x16_bf16 v[16:31], a[8:11], v[168:171], v[16:31]
  ds_read_b128 v[64:67], v2
  ds_read_b128 v[68:71], v2 offset:32
  ds_read_b128 v[72:75], v2 offset:64
  ds_read_b128 v[76:79], v2 offset:96
  v_pk_fma_f16 v189, v189, v57, s21 op_sel:[0,0,1]
  v_pk_fma_f16 v190, v190, v58, s21 op_sel:[0,0,1]
  v_cvt_pk_bf16_f32 v124, v88, v89
  v_pk_fma_f16 v191, v191, v59, s21 op_sel:[0,0,1]
  v_cvt_pk_bf16_f32 v125, v90, v91
  v_mfma_f32_32x32x16_bf16 v[16:31], a[12:15], v[172:175], v[16:31]
  ds_read_b128 v[192:195], v1 offset:8192
  ds_read_b128 v[196:199], v1 offset:9216
  v_cvt_pk_bf16_f32 v126, v92, v93
  v_cvt_pk_bf16_f32 v127, v94, v95
  v_pk_fma_f16 v188, v188, v56, s21 op_sel_hi:[1,1,0]
  v_cvt_pk_bf16_f32 v128, v96, v97
  v_pk_fma_f16 v189, v189, v57, s21 op_sel_hi:[1,1,0]
  v_cvt_pk_bf16_f32 v129, v98, v99
  v_pk_fma_f16 v190, v190, v58, s21 op_sel_hi:[1,1,0]
  v_mfma_f32_32x32x16_bf16 v[16:31], a[16:19], v[176:179], v[16:31]
  ds_read_b128 v[80:83], v2 offset:128
  ds_read_b128 v[84:87], v2 offset:160
  ds_read_b128 v[88:91], v2 offset:192
  ds_read_b128 v[92:95], v2 offset:224
  v_pk_fma_f16 v191, v191, v59, s21 op_sel_hi:[1,1,0]
  v_pk_fma_f16 v188, v188, v56, s23 op_sel:[0,0,1]
  v_cvt_pk_bf16_f32 v130, v100, v101
  v_pk_fma_f16 v189, v189, v57, s23 op_sel:[0,0,1]
  v_cvt_pk_bf16_f32 v131, v102, v103
  v_mfma_f32_32x32x16_bf16 v[16:31], a[20:23], v[180:183], v[16:31]
  s_nop 0
  s_waitcnt lgkmcnt(6)
  ds_read_b128 v[200:203], v1 offset:10240
  ds_read_b128 v[204:207], v1 offset:11264
  v_cvt_pk_bf16_f32 v132, v104, v105
  v_cvt_pk_bf16_f32 v133, v106, v107
  v_pk_fma_f16 v190, v190, v58, s23 op_sel:[0,0,1]
  v_cvt_pk_bf16_f32 v134, v108, v109
  v_pk_fma_f16 v191, v191, v59, s23 op_sel:[0,0,1]
  v_cvt_pk_bf16_f32 v135, v110, v111
  v_pk_fma_f16 v188, v188, v52, 0.5 op_sel_hi:[1,1,0] clamp
  v_mfma_f32_32x32x16_bf16 v[64:79], v[240:243], v[136:139], v[64:79]
  ds_read_b128 v[96:99], v2 offset:256
  ds_read_b128 v[100:103], v2 offset:288
  ds_read_b128 v[104:107], v2 offset:320
  ds_read_b128 v[108:111], v2 offset:352
  v_pk_fma_f16 v189, v189, v53, 0.5 op_sel_hi:[1,1,0] clamp
  v_pk_fma_f16 v190, v190, v54, 0.5 op_sel_hi:[1,1,0] clamp
  v_pk_fma_f16 v191, v191, v55, 0.5 op_sel_hi:[1,1,0] clamp
  v_pk_mul_f16 v188, v188, v52
  v_pk_mul_f16 v189, v189, v53
  v_pk_mul_f16 v190, v190, v54
  v_pk_mul_f16 v191, v191, v55
  v_mfma_f32_32x32x16_bf16 v[64:79], v[244:247], v[140:143], v[64:79]
  s_nop 0
  s_waitcnt lgkmcnt(6)
  ds_read_b128 v[208:211], v1 offset:12288
  ds_read_b128 v[212:215], v1 offset:13312
  v_cvt_pk_f16_f32 v48, v16, v17
  v_cvt_pk_f16_f32 v49, v18, v19
  v_cvt_pk_f16_f32 v50, v20, v21
  v_cvt_pk_f16_f32 v51, v22, v23
  v_mfma_f32_32x32x16_bf16 v[80:95], v[240:243], v[144:147], v[80:95]
  v_cvt_pk_f16_f32 v52, v24, v25
  v_cvt_pk_f16_f32 v53, v26, v27
  v_cvt_pk_f16_f32 v54, v28, v29
  v_cvt_pk_f16_f32 v55, v30, v31
  v_pk_fma_f16 v56, v48, v48, s23 op_sel_hi:[1,1,0]
  v_pk_fma_f16 v57, v49, v49, s23 op_sel_hi:[1,1,0]
  v_mfma_f32_32x32x16_bf16 v[80:95], v[244:247], v[148:151], v[80:95]
  s_nop 0
  s_waitcnt lgkmcnt(2)
  v_pk_fma_f16 v58, v50, v50, s23 op_sel_hi:[1,1,0]
  v_pk_fma_f16 v59, v51, v51, s23 op_sel_hi:[1,1,0]
  v_mfma_f32_32x32x16_bf16 v[96:111], v[240:243], v[152:155], v[96:111]
  v_mfma_f32_32x32x16_bf16 v[96:111], v[244:247], v[156:159], v[96:111]
  s_waitcnt lgkmcnt(0)
  v_mfma_f32_32x32x16_f16 v[64:79], v[192:195], v[184:187], v[64:79]
  s_mov_b32 m0, s31
  v_mfma_f32_32x32x16_f16 v[80:95], v[196:199], v[184:187], v[80:95]
  buffer_load_dwordx4 v6, s[4:7], s52 offen lds
  v_mfma_f32_32x32x16_f16 v[96:111], v[200:203], v[184:187], v[96:111]
  buffer_load_dwordx4 v7, s[4:7], s52 offen offset:1024 lds
  v_pk_fma_f16 v184, v56, s20, s20 op_sel:[0,1,0] op_sel_hi:[1,1,0]
  v_pk_fma_f16 v185, v57, s20, s20 op_sel:[0,1,0] op_sel_hi:[1,1,0]
  v_pk_fma_f16 v186, v58, s20, s20 op_sel:[0,1,0] op_sel_hi:[1,1,0]
  v_pk_fma_f16 v187, v59, s20, s20 op_sel:[0,1,0] op_sel_hi:[1,1,0]
  v_pk_fma_f16 v184, v184, v56, s21 op_sel:[0,0,1]
  v_mfma_f32_32x32x16_f16 v[64:79], v[204:207], v[188:191], v[64:79]
  buffer_load_dwordx4 v8, s[4:7], s52 offen offset:2048 lds
  v_pk_fma_f16 v185, v185, v57, s21 op_sel:[0,0,1]
  v_pk_fma_f16 v186, v186, v58, s21 op_sel:[0,0,1]
  v_pk_fma_f16 v187, v187, v59, s21 op_sel:[0,0,1]
  v_pk_fma_f16 v184, v184, v56, s21 op_sel_hi:[1,1,0]
  v_pk_fma_f16 v185, v185, v57, s21 op_sel_hi:[1,1,0]
  v_mfma_f32_32x32x16_f16 v[80:95], v[208:211], v[188:191], v[80:95]
  buffer_load_dwordx4 v9, s[4:7], s52 offen offset:3072 lds
  v_pk_fma_f16 v186, v186, v58, s21 op_sel_hi:[1,1,0]
  v_pk_fma_f16 v187, v187, v59, s21 op_sel_hi:[1,1,0]
  v_pk_fma_f16 v184, v184, v56, s23 op_sel:[0,0,1]
  v_pk_fma_f16 v185, v185, v57, s23 op_sel:[0,0,1]
  v_pk_fma_f16 v186, v186, v58, s23 op_sel:[0,0,1]
  v_mfma_f32_32x32x16_f16 v[96:111], v[212:215], v[188:191], v[96:111]
  v_pk_fma_f16 v187, v187, v59, s23 op_sel:[0,0,1]
  v_pk_fma_f16 v184, v184, v48, 0.5 op_sel_hi:[1,1,0] clamp
  v_pk_fma_f16 v185, v185, v49, 0.5 op_sel_hi:[1,1,0] clamp
  v_pk_fma_f16 v186, v186, v50, 0.5 op_sel_hi:[1,1,0] clamp
  v_pk_fma_f16 v187, v187, v51, 0.5 op_sel_hi:[1,1,0] clamp
  v_pk_mul_f16 v184, v184, v48
  v_mfma_f32_32x32x16_bf16 v[16:31], a[24:27], v[160:163], 0
  ds_read_b128 v[192:195], v1 offset:14336
  ds_read_b128 v[196:199], v1 offset:15360
  v_pk_mul_f16 v185, v185, v49
  v_pk_mul_f16 v186, v186, v50
  v_pk_mul_f16 v187, v187, v51
  v_pk_fma_f16 v56, v52, v52, s23 op_sel_hi:[1,1,0]
  v_mfma_f32_32x32x16_bf16 v[16:31], a[28:31], v[164:167], v[16:31]
  ds_read_b128 v[200:203], v1 offset:16384
  ds_read_b128 v[204:207], v1 offset:17408
  v_pk_fma_f16 v57, v53, v53, s23 op_sel_hi:[1,1,0]
  v_pk_fma_f16 v58, v54, v54, s23 op_sel_hi:[1,1,0]
  v_pk_fma_f16 v59, v55, v55, s23 op_sel_hi:[1,1,0]
  v_pk_fma_f16 v188, v56, s20, s20 op_sel:[0,1,0] op_sel_hi:[1,1,0]
  v_mfma_f32_32x32x16_bf16 v[16:31], a[32:35], v[168:171], v[16:31]
  ds_read_b128 v[208:211], v1 offset:18432
  ds_read_b128 v[212:215], v1 offset:19456
  v_pk_fma_f16 v189, v57, s20, s20 op_sel:[0,1,0] op_sel_hi:[1,1,0]
  v_pk_fma_f16 v190, v58, s20, s20 op_sel:[0,1,0] op_sel_hi:[1,1,0]
  v_pk_fma_f16 v191, v59, s20, s20 op_sel:[0,1,0] op_sel_hi:[1,1,0]
  v_pk_fma_f16 v188, v188, v56, s21 op_sel:[0,0,1]
  v_mfma_f32_32x32x16_bf16 v[16:31], a[36:39], v[172:175], v[16:31]
  buffer_store_dwordx4 v[112:115], v10, s[8:11], s28 offen
  v_pk_fma_f16 v189, v189, v57, s21 op_sel:[0,0,1]
  v_pk_fma_f16 v190, v190, v58, s21 op_sel:[0,0,1]
  v_pk_fma_f16 v191, v191, v59, s21 op_sel:[0,0,1]
  v_pk_fma_f16 v188, v188, v56, s21 op_sel_hi:[1,1,0]
  v_pk_fma_f16 v189, v189, v57, s21 op_sel_hi:[1,1,0]
  v_mfma_f32_32x32x16_bf16 v[16:31], a[40:43], v[176:179], v[16:31]
  v_pk_fma_f16 v190, v190, v58, s21 op_sel_hi:[1,1,0]
  v_pk_fma_f16 v191, v191, v59, s21 op_sel_hi:[1,1,0]
  v_pk_fma_f16 v188, v188, v56, s23 op_sel:[0,0,1]
  v_pk_fma_f16 v189, v189, v57, s23 op_sel:[0,0,1]
  v_pk_fma_f16 v190, v190, v58, s23 op_sel:[0,0,1]
  v_pk_fma_f16 v191, v191, v59, s23 op_sel:[0,0,1]
  v_mfma_f32_32x32x16_bf16 v[16:31], a[44:47], v[180:183], v[16:31]
  s_nop 0
  s_waitcnt lgkmcnt(0)
  v_pk_fma_f16 v188, v188, v52, 0.5 op_sel_hi:[1,1,0] clamp
  v_pk_fma_f16 v189, v189, v53, 0.5 op_sel_hi:[1,1,0] clamp
  v_pk_fma_f16 v190, v190, v54, 0.5 op_sel_hi:[1,1,0] clamp
  v_pk_fma_f16 v191, v191, v55, 0.5 op_sel_hi:[1,1,0] clamp
  v_pk_mul_f16 v188, v188, v52
  v_pk_mul_f16 v189, v189, v53
  v_mfma_f32_32x32x16_f16 v[64:79], v[192:195], v[184:187], v[64:79]
  v_pk_mul_f16 v190, v190, v54
  v_pk_mul_f16 v191, v191, v55
  v_mfma_f32_32x32x16_f16 v[80:95], v[196:199], v[184:187], v[80:95]
  s_nop 0
  s_nop 0
  v_cvt_pk_f16_f32 v48, v16, v17
  v_cvt_pk_f16_f32 v49, v18, v19
  v_cvt_pk_f16_f32 v50, v20, v21
  v_cvt_pk_f16_f32 v51, v22, v23
  v_cvt_pk_f16_f32 v52, v24, v25
  v_cvt_pk_f16_f32 v53, v26, v27
  v_mfma_f32_32x32x16_f16 v[96:111], v[200:203], v[184:187], v[96:111]
  v_cvt_pk_f16_f32 v54, v28, v29
  v_cvt_pk_f16_f32 v55, v30, v31
  v_pk_fma_f16 v56, v48, v48, s23 op_sel_hi:[1,1,0]
  v_pk_fma_f16 v57, v49, v49, s23 op_sel_hi:[1,1,0]
  v_pk_fma_f16 v58, v50, v50, s23 op_sel_hi:[1,1,0]
  v_subrev_u32 v11, 0x4100, v5
  v_mfma_f32_32x32x16_f16 v[64:79], v[204:207], v[188:191], v[64:79]
  v_pk_fma_f16 v59, v51, v51, s23 op_sel_hi:[1,1,0]
  v_pk_fma_f16 v184, v56, s20, s20 op_sel:[0,1,0] op_sel_hi:[1,1,0]
  v_pk_fma_f16 v185, v57, s20, s20 op_sel:[0,1,0] op_sel_hi:[1,1,0]
  v_pk_fma_f16 v186, v58, s20, s20 op_sel:[0,1,0] op_sel_hi:[1,1,0]
  v_pk_fma_f16 v187, v59, s20, s20 op_sel:[0,1,0] op_sel_hi:[1,1,0]
  v_add_u32 v5, 0x8200, v5
  v_mfma_f32_32x32x16_f16 v[80:95], v[208:211], v[188:191], v[80:95]
  v_pk_fma_f16 v184, v184, v56, s21 op_sel:[0,0,1]
  v_pk_fma_f16 v185, v185, v57, s21 op_sel:[0,0,1]
  v_pk_fma_f16 v186, v186, v58, s21 op_sel:[0,0,1]
  v_pk_fma_f16 v187, v187, v59, s21 op_sel:[0,0,1]
  v_pk_fma_f16 v184, v184, v56, s21 op_sel_hi:[1,1,0]
  v_min_u32_e64 v5, v11, v5
  v_mfma_f32_32x32x16_f16 v[96:111], v[212:215], v[188:191], v[96:111]
  v_pk_fma_f16 v185, v185, v57, s21 op_sel_hi:[1,1,0]
  v_pk_fma_f16 v186, v186, v58, s21 op_sel_hi:[1,1,0]
  v_pk_fma_f16 v187, v187, v59, s21 op_sel_hi:[1,1,0]
  v_pk_fma_f16 v184, v184, v56, s23 op_sel:[0,0,1]
  v_pk_fma_f16 v185, v185, v57, s23 op_sel:[0,0,1]
  v_pk_fma_f16 v186, v186, v58, s23 op_sel:[0,0,1]
  v_mfma_f32_32x32x16_bf16 v[16:31], a[48:51], v[160:163], 0
  ds_read_b128 v[192:195], v1 offset:20480
  ds_read_b128 v[196:199], v1 offset:21504
  v_pk_fma_f16 v187, v187, v59, s23 op_sel:[0,0,1]
  v_pk_fma_f16 v184, v184, v48, 0.5 op_sel_hi:[1,1,0] clamp
  v_pk_fma_f16 v185, v185, v49, 0.5 op_sel_hi:[1,1,0] clamp
  v_pk_fma_f16 v186, v186, v50, 0.5 op_sel_hi:[1,1,0] clamp
  v_mfma_f32_32x32x16_bf16 v[16:31], a[52:55], v[164:167], v[16:31]
  ds_read_b128 v[200:203], v1 offset:22528
  ds_read_b128 v[204:207], v1 offset:23552
  v_pk_fma_f16 v187, v187, v51, 0.5 op_sel_hi:[1,1,0] clamp
  v_pk_mul_f16 v184, v184, v48
  v_pk_mul_f16 v185, v185, v49
  v_pk_mul_f16 v186, v186, v50
  v_mfma_f32_32x32x16_bf16 v[16:31], a[56:59], v[168:171], v[16:31]
  ds_read_b128 v[208:211], v1 offset:24576
  ds_read_b128 v[212:215], v1 offset:25600
  v_pk_mul_f16 v187, v187, v51
  v_pk_fma_f16 v56, v52, v52, s23 op_sel_hi:[1,1,0]
  v_pk_fma_f16 v57, v53, v53, s23 op_sel_hi:[1,1,0]
  v_pk_fma_f16 v58, v54, v54, s23 op_sel_hi:[1,1,0]
  v_mfma_f32_32x32x16_bf16 v[16:31], a[60:63], v[172:175], v[16:31]
  buffer_store_dwordx4 v[116:119], v10, s[8:11], s28 offen offset:32
  v_pk_fma_f16 v59, v55, v55, s23 op_sel_hi:[1,1,0]
  v_pk_fma_f16 v188, v56, s20, s20 op_sel:[0,1,0] op_sel_hi:[1,1,0]
  v_pk_fma_f16 v189, v57, s20, s20 op_sel:[0,1,0] op_sel_hi:[1,1,0]
  v_pk_fma_f16 v190, v58, s20, s20 op_sel:[0,1,0] op_sel_hi:[1,1,0]
  v_pk_fma_f16 v191, v59, s20, s20 op_sel:[0,1,0] op_sel_hi:[1,1,0]
  v_mfma_f32_32x32x16_bf16 v[16:31], a[64:67], v[176:179], v[16:31]
  v_pk_fma_f16 v188, v188, v56, s21 op_sel:[0,0,1]
  v_pk_fma_f16 v189, v189, v57, s21 op_sel:[0,0,1]
  v_pk_fma_f16 v190, v190, v58, s21 op_sel:[0,0,1]
  v_pk_fma_f16 v191, v191, v59, s21 op_sel:[0,0,1]
  v_pk_fma_f16 v188, v188, v56, s21 op_sel_hi:[1,1,0]
  v_pk_fma_f16 v189, v189, v57, s21 op_sel_hi:[1,1,0]
  v_mfma_f32_32x32x16_bf16 v[16:31], a[68:71], v[180:183], v[16:31]
  s_nop 0
  s_waitcnt lgkmcnt(0)
  v_pk_fma_f16 v190, v190, v58, s21 op_sel_hi:[1,1,0]
  v_pk_fma_f16 v191, v191, v59, s21 op_sel_hi:[1,1,0]
  v_pk_fma_f16 v188, v188, v56, s23 op_sel:[0,0,1]
  v_pk_fma_f16 v189, v189, v57, s23 op_sel:[0,0,1]
  v_pk_fma_f16 v190, v190, v58, s23 op_sel:[0,0,1]
  v_pk_fma_f16 v191, v191, v59, s23 op_sel:[0,0,1]
  v_pk_fma_f16 v188, v188, v52, 0.5 op_sel_hi:[1,1,0] clamp
  v_mfma_f32_32x32x16_f16 v[64:79], v[192:195], v[184:187], v[64:79]
  s_add_u32 s29, s29, 0x60000
  v_pk_fma_f16 v189, v189, v53, 0.5 op_sel_hi:[1,1,0] clamp
  v_pk_fma_f16 v190, v190, v54, 0.5 op_sel_hi:[1,1,0] clamp
  v_pk_fma_f16 v191, v191, v55, 0.5 op_sel_hi:[1,1,0] clamp
  v_pk_mul_f16 v188, v188, v52
  v_pk_mul_f16 v189, v189, v53
  v_pk_mul_f16 v190, v190, v54
  v_pk_mul_f16 v191, v191, v55
  v_mfma_f32_32x32x16_f16 v[80:95], v[196:199], v[184:187], v[80:95]
  s_add_u32 s52, s52, 0x60000
  v_cvt_pk_f16_f32 v48, v16, v17
  v_cvt_pk_f16_f32 v49, v18, v19
  v_cvt_pk_f16_f32 v50, v20, v21
  v_cvt_pk_f16_f32 v51, v22, v23
  v_cvt_pk_f16_f32 v52, v24, v25
  v_cvt_pk_f16_f32 v53, v26, v27
  v_mfma_f32_32x32x16_f16 v[96:111], v[200:203], v[184:187], v[96:111]
  s_mov_b32 s32, s30
  v_cvt_pk_f16_f32 v54, v28, v29
  v_cvt_pk_f16_f32 v55, v30, v31
  v_pk_fma_f16 v56, v48, v48, s23 op_sel_hi:[1,1,0]
  v_pk_fma_f16 v57, v49, v49, s23 op_sel_hi:[1,1,0]
  v_pk_fma_f16 v58, v50, v50, s23 op_sel_hi:[1,1,0]
  v_subrev_u32 v11, 0x4100, v4
  v_mfma_f32_32x32x16_f16 v[64:79], v[204:207], v[188:191], v[64:79]
  s_add_u32 s30, s33, 32
  v_pk_fma_f16 v59, v51, v51, s23 op_sel_hi:[1,1,0]
  v_pk_fma_f16 v184, v56, s20, s20 op_sel:[0,1,0] op_sel_hi:[1,1,0]
  v_pk_fma_f16 v185, v57, s20, s20 op_sel:[0,1,0] op_sel_hi:[1,1,0]
  v_pk_fma_f16 v186, v58, s20, s20 op_sel:[0,1,0] op_sel_hi:[1,1,0]
  v_pk_fma_f16 v187, v59, s20, s20 op_sel:[0,1,0] op_sel_hi:[1,1,0]
  v_add_u32 v4, 0x8200, v4
  v_mfma_f32_32x32x16_f16 v[80:95], v[208:211], v[188:191], v[80:95]
  s_nop 0
  s_sub_u32 s33, s31, 0
  v_pk_fma_f16 v184, v184, v56, s21 op_sel:[0,0,1]
  v_pk_fma_f16 v185, v185, v57, s21 op_sel:[0,0,1]
  v_pk_fma_f16 v186, v186, v58, s21 op_sel:[0,0,1]
  v_pk_fma_f16 v187, v187, v59, s21 op_sel:[0,0,1]
  v_pk_fma_f16 v184, v184, v56, s21 op_sel_hi:[1,1,0]
  v_min_u32_e64 v4, v11, v4
  v_mfma_f32_32x32x16_f16 v[96:111], v[212:215], v[188:191], v[96:111]
  v_pk_fma_f16 v185, v185, v57, s21 op_sel_hi:[1,1,0]
  v_pk_fma_f16 v186, v186, v58, s21 op_sel_hi:[1,1,0]
  v_pk_fma_f16 v187, v187, v59, s21 op_sel_hi:[1,1,0]
  v_pk_fma_f16 v184, v184, v56, s23 op_sel:[0,0,1]
  v_pk_fma_f16 v185, v185, v57, s23 op_sel:[0,0,1]
  v_pk_fma_f16 v186, v186, v58, s23 op_sel:[0,0,1]
  v_mfma_f32_32x32x16_bf16 v[16:31], a[72:75], v[160:163], 0
  ds_read_b128 v[192:195], v1 offset:26624
  ds_read_b128 v[196:199], v1 offset:27648
  v_pk_fma_f16 v187, v187, v59, s23 op_sel:[0,0,1]
  v_pk_fma_f16 v184, v184, v48, 0.5 op_sel_hi:[1,1,0] clamp
  v_pk_fma_f16 v185, v185, v49, 0.5 op_sel_hi:[1,1,0] clamp
  v_pk_fma_f16 v186, v186, v50, 0.5 op_sel_hi:[1,1,0] clamp
  v_mfma_f32_32x32x16_bf16 v[16:31], a[76:79], v[164:167], v[16:31]
  ds_read_b128 v[200:203], v1 offset:28672
  ds_read_b128 v[204:207], v1 offset:29696
  v_pk_fma_f16 v187, v187, v51, 0.5 op_sel_hi:[1,1,0] clamp
  v_pk_mul_f16 v184, v184, v48
  v_pk_mul_f16 v185, v185, v49
  v_pk_mul_f16 v186, v186, v50
  v_mfma_f32_32x32x16_bf16 v[16:31], a[80:83], v[168:171], v[16:31]
  ds_read_b128 v[208:211], v1 offset:30720
  ds_read_b128 v[212:215], v1 offset:31744
  v_pk_mul_f16 v187, v187, v51
  v_pk_fma_f16 v56, v52, v52, s23 op_sel_hi:[1,1,0]
  v_pk_fma_f16 v57, v53, v53, s23 op_sel_hi:[1,1,0]
  v_pk_fma_f16 v58, v54, v54, s23 op_sel_hi:[1,1,0]
  v_mfma_f32_32x32x16_bf16 v[16:31], a[84:87], v[172:175], v[16:31]
  buffer_load_dword v249, v248, s[4:7], s29 offen
  v_pk_fma_f16 v59, v55, v55, s23 op_sel_hi:[1,1,0]
  v_pk_fma_f16 v188, v56, s20, s20 op_sel:[0,1,0] op_sel_hi:[1,1,0]
  v_pk_fma_f16 v189, v57, s20, s20 op_sel:[0,1,0] op_sel_hi:[1,1,0]
  v_pk_fma_f16 v190, v58, s20, s20 op_sel:[0,1,0] op_sel_hi:[1,1,0]
  v_pk_fma_f16 v191, v59, s20, s20 op_sel:[0,1,0] op_sel_hi:[1,1,0]
  v_mfma_f32_32x32x16_bf16 v[16:31], a[88:91], v[176:179], v[16:31]
  v_pk_fma_f16 v188, v188, v56, s21 op_sel:[0,0,1]
  v_pk_fma_f16 v189, v189, v57, s21 op_sel:[0,0,1]
  v_pk_fma_f16 v190, v190, v58, s21 op_sel:[0,0,1]
  v_pk_fma_f16 v191, v191, v59, s21 op_sel:[0,0,1]
  v_pk_fma_f16 v188, v188, v56, s21 op_sel_hi:[1,1,0]
  v_pk_fma_f16 v189, v189, v57, s21 op_sel_hi:[1,1,0]
  v_pk_fma_f16 v190, v190, v58, s21 op_sel_hi:[1,1,0]
  v_mfma_f32_32x32x16_bf16 v[16:31], a[92:95], v[180:183], v[16:31]
  s_nop 0
  s_waitcnt lgkmcnt(0)
  v_pk_fma_f16 v191, v191, v59, s21 op_sel_hi:[1,1,0]
  v_pk_fma_f16 v188, v188, v56, s23 op_sel:[0,0,1]
  v_pk_fma_f16 v189, v189, v57, s23 op_sel:[0,0,1]
  v_pk_fma_f16 v190, v190, v58, s23 op_sel:[0,0,1]
  v_pk_fma_f16 v191, v191, v59, s23 op_sel:[0,0,1]
  v_pk_fma_f16 v188, v188, v52, 0.5 op_sel_hi:[1,1,0] clamp
  v_pk_fma_f16 v189, v189, v53, 0.5 op_sel_hi:[1,1,0] clamp
  v_mfma_f32_32x32x16_f16 v[64:79], v[192:195], v[184:187], v[64:79]
  s_nop 0
  s_waitcnt vmcnt(3)
  ds_read_b128 v[220:223], v4 offset:96
  v_pk_fma_f16 v190, v190, v54, 0.5 op_sel_hi:[1,1,0] clamp
  v_pk_fma_f16 v191, v191, v55, 0.5 op_sel_hi:[1,1,0] clamp
  v_pk_mul_f16 v188, v188, v52
  v_pk_mul_f16 v189, v189, v53
  v_pk_mul_f16 v190, v190, v54
  v_pk_mul_f16 v191, v191, v55
  v_mfma_f32_32x32x16_f16 v[80:95], v[196:199], v[184:187], v[80:95]
  ds_read_b128 v[228:231], v4 offset:288
  v_cvt_pk_f16_f32 v48, v16, v17
  v_cvt_pk_f16_f32 v49, v18, v19
  v_cvt_pk_f16_f32 v50, v20, v21
  v_cvt_pk_f16_f32 v51, v22, v23
  v_cvt_pk_f16_f32 v52, v24, v25
  v_mfma_f32_32x32x16_f16 v[96:111], v[200:203], v[184:187], v[96:111]
  ds_read_b128 v[236:239], v4 offset:480
  v_cvt_pk_f16_f32 v53, v26, v27
  v_cvt_pk_f16_f32 v54, v28, v29
  v_cvt_pk_f16_f32 v55, v30, v31
  v_pk_fma_f16 v56, v48, v48, s23 op_sel_hi:[1,1,0]
  v_pk_fma_f16 v57, v49, v49, s23 op_sel_hi:[1,1,0]
  v_mfma_f32_32x32x16_f16 v[64:79], v[204:207], v[188:191], v[64:79]
  v_pk_fma_f16 v58, v50, v50, s23 op_sel_hi:[1,1,0]
  v_pk_fma_f16 v59, v51, v51, s23 op_sel_hi:[1,1,0]
  v_pk_fma_f16 v184, v56, s20, s20 op_sel:[0,1,0] op_sel_hi:[1,1,0]
  v_pk_fma_f16 v185, v57, s20, s20 op_sel:[0,1,0] op_sel_hi:[1,1,0]
  v_pk_fma_f16 v186, v58, s20, s20 op_sel:[0,1,0] op_sel_hi:[1,1,0]
  v_pk_fma_f16 v187, v59, s20, s20 op_sel:[0,1,0] op_sel_hi:[1,1,0]
  v_mfma_f32_32x32x16_f16 v[80:95], v[208:211], v[188:191], v[80:95]
  v_pk_fma_f16 v184, v184, v56, s21 op_sel:[0,0,1]
  v_pk_fma_f16 v185, v185, v57, s21 op_sel:[0,0,1]
  v_pk_fma_f16 v186, v186, v58, s21 op_sel:[0,0,1]
  v_pk_fma_f16 v187, v187, v59, s21 op_sel:[0,0,1]
  v_pk_fma_f16 v184, v184, v56, s21 op_sel_hi:[1,1,0]
  v_pk_fma_f16 v185, v185, v57, s21 op_sel_hi:[1,1,0]
  v_mfma_f32_32x32x16_f16 v[96:111], v[212:215], v[188:191], v[96:111]
  s_nop 0
  s_waitcnt lgkmcnt(0)
  v_pk_fma_f16 v186, v186, v58, s21 op_sel_hi:[1,1,0]
  v_pk_fma_f16 v187, v187, v59, s21 op_sel_hi:[1,1,0]
  v_pk_fma_f16 v184, v184, v56, s23 op_sel:[0,0,1]
  v_pk_fma_f16 v185, v185, v57, s23 op_sel:[0,0,1]
  v_pk_fma_f16 v186, v186, v58, s23 op_sel:[0,0,1]
  v_pk_fma_f16 v187, v187, v59, s23 op_sel:[0,0,1]
  v_mfma_f32_32x32x16_bf16 v[16:31], a[96:99], v[160:163], 0
  ds_read_b128 v[192:195], v0 offset:24576
  ds_read_b128 v[196:199], v0 offset:25600
  v_pk_fma_f16 v184, v184, v48, 0.5 op_sel_hi:[1,1,0] clamp
  v_pk_fma_f16 v185, v185, v49, 0.5 op_sel_hi:[1,1,0] clamp
  v_pk_fma_f16 v186, v186, v50, 0.5 op_sel_hi:[1,1,0] clamp
  v_pk_fma_f16 v187, v187, v51, 0.5 op_sel_hi:[1,1,0] clamp
  v_mfma_f32_16x16x32_bf16 v[136:139], a[240:243], v[220:223], 0
  ds_read_b128 v[216:219], v3 offset:2800
  ds_read_b128 v[220:223], v4 offset:112
  v_mfma_f32_32x32x16_bf16 v[16:31], a[100:103], v[164:167], v[16:31]
  ds_read_b128 v[200:203], v0 offset:26624
  ds_read_b128 v[204:207], v0 offset:27648
  v_pk_mul_f16 v184, v184, v48
  v_pk_mul_f16 v185, v185, v49
  v_pk_mul_f16 v186, v186, v50
  v_pk_mul_f16 v187, v187, v51
  v_mfma_f32_16x16x32_bf16 v[136:139], a[244:247], v[228:231], v[136:139]
  ds_read_b128 v[224:227], v3 offset:7600
  ds_read_b128 v[228:231], v4 offset:304
  v_mfma_f32_32x32x16_bf16 v[16:31], a[104:107], v[168:171], v[16:31]
  ds_read_b128 v[208:211], v0 offset:28672
  ds_read_b128 v[212:215], v0 offset:29696
  v_pk_fma_f16 v56, v52, v52, s23 op_sel_hi:[1,1,0]
  v_pk_fma_f16 v57, v53, v53, s23 op_sel_hi:[1,1,0]
  v_pk_fma_f16 v58, v54, v54, s23 op_sel_hi:[1,1,0]
  v_pk_fma_f16 v59, v55, v55, s23 op_sel_hi:[1,1,0]
  v_mfma_f32_16x16x32_bf16 v[136:139], a[248:251], v[236:239], v[136:139]
  ds_read_b128 v[232:235], v3 offset:12400
  ds_read_b128 v[236:239], v4 offset:496
  v_mfma_f32_32x32x16_bf16 v[16:31], a[108:111], v[172:175], v[16:31]
  buffer_store_dwordx4 v[120:123], v10, s[8:11], s28 offen offset:64
  v_pk_fma_f16 v188, v56, s20, s20 op_sel:[0,1,0] op_sel_hi:[1,1,0]
  v_pk_fma_f16 v189, v57, s20, s20 op_sel:[0,1,0] op_sel_hi:[1,1,0]
  v_pk_fma_f16 v190, v58, s20, s20 op_sel:[0,1,0] op_sel_hi:[1,1,0]
  v_pk_fma_f16 v191, v59, s20, s20 op_sel:[0,1,0] op_sel_hi:[1,1,0]
  v_pk_fma_f16 v188, v188, v56, s21 op_sel:[0,0,1]
  v_mfma_f32_32x32x16_bf16 v[16:31], a[112:115], v[176:179], v[16:31]
  v_pk_fma_f16 v189, v189, v57, s21 op_sel:[0,0,1]
  v_pk_fma_f16 v190, v190, v58, s21 op_sel:[0,0,1]
  v_pk_fma_f16 v191, v191, v59, s21 op_sel:[0,0,1]
  v_pk_fma_f16 v188, v188, v56, s21 op_sel_hi:[1,1,0]
  v_pk_fma_f16 v189, v189, v57, s21 op_sel_hi:[1,1,0]
  v_pk_fma_f16 v190, v190, v58, s21 op_sel_hi:[1,1,0]
  v_mfma_f32_32x32x16_bf16 v[16:31], a[116:119], v[180:183], v[16:31]
  s_nop 0
  s_waitcnt lgkmcnt(0)
  v_pk_fma_f16 v191, v191, v59, s21 op_sel_hi:[1,1,0]
  v_pk_fma_f16 v188, v188, v56, s23 op_sel:[0,0,1]
  v_pk_fma_f16 v189, v189, v57, s23 op_sel:[0,0,1]
  v_pk_fma_f16 v190, v190, v58, s23 op_sel:[0,0,1]
  v_pk_fma_f16 v191, v191, v59, s23 op_sel:[0,0,1]
  v_pk_fma_f16 v188, v188, v52, 0.5 op_sel_hi:[1,1,0] clamp
  v_mfma_f32_32x32x16_f16 v[64:79], v[192:195], v[184:187], v[64:79]
  v_pk_fma_f16 v189, v189, v53, 0.5 op_sel_hi:[1,1,0] clamp
  v_pk_fma_f16 v190, v190, v54, 0.5 op_sel_hi:[1,1,0] clamp
  v_pk_fma_f16 v191, v191, v55, 0.5 op_sel_hi:[1,1,0] clamp
  v_pk_mul_f16 v188, v188, v52
  v_pk_mul_f16 v189, v189, v53
  v_pk_mul_f16 v190, v190, v54
  v_pk_mul_f16 v191, v191, v55
  v_mfma_f32_16x16x32_bf16 v[140:143], v[216:219], v[220:223], 0
  ds_read_b128 v[220:223], v4 offset:128
  v_cvt_pk_f16_f32 v48, v16, v17
  v_mfma_f32_32x32x16_f16 v[80:95], v[196:199], v[184:187], v[80:95]
  v_cvt_pk_f16_f32 v49, v18, v19
  v_cvt_pk_f16_f32 v50, v20, v21
  v_cvt_pk_f16_f32 v51, v22, v23
  v_cvt_pk_f16_f32 v52, v24, v25
  v_cvt_pk_f16_f32 v53, v26, v27
  v_cvt_pk_f16_f32 v54, v28, v29
  v_mfma_f32_16x16x32_bf16 v[140:143], v[224:227], v[228:231], v[140:143]
  ds_read_b128 v[224:227], v3 offset:8000
  ds_read_b128 v[228:231], v4 offset:320
  v_mfma_f32_32x32x16_f16 v[96:111], v[200:203], v[184:187], v[96:111]
  s_nop 0
  s_sub_u32 s31, s32, 32
  v_cvt_pk_f16_f32 v55, v30, v31
  v_pk_fma_f16 v56, v48, v48, s23 op_sel_hi:[1,1,0]
  v_pk_fma_f16 v57, v49, v49, s23 op_sel_hi:[1,1,0]
  v_pk_fma_f16 v58, v50, v50, s23 op_sel_hi:[1,1,0]
  v_pk_fma_f16 v59, v51, v51, s23 op_sel_hi:[1,1,0]
  v_pk_fma_f16 v184, v56, s20, s20 op_sel:[0,1,0] op_sel_hi:[1,1,0]
  v_mfma_f32_16x16x32_bf16 v[140:143], v[232:235], v[236:239], v[140:143]
  ds_read_b128 v[232:235], v3 offset:12800
  ds_read_b128 v[236:239], v4 offset:512
  v_mfma_f32_32x32x16_f16 v[64:79], v[204:207], v[188:191], v[64:79]
  v_pk_fma_f16 v185, v57, s20, s20 op_sel:[0,1,0] op_sel_hi:[1,1,0]
  v_pk_fma_f16 v186, v58, s20, s20 op_sel:[0,1,0] op_sel_hi:[1,1,0]
  v_pk_fma_f16 v187, v59, s20, s20 op_sel:[0,1,0] op_sel_hi:[1,1,0]
  v_pk_fma_f16 v184, v184, v56, s21 op_sel:[0,0,1]
  v_pk_fma_f16 v185, v185, v57, s21 op_sel:[0,0,1]
  v_pk_fma_f16 v186, v186, v58, s21 op_sel:[0,0,1]
  v_mfma_f32_32x32x16_f16 v[80:95], v[208:211], v[188:191], v[80:95]
  v_pk_fma_f16 v187, v187, v59, s21 op_sel:[0,0,1]
  v_pk_fma_f16 v184, v184, v56, s21 op_sel_hi:[1,1,0]
  v_pk_fma_f16 v185, v185, v57, s21 op_sel_hi:[1,1,0]
  v_pk_fma_f16 v186, v186, v58, s21 op_sel_hi:[1,1,0]
  v_pk_fma_f16 v187, v187, v59, s21 op_sel_hi:[1,1,0]
  v_pk_fma_f16 v184, v184, v56, s23 op_sel:[0,0,1]
  v_mfma_f32_32x32x16_f16 v[96:111], v[212:215], v[188:191], v[96:111]
  s_nop 0
  s_waitcnt lgkmcnt(0)
  v_pk_fma_f16 v185, v185, v57, s23 op_sel:[0,0,1]
  v_pk_fma_f16 v186, v186, v58, s23 op_sel:[0,0,1]
  v_pk_fma_f16 v187, v187, v59, s23 op_sel:[0,0,1]
  v_pk_fma_f16 v184, v184, v48, 0.5 op_sel_hi:[1,1,0] clamp
  v_pk_fma_f16 v185, v185, v49, 0.5 op_sel_hi:[1,1,0] clamp
  v_pk_fma_f16 v186, v186, v50, 0.5 op_sel_hi:[1,1,0] clamp
  v_mfma_f32_32x32x16_bf16 v[16:31], a[120:123], v[160:163], 0
  ds_read_b128 v[192:195], v0 offset:30720
  ds_read_b128 v[196:199], v0 offset:31744
  v_pk_fma_f16 v187, v187, v51, 0.5 op_sel_hi:[1,1,0] clamp
  v_pk_mul_f16 v184, v184, v48
  v_pk_mul_f16 v185, v185, v49
  v_pk_mul_f16 v186, v186, v50
  v_mfma_f32_16x16x32_bf16 v[144:147], a[252:255], v[220:223], 0
  ds_read_b128 v[216:219], v3 offset:3600
  ds_read_b128 v[220:223], v4 offset:144
  v_mfma_f32_32x32x16_bf16 v[16:31], a[124:127], v[164:167], v[16:31]
  ds_read_b128 v[200:203], v0 offset:32768
  ds_read_b128 v[204:207], v0 offset:33792
  v_pk_mul_f16 v187, v187, v51
  v_pk_fma_f16 v56, v52, v52, s23 op_sel_hi:[1,1,0]
  v_pk_fma_f16 v57, v53, v53, s23 op_sel_hi:[1,1,0]
  v_pk_fma_f16 v58, v54, v54, s23 op_sel_hi:[1,1,0]
  v_mfma_f32_16x16x32_bf16 v[144:147], v[224:227], v[228:231], v[144:147]
  ds_read_b128 v[224:227], v3 offset:8400
  ds_read_b128 v[228:231], v4 offset:336
  v_mfma_f32_32x32x16_bf16 v[16:31], a[128:131], v[168:171], v[16:31]
  ds_read_b128 v[208:211], v0 offset:34816
  ds_read_b128 v[212:215], v0 offset:35840
  v_pk_fma_f16 v59, v55, v55, s23 op_sel_hi:[1,1,0]
  v_pk_fma_f16 v188, v56, s20, s20 op_sel:[0,1,0] op_sel_hi:[1,1,0]
  v_pk_fma_f16 v189, v57, s20, s20 op_sel:[0,1,0] op_sel_hi:[1,1,0]
  v_pk_fma_f16 v190, v58, s20, s20 op_sel:[0,1,0] op_sel_hi:[1,1,0]
  v_mfma_f32_16x16x32_bf16 v[144:147], v[232:235], v[236:239], v[144:147]
  ds_read_b128 v[232:235], v3 offset:13200
  ds_read_b128 v[236:239], v4 offset:528
  v_mfma_f32_32x32x16_bf16 v[16:31], a[132:135], v[172:175], v[16:31]
  buffer_store_dwordx4 v[124:127], v10, s[8:11], s28 offen offset:96
  v_pk_fma_f16 v191, v59, s20, s20 op_sel:[0,1,0] op_sel_hi:[1,1,0]
  v_pk_fma_f16 v188, v188, v56, s21 op_sel:[0,0,1]
  v_pk_fma_f16 v189, v189, v57, s21 op_sel:[0,0,1]
  v_pk_fma_f16 v190, v190, v58, s21 op_sel:[0,0,1]
  v_pk_fma_f16 v191, v191, v59, s21 op_sel:[0,0,1]
  v_mfma_f32_32x32x16_bf16 v[16:31], a[136:139], v[176:179], v[16:31]
  v_pk_fma_f16 v188, v188, v56, s21 op_sel_hi:[1,1,0]
  v_pk_fma_f16 v189, v189, v57, s21 op_sel_hi:[1,1,0]
  v_pk_fma_f16 v190, v190, v58, s21 op_sel_hi:[1,1,0]
  v_pk_fma_f16 v191, v191, v59, s21 op_sel_hi:[1,1,0]
  v_pk_fma_f16 v188, v188, v56, s23 op_sel:[0,0,1]
  v_pk_fma_f16 v189, v189, v57, s23 op_sel:[0,0,1]
  v_mfma_f32_32x32x16_bf16 v[16:31], a[140:143], v[180:183], v[16:31]
  s_nop 0
  s_waitcnt lgkmcnt(0)
  v_pk_fma_f16 v190, v190, v58, s23 op_sel:[0,0,1]
  v_pk_fma_f16 v191, v191, v59, s23 op_sel:[0,0,1]
  v_pk_fma_f16 v188, v188, v52, 0.5 op_sel_hi:[1,1,0] clamp
  v_pk_fma_f16 v189, v189, v53, 0.5 op_sel_hi:[1,1,0] clamp
  v_pk_fma_f16 v190, v190, v54, 0.5 op_sel_hi:[1,1,0] clamp
  v_pk_fma_f16 v191, v191, v55, 0.5 op_sel_hi:[1,1,0] clamp
  v_mfma_f32_32x32x16_f16 v[64:79], v[192:195], v[184:187], v[64:79]
  v_pk_mul_f16 v188, v188, v52
  v_pk_mul_f16 v189, v189, v53
  v_pk_mul_f16 v190, v190, v54
  v_pk_mul_f16 v191, v191, v55
  v_mfma_f32_16x16x32_bf16 v[148:151], v[216:219], v[220:223], 0
  ds_read_b128 v[216:219], v3 offset:4000
  ds_read_b128 v[220:223], v4 offset:160
  v_mfma_f32_32x32x16_f16 v[80:95], v[196:199], v[184:187], v[80:95]
  v_cvt_pk_f16_f32 v48, v16, v17
  v_cvt_pk_f16_f32 v49, v18, v19
  v_cvt_pk_f16_f32 v50, v20, v21
  v_cvt_pk_f16_f32 v51, v22, v23
  v_cvt_pk_f16_f32 v52, v24, v25
  v_cvt_pk_f16_f32 v53, v26, v27
  v_mfma_f32_16x16x32_bf16 v[148:151], v[224:227], v[228:231], v[148:151]
  ds_read_b128 v[224:227], v3 offset:8800
  ds_read_b128 v[228:231], v4 offset:352
  v_mfma_f32_32x32x16_f16 v[96:111], v[200:203], v[184:187], v[96:111]
  v_cvt_pk_f16_f32 v54, v28, v29
  v_cvt_pk_f16_f32 v55, v30, v31
  v_pk_fma_f16 v56, v48, v48, s23 op_sel_hi:[1,1,0]
  v_pk_fma_f16 v57, v49, v49, s23 op_sel_hi:[1,1,0]
  v_pk_fma_f16 v58, v50, v50, s23 op_sel_hi:[1,1,0]
  v_pk_fma_f16 v59, v51, v51, s23 op_sel_hi:[1,1,0]
  v_mfma_f32_16x16x32_bf16 v[148:151], v[232:235], v[236:239], v[148:151]
  ds_read_b128 v[232:235], v3 offset:13600
  ds_read_b128 v[236:239], v4 offset:544
  v_mfma_f32_32x32x16_f16 v[64:79], v[204:207], v[188:191], v[64:79]
  v_pk_fma_f16 v184, v56, s20, s20 op_sel:[0,1,0] op_sel_hi:[1,1,0]
  v_pk_fma_f16 v185, v57, s20, s20 op_sel:[0,1,0] op_sel_hi:[1,1,0]
  v_pk_fma_f16 v186, v58, s20, s20 op_sel:[0,1,0] op_sel_hi:[1,1,0]
  v_pk_fma_f16 v187, v59, s20, s20 op_sel:[0,1,0] op_sel_hi:[1,1,0]
  v_pk_fma_f16 v184, v184, v56, s21 op_sel:[0,0,1]
  v_pk_fma_f16 v185, v185, v57, s21 op_sel:[0,0,1]
  v_mfma_f32_32x32x16_f16 v[80:95], v[208:211], v[188:191], v[80:95]
  v_pk_fma_f16 v186, v186, v58, s21 op_sel:[0,0,1]
  v_pk_fma_f16 v187, v187, v59, s21 op_sel:[0,0,1]
  v_pk_fma_f16 v184, v184, v56, s21 op_sel_hi:[1,1,0]
  v_pk_fma_f16 v185, v185, v57, s21 op_sel_hi:[1,1,0]
  v_pk_fma_f16 v186, v186, v58, s21 op_sel_hi:[1,1,0]
  v_pk_fma_f16 v187, v187, v59, s21 op_sel_hi:[1,1,0]
  v_mfma_f32_32x32x16_f16 v[96:111], v[212:215], v[188:191], v[96:111]
  s_nop 0
  s_waitcnt lgkmcnt(0)
  v_pk_fma_f16 v184, v184, v56, s23 op_sel:[0,0,1]
  v_pk_fma_f16 v185, v185, v57, s23 op_sel:[0,0,1]
  v_pk_fma_f16 v186, v186, v58, s23 op_sel:[0,0,1]
  v_pk_fma_f16 v187, v187, v59, s23 op_sel:[0,0,1]
  v_pk_fma_f16 v184, v184, v48, 0.5 op_sel_hi:[1,1,0] clamp
  v_pk_fma_f16 v185, v185, v49, 0.5 op_sel_hi:[1,1,0] clamp
  v_mfma_f32_32x32x16_bf16 v[16:31], a[144:147], v[160:163], 0
  ds_read_b128 v[192:195], v0 offset:36864
  ds_read_b128 v[196:199], v0 offset:37888
  v_pk_fma_f16 v186, v186, v50, 0.5 op_sel_hi:[1,1,0] clamp
  v_pk_fma_f16 v187, v187, v51, 0.5 op_sel_hi:[1,1,0] clamp
  v_pk_mul_f16 v184, v184, v48
  v_pk_mul_f16 v185, v185, v49
  v_mfma_f32_16x16x32_bf16 v[152:155], v[216:219], v[220:223], 0
  ds_read_b128 v[216:219], v3 offset:4400
  ds_read_b128 v[220:223], v4 offset:176
  v_mfma_f32_32x32x16_bf16 v[16:31], a[148:151], v[164:167], v[16:31]
  ds_read_b128 v[200:203], v0 offset:38912
  ds_read_b128 v[204:207], v0 offset:39936
  v_pk_mul_f16 v186, v186, v50
  v_pk_mul_f16 v187, v187, v51
  v_pk_fma_f16 v56, v52, v52, s23 op_sel_hi:[1,1,0]
  v_pk_fma_f16 v57, v53, v53, s23 op_sel_hi:[1,1,0]
  v_mfma_f32_16x16x32_bf16 v[152:155], v[224:227], v[228:231], v[152:155]
  ds_read_b128 v[224:227], v3 offset:9200
  ds_read_b128 v[228:231], v4 offset:368
  v_mfma_f32_32x32x16_bf16 v[16:31], a[152:155], v[168:171], v[16:31]
  ds_read_b128 v[208:211], v0 offset:40960
  ds_read_b128 v[212:215], v0 offset:41984
  v_pk_fma_f16 v58, v54, v54, s23 op_sel_hi:[1,1,0]
  v_pk_fma_f16 v59, v55, v55, s23 op_sel_hi:[1,1,0]
  v_pk_fma_f16 v188, v56, s20, s20 op_sel:[0,1,0] op_sel_hi:[1,1,0]
  v_pk_fma_f16 v189, v57, s20, s20 op_sel:[0,1,0] op_sel_hi:[1,1,0]
  v_mfma_f32_16x16x32_bf16 v[152:155], v[232:235], v[236:239], v[152:155]
  ds_read_b128 v[232:235], v3 offset:14000
  ds_read_b128 v[236:239], v4 offset:560
  v_mfma_f32_32x32x16_bf16 v[16:31], a[156:159], v[172:175], v[16:31]
  v_pk_fma_f16 v190, v58, s20, s20 op_sel:[0,1,0] op_sel_hi:[1,1,0]
  v_pk_fma_f16 v191, v59, s20, s20 op_sel:[0,1,0] op_sel_hi:[1,1,0]
  v_pk_fma_f16 v188, v188, v56, s21 op_sel:[0,0,1]
  v_pk_fma_f16 v189, v189, v57, s21 op_sel:[0,0,1]
  v_pk_fma_f16 v190, v190, v58, s21 op_sel:[0,0,1]
  v_pk_fma_f16 v191, v191, v59, s21 op_sel:[0,0,1]
  v_mfma_f32_32x32x16_bf16 v[16:31], a[160:163], v[176:179], v[16:31]
  v_pk_fma_f16 v188, v188, v56, s21 op_sel_hi:[1,1,0]
  v_pk_fma_f16 v189, v189, v57, s21 op_sel_hi:[1,1,0]
  v_pk_fma_f16 v190, v190, v58, s21 op_sel_hi:[1,1,0]
  v_pk_fma_f16 v191, v191, v59, s21 op_sel_hi:[1,1,0]
  v_pk_fma_f16 v188, v188, v56, s23 op_sel:[0,0,1]
  v_pk_fma_f16 v189, v189, v57, s23 op_sel:[0,0,1]
  v_mfma_f32_32x32x16_bf16 v[16:31], a[164:167], v[180:183], v[16:31]
  s_nop 0
  s_waitcnt lgkmcnt(0)
  v_pk_fma_f16 v190, v190, v58, s23 op_sel:[0,0,1]
  v_pk_fma_f16 v191, v191, v59, s23 op_sel:[0,0,1]
  v_pk_fma_f16 v188, v188, v52, 0.5 op_sel_hi:[1,1,0] clamp
  v_pk_fma_f16 v189, v189, v53, 0.5 op_sel_hi:[1,1,0] clamp
  v_pk_fma_f16 v190, v190, v54, 0.5 op_sel_hi:[1,1,0] clamp
  v_pk_fma_f16 v191, v191, v55, 0.5 op_sel_hi:[1,1,0] clamp
  v_mfma_f32_32x32x16_f16 v[64:79], v[192:195], v[184:187], v[64:79]
  v_pk_mul_f16 v188, v188, v52
  v_pk_mul_f16 v189, v189, v53
  v_pk_mul_f16 v190, v190, v54
  v_pk_mul_f16 v191, v191, v55
  v_mfma_f32_16x16x32_bf16 v[156:159], v[216:219], v[220:223], 0
  ds_read_b128 v[216:219], v3
  ds_read_b128 v[220:223], v4
  v_mfma_f32_32x32x16_f16 v[80:95], v[196:199], v[184:187], v[80:95]
  v_cvt_pk_f16_f32 v48, v16, v17
  v_cvt_pk_f16_f32 v49, v18, v19
  v_cvt_pk_f16_f32 v50, v20, v21
  v_cvt_pk_f16_f32 v51, v22, v23
  v_cvt_pk_f16_f32 v52, v24, v25
  v_cvt_pk_f16_f32 v53, v26, v27
  v_mfma_f32_16x16x32_bf16 v[156:159], v[224:227], v[228:231], v[156:159]
  ds_read_b128 v[224:227], v3 offset:4800
  ds_read_b128 v[228:231], v4 offset:192
  v_mfma_f32_32x32x16_f16 v[96:111], v[200:203], v[184:187], v[96:111]
  v_cvt_pk_f16_f32 v54, v28, v29
  v_cvt_pk_f16_f32 v55, v30, v31
  v_pk_fma_f16 v56, v48, v48, s23 op_sel_hi:[1,1,0]
  v_pk_fma_f16 v57, v49, v49, s23 op_sel_hi:[1,1,0]
  v_pk_fma_f16 v58, v50, v50, s23 op_sel_hi:[1,1,0]
  v_pk_fma_f16 v59, v51, v51, s23 op_sel_hi:[1,1,0]
  v_mfma_f32_16x16x32_bf16 v[156:159], v[232:235], v[236:239], v[156:159]
  ds_read_b128 v[232:235], v3 offset:9600
  ds_read_b128 v[236:239], v4 offset:384
  v_mfma_f32_32x32x16_f16 v[64:79], v[204:207], v[188:191], v[64:79]
  v_pk_fma_f16 v184, v56, s20, s20 op_sel:[0,1,0] op_sel_hi:[1,1,0]
  v_pk_fma_f16 v185, v57, s20, s20 op_sel:[0,1,0] op_sel_hi:[1,1,0]
  v_pk_fma_f16 v186, v58, s20, s20 op_sel:[0,1,0] op_sel_hi:[1,1,0]
  v_pk_fma_f16 v187, v59, s20, s20 op_sel:[0,1,0] op_sel_hi:[1,1,0]
  v_pk_fma_f16 v184, v184, v56, s21 op_sel:[0,0,1]
  v_pk_fma_f16 v185, v185, v57, s21 op_sel:[0,0,1]
  v_mfma_f32_32x32x16_f16 v[80:95], v[208:211], v[188:191], v[80:95]
  v_pk_fma_f16 v186, v186, v58, s21 op_sel:[0,0,1]
  v_pk_fma_f16 v187, v187, v59, s21 op_sel:[0,0,1]
  v_pk_fma_f16 v184, v184, v56, s21 op_sel_hi:[1,1,0]
  v_pk_fma_f16 v185, v185, v57, s21 op_sel_hi:[1,1,0]
  v_pk_fma_f16 v186, v186, v58, s21 op_sel_hi:[1,1,0]
  v_pk_fma_f16 v187, v187, v59, s21 op_sel_hi:[1,1,0]
  v_mfma_f32_32x32x16_f16 v[96:111], v[212:215], v[188:191], v[96:111]
  s_nop 0
  s_waitcnt lgkmcnt(0)
  v_pk_fma_f16 v184, v184, v56, s23 op_sel:[0,0,1]
  v_pk_fma_f16 v185, v185, v57, s23 op_sel:[0,0,1]
  v_pk_fma_f16 v186, v186, v58, s23 op_sel:[0,0,1]
  v_pk_fma_f16 v187, v187, v59, s23 op_sel:[0,0,1]
  v_pk_fma_f16 v184, v184, v48, 0.5 op_sel_hi:[1,1,0] clamp
  v_pk_fma_f16 v185, v185, v49, 0.5 op_sel_hi:[1,1,0] clamp
  v_mfma_f32_32x32x16_bf16 v[16:31], a[168:171], v[160:163], 0
  ds_read_b128 v[192:195], v0 offset:43008
  ds_read_b128 v[196:199], v0 offset:44032
  v_pk_fma_f16 v186, v186, v50, 0.5 op_sel_hi:[1,1,0] clamp
  v_pk_fma_f16 v187, v187, v51, 0.5 op_sel_hi:[1,1,0] clamp
  v_pk_mul_f16 v184, v184, v48
  v_pk_mul_f16 v185, v185, v49
  v_mfma_f32_16x16x32_bf16 v[112:115], v[216:219], v[220:223], 0
  ds_read_b128 v[216:219], v3 offset:400
  ds_read_b128 v[220:223], v4 offset:16
  v_mfma_f32_32x32x16_bf16 v[16:31], a[172:175], v[164:167], v[16:31]
  ds_read_b128 v[200:203], v0 offset:45056
  ds_read_b128 v[204:207], v0 offset:46080
  v_pk_mul_f16 v186, v186, v50
  v_pk_mul_f16 v187, v187, v51
  v_pk_fma_f16 v56, v52, v52, s23 op_sel_hi:[1,1,0]
  v_pk_fma_f16 v57, v53, v53, s23 op_sel_hi:[1,1,0]
  v_mfma_f32_16x16x32_bf16 v[112:115], v[224:227], v[228:231], v[112:115]
  ds_read_b128 v[224:227], v3 offset:5200
  ds_read_b128 v[228:231], v4 offset:208
  v_mfma_f32_32x32x16_bf16 v[16:31], a[176:179], v[168:171], v[16:31]
  ds_read_b128 v[208:211], v0 offset:47104
  ds_read_b128 v[212:215], v0 offset:48128
  v_pk_fma_f16 v58, v54, v54, s23 op_sel_hi:[1,1,0]
  v_pk_fma_f16 v59, v55, v55, s23 op_sel_hi:[1,1,0]
  v_pk_fma_f16 v188, v56, s20, s20 op_sel:[0,1,0] op_sel_hi:[1,1,0]
  v_pk_fma_f16 v189, v57, s20, s20 op_sel:[0,1,0] op_sel_hi:[1,1,0]
  v_mfma_f32_16x16x32_bf16 v[112:115], v[232:235], v[236:239], v[112:115]
  ds_read_b128 v[232:235], v3 offset:10000
  ds_read_b128 v[236:239], v4 offset:400
  v_mfma_f32_32x32x16_bf16 v[16:31], a[180:183], v[172:175], v[16:31]
  buffer_store_dwordx4 v[128:131], v10, s[8:11], s28 offen offset:128
  v_pk_fma_f16 v190, v58, s20, s20 op_sel:[0,1,0] op_sel_hi:[1,1,0]
  v_pk_fma_f16 v191, v59, s20, s20 op_sel:[0,1,0] op_sel_hi:[1,1,0]
  v_pk_fma_f16 v188, v188, v56, s21 op_sel:[0,0,1]
  v_pk_fma_f16 v189, v189, v57, s21 op_sel:[0,0,1]
  v_pk_fma_f16 v190, v190, v58, s21 op_sel:[0,0,1]
  v_mfma_f32_32x32x16_bf16 v[16:31], a[184:187], v[176:179], v[16:31]
  v_pk_fma_f16 v191, v191, v59, s21 op_sel:[0,0,1]
  v_pk_fma_f16 v188, v188, v56, s21 op_sel_hi:[1,1,0]
  v_pk_fma_f16 v189, v189, v57, s21 op_sel_hi:[1,1,0]
  v_pk_fma_f16 v190, v190, v58, s21 op_sel_hi:[1,1,0]
  v_pk_fma_f16 v191, v191, v59, s21 op_sel_hi:[1,1,0]
  v_pk_fma_f16 v188, v188, v56, s23 op_sel:[0,0,1]
  v_mfma_f32_32x32x16_bf16 v[16:31], a[188:191], v[180:183], v[16:31]
  s_nop 0
  s_waitcnt lgkmcnt(0)
  v_pk_fma_f16 v189, v189, v57, s23 op_sel:[0,0,1]
  v_pk_fma_f16 v190, v190, v58, s23 op_sel:[0,0,1]
  v_pk_fma_f16 v191, v191, v59, s23 op_sel:[0,0,1]
  v_pk_fma_f16 v188, v188, v52, 0.5 op_sel_hi:[1,1,0] clamp
  v_pk_fma_f16 v189, v189, v53, 0.5 op_sel_hi:[1,1,0] clamp
  v_pk_fma_f16 v190, v190, v54, 0.5 op_sel_hi:[1,1,0] clamp
  v_mfma_f32_32x32x16_f16 v[64:79], v[192:195], v[184:187], v[64:79]
  v_pk_fma_f16 v191, v191, v55, 0.5 op_sel_hi:[1,1,0] clamp
  v_pk_mul_f16 v188, v188, v52
  v_pk_mul_f16 v189, v189, v53
  v_pk_mul_f16 v190, v190, v54
  v_pk_mul_f16 v191, v191, v55
  v_mfma_f32_16x16x32_bf16 v[116:119], v[216:219], v[220:223], 0
  ds_read_b128 v[216:219], v3 offset:800
  ds_read_b128 v[220:223], v4 offset:32
  v_mfma_f32_32x32x16_f16 v[80:95], v[196:199], v[184:187], v[80:95]
  v_cvt_pk_f16_f32 v48, v16, v17
  v_cvt_pk_f16_f32 v49, v18, v19
  v_cvt_pk_f16_f32 v50, v20, v21
  v_cvt_pk_f16_f32 v51, v22, v23
  v_cvt_pk_f16_f32 v52, v24, v25
  v_cvt_pk_f16_f32 v53, v26, v27
  v_mfma_f32_16x16x32_bf16 v[116:119], v[224:227], v[228:231], v[116:119]
  ds_read_b128 v[224:227], v3 offset:5600
  ds_read_b128 v[228:231], v4 offset:224
  v_mfma_f32_32x32x16_f16 v[96:111], v[200:203], v[184:187], v[96:111]
  v_cvt_pk_f16_f32 v54, v28, v29
  v_cvt_pk_f16_f32 v55, v30, v31
  v_pk_fma_f16 v56, v48, v48, s23 op_sel_hi:[1,1,0]
  v_pk_fma_f16 v57, v49, v49, s23 op_sel_hi:[1,1,0]
  v_pk_fma_f16 v58, v50, v50, s23 op_sel_hi:[1,1,0]
  v_pk_fma_f16 v59, v51, v51, s23 op_sel_hi:[1,1,0]
  v_mfma_f32_16x16x32_bf16 v[116:119], v[232:235], v[236:239], v[116:119]
  ds_read_b128 v[232:235], v3 offset:10400
  ds_read_b128 v[236:239], v4 offset:416
  v_mfma_f32_32x32x16_f16 v[64:79], v[204:207], v[188:191], v[64:79]
  v_pk_fma_f16 v184, v56, s20, s20 op_sel:[0,1,0] op_sel_hi:[1,1,0]
  v_pk_fma_f16 v185, v57, s20, s20 op_sel:[0,1,0] op_sel_hi:[1,1,0]
  v_pk_fma_f16 v186, v58, s20, s20 op_sel:[0,1,0] op_sel_hi:[1,1,0]
  v_pk_fma_f16 v187, v59, s20, s20 op_sel:[0,1,0] op_sel_hi:[1,1,0]
  v_pk_fma_f16 v184, v184, v56, s21 op_sel:[0,0,1]
  v_pk_fma_f16 v185, v185, v57, s21 op_sel:[0,0,1]
  v_mfma_f32_32x32x16_f16 v[80:95], v[208:211], v[188:191], v[80:95]
  v_pk_fma_f16 v186, v186, v58, s21 op_sel:[0,0,1]
  v_pk_fma_f16 v187, v187, v59, s21 op_sel:[0,0,1]
  v_pk_fma_f16 v184, v184, v56, s21 op_sel_hi:[1,1,0]
  v_pk_fma_f16 v185, v185, v57, s21 op_sel_hi:[1,1,0]
  v_pk_fma_f16 v186, v186, v58, s21 op_sel_hi:[1,1,0]
  v_pk_fma_f16 v187, v187, v59, s21 op_sel_hi:[1,1,0]
  v_mfma_f32_32x32x16_f16 v[96:111], v[212:215], v[188:191], v[96:111]
  s_nop 0
  s_waitcnt lgkmcnt(0)
  v_pk_fma_f16 v184, v184, v56, s23 op_sel:[0,0,1]
  v_pk_fma_f16 v185, v185, v57, s23 op_sel:[0,0,1]
  v_pk_fma_f16 v186, v186, v58, s23 op_sel:[0,0,1]
  v_pk_fma_f16 v187, v187, v59, s23 op_sel:[0,0,1]
  v_pk_fma_f16 v184, v184, v48, 0.5 op_sel_hi:[1,1,0] clamp
  v_pk_fma_f16 v185, v185, v49, 0.5 op_sel_hi:[1,1,0] clamp
  v_mfma_f32_32x32x16_bf16 v[16:31], a[192:195], v[160:163], 0
  ds_read_b128 v[192:195], v0 offset:49152
  ds_read_b128 v[196:199], v0 offset:50176
  v_pk_fma_f16 v186, v186, v50, 0.5 op_sel_hi:[1,1,0] clamp
  v_pk_fma_f16 v187, v187, v51, 0.5 op_sel_hi:[1,1,0] clamp
  v_pk_mul_f16 v184, v184, v48
  v_pk_mul_f16 v185, v185, v49
  v_mfma_f32_16x16x32_bf16 v[120:123], v[216:219], v[220:223], 0
  ds_read_b128 v[216:219], v3 offset:1200
  ds_read_b128 v[220:223], v4 offset:48
  v_mfma_f32_32x32x16_bf16 v[16:31], a[196:199], v[164:167], v[16:31]
  ds_read_b128 v[200:203], v0 offset:51200
  ds_read_b128 v[204:207], v0 offset:52224
  v_pk_mul_f16 v186, v186, v50
  v_pk_mul_f16 v187, v187, v51
  v_pk_fma_f16 v56, v52, v52, s23 op_sel_hi:[1,1,0]
  v_pk_fma_f16 v57, v53, v53, s23 op_sel_hi:[1,1,0]
  v_mfma_f32_16x16x32_bf16 v[120:123], v[224:227], v[228:231], v[120:123]
  ds_read_b128 v[224:227], v3 offset:6000
  ds_read_b128 v[228:231], v4 offset:240
  v_mfma_f32_32x32x16_bf16 v[16:31], a[200:203], v[168:171], v[16:31]
  ds_read_b128 v[208:211], v0 offset:53248
  ds_read_b128 v[212:215], v0 offset:54272
  v_pk_fma_f16 v58, v54, v54, s23 op_sel_hi:[1,1,0]
  v_pk_fma_f16 v59, v55, v55, s23 op_sel_hi:[1,1,0]
  v_pk_fma_f16 v188, v56, s20, s20 op_sel:[0,1,0] op_sel_hi:[1,1,0]
  v_pk_fma_f16 v189, v57, s20, s20 op_sel:[0,1,0] op_sel_hi:[1,1,0]
  v_mfma_f32_16x16x32_bf16 v[120:123], v[232:235], v[236:239], v[120:123]
  ds_read_b128 v[232:235], v3 offset:10800
  ds_read_b128 v[236:239], v4 offset:432
  v_mfma_f32_32x32x16_bf16 v[16:31], a[204:207], v[172:175], v[16:31]
  buffer_store_dwordx4 v[132:135], v10, s[8:11], s28 offen offset:160
  v_pk_fma_f16 v190, v58, s20, s20 op_sel:[0,1,0] op_sel_hi:[1,1,0]
  v_pk_fma_f16 v191, v59, s20, s20 op_sel:[0,1,0] op_sel_hi:[1,1,0]
  v_pk_fma_f16 v188, v188, v56, s21 op_sel:[0,0,1]
  v_pk_fma_f16 v189, v189, v57, s21 op_sel:[0,0,1]
  v_pk_fma_f16 v190, v190, v58, s21 op_sel:[0,0,1]
  v_mfma_f32_32x32x16_bf16 v[16:31], a[208:211], v[176:179], v[16:31]
  v_pk_fma_f16 v191, v191, v59, s21 op_sel:[0,0,1]
  v_pk_fma_f16 v188, v188, v56, s21 op_sel_hi:[1,1,0]
  v_pk_fma_f16 v189, v189, v57, s21 op_sel_hi:[1,1,0]
  v_pk_fma_f16 v190, v190, v58, s21 op_sel_hi:[1,1,0]
  v_pk_fma_f16 v191, v191, v59, s21 op_sel_hi:[1,1,0]
  v_pk_fma_f16 v188, v188, v56, s23 op_sel:[0,0,1]
  v_mfma_f32_32x32x16_bf16 v[16:31], a[212:215], v[180:183], v[16:31]
  s_nop 0
  s_waitcnt lgkmcnt(0)
  v_pk_fma_f16 v189, v189, v57, s23 op_sel:[0,0,1]
  v_pk_fma_f16 v190, v190, v58, s23 op_sel:[0,0,1]
  v_pk_fma_f16 v191, v191, v59, s23 op_sel:[0,0,1]
  v_pk_fma_f16 v188, v188, v52, 0.5 op_sel_hi:[1,1,0] clamp
  v_pk_fma_f16 v189, v189, v53, 0.5 op_sel_hi:[1,1,0] clamp
  v_pk_fma_f16 v190, v190, v54, 0.5 op_sel_hi:[1,1,0] clamp
  v_mfma_f32_32x32x16_f16 v[64:79], v[192:195], v[184:187], v[64:79]
  v_pk_fma_f16 v191, v191, v55, 0.5 op_sel_hi:[1,1,0] clamp
  v_pk_mul_f16 v188, v188, v52
  v_pk_mul_f16 v189, v189, v53
  v_pk_mul_f16 v190, v190, v54
  v_pk_mul_f16 v191, v191, v55
  v_mfma_f32_16x16x32_bf16 v[124:127], v[216:219], v[220:223], 0
  ds_read_b128 v[216:219], v3 offset:1600
  ds_read_b128 v[220:223], v4 offset:64
  v_mfma_f32_32x32x16_f16 v[80:95], v[196:199], v[184:187], v[80:95]
  v_cvt_pk_f16_f32 v48, v16, v17
  v_cvt_pk_f16_f32 v49, v18, v19
  v_cvt_pk_f16_f32 v50, v20, v21
  v_cvt_pk_f16_f32 v51, v22, v23
  v_cvt_pk_f16_f32 v52, v24, v25
  v_cvt_pk_f16_f32 v53, v26, v27
  v_mfma_f32_16x16x32_bf16 v[124:127], v[224:227], v[228:231], v[124:127]
  ds_read_b128 v[224:227], v3 offset:6400
  ds_read_b128 v[228:231], v4 offset:256
  v_mfma_f32_32x32x16_f16 v[96:111], v[200:203], v[184:187], v[96:111]
  v_cvt_pk_f16_f32 v54, v28, v29
  v_cvt_pk_f16_f32 v55, v30, v31
  v_pk_fma_f16 v56, v48, v48, s23 op_sel_hi:[1,1,0]
  v_pk_fma_f16 v57, v49, v49, s23 op_sel_hi:[1,1,0]
  v_pk_fma_f16 v58, v50, v50, s23 op_sel_hi:[1,1,0]
  v_pk_fma_f16 v59, v51, v51, s23 op_sel_hi:[1,1,0]
  v_mfma_f32_16x16x32_bf16 v[124:127], v[232:235], v[236:239], v[124:127]
  ds_read_b128 v[232:235], v3 offset:11200
  ds_read_b128 v[236:239], v4 offset:448
  v_mfma_f32_32x32x16_f16 v[64:79], v[204:207], v[188:191], v[64:79]
  v_pk_fma_f16 v184, v56, s20, s20 op_sel:[0,1,0] op_sel_hi:[1,1,0]
  v_pk_fma_f16 v185, v57, s20, s20 op_sel:[0,1,0] op_sel_hi:[1,1,0]
  v_pk_fma_f16 v186, v58, s20, s20 op_sel:[0,1,0] op_sel_hi:[1,1,0]
  v_pk_fma_f16 v187, v59, s20, s20 op_sel:[0,1,0] op_sel_hi:[1,1,0]
  v_pk_fma_f16 v184, v184, v56, s21 op_sel:[0,0,1]
  v_pk_fma_f16 v185, v185, v57, s21 op_sel:[0,0,1]
  v_mfma_f32_32x32x16_f16 v[80:95], v[208:211], v[188:191], v[80:95]
  v_pk_fma_f16 v186, v186, v58, s21 op_sel:[0,0,1]
  v_pk_fma_f16 v187, v187, v59, s21 op_sel:[0,0,1]
  v_pk_fma_f16 v184, v184, v56, s21 op_sel_hi:[1,1,0]
  v_pk_fma_f16 v185, v185, v57, s21 op_sel_hi:[1,1,0]
  v_pk_fma_f16 v186, v186, v58, s21 op_sel_hi:[1,1,0]
  v_pk_fma_f16 v187, v187, v59, s21 op_sel_hi:[1,1,0]
  v_mfma_f32_32x32x16_f16 v[96:111], v[212:215], v[188:191], v[96:111]
  s_nop 0
  s_waitcnt lgkmcnt(0)
  v_pk_fma_f16 v184, v184, v56, s23 op_sel:[0,0,1]
  v_pk_fma_f16 v185, v185, v57, s23 op_sel:[0,0,1]
  v_pk_fma_f16 v186, v186, v58, s23 op_sel:[0,0,1]
  v_pk_fma_f16 v187, v187, v59, s23 op_sel:[0,0,1]
  v_pk_fma_f16 v184, v184, v48, 0.5 op_sel_hi:[1,1,0] clamp
  v_pk_fma_f16 v185, v185, v49, 0.5 op_sel_hi:[1,1,0] clamp
  v_mfma_f32_32x32x16_bf16 v[16:31], a[216:219], v[160:163], 0
  ds_read_b128 v[192:195], v0 offset:55296
  ds_read_b128 v[196:199], v0 offset:56320
  v_pk_fma_f16 v186, v186, v50, 0.5 op_sel_hi:[1,1,0] clamp
  v_pk_fma_f16 v187, v187, v51, 0.5 op_sel_hi:[1,1,0] clamp
  v_pk_mul_f16 v184, v184, v48
  v_pk_mul_f16 v185, v185, v49
  v_mfma_f32_16x16x32_bf16 v[128:131], v[216:219], v[220:223], 0
  ds_read_b128 v[216:219], v3 offset:2000
  ds_read_b128 v[220:223], v4 offset:80
  v_mfma_f32_32x32x16_bf16 v[16:31], a[220:223], v[164:167], v[16:31]
  ds_read_b128 v[200:203], v0 offset:57344
  ds_read_b128 v[204:207], v0 offset:58368
  v_pk_mul_f16 v186, v186, v50
  v_pk_mul_f16 v187, v187, v51
  v_pk_fma_f16 v56, v52, v52, s23 op_sel_hi:[1,1,0]
  v_pk_fma_f16 v57, v53, v53, s23 op_sel_hi:[1,1,0]
  v_mfma_f32_16x16x32_bf16 v[128:131], v[224:227], v[228:231], v[128:131]
  ds_read_b128 v[224:227], v3 offset:6800
  ds_read_b128 v[228:231], v4 offset:272
  v_mfma_f32_32x32x16_bf16 v[16:31], a[224:227], v[168:171], v[16:31]
  ds_read_b128 v[208:211], v0 offset:59392
  ds_read_b128 v[212:215], v0 offset:60416
  v_pk_fma_f16 v58, v54, v54, s23 op_sel_hi:[1,1,0]
  v_pk_fma_f16 v59, v55, v55, s23 op_sel_hi:[1,1,0]
  v_pk_fma_f16 v188, v56, s20, s20 op_sel:[0,1,0] op_sel_hi:[1,1,0]
  v_pk_fma_f16 v189, v57, s20, s20 op_sel:[0,1,0] op_sel_hi:[1,1,0]
  v_mfma_f32_16x16x32_bf16 v[128:131], v[232:235], v[236:239], v[128:131]
  ds_read_b128 v[232:235], v3 offset:11600
  ds_read_b128 v[236:239], v4 offset:464
  v_mfma_f32_32x32x16_bf16 v[16:31], a[228:231], v[172:175], v[16:31]
  v_pk_fma_f16 v190, v58, s20, s20 op_sel:[0,1,0] op_sel_hi:[1,1,0]
  v_pk_fma_f16 v191, v59, s20, s20 op_sel:[0,1,0] op_sel_hi:[1,1,0]
  v_pk_fma_f16 v188, v188, v56, s21 op_sel:[0,0,1]
  v_pk_fma_f16 v189, v189, v57, s21 op_sel:[0,0,1]
  v_pk_fma_f16 v190, v190, v58, s21 op_sel:[0,0,1]
  v_pk_fma_f16 v191, v191, v59, s21 op_sel:[0,0,1]
  v_mfma_f32_32x32x16_bf16 v[16:31], a[232:235], v[176:179], v[16:31]
  v_pk_fma_f16 v188, v188, v56, s21 op_sel_hi:[1,1,0]
  v_pk_fma_f16 v189, v189, v57, s21 op_sel_hi:[1,1,0]
  v_pk_fma_f16 v190, v190, v58, s21 op_sel_hi:[1,1,0]
  v_pk_fma_f16 v191, v191, v59, s21 op_sel_hi:[1,1,0]
  v_pk_fma_f16 v188, v188, v56, s23 op_sel:[0,0,1]
  v_pk_fma_f16 v189, v189, v57, s23 op_sel:[0,0,1]
  v_mfma_f32_32x32x16_bf16 v[16:31], a[236:239], v[180:183], v[16:31]
  s_nop 0
  s_waitcnt lgkmcnt(0)
  v_pk_fma_f16 v190, v190, v58, s23 op_sel:[0,0,1]
  v_pk_fma_f16 v191, v191, v59, s23 op_sel:[0,0,1]
  v_pk_fma_f16 v188, v188, v52, 0.5 op_sel_hi:[1,1,0] clamp
  v_pk_fma_f16 v189, v189, v53, 0.5 op_sel_hi:[1,1,0] clamp
  v_pk_fma_f16 v190, v190, v54, 0.5 op_sel_hi:[1,1,0] clamp
  v_pk_fma_f16 v191, v191, v55, 0.5 op_sel_hi:[1,1,0] clamp
  v_mfma_f32_32x32x16_f16 v[64:79], v[192:195], v[184:187], v[64:79]
  v_pk_mul_f16 v188, v188, v52
  v_pk_mul_f16 v189, v189, v53
  v_pk_mul_f16 v190, v190, v54
  v_pk_mul_f16 v191, v191, v55
  v_mfma_f32_16x16x32_bf16 v[132:135], v[216:219], v[220:223], 0
  v_cvt_pk_f16_f32 v48, v16, v17
  v_cvt_pk_f16_f32 v49, v18, v19
  v_mfma_f32_32x32x16_f16 v[80:95], v[196:199], v[184:187], v[80:95]
  v_cvt_pk_f16_f32 v50, v20, v21
  v_cvt_pk_f16_f32 v51, v22, v23
  v_cvt_pk_f16_f32 v52, v24, v25
  v_cvt_pk_f16_f32 v53, v26, v27
  v_cvt_pk_f16_f32 v54, v28, v29
  v_cvt_pk_f16_f32 v55, v30, v31
  v_mfma_f32_16x16x32_bf16 v[132:135], v[224:227], v[228:231], v[132:135]
  v_pk_fma_f16 v56, v48, v48, s23 op_sel_hi:[1,1,0]
  v_pk_fma_f16 v57, v49, v49, s23 op_sel_hi:[1,1,0]
  v_mfma_f32_32x32x16_f16 v[96:111], v[200:203], v[184:187], v[96:111]
  v_pk_fma_f16 v58, v50, v50, s23 op_sel_hi:[1,1,0]
  v_pk_fma_f16 v59, v51, v51, s23 op_sel_hi:[1,1,0]
  v_pk_fma_f16 v184, v56, s20, s20 op_sel:[0,1,0] op_sel_hi:[1,1,0]
  v_pk_fma_f16 v185, v57, s20, s20 op_sel:[0,1,0] op_sel_hi:[1,1,0]
  v_pk_fma_f16 v186, v58, s20, s20 op_sel:[0,1,0] op_sel_hi:[1,1,0]
  v_pk_fma_f16 v187, v59, s20, s20 op_sel:[0,1,0] op_sel_hi:[1,1,0]
  v_mfma_f32_16x16x32_bf16 v[132:135], v[232:235], v[236:239], v[132:135]
  ds_read_b128 v[236:239], v0 offset:17408
  v_pk_fma_f16 v184, v184, v56, s21 op_sel:[0,0,1]
  v_mfma_f32_32x32x16_f16 v[64:79], v[204:207], v[188:191], v[64:79]
  s_nop 0
  s_mov_b32 s28, s34
  v_pk_fma_f16 v185, v185, v57, s21 op_sel:[0,0,1]
  v_pk_fma_f16 v186, v186, v58, s21 op_sel:[0,0,1]
  v_pk_fma_f16 v187, v187, v59, s21 op_sel:[0,0,1]
  v_pk_fma_f16 v184, v184, v56, s21 op_sel_hi:[1,1,0]
  v_pk_fma_f16 v185, v185, v57, s21 op_sel_hi:[1,1,0]
  v_pk_fma_f16 v186, v186, v58, s21 op_sel_hi:[1,1,0]
  v_pk_fma_f16 v187, v187, v59, s21 op_sel_hi:[1,1,0]
  v_mfma_f32_32x32x16_f16 v[80:95], v[208:211], v[188:191], v[80:95]
  s_add_u32 s34, s34, 0x60000
  v_pk_fma_f16 v184, v184, v56, s23 op_sel:[0,0,1]
  v_pk_fma_f16 v185, v185, v57, s23 op_sel:[0,0,1]
  v_pk_fma_f16 v186, v186, v58, s23 op_sel:[0,0,1]
  v_pk_fma_f16 v187, v187, v59, s23 op_sel:[0,0,1]
  v_pk_fma_f16 v184, v184, v48, 0.5 op_sel_hi:[1,1,0] clamp
  v_pk_fma_f16 v185, v185, v49, 0.5 op_sel_hi:[1,1,0] clamp
  v_pk_fma_f16 v186, v186, v50, 0.5 op_sel_hi:[1,1,0] clamp
  v_mfma_f32_32x32x16_f16 v[96:111], v[212:215], v[188:191], v[96:111]
  s_nop 0
  s_waitcnt lgkmcnt(0)
  v_pk_fma_f16 v187, v187, v51, 0.5 op_sel_hi:[1,1,0] clamp
  v_pk_mul_f16 v184, v184, v48
  v_pk_mul_f16 v185, v185, v49
  v_pk_mul_f16 v186, v186, v50
  v_pk_mul_f16 v187, v187, v51
  v_pk_fma_f16 v56, v52, v52, s23 op_sel_hi:[1,1,0]
  v_pk_fma_f16 v57, v53, v53, s23 op_sel_hi:[1,1,0]
  v_mfma_f32_32x32x16_bf16 v[16:31], v[32:35], v[160:163], 0
  ds_read_b128 v[192:195], v0 offset:61440
  ds_read_b128 v[196:199], v0 offset:62464
  v_pk_fma_f16 v58, v54, v54, s23 op_sel_hi:[1,1,0]
  v_pk_fma_f16 v59, v55, v55, s23 op_sel_hi:[1,1,0]
  v_pk_fma_f16 v188, v56, s20, s20 op_sel:[0,1,0] op_sel_hi:[1,1,0]
  v_pk_fma_f16 v189, v57, s20, s20 op_sel:[0,1,0] op_sel_hi:[1,1,0]
  v_pk_fma_f16 v190, v58, s20, s20 op_sel:[0,1,0] op_sel_hi:[1,1,0]
  v_pk_fma_f16 v191, v59, s20, s20 op_sel:[0,1,0] op_sel_hi:[1,1,0]
  v_pk_fma_f16 v188, v188, v56, s21 op_sel:[0,0,1]
  v_pk_fma_f16 v189, v189, v57, s21 op_sel:[0,0,1]
  v_pk_add_f32 v[12:13], v[112:113], v[114:115]
  v_pk_mul_f32 v[14:15], v[112:113], v[112:113]
  v_pk_fma_f32 v[14:15], v[114:115], v[114:115], v[14:15]
  v_pk_add_f32 v[12:13], v[12:13], v[116:117]
  v_pk_fma_f32 v[14:15], v[116:117], v[116:117], v[14:15]
  v_pk_add_f32 v[12:13], v[12:13], v[118:119]
  v_pk_fma_f32 v[14:15], v[118:119], v[118:119], v[14:15]
  v_pk_add_f32 v[12:13], v[12:13], v[120:121]
  v_pk_fma_f32 v[14:15], v[120:121], v[120:121], v[14:15]
  v_pk_add_f32 v[12:13], v[12:13], v[122:123]
  v_pk_fma_f32 v[14:15], v[122:123], v[122:123], v[14:15]
  v_pk_add_f32 v[12:13], v[12:13], v[124:125]
  v_pk_fma_f32 v[14:15], v[124:125], v[124:125], v[14:15]
  v_pk_add_f32 v[12:13], v[12:13], v[126:127]
  v_pk_fma_f32 v[14:15], v[126:127], v[126:127], v[14:15]
  v_pk_add_f32 v[12:13], v[12:13], v[128:129]
  v_pk_fma_f32 v[14:15], v[128:129], v[128:129], v[14:15]
  v_pk_add_f32 v[12:13], v[12:13], v[130:131]
  v_pk_fma_f32 v[14:15], v[130:131], v[130:131], v[14:15]
  v_pk_add_f32 v[12:13], v[12:13], v[132:133]
  v_pk_fma_f32 v[14:15], v[132:133], v[132:133], v[14:15]
  v_pk_add_f32 v[12:13], v[12:13], v[134:135]
  v_pk_fma_f32 v[14:15], v[134:135], v[134:135], v[14:15]
  v_pk_add_f32 v[12:13], v[12:13], v[136:137]
  v_pk_fma_f32 v[14:15], v[136:137], v[136:137], v[14:15]
  v_pk_add_f32 v[12:13], v[12:13], v[138:139]
  v_pk_fma_f32 v[14:15], v[138:139], v[138:139], v[14:15]
  v_pk_add_f32 v[12:13], v[12:13], v[140:141]
  v_pk_fma_f32 v[14:15], v[140:141], v[140:141], v[14:15]
  v_pk_add_f32 v[12:13], v[12:13], v[142:143]
  v_pk_fma_f32 v[14:15], v[142:143], v[142:143], v[14:15]
  v_pk_add_f32 v[12:13], v[12:13], v[144:145]
  v_pk_fma_f32 v[14:15], v[144:145], v[144:145], v[14:15]
  v_pk_add_f32 v[12:13], v[12:13], v[146:147]
  v_pk_fma_f32 v[14:15], v[146:147], v[146:147], v[14:15]
  v_pk_add_f32 v[12:13], v[12:13], v[148:149]
  v_pk_fma_f32 v[14:15], v[148:149], v[148:149], v[14:15]
  v_pk_add_f32 v[12:13], v[12:13], v[150:151]
  v_pk_fma_f32 v[14:15], v[150:151], v[150:151], v[14:15]
  v_pk_add_f32 v[12:13], v[12:13], v[152:153]
  v_pk_fma_f32 v[14:15], v[152:153], v[152:153], v[14:15]
  v_pk_add_f32 v[12:13], v[12:13], v[154:155]
  v_pk_fma_f32 v[14:15], v[154:155], v[154:155], v[14:15]
  v_pk_add_f32 v[12:13], v[12:13], v[156:157]
  v_pk_fma_f32 v[14:15], v[156:157], v[156:157], v[14:15]
  v_pk_add_f32 v[12:13], v[12:13], v[158:159]
  v_pk_fma_f32 v[14:15], v[158:159], v[158:159], v[14:15]
  v_mfma_f32_32x32x16_bf16 v[16:31], v[36:39], v[164:167], v[16:31]
  ds_read_b128 v[200:203], v0 offset:63488
  ds_read_b128 v[204:207], v0 offset:64512
  v_add_f32 v12, v12, v13
  v_add_f32 v14, v14, v15
  s_nop 1
  v_permlane32_swap_b32 v12, v14
  v_pk_fma_f16 v190, v190, v58, s21 op_sel:[0,0,1]
  v_mfma_f32_32x32x16_bf16 v[16:31], v[40:43], v[168:171], v[16:31]
  ds_read_b128 v[208:211], v1
  ds_read_b128 v[212:215], v1 offset:1024
  v_add_f32 v12, v12, v14
  v_mov_b32 v14, v12
  s_nop 1
  v_permlane32_swap_b32 v12, v14
  v_mul_f32_e64 v12, s24, v12
  v_mfma_f32_32x32x16_bf16 v[16:31], v[44:47], v[172:175], v[16:31]
  v_pk_fma_f16 v191, v191, v59, s21 op_sel:[0,0,1]
  v_pk_fma_f16 v188, v188, v56, s21 op_sel_hi:[1,1,0]
  v_mul_f32_e64 v13, s24, v14
  v_pk_fma_f16 v189, v189, v57, s21 op_sel_hi:[1,1,0]
  v_fma_f32 v13, -v12, v12, v13
  v_pk_fma_f16 v190, v190, v58, s21 op_sel_hi:[1,1,0]
  v_max_f32_e64 v13, 0, v13
  v_mfma_f32_32x32x16_bf16 v[16:31], v[60:63], v[176:179], v[16:31]
  v_add_f32 v13, s25, v13
  v_rsq_f32 v13, v13
  v_pk_fma_f16 v191, v191, v59, s21 op_sel_hi:[1,1,0]
  v_mul_f32 v14, s22, v13
  v_mul_f32_e64 v12, -v12, v14
  v_pk_fma_f16 v188, v188, v56, s23 op_sel:[0,0,1]
  v_mfma_f32_32x32x16_bf16 v[16:31], v[236:239], v[180:183], v[16:31]
  s_waitcnt lgkmcnt(0)
  v_pk_fma_f16 v189, v189, v57, s23 op_sel:[0,0,1]
  v_pk_fma_f16 v190, v190, v58, s23 op_sel:[0,0,1]
  v_pk_fma_f16 v191, v191, v59, s23 op_sel:[0,0,1]
  v_pk_fma_f16 v188, v188, v52, 0.5 op_sel_hi:[1,1,0] clamp
  v_pk_fma_f16 v189, v189, v53, 0.5 op_sel_hi:[1,1,0] clamp
  v_pk_fma_f16 v190, v190, v54, 0.5 op_sel_hi:[1,1,0] clamp
  v_pk_fma_f16 v191, v191, v55, 0.5 op_sel_hi:[1,1,0] clamp
  v_pk_mul_f16 v188, v188, v52
  v_pk_mul_f16 v189, v189, v53
  v_pk_mul_f16 v190, v190, v54
  v_pk_mul_f16 v191, v191, v55
  v_pk_fma_f32 v[112:113], v[112:113], v[14:15], v[12:13] op_sel_hi:[1,0,0]
  v_pk_fma_f32 v[114:115], v[114:115], v[14:15], v[12:13] op_sel_hi:[1,0,0]
  v_pk_fma_f32 v[116:117], v[116:117], v[14:15], v[12:13] op_sel_hi:[1,0,0]
  v_pk_fma_f32 v[118:119], v[118:119], v[14:15], v[12:13] op_sel_hi:[1,0,0]
  v_pk_fma_f32 v[120:121], v[120:121], v[14:15], v[12:13] op_sel_hi:[1,0,0]
  v_pk_fma_f32 v[122:123], v[122:123], v[14:15], v[12:13] op_sel_hi:[1,0,0]
  v_pk_fma_f32 v[124:125], v[124:125], v[14:15], v[12:13] op_sel_hi:[1,0,0]
  v_pk_fma_f32 v[126:127], v[126:127], v[14:15], v[12:13] op_sel_hi:[1,0,0]
  v_pk_fma_f32 v[128:129], v[128:129], v[14:15], v[12:13] op_sel_hi:[1,0,0]
  v_pk_fma_f32 v[130:131], v[130:131], v[14:15], v[12:13] op_sel_hi:[1,0,0]
  v_pk_fma_f32 v[132:133], v[132:133], v[14:15], v[12:13] op_sel_hi:[1,0,0]
  v_pk_fma_f32 v[134:135], v[134:135], v[14:15], v[12:13] op_sel_hi:[1,0,0]
  v_pk_fma_f32 v[136:137], v[136:137], v[14:15], v[12:13] op_sel_hi:[1,0,0]
  v_pk_fma_f32 v[138:139], v[138:139], v[14:15], v[12:13] op_sel_hi:[1,0,0]
  v_pk_fma_f32 v[140:141], v[140:141], v[14:15], v[12:13] op_sel_hi:[1,0,0]
  v_pk_fma_f32 v[142:143], v[142:143], v[14:15], v[12:13] op_sel_hi:[1,0,0]
  v_pk_fma_f32 v[144:145], v[144:145], v[14:15], v[12:13] op_sel_hi:[1,0,0]
  v_pk_fma_f32 v[146:147], v[146:147], v[14:15], v[12:13] op_sel_hi:[1,0,0]
  v_pk_fma_f32 v[148:149], v[148:149], v[14:15], v[12:13] op_sel_hi:[1,0,0]
  v_pk_fma_f32 v[150:151], v[150:151], v[14:15], v[12:13] op_sel_hi:[1,0,0]
  v_pk_fma_f32 v[152:153], v[152:153], v[14:15], v[12:13] op_sel_hi:[1,0,0]
  v_pk_fma_f32 v[154:155], v[154:155], v[14:15], v[12:13] op_sel_hi:[1,0,0]
  v_pk_fma_f32 v[156:157], v[156:157], v[14:15], v[12:13] op_sel_hi:[1,0,0]
  v_pk_fma_f32 v[158:159], v[158:159], v[14:15], v[12:13] op_sel_hi:[1,0,0]
  v_mfma_f32_32x32x16_f16 v[64:79], v[192:195], v[184:187], v[64:79]
  ds_read_b128 v[216:219], v0 offset:18432
  ds_read_b128 v[220:223], v0 offset:19456
  v_cndmask_b32 v159, v159, v250, s[12:13]
  v_cvt_pk_bf16_f32 v160, v112, v113
  v_cvt_pk_bf16_f32 v161, v114, v115
  v_cvt_pk_bf16_f32 v162, v116, v117
  v_cvt_pk_f16_f32 v48, v16, v17
  v_mfma_f32_32x32x16_f16 v[80:95], v[196:199], v[184:187], v[80:95]
  ds_read_b128 v[224:227], v0 offset:20480
  ds_read_b128 v[228:231], v0 offset:21504
  v_cvt_pk_bf16_f32 v163, v118, v119
  v_cvt_pk_bf16_f32 v164, v120, v121
  v_cvt_pk_bf16_f32 v165, v122, v123
  v_cvt_pk_bf16_f32 v166, v124, v125
  v_cvt_pk_f16_f32 v49, v18, v19
  v_mfma_f32_32x32x16_f16 v[96:111], v[200:203], v[184:187], v[96:111]
  ds_read_b128 v[232:235], v0 offset:22528
  ds_read_b128 v[236:239], v0 offset:23552
  v_cvt_pk_bf16_f32 v167, v126, v127
  v_cvt_pk_bf16_f32 v168, v128, v129
  v_cvt_pk_bf16_f32 v169, v130, v131
  v_cvt_pk_bf16_f32 v170, v132, v133
  v_cvt_pk_f16_f32 v50, v20, v21
  v_mfma_f32_32x32x16_f16 v[64:79], v[204:207], v[188:191], v[64:79]
  v_cvt_pk_bf16_f32 v171, v134, v135
  v_cvt_pk_bf16_f32 v172, v136, v137
  v_cvt_pk_f16_f32 v51, v22, v23
  v_cvt_pk_bf16_f32 v173, v138, v139
  v_cvt_pk_f16_f32 v52, v24, v25
  v_cvt_pk_bf16_f32 v174, v140, v141
  v_cvt_pk_f16_f32 v53, v26, v27
  v_mfma_f32_32x32x16_f16 v[80:95], v[208:211], v[188:191], v[80:95]
  v_cvt_pk_bf16_f32 v175, v142, v143
  v_cvt_pk_bf16_f32 v176, v144, v145
  v_cvt_pk_f16_f32 v54, v28, v29
  v_cvt_pk_bf16_f32 v177, v146, v147
  v_cvt_pk_f16_f32 v55, v30, v31
  v_cvt_pk_bf16_f32 v178, v148, v149
  v_pk_fma_f16 v56, v48, v48, s23 op_sel_hi:[1,1,0]
  v_mfma_f32_32x32x16_f16 v[96:111], v[212:215], v[188:191], v[96:111]
  s_nop 0
  s_waitcnt lgkmcnt(0)
  v_cvt_pk_bf16_f32 v179, v150, v151
  v_cvt_pk_bf16_f32 v180, v152, v153
  v_pk_fma_f16 v57, v49, v49, s23 op_sel_hi:[1,1,0]
  v_cvt_pk_bf16_f32 v181, v154, v155
  v_cvt_pk_bf16_f32 v182, v156, v157
  v_pk_fma_f16 v58, v50, v50, s23 op_sel_hi:[1,1,0]
  v_cvt_pk_bf16_f32 v183, v158, v159
  v_pk_fma_f16 v59, v51, v51, s23 op_sel_hi:[1,1,0]
  s_sub_u32 s26, s26, 1
  s_cmp_lg_u32 s26, 0
  s_waitcnt vmcnt(4)
  s_cbranch_scc1 L_loop
  v_mfma_f32_32x32x16_bf16 v[16:31], v[216:219], v[160:163], 0
  ds_read_b128 v[192:195], v1 offset:2048
  ds_read_b128 v[196:199], v1 offset:3072
  ds_read_b128 v[200:203], v1 offset:4096
  v_pk_fma_f16 v184, v56, s20, s20 op_sel:[0,1,0] op_sel_hi:[1,1,0]
  v_pk_fma_f16 v185, v57, s20, s20 op_sel:[0,1,0] op_sel_hi:[1,1,0]
  v_pk_fma_f16 v186, v58, s20, s20 op_sel:[0,1,0] op_sel_hi:[1,1,0]
  v_pk_fma_f16 v187, v59, s20, s20 op_sel:[0,1,0] op_sel_hi:[1,1,0]
  v_pk_fma_f16 v184, v184, v56, s21 op_sel:[0,0,1]
  v_mfma_f32_32x32x16_bf16 v[16:31], v[220:223], v[164:167], v[16:31]
  ds_read_b128 v[204:207], v1 offset:5120
  ds_read_b128 v[208:211], v1 offset:6144
  ds_read_b128 v[212:215], v1 offset:7168
  v_pk_fma_f16 v185, v185, v57, s21 op_sel:[0,0,1]
  v_pk_fma_f16 v186, v186, v58, s21 op_sel:[0,0,1]
  v_pk_fma_f16 v187, v187, v59, s21 op_sel:[0,0,1]
  v_pk_fma_f16 v184, v184, v56, s21 op_sel_hi:[1,1,0]
  v_pk_fma_f16 v185, v185, v57, s21 op_sel_hi:[1,1,0]
  v_pk_fma_f16 v186, v186, v58, s21 op_sel_hi:[1,1,0]
  v_mfma_f32_32x32x16_bf16 v[16:31], v[224:227], v[168:171], v[16:31]
  ds_read_b128 v[136:139], v5
  ds_read_b128 v[140:143], v5 offset:32
  ds_read_b128 v[144:147], v5 offset:64
  v_pk_fma_f16 v187, v187, v59, s21 op_sel_hi:[1,1,0]
  v_pk_fma_f16 v184, v184, v56, s23 op_sel:[0,0,1]
  v_pk_fma_f16 v185, v185, v57, s23 op_sel:[0,0,1]
  v_pk_fma_f16 v186, v186, v58, s23 op_sel:[0,0,1]
  v_pk_fma_f16 v187, v187, v59, s23 op_sel:[0,0,1]
  v_pk_fma_f16 v184, v184, v48, 0.5 op_sel_hi:[1,1,0] clamp
  v_mfma_f32_32x32x16_bf16 v[16:31], v[228:231], v[172:175], v[16:31]
  ds_read_b128 v[148:151], v5 offset:96
  ds_read_b128 v[152:155], v5 offset:128
  ds_read_b128 v[156:159], v5 offset:160
  v_pk_fma_f16 v185, v185, v49, 0.5 op_sel_hi:[1,1,0] clamp
  v_pk_fma_f16 v186, v186, v50, 0.5 op_sel_hi:[1,1,0] clamp
  v_pk_fma_f16 v187, v187, v51, 0.5 op_sel_hi:[1,1,0] clamp
  v_pk_mul_f16 v184, v184, v48
  v_pk_mul_f16 v185, v185, v49
  v_pk_mul_f16 v186, v186, v50
  v_mfma_f32_32x32x16_bf16 v[16:31], v[232:235], v[176:179], v[16:31]
  v_pk_mul_f16 v187, v187, v51
  v_pk_fma_f16 v56, v52, v52, s23 op_sel_hi:[1,1,0]
  v_pk_fma_f16 v57, v53, v53, s23 op_sel_hi:[1,1,0]
  v_pk_fma_f16 v58, v54, v54, s23 op_sel_hi:[1,1,0]
  v_pk_fma_f16 v59, v55, v55, s23 op_sel_hi:[1,1,0]
  v_pk_fma_f16 v188, v56, s20, s20 op_sel:[0,1,0] op_sel_hi:[1,1,0]
  v_pk_fma_f16 v189, v57, s20, s20 op_sel:[0,1,0] op_sel_hi:[1,1,0]
  v_pk_fma_f16 v190, v58, s20, s20 op_sel:[0,1,0] op_sel_hi:[1,1,0]
  v_pk_fma_f16 v191, v59, s20, s20 op_sel:[0,1,0] op_sel_hi:[1,1,0]
  v_mfma_f32_32x32x16_bf16 v[16:31], v[236:239], v[180:183], v[16:31]
  s_nop 0
  s_waitcnt lgkmcnt(0)
  v_pk_fma_f16 v188, v188, v56, s21 op_sel:[0,0,1]
  v_pk_fma_f16 v189, v189, v57, s21 op_sel:[0,0,1]
  v_pk_fma_f16 v190, v190, v58, s21 op_sel:[0,0,1]
  v_pk_fma_f16 v191, v191, v59, s21 op_sel:[0,0,1]
  v_pk_fma_f16 v188, v188, v56, s21 op_sel_hi:[1,1,0]
  v_pk_fma_f16 v189, v189, v57, s21 op_sel_hi:[1,1,0]
  v_pk_fma_f16 v190, v190, v58, s21 op_sel_hi:[1,1,0]
  v_pk_fma_f16 v191, v191, v59, s21 op_sel_hi:[1,1,0]
  v_pk_fma_f16 v188, v188, v56, s23 op_sel:[0,0,1]
  v_mfma_f32_32x32x16_f16 v[64:79], v[192:195], v[184:187], v[64:79]
  v_pk_fma_f16 v189, v189, v57, s23 op_sel:[0,0,1]
  v_pk_fma_f16 v190, v190, v58, s23 op_sel:[0,0,1]
  v_pk_fma_f16 v191, v191, v59, s23 op_sel:[0,0,1]
  v_pk_fma_f16 v188, v188, v52, 0.5 op_sel_hi:[1,1,0] clamp
  v_pk_fma_f16 v189, v189, v53, 0.5 op_sel_hi:[1,1,0] clamp
  v_pk_fma_f16 v190, v190, v54, 0.5 op_sel_hi:[1,1,0] clamp
  v_pk_fma_f16 v191, v191, v55, 0.5 op_sel_hi:[1,1,0] clamp
  v_pk_mul_f16 v188, v188, v52
  v_pk_mul_f16 v189, v189, v53
  v_pk_mul_f16 v190, v190, v54
  v_pk_mul_f16 v191, v191, v55
  v_mfma_f32_32x32x16_f16 v[80:95], v[196:199], v[184:187], v[80:95]
  v_cvt_pk_f16_f32 v48, v16, v17
  v_cvt_pk_f16_f32 v49, v18, v19
  v_cvt_pk_f16_f32 v50, v20, v21
  v_cvt_pk_f16_f32 v51, v22, v23
  v_cvt_pk_f16_f32 v52, v24, v25
  v_cvt_pk_f16_f32 v53, v26, v27
  v_cvt_pk_f16_f32 v54, v28, v29
  v_cvt_pk_f16_f32 v55, v30, v31
  v_mfma_f32_32x32x16_f16 v[96:111], v[200:203], v[184:187], v[96:111]
  v_pk_fma_f16 v56, v48, v48, s23 op_sel_hi:[1,1,0]
  v_pk_fma_f16 v57, v49, v49, s23 op_sel_hi:[1,1,0]
  v_pk_fma_f16 v58, v50, v50, s23 op_sel_hi:[1,1,0]
  v_pk_fma_f16 v59, v51, v51, s23 op_sel_hi:[1,1,0]
  v_pk_fma_f16 v184, v56, s20, s20 op_sel:[0,1,0] op_sel_hi:[1,1,0]
  v_pk_fma_f16 v185, v57, s20, s20 op_sel:[0,1,0] op_sel_hi:[1,1,0]
  v_pk_fma_f16 v186, v58, s20, s20 op_sel:[0,1,0] op_sel_hi:[1,1,0]
  v_pk_fma_f16 v187, v59, s20, s20 op_sel:[0,1,0] op_sel_hi:[1,1,0]
  v_mfma_f32_32x32x16_f16 v[64:79], v[204:207], v[188:191], v[64:79]
  v_pk_fma_f16 v184, v184, v56, s21 op_sel:[0,0,1]
  v_pk_fma_f16 v185, v185, v57, s21 op_sel:[0,0,1]
  v_pk_fma_f16 v186, v186, v58, s21 op_sel:[0,0,1]
  v_pk_fma_f16 v187, v187, v59, s21 op_sel:[0,0,1]
  v_pk_fma_f16 v184, v184, v56, s21 op_sel_hi:[1,1,0]
  v_pk_fma_f16 v185, v185, v57, s21 op_sel_hi:[1,1,0]
  v_pk_fma_f16 v186, v186, v58, s21 op_sel_hi:[1,1,0]
  v_pk_fma_f16 v187, v187, v59, s21 op_sel_hi:[1,1,0]
  v_mfma_f32_32x32x16_f16 v[80:95], v[208:211], v[188:191], v[80:95]
  v_pk_fma_f16 v184, v184, v56, s23 op_sel:[0,0,1]
  v_pk_fma_f16 v185, v185, v57, s23 op_sel:[0,0,1]
  v_pk_fma_f16 v186, v186, v58, s23 op_sel:[0,0,1]
  v_pk_fma_f16 v187, v187, v59, s23 op_sel:[0,0,1]
  v_pk_fma_f16 v184, v184, v48, 0.5 op_sel_hi:[1,1,0] clamp
  v_pk_fma_f16 v185, v185, v49, 0.5 op_sel_hi:[1,1,0] clamp
  v_pk_fma_f16 v186, v186, v50, 0.5 op_sel_hi:[1,1,0] clamp
  v_pk_fma_f16 v187, v187, v51, 0.5 op_sel_hi:[1,1,0] clamp
  v_mfma_f32_32x32x16_f16 v[96:111], v[212:215], v[188:191], v[96:111]
  v_pk_mul_f16 v184, v184, v48
  v_pk_mul_f16 v185, v185, v49
  v_pk_mul_f16 v186, v186, v50
  v_pk_mul_f16 v187, v187, v51
  v_pk_fma_f16 v56, v52, v52, s23 op_sel_hi:[1,1,0]
  v_pk_fma_f16 v57, v53, v53, s23 op_sel_hi:[1,1,0]
  v_pk_fma_f16 v58, v54, v54, s23 op_sel_hi:[1,1,0]
  v_pk_fma_f16 v59, v55, v55, s23 op_sel_hi:[1,1,0]
  v_mfma_f32_32x32x16_bf16 v[16:31], a[0:3], v[160:163], 0
  v_cvt_pk_bf16_f32 v112, v64, v65
  v_cvt_pk_bf16_f32 v113, v66, v67
  v_cvt_pk_bf16_f32 v114, v68, v69
  v_pk_fma_f16 v188, v56, s20, s20 op_sel:[0,1,0] op_sel_hi:[1,1,0]
  v_cvt_pk_bf16_f32 v115, v70, v71
  v_cvt_pk_bf16_f32 v116, v72, v73
  v_cvt_pk_bf16_f32 v117, v74, v75
  v_pk_fma_f16 v189, v57, s20, s20 op_sel:[0,1,0] op_sel_hi:[1,1,0]
  v_mfma_f32_32x32x16_bf16 v[16:31], a[4:7], v[164:167], v[16:31]
  v_cvt_pk_bf16_f32 v118, v76, v77
  v_cvt_pk_bf16_f32 v119, v78, v79
  v_pk_fma_f16 v190, v58, s20, s20 op_sel:[0,1,0] op_sel_hi:[1,1,0]
  v_cvt_pk_bf16_f32 v120, v80, v81
  v_cvt_pk_bf16_f32 v121, v82, v83
  v_pk_fma_f16 v191, v59, s20, s20 op_sel:[0,1,0] op_sel_hi:[1,1,0]
  v_cvt_pk_bf16_f32 v122, v84, v85
  v_cvt_pk_bf16_f32 v123, v86, v87
  v_pk_fma_f16 v188, v188, v56, s21 op_sel:[0,0,1]
  v_mfma_f32_32x32x16_bf16 v[16:31], a[8:11], v[168:171], v[16:31]
  ds_read_b128 v[64:67], v2
  ds_read_b128 v[68:71], v2 offset:32
  ds_read_b128 v[72:75], v2 offset:64
  ds_read_b128 v[76:79], v2 offset:96
  v_pk_fma_f16 v189, v189, v57, s21 op_sel:[0,0,1]
  v_pk_fma_f16 v190, v190, v58, s21 op_sel:[0,0,1]
  v_cvt_pk_bf16_f32 v124, v88, v89
  v_pk_fma_f16 v191, v191, v59, s21 op_sel:[0,0,1]
  v_cvt_pk_bf16_f32 v125, v90, v91
  v_mfma_f32_32x32x16_bf16 v[16:31], a[12:15], v[172:175], v[16:31]
  ds_read_b128 v[192:195], v1 offset:8192
  ds_read_b128 v[196:199], v1 offset:9216
  v_cvt_pk_bf16_f32 v126, v92, v93
  v_cvt_pk_bf16_f32 v127, v94, v95
  v_pk_fma_f16 v188, v188, v56, s21 op_sel_hi:[1,1,0]
  v_cvt_pk_bf16_f32 v128, v96, v97
  v_pk_fma_f16 v189, v189, v57, s21 op_sel_hi:[1,1,0]
  v_cvt_pk_bf16_f32 v129, v98, v99
  v_pk_fma_f16 v190, v190, v58, s21 op_sel_hi:[1,1,0]
  v_mfma_f32_32x32x16_bf16 v[16:31], a[16:19], v[176:179], v[16:31]
  ds_read_b128 v[80:83], v2 offset:128
  ds_read_b128 v[84:87], v2 offset:160
  ds_read_b128 v[88:91], v2 offset:192
  ds_read_b128 v[92:95], v2 offset:224
  v_pk_fma_f16 v191, v191, v59, s21 op_sel_hi:[1,1,0]
  v_pk_fma_f16 v188, v188, v56, s23 op_sel:[0,0,1]
  v_cvt_pk_bf16_f32 v130, v100, v101
  v_pk_fma_f16 v189, v189, v57, s23 op_sel:[0,0,1]
  v_cvt_pk_bf16_f32 v131, v102, v103
  v_mfma_f32_32x32x16_bf16 v[16:31], a[20:23], v[180:183], v[16:31]
  s_nop 0
  s_waitcnt lgkmcnt(6)
  ds_read_b128 v[200:203], v1 offset:10240
  ds_read_b128 v[204:207], v1 offset:11264
  v_cvt_pk_bf16_f32 v132, v104, v105
  v_cvt_pk_bf16_f32 v133, v106, v107
  v_pk_fma_f16 v190, v190, v58, s23 op_sel:[0,0,1]
  v_cvt_pk_bf16_f32 v134, v108, v109
  v_pk_fma_f16 v191, v191, v59, s23 op_sel:[0,0,1]
  v_cvt_pk_bf16_f32 v135, v110, v111
  v_pk_fma_f16 v188, v188, v52, 0.5 op_sel_hi:[1,1,0] clamp
  v_mfma_f32_32x32x16_bf16 v[64:79], v[240:243], v[136:139], v[64:79]
  ds_read_b128 v[96:99], v2 offset:256
  ds_read_b128 v[100:103], v2 offset:288
  ds_read_b128 v[104:107], v2 offset:320
  ds_read_b128 v[108:111], v2 offset:352
  v_pk_fma_f16 v189, v189, v53, 0.5 op_sel_hi:[1,1,0] clamp
  v_pk_fma_f16 v190, v190, v54, 0.5 op_sel_hi:[1,1,0] clamp
  v_pk_fma_f16 v191, v191, v55, 0.5 op_sel_hi:[1,1,0] clamp
  v_pk_mul_f16 v188, v188, v52
  v_pk_mul_f16 v189, v189, v53
  v_pk_mul_f16 v190, v190, v54
  v_pk_mul_f16 v191, v191, v55
  v_mfma_f32_32x32x16_bf16 v[64:79], v[244:247], v[140:143], v[64:79]
  s_nop 0
  s_waitcnt lgkmcnt(6)
  ds_read_b128 v[208:211], v1 offset:12288
  ds_read_b128 v[212:215], v1 offset:13312
  v_cvt_pk_f16_f32 v48, v16, v17
  v_cvt_pk_f16_f32 v49, v18, v19
  v_cvt_pk_f16_f32 v50, v20, v21
  v_cvt_pk_f16_f32 v51, v22, v23
  v_mfma_f32_32x32x16_bf16 v[80:95], v[240:243], v[144:147], v[80:95]
  v_cvt_pk_f16_f32 v52, v24, v25
  v_cvt_pk_f16_f32 v53, v26, v27
  v_cvt_pk_f16_f32 v54, v28, v29
  v_cvt_pk_f16_f32 v55, v30, v31
  v_pk_fma_f16 v56, v48, v48, s23 op_sel_hi:[1,1,0]
  v_pk_fma_f16 v57, v49, v49, s23 op_sel_hi:[1,1,0]
  v_mfma_f32_32x32x16_bf16 v[80:95], v[244:247], v[148:151], v[80:95]
  s_waitcnt lgkmcnt(2)
  v_pk_fma_f16 v58, v50, v50, s23 op_sel_hi:[1,1,0]
  v_pk_fma_f16 v59, v51, v51, s23 op_sel_hi:[1,1,0]
  v_mfma_f32_32x32x16_bf16 v[96:111], v[240:243], v[152:155], v[96:111]
  v_mfma_f32_32x32x16_bf16 v[96:111], v[244:247], v[156:159], v[96:111]
  s_waitcnt lgkmcnt(0)
  v_mfma_f32_32x32x16_f16 v[64:79], v[192:195], v[184:187], v[64:79]
  v_mfma_f32_32x32x16_f16 v[80:95], v[196:199], v[184:187], v[80:95]
  v_mfma_f32_32x32x16_f16 v[96:111], v[200:203], v[184:187], v[96:111]
  v_pk_fma_f16 v184, v56, s20, s20 op_sel:[0,1,0] op_sel_hi:[1,1,0]
  v_pk_fma_f16 v185, v57, s20, s20 op_sel:[0,1,0] op_sel_hi:[1,1,0]
  v_pk_fma_f16 v186, v58, s20, s20 op_sel:[0,1,0] op_sel_hi:[1,1,0]
  v_pk_fma_f16 v187, v59, s20, s20 op_sel:[0,1,0] op_sel_hi:[1,1,0]
  v_pk_fma_f16 v184, v184, v56, s21 op_sel:[0,0,1]
  v_pk_fma_f16 v185, v185, v57, s21 op_sel:[0,0,1]
  v_mfma_f32_32x32x16_f16 v[64:79], v[204:207], v[188:191], v[64:79]
  v_pk_fma_f16 v186, v186, v58, s21 op_sel:[0,0,1]
  v_pk_fma_f16 v187, v187, v59, s21 op_sel:[0,0,1]
  v_pk_fma_f16 v184, v184, v56, s21 op_sel_hi:[1,1,0]
  v_pk_fma_f16 v185, v185, v57, s21 op_sel_hi:[1,1,0]
  v_pk_fma_f16 v186, v186, v58, s21 op_sel_hi:[1,1,0]
  v_pk_fma_f16 v187, v187, v59, s21 op_sel_hi:[1,1,0]
  v_mfma_f32_32x32x16_f16 v[80:95], v[208:211], v[188:191], v[80:95]
  v_pk_fma_f16 v184, v184, v56, s23 op_sel:[0,0,1]
  v_pk_fma_f16 v185, v185, v57, s23 op_sel:[0,0,1]
  v_pk_fma_f16 v186, v186, v58, s23 op_sel:[0,0,1]
  v_pk_fma_f16 v187, v187, v59, s23 op_sel:[0,0,1]
  v_pk_fma_f16 v184, v184, v48, 0.5 op_sel_hi:[1,1,0] clamp
  v_pk_fma_f16 v185, v185, v49, 0.5 op_sel_hi:[1,1,0] clamp
  v_mfma_f32_32x32x16_f16 v[96:111], v[212:215], v[188:191], v[96:111]
  v_pk_fma_f16 v186, v186, v50, 0.5 op_sel_hi:[1,1,0] clamp
  v_pk_fma_f16 v187, v187, v51, 0.5 op_sel_hi:[1,1,0] clamp
  v_pk_mul_f16 v184, v184, v48
  v_pk_mul_f16 v185, v185, v49
  v_pk_mul_f16 v186, v186, v50
  v_pk_mul_f16 v187, v187, v51
  v_mfma_f32_32x32x16_bf16 v[16:31], a[24:27], v[160:163], 0
  ds_read_b128 v[192:195], v1 offset:14336
  ds_read_b128 v[196:199], v1 offset:15360
  v_pk_fma_f16 v56, v52, v52, s23 op_sel_hi:[1,1,0]
  v_pk_fma_f16 v57, v53, v53, s23 op_sel_hi:[1,1,0]
  v_pk_fma_f16 v58, v54, v54, s23 op_sel_hi:[1,1,0]
  v_pk_fma_f16 v59, v55, v55, s23 op_sel_hi:[1,1,0]
  v_mfma_f32_32x32x16_bf16 v[16:31], a[28:31], v[164:167], v[16:31]
  ds_read_b128 v[200:203], v1 offset:16384
  ds_read_b128 v[204:207], v1 offset:17408
  v_pk_fma_f16 v188, v56, s20, s20 op_sel:[0,1,0] op_sel_hi:[1,1,0]
  v_pk_fma_f16 v189, v57, s20, s20 op_sel:[0,1,0] op_sel_hi:[1,1,0]
  v_pk_fma_f16 v190, v58, s20, s20 op_sel:[0,1,0] op_sel_hi:[1,1,0]
  v_pk_fma_f16 v191, v59, s20, s20 op_sel:[0,1,0] op_sel_hi:[1,1,0]
  v_mfma_f32_32x32x16_bf16 v[16:31], a[32:35], v[168:171], v[16:31]
  ds_read_b128 v[208:211], v1 offset:18432
  ds_read_b128 v[212:215], v1 offset:19456
  v_pk_fma_f16 v188, v188, v56, s21 op_sel:[0,0,1]
  v_pk_fma_f16 v189, v189, v57, s21 op_sel:[0,0,1]
  v_pk_fma_f16 v190, v190, v58, s21 op_sel:[0,0,1]
  v_pk_fma_f16 v191, v191, v59, s21 op_sel:[0,0,1]
  v_mfma_f32_32x32x16_bf16 v[16:31], a[36:39], v[172:175], v[16:31]
  buffer_store_dwordx4 v[112:115], v10, s[8:11], s28 offen
  v_pk_fma_f16 v188, v188, v56, s21 op_sel_hi:[1,1,0]
  v_pk_fma_f16 v189, v189, v57, s21 op_sel_hi:[1,1,0]
  v_pk_fma_f16 v190, v190, v58, s21 op_sel_hi:[1,1,0]
  v_pk_fma_f16 v191, v191, v59, s21 op_sel_hi:[1,1,0]
  v_pk_fma_f16 v188, v188, v56, s23 op_sel:[0,0,1]
  v_mfma_f32_32x32x16_bf16 v[16:31], a[40:43], v[176:179], v[16:31]
  v_pk_fma_f16 v189, v189, v57, s23 op_sel:[0,0,1]
  v_pk_fma_f16 v190, v190, v58, s23 op_sel:[0,0,1]
  v_pk_fma_f16 v191, v191, v59, s23 op_sel:[0,0,1]
  v_pk_fma_f16 v188, v188, v52, 0.5 op_sel_hi:[1,1,0] clamp
  v_pk_fma_f16 v189, v189, v53, 0.5 op_sel_hi:[1,1,0] clamp
  v_pk_fma_f16 v190, v190, v54, 0.5 op_sel_hi:[1,1,0] clamp
  v_mfma_f32_32x32x16_bf16 v[16:31], a[44:47], v[180:183], v[16:31]
  s_waitcnt lgkmcnt(0)
  v_pk_fma_f16 v191, v191, v55, 0.5 op_sel_hi:[1,1,0] clamp
  v_pk_mul_f16 v188, v188, v52
  v_pk_mul_f16 v189, v189, v53
  v_pk_mul_f16 v190, v190, v54
  v_pk_mul_f16 v191, v191, v55
  v_mfma_f32_32x32x16_f16 v[64:79], v[192:195], v[184:187], v[64:79]
  v_mfma_f32_32x32x16_f16 v[80:95], v[196:199], v[184:187], v[80:95]
  s_nop 3
  v_cvt_pk_f16_f32 v48, v16, v17
  v_cvt_pk_f16_f32 v49, v18, v19
  v_cvt_pk_f16_f32 v50, v20, v21
  v_cvt_pk_f16_f32 v51, v22, v23
  v_cvt_pk_f16_f32 v52, v24, v25
  v_cvt_pk_f16_f32 v53, v26, v27
  v_mfma_f32_32x32x16_f16 v[96:111], v[200:203], v[184:187], v[96:111]
  v_cvt_pk_f16_f32 v54, v28, v29
  v_cvt_pk_f16_f32 v55, v30, v31
  v_pk_fma_f16 v56, v48, v48, s23 op_sel_hi:[1,1,0]
  v_pk_fma_f16 v57, v49, v49, s23 op_sel_hi:[1,1,0]
  v_pk_fma_f16 v58, v50, v50, s23 op_sel_hi:[1,1,0]
  v_pk_fma_f16 v59, v51, v51, s23 op_sel_hi:[1,1,0]
  v_mfma_f32_32x32x16_f16 v[64:79], v[204:207], v[188:191], v[64:79]
  v_pk_fma_f16 v184, v56, s20, s20 op_sel:[0,1,0] op_sel_hi:[1,1,0]
  v_pk_fma_f16 v185, v57, s20, s20 op_sel:[0,1,0] op_sel_hi:[1,1,0]
  v_pk_fma_f16 v186, v58, s20, s20 op_sel:[0,1,0] op_sel_hi:[1,1,0]
  v_pk_fma_f16 v187, v59, s20, s20 op_sel:[0,1,0] op_sel_hi:[1,1,0]
  v_pk_fma_f16 v184, v184, v56, s21 op_sel:[0,0,1]
  v_pk_fma_f16 v185, v185, v57, s21 op_sel:[0,0,1]
  v_mfma_f32_32x32x16_f16 v[80:95], v[208:211], v[188:191], v[80:95]
  v_pk_fma_f16 v186, v186, v58, s21 op_sel:[0,0,1]
  v_pk_fma_f16 v187, v187, v59, s21 op_sel:[0,0,1]
  v_pk_fma_f16 v184, v184, v56, s21 op_sel_hi:[1,1,0]
  v_pk_fma_f16 v185, v185, v57, s21 op_sel_hi:[1,1,0]
  v_pk_fma_f16 v186, v186, v58, s21 op_sel_hi:[1,1,0]
  v_pk_fma_f16 v187, v187, v59, s21 op_sel_hi:[1,1,0]
  v_mfma_f32_32x32x16_f16 v[96:111], v[212:215], v[188:191], v[96:111]
  v_pk_fma_f16 v184, v184, v56, s23 op_sel:[0,0,1]
  v_pk_fma_f16 v185, v185, v57, s23 op_sel:[0,0,1]
  v_pk_fma_f16 v186, v186, v58, s23 op_sel:[0,0,1]
  v_pk_fma_f16 v187, v187, v59, s23 op_sel:[0,0,1]
  v_pk_fma_f16 v184, v184, v48, 0.5 op_sel_hi:[1,1,0] clamp
  v_pk_fma_f16 v185, v185, v49, 0.5 op_sel_hi:[1,1,0] clamp
  v_mfma_f32_32x32x16_bf16 v[16:31], a[48:51], v[160:163], 0
  ds_read_b128 v[192:195], v1 offset:20480
  ds_read_b128 v[196:199], v1 offset:21504
  v_pk_fma_f16 v186, v186, v50, 0.5 op_sel_hi:[1,1,0] clamp
  v_pk_fma_f16 v187, v187, v51, 0.5 op_sel_hi:[1,1,0] clamp
  v_pk_mul_f16 v184, v184, v48
  v_pk_mul_f16 v185, v185, v49
  v_mfma_f32_32x32x16_bf16 v[16:31], a[52:55], v[164:167], v[16:31]
  ds_read_b128 v[200:203], v1 offset:22528
  ds_read_b128 v[204:207], v1 offset:23552
  v_pk_mul_f16 v186, v186, v50
  v_pk_mul_f16 v187, v187, v51
  v_pk_fma_f16 v56, v52, v52, s23 op_sel_hi:[1,1,0]
  v_pk_fma_f16 v57, v53, v53, s23 op_sel_hi:[1,1,0]
  v_mfma_f32_32x32x16_bf16 v[16:31], a[56:59], v[168:171], v[16:31]
  ds_read_b128 v[208:211], v1 offset:24576
  ds_read_b128 v[212:215], v1 offset:25600
  v_pk_fma_f16 v58, v54, v54, s23 op_sel_hi:[1,1,0]
  v_pk_fma_f16 v59, v55, v55, s23 op_sel_hi:[1,1,0]
  v_pk_fma_f16 v188, v56, s20, s20 op_sel:[0,1,0] op_sel_hi:[1,1,0]
  v_pk_fma_f16 v189, v57, s20, s20 op_sel:[0,1,0] op_sel_hi:[1,1,0]
  v_mfma_f32_32x32x16_bf16 v[16:31], a[60:63], v[172:175], v[16:31]
  buffer_store_dwordx4 v[116:119], v10, s[8:11], s28 offen offset:32
  v_pk_fma_f16 v190, v58, s20, s20 op_sel:[0,1,0] op_sel_hi:[1,1,0]
  v_pk_fma_f16 v191, v59, s20, s20 op_sel:[0,1,0] op_sel_hi:[1,1,0]
  v_pk_fma_f16 v188, v188, v56, s21 op_sel:[0,0,1]
  v_pk_fma_f16 v189, v189, v57, s21 op_sel:[0,0,1]
  v_pk_fma_f16 v190, v190, v58, s21 op_sel:[0,0,1]
  v_mfma_f32_32x32x16_bf16 v[16:31], a[64:67], v[176:179], v[16:31]
  v_pk_fma_f16 v191, v191, v59, s21 op_sel:[0,0,1]
  v_pk_fma_f16 v188, v188, v56, s21 op_sel_hi:[1,1,0]
  v_pk_fma_f16 v189, v189, v57, s21 op_sel_hi:[1,1,0]
  v_pk_fma_f16 v190, v190, v58, s21 op_sel_hi:[1,1,0]
  v_pk_fma_f16 v191, v191, v59, s21 op_sel_hi:[1,1,0]
  v_pk_fma_f16 v188, v188, v56, s23 op_sel:[0,0,1]
  v_mfma_f32_32x32x16_bf16 v[16:31], a[68:71], v[180:183], v[16:31]
  s_nop 0
  s_waitcnt lgkmcnt(0)
  v_pk_fma_f16 v189, v189, v57, s23 op_sel:[0,0,1]
  v_pk_fma_f16 v190, v190, v58, s23 op_sel:[0,0,1]
  v_pk_fma_f16 v191, v191, v59, s23 op_sel:[0,0,1]
  v_pk_fma_f16 v188, v188, v52, 0.5 op_sel_hi:[1,1,0] clamp
  v_pk_fma_f16 v189, v189, v53, 0.5 op_sel_hi:[1,1,0] clamp
  v_pk_fma_f16 v190, v190, v54, 0.5 op_sel_hi:[1,1,0] clamp
  v_mfma_f32_32x32x16_f16 v[64:79], v[192:195], v[184:187], v[64:79]
  v_pk_fma_f16 v191, v191, v55, 0.5 op_sel_hi:[1,1,0] clamp
  v_pk_mul_f16 v188, v188, v52
  v_pk_mul_f16 v189, v189, v53
  v_pk_mul_f16 v190, v190, v54
  v_pk_mul_f16 v191, v191, v55
  v_mfma_f32_32x32x16_f16 v[80:95], v[196:199], v[184:187], v[80:95]
  v_cvt_pk_f16_f32 v48, v16, v17
  v_cvt_pk_f16_f32 v49, v18, v19
  v_cvt_pk_f16_f32 v50, v20, v21
  v_cvt_pk_f16_f32 v51, v22, v23
  v_cvt_pk_f16_f32 v52, v24, v25
  v_cvt_pk_f16_f32 v53, v26, v27
  v_mfma_f32_32x32x16_f16 v[96:111], v[200:203], v[184:187], v[96:111]
  v_cvt_pk_f16_f32 v54, v28, v29
  v_cvt_pk_f16_f32 v55, v30, v31
  v_pk_fma_f16 v56, v48, v48, s23 op_sel_hi:[1,1,0]
  v_pk_fma_f16 v57, v49, v49, s23 op_sel_hi:[1,1,0]
  v_pk_fma_f16 v58, v50, v50, s23 op_sel_hi:[1,1,0]
  v_pk_fma_f16 v59, v51, v51, s23 op_sel_hi:[1,1,0]
  v_mfma_f32_32x32x16_f16 v[64:79], v[204:207], v[188:191], v[64:79]
  v_pk_fma_f16 v184, v56, s20, s20 op_sel:[0,1,0] op_sel_hi:[1,1,0]
  v_pk_fma_f16 v185, v57, s20, s20 op_sel:[0,1,0] op_sel_hi:[1,1,0]
  v_pk_fma_f16 v186, v58, s20, s20 op_sel:[0,1,0] op_sel_hi:[1,1,0]
  v_pk_fma_f16 v187, v59, s20, s20 op_sel:[0,1,0] op_sel_hi:[1,1,0]
  v_pk_fma_f16 v184, v184, v56, s21 op_sel:[0,0,1]
  v_pk_fma_f16 v185, v185, v57, s21 op_sel:[0,0,1]
  v_mfma_f32_32x32x16_f16 v[80:95], v[208:211], v[188:191], v[80:95]
  v_pk_fma_f16 v186, v186, v58, s21 op_sel:[0,0,1]
  v_pk_fma_f16 v187, v187, v59, s21 op_sel:[0,0,1]
  v_pk_fma_f16 v184, v184, v56, s21 op_sel_hi:[1,1,0]
  v_pk_fma_f16 v185, v185, v57, s21 op_sel_hi:[1,1,0]
  v_pk_fma_f16 v186, v186, v58, s21 op_sel_hi:[1,1,0]
  v_pk_fma_f16 v187, v187, v59, s21 op_sel_hi:[1,1,0]
  v_mfma_f32_32x32x16_f16 v[96:111], v[212:215], v[188:191], v[96:111]
  v_pk_fma_f16 v184, v184, v56, s23 op_sel:[0,0,1]
  v_pk_fma_f16 v185, v185, v57, s23 op_sel:[0,0,1]
  v_pk_fma_f16 v186, v186, v58, s23 op_sel:[0,0,1]
  v_pk_fma_f16 v187, v187, v59, s23 op_sel:[0,0,1]
  v_pk_fma_f16 v184, v184, v48, 0.5 op_sel_hi:[1,1,0] clamp
  v_pk_fma_f16 v185, v185, v49, 0.5 op_sel_hi:[1,1,0] clamp
  v_mfma_f32_32x32x16_bf16 v[16:31], a[72:75], v[160:163], 0
  ds_read_b128 v[192:195], v1 offset:26624
  ds_read_b128 v[196:199], v1 offset:27648
  v_pk_fma_f16 v186, v186, v50, 0.5 op_sel_hi:[1,1,0] clamp
  v_pk_fma_f16 v187, v187, v51, 0.5 op_sel_hi:[1,1,0] clamp
  v_pk_mul_f16 v184, v184, v48
  v_pk_mul_f16 v185, v185, v49
  v_mfma_f32_32x32x16_bf16 v[16:31], a[76:79], v[164:167], v[16:31]
  ds_read_b128 v[200:203], v1 offset:28672
  ds_read_b128 v[204:207], v1 offset:29696
  v_pk_mul_f16 v186, v186, v50
  v_pk_mul_f16 v187, v187, v51
  v_pk_fma_f16 v56, v52, v52, s23 op_sel_hi:[1,1,0]
  v_pk_fma_f16 v57, v53, v53, s23 op_sel_hi:[1,1,0]
  v_mfma_f32_32x32x16_bf16 v[16:31], a[80:83], v[168:171], v[16:31]
  ds_read_b128 v[208:211], v1 offset:30720
  ds_read_b128 v[212:215], v1 offset:31744
  v_pk_fma_f16 v58, v54, v54, s23 op_sel_hi:[1,1,0]
  v_pk_fma_f16 v59, v55, v55, s23 op_sel_hi:[1,1,0]
  v_pk_fma_f16 v188, v56, s20, s20 op_sel:[0,1,0] op_sel_hi:[1,1,0]
  v_pk_fma_f16 v189, v57, s20, s20 op_sel:[0,1,0] op_sel_hi:[1,1,0]
  v_mfma_f32_32x32x16_bf16 v[16:31], a[84:87], v[172:175], v[16:31]
  v_pk_fma_f16 v190, v58, s20, s20 op_sel:[0,1,0] op_sel_hi:[1,1,0]
  v_pk_fma_f16 v191, v59, s20, s20 op_sel:[0,1,0] op_sel_hi:[1,1,0]
  v_pk_fma_f16 v188, v188, v56, s21 op_sel:[0,0,1]
  v_pk_fma_f16 v189, v189, v57, s21 op_sel:[0,0,1]
  v_pk_fma_f16 v190, v190, v58, s21 op_sel:[0,0,1]
  v_pk_fma_f16 v191, v191, v59, s21 op_sel:[0,0,1]
  v_mfma_f32_32x32x16_bf16 v[16:31], a[88:91], v[176:179], v[16:31]
  v_pk_fma_f16 v188, v188, v56, s21 op_sel_hi:[1,1,0]
  v_pk_fma_f16 v189, v189, v57, s21 op_sel_hi:[1,1,0]
  v_pk_fma_f16 v190, v190, v58, s21 op_sel_hi:[1,1,0]
  v_pk_fma_f16 v191, v191, v59, s21 op_sel_hi:[1,1,0]
  v_pk_fma_f16 v188, v188, v56, s23 op_sel:[0,0,1]
  v_pk_fma_f16 v189, v189, v57, s23 op_sel:[0,0,1]
  v_mfma_f32_32x32x16_bf16 v[16:31], a[92:95], v[180:183], v[16:31]
  s_nop 0
  s_waitcnt lgkmcnt(0)
  v_pk_fma_f16 v190, v190, v58, s23 op_sel:[0,0,1]
  v_pk_fma_f16 v191, v191, v59, s23 op_sel:[0,0,1]
  v_pk_fma_f16 v188, v188, v52, 0.5 op_sel_hi:[1,1,0] clamp
  v_pk_fma_f16 v189, v189, v53, 0.5 op_sel_hi:[1,1,0] clamp
  v_pk_fma_f16 v190, v190, v54, 0.5 op_sel_hi:[1,1,0] clamp
  v_pk_fma_f16 v191, v191, v55, 0.5 op_sel_hi:[1,1,0] clamp
  v_mfma_f32_32x32x16_f16 v[64:79], v[192:195], v[184:187], v[64:79]
  v_pk_mul_f16 v188, v188, v52
  v_pk_mul_f16 v189, v189, v53
  v_pk_mul_f16 v190, v190, v54
  v_pk_mul_f16 v191, v191, v55
  v_mfma_f32_32x32x16_f16 v[80:95], v[196:199], v[184:187], v[80:95]
  v_cvt_pk_f16_f32 v48, v16, v17
  v_cvt_pk_f16_f32 v49, v18, v19
  v_cvt_pk_f16_f32 v50, v20, v21
  v_cvt_pk_f16_f32 v51, v22, v23
  v_cvt_pk_f16_f32 v52, v24, v25
  v_cvt_pk_f16_f32 v53, v26, v27
  v_mfma_f32_32x32x16_f16 v[96:111], v[200:203], v[184:187], v[96:111]
  v_cvt_pk_f16_f32 v54, v28, v29
  v_cvt_pk_f16_f32 v55, v30, v31
  v_pk_fma_f16 v56, v48, v48, s23 op_sel_hi:[1,1,0]
  v_pk_fma_f16 v57, v49, v49, s23 op_sel_hi:[1,1,0]
  v_pk_fma_f16 v58, v50, v50, s23 op_sel_hi:[1,1,0]
  v_pk_fma_f16 v59, v51, v51, s23 op_sel_hi:[1,1,0]
  v_mfma_f32_32x32x16_f16 v[64:79], v[204:207], v[188:191], v[64:79]
  v_pk_fma_f16 v184, v56, s20, s20 op_sel:[0,1,0] op_sel_hi:[1,1,0]
  v_pk_fma_f16 v185, v57, s20, s20 op_sel:[0,1,0] op_sel_hi:[1,1,0]
  v_pk_fma_f16 v186, v58, s20, s20 op_sel:[0,1,0] op_sel_hi:[1,1,0]
  v_pk_fma_f16 v187, v59, s20, s20 op_sel:[0,1,0] op_sel_hi:[1,1,0]
  v_pk_fma_f16 v184, v184, v56, s21 op_sel:[0,0,1]
  v_pk_fma_f16 v185, v185, v57, s21 op_sel:[0,0,1]
  v_mfma_f32_32x32x16_f16 v[80:95], v[208:211], v[188:191], v[80:95]
  v_pk_fma_f16 v186, v186, v58, s21 op_sel:[0,0,1]
  v_pk_fma_f16 v187, v187, v59, s21 op_sel:[0,0,1]
  v_pk_fma_f16 v184, v184, v56, s21 op_sel_hi:[1,1,0]
  v_pk_fma_f16 v185, v185, v57, s21 op_sel_hi:[1,1,0]
  v_pk_fma_f16 v186, v186, v58, s21 op_sel_hi:[1,1,0]
  v_pk_fma_f16 v187, v187, v59, s21 op_sel_hi:[1,1,0]
  v_mfma_f32_32x32x16_f16 v[96:111], v[212:215], v[188:191], v[96:111]
  v_pk_fma_f16 v184, v184, v56, s23 op_sel:[0,0,1]
  v_pk_fma_f16 v185, v185, v57, s23 op_sel:[0,0,1]
  v_pk_fma_f16 v186, v186, v58, s23 op_sel:[0,0,1]
  v_pk_fma_f16 v187, v187, v59, s23 op_sel:[0,0,1]
  v_pk_fma_f16 v184, v184, v48, 0.5 op_sel_hi:[1,1,0] clamp
  v_pk_fma_f16 v185, v185, v49, 0.5 op_sel_hi:[1,1,0] clamp
  v_mfma_f32_32x32x16_bf16 v[16:31], a[96:99], v[160:163], 0
  ds_read_b128 v[192:195], v0 offset:24576
  ds_read_b128 v[196:199], v0 offset:25600
  v_pk_fma_f16 v186, v186, v50, 0.5 op_sel_hi:[1,1,0] clamp
  v_pk_fma_f16 v187, v187, v51, 0.5 op_sel_hi:[1,1,0] clamp
  v_pk_mul_f16 v184, v184, v48
  v_pk_mul_f16 v185, v185, v49
  v_mfma_f32_32x32x16_bf16 v[16:31], a[100:103], v[164:167], v[16:31]
  ds_read_b128 v[200:203], v0 offset:26624
  ds_read_b128 v[204:207], v0 offset:27648
  v_pk_mul_f16 v186, v186, v50
  v_pk_mul_f16 v187, v187, v51
  v_pk_fma_f16 v56, v52, v52, s23 op_sel_hi:[1,1,0]
  v_pk_fma_f16 v57, v53, v53, s23 op_sel_hi:[1,1,0]
  v_mfma_f32_32x32x16_bf16 v[16:31], a[104:107], v[168:171], v[16:31]
  ds_read_b128 v[208:211], v0 offset:28672
  ds_read_b128 v[212:215], v0 offset:29696
  v_pk_fma_f16 v58, v54, v54, s23 op_sel_hi:[1,1,0]
  v_pk_fma_f16 v59, v55, v55, s23 op_sel_hi:[1,1,0]
  v_pk_fma_f16 v188, v56, s20, s20 op_sel:[0,1,0] op_sel_hi:[1,1,0]
  v_pk_fma_f16 v189, v57, s20, s20 op_sel:[0,1,0] op_sel_hi:[1,1,0]
  v_mfma_f32_32x32x16_bf16 v[16:31], a[108:111], v[172:175], v[16:31]
  buffer_store_dwordx4 v[120:123], v10, s[8:11], s28 offen offset:64
  v_pk_fma_f16 v190, v58, s20, s20 op_sel:[0,1,0] op_sel_hi:[1,1,0]
  v_pk_fma_f16 v191, v59, s20, s20 op_sel:[0,1,0] op_sel_hi:[1,1,0]
  v_pk_fma_f16 v188, v188, v56, s21 op_sel:[0,0,1]
  v_pk_fma_f16 v189, v189, v57, s21 op_sel:[0,0,1]
  v_pk_fma_f16 v190, v190, v58, s21 op_sel:[0,0,1]
  v_mfma_f32_32x32x16_bf16 v[16:31], a[112:115], v[176:179], v[16:31]
  v_pk_fma_f16 v191, v191, v59, s21 op_sel:[0,0,1]
  v_pk_fma_f16 v188, v188, v56, s21 op_sel_hi:[1,1,0]
  v_pk_fma_f16 v189, v189, v57, s21 op_sel_hi:[1,1,0]
  v_pk_fma_f16 v190, v190, v58, s21 op_sel_hi:[1,1,0]
  v_pk_fma_f16 v191, v191, v59, s21 op_sel_hi:[1,1,0]
  v_pk_fma_f16 v188, v188, v56, s23 op_sel:[0,0,1]
  v_mfma_f32_32x32x16_bf16 v[16:31], a[116:119], v[180:183], v[16:31]
  s_nop 0
  s_waitcnt lgkmcnt(0)
  v_pk_fma_f16 v189, v189, v57, s23 op_sel:[0,0,1]
  v_pk_fma_f16 v190, v190, v58, s23 op_sel:[0,0,1]
  v_pk_fma_f16 v191, v191, v59, s23 op_sel:[0,0,1]
  v_pk_fma_f16 v188, v188, v52, 0.5 op_sel_hi:[1,1,0] clamp
  v_pk_fma_f16 v189, v189, v53, 0.5 op_sel_hi:[1,1,0] clamp
  v_pk_fma_f16 v190, v190, v54, 0.5 op_sel_hi:[1,1,0] clamp
  v_mfma_f32_32x32x16_f16 v[64:79], v[192:195], v[184:187], v[64:79]
  v_pk_fma_f16 v191, v191, v55, 0.5 op_sel_hi:[1,1,0] clamp
  v_pk_mul_f16 v188, v188, v52
  v_pk_mul_f16 v189, v189, v53
  v_pk_mul_f16 v190, v190, v54
  v_pk_mul_f16 v191, v191, v55
  v_mfma_f32_32x32x16_f16 v[80:95], v[196:199], v[184:187], v[80:95]
  v_cvt_pk_f16_f32 v48, v16, v17
  v_cvt_pk_f16_f32 v49, v18, v19
  v_cvt_pk_f16_f32 v50, v20, v21
  v_cvt_pk_f16_f32 v51, v22, v23
  v_cvt_pk_f16_f32 v52, v24, v25
  v_cvt_pk_f16_f32 v53, v26, v27
  v_mfma_f32_32x32x16_f16 v[96:111], v[200:203], v[184:187], v[96:111]
  v_cvt_pk_f16_f32 v54, v28, v29
  v_cvt_pk_f16_f32 v55, v30, v31
  v_pk_fma_f16 v56, v48, v48, s23 op_sel_hi:[1,1,0]
  v_pk_fma_f16 v57, v49, v49, s23 op_sel_hi:[1,1,0]
  v_pk_fma_f16 v58, v50, v50, s23 op_sel_hi:[1,1,0]
  v_pk_fma_f16 v59, v51, v51, s23 op_sel_hi:[1,1,0]
  v_mfma_f32_32x32x16_f16 v[64:79], v[204:207], v[188:191], v[64:79]
  v_pk_fma_f16 v184, v56, s20, s20 op_sel:[0,1,0] op_sel_hi:[1,1,0]
  v_pk_fma_f16 v185, v57, s20, s20 op_sel:[0,1,0] op_sel_hi:[1,1,0]
  v_pk_fma_f16 v186, v58, s20, s20 op_sel:[0,1,0] op_sel_hi:[1,1,0]
  v_pk_fma_f16 v187, v59, s20, s20 op_sel:[0,1,0] op_sel_hi:[1,1,0]
  v_pk_fma_f16 v184, v184, v56, s21 op_sel:[0,0,1]
  v_pk_fma_f16 v185, v185, v57, s21 op_sel:[0,0,1]
  v_mfma_f32_32x32x16_f16 v[80:95], v[208:211], v[188:191], v[80:95]
  v_pk_fma_f16 v186, v186, v58, s21 op_sel:[0,0,1]
  v_pk_fma_f16 v187, v187, v59, s21 op_sel:[0,0,1]
  v_pk_fma_f16 v184, v184, v56, s21 op_sel_hi:[1,1,0]
  v_pk_fma_f16 v185, v185, v57, s21 op_sel_hi:[1,1,0]
  v_pk_fma_f16 v186, v186, v58, s21 op_sel_hi:[1,1,0]
  v_pk_fma_f16 v187, v187, v59, s21 op_sel_hi:[1,1,0]
  v_mfma_f32_32x32x16_f16 v[96:111], v[212:215], v[188:191], v[96:111]
  v_pk_fma_f16 v184, v184, v56, s23 op_sel:[0,0,1]
  v_pk_fma_f16 v185, v185, v57, s23 op_sel:[0,0,1]
  v_pk_fma_f16 v186, v186, v58, s23 op_sel:[0,0,1]
  v_pk_fma_f16 v187, v187, v59, s23 op_sel:[0,0,1]
  v_pk_fma_f16 v184, v184, v48, 0.5 op_sel_hi:[1,1,0] clamp
  v_pk_fma_f16 v185, v185, v49, 0.5 op_sel_hi:[1,1,0] clamp
  v_mfma_f32_32x32x16_bf16 v[16:31], a[120:123], v[160:163], 0
  ds_read_b128 v[192:195], v0 offset:30720
  ds_read_b128 v[196:199], v0 offset:31744
  v_pk_fma_f16 v186, v186, v50, 0.5 op_sel_hi:[1,1,0] clamp
  v_pk_fma_f16 v187, v187, v51, 0.5 op_sel_hi:[1,1,0] clamp
  v_pk_mul_f16 v184, v184, v48
  v_pk_mul_f16 v185, v185, v49
  v_mfma_f32_32x32x16_bf16 v[16:31], a[124:127], v[164:167], v[16:31]
  ds_read_b128 v[200:203], v0 offset:32768
  ds_read_b128 v[204:207], v0 offset:33792
  v_pk_mul_f16 v186, v186, v50
  v_pk_mul_f16 v187, v187, v51
  v_pk_fma_f16 v56, v52, v52, s23 op_sel_hi:[1,1,0]
  v_pk_fma_f16 v57, v53, v53, s23 op_sel_hi:[1,1,0]
  v_mfma_f32_32x32x16_bf16 v[16:31], a[128:131], v[168:171], v[16:31]
  ds_read_b128 v[208:211], v0 offset:34816
  ds_read_b128 v[212:215], v0 offset:35840
  v_pk_fma_f16 v58, v54, v54, s23 op_sel_hi:[1,1,0]
  v_pk_fma_f16 v59, v55, v55, s23 op_sel_hi:[1,1,0]
  v_pk_fma_f16 v188, v56, s20, s20 op_sel:[0,1,0] op_sel_hi:[1,1,0]
  v_pk_fma_f16 v189, v57, s20, s20 op_sel:[0,1,0] op_sel_hi:[1,1,0]
  v_mfma_f32_32x32x16_bf16 v[16:31], a[132:135], v[172:175], v[16:31]
  buffer_store_dwordx4 v[124:127], v10, s[8:11], s28 offen offset:96
  v_pk_fma_f16 v190, v58, s20, s20 op_sel:[0,1,0] op_sel_hi:[1,1,0]
  v_pk_fma_f16 v191, v59, s20, s20 op_sel:[0,1,0] op_sel_hi:[1,1,0]
  v_pk_fma_f16 v188, v188, v56, s21 op_sel:[0,0,1]
  v_pk_fma_f16 v189, v189, v57, s21 op_sel:[0,0,1]
  v_pk_fma_f16 v190, v190, v58, s21 op_sel:[0,0,1]
  v_mfma_f32_32x32x16_bf16 v[16:31], a[136:139], v[176:179], v[16:31]
  v_pk_fma_f16 v191, v191, v59, s21 op_sel:[0,0,1]
  v_pk_fma_f16 v188, v188, v56, s21 op_sel_hi:[1,1,0]
  v_pk_fma_f16 v189, v189, v57, s21 op_sel_hi:[1,1,0]
  v_pk_fma_f16 v190, v190, v58, s21 op_sel_hi:[1,1,0]
  v_pk_fma_f16 v191, v191, v59, s21 op_sel_hi:[1,1,0]
  v_pk_fma_f16 v188, v188, v56, s23 op_sel:[0,0,1]
  v_mfma_f32_32x32x16_bf16 v[16:31], a[140:143], v[180:183], v[16:31]
  s_nop 0
  s_waitcnt lgkmcnt(0)
  v_pk_fma_f16 v189, v189, v57, s23 op_sel:[0,0,1]
  v_pk_fma_f16 v190, v190, v58, s23 op_sel:[0,0,1]
  v_pk_fma_f16 v191, v191, v59, s23 op_sel:[0,0,1]
  v_pk_fma_f16 v188, v188, v52, 0.5 op_sel_hi:[1,1,0] clamp
  v_pk_fma_f16 v189, v189, v53, 0.5 op_sel_hi:[1,1,0] clamp
  v_pk_fma_f16 v190, v190, v54, 0.5 op_sel_hi:[1,1,0] clamp
  v_mfma_f32_32x32x16_f16 v[64:79], v[192:195], v[184:187], v[64:79]
  v_pk_fma_f16 v191, v191, v55, 0.5 op_sel_hi:[1,1,0] clamp
  v_pk_mul_f16 v188, v188, v52
  v_pk_mul_f16 v189, v189, v53
  v_pk_mul_f16 v190, v190, v54
  v_pk_mul_f16 v191, v191, v55
  v_mfma_f32_32x32x16_f16 v[80:95], v[196:199], v[184:187], v[80:95]
  v_cvt_pk_f16_f32 v48, v16, v17
  v_cvt_pk_f16_f32 v49, v18, v19
  v_cvt_pk_f16_f32 v50, v20, v21
  v_cvt_pk_f16_f32 v51, v22, v23
  v_cvt_pk_f16_f32 v52, v24, v25
  v_cvt_pk_f16_f32 v53, v26, v27
  v_mfma_f32_32x32x16_f16 v[96:111], v[200:203], v[184:187], v[96:111]
  v_cvt_pk_f16_f32 v54, v28, v29
  v_cvt_pk_f16_f32 v55, v30, v31
  v_pk_fma_f16 v56, v48, v48, s23 op_sel_hi:[1,1,0]
  v_pk_fma_f16 v57, v49, v49, s23 op_sel_hi:[1,1,0]
  v_pk_fma_f16 v58, v50, v50, s23 op_sel_hi:[1,1,0]
  v_pk_fma_f16 v59, v51, v51, s23 op_sel_hi:[1,1,0]
  v_mfma_f32_32x32x16_f16 v[64:79], v[204:207], v[188:191], v[64:79]
  v_pk_fma_f16 v184, v56, s20, s20 op_sel:[0,1,0] op_sel_hi:[1,1,0]
  v_pk_fma_f16 v185, v57, s20, s20 op_sel:[0,1,0] op_sel_hi:[1,1,0]
  v_pk_fma_f16 v186, v58, s20, s20 op_sel:[0,1,0] op_sel_hi:[1,1,0]
  v_pk_fma_f16 v187, v59, s20, s20 op_sel:[0,1,0] op_sel_hi:[1,1,0]
  v_pk_fma_f16 v184, v184, v56, s21 op_sel:[0,0,1]
  v_pk_fma_f16 v185, v185, v57, s21 op_sel:[0,0,1]
  v_mfma_f32_32x32x16_f16 v[80:95], v[208:211], v[188:191], v[80:95]
  v_pk_fma_f16 v186, v186, v58, s21 op_sel:[0,0,1]
  v_pk_fma_f16 v187, v187, v59, s21 op_sel:[0,0,1]
  v_pk_fma_f16 v184, v184, v56, s21 op_sel_hi:[1,1,0]
  v_pk_fma_f16 v185, v185, v57, s21 op_sel_hi:[1,1,0]
  v_pk_fma_f16 v186, v186, v58, s21 op_sel_hi:[1,1,0]
  v_pk_fma_f16 v187, v187, v59, s21 op_sel_hi:[1,1,0]
  v_mfma_f32_32x32x16_f16 v[96:111], v[212:215], v[188:191], v[96:111]
  v_pk_fma_f16 v184, v184, v56, s23 op_sel:[0,0,1]
  v_pk_fma_f16 v185, v185, v57, s23 op_sel:[0,0,1]
  v_pk_fma_f16 v186, v186, v58, s23 op_sel:[0,0,1]
  v_pk_fma_f16 v187, v187, v59, s23 op_sel:[0,0,1]
  v_pk_fma_f16 v184, v184, v48, 0.5 op_sel_hi:[1,1,0] clamp
  v_pk_fma_f16 v185, v185, v49, 0.5 op_sel_hi:[1,1,0] clamp
  v_mfma_f32_32x32x16_bf16 v[16:31], a[144:147], v[160:163], 0
  ds_read_b128 v[192:195], v0 offset:36864
  ds_read_b128 v[196:199], v0 offset:37888
  v_pk_fma_f16 v186, v186, v50, 0.5 op_sel_hi:[1,1,0] clamp
  v_pk_fma_f16 v187, v187, v51, 0.5 op_sel_hi:[1,1,0] clamp
  v_pk_mul_f16 v184, v184, v48
  v_pk_mul_f16 v185, v185, v49
  v_mfma_f32_32x32x16_bf16 v[16:31], a[148:151], v[164:167], v[16:31]
  ds_read_b128 v[200:203], v0 offset:38912
  ds_read_b128 v[204:207], v0 offset:39936
  v_pk_mul_f16 v186, v186, v50
  v_pk_mul_f16 v187, v187, v51
  v_pk_fma_f16 v56, v52, v52, s23 op_sel_hi:[1,1,0]
  v_pk_fma_f16 v57, v53, v53, s23 op_sel_hi:[1,1,0]
  v_mfma_f32_32x32x16_bf16 v[16:31], a[152:155], v[168:171], v[16:31]
  ds_read_b128 v[208:211], v0 offset:40960
  ds_read_b128 v[212:215], v0 offset:41984
  v_pk_fma_f16 v58, v54, v54, s23 op_sel_hi:[1,1,0]
  v_pk_fma_f16 v59, v55, v55, s23 op_sel_hi:[1,1,0]
  v_pk_fma_f16 v188, v56, s20, s20 op_sel:[0,1,0] op_sel_hi:[1,1,0]
  v_pk_fma_f16 v189, v57, s20, s20 op_sel:[0,1,0] op_sel_hi:[1,1,0]
  v_mfma_f32_32x32x16_bf16 v[16:31], a[156:159], v[172:175], v[16:31]
  v_pk_fma_f16 v190, v58, s20, s20 op_sel:[0,1,0] op_sel_hi:[1,1,0]
  v_pk_fma_f16 v191, v59, s20, s20 op_sel:[0,1,0] op_sel_hi:[1,1,0]
  v_pk_fma_f16 v188, v188, v56, s21 op_sel:[0,0,1]
  v_pk_fma_f16 v189, v189, v57, s21 op_sel:[0,0,1]
  v_pk_fma_f16 v190, v190, v58, s21 op_sel:[0,0,1]
  v_pk_fma_f16 v191, v191, v59, s21 op_sel:[0,0,1]
  v_mfma_f32_32x32x16_bf16 v[16:31], a[160:163], v[176:179], v[16:31]
  v_pk_fma_f16 v188, v188, v56, s21 op_sel_hi:[1,1,0]
  v_pk_fma_f16 v189, v189, v57, s21 op_sel_hi:[1,1,0]
  v_pk_fma_f16 v190, v190, v58, s21 op_sel_hi:[1,1,0]
  v_pk_fma_f16 v191, v191, v59, s21 op_sel_hi:[1,1,0]
  v_pk_fma_f16 v188, v188, v56, s23 op_sel:[0,0,1]
  v_pk_fma_f16 v189, v189, v57, s23 op_sel:[0,0,1]
  v_mfma_f32_32x32x16_bf16 v[16:31], a[164:167], v[180:183], v[16:31]
  s_nop 0
  s_waitcnt lgkmcnt(0)
  v_pk_fma_f16 v190, v190, v58, s23 op_sel:[0,0,1]
  v_pk_fma_f16 v191, v191, v59, s23 op_sel:[0,0,1]
  v_pk_fma_f16 v188, v188, v52, 0.5 op_sel_hi:[1,1,0] clamp
  v_pk_fma_f16 v189, v189, v53, 0.5 op_sel_hi:[1,1,0] clamp
  v_pk_fma_f16 v190, v190, v54, 0.5 op_sel_hi:[1,1,0] clamp
  v_pk_fma_f16 v191, v191, v55, 0.5 op_sel_hi:[1,1,0] clamp
  v_mfma_f32_32x32x16_f16 v[64:79], v[192:195], v[184:187], v[64:79]
  v_pk_mul_f16 v188, v188, v52
  v_pk_mul_f16 v189, v189, v53
  v_pk_mul_f16 v190, v190, v54
  v_pk_mul_f16 v191, v191, v55
  v_mfma_f32_32x32x16_f16 v[80:95], v[196:199], v[184:187], v[80:95]
  v_cvt_pk_f16_f32 v48, v16, v17
  v_cvt_pk_f16_f32 v49, v18, v19
  v_cvt_pk_f16_f32 v50, v20, v21
  v_cvt_pk_f16_f32 v51, v22, v23
  v_cvt_pk_f16_f32 v52, v24, v25
  v_cvt_pk_f16_f32 v53, v26, v27
  v_mfma_f32_32x32x16_f16 v[96:111], v[200:203], v[184:187], v[96:111]
  v_cvt_pk_f16_f32 v54, v28, v29
  v_cvt_pk_f16_f32 v55, v30, v31
  v_pk_fma_f16 v56, v48, v48, s23 op_sel_hi:[1,1,0]
  v_pk_fma_f16 v57, v49, v49, s23 op_sel_hi:[1,1,0]
  v_pk_fma_f16 v58, v50, v50, s23 op_sel_hi:[1,1,0]
  v_pk_fma_f16 v59, v51, v51, s23 op_sel_hi:[1,1,0]
  v_mfma_f32_32x32x16_f16 v[64:79], v[204:207], v[188:191], v[64:79]
  v_pk_fma_f16 v184, v56, s20, s20 op_sel:[0,1,0] op_sel_hi:[1,1,0]
  v_pk_fma_f16 v185, v57, s20, s20 op_sel:[0,1,0] op_sel_hi:[1,1,0]
  v_pk_fma_f16 v186, v58, s20, s20 op_sel:[0,1,0] op_sel_hi:[1,1,0]
  v_pk_fma_f16 v187, v59, s20, s20 op_sel:[0,1,0] op_sel_hi:[1,1,0]
  v_pk_fma_f16 v184, v184, v56, s21 op_sel:[0,0,1]
  v_pk_fma_f16 v185, v185, v57, s21 op_sel:[0,0,1]
  v_mfma_f32_32x32x16_f16 v[80:95], v[208:211], v[188:191], v[80:95]
  v_pk_fma_f16 v186, v186, v58, s21 op_sel:[0,0,1]
  v_pk_fma_f16 v187, v187, v59, s21 op_sel:[0,0,1]
  v_pk_fma_f16 v184, v184, v56, s21 op_sel_hi:[1,1,0]
  v_pk_fma_f16 v185, v185, v57, s21 op_sel_hi:[1,1,0]
  v_pk_fma_f16 v186, v186, v58, s21 op_sel_hi:[1,1,0]
  v_pk_fma_f16 v187, v187, v59, s21 op_sel_hi:[1,1,0]
  v_mfma_f32_32x32x16_f16 v[96:111], v[212:215], v[188:191], v[96:111]
  v_pk_fma_f16 v184, v184, v56, s23 op_sel:[0,0,1]
  v_pk_fma_f16 v185, v185, v57, s23 op_sel:[0,0,1]
  v_pk_fma_f16 v186, v186, v58, s23 op_sel:[0,0,1]
  v_pk_fma_f16 v187, v187, v59, s23 op_sel:[0,0,1]
  v_pk_fma_f16 v184, v184, v48, 0.5 op_sel_hi:[1,1,0] clamp
  v_pk_fma_f16 v185, v185, v49, 0.5 op_sel_hi:[1,1,0] clamp
  v_mfma_f32_32x32x16_bf16 v[16:31], a[168:171], v[160:163], 0
  ds_read_b128 v[192:195], v0 offset:43008
  ds_read_b128 v[196:199], v0 offset:44032
  v_pk_fma_f16 v186, v186, v50, 0.5 op_sel_hi:[1,1,0] clamp
  v_pk_fma_f16 v187, v187, v51, 0.5 op_sel_hi:[1,1,0] clamp
  v_pk_mul_f16 v184, v184, v48
  v_pk_mul_f16 v185, v185, v49
  v_mfma_f32_32x32x16_bf16 v[16:31], a[172:175], v[164:167], v[16:31]
  ds_read_b128 v[200:203], v0 offset:45056
  ds_read_b128 v[204:207], v0 offset:46080
  v_pk_mul_f16 v186, v186, v50
  v_pk_mul_f16 v187, v187, v51
  v_pk_fma_f16 v56, v52, v52, s23 op_sel_hi:[1,1,0]
  v_pk_fma_f16 v57, v53, v53, s23 op_sel_hi:[1,1,0]
  v_mfma_f32_32x32x16_bf16 v[16:31], a[176:179], v[168:171], v[16:31]
  ds_read_b128 v[208:211], v0 offset:47104
  ds_read_b128 v[212:215], v0 offset:48128
  v_pk_fma_f16 v58, v54, v54, s23 op_sel_hi:[1,1,0]
  v_pk_fma_f16 v59, v55, v55, s23 op_sel_hi:[1,1,0]
  v_pk_fma_f16 v188, v56, s20, s20 op_sel:[0,1,0] op_sel_hi:[1,1,0]
  v_pk_fma_f16 v189, v57, s20, s20 op_sel:[0,1,0] op_sel_hi:[1,1,0]
  v_mfma_f32_32x32x16_bf16 v[16:31], a[180:183], v[172:175], v[16:31]
  buffer_store_dwordx4 v[128:131], v10, s[8:11], s28 offen offset:128
  v_pk_fma_f16 v190, v58, s20, s20 op_sel:[0,1,0] op_sel_hi:[1,1,0]
  v_pk_fma_f16 v191, v59, s20, s20 op_sel:[0,1,0] op_sel_hi:[1,1,0]
  v_pk_fma_f16 v188, v188, v56, s21 op_sel:[0,0,1]
  v_pk_fma_f16 v189, v189, v57, s21 op_sel:[0,0,1]
  v_pk_fma_f16 v190, v190, v58, s21 op_sel:[0,0,1]
  v_mfma_f32_32x32x16_bf16 v[16:31], a[184:187], v[176:179], v[16:31]
  v_pk_fma_f16 v191, v191, v59, s21 op_sel:[0,0,1]
  v_pk_fma_f16 v188, v188, v56, s21 op_sel_hi:[1,1,0]
  v_pk_fma_f16 v189, v189, v57, s21 op_sel_hi:[1,1,0]
  v_pk_fma_f16 v190, v190, v58, s21 op_sel_hi:[1,1,0]
  v_pk_fma_f16 v191, v191, v59, s21 op_sel_hi:[1,1,0]
  v_pk_fma_f16 v188, v188, v56, s23 op_sel:[0,0,1]
  v_mfma_f32_32x32x16_bf16 v[16:31], a[188:191], v[180:183], v[16:31]
  s_nop 0
  s_waitcnt lgkmcnt(0)
  v_pk_fma_f16 v189, v189, v57, s23 op_sel:[0,0,1]
  v_pk_fma_f16 v190, v190, v58, s23 op_sel:[0,0,1]
  v_pk_fma_f16 v191, v191, v59, s23 op_sel:[0,0,1]
  v_pk_fma_f16 v188, v188, v52, 0.5 op_sel_hi:[1,1,0] clamp
  v_pk_fma_f16 v189, v189, v53, 0.5 op_sel_hi:[1,1,0] clamp
  v_pk_fma_f16 v190, v190, v54, 0.5 op_sel_hi:[1,1,0] clamp
  v_mfma_f32_32x32x16_f16 v[64:79], v[192:195], v[184:187], v[64:79]
  v_pk_fma_f16 v191, v191, v55, 0.5 op_sel_hi:[1,1,0] clamp
  v_pk_mul_f16 v188, v188, v52
  v_pk_mul_f16 v189, v189, v53
  v_pk_mul_f16 v190, v190, v54
  v_pk_mul_f16 v191, v191, v55
  v_mfma_f32_32x32x16_f16 v[80:95], v[196:199], v[184:187], v[80:95]
  v_cvt_pk_f16_f32 v48, v16, v17
  v_cvt_pk_f16_f32 v49, v18, v19
  v_cvt_pk_f16_f32 v50, v20, v21
  v_cvt_pk_f16_f32 v51, v22, v23
  v_cvt_pk_f16_f32 v52, v24, v25
  v_cvt_pk_f16_f32 v53, v26, v27
  v_mfma_f32_32x32x16_f16 v[96:111], v[200:203], v[184:187], v[96:111]
  v_cvt_pk_f16_f32 v54, v28, v29
  v_cvt_pk_f16_f32 v55, v30, v31
  v_pk_fma_f16 v56, v48, v48, s23 op_sel_hi:[1,1,0]
  v_pk_fma_f16 v57, v49, v49, s23 op_sel_hi:[1,1,0]
  v_pk_fma_f16 v58, v50, v50, s23 op_sel_hi:[1,1,0]
  v_pk_fma_f16 v59, v51, v51, s23 op_sel_hi:[1,1,0]
  v_mfma_f32_32x32x16_f16 v[64:79], v[204:207], v[188:191], v[64:79]
  v_pk_fma_f16 v184, v56, s20, s20 op_sel:[0,1,0] op_sel_hi:[1,1,0]
  v_pk_fma_f16 v185, v57, s20, s20 op_sel:[0,1,0] op_sel_hi:[1,1,0]
  v_pk_fma_f16 v186, v58, s20, s20 op_sel:[0,1,0] op_sel_hi:[1,1,0]
  v_pk_fma_f16 v187, v59, s20, s20 op_sel:[0,1,0] op_sel_hi:[1,1,0]
  v_pk_fma_f16 v184, v184, v56, s21 op_sel:[0,0,1]
  v_pk_fma_f16 v185, v185, v57, s21 op_sel:[0,0,1]
  v_mfma_f32_32x32x16_f16 v[80:95], v[208:211], v[188:191], v[80:95]
  v_pk_fma_f16 v186, v186, v58, s21 op_sel:[0,0,1]
  v_pk_fma_f16 v187, v187, v59, s21 op_sel:[0,0,1]
  v_pk_fma_f16 v184, v184, v56, s21 op_sel_hi:[1,1,0]
  v_pk_fma_f16 v185, v185, v57, s21 op_sel_hi:[1,1,0]
  v_pk_fma_f16 v186, v186, v58, s21 op_sel_hi:[1,1,0]
  v_pk_fma_f16 v187, v187, v59, s21 op_sel_hi:[1,1,0]
  v_mfma_f32_32x32x16_f16 v[96:111], v[212:215], v[188:191], v[96:111]
  v_pk_fma_f16 v184, v184, v56, s23 op_sel:[0,0,1]
  v_pk_fma_f16 v185, v185, v57, s23 op_sel:[0,0,1]
  v_pk_fma_f16 v186, v186, v58, s23 op_sel:[0,0,1]
  v_pk_fma_f16 v187, v187, v59, s23 op_sel:[0,0,1]
  v_pk_fma_f16 v184, v184, v48, 0.5 op_sel_hi:[1,1,0] clamp
  v_pk_fma_f16 v185, v185, v49, 0.5 op_sel_hi:[1,1,0] clamp
  v_mfma_f32_32x32x16_bf16 v[16:31], a[192:195], v[160:163], 0
  ds_read_b128 v[192:195], v0 offset:49152
  ds_read_b128 v[196:199], v0 offset:50176
  v_pk_fma_f16 v186, v186, v50, 0.5 op_sel_hi:[1,1,0] clamp
  v_pk_fma_f16 v187, v187, v51, 0.5 op_sel_hi:[1,1,0] clamp
  v_pk_mul_f16 v184, v184, v48
  v_pk_mul_f16 v185, v185, v49
  v_mfma_f32_32x32x16_bf16 v[16:31], a[196:199], v[164:167], v[16:31]
  ds_read_b128 v[200:203], v0 offset:51200
  ds_read_b128 v[204:207], v0 offset:52224
  v_pk_mul_f16 v186, v186, v50
  v_pk_mul_f16 v187, v187, v51
  v_pk_fma_f16 v56, v52, v52, s23 op_sel_hi:[1,1,0]
  v_pk_fma_f16 v57, v53, v53, s23 op_sel_hi:[1,1,0]
  v_mfma_f32_32x32x16_bf16 v[16:31], a[200:203], v[168:171], v[16:31]
  ds_read_b128 v[208:211], v0 offset:53248
  ds_read_b128 v[212:215], v0 offset:54272
  v_pk_fma_f16 v58, v54, v54, s23 op_sel_hi:[1,1,0]
  v_pk_fma_f16 v59, v55, v55, s23 op_sel_hi:[1,1,0]
  v_pk_fma_f16 v188, v56, s20, s20 op_sel:[0,1,0] op_sel_hi:[1,1,0]
  v_pk_fma_f16 v189, v57, s20, s20 op_sel:[0,1,0] op_sel_hi:[1,1,0]
  v_mfma_f32_32x32x16_bf16 v[16:31], a[204:207], v[172:175], v[16:31]
  buffer_store_dwordx4 v[132:135], v10, s[8:11], s28 offen offset:160
  v_pk_fma_f16 v190, v58, s20, s20 op_sel:[0,1,0] op_sel_hi:[1,1,0]
  v_pk_fma_f16 v191, v59, s20, s20 op_sel:[0,1,0] op_sel_hi:[1,1,0]
  v_pk_fma_f16 v188, v188, v56, s21 op_sel:[0,0,1]
  v_pk_fma_f16 v189, v189, v57, s21 op_sel:[0,0,1]
  v_pk_fma_f16 v190, v190, v58, s21 op_sel:[0,0,1]
  v_mfma_f32_32x32x16_bf16 v[16:31], a[208:211], v[176:179], v[16:31]
  v_pk_fma_f16 v191, v191, v59, s21 op_sel:[0,0,1]
  v_pk_fma_f16 v188, v188, v56, s21 op_sel_hi:[1,1,0]
  v_pk_fma_f16 v189, v189, v57, s21 op_sel_hi:[1,1,0]
  v_pk_fma_f16 v190, v190, v58, s21 op_sel_hi:[1,1,0]
  v_pk_fma_f16 v191, v191, v59, s21 op_sel_hi:[1,1,0]
  v_pk_fma_f16 v188, v188, v56, s23 op_sel:[0,0,1]
  v_mfma_f32_32x32x16_bf16 v[16:31], a[212:215], v[180:183], v[16:31]
  s_nop 0
  s_waitcnt lgkmcnt(0)
  v_pk_fma_f16 v189, v189, v57, s23 op_sel:[0,0,1]
  v_pk_fma_f16 v190, v190, v58, s23 op_sel:[0,0,1]
  v_pk_fma_f16 v191, v191, v59, s23 op_sel:[0,0,1]
  v_pk_fma_f16 v188, v188, v52, 0.5 op_sel_hi:[1,1,0] clamp
  v_pk_fma_f16 v189, v189, v53, 0.5 op_sel_hi:[1,1,0] clamp
  v_pk_fma_f16 v190, v190, v54, 0.5 op_sel_hi:[1,1,0] clamp
  v_mfma_f32_32x32x16_f16 v[64:79], v[192:195], v[184:187], v[64:79]
  v_pk_fma_f16 v191, v191, v55, 0.5 op_sel_hi:[1,1,0] clamp
  v_pk_mul_f16 v188, v188, v52
  v_pk_mul_f16 v189, v189, v53
  v_pk_mul_f16 v190, v190, v54
  v_pk_mul_f16 v191, v191, v55
  v_mfma_f32_32x32x16_f16 v[80:95], v[196:199], v[184:187], v[80:95]
  v_cvt_pk_f16_f32 v48, v16, v17
  v_cvt_pk_f16_f32 v49, v18, v19
  v_cvt_pk_f16_f32 v50, v20, v21
  v_cvt_pk_f16_f32 v51, v22, v23
  v_cvt_pk_f16_f32 v52, v24, v25
  v_cvt_pk_f16_f32 v53, v26, v27
  v_mfma_f32_32x32x16_f16 v[96:111], v[200:203], v[184:187], v[96:111]
  v_cvt_pk_f16_f32 v54, v28, v29
  v_cvt_pk_f16_f32 v55, v30, v31
  v_pk_fma_f16 v56, v48, v48, s23 op_sel_hi:[1,1,0]
  v_pk_fma_f16 v57, v49, v49, s23 op_sel_hi:[1,1,0]
  v_pk_fma_f16 v58, v50, v50, s23 op_sel_hi:[1,1,0]
  v_pk_fma_f16 v59, v51, v51, s23 op_sel_hi:[1,1,0]
  v_mfma_f32_32x32x16_f16 v[64:79], v[204:207], v[188:191], v[64:79]
  v_pk_fma_f16 v184, v56, s20, s20 op_sel:[0,1,0] op_sel_hi:[1,1,0]
  v_pk_fma_f16 v185, v57, s20, s20 op_sel:[0,1,0] op_sel_hi:[1,1,0]
  v_pk_fma_f16 v186, v58, s20, s20 op_sel:[0,1,0] op_sel_hi:[1,1,0]
  v_pk_fma_f16 v187, v59, s20, s20 op_sel:[0,1,0] op_sel_hi:[1,1,0]
  v_pk_fma_f16 v184, v184, v56, s21 op_sel:[0,0,1]
  v_pk_fma_f16 v185, v185, v57, s21 op_sel:[0,0,1]
  v_mfma_f32_32x32x16_f16 v[80:95], v[208:211], v[188:191], v[80:95]
  v_pk_fma_f16 v186, v186, v58, s21 op_sel:[0,0,1]
  v_pk_fma_f16 v187, v187, v59, s21 op_sel:[0,0,1]
  v_pk_fma_f16 v184, v184, v56, s21 op_sel_hi:[1,1,0]
  v_pk_fma_f16 v185, v185, v57, s21 op_sel_hi:[1,1,0]
  v_pk_fma_f16 v186, v186, v58, s21 op_sel_hi:[1,1,0]
  v_pk_fma_f16 v187, v187, v59, s21 op_sel_hi:[1,1,0]
  v_mfma_f32_32x32x16_f16 v[96:111], v[212:215], v[188:191], v[96:111]
  v_pk_fma_f16 v184, v184, v56, s23 op_sel:[0,0,1]
  v_pk_fma_f16 v185, v185, v57, s23 op_sel:[0,0,1]
  v_pk_fma_f16 v186, v186, v58, s23 op_sel:[0,0,1]
  v_pk_fma_f16 v187, v187, v59, s23 op_sel:[0,0,1]
  v_pk_fma_f16 v184, v184, v48, 0.5 op_sel_hi:[1,1,0] clamp
  v_pk_fma_f16 v185, v185, v49, 0.5 op_sel_hi:[1,1,0] clamp
  v_mfma_f32_32x32x16_bf16 v[16:31], a[216:219], v[160:163], 0
  ds_read_b128 v[192:195], v0 offset:55296
  ds_read_b128 v[196:199], v0 offset:56320
  v_pk_fma_f16 v186, v186, v50, 0.5 op_sel_hi:[1,1,0] clamp
  v_pk_fma_f16 v187, v187, v51, 0.5 op_sel_hi:[1,1,0] clamp
  v_pk_mul_f16 v184, v184, v48
  v_pk_mul_f16 v185, v185, v49
  v_mfma_f32_32x32x16_bf16 v[16:31], a[220:223], v[164:167], v[16:31]
  ds_read_b128 v[200:203], v0 offset:57344
  ds_read_b128 v[204:207], v0 offset:58368
  v_pk_mul_f16 v186, v186, v50
  v_pk_mul_f16 v187, v187, v51
  v_pk_fma_f16 v56, v52, v52, s23 op_sel_hi:[1,1,0]
  v_pk_fma_f16 v57, v53, v53, s23 op_sel_hi:[1,1,0]
  v_mfma_f32_32x32x16_bf16 v[16:31], a[224:227], v[168:171], v[16:31]
  ds_read_b128 v[208:211], v0 offset:59392
  ds_read_b128 v[212:215], v0 offset:60416
  v_pk_fma_f16 v58, v54, v54, s23 op_sel_hi:[1,1,0]
  v_pk_fma_f16 v59, v55, v55, s23 op_sel_hi:[1,1,0]
  v_pk_fma_f16 v188, v56, s20, s20 op_sel:[0,1,0] op_sel_hi:[1,1,0]
  v_pk_fma_f16 v189, v57, s20, s20 op_sel:[0,1,0] op_sel_hi:[1,1,0]
  v_mfma_f32_32x32x16_bf16 v[16:31], a[228:231], v[172:175], v[16:31]
  v_pk_fma_f16 v190, v58, s20, s20 op_sel:[0,1,0] op_sel_hi:[1,1,0]
  v_pk_fma_f16 v191, v59, s20, s20 op_sel:[0,1,0] op_sel_hi:[1,1,0]
  v_pk_fma_f16 v188, v188, v56, s21 op_sel:[0,0,1]
  v_pk_fma_f16 v189, v189, v57, s21 op_sel:[0,0,1]
  v_pk_fma_f16 v190, v190, v58, s21 op_sel:[0,0,1]
  v_pk_fma_f16 v191, v191, v59, s21 op_sel:[0,0,1]
  v_mfma_f32_32x32x16_bf16 v[16:31], a[232:235], v[176:179], v[16:31]
  v_pk_fma_f16 v188, v188, v56, s21 op_sel_hi:[1,1,0]
  v_pk_fma_f16 v189, v189, v57, s21 op_sel_hi:[1,1,0]
  v_pk_fma_f16 v190, v190, v58, s21 op_sel_hi:[1,1,0]
  v_pk_fma_f16 v191, v191, v59, s21 op_sel_hi:[1,1,0]
  v_pk_fma_f16 v188, v188, v56, s23 op_sel:[0,0,1]
  v_pk_fma_f16 v189, v189, v57, s23 op_sel:[0,0,1]
  v_mfma_f32_32x32x16_bf16 v[16:31], a[236:239], v[180:183], v[16:31]
  s_nop 0
  s_waitcnt lgkmcnt(0)
  v_pk_fma_f16 v190, v190, v58, s23 op_sel:[0,0,1]
  v_pk_fma_f16 v191, v191, v59, s23 op_sel:[0,0,1]
  v_pk_fma_f16 v188, v188, v52, 0.5 op_sel_hi:[1,1,0] clamp
  v_pk_fma_f16 v189, v189, v53, 0.5 op_sel_hi:[1,1,0] clamp
  v_pk_fma_f16 v190, v190, v54, 0.5 op_sel_hi:[1,1,0] clamp
  v_pk_fma_f16 v191, v191, v55, 0.5 op_sel_hi:[1,1,0] clamp
  v_mfma_f32_32x32x16_f16 v[64:79], v[192:195], v[184:187], v[64:79]
  ds_read_b128 v[236:239], v0 offset:17408
  v_pk_mul_f16 v188, v188, v52
  v_pk_mul_f16 v189, v189, v53
  v_pk_mul_f16 v190, v190, v54
  v_pk_mul_f16 v191, v191, v55
  v_mfma_f32_32x32x16_f16 v[80:95], v[196:199], v[184:187], v[80:95]
  v_cvt_pk_f16_f32 v48, v16, v17
  v_cvt_pk_f16_f32 v49, v18, v19
  v_cvt_pk_f16_f32 v50, v20, v21
  v_cvt_pk_f16_f32 v51, v22, v23
  v_cvt_pk_f16_f32 v52, v24, v25
  v_cvt_pk_f16_f32 v53, v26, v27
  v_mfma_f32_32x32x16_f16 v[96:111], v[200:203], v[184:187], v[96:111]
  v_cvt_pk_f16_f32 v54, v28, v29
  v_cvt_pk_f16_f32 v55, v30, v31
  v_pk_fma_f16 v56, v48, v48, s23 op_sel_hi:[1,1,0]
  v_pk_fma_f16 v57, v49, v49, s23 op_sel_hi:[1,1,0]
  v_pk_fma_f16 v58, v50, v50, s23 op_sel_hi:[1,1,0]
  v_pk_fma_f16 v59, v51, v51, s23 op_sel_hi:[1,1,0]
  v_mfma_f32_32x32x16_f16 v[64:79], v[204:207], v[188:191], v[64:79]
  s_nop 0
  s_mov_b32 s28, s34
  v_pk_fma_f16 v184, v56, s20, s20 op_sel:[0,1,0] op_sel_hi:[1,1,0]
  v_pk_fma_f16 v185, v57, s20, s20 op_sel:[0,1,0] op_sel_hi:[1,1,0]
  v_pk_fma_f16 v186, v58, s20, s20 op_sel:[0,1,0] op_sel_hi:[1,1,0]
  v_pk_fma_f16 v187, v59, s20, s20 op_sel:[0,1,0] op_sel_hi:[1,1,0]
  v_pk_fma_f16 v184, v184, v56, s21 op_sel:[0,0,1]
  v_pk_fma_f16 v185, v185, v57, s21 op_sel:[0,0,1]
  v_mfma_f32_32x32x16_f16 v[80:95], v[208:211], v[188:191], v[80:95]
  s_add_u32 s34, s34, 0x60000
  v_pk_fma_f16 v186, v186, v58, s21 op_sel:[0,0,1]
  v_pk_fma_f16 v187, v187, v59, s21 op_sel:[0,0,1]
  v_pk_fma_f16 v184, v184, v56, s21 op_sel_hi:[1,1,0]
  v_pk_fma_f16 v185, v185, v57, s21 op_sel_hi:[1,1,0]
  v_pk_fma_f16 v186, v186, v58, s21 op_sel_hi:[1,1,0]
  v_pk_fma_f16 v187, v187, v59, s21 op_sel_hi:[1,1,0]
  v_mfma_f32_32x32x16_f16 v[96:111], v[212:215], v[188:191], v[96:111]
  s_nop 0
  s_waitcnt lgkmcnt(0)
  v_pk_fma_f16 v184, v184, v56, s23 op_sel:[0,0,1]
  v_pk_fma_f16 v185, v185, v57, s23 op_sel:[0,0,1]
  v_pk_fma_f16 v186, v186, v58, s23 op_sel:[0,0,1]
  v_pk_fma_f16 v187, v187, v59, s23 op_sel:[0,0,1]
  v_pk_fma_f16 v184, v184, v48, 0.5 op_sel_hi:[1,1,0] clamp
  v_pk_fma_f16 v185, v185, v49, 0.5 op_sel_hi:[1,1,0] clamp
  v_mfma_f32_32x32x16_bf16 v[16:31], v[32:35], v[160:163], 0
  ds_read_b128 v[192:195], v0 offset:61440
  ds_read_b128 v[196:199], v0 offset:62464
  v_pk_fma_f16 v186, v186, v50, 0.5 op_sel_hi:[1,1,0] clamp
  v_pk_fma_f16 v187, v187, v51, 0.5 op_sel_hi:[1,1,0] clamp
  v_pk_mul_f16 v184, v184, v48
  v_pk_mul_f16 v185, v185, v49
  v_mfma_f32_32x32x16_bf16 v[16:31], v[36:39], v[164:167], v[16:31]
  ds_read_b128 v[200:203], v0 offset:63488
  ds_read_b128 v[204:207], v0 offset:64512
  v_pk_mul_f16 v186, v186, v50
  v_pk_mul_f16 v187, v187, v51
  v_pk_fma_f16 v56, v52, v52, s23 op_sel_hi:[1,1,0]
  v_pk_fma_f16 v57, v53, v53, s23 op_sel_hi:[1,1,0]
  v_mfma_f32_32x32x16_bf16 v[16:31], v[40:43], v[168:171], v[16:31]
  ds_read_b128 v[208:211], v1
  ds_read_b128 v[212:215], v1 offset:1024
  v_pk_fma_f16 v58, v54, v54, s23 op_sel_hi:[1,1,0]
  v_pk_fma_f16 v59, v55, v55, s23 op_sel_hi:[1,1,0]
  v_pk_fma_f16 v188, v56, s20, s20 op_sel:[0,1,0] op_sel_hi:[1,1,0]
  v_pk_fma_f16 v189, v57, s20, s20 op_sel:[0,1,0] op_sel_hi:[1,1,0]
  v_mfma_f32_32x32x16_bf16 v[16:31], v[44:47], v[172:175], v[16:31]
  v_pk_fma_f16 v190, v58, s20, s20 op_sel:[0,1,0] op_sel_hi:[1,1,0]
  v_pk_fma_f16 v191, v59, s20, s20 op_sel:[0,1,0] op_sel_hi:[1,1,0]
  v_pk_fma_f16 v188, v188, v56, s21 op_sel:[0,0,1]
  v_pk_fma_f16 v189, v189, v57, s21 op_sel:[0,0,1]
  v_pk_fma_f16 v190, v190, v58, s21 op_sel:[0,0,1]
  v_pk_fma_f16 v191, v191, v59, s21 op_sel:[0,0,1]
  v_mfma_f32_32x32x16_bf16 v[16:31], v[60:63], v[176:179], v[16:31]
  v_pk_fma_f16 v188, v188, v56, s21 op_sel_hi:[1,1,0]
  v_pk_fma_f16 v189, v189, v57, s21 op_sel_hi:[1,1,0]
  v_pk_fma_f16 v190, v190, v58, s21 op_sel_hi:[1,1,0]
  v_pk_fma_f16 v191, v191, v59, s21 op_sel_hi:[1,1,0]
  v_pk_fma_f16 v188, v188, v56, s23 op_sel:[0,0,1]
  v_pk_fma_f16 v189, v189, v57, s23 op_sel:[0,0,1]
  v_mfma_f32_32x32x16_bf16 v[16:31], v[236:239], v[180:183], v[16:31]
  s_nop 0
  s_waitcnt lgkmcnt(0)
  v_pk_fma_f16 v190, v190, v58, s23 op_sel:[0,0,1]
  v_pk_fma_f16 v191, v191, v59, s23 op_sel:[0,0,1]
  v_pk_fma_f16 v188, v188, v52, 0.5 op_sel_hi:[1,1,0] clamp
  v_pk_fma_f16 v189, v189, v53, 0.5 op_sel_hi:[1,1,0] clamp
  v_pk_fma_f16 v190, v190, v54, 0.5 op_sel_hi:[1,1,0] clamp
  v_pk_fma_f16 v191, v191, v55, 0.5 op_sel_hi:[1,1,0] clamp
  v_mfma_f32_32x32x16_f16 v[64:79], v[192:195], v[184:187], v[64:79]
  v_pk_mul_f16 v188, v188, v52
  v_pk_mul_f16 v189, v189, v53
  v_pk_mul_f16 v190, v190, v54
  v_pk_mul_f16 v191, v191, v55
  v_mfma_f32_32x32x16_f16 v[80:95], v[196:199], v[184:187], v[80:95]
  v_cvt_pk_f16_f32 v48, v16, v17
  v_cvt_pk_f16_f32 v49, v18, v19
  v_cvt_pk_f16_f32 v50, v20, v21
  v_cvt_pk_f16_f32 v51, v22, v23
  v_cvt_pk_f16_f32 v52, v24, v25
  v_cvt_pk_f16_f32 v53, v26, v27
  v_cvt_pk_f16_f32 v54, v28, v29
  v_cvt_pk_f16_f32 v55, v30, v31
  v_mfma_f32_32x32x16_f16 v[96:111], v[200:203], v[184:187], v[96:111]
  v_pk_fma_f16 v56, v48, v48, s23 op_sel_hi:[1,1,0]
  v_pk_fma_f16 v57, v49, v49, s23 op_sel_hi:[1,1,0]
  v_pk_fma_f16 v58, v50, v50, s23 op_sel_hi:[1,1,0]
  v_pk_fma_f16 v59, v51, v51, s23 op_sel_hi:[1,1,0]
  v_pk_fma_f16 v184, v56, s20, s20 op_sel:[0,1,0] op_sel_hi:[1,1,0]
  v_pk_fma_f16 v185, v57, s20, s20 op_sel:[0,1,0] op_sel_hi:[1,1,0]
  v_pk_fma_f16 v186, v58, s20, s20 op_sel:[0,1,0] op_sel_hi:[1,1,0]
  v_pk_fma_f16 v187, v59, s20, s20 op_sel:[0,1,0] op_sel_hi:[1,1,0]
  v_mfma_f32_32x32x16_f16 v[64:79], v[204:207], v[188:191], v[64:79]
  v_pk_fma_f16 v184, v184, v56, s21 op_sel:[0,0,1]
  v_pk_fma_f16 v185, v185, v57, s21 op_sel:[0,0,1]
  v_pk_fma_f16 v186, v186, v58, s21 op_sel:[0,0,1]
  v_pk_fma_f16 v187, v187, v59, s21 op_sel:[0,0,1]
  v_pk_fma_f16 v184, v184, v56, s21 op_sel_hi:[1,1,0]
  v_pk_fma_f16 v185, v185, v57, s21 op_sel_hi:[1,1,0]
  v_pk_fma_f16 v186, v186, v58, s21 op_sel_hi:[1,1,0]
  v_pk_fma_f16 v187, v187, v59, s21 op_sel_hi:[1,1,0]
  v_mfma_f32_32x32x16_f16 v[80:95], v[208:211], v[188:191], v[80:95]
  v_pk_fma_f16 v184, v184, v56, s23 op_sel:[0,0,1]
  v_pk_fma_f16 v185, v185, v57, s23 op_sel:[0,0,1]
  v_pk_fma_f16 v186, v186, v58, s23 op_sel:[0,0,1]
  v_pk_fma_f16 v187, v187, v59, s23 op_sel:[0,0,1]
  v_pk_fma_f16 v184, v184, v48, 0.5 op_sel_hi:[1,1,0] clamp
  v_pk_fma_f16 v185, v185, v49, 0.5 op_sel_hi:[1,1,0] clamp
  v_pk_fma_f16 v186, v186, v50, 0.5 op_sel_hi:[1,1,0] clamp
  v_pk_fma_f16 v187, v187, v51, 0.5 op_sel_hi:[1,1,0] clamp
  v_mfma_f32_32x32x16_f16 v[96:111], v[212:215], v[188:191], v[96:111]
  ds_read_b128 v[192:195], v1 offset:2048
  ds_read_b128 v[196:199], v1 offset:3072
  ds_read_b128 v[200:203], v1 offset:4096
  ds_read_b128 v[204:207], v1 offset:5120
  ds_read_b128 v[208:211], v1 offset:6144
  ds_read_b128 v[212:215], v1 offset:7168
  v_pk_mul_f16 v184, v184, v48
  v_pk_mul_f16 v185, v185, v49
  v_pk_mul_f16 v186, v186, v50
  v_pk_mul_f16 v187, v187, v51
  s_waitcnt lgkmcnt(5)
  s_nop 0
  v_mfma_f32_32x32x16_f16 v[64:79], v[192:195], v[184:187], v[64:79]
  v_pk_fma_f16 v56, v52, v52, s23 op_sel_hi:[1,1,0]
  v_pk_fma_f16 v57, v53, v53, s23 op_sel_hi:[1,1,0]
  v_pk_fma_f16 v58, v54, v54, s23 op_sel_hi:[1,1,0]
  v_pk_fma_f16 v59, v55, v55, s23 op_sel_hi:[1,1,0]
  v_pk_fma_f16 v188, v56, s20, s20 op_sel:[0,1,0] op_sel_hi:[1,1,0]
  v_pk_fma_f16 v189, v57, s20, s20 op_sel:[0,1,0] op_sel_hi:[1,1,0]
  v_pk_fma_f16 v190, v58, s20, s20 op_sel:[0,1,0] op_sel_hi:[1,1,0]
  v_pk_fma_f16 v191, v59, s20, s20 op_sel:[0,1,0] op_sel_hi:[1,1,0]
  v_pk_fma_f16 v188, v188, v56, s21 op_sel:[0,0,1]
  s_nop 0
  s_waitcnt lgkmcnt(4)
  v_mfma_f32_32x32x16_f16 v[80:95], v[196:199], v[184:187], v[80:95]
  v_pk_fma_f16 v189, v189, v57, s21 op_sel:[0,0,1]
  v_pk_fma_f16 v190, v190, v58, s21 op_sel:[0,0,1]
  v_pk_fma_f16 v191, v191, v59, s21 op_sel:[0,0,1]
  v_pk_fma_f16 v188, v188, v56, s21 op_sel_hi:[1,1,0]
  v_pk_fma_f16 v189, v189, v57, s21 op_sel_hi:[1,1,0]
  v_pk_fma_f16 v190, v190, v58, s21 op_sel_hi:[1,1,0]
  v_pk_fma_f16 v191, v191, v59, s21 op_sel_hi:[1,1,0]
  v_pk_fma_f16 v188, v188, v56, s23 op_sel:[0,0,1]
  v_pk_fma_f16 v189, v189, v57, s23 op_sel:[0,0,1]
  s_nop 0
  s_waitcnt lgkmcnt(3)
  v_mfma_f32_32x32x16_f16 v[96:111], v[200:203], v[184:187], v[96:111]
  v_pk_fma_f16 v190, v190, v58, s23 op_sel:[0,0,1]
  v_pk_fma_f16 v191, v191, v59, s23 op_sel:[0,0,1]
  v_pk_fma_f16 v188, v188, v52, 0.5 op_sel_hi:[1,1,0] clamp
  v_pk_fma_f16 v189, v189, v53, 0.5 op_sel_hi:[1,1,0] clamp
  v_pk_fma_f16 v190, v190, v54, 0.5 op_sel_hi:[1,1,0] clamp
  v_pk_fma_f16 v191, v191, v55, 0.5 op_sel_hi:[1,1,0] clamp
  v_pk_mul_f16 v188, v188, v52
  v_pk_mul_f16 v189, v189, v53
  v_pk_mul_f16 v190, v190, v54
  v_pk_mul_f16 v191, v191, v55
  s_waitcnt lgkmcnt(2)
  s_nop 0
  v_mfma_f32_32x32x16_f16 v[64:79], v[204:207], v[188:191], v[64:79]
  s_waitcnt lgkmcnt(1)
  v_mfma_f32_32x32x16_f16 v[80:95], v[208:211], v[188:191], v[80:95]
  s_waitcnt lgkmcnt(0)
  v_mfma_f32_32x32x16_f16 v[96:111], v[212:215], v[188:191], v[96:111]
  s_nop 0
  s_nop 7
  v_cvt_pk_bf16_f32 v112, v64, v65
  v_cvt_pk_bf16_f32 v113, v66, v67
  v_cvt_pk_bf16_f32 v114, v68, v69
  v_cvt_pk_bf16_f32 v115, v70, v71
  buffer_store_dwordx4 v[112:115], v10, s[8:11], s28 offen
  v_cvt_pk_bf16_f32 v116, v72, v73
  v_cvt_pk_bf16_f32 v117, v74, v75
  v_cvt_pk_bf16_f32 v118, v76, v77
  v_cvt_pk_bf16_f32 v119, v78, v79
  buffer_store_dwordx4 v[116:119], v10, s[8:11], s28 offen offset:32
  v_cvt_pk_bf16_f32 v120, v80, v81
  v_cvt_pk_bf16_f32 v121, v82, v83
  v_cvt_pk_bf16_f32 v122, v84, v85
  v_cvt_pk_bf16_f32 v123, v86, v87
  buffer_store_dwordx4 v[120:123], v10, s[8:11], s28 offen offset:64
  v_cvt_pk_bf16_f32 v124, v88, v89
  v_cvt_pk_bf16_f32 v125, v90, v91
  v_cvt_pk_bf16_f32 v126, v92, v93
  v_cvt_pk_bf16_f32 v127, v94, v95
  buffer_store_dwordx4 v[124:127], v10, s[8:11], s28 offen offset:96
  v_cvt_pk_bf16_f32 v128, v96, v97
  v_cvt_pk_bf16_f32 v129, v98, v99
  v_cvt_pk_bf16_f32 v130, v100, v101
  v_cvt_pk_bf16_f32 v131, v102, v103
  buffer_store_dwordx4 v[128:131], v10, s[8:11], s28 offen offset:128
  v_cvt_pk_bf16_f32 v132, v104, v105
  v_cvt_pk_bf16_f32 v133, v106, v107
  v_cvt_pk_bf16_f32 v134, v108, v109
  v_cvt_pk_bf16_f32 v135, v110, v111
  buffer_store_dwordx4 v[132:135], v10, s[8:11], s28 offen offset:160
L_end:
  s_endpgm
L_slow:
  s_waitcnt vmcnt(0) lgkmcnt(0)
  s_nop 15
  s_nop 15
  s_barrier
  v_mbcnt_lo_u32_b32 v0, -1, 0
  v_mbcnt_hi_u32_b32 v0, -1, v0
  v_lshl_add_u32 v0, s27, 6, v0
  s_nop 4
  .p2align 7
  s_cmp_ge_u32 s2, 0x100
  s_nop 0
  s_cbranch_scc1 S_end
  s_load_dwordx2 s[4:5], s[0:1], 0
  s_load_dwordx2 s[60:61], s[0:1], 8
  s_load_dwordx2 s[64:65], s[0:1], 16
  s_load_dwordx2 s[68:69], s[0:1], 24
  s_load_dwordx2 s[72:73], s[0:1], 32
  s_load_dwordx2 s[76:77], s[0:1], 40
  s_load_dwordx2 s[80:81], s[0:1], 48
  s_load_dwordx2 s[8:9], s[0:1], 56
  s_getpc_b64 s[40:41]
S_pc:
  s_lshl_b32 s32, s2, 9
  s_and_b32 s32, s32, 0xf000
  v_lshl_add_u32 v249, v0, 4, s32
  v_lshrrev_b32_e64 v112, 6, v0
  v_min_u32 v249, S_end-S_pc-12, v249
  v_and_b32 v113, 63, v0
  global_load_dwordx4 v[108:111], v249, s[40:41]
  v_readfirstlane_b32 s27, v112
  s_mov_b32 s62, 0x6c0
  s_mov_b32 s63, 0x20000
  s_mov_b32 s82, 0xc0
  s_mov_b32 s83, 0x20000
  s_mov_b32 s78, 0xc0
  s_mov_b32 s79, 0x20000
  s_mov_b32 s66, 0x12000
  s_mov_b32 s67, 0x20000
  s_mov_b32 s74, 0x12000
  s_mov_b32 s75, 0x20000
  v_bfe_u32 v114, v113, 3, 1
  v_bfe_u32 v115, v113, 4, 1
  v_bfe_u32 v116, v113, 2, 1
  v_and_b32 v117, 3, v113
  v_lshlrev_b32 v118, 4, v113
  s_min_u32 s44, s27, 2
  s_lshl_b32 s45, s44, 6
  s_mul_i32 s46, s44, 0x240
  v_lshlrev_b32 v119, 1, v113
  v_and_b32 v120, 31, v113
  v_lshlrev_b32 v121, 1, v120
  v_lshlrev_b32 v122, 4, v115
  v_lshl_add_u32 v122, v116, 3, v122
  v_lshl_add_u32 v122, v114, 2, v122
  v_add_u32 v122, v122, v117
  v_lshlrev_b32 v123, 1, v122
  s_lshr_b32 s35, s2, 3
  s_lshl_b32 s35, s35, 2
  s_add_u32 s35, s35, s27
  s_sub_u32 s55, s35, 0x48
  s_min_u32 s35, s35, s55
  s_lshl_b32 s47, s35, 10
  s_and_b32 s54, s2, 6
  s_lshl_b32 s54, s54, 1
  s_lshr_b32 s32, s2, 6
  s_add_u32 s54, s54, s32
  s_mul_i32 s59, s54, 0x300000
  s_and_b32 s53, s2, 1
  s_lshl_b32 s53, s53, 8
  s_and_b32 s32, s2, 56
  s_lshl_b32 s32, s32, 2
  s_add_u32 s53, s53, s32
  s_lshl_b32 s32, s27, 3
  s_add_u32 s53, s53, s32
  s_mul_i32 s3, s53, 0xc0
  s_add_u32 s3, s3, 0xf40
  s_mov_b32 s6, 0x3000000
  s_mov_b32 s7, 0x20000
  s_cmp_eq_u32 s53, 0
  s_cselect_b32 s35, 12, 0
  s_sub_u32 s55, 0x78, s35
  s_cmp_eq_u32 s53, 0x1f8
  s_cselect_b32 s55, 0x6c, s55
  s_mul_i32 s15, s27, 0x1040
  s_add_u32 s48, s59, 0x17000
  s_add_u32 s49, s59, 0x47000
  s_waitcnt lgkmcnt(0)
  v_add_u32 v124, 64, v113
  buffer_load_dwordx4 v[108:111], v118, s[64:67], s47 offen
  v_subrev_u32 v127, 57, v113
  v_cmp_le_u32 vcc, 57, v113
  buffer_load_dwordx4 v[108:111], v118, s[72:75], s47 offen
  v_add_u32_e64 v125, 7, v113
  v_add_u32 v126, 0x47, v113
  buffer_load_ushort v129, v119, s[60:63], s46 offen
  v_mov_b32 v199, 0x17c00
  v_cndmask_b32_e64 v124, v124, v127, vcc
  buffer_load_ushort v130, v119, s[60:63], s46 offen offset:128
  v_mov_b32 v127, 0xfffffc00
  v_cndmask_b32 v199, v127, v199, vcc
  v_add_u32 v198, s3, v118
  buffer_load_ushort v131, v119, s[60:63], s46 offen offset:256
  v_lshl_add_u32 v199, v124, 4, v199
  v_add_u32_e64 v199, s3, v199
  buffer_load_ushort v132, v119, s[60:63], s46 offen offset:384
  v_add_u32 v200, 0x17870, v198
  v_add_u32 v201, 0x17870, v198
  buffer_load_ushort v133, v121, s[60:63], s46 offen offset:512
  v_mov_b32 v128, 0x80000000
  v_subrev_u32_e64 v6, s35, v113
  buffer_load_ushort v137, v123, s[80:83], s45 offen
  v_cmp_gt_u32 s[36:37], s55, v6
  v_subrev_u32_e64 v7, s35, v124
  v_cmp_gt_u32 s[38:39], s55, v7
  buffer_load_ushort v138, v123, s[76:79], s45 offen
  v_subrev_u32_e64 v8, s35, v125
  v_cmp_gt_u32 s[40:41], s55, v8
  buffer_load_ushort v134, v123, s[80:83], 0 offen
  v_subrev_u32_e64 v9, s35, v126
  v_cmp_gt_u32 s[42:43], s55, v9
  buffer_load_ushort v135, v123, s[80:83], 0 offen offset:64
  v_cndmask_b32 v6, v128, v198, s[36:37]
  v_cndmask_b32 v7, v128, v199, s[38:39]
  buffer_load_ushort v136, v123, s[80:83], 0 offen offset:128
  v_cndmask_b32 v8, v128, v200, s[40:41]
  v_cndmask_b32 v9, v128, v201, s[42:43]
  s_add_u32 m0, s15, 0x4120
  s_nop 0
  s_nop 0
  buffer_load_dwordx4 v6, s[4:7], s48 offen lds
  buffer_load_dwordx4 v7, s[4:7], s48 offen offset:1024 lds
  buffer_load_dwordx4 v8, s[4:7], s48 offen offset:2048 lds
  buffer_load_dwordx4 v9, s[4:7], s48 offen offset:3072 lds
  s_sub_u32 s56, s59, 0x19000
  v_add_u32_e64 v198, s56, v6
  s_add_u32 s56, s56, 0x400
  v_add_u32_e64 v199, s56, v7
  s_add_u32 s56, s56, 0x400
  v_add_u32_e64 v200, s56, v8
  s_add_u32 s56, s56, 0x400
  v_add_u32 v201, s56, v9
  v_lshrrev_b32 v139, 5, v113
  v_lshlrev_b32_e64 v202, 4, v117
  v_lshl_add_u32 v202, v139, 6, v202
  v_bfe_u32 v124, v113, 3, 2
  v_lshl_add_u32 v124, v116, 2, v124
  v_cmp_eq_u32_e64 vcc, 7, v124
  v_mul_u32_u24 v203, 0x300, v124
  v_add_u32 v203, v203, v202
  v_cndmask_b32 v204, v128, v202, vcc
  s_mov_b32 s70, 0x300
  s_mov_b32 s71, 0x20000
  s_mov_b32 s10, 0x3000000
  s_mov_b32 s11, 0x20000
  s_and_b32 s36, s27, 2
  s_add_u32 s37, s27, 1
  s_lshr_b32 s37, s37, 1
  s_and_b32 s38, s37, 1
  s_cmp_eq_u32 s27, 1
  s_cselect_b32 s39, 0, 3
  s_cselect_b32 s51, 0x1000, 0
  s_lshl_b32 s32, s36, 8
  s_lshl_b32 s33, s37, 8
  s_add_u32 s43, s32, 0x11d00
  s_add_u32 s50, s33, 0x11d00
  s_add_u32 s51, s51, s33
  s_mul_i32 s40, s38, 0x6000
  s_add_u32 s40, s40, s32
  s_mul_i32 s41, s38, 0x1800
  s_add_u32 s41, s41, s32
  s_add_u32 s41, s41, 0x3000
  s_mul_i32 s42, s39, 0x3000
  s_add_u32 s42, s42, s33
  s_mul_i32 s32, s36, 0x6000
  s_lshl_b32 s33, s38, 11
  s_add_u32 s33, s33, s32
  s_add_u32 s33, s33, 0x10000
  v_add_u32_e64 v195, s33, v118
  s_lshl_b32 s33, s38, 3
  s_add_u32 s33, s33, s32
  s_add_u32 s33, s33, 0x10400
  v_add_u32_e64 v196, s33, v118
  s_mul_i32 s32, s37, 0x6000
  s_lshl_b32 s33, s39, 10
  s_add_u32 s33, s33, s32
  s_add_u32 s33, s33, 0x10000
  v_add_u32 v197, s33, v118
  v_add_u32 v125, 16, v113
  v_lshrrev_b32_e64 v125, 6, v125
  buffer_load_dwordx4 a[72:75], v202, s[64:67], s43 offen
  v_lshlrev_b32 v125, 4, v125
  v_xor_b32 v254, v125, v118
  v_lshl_add_u32 v125, v139, 4, 16
  v_xor_b32_e64 v255, v125, v118
  v_mul_u32_u24 v125, 0x1200, v139
  v_add_u32_e64 v255, v125, v255
  v_add_u32 v125, 0xb0, v113
  v_lshrrev_b32 v125, 6, v125
  v_lshlrev_b32 v125, 4, v125
  v_xor_b32_e64 v194, v125, v118
  v_add_u32 v194, 0x1200, v194
  s_mul_i32 s14, s27, 0x1800
  s_add_u32 s32, s27, 3
  s_and_b32 s32, s32, 3
  s_mul_i32 s32, s32, 0x600
  s_cmp_eq_u32 s27, 0
  s_cselect_b32 s57, 0, 3
  s_cselect_b32 s53, 3, 6
  s_cselect_b32 s55, 6, 0
  s_lshl_b32 s57, s57, 13
  s_add_u32 s57, s57, s32
  s_add_u32 s58, s57, 0x3000
  s_lshl_b32 s53, s53, 13
  s_add_u32 s53, s53, s32
  s_add_u32 s54, s53, 0x3000
  s_lshl_b32 s55, s55, 13
  s_add_u32 s55, s55, s32
  s_add_u32 s56, s55, 0x3000
  v_and_b32_e64 v145, 7, v113
  buffer_load_dwordx4 a[76:79], v202, s[64:67], s43 offen offset:128
  v_lshrrev_b32 v146, 4, v113
  v_lshlrev_b32 v147, 4, v139
  v_and_b32 v141, 1, v113
  v_lshlrev_b32 v141, 4, v141
  v_mov_b32 v127, 0xffff
  v_lshlrev_b32_e64 v127, v141, v127
  v_bfe_u32 v125, v113, 1, 2
  buffer_load_dwordx4 a[80:83], v202, s[64:67], s50 offen
  v_lshlrev_b32 v125, v125, 1
  v_bfe_i32 v56, v125, 0, 1
  v_mov_b32 v60, 0
  v_and_b32 v56, v56, v127
  v_bfe_i32 v57, v125, 1, 1
  v_mov_b32 v61, 0
  v_and_b32 v57, v57, v127
  v_bfe_i32 v58, v125, 2, 1
  v_mov_b32 v62, 0
  v_and_b32 v58, v58, v127
  v_bfe_i32 v59, v125, 3, 1
  v_mov_b32 v63, 0
  v_and_b32 v59, v59, v127
  v_min_u32_e64 v125, 35, v113
  v_mul_u32_u24 v125, 0x190, v125
  ds_write_b128 v125, v[60:63] offset:50304
  s_lshl_b32 s32, s44, 7
  v_lshrrev_b32 v142, 3, v113
  buffer_load_dwordx4 a[84:87], v202, s[64:67], s50 offen offset:128
  v_mul_u32_u24 v142, 0x190, v142
  v_lshl_add_u32 v142, v145, 4, v142
  v_add_u32 v142, s32, v142
  v_lshrrev_b32 v143, 3, v120
  v_mul_u32_u24 v143, 0x190, v143
  v_lshl_add_u32 v143, v145, 4, v143
  v_add_u32_e64 v143, s32, v143
  v_lshl_add_u32 v144, v120, 2, s32
  v_sub_u32_e64 v125, v146, v116
  v_lshl_add_u32 v126, v114, 2, v117
  v_lshl_add_u32 v126, v125, 3, v126
  v_min_u32 v126, 24, v126
  v_lshlrev_b32 v126, 4, v126
  v_add_u32 v3, 0xc300, v126
  v_lshlrev_b32_e64 v148, 2, v115
  v_lshl_add_u32 v148, v114, 1, v148
  v_bfe_u32 v126, v113, 1, 1
  buffer_load_dwordx4 a[88:91], v204, s[68:71], s51 offen
  v_add_u32 v148, v148, v126
  v_xor_b32 v126, v116, v139
  v_lshl_add_u32 v148, v126, 3, v148
  v_lshlrev_b32 v148, v148, 1
  v_mov_b32 v126, 0x3f80
  v_lshlrev_b32_e64 v126, v141, v126
  v_mov_b32 v125, 0xbf80
  v_lshlrev_b32_e64 v125, v141, v125
  v_bfe_i32 v160, v148, 0, 1
  v_and_b32 v240, v160, v126
  v_and_b32 v184, v160, v125
  v_bfe_i32 v161, v148, 1, 1
  v_and_b32 v241, v161, v126
  v_and_b32 v185, v161, v125
  v_bfe_i32 v162, v148, 2, 1
  v_and_b32 v242, v162, v126
  v_and_b32 v186, v162, v125
  v_bfe_i32 v163, v148, 3, 1
  buffer_load_dwordx4 a[92:95], v204, s[68:71], s51 offen offset:128
  v_and_b32 v243, v163, v126
  v_and_b32 v187, v163, v125
  v_bfe_i32 v164, v148, 4, 1
  v_and_b32 v244, v164, v126
  v_and_b32 v188, v164, v125
  v_bfe_i32 v165, v148, 5, 1
  v_and_b32 v245, v165, v126
  v_and_b32 v189, v165, v125
  v_bfe_i32 v166, v148, 6, 1
  v_and_b32 v246, v166, v126
  v_and_b32 v190, v166, v125
  v_bfe_i32 v167, v148, 7, 1
  v_and_b32 v247, v167, v126
  v_and_b32 v191, v167, v125
  s_mov_b32 s22, 0x3eeff558
  s_mov_b32 s24, 0x3c2aaaab
  s_mov_b32 s25, 0x3727c5ac
  s_mov_b32 s20, 0x409d30fc
  s_mov_b32 s21, 0x409d30fc
  s_mov_b32 s23, 0x3eeff558
  s_mov_b32 s12, 0
  s_mov_b32 s13, -1
  s_add_u32 s29, s59, 0x77000
  s_add_u32 s52, s59, 0xa7000
  v_mul_u32_u24 v149, 0xc0, v145
  buffer_load_dwordx4 a[0:3], v203, s[64:67], s40 offen
  v_add_u32_e64 v127, s15, v149
  v_lshl_add_u32 v150, v114, 1, v146
  v_lshrrev_b32_e64 v125, 1, v150
  v_mul_u32_u24 v140, 0x4100, v125
  v_and_b32_e64 v125, 1, v125
  v_lshl_add_u32 v140, v125, 5, v140
  v_and_b32_e64 v125, 1, v150
  v_mul_u32_u24 v125, 0x790, v125
  v_add3_u32 v4, v140, v125, v127
  v_lshl_add_u32 v151, v114, 1, v115
  buffer_load_dwordx4 a[4:7], v203, s[64:67], s40 offen offset:128
  s_add_u32 s40, s40, 0x1800
  v_add_u32_e64 v150, 1, v151
  v_add_u32 v127, 0xc0, v127
  v_add_u32 v127, v127, v147
  v_lshrrev_b32 v125, 1, v150
  v_mul_u32_u24 v140, 0x4100, v125
  v_and_b32_e64 v125, 1, v125
  v_lshl_add_u32 v140, v125, 5, v140
  v_and_b32_e64 v125, 1, v150
  v_mul_u32_u24 v125, 0x790, v125
  v_add3_u32 v5, v140, v125, v127
  v_mul_u32_u24 v125, 0x18000, v151
  v_add3_u32 v10, v125, v147, v149
  s_sub_u32 s32, s3, 0xf40
  v_add_u32_e64 v10, s32, v10
  v_add_u32 v2, 0xfb40, v147
  v_add_u32 v0, 0x10000, v118
  v_add_u32 v1, 0x20000, v118
  v_and_b32_e64 v125, 15, v113
  buffer_load_dwordx4 a[8:11], v203, s[64:67], s40 offen
  v_lshlrev_b32 v125, 7, v125
  v_mul_u32_u24 v126, 0x18000, v146
  s_sub_u32 s32, s3, 64
  v_add3_u32 v248, v125, v126, s32
  v_mov_b32 v250, 0x3ef00000
  s_add_u32 s32, s14, 0x16000
  v_add_u32_e64 v253, s32, v118
  v_bfe_u32 v125, v122, 2, 2
  v_xor_b32_e64 v125, v125, v139
  v_lshl_add_u32 v125, v125, 4, s32
  v_mul_u32_u24 v126, 0xc0, v122
  v_add_u32 v251, v125, v126
  v_xor_b32 v252, 32, v251
  s_add_u32 s30, s15, 32
  s_add_u32 s31, s15, 0x4100
  s_mov_b32 s34, s59
  s_mov_b32 s28, 0x80000000
  s_add_u32 s33, s15, 0x8200
  buffer_load_dwordx4 a[12:15], v203, s[64:67], s40 offen offset:128
  buffer_load_dwordx4 a[16:19], v203, s[64:67], s41 offen
  buffer_load_dwordx4 a[20:23], v203, s[64:67], s41 offen offset:128
  s_waitcnt vmcnt(25)
  v_lshl_or_b32 v129, v129, 16, v129
  v_and_b32 v16, v56, v129
  v_and_b32 v17, v57, v129
  v_and_b32 v18, v58, v129
  v_and_b32 v19, v59, v129
  ds_write_b128 v142, v[16:19] offset:49920
  s_waitcnt vmcnt(24)
  v_lshl_or_b32 v130, v130, 16, v130
  v_and_b32 v20, v56, v130
  v_and_b32 v21, v57, v130
  v_and_b32 v22, v58, v130
  v_and_b32 v23, v59, v130
  ds_write_b128 v142, v[20:23] offset:53120
  s_waitcnt vmcnt(23)
  v_lshl_or_b32 v131, v131, 16, v131
  v_and_b32 v24, v56, v131
  v_and_b32 v25, v57, v131
  v_and_b32 v26, v58, v131
  v_and_b32 v27, v59, v131
  ds_write_b128 v142, v[24:27] offset:56320
  s_waitcnt vmcnt(22)
  v_lshl_or_b32 v132, v132, 16, v132
  v_and_b32 v28, v56, v132
  v_and_b32 v29, v57, v132
  v_and_b32 v30, v58, v132
  v_and_b32 v31, v59, v132
  ds_write_b128 v142, v[28:31] offset:59520
  s_waitcnt vmcnt(21)
  v_lshl_or_b32 v133, v133, 16, v133
  v_and_b32 v16, v56, v133
  v_and_b32 v17, v57, v133
  v_and_b32 v18, v58, v133
  v_and_b32_e64 v19, v59, v133
  ds_write_b128 v143, v[16:19] offset:62720
  s_waitcnt vmcnt(20)
  v_lshlrev_b32 v137, 16, v137
  s_waitcnt vmcnt(19)
  v_lshlrev_b32 v138, 16, v138
  v_mul_f32 v138, v137, v138
  s_waitcnt vmcnt(18)
  v_lshlrev_b32 v134, v141, v134
  s_waitcnt vmcnt(17)
  v_lshlrev_b32 v135, v141, v135
  s_waitcnt vmcnt(16)
  v_lshlrev_b32_e64 v136, v141, v136
  ds_write_b32 v144, v138 offset:64320
  s_waitcnt lgkmcnt(0)
  s_barrier
  ds_read_b128 a[96:99], v3
  ds_read_b128 a[100:103], v3 offset:4800
  ds_read_b128 a[104:107], v3 offset:9600
  ds_read_b128 a[108:111], v3 offset:400
  ds_read_b128 a[112:115], v3 offset:5200
  ds_read_b128 a[116:119], v3 offset:10000
  v_and_b32 v125, v160, v134
  v_and_b32 v126, v161, v134
  v_and_b32_e64 v127, v162, v134
  buffer_load_dwordx4 a[24:27], v203, s[64:67], s42 offen
  v_and_b32_e64 v140, v163, v134
  v_accvgpr_write_b32 a192, v125
  v_accvgpr_write_b32 a193, v126
  v_accvgpr_write_b32 a194, v127
  v_accvgpr_write_b32 a195, v140
  ds_read_b128 a[120:123], v3 offset:800
  ds_read_b128 a[124:127], v3 offset:5600
  ds_read_b128 a[128:131], v3 offset:10400
  ds_read_b128 a[132:135], v3 offset:1200
  ds_read_b128 a[136:139], v3 offset:6000
  ds_read_b128 a[140:143], v3 offset:10800
  buffer_load_dwordx4 a[28:31], v203, s[64:67], s42 offen offset:128
  s_add_u32 s42, s42, 0x1800
  v_and_b32 v125, v164, v134
  v_and_b32 v126, v165, v134
  v_and_b32 v127, v166, v134
  v_and_b32 v140, v167, v134
  v_accvgpr_write_b32 a196, v125
  v_accvgpr_write_b32 a197, v126
  v_accvgpr_write_b32 a198, v127
  v_accvgpr_write_b32 a199, v140
  ds_read_b128 a[144:147], v3 offset:1600
  ds_read_b128 a[148:151], v3 offset:6400
  buffer_load_dwordx4 a[32:35], v203, s[64:67], s42 offen
  ds_read_b128 a[152:155], v3 offset:11200
  ds_read_b128 a[156:159], v3 offset:2000
  ds_read_b128 a[160:163], v3 offset:6800
  ds_read_b128 a[164:167], v3 offset:11600
  v_and_b32 v125, v160, v135
  v_and_b32 v126, v161, v135
  v_and_b32 v127, v162, v135
  v_and_b32 v140, v163, v135
  v_accvgpr_write_b32 a200, v125
  v_accvgpr_write_b32 a201, v126
  v_accvgpr_write_b32 a202, v127
  buffer_load_dwordx4 a[36:39], v203, s[64:67], s42 offen offset:128
  s_add_u32 s42, s42, 0x1800
  v_accvgpr_write_b32 a203, v140
  ds_read_b128 a[240:243], v3 offset:2400
  ds_read_b128 a[244:247], v3 offset:7200
  ds_read_b128 a[248:251], v3 offset:12000
  ds_read_b128 a[168:171], v3 offset:2800
  ds_read_b128 a[172:175], v3 offset:7600
  ds_read_b128 a[176:179], v3 offset:12400
  v_and_b32 v125, v164, v135
  v_and_b32 v126, v165, v135
  v_and_b32 v127, v166, v135
  v_and_b32 v140, v167, v135
  buffer_load_dwordx4 a[40:43], v203, s[64:67], s42 offen
  v_accvgpr_write_b32 a204, v125
  v_accvgpr_write_b32 a205, v126
  v_accvgpr_write_b32 a206, v127
  v_accvgpr_write_b32 a207, v140
  ds_read_b128 a[252:255], v3 offset:3200
  ds_read_b128 a[180:183], v3 offset:8000
  ds_read_b128 a[184:187], v3 offset:12800
  ds_read_b128 a[188:191], v3 offset:3600
  ds_read_b128 a[216:219], v3 offset:8400
  ds_read_b128 a[220:223], v3 offset:13200
  buffer_load_dwordx4 a[44:47], v203, s[64:67], s42 offen offset:128
  s_add_u32 s42, s42, 0x1800
  v_and_b32 v125, v160, v136
  v_and_b32 v126, v161, v136
  v_and_b32 v127, v162, v136
  v_and_b32 v140, v163, v136
  v_accvgpr_write_b32 a208, v125
  v_accvgpr_write_b32 a209, v126
  v_accvgpr_write_b32 a210, v127
  v_accvgpr_write_b32 a211, v140
  ds_read_b128 a[224:227], v3 offset:4000
  ds_read_b128 a[228:231], v3 offset:8800
  ds_read_b128 a[232:235], v3 offset:13600
  buffer_load_dwordx4 a[48:51], v203, s[64:67], s42 offen
  ds_read_b128 a[236:239], v3 offset:4400
  ds_read_b128 v[208:211], v3 offset:9200
  ds_read_b128 v[212:215], v3 offset:14000
  v_and_b32 v125, v164, v136
  v_and_b32 v126, v165, v136
  v_and_b32 v127, v166, v136
  v_and_b32 v140, v167, v136
  v_accvgpr_write_b32 a212, v125
  v_accvgpr_write_b32 a213, v126
  v_accvgpr_write_b32 a214, v127
  buffer_load_dwordx4 a[52:55], v203, s[64:67], s42 offen offset:128
  s_add_u32 s42, s42, 0x1800
  v_accvgpr_write_b32 a215, v140
  s_waitcnt vmcnt(19)
  v_mfma_f32_32x32x16_bf16 v[16:31], a[72:75], v[184:187], 0
  buffer_load_dwordx4 a[56:59], v203, s[64:67], s42 offen
  s_waitcnt vmcnt(19)
  v_mfma_f32_32x32x16_bf16 v[16:31], a[76:79], v[188:191], v[16:31]
  s_waitcnt vmcnt(18)
  v_mfma_f32_32x32x16_bf16 v[32:47], a[80:83], v[184:187], 0
  buffer_load_dwordx4 a[60:63], v203, s[64:67], s42 offen offset:128
  s_add_u32 s42, s42, 0x1800
  s_waitcnt vmcnt(15)
  v_mfma_f32_32x32x16_bf16 v[48:63], a[0:3], v[240:243], v[16:31]
  buffer_load_dwordx4 a[64:67], v203, s[64:67], s42 offen
  v_mfma_f32_32x32x16_bf16 v[32:47], a[84:87], v[188:191], v[32:47]
  s_waitcnt vmcnt(15)
  v_mfma_f32_32x32x16_bf16 v[48:63], a[4:7], v[244:247], v[48:63]
  buffer_load_dwordx4 a[68:71], v203, s[64:67], s42 offen offset:128
  s_waitcnt vmcnt(15)
  v_mfma_f32_32x32x16_bf16 v[216:231], a[8:11], v[240:243], v[16:31]
  s_add_u32 m0, s15, 0x8200
  s_nop 0
  buffer_load_dwordx4 v6, s[4:7], s49 offen lds
  s_waitcnt vmcnt(15)
  v_mfma_f32_32x32x16_bf16 v[216:231], a[12:15], v[244:247], v[216:231]
  buffer_load_dwordx4 v7, s[4:7], s49 offen offset:1024 lds
  s_nop 2
  v_cvt_pk_bf16_f32 v64, v48, v52
  v_cvt_pk_bf16_f32 v65, v56, v60
  v_cvt_pk_bf16_f32 v68, v49, v53
  v_cvt_pk_bf16_f32 v69, v57, v61
  s_waitcnt vmcnt(15)
  v_mfma_f32_32x32x16_bf16 v[96:111], a[16:19], v[240:243], v[16:31]
  buffer_load_dwordx4 v8, s[4:7], s49 offen offset:2048 lds
  v_cvt_pk_bf16_f32 v72, v50, v54
  v_cvt_pk_bf16_f32 v73, v58, v62
  v_cvt_pk_bf16_f32 v76, v51, v55
  v_cvt_pk_bf16_f32 v77, v59, v63
  s_waitcnt vmcnt(15)
  v_mfma_f32_32x32x16_bf16 v[96:111], a[20:23], v[244:247], v[96:111]
  buffer_load_dwordx4 v9, s[4:7], s49 offen offset:3072 lds
  v_cvt_pk_bf16_f32 v66, v216, v220
  v_cvt_pk_bf16_f32 v67, v224, v228
  v_cvt_pk_bf16_f32 v70, v217, v221
  v_cvt_pk_bf16_f32 v71, v225, v229
  ds_write_b128 v195, v[64:67]
  s_waitcnt vmcnt(15)
  v_mfma_f32_32x32x16_bf16 v[48:63], a[24:27], v[240:243], v[32:47]
  s_add_u32 m0, s15, 0
  s_nop 0
  buffer_load_dwordx4 v198, s[4:7], 0 offen lds
  ds_write_b128 v195, v[68:71] offset:6144
  v_cvt_pk_bf16_f32 v74, v218, v222
  v_cvt_pk_bf16_f32 v75, v226, v230
  v_cvt_pk_bf16_f32 v78, v219, v223
  v_cvt_pk_bf16_f32 v79, v227, v231
  s_waitcnt vmcnt(15)
  v_mfma_f32_32x32x16_bf16 v[48:63], a[28:31], v[244:247], v[48:63]
  s_add_u32 m0, s15, 0x400
  s_nop 0
  buffer_load_dwordx4 v199, s[4:7], 0 offen lds
  ds_write_b128 v195, v[72:75] offset:12288
  v_cvt_pk_bf16_f32 v80, v96, v100
  v_cvt_pk_bf16_f32 v81, v104, v108
  v_cvt_pk_bf16_f32 v84, v97, v101
  v_cvt_pk_bf16_f32 v85, v105, v109
  s_waitcnt vmcnt(15)
  v_mfma_f32_32x32x16_bf16 v[216:231], a[32:35], v[240:243], v[32:47]
  s_add_u32 m0, s15, 0x800
  s_nop 0
  buffer_load_dwordx4 v200, s[4:7], 0 offen lds
  ds_write_b128 v195, v[76:79] offset:18432
  v_cvt_pk_bf16_f32 v88, v98, v102
  v_cvt_pk_bf16_f32 v89, v106, v110
  v_cvt_pk_bf16_f32 v92, v99, v103
  v_cvt_pk_bf16_f32 v93, v107, v111
  s_waitcnt vmcnt(15)
  v_mfma_f32_32x32x16_bf16 v[216:231], a[36:39], v[244:247], v[216:231]
  s_add_u32 m0, s15, 0xc00
  s_nop 0
  buffer_load_dwordx4 v201, s[4:7], 0 offen lds
  ds_write_b64 v196, v[80:81]
  ds_write_b64 v196, v[84:85] offset:6144
  v_cvt_pk_bf16_f32 v64, v48, v52
  v_cvt_pk_bf16_f32 v65, v56, v60
  v_cvt_pk_bf16_f32 v68, v49, v53
  v_cvt_pk_bf16_f32 v69, v57, v61
  s_waitcnt vmcnt(15)
  v_mfma_f32_32x32x16_bf16 v[96:111], a[40:43], v[240:243], v[32:47]
  s_add_u32 m0, s14, 0x22000
  s_nop 0
  buffer_load_dwordx4 v254, s[72:75], s57 offen lds
  ds_write_b64 v196, v[88:89] offset:12288
  ds_write_b64 v196, v[92:93] offset:18432
  v_cvt_pk_bf16_f32 v72, v50, v54
  v_cvt_pk_bf16_f32 v73, v58, v62
  v_cvt_pk_bf16_f32 v76, v51, v55
  v_cvt_pk_bf16_f32 v77, v59, v63
  s_waitcnt vmcnt(15)
  v_mfma_f32_32x32x16_bf16 v[96:111], a[44:47], v[244:247], v[96:111]
  buffer_load_dwordx4 v255, s[72:75], s57 offen offset:1024 lds
  v_cvt_pk_bf16_f32 v66, v216, v220
  v_cvt_pk_bf16_f32 v67, v224, v228
  v_cvt_pk_bf16_f32 v70, v217, v221
  v_cvt_pk_bf16_f32 v71, v225, v229
  ds_write_b128 v197, v[64:67]
  s_waitcnt vmcnt(15)
  v_mfma_f32_32x32x16_bf16 v[48:63], a[48:51], v[240:243], v[32:47]
  buffer_load_dwordx4 v194, s[72:75], s57 offen offset:2048 lds
  ds_write_b128 v197, v[68:71] offset:6144
  v_cvt_pk_bf16_f32 v74, v218, v222
  v_cvt_pk_bf16_f32 v75, v226, v230
  v_cvt_pk_bf16_f32 v78, v219, v223
  v_cvt_pk_bf16_f32 v79, v227, v231
  s_waitcnt vmcnt(15)
  v_mfma_f32_32x32x16_bf16 v[48:63], a[52:55], v[244:247], v[48:63]
  s_add_u32 m0, s14, 0x22c00
  s_nop 0
  buffer_load_dwordx4 v254, s[72:75], s58 offen lds
  ds_write_b128 v197, v[72:75] offset:12288
  v_cvt_pk_bf16_f32 v80, v96, v100
  v_cvt_pk_bf16_f32 v81, v104, v108
  v_cvt_pk_bf16_f32 v84, v97, v101
  v_cvt_pk_bf16_f32 v85, v105, v109
  s_nop 0
  s_waitcnt vmcnt(15)
  v_mfma_f32_32x32x16_bf16 v[216:231], a[56:59], v[240:243], v[32:47]
  buffer_load_dwordx4 v255, s[72:75], s58 offen offset:1024 lds
  ds_write_b128 v197, v[76:79] offset:18432
  v_cvt_pk_bf16_f32 v88, v98, v102
  v_cvt_pk_bf16_f32 v89, v106, v110
  v_cvt_pk_bf16_f32 v92, v99, v103
  v_cvt_pk_bf16_f32 v93, v107, v111
  v_mfma_f32_32x32x16_bf16 v[96:111], a[88:91], v[240:243], v[32:47]
  s_nop 0
  s_waitcnt vmcnt(15)
  v_mfma_f32_32x32x16_bf16 v[216:231], a[60:63], v[244:247], v[216:231]
  buffer_load_dwordx4 v194, s[72:75], s58 offen offset:2048 lds
  v_cvt_pk_bf16_f32 v82, v48, v52
  v_cvt_pk_bf16_f32 v83, v56, v60
  v_cvt_pk_bf16_f32 v86, v49, v53
  v_cvt_pk_bf16_f32 v87, v57, v61
  ds_write_b128 v197, v[80:83] offset:1024
  v_mfma_f32_32x32x16_bf16 v[96:111], a[92:95], v[244:247], v[96:111]
  s_waitcnt vmcnt(15)
  v_mfma_f32_32x32x16_bf16 v[96:111], a[64:67], v[240:243], v[96:111]
  ds_write_b128 v197, v[84:87] offset:7168
  v_cvt_pk_bf16_f32 v90, v50, v54
  v_cvt_pk_bf16_f32 v91, v58, v62
  v_cvt_pk_bf16_f32 v94, v51, v55
  v_cvt_pk_bf16_f32 v95, v59, v63
  s_waitcnt vmcnt(14)
  v_mfma_f32_32x32x16_bf16 v[96:111], a[68:71], v[244:247], v[96:111]
  ds_write_b128 v197, v[88:91] offset:13312
  v_cvt_pk_bf16_f32 v64, v216, v220
  v_cvt_pk_bf16_f32 v65, v224, v228
  v_cvt_pk_bf16_f32 v68, v217, v221
  v_cvt_pk_bf16_f32 v69, v225, v229
  ds_write_b128 v197, v[92:95] offset:19456
  v_cvt_pk_bf16_f32 v72, v218, v222
  v_cvt_pk_bf16_f32 v73, v226, v230
  v_cvt_pk_bf16_f32 v76, v219, v223
  v_cvt_pk_bf16_f32 v77, v227, v231
  s_nop 0
  s_nop 1
  v_cvt_pk_bf16_f32 v66, v96, v100
  v_cvt_pk_bf16_f32 v67, v104, v108
  v_cvt_pk_bf16_f32 v70, v97, v101
  v_cvt_pk_bf16_f32 v71, v105, v109
  ds_write_b128 v197, v[64:67] offset:2048
  ds_write_b128 v197, v[68:71] offset:8192
  v_cvt_pk_bf16_f32 v74, v98, v102
  v_cvt_pk_bf16_f32 v75, v106, v110
  v_cvt_pk_bf16_f32 v78, v99, v103
  v_cvt_pk_bf16_f32 v79, v107, v111
  ds_write_b128 v197, v[72:75] offset:14336
  ds_write_b128 v197, v[76:79] offset:20480
  s_waitcnt lgkmcnt(0)
  s_barrier
  ds_read_b128 a[0:3], v0 offset:24576
  ds_read_b128 a[4:7], v0 offset:25600
  ds_read_b128 a[8:11], v0 offset:26624
  ds_read_b128 a[12:15], v0 offset:27648
  ds_read_b128 a[16:19], v0 offset:28672
  ds_read_b128 a[20:23], v0 offset:29696
  ds_read_b128 a[24:27], v0 offset:30720
  ds_read_b128 a[28:31], v0 offset:31744
  ds_read_b128 a[32:35], v0 offset:32768
  ds_read_b128 a[36:39], v0 offset:33792
  ds_read_b128 a[40:43], v0 offset:34816
  ds_read_b128 a[44:47], v0 offset:35840
  ds_read_b128 a[48:51], v0 offset:36864
  ds_read_b128 a[52:55], v0 offset:37888
  ds_read_b128 a[56:59], v0 offset:38912
  ds_read_b128 a[60:63], v0 offset:39936
  ds_read_b128 a[64:67], v0 offset:40960
  ds_read_b128 a[68:71], v0 offset:41984
  ds_read_b128 a[72:75], v0 offset:43008
  ds_read_b128 a[76:79], v0 offset:44032
  ds_read_b128 a[80:83], v0 offset:45056
  ds_read_b128 a[84:87], v0 offset:46080
  ds_read_b128 a[88:91], v0 offset:47104
  ds_read_b128 a[92:95], v0 offset:48128
  s_nop 0
  s_waitcnt vmcnt(6)
  ds_read_b128 v[216:219], v4
  ds_read_b128 v[220:223], v4 offset:16
  ds_read_b128 v[224:227], v4 offset:192
  ds_read_b128 v[228:231], v4 offset:208
  ds_read_b128 v[232:235], v4 offset:384
  ds_read_b128 v[236:239], v4 offset:400
  ds_read_b128 v[160:163], v4 offset:32
  ds_read_b128 v[164:167], v4 offset:48
  ds_read_b128 v[168:171], v4 offset:224
  ds_read_b128 v[172:175], v4 offset:240
  ds_read_b128 v[176:179], v4 offset:416
  s_waitcnt lgkmcnt(10)
  v_mfma_f32_16x16x32_bf16 v[112:115], a[96:99], v[216:219], 0
  s_waitcnt lgkmcnt(9)
  ds_read_b128 v[180:183], v4 offset:432
  v_mfma_f32_16x16x32_bf16 v[116:119], a[108:111], v[220:223], 0
  s_waitcnt lgkmcnt(9)
  ds_read_b128 v[216:219], v4 offset:64
  v_mfma_f32_16x16x32_bf16 v[112:115], a[100:103], v[224:227], v[112:115]
  s_waitcnt lgkmcnt(9)
  ds_read_b128 v[220:223], v4 offset:80
  v_mfma_f32_16x16x32_bf16 v[116:119], a[112:115], v[228:231], v[116:119]
  s_waitcnt lgkmcnt(9)
  ds_read_b128 v[224:227], v4 offset:256
  v_mfma_f32_16x16x32_bf16 v[112:115], a[104:107], v[232:235], v[112:115]
  s_waitcnt lgkmcnt(9)
  ds_read_b128 v[228:231], v4 offset:272
  v_mfma_f32_16x16x32_bf16 v[116:119], a[116:119], v[236:239], v[116:119]
  s_waitcnt lgkmcnt(9)
  ds_read_b128 v[232:235], v4 offset:448
  v_mfma_f32_16x16x32_bf16 v[120:123], a[120:123], v[160:163], 0
  s_waitcnt lgkmcnt(9)
  ds_read_b128 v[236:239], v4 offset:464
  v_mfma_f32_16x16x32_bf16 v[124:127], a[132:135], v[164:167], 0
  s_waitcnt lgkmcnt(9)
  ds_read_b128 v[160:163], v4 offset:96
  v_mfma_f32_16x16x32_bf16 v[120:123], a[124:127], v[168:171], v[120:123]
  s_waitcnt lgkmcnt(9)
  ds_read_b128 v[164:167], v4 offset:112
  v_mfma_f32_16x16x32_bf16 v[124:127], a[136:139], v[172:175], v[124:127]
  s_waitcnt lgkmcnt(9)
  ds_read_b128 v[168:171], v4 offset:288
  v_mfma_f32_16x16x32_bf16 v[120:123], a[128:131], v[176:179], v[120:123]
  s_waitcnt lgkmcnt(9)
  ds_read_b128 v[172:175], v4 offset:304
  v_mfma_f32_16x16x32_bf16 v[124:127], a[140:143], v[180:183], v[124:127]
  s_waitcnt lgkmcnt(9)
  ds_read_b128 v[176:179], v4 offset:480
  v_mfma_f32_16x16x32_bf16 v[128:131], a[144:147], v[216:219], 0
  s_waitcnt lgkmcnt(9)
  ds_read_b128 v[180:183], v4 offset:496
  v_mfma_f32_16x16x32_bf16 v[132:135], a[156:159], v[220:223], 0
  s_waitcnt lgkmcnt(9)
  ds_read_b128 v[216:219], v4 offset:128
  v_mfma_f32_16x16x32_bf16 v[128:131], a[148:151], v[224:227], v[128:131]
  s_waitcnt lgkmcnt(9)
  ds_read_b128 v[220:223], v4 offset:144
  v_mfma_f32_16x16x32_bf16 v[132:135], a[160:163], v[228:231], v[132:135]
  s_waitcnt lgkmcnt(9)
  ds_read_b128 v[224:227], v4 offset:320
  v_mfma_f32_16x16x32_bf16 v[128:131], a[152:155], v[232:235], v[128:131]
  s_waitcnt lgkmcnt(9)
  ds_read_b128 v[228:231], v4 offset:336
  v_mfma_f32_16x16x32_bf16 v[132:135], a[164:167], v[236:239], v[132:135]
  s_waitcnt lgkmcnt(9)
  ds_read_b128 v[232:235], v4 offset:512
  v_mfma_f32_16x16x32_bf16 v[136:139], a[240:243], v[160:163], 0
  s_waitcnt lgkmcnt(9)
  ds_read_b128 v[236:239], v4 offset:528
  v_mfma_f32_16x16x32_bf16 v[140:143], a[168:171], v[164:167], 0
  s_waitcnt lgkmcnt(9)
  ds_read_b128 v[160:163], v4 offset:160
  v_mfma_f32_16x16x32_bf16 v[136:139], a[244:247], v[168:171], v[136:139]
  s_waitcnt lgkmcnt(9)
  ds_read_b128 v[164:167], v4 offset:176
  v_mfma_f32_16x16x32_bf16 v[140:143], a[172:175], v[172:175], v[140:143]
  s_waitcnt lgkmcnt(9)
  ds_read_b128 v[168:171], v4 offset:352
  v_mfma_f32_16x16x32_bf16 v[136:139], a[248:251], v[176:179], v[136:139]
  s_waitcnt lgkmcnt(9)
  ds_read_b128 v[172:175], v4 offset:368
  v_mfma_f32_16x16x32_bf16 v[140:143], a[176:179], v[180:183], v[140:143]
  s_waitcnt lgkmcnt(9)
  ds_read_b128 v[176:179], v4 offset:544
  v_mfma_f32_16x16x32_bf16 v[144:147], a[252:255], v[216:219], 0
  s_waitcnt lgkmcnt(9)
  ds_read_b128 v[180:183], v4 offset:560
  v_mfma_f32_16x16x32_bf16 v[148:151], a[188:191], v[220:223], 0
  s_waitcnt lgkmcnt(9)
  v_mfma_f32_16x16x32_bf16 v[144:147], a[180:183], v[224:227], v[144:147]
  s_waitcnt lgkmcnt(8)
  v_mfma_f32_16x16x32_bf16 v[148:151], a[216:219], v[228:231], v[148:151]
  s_waitcnt lgkmcnt(7)
  v_mfma_f32_16x16x32_bf16 v[144:147], a[184:187], v[232:235], v[144:147]
  s_waitcnt lgkmcnt(6)
  v_mfma_f32_16x16x32_bf16 v[148:151], a[220:223], v[236:239], v[148:151]
  s_waitcnt lgkmcnt(5)
  v_mfma_f32_16x16x32_bf16 v[152:155], a[224:227], v[160:163], 0
  s_waitcnt lgkmcnt(4)
  v_mfma_f32_16x16x32_bf16 v[156:159], a[236:239], v[164:167], 0
  s_waitcnt lgkmcnt(3)
  v_mfma_f32_16x16x32_bf16 v[152:155], a[228:231], v[168:171], v[152:155]
  s_waitcnt lgkmcnt(2)
  v_mfma_f32_16x16x32_bf16 v[156:159], v[208:211], v[172:175], v[156:159]
  s_waitcnt lgkmcnt(1)
  v_mfma_f32_16x16x32_bf16 v[152:155], a[232:235], v[176:179], v[152:155]
  s_waitcnt lgkmcnt(0)
  v_mfma_f32_16x16x32_bf16 v[156:159], v[212:215], v[180:183], v[156:159]
  buffer_load_dword v249, v248, s[4:7], s29 offen
  v_pk_add_f32 v[12:13], v[112:113], v[114:115]
  v_pk_mul_f32 v[14:15], v[112:113], v[112:113]
  v_pk_fma_f32 v[14:15], v[114:115], v[114:115], v[14:15]
  v_pk_add_f32 v[12:13], v[12:13], v[116:117]
  v_pk_fma_f32 v[14:15], v[116:117], v[116:117], v[14:15]
  v_pk_add_f32 v[12:13], v[12:13], v[118:119]
  v_pk_fma_f32 v[14:15], v[118:119], v[118:119], v[14:15]
  v_pk_add_f32 v[12:13], v[12:13], v[120:121]
  v_pk_fma_f32 v[14:15], v[120:121], v[120:121], v[14:15]
  v_pk_add_f32 v[12:13], v[12:13], v[122:123]
  v_pk_fma_f32 v[14:15], v[122:123], v[122:123], v[14:15]
  v_pk_add_f32 v[12:13], v[12:13], v[124:125]
  ds_read_b128 v[216:219], v0 offset:18432
  ds_read_b128 v[220:223], v0 offset:19456
  ds_read_b128 v[224:227], v0 offset:20480
  ds_read_b128 v[228:231], v0 offset:21504
  v_pk_fma_f32 v[14:15], v[124:125], v[124:125], v[14:15]
  v_pk_add_f32 v[12:13], v[12:13], v[126:127]
  v_pk_fma_f32 v[14:15], v[126:127], v[126:127], v[14:15]
  v_pk_add_f32 v[12:13], v[12:13], v[128:129]
  v_pk_fma_f32 v[14:15], v[128:129], v[128:129], v[14:15]
  v_pk_add_f32 v[12:13], v[12:13], v[130:131]
  v_pk_fma_f32 v[14:15], v[130:131], v[130:131], v[14:15]
  v_pk_add_f32 v[12:13], v[12:13], v[132:133]
  v_pk_fma_f32 v[14:15], v[132:133], v[132:133], v[14:15]
  v_pk_add_f32 v[12:13], v[12:13], v[134:135]
  v_pk_fma_f32 v[14:15], v[134:135], v[134:135], v[14:15]
  v_pk_add_f32 v[12:13], v[12:13], v[136:137]
  ds_read_b128 v[232:235], v0 offset:22528
  ds_read_b128 v[236:239], v0 offset:23552
  ds_read_b128 a[96:99], v0 offset:49152
  ds_read_b128 a[100:103], v0 offset:50176
  v_pk_fma_f32 v[14:15], v[136:137], v[136:137], v[14:15]
  v_pk_add_f32 v[12:13], v[12:13], v[138:139]
  v_pk_fma_f32 v[14:15], v[138:139], v[138:139], v[14:15]
  v_pk_add_f32 v[12:13], v[12:13], v[140:141]
  v_pk_fma_f32 v[14:15], v[140:141], v[140:141], v[14:15]
  v_pk_add_f32 v[12:13], v[12:13], v[142:143]
  v_pk_fma_f32 v[14:15], v[142:143], v[142:143], v[14:15]
  v_pk_add_f32 v[12:13], v[12:13], v[144:145]
  v_pk_fma_f32 v[14:15], v[144:145], v[144:145], v[14:15]
  v_pk_add_f32 v[12:13], v[12:13], v[146:147]
  v_pk_fma_f32 v[14:15], v[146:147], v[146:147], v[14:15]
  v_pk_add_f32 v[12:13], v[12:13], v[148:149]
  ds_read_b128 a[104:107], v0 offset:51200
  ds_read_b128 a[108:111], v0 offset:52224
  ds_read_b128 a[112:115], v0 offset:53248
  ds_read_b128 a[116:119], v0 offset:54272
  v_pk_fma_f32 v[14:15], v[148:149], v[148:149], v[14:15]
  v_pk_add_f32 v[12:13], v[12:13], v[150:151]
  v_pk_fma_f32 v[14:15], v[150:151], v[150:151], v[14:15]
  v_pk_add_f32 v[12:13], v[12:13], v[152:153]
  v_pk_fma_f32 v[14:15], v[152:153], v[152:153], v[14:15]
  v_pk_add_f32 v[12:13], v[12:13], v[154:155]
  v_pk_fma_f32 v[14:15], v[154:155], v[154:155], v[14:15]
  v_pk_add_f32 v[12:13], v[12:13], v[156:157]
  v_pk_fma_f32 v[14:15], v[156:157], v[156:157], v[14:15]
  v_pk_add_f32 v[12:13], v[12:13], v[158:159]
  v_pk_fma_f32 v[14:15], v[158:159], v[158:159], v[14:15]
  v_add_f32_e64 v12, v12, v13
  ds_read_b128 a[120:123], v0 offset:55296
  ds_read_b128 a[124:127], v0 offset:56320
  ds_read_b128 a[128:131], v0 offset:57344
  ds_read_b128 a[132:135], v0 offset:58368
  v_add_f32 v14, v14, v15
  s_nop 1
  v_permlane32_swap_b32 v12, v14
  v_add_f32 v12, v12, v14
  v_mov_b32 v14, v12
  s_nop 1
  v_permlane32_swap_b32 v12, v14
  v_mul_f32 v12, s24, v12
  v_mul_f32_e64 v13, s24, v14
  v_fma_f32 v13, -v12, v12, v13
  v_max_f32 v13, 0, v13
  v_add_f32 v13, s25, v13
  v_rsq_f32 v13, v13
  s_nop 0
  v_mul_f32_e64 v14, s22, v13
  ds_read_b128 a[136:139], v0 offset:59392
  ds_read_b128 a[140:143], v0 offset:60416
  ds_read_b128 a[144:147], v0 offset:61440
  ds_read_b128 a[148:151], v0 offset:62464
  v_mul_f32_e64 v12, -v12, v14
  v_pk_fma_f32 v[112:113], v[112:113], v[14:15], v[12:13] op_sel_hi:[1,0,0]
  v_pk_fma_f32 v[114:115], v[114:115], v[14:15], v[12:13] op_sel_hi:[1,0,0]
  v_pk_fma_f32 v[116:117], v[116:117], v[14:15], v[12:13] op_sel_hi:[1,0,0]
  v_pk_fma_f32 v[118:119], v[118:119], v[14:15], v[12:13] op_sel_hi:[1,0,0]
  v_pk_fma_f32 v[120:121], v[120:121], v[14:15], v[12:13] op_sel_hi:[1,0,0]
  v_pk_fma_f32 v[122:123], v[122:123], v[14:15], v[12:13] op_sel_hi:[1,0,0]
  v_pk_fma_f32 v[124:125], v[124:125], v[14:15], v[12:13] op_sel_hi:[1,0,0]
  v_pk_fma_f32 v[126:127], v[126:127], v[14:15], v[12:13] op_sel_hi:[1,0,0]
  v_pk_fma_f32 v[128:129], v[128:129], v[14:15], v[12:13] op_sel_hi:[1,0,0]
  v_pk_fma_f32 v[130:131], v[130:131], v[14:15], v[12:13] op_sel_hi:[1,0,0]
  v_pk_fma_f32 v[132:133], v[132:133], v[14:15], v[12:13] op_sel_hi:[1,0,0]
  ds_read_b128 a[152:155], v0 offset:63488
  ds_read_b128 a[156:159], v0 offset:64512
  ds_read_b128 a[160:163], v1
  ds_read_b128 a[164:167], v1 offset:1024
  v_pk_fma_f32 v[134:135], v[134:135], v[14:15], v[12:13] op_sel_hi:[1,0,0]
  v_pk_fma_f32 v[136:137], v[136:137], v[14:15], v[12:13] op_sel_hi:[1,0,0]
  v_pk_fma_f32 v[138:139], v[138:139], v[14:15], v[12:13] op_sel_hi:[1,0,0]
  v_pk_fma_f32 v[140:141], v[140:141], v[14:15], v[12:13] op_sel_hi:[1,0,0]
  v_pk_fma_f32 v[142:143], v[142:143], v[14:15], v[12:13] op_sel_hi:[1,0,0]
  v_pk_fma_f32 v[144:145], v[144:145], v[14:15], v[12:13] op_sel_hi:[1,0,0]
  v_pk_fma_f32 v[146:147], v[146:147], v[14:15], v[12:13] op_sel_hi:[1,0,0]
  v_pk_fma_f32 v[148:149], v[148:149], v[14:15], v[12:13] op_sel_hi:[1,0,0]
  v_pk_fma_f32 v[150:151], v[150:151], v[14:15], v[12:13] op_sel_hi:[1,0,0]
  v_pk_fma_f32 v[152:153], v[152:153], v[14:15], v[12:13] op_sel_hi:[1,0,0]
  v_pk_fma_f32 v[154:155], v[154:155], v[14:15], v[12:13] op_sel_hi:[1,0,0]
  v_pk_fma_f32 v[156:157], v[156:157], v[14:15], v[12:13] op_sel_hi:[1,0,0]
  ds_read_b128 a[168:171], v1 offset:2048
  ds_read_b128 a[172:175], v1 offset:3072
  ds_read_b128 a[176:179], v1 offset:4096
  ds_read_b128 a[180:183], v1 offset:5120
  v_pk_fma_f32 v[158:159], v[158:159], v[14:15], v[12:13] op_sel_hi:[1,0,0]
  v_cndmask_b32 v159, v159, v250, s[12:13]
  v_cvt_pk_bf16_f32 v160, v112, v113
  v_cvt_pk_bf16_f32 v161, v114, v115
  v_cvt_pk_bf16_f32 v162, v116, v117
  v_cvt_pk_bf16_f32 v163, v118, v119
  v_cvt_pk_bf16_f32 v164, v120, v121
  v_cvt_pk_bf16_f32 v165, v122, v123
  v_cvt_pk_bf16_f32 v166, v124, v125
  v_cvt_pk_bf16_f32 v167, v126, v127
  v_cvt_pk_bf16_f32 v168, v128, v129
  v_cvt_pk_bf16_f32 v169, v130, v131
  ds_read_b128 a[184:187], v1 offset:6144
  ds_read_b128 a[188:191], v1 offset:7168
  v_cvt_pk_bf16_f32 v170, v132, v133
  v_cvt_pk_bf16_f32 v171, v134, v135
  v_cvt_pk_bf16_f32 v172, v136, v137
  v_cvt_pk_bf16_f32 v173, v138, v139
  v_cvt_pk_bf16_f32 v174, v140, v141
  v_cvt_pk_bf16_f32 v175, v142, v143
  v_cvt_pk_bf16_f32 v176, v144, v145
  v_cvt_pk_bf16_f32 v177, v146, v147
  v_cvt_pk_bf16_f32 v178, v148, v149
  v_cvt_pk_bf16_f32 v179, v150, v151
  v_cvt_pk_bf16_f32 v180, v152, v153
  v_cvt_pk_bf16_f32 v181, v154, v155
  v_cvt_pk_bf16_f32 v182, v156, v157
  v_cvt_pk_bf16_f32 v183, v158, v159
  s_nop 0
  s_waitcnt lgkmcnt(15)
  v_mfma_f32_32x32x16_bf16 v[16:31], v[216:219], v[160:163], 0
  ds_read_b128 v[136:139], v5
  ds_read_b128 v[140:143], v5 offset:32
  ds_read_b128 v[144:147], v5 offset:64
  v_mfma_f32_32x32x16_bf16 v[16:31], v[220:223], v[164:167], v[16:31]
  ds_read_b128 v[148:151], v5 offset:96
  ds_read_b128 v[152:155], v5 offset:128
  ds_read_b128 v[156:159], v5 offset:160
  v_mfma_f32_32x32x16_bf16 v[16:31], v[224:227], v[168:171], v[16:31]
  s_nop 0
  s_waitcnt vmcnt(1)
  ds_read_b128 a[216:219], v251 offset:49152
  ds_read_b128 a[220:223], v252 offset:49152
  v_mfma_f32_32x32x16_bf16 v[16:31], v[228:231], v[172:175], v[16:31]
  ds_read_b128 a[224:227], v251 offset:49216
  ds_read_b128 a[228:231], v252 offset:49216
  ds_read_b128 a[232:235], v251 offset:49280
  v_mfma_f32_32x32x16_bf16 v[16:31], v[232:235], v[176:179], v[16:31]
  ds_read_b128 a[236:239], v252 offset:49280
  v_mfma_f32_32x32x16_bf16 v[16:31], v[236:239], v[180:183], v[16:31]
  s_nop 0
  s_nop 11
  v_pk_fma_f32 v[48:49], v[16:17], v[16:17], s[20:21] neg_lo:[1,0,1] neg_hi:[1,0,1]
  v_pk_fma_f32 v[50:51], v[18:19], v[18:19], s[20:21] neg_lo:[1,0,1] neg_hi:[1,0,1]
  v_pk_fma_f32 v[52:53], v[20:21], v[20:21], s[20:21] neg_lo:[1,0,1] neg_hi:[1,0,1]
  v_pk_fma_f32 v[54:55], v[22:23], v[22:23], s[20:21] neg_lo:[1,0,1] neg_hi:[1,0,1]
  v_pk_fma_f32 v[56:57], v[24:25], v[24:25], s[20:21] neg_lo:[1,0,1] neg_hi:[1,0,1]
  v_pk_fma_f32 v[58:59], v[26:27], v[26:27], s[20:21] neg_lo:[1,0,1] neg_hi:[1,0,1]
  v_pk_fma_f32 v[60:61], v[28:29], v[28:29], s[20:21] neg_lo:[1,0,1] neg_hi:[1,0,1]
  v_pk_fma_f32 v[62:63], v[30:31], v[30:31], s[20:21] neg_lo:[1,0,1] neg_hi:[1,0,1]
  v_pk_mul_f32 v[48:49], v[16:17], v[48:49]
  v_pk_mul_f32 v[50:51], v[18:19], v[50:51]
  v_pk_mul_f32 v[52:53], v[20:21], v[52:53]
  v_pk_mul_f32 v[54:55], v[22:23], v[54:55]
  v_pk_mul_f32 v[56:57], v[24:25], v[56:57]
  v_pk_mul_f32 v[58:59], v[26:27], v[58:59]
  v_pk_mul_f32 v[60:61], v[28:29], v[60:61]
  v_pk_mul_f32 v[62:63], v[30:31], v[62:63]
  s_waitcnt lgkmcnt(5)
  v_mfma_f32_32x32x16_bf16 v[64:79], a[216:219], a[192:195], 0
  s_mov_b32 m0, s30
  v_exp_f32 v48, v48
  v_exp_f32 v49, v49
  v_exp_f32 v50, v50
  v_exp_f32 v51, v51
  v_exp_f32 v52, v52
  s_waitcnt lgkmcnt(4)
  v_mfma_f32_32x32x16_bf16 v[64:79], a[220:223], a[196:199], v[64:79]
  buffer_load_dwordx4 v6, s[4:7], s29 offen lds
  v_exp_f32 v53, v53
  s_waitcnt lgkmcnt(3)
  v_mfma_f32_32x32x16_bf16 v[80:95], a[224:227], a[200:203], 0
  buffer_load_dwordx4 v7, s[4:7], s29 offen offset:1024 lds
  s_waitcnt lgkmcnt(2)
  v_mfma_f32_32x32x16_bf16 v[80:95], a[228:231], a[204:207], v[80:95]
  buffer_load_dwordx4 v8, s[4:7], s29 offen offset:2048 lds
  s_nop 3
  v_cvt_pk_bf16_f32 v64, v64, v65
  v_cvt_pk_bf16_f32 v65, v66, v67
  v_cvt_pk_bf16_f32 v66, v68, v69
  v_cvt_pk_bf16_f32 v67, v70, v71
  ds_write_b128 v253, v[64:67] offset:49152
  v_exp_f32 v54, v54
  v_exp_f32 v55, v55
  v_cvt_pk_bf16_f32 v68, v72, v73
  v_cvt_pk_bf16_f32 v69, v74, v75
  v_cvt_pk_bf16_f32 v70, v76, v77
  s_waitcnt lgkmcnt(2)
  v_mfma_f32_32x32x16_bf16 v[96:111], a[232:235], a[208:211], 0
  buffer_load_dwordx4 v9, s[4:7], s29 offen offset:3072 lds
  v_cvt_pk_bf16_f32 v71, v78, v79
  v_exp_f32 v56, v56
  v_exp_f32 v57, v57
  ds_write_b128 v253, v[68:71] offset:52224
  s_waitcnt lgkmcnt(2)
  v_mfma_f32_32x32x16_bf16 v[96:111], a[236:239], a[212:215], v[96:111]
  v_cvt_pk_bf16_f32 v80, v80, v81
  v_cvt_pk_bf16_f32 v81, v82, v83
  v_cvt_pk_bf16_f32 v82, v84, v85
  v_cvt_pk_bf16_f32 v83, v86, v87
  v_exp_f32 v58, v58
  v_exp_f32 v59, v59
  ds_write_b128 v253, v[80:83] offset:50176
  v_cvt_pk_bf16_f32 v84, v88, v89
  v_cvt_pk_bf16_f32 v85, v90, v91
  v_cvt_pk_bf16_f32 v86, v92, v93
  v_cvt_pk_bf16_f32 v87, v94, v95
  v_exp_f32 v60, v60
  v_exp_f32 v61, v61
  ds_write_b128 v253, v[84:87] offset:53248
  v_cvt_pk_bf16_f32 v96, v96, v97
  v_cvt_pk_bf16_f32 v97, v98, v99
  v_cvt_pk_bf16_f32 v98, v100, v101
  v_cvt_pk_bf16_f32 v99, v102, v103
  v_exp_f32 v62, v62
  v_exp_f32 v63, v63
  v_cvt_pk_bf16_f32 v100, v104, v105
  v_cvt_pk_bf16_f32 v101, v106, v107
  v_cvt_pk_bf16_f32 v102, v108, v109
  v_cvt_pk_bf16_f32 v103, v110, v111
  ds_write_b128 v253, v[96:99] offset:51200
  v_pk_fma_f32 v[48:49], v[48:49], s[22:23], s[22:23]
  v_pk_fma_f32 v[50:51], v[50:51], s[22:23], s[22:23]
  v_pk_fma_f32 v[52:53], v[52:53], s[22:23], s[22:23]
  v_pk_fma_f32 v[54:55], v[54:55], s[22:23], s[22:23]
  v_pk_fma_f32 v[56:57], v[56:57], s[22:23], s[22:23]
  v_pk_fma_f32 v[58:59], v[58:59], s[22:23], s[22:23]
  v_pk_fma_f32 v[60:61], v[60:61], s[22:23], s[22:23]
  v_pk_fma_f32 v[62:63], v[62:63], s[22:23], s[22:23]
  ds_write_b128 v253, v[100:103] offset:54272
  s_waitcnt lgkmcnt(0)
  s_barrier
  v_mfma_f32_32x32x16_bf16 v[32:47], a[0:3], v[160:163], 0
  ds_read_b128 v[64:67], v2
  ds_read_b128 v[68:71], v2 offset:32
  ds_read_b128 v[72:75], v2 offset:64
  s_add_u32 m0, s14, 0x16000
  v_rcp_f32_e64 v48, v48
  v_mfma_f32_32x32x16_bf16 v[32:47], a[4:7], v[164:167], v[32:47]
  ds_read_b128 v[76:79], v2 offset:96
  ds_read_b128 v[80:83], v2 offset:128
  ds_read_b128 v[84:87], v2 offset:160
  buffer_load_dwordx4 v254, s[72:75], s53 offen lds
  v_rcp_f32_e64 v49, v49
  v_mfma_f32_32x32x16_bf16 v[32:47], a[8:11], v[168:171], v[32:47]
  ds_read_b128 v[88:91], v2 offset:192
  ds_read_b128 v[92:95], v2 offset:224
  ds_read_b128 v[96:99], v2 offset:256
  buffer_load_dwordx4 v255, s[72:75], s53 offen offset:1024 lds
  v_rcp_f32_e64 v50, v50
  v_mfma_f32_32x32x16_bf16 v[32:47], a[12:15], v[172:175], v[32:47]
  ds_read_b128 v[100:103], v2 offset:288
  ds_read_b128 v[104:107], v2 offset:320
  ds_read_b128 v[108:111], v2 offset:352
  v_rcp_f32_e64 v51, v51
  v_mfma_f32_32x32x16_bf16 v[32:47], a[16:19], v[176:179], v[32:47]
  buffer_load_dwordx4 v194, s[72:75], s53 offen offset:2048 lds
  s_add_u32 m0, s14, 0x16c00
  v_rcp_f32 v52, v52
  v_rcp_f32 v53, v53
  v_mfma_f32_32x32x16_bf16 v[32:47], a[20:23], v[180:183], v[32:47]
  s_waitcnt lgkmcnt(0)
  buffer_load_dwordx4 v254, s[72:75], s54 offen lds
  v_rcp_f32 v54, v54
  v_rcp_f32_e64 v55, v55
  v_mfma_f32_32x32x16_bf16 v[64:79], v[240:243], v[136:139], v[64:79]
  v_mov_b32 v112, v194
  v_rcp_f32 v56, v56
  v_rcp_f32_e64 v57, v57
  v_mfma_f32_32x32x16_bf16 v[64:79], v[244:247], v[140:143], v[64:79]
  buffer_load_dwordx4 v255, s[72:75], s54 offen offset:1024 lds
  v_rcp_f32 v58, v58
  v_rcp_f32 v59, v59
  v_mfma_f32_32x32x16_bf16 v[80:95], v[240:243], v[144:147], v[80:95]
  buffer_load_dwordx4 v194, s[72:75], s54 offen offset:2048 lds
  v_rcp_f32 v60, v60
  v_rcp_f32 v61, v61
  v_mfma_f32_32x32x16_bf16 v[80:95], v[244:247], v[148:151], v[80:95]
  ds_read_b128 v[192:195], v1 offset:8192
  ds_read_b128 v[196:199], v1 offset:9216
  v_rcp_f32 v62, v62
  v_rcp_f32 v63, v63
  v_mfma_f32_32x32x16_bf16 v[96:111], v[240:243], v[152:155], v[96:111]
  ds_read_b128 v[200:203], v1 offset:10240
  ds_read_b128 v[204:207], v1 offset:11264
  v_mfma_f32_32x32x16_bf16 v[96:111], v[244:247], v[156:159], v[96:111]
  s_nop 0
  s_waitcnt lgkmcnt(0)
  ds_read_b128 v[208:211], v1 offset:12288
  ds_read_b128 v[212:215], v1 offset:13312
  v_pk_mul_f32 v[16:17], v[16:17], v[48:49]
  v_pk_mul_f32 v[18:19], v[18:19], v[50:51]
  v_pk_mul_f32 v[20:21], v[20:21], v[52:53]
  v_pk_mul_f32 v[22:23], v[22:23], v[54:55]
  v_pk_mul_f32 v[24:25], v[24:25], v[56:57]
  v_pk_mul_f32 v[26:27], v[26:27], v[58:59]
  v_pk_mul_f32 v[28:29], v[28:29], v[60:61]
  v_pk_mul_f32 v[30:31], v[30:31], v[62:63]
  v_pk_fma_f32 v[48:49], v[32:33], v[32:33], s[20:21] neg_lo:[1,0,1] neg_hi:[1,0,1]
  v_pk_fma_f32 v[50:51], v[34:35], v[34:35], s[20:21] neg_lo:[1,0,1] neg_hi:[1,0,1]
  v_pk_fma_f32 v[52:53], v[36:37], v[36:37], s[20:21] neg_lo:[1,0,1] neg_hi:[1,0,1]
  v_pk_fma_f32 v[54:55], v[38:39], v[38:39], s[20:21] neg_lo:[1,0,1] neg_hi:[1,0,1]
  v_pk_fma_f32 v[56:57], v[40:41], v[40:41], s[20:21] neg_lo:[1,0,1] neg_hi:[1,0,1]
  v_pk_fma_f32 v[58:59], v[42:43], v[42:43], s[20:21] neg_lo:[1,0,1] neg_hi:[1,0,1]
  v_pk_fma_f32 v[60:61], v[44:45], v[44:45], s[20:21] neg_lo:[1,0,1] neg_hi:[1,0,1]
  v_pk_fma_f32 v[62:63], v[46:47], v[46:47], s[20:21] neg_lo:[1,0,1] neg_hi:[1,0,1]
  v_pk_mul_f32 v[48:49], v[32:33], v[48:49]
  v_pk_mul_f32 v[50:51], v[34:35], v[50:51]
  v_pk_mul_f32 v[52:53], v[36:37], v[52:53]
  v_pk_mul_f32 v[54:55], v[38:39], v[54:55]
  v_pk_mul_f32 v[56:57], v[40:41], v[56:57]
  v_cvt_pk_bf16_f32 v184, v16, v17
  v_cvt_pk_bf16_f32 v185, v18, v19
  v_cvt_pk_bf16_f32 v186, v20, v21
  v_cvt_pk_bf16_f32 v187, v22, v23
  v_pk_mul_f32 v[58:59], v[42:43], v[58:59]
  v_pk_mul_f32 v[60:61], v[44:45], v[60:61]
  v_pk_mul_f32 v[62:63], v[46:47], v[62:63]
  v_mfma_f32_32x32x16_bf16 v[64:79], v[192:195], v[184:187], v[64:79]
  s_mov_b32 m0, s31
  v_cvt_pk_bf16_f32 v188, v24, v25
  v_cvt_pk_bf16_f32 v189, v26, v27
  v_cvt_pk_bf16_f32 v190, v28, v29
  v_cvt_pk_bf16_f32 v191, v30, v31
  v_exp_f32 v48, v48
  v_mfma_f32_32x32x16_bf16 v[80:95], v[196:199], v[184:187], v[80:95]
  buffer_load_dwordx4 v6, s[4:7], s52 offen lds
  v_exp_f32 v49, v49
  v_exp_f32 v50, v50
  v_exp_f32_e64 v51, v51
  v_mfma_f32_32x32x16_bf16 v[96:111], v[200:203], v[184:187], v[96:111]
  buffer_load_dwordx4 v7, s[4:7], s52 offen offset:1024 lds
  v_exp_f32 v52, v52
  v_exp_f32 v53, v53
  v_mfma_f32_32x32x16_bf16 v[64:79], v[204:207], v[188:191], v[64:79]
  buffer_load_dwordx4 v8, s[4:7], s52 offen offset:2048 lds
  v_exp_f32 v54, v54
  v_exp_f32 v55, v55
  v_exp_f32 v56, v56
  s_waitcnt lgkmcnt(1)
  v_mfma_f32_32x32x16_bf16 v[80:95], v[208:211], v[188:191], v[80:95]
  buffer_load_dwordx4 v9, s[4:7], s52 offen offset:3072 lds
  v_exp_f32_e64 v57, v57
  v_exp_f32 v58, v58
  s_waitcnt lgkmcnt(0)
  v_mfma_f32_32x32x16_bf16 v[96:111], v[212:215], v[188:191], v[96:111]
  v_exp_f32 v59, v59
  v_exp_f32 v60, v60
  v_exp_f32 v61, v61
  v_exp_f32 v62, v62
  v_exp_f32_e64 v63, v63
  v_pk_fma_f32 v[48:49], v[48:49], s[22:23], s[22:23]
  v_pk_fma_f32 v[50:51], v[50:51], s[22:23], s[22:23]
  v_pk_fma_f32 v[52:53], v[52:53], s[22:23], s[22:23]
  v_pk_fma_f32 v[54:55], v[54:55], s[22:23], s[22:23]
  v_pk_fma_f32 v[56:57], v[56:57], s[22:23], s[22:23]
  v_pk_fma_f32 v[58:59], v[58:59], s[22:23], s[22:23]
  v_pk_fma_f32 v[60:61], v[60:61], s[22:23], s[22:23]
  v_pk_fma_f32 v[62:63], v[62:63], s[22:23], s[22:23]
  v_mfma_f32_32x32x16_bf16 v[16:31], a[24:27], v[160:163], 0
  ds_read_b128 v[192:195], v1 offset:14336
  ds_read_b128 v[196:199], v1 offset:15360
  s_add_u32 m0, s14, 0x1c000
  v_rcp_f32 v48, v48
  v_rcp_f32 v49, v49
  v_mfma_f32_32x32x16_bf16 v[16:31], a[28:31], v[164:167], v[16:31]
  ds_read_b128 v[200:203], v1 offset:16384
  ds_read_b128 v[204:207], v1 offset:17408
  buffer_load_dwordx4 v254, s[72:75], s55 offen lds
  v_rcp_f32 v50, v50
  v_rcp_f32 v51, v51
  v_mfma_f32_32x32x16_bf16 v[16:31], a[32:35], v[168:171], v[16:31]
  ds_read_b128 v[208:211], v1 offset:18432
  ds_read_b128 v[212:215], v1 offset:19456
  v_rcp_f32 v52, v52
  v_rcp_f32 v53, v53
  v_mfma_f32_32x32x16_bf16 v[16:31], a[36:39], v[172:175], v[16:31]
  buffer_load_dwordx4 v255, s[72:75], s55 offen offset:1024 lds
  v_rcp_f32 v54, v54
  v_rcp_f32 v55, v55
  v_rcp_f32_e64 v56, v56
  v_mfma_f32_32x32x16_bf16 v[16:31], a[40:43], v[176:179], v[16:31]
  v_rcp_f32 v57, v57
  v_rcp_f32 v58, v58
  v_rcp_f32 v59, v59
  v_mfma_f32_32x32x16_bf16 v[16:31], a[44:47], v[180:183], v[16:31]
  s_waitcnt lgkmcnt(0)
  buffer_load_dwordx4 v112, s[72:75], s55 offen offset:2048 lds
  v_rcp_f32 v60, v60
  v_rcp_f32 v61, v61
  v_rcp_f32 v62, v62
  v_rcp_f32 v63, v63
  v_pk_mul_f32 v[32:33], v[32:33], v[48:49]
  v_pk_mul_f32 v[34:35], v[34:35], v[50:51]
  v_pk_mul_f32 v[36:37], v[36:37], v[52:53]
  v_pk_mul_f32 v[38:39], v[38:39], v[54:55]
  v_pk_mul_f32 v[40:41], v[40:41], v[56:57]
  v_pk_mul_f32 v[42:43], v[42:43], v[58:59]
  v_pk_mul_f32 v[44:45], v[44:45], v[60:61]
  v_pk_mul_f32 v[46:47], v[46:47], v[62:63]
  v_pk_fma_f32 v[48:49], v[16:17], v[16:17], s[20:21] neg_lo:[1,0,1] neg_hi:[1,0,1]
  v_pk_fma_f32 v[50:51], v[18:19], v[18:19], s[20:21] neg_lo:[1,0,1] neg_hi:[1,0,1]
  v_pk_fma_f32 v[52:53], v[20:21], v[20:21], s[20:21] neg_lo:[1,0,1] neg_hi:[1,0,1]
  v_pk_fma_f32 v[54:55], v[22:23], v[22:23], s[20:21] neg_lo:[1,0,1] neg_hi:[1,0,1]
  v_pk_fma_f32 v[56:57], v[24:25], v[24:25], s[20:21] neg_lo:[1,0,1] neg_hi:[1,0,1]
  v_pk_fma_f32 v[58:59], v[26:27], v[26:27], s[20:21] neg_lo:[1,0,1] neg_hi:[1,0,1]
  v_pk_fma_f32 v[60:61], v[28:29], v[28:29], s[20:21] neg_lo:[1,0,1] neg_hi:[1,0,1]
  v_pk_fma_f32 v[62:63], v[30:31], v[30:31], s[20:21] neg_lo:[1,0,1] neg_hi:[1,0,1]
  v_pk_mul_f32 v[48:49], v[16:17], v[48:49]
  v_pk_mul_f32 v[50:51], v[18:19], v[50:51]
  v_pk_mul_f32 v[52:53], v[20:21], v[52:53]
  v_pk_mul_f32 v[54:55], v[22:23], v[54:55]
  v_pk_mul_f32 v[56:57], v[24:25], v[56:57]
  v_cvt_pk_bf16_f32 v184, v32, v33
  v_cvt_pk_bf16_f32 v185, v34, v35
  v_cvt_pk_bf16_f32 v186, v36, v37
  v_cvt_pk_bf16_f32 v187, v38, v39
  v_pk_mul_f32 v[58:59], v[26:27], v[58:59]
  v_pk_mul_f32 v[60:61], v[28:29], v[60:61]
  v_pk_mul_f32 v[62:63], v[30:31], v[62:63]
  v_mfma_f32_32x32x16_bf16 v[64:79], v[192:195], v[184:187], v[64:79]
  s_add_u32 m0, s14, 0x1cc00
  v_cvt_pk_bf16_f32 v188, v40, v41
  v_cvt_pk_bf16_f32 v189, v42, v43
  v_cvt_pk_bf16_f32 v190, v44, v45
  v_cvt_pk_bf16_f32 v191, v46, v47
  v_exp_f32_e64 v48, v48
  v_mfma_f32_32x32x16_bf16 v[80:95], v[196:199], v[184:187], v[80:95]
  buffer_load_dwordx4 v254, s[72:75], s56 offen lds
  v_exp_f32 v49, v49
  v_exp_f32 v50, v50
  v_exp_f32 v51, v51
  v_mfma_f32_32x32x16_bf16 v[96:111], v[200:203], v[184:187], v[96:111]
  s_waitcnt vmcnt(8)
  ds_read_b128 a[216:219], v251
  ds_read_b128 a[220:223], v252
  ds_read_b128 a[224:227], v251 offset:64
  v_exp_f32 v52, v52
  v_exp_f32 v53, v53
  v_mfma_f32_32x32x16_bf16 v[64:79], v[204:207], v[188:191], v[64:79]
  ds_read_b128 a[228:231], v252 offset:64
  ds_read_b128 a[232:235], v251 offset:128
  ds_read_b128 a[236:239], v252 offset:128
  buffer_load_dwordx4 v255, s[72:75], s56 offen offset:1024 lds
  v_subrev_u32 v11, 0x4100, v5
  v_exp_f32_e64 v54, v54
  v_mfma_f32_32x32x16_bf16 v[80:95], v[208:211], v[188:191], v[80:95]
  v_exp_f32 v55, v55
  v_exp_f32 v56, v56
  v_exp_f32_e64 v57, v57
  v_exp_f32 v58, v58
  v_mfma_f32_32x32x16_bf16 v[96:111], v[212:215], v[188:191], v[96:111]
  s_waitcnt lgkmcnt(0)
  buffer_load_dwordx4 v112, s[72:75], s56 offen offset:2048 lds
  v_add_u32 v5, 0x8200, v5
  v_exp_f32 v59, v59
  v_exp_f32 v60, v60
  v_exp_f32 v61, v61
  v_exp_f32 v62, v62
  v_exp_f32 v63, v63
  v_min_u32 v5, v11, v5
  v_pk_fma_f32 v[48:49], v[48:49], s[22:23], s[22:23]
  v_pk_fma_f32 v[50:51], v[50:51], s[22:23], s[22:23]
  v_pk_fma_f32 v[52:53], v[52:53], s[22:23], s[22:23]
  v_pk_fma_f32 v[54:55], v[54:55], s[22:23], s[22:23]
  v_pk_fma_f32 v[56:57], v[56:57], s[22:23], s[22:23]
  v_pk_fma_f32 v[58:59], v[58:59], s[22:23], s[22:23]
  v_pk_fma_f32 v[60:61], v[60:61], s[22:23], s[22:23]
  v_pk_fma_f32 v[62:63], v[62:63], s[22:23], s[22:23]
  v_mfma_f32_32x32x16_bf16 v[112:127], a[216:219], a[192:195], 0
  ds_read_b128 v[192:195], v1 offset:20480
  ds_read_b128 v[196:199], v1 offset:21504
  v_rcp_f32 v48, v48
  v_rcp_f32 v49, v49
  v_mfma_f32_32x32x16_bf16 v[112:127], a[220:223], a[196:199], v[112:127]
  ds_read_b128 v[200:203], v1 offset:22528
  ds_read_b128 v[204:207], v1 offset:23552
  v_rcp_f32 v50, v50
  v_rcp_f32 v51, v51
  v_mfma_f32_32x32x16_bf16 v[128:143], a[224:227], a[200:203], 0
  ds_read_b128 v[208:211], v1 offset:24576
  ds_read_b128 v[212:215], v1 offset:25600
  v_rcp_f32_e64 v52, v52
  v_rcp_f32 v53, v53
  v_mfma_f32_32x32x16_bf16 v[128:143], a[228:231], a[204:207], v[128:143]
  s_nop 1
  v_cvt_pk_bf16_f32 v112, v112, v113
  v_cvt_pk_bf16_f32 v113, v114, v115
  v_cvt_pk_bf16_f32 v114, v116, v117
  v_cvt_pk_bf16_f32 v115, v118, v119
  v_rcp_f32_e64 v54, v54
  v_mfma_f32_32x32x16_bf16 v[144:159], a[232:235], a[208:211], 0
  ds_write_b128 v253, v[112:115]
  v_cvt_pk_bf16_f32 v116, v120, v121
  v_cvt_pk_bf16_f32 v117, v122, v123
  v_cvt_pk_bf16_f32 v118, v124, v125
  v_cvt_pk_bf16_f32 v119, v126, v127
  v_mfma_f32_32x32x16_bf16 v[144:159], a[236:239], a[212:215], v[144:159]
  ds_write_b128 v253, v[116:119] offset:3072
  v_cvt_pk_bf16_f32 v128, v128, v129
  v_cvt_pk_bf16_f32 v129, v130, v131
  v_cvt_pk_bf16_f32 v130, v132, v133
  v_cvt_pk_bf16_f32 v131, v134, v135
  v_mfma_f32_32x32x16_bf16 v[32:47], a[48:51], v[160:163], 0
  ds_write_b128 v253, v[128:131] offset:1024
  v_cvt_pk_bf16_f32 v132, v136, v137
  v_cvt_pk_bf16_f32 v133, v138, v139
  v_cvt_pk_bf16_f32 v134, v140, v141
  v_cvt_pk_bf16_f32 v135, v142, v143
  v_mfma_f32_32x32x16_bf16 v[32:47], a[52:55], v[164:167], v[32:47]
  ds_write_b128 v253, v[132:135] offset:4096
  v_cvt_pk_bf16_f32 v144, v144, v145
  v_cvt_pk_bf16_f32 v145, v146, v147
  v_cvt_pk_bf16_f32 v146, v148, v149
  v_cvt_pk_bf16_f32 v147, v150, v151
  v_mfma_f32_32x32x16_bf16 v[32:47], a[56:59], v[168:171], v[32:47]
  ds_write_b128 v253, v[144:147] offset:2048
  v_cvt_pk_bf16_f32 v148, v152, v153
  v_cvt_pk_bf16_f32 v149, v154, v155
  v_cvt_pk_bf16_f32 v150, v156, v157
  v_cvt_pk_bf16_f32 v151, v158, v159
  v_mfma_f32_32x32x16_bf16 v[32:47], a[60:63], v[172:175], v[32:47]
  ds_write_b128 v253, v[148:151] offset:5120
  v_rcp_f32 v55, v55
  v_rcp_f32 v56, v56
  v_mfma_f32_32x32x16_bf16 v[32:47], a[64:67], v[176:179], v[32:47]
  v_rcp_f32 v57, v57
  v_rcp_f32 v58, v58
  v_rcp_f32_e64 v59, v59
  v_mfma_f32_32x32x16_bf16 v[32:47], a[68:71], v[180:183], v[32:47]
  s_waitcnt lgkmcnt(6)
  v_rcp_f32 v60, v60
  v_rcp_f32 v61, v61
  v_rcp_f32 v62, v62
  v_rcp_f32_e64 v63, v63
  v_pk_mul_f32 v[16:17], v[16:17], v[48:49]
  v_pk_mul_f32 v[18:19], v[18:19], v[50:51]
  v_pk_mul_f32 v[20:21], v[20:21], v[52:53]
  v_pk_mul_f32 v[22:23], v[22:23], v[54:55]
  v_pk_mul_f32 v[24:25], v[24:25], v[56:57]
  v_pk_mul_f32 v[26:27], v[26:27], v[58:59]
  v_pk_mul_f32 v[28:29], v[28:29], v[60:61]
  v_pk_mul_f32 v[30:31], v[30:31], v[62:63]
  v_pk_fma_f32 v[48:49], v[32:33], v[32:33], s[20:21] neg_lo:[1,0,1] neg_hi:[1,0,1]
  v_pk_fma_f32 v[50:51], v[34:35], v[34:35], s[20:21] neg_lo:[1,0,1] neg_hi:[1,0,1]
  v_pk_fma_f32 v[52:53], v[36:37], v[36:37], s[20:21] neg_lo:[1,0,1] neg_hi:[1,0,1]
  v_pk_fma_f32 v[54:55], v[38:39], v[38:39], s[20:21] neg_lo:[1,0,1] neg_hi:[1,0,1]
  v_pk_fma_f32 v[56:57], v[40:41], v[40:41], s[20:21] neg_lo:[1,0,1] neg_hi:[1,0,1]
  v_pk_fma_f32 v[58:59], v[42:43], v[42:43], s[20:21] neg_lo:[1,0,1] neg_hi:[1,0,1]
  v_pk_fma_f32 v[60:61], v[44:45], v[44:45], s[20:21] neg_lo:[1,0,1] neg_hi:[1,0,1]
  v_pk_fma_f32 v[62:63], v[46:47], v[46:47], s[20:21] neg_lo:[1,0,1] neg_hi:[1,0,1]
  v_pk_mul_f32 v[48:49], v[32:33], v[48:49]
  v_pk_mul_f32 v[50:51], v[34:35], v[50:51]
  v_pk_mul_f32 v[52:53], v[36:37], v[52:53]
  v_pk_mul_f32 v[54:55], v[38:39], v[54:55]
  v_pk_mul_f32 v[56:57], v[40:41], v[56:57]
  v_cvt_pk_bf16_f32 v184, v16, v17
  v_cvt_pk_bf16_f32 v185, v18, v19
  v_cvt_pk_bf16_f32 v186, v20, v21
  v_cvt_pk_bf16_f32 v187, v22, v23
  v_pk_mul_f32 v[58:59], v[42:43], v[58:59]
  v_pk_mul_f32 v[60:61], v[44:45], v[60:61]
  v_pk_mul_f32 v[62:63], v[46:47], v[62:63]
  v_mfma_f32_32x32x16_bf16 v[64:79], v[192:195], v[184:187], v[64:79]
  s_add_u32 s29, s29, 0x60000
  v_cvt_pk_bf16_f32 v188, v24, v25
  v_cvt_pk_bf16_f32 v189, v26, v27
  v_cvt_pk_bf16_f32 v190, v28, v29
  v_cvt_pk_bf16_f32 v191, v30, v31
  v_exp_f32_e64 v48, v48
  v_mfma_f32_32x32x16_bf16 v[80:95], v[196:199], v[184:187], v[80:95]
  s_add_u32 s52, s52, 0x60000
  v_exp_f32 v49, v49
  v_exp_f32 v50, v50
  v_exp_f32_e64 v51, v51
  v_mfma_f32_32x32x16_bf16 v[96:111], v[200:203], v[184:187], v[96:111]
  s_mov_b32 s32, s30
  s_waitcnt vmcnt(0)
  ds_read_b128 a[216:219], v251 offset:24576
  ds_read_b128 a[220:223], v252 offset:24576
  ds_read_b128 a[224:227], v251 offset:24640
  v_exp_f32_e64 v52, v52
  v_exp_f32 v53, v53
  v_mfma_f32_32x32x16_bf16 v[64:79], v[204:207], v[188:191], v[64:79]
  s_add_u32 s30, s33, 32
  ds_read_b128 a[228:231], v252 offset:24640
  ds_read_b128 a[232:235], v251 offset:24704
  ds_read_b128 a[236:239], v252 offset:24704
  v_subrev_u32 v11, 0x4100, v4
  v_exp_f32_e64 v54, v54
  v_mfma_f32_32x32x16_bf16 v[80:95], v[208:211], v[188:191], v[80:95]
  s_sub_u32 s33, s31, 0
  v_exp_f32 v55, v55
  v_exp_f32 v56, v56
  v_exp_f32 v57, v57
  v_exp_f32 v58, v58
  v_mfma_f32_32x32x16_bf16 v[96:111], v[212:215], v[188:191], v[96:111]
  s_waitcnt lgkmcnt(0)
  v_add_u32 v4, 0x8200, v4
  v_exp_f32 v59, v59
  v_exp_f32 v60, v60
  v_exp_f32 v61, v61
  v_exp_f32 v62, v62
  v_exp_f32 v63, v63
  v_min_u32 v4, v11, v4
  v_pk_fma_f32 v[48:49], v[48:49], s[22:23], s[22:23]
  v_pk_fma_f32 v[50:51], v[50:51], s[22:23], s[22:23]
  v_pk_fma_f32 v[52:53], v[52:53], s[22:23], s[22:23]
  v_pk_fma_f32 v[54:55], v[54:55], s[22:23], s[22:23]
  v_pk_fma_f32 v[56:57], v[56:57], s[22:23], s[22:23]
  v_pk_fma_f32 v[58:59], v[58:59], s[22:23], s[22:23]
  v_pk_fma_f32 v[60:61], v[60:61], s[22:23], s[22:23]
  v_pk_fma_f32 v[62:63], v[62:63], s[22:23], s[22:23]
  v_mfma_f32_32x32x16_bf16 v[112:127], a[216:219], a[192:195], 0
  ds_read_b128 v[192:195], v1 offset:26624
  ds_read_b128 v[196:199], v1 offset:27648
  v_rcp_f32 v48, v48
  v_rcp_f32 v49, v49
  v_mfma_f32_32x32x16_bf16 v[112:127], a[220:223], a[196:199], v[112:127]
  ds_read_b128 v[200:203], v1 offset:28672
  ds_read_b128 v[204:207], v1 offset:29696
  v_rcp_f32 v50, v50
  v_rcp_f32 v51, v51
  v_mfma_f32_32x32x16_bf16 v[128:143], a[224:227], a[200:203], 0
  ds_read_b128 v[208:211], v1 offset:30720
  ds_read_b128 v[212:215], v1 offset:31744
  v_rcp_f32_e64 v52, v52
  v_rcp_f32 v53, v53
  v_mfma_f32_32x32x16_bf16 v[128:143], a[228:231], a[204:207], v[128:143]
  s_nop 1
  v_cvt_pk_bf16_f32 v112, v112, v113
  v_cvt_pk_bf16_f32 v113, v114, v115
  v_cvt_pk_bf16_f32 v114, v116, v117
  v_cvt_pk_bf16_f32 v115, v118, v119
  v_rcp_f32_e64 v54, v54
  v_mfma_f32_32x32x16_bf16 v[144:159], a[232:235], a[208:211], 0
  ds_write_b128 v253, v[112:115] offset:24576
  v_cvt_pk_bf16_f32 v116, v120, v121
  v_cvt_pk_bf16_f32 v117, v122, v123
  v_cvt_pk_bf16_f32 v118, v124, v125
  v_cvt_pk_bf16_f32 v119, v126, v127
  v_mfma_f32_32x32x16_bf16 v[144:159], a[236:239], a[212:215], v[144:159]
  ds_write_b128 v253, v[116:119] offset:27648
  v_cvt_pk_bf16_f32 v128, v128, v129
  v_cvt_pk_bf16_f32 v129, v130, v131
  v_cvt_pk_bf16_f32 v130, v132, v133
  v_cvt_pk_bf16_f32 v131, v134, v135
  v_mfma_f32_32x32x16_bf16 v[16:31], a[72:75], v[160:163], 0
  ds_write_b128 v253, v[128:131] offset:25600
  v_cvt_pk_bf16_f32 v132, v136, v137
  v_cvt_pk_bf16_f32 v133, v138, v139
  v_cvt_pk_bf16_f32 v134, v140, v141
  v_cvt_pk_bf16_f32 v135, v142, v143
  v_mfma_f32_32x32x16_bf16 v[16:31], a[76:79], v[164:167], v[16:31]
  ds_write_b128 v253, v[132:135] offset:28672
  v_cvt_pk_bf16_f32 v144, v144, v145
  v_cvt_pk_bf16_f32 v145, v146, v147
  v_cvt_pk_bf16_f32 v146, v148, v149
  v_cvt_pk_bf16_f32 v147, v150, v151
  v_mfma_f32_32x32x16_bf16 v[16:31], a[80:83], v[168:171], v[16:31]
  ds_write_b128 v253, v[144:147] offset:26624
  v_cvt_pk_bf16_f32 v148, v152, v153
  v_cvt_pk_bf16_f32 v149, v154, v155
  v_cvt_pk_bf16_f32 v150, v156, v157
  v_cvt_pk_bf16_f32 v151, v158, v159
  v_mfma_f32_32x32x16_bf16 v[16:31], a[84:87], v[172:175], v[16:31]
  ds_write_b128 v253, v[148:151] offset:29696
  buffer_load_dword v249, v248, s[4:7], s29 offen
  v_rcp_f32_e64 v55, v55
  v_mfma_f32_32x32x16_bf16 v[16:31], a[88:91], v[176:179], v[16:31]
  v_rcp_f32 v56, v56
  v_rcp_f32 v57, v57
  v_rcp_f32_e64 v58, v58
  v_mfma_f32_32x32x16_bf16 v[16:31], a[92:95], v[180:183], v[16:31]
  s_waitcnt lgkmcnt(6)
  v_rcp_f32 v59, v59
  v_rcp_f32 v60, v60
  v_rcp_f32 v61, v61
  v_rcp_f32 v62, v62
  v_rcp_f32 v63, v63
  v_pk_mul_f32 v[32:33], v[32:33], v[48:49]
  v_pk_mul_f32 v[34:35], v[34:35], v[50:51]
  v_pk_mul_f32 v[36:37], v[36:37], v[52:53]
  v_pk_mul_f32 v[38:39], v[38:39], v[54:55]
  v_pk_mul_f32 v[40:41], v[40:41], v[56:57]
  v_pk_mul_f32 v[42:43], v[42:43], v[58:59]
  v_pk_mul_f32 v[44:45], v[44:45], v[60:61]
  v_pk_mul_f32 v[46:47], v[46:47], v[62:63]
  v_pk_fma_f32 v[48:49], v[16:17], v[16:17], s[20:21] neg_lo:[1,0,1] neg_hi:[1,0,1]
  v_pk_fma_f32 v[50:51], v[18:19], v[18:19], s[20:21] neg_lo:[1,0,1] neg_hi:[1,0,1]
  v_pk_fma_f32 v[52:53], v[20:21], v[20:21], s[20:21] neg_lo:[1,0,1] neg_hi:[1,0,1]
  v_pk_fma_f32 v[54:55], v[22:23], v[22:23], s[20:21] neg_lo:[1,0,1] neg_hi:[1,0,1]
  v_pk_fma_f32 v[56:57], v[24:25], v[24:25], s[20:21] neg_lo:[1,0,1] neg_hi:[1,0,1]
  v_pk_fma_f32 v[58:59], v[26:27], v[26:27], s[20:21] neg_lo:[1,0,1] neg_hi:[1,0,1]
  v_pk_fma_f32 v[60:61], v[28:29], v[28:29], s[20:21] neg_lo:[1,0,1] neg_hi:[1,0,1]
  v_pk_fma_f32 v[62:63], v[30:31], v[30:31], s[20:21] neg_lo:[1,0,1] neg_hi:[1,0,1]
  v_pk_mul_f32 v[48:49], v[16:17], v[48:49]
  v_pk_mul_f32 v[50:51], v[18:19], v[50:51]
  v_pk_mul_f32 v[52:53], v[20:21], v[52:53]
  v_pk_mul_f32 v[54:55], v[22:23], v[54:55]
  v_pk_mul_f32 v[56:57], v[24:25], v[56:57]
  v_cvt_pk_bf16_f32 v184, v32, v33
  v_cvt_pk_bf16_f32 v185, v34, v35
  v_cvt_pk_bf16_f32 v186, v36, v37
  v_cvt_pk_bf16_f32 v187, v38, v39
  v_pk_mul_f32 v[58:59], v[26:27], v[58:59]
  v_pk_mul_f32 v[60:61], v[28:29], v[60:61]
  v_pk_mul_f32 v[62:63], v[30:31], v[62:63]
  v_mfma_f32_32x32x16_bf16 v[64:79], v[192:195], v[184:187], v[64:79]
  ds_read_b128 v[220:223], v4 offset:96
  v_cvt_pk_bf16_f32 v188, v40, v41
  v_cvt_pk_bf16_f32 v189, v42, v43
  v_cvt_pk_bf16_f32 v190, v44, v45
  v_cvt_pk_bf16_f32 v191, v46, v47
  v_mfma_f32_32x32x16_bf16 v[80:95], v[196:199], v[184:187], v[80:95]
  ds_read_b128 v[228:231], v4 offset:288
  v_exp_f32 v48, v48
  v_exp_f32 v49, v49
  v_exp_f32_e64 v50, v50
  v_mfma_f32_32x32x16_bf16 v[96:111], v[200:203], v[184:187], v[96:111]
  ds_read_b128 v[236:239], v4 offset:480
  v_exp_f32 v51, v51
  v_exp_f32 v52, v52
  v_mfma_f32_32x32x16_bf16 v[64:79], v[204:207], v[188:191], v[64:79]
  v_exp_f32 v53, v53
  v_exp_f32 v54, v54
  v_exp_f32_e64 v55, v55
  v_mfma_f32_32x32x16_bf16 v[80:95], v[208:211], v[188:191], v[80:95]
  v_exp_f32 v56, v56
  v_exp_f32 v57, v57
  v_exp_f32_e64 v58, v58
  v_mfma_f32_32x32x16_bf16 v[96:111], v[212:215], v[188:191], v[96:111]
  s_waitcnt lgkmcnt(0)
  v_exp_f32 v59, v59
  v_exp_f32 v60, v60
  v_exp_f32 v61, v61
  v_exp_f32 v62, v62
  v_exp_f32 v63, v63
  v_pk_fma_f32 v[48:49], v[48:49], s[22:23], s[22:23]
  v_pk_fma_f32 v[50:51], v[50:51], s[22:23], s[22:23]
  v_pk_fma_f32 v[52:53], v[52:53], s[22:23], s[22:23]
  v_pk_fma_f32 v[54:55], v[54:55], s[22:23], s[22:23]
  v_pk_fma_f32 v[56:57], v[56:57], s[22:23], s[22:23]
  v_pk_fma_f32 v[58:59], v[58:59], s[22:23], s[22:23]
  v_pk_fma_f32 v[60:61], v[60:61], s[22:23], s[22:23]
  v_pk_fma_f32 v[62:63], v[62:63], s[22:23], s[22:23]
  s_barrier
  v_mfma_f32_32x32x16_bf16 v[32:47], a[96:99], v[160:163], 0
  ds_read_b128 v[192:195], v0 offset:24576
  ds_read_b128 v[196:199], v0 offset:25600
  v_rcp_f32 v48, v48
  v_rcp_f32_e64 v49, v49
  v_mfma_f32_16x16x32_bf16 v[136:139], a[240:243], v[220:223], 0
  ds_read_b128 v[216:219], v3 offset:2800
  ds_read_b128 v[220:223], v4 offset:112
  v_mfma_f32_32x32x16_bf16 v[32:47], a[100:103], v[164:167], v[32:47]
  ds_read_b128 v[200:203], v0 offset:26624
  ds_read_b128 v[204:207], v0 offset:27648
  v_rcp_f32 v50, v50
  v_rcp_f32 v51, v51
  v_mfma_f32_16x16x32_bf16 v[136:139], a[244:247], v[228:231], v[136:139]
  ds_read_b128 v[224:227], v3 offset:7600
  ds_read_b128 v[228:231], v4 offset:304
  v_mfma_f32_32x32x16_bf16 v[32:47], a[104:107], v[168:171], v[32:47]
  ds_read_b128 v[208:211], v0 offset:28672
  ds_read_b128 v[212:215], v0 offset:29696
  v_rcp_f32 v52, v52
  v_rcp_f32 v53, v53
  v_mfma_f32_16x16x32_bf16 v[136:139], a[248:251], v[236:239], v[136:139]
  ds_read_b128 v[232:235], v3 offset:12400
  ds_read_b128 v[236:239], v4 offset:496
  v_mfma_f32_32x32x16_bf16 v[32:47], a[108:111], v[172:175], v[32:47]
  v_rcp_f32 v54, v54
  v_rcp_f32 v55, v55
  v_rcp_f32_e64 v56, v56
  v_mfma_f32_32x32x16_bf16 v[32:47], a[112:115], v[176:179], v[32:47]
  v_rcp_f32 v57, v57
  v_rcp_f32 v58, v58
  v_rcp_f32_e64 v59, v59
  v_mfma_f32_32x32x16_bf16 v[32:47], a[116:119], v[180:183], v[32:47]
  s_waitcnt lgkmcnt(0)
  v_rcp_f32 v60, v60
  v_rcp_f32 v61, v61
  v_rcp_f32 v62, v62
  v_rcp_f32_e64 v63, v63
  v_pk_mul_f32 v[16:17], v[16:17], v[48:49]
  v_pk_mul_f32 v[18:19], v[18:19], v[50:51]
  v_pk_mul_f32 v[20:21], v[20:21], v[52:53]
  v_pk_mul_f32 v[22:23], v[22:23], v[54:55]
  v_pk_mul_f32 v[24:25], v[24:25], v[56:57]
  v_pk_mul_f32 v[26:27], v[26:27], v[58:59]
  v_pk_mul_f32 v[28:29], v[28:29], v[60:61]
  v_pk_mul_f32 v[30:31], v[30:31], v[62:63]
  v_pk_add_f32 v[12:13], v[136:137], v[138:139]
  v_pk_mul_f32 v[14:15], v[136:137], v[136:137]
  v_pk_fma_f32 v[14:15], v[138:139], v[138:139], v[14:15]
  v_pk_fma_f32 v[48:49], v[32:33], v[32:33], s[20:21] neg_lo:[1,0,1] neg_hi:[1,0,1]
  v_pk_fma_f32 v[50:51], v[34:35], v[34:35], s[20:21] neg_lo:[1,0,1] neg_hi:[1,0,1]
  v_pk_fma_f32 v[52:53], v[36:37], v[36:37], s[20:21] neg_lo:[1,0,1] neg_hi:[1,0,1]
  v_pk_fma_f32 v[54:55], v[38:39], v[38:39], s[20:21] neg_lo:[1,0,1] neg_hi:[1,0,1]
  v_pk_fma_f32 v[56:57], v[40:41], v[40:41], s[20:21] neg_lo:[1,0,1] neg_hi:[1,0,1]
  v_pk_fma_f32 v[58:59], v[42:43], v[42:43], s[20:21] neg_lo:[1,0,1] neg_hi:[1,0,1]
  v_pk_fma_f32 v[60:61], v[44:45], v[44:45], s[20:21] neg_lo:[1,0,1] neg_hi:[1,0,1]
  v_pk_fma_f32 v[62:63], v[46:47], v[46:47], s[20:21] neg_lo:[1,0,1] neg_hi:[1,0,1]
  v_pk_mul_f32 v[48:49], v[32:33], v[48:49]
  v_pk_mul_f32 v[50:51], v[34:35], v[50:51]
  v_pk_mul_f32 v[52:53], v[36:37], v[52:53]
  v_pk_mul_f32 v[54:55], v[38:39], v[54:55]
  v_pk_mul_f32 v[56:57], v[40:41], v[56:57]
  v_pk_mul_f32 v[58:59], v[42:43], v[58:59]
  v_pk_mul_f32 v[60:61], v[44:45], v[60:61]
  v_pk_mul_f32 v[62:63], v[46:47], v[62:63]
  v_mfma_f32_16x16x32_bf16 v[140:143], v[216:219], v[220:223], 0
  v_cvt_pk_bf16_f32 v184, v16, v17
  v_cvt_pk_bf16_f32 v185, v18, v19
  v_mfma_f32_16x16x32_bf16 v[140:143], v[224:227], v[228:231], v[140:143]
  v_cvt_pk_bf16_f32 v186, v20, v21
  v_cvt_pk_bf16_f32 v187, v22, v23
  v_mfma_f32_16x16x32_bf16 v[140:143], v[232:235], v[236:239], v[140:143]
  ds_read_b128 v[220:223], v4 offset:128
  v_mfma_f32_32x32x16_bf16 v[64:79], v[192:195], v[184:187], v[64:79]
  ds_read_b128 v[224:227], v3 offset:8000
  ds_read_b128 v[228:231], v4 offset:320
  v_cvt_pk_bf16_f32 v188, v24, v25
  v_cvt_pk_bf16_f32 v189, v26, v27
  v_cvt_pk_bf16_f32 v190, v28, v29
  v_cvt_pk_bf16_f32 v191, v30, v31
  v_mfma_f32_32x32x16_bf16 v[80:95], v[196:199], v[184:187], v[80:95]
  ds_read_b128 v[232:235], v3 offset:12800
  ds_read_b128 v[236:239], v4 offset:512
  v_exp_f32 v48, v48
  v_exp_f32 v49, v49
  v_mfma_f32_32x32x16_bf16 v[96:111], v[200:203], v[184:187], v[96:111]
  s_sub_u32 s31, s32, 32
  v_exp_f32 v50, v50
  v_exp_f32 v51, v51
  v_exp_f32 v52, v52
  v_mfma_f32_32x32x16_bf16 v[64:79], v[204:207], v[188:191], v[64:79]
  v_exp_f32 v53, v53
  v_exp_f32 v54, v54
  v_exp_f32_e64 v55, v55
  v_mfma_f32_32x32x16_bf16 v[80:95], v[208:211], v[188:191], v[80:95]
  v_exp_f32 v56, v56
  v_exp_f32 v57, v57
  v_exp_f32_e64 v58, v58
  v_mfma_f32_32x32x16_bf16 v[96:111], v[212:215], v[188:191], v[96:111]
  s_waitcnt lgkmcnt(0)
  v_exp_f32 v59, v59
  v_exp_f32 v60, v60
  v_exp_f32 v61, v61
  v_exp_f32 v62, v62
  v_exp_f32 v63, v63
  v_pk_add_f32 v[12:13], v[12:13], v[140:141]
  v_pk_fma_f32 v[14:15], v[140:141], v[140:141], v[14:15]
  v_pk_add_f32 v[12:13], v[12:13], v[142:143]
  v_pk_fma_f32 v[14:15], v[142:143], v[142:143], v[14:15]
  v_pk_fma_f32 v[48:49], v[48:49], s[22:23], s[22:23]
  v_pk_fma_f32 v[50:51], v[50:51], s[22:23], s[22:23]
  v_pk_fma_f32 v[52:53], v[52:53], s[22:23], s[22:23]
  v_pk_fma_f32 v[54:55], v[54:55], s[22:23], s[22:23]
  v_pk_fma_f32 v[56:57], v[56:57], s[22:23], s[22:23]
  v_pk_fma_f32 v[58:59], v[58:59], s[22:23], s[22:23]
  v_pk_fma_f32 v[60:61], v[60:61], s[22:23], s[22:23]
  v_pk_fma_f32 v[62:63], v[62:63], s[22:23], s[22:23]
  v_mfma_f32_32x32x16_bf16 v[16:31], a[120:123], v[160:163], 0
  ds_read_b128 v[192:195], v0 offset:30720
  ds_read_b128 v[196:199], v0 offset:31744
  v_rcp_f32 v48, v48
  v_rcp_f32 v49, v49
  v_mfma_f32_16x16x32_bf16 v[144:147], a[252:255], v[220:223], 0
  ds_read_b128 v[216:219], v3 offset:3600
  ds_read_b128 v[220:223], v4 offset:144
  v_mfma_f32_32x32x16_bf16 v[16:31], a[124:127], v[164:167], v[16:31]
  ds_read_b128 v[200:203], v0 offset:32768
  ds_read_b128 v[204:207], v0 offset:33792
  v_rcp_f32 v50, v50
  v_rcp_f32 v51, v51
  v_mfma_f32_16x16x32_bf16 v[144:147], v[224:227], v[228:231], v[144:147]
  ds_read_b128 v[224:227], v3 offset:8400
  ds_read_b128 v[228:231], v4 offset:336
  v_mfma_f32_32x32x16_bf16 v[16:31], a[128:131], v[168:171], v[16:31]
  ds_read_b128 v[208:211], v0 offset:34816
  ds_read_b128 v[212:215], v0 offset:35840
  v_rcp_f32 v52, v52
  v_rcp_f32 v53, v53
  v_mfma_f32_16x16x32_bf16 v[144:147], v[232:235], v[236:239], v[144:147]
  ds_read_b128 v[232:235], v3 offset:13200
  ds_read_b128 v[236:239], v4 offset:528
  v_mfma_f32_32x32x16_bf16 v[16:31], a[132:135], v[172:175], v[16:31]
  v_rcp_f32 v54, v54
  v_rcp_f32 v55, v55
  v_rcp_f32_e64 v56, v56
  v_mfma_f32_32x32x16_bf16 v[16:31], a[136:139], v[176:179], v[16:31]
  ds_read_b128 a[192:195], v0
  ds_read_b128 a[196:199], v0 offset:1024
  ds_read_b128 a[200:203], v0 offset:2048
  v_rcp_f32 v57, v57
  v_rcp_f32 v58, v58
  v_mfma_f32_32x32x16_bf16 v[16:31], a[140:143], v[180:183], v[16:31]
  s_waitcnt lgkmcnt(3)
  v_rcp_f32 v59, v59
  v_rcp_f32 v60, v60
  v_rcp_f32 v61, v61
  v_rcp_f32 v62, v62
  v_rcp_f32 v63, v63
  v_pk_mul_f32 v[32:33], v[32:33], v[48:49]
  v_pk_mul_f32 v[34:35], v[34:35], v[50:51]
  v_pk_mul_f32 v[36:37], v[36:37], v[52:53]
  v_pk_mul_f32 v[38:39], v[38:39], v[54:55]
  v_pk_mul_f32 v[40:41], v[40:41], v[56:57]
  v_pk_mul_f32 v[42:43], v[42:43], v[58:59]
  v_pk_mul_f32 v[44:45], v[44:45], v[60:61]
  v_pk_mul_f32 v[46:47], v[46:47], v[62:63]
  v_pk_add_f32 v[12:13], v[12:13], v[144:145]
  v_pk_fma_f32 v[14:15], v[144:145], v[144:145], v[14:15]
  v_pk_add_f32 v[12:13], v[12:13], v[146:147]
  v_pk_fma_f32 v[14:15], v[146:147], v[146:147], v[14:15]
  v_pk_fma_f32 v[48:49], v[16:17], v[16:17], s[20:21] neg_lo:[1,0,1] neg_hi:[1,0,1]
  v_pk_fma_f32 v[50:51], v[18:19], v[18:19], s[20:21] neg_lo:[1,0,1] neg_hi:[1,0,1]
  v_pk_fma_f32 v[52:53], v[20:21], v[20:21], s[20:21] neg_lo:[1,0,1] neg_hi:[1,0,1]
  v_pk_fma_f32 v[54:55], v[22:23], v[22:23], s[20:21] neg_lo:[1,0,1] neg_hi:[1,0,1]
  v_pk_fma_f32 v[56:57], v[24:25], v[24:25], s[20:21] neg_lo:[1,0,1] neg_hi:[1,0,1]
  v_pk_fma_f32 v[58:59], v[26:27], v[26:27], s[20:21] neg_lo:[1,0,1] neg_hi:[1,0,1]
  v_pk_fma_f32 v[60:61], v[28:29], v[28:29], s[20:21] neg_lo:[1,0,1] neg_hi:[1,0,1]
  v_pk_fma_f32 v[62:63], v[30:31], v[30:31], s[20:21] neg_lo:[1,0,1] neg_hi:[1,0,1]
  v_pk_mul_f32 v[48:49], v[16:17], v[48:49]
  v_pk_mul_f32 v[50:51], v[18:19], v[50:51]
  v_pk_mul_f32 v[52:53], v[20:21], v[52:53]
  v_pk_mul_f32 v[54:55], v[22:23], v[54:55]
  v_pk_mul_f32 v[56:57], v[24:25], v[56:57]
  v_pk_mul_f32 v[58:59], v[26:27], v[58:59]
  v_pk_mul_f32 v[60:61], v[28:29], v[60:61]
  v_pk_mul_f32 v[62:63], v[30:31], v[62:63]
  v_mfma_f32_16x16x32_bf16 v[148:151], v[216:219], v[220:223], 0
  v_cvt_pk_bf16_f32 v184, v32, v33
  v_cvt_pk_bf16_f32 v185, v34, v35
  v_mfma_f32_16x16x32_bf16 v[148:151], v[224:227], v[228:231], v[148:151]
  v_cvt_pk_bf16_f32 v186, v36, v37
  v_cvt_pk_bf16_f32 v187, v38, v39
  v_mfma_f32_16x16x32_bf16 v[148:151], v[232:235], v[236:239], v[148:151]
  ds_read_b128 v[216:219], v3 offset:4000
  ds_read_b128 v[220:223], v4 offset:160
  v_mfma_f32_32x32x16_bf16 v[64:79], v[192:195], v[184:187], v[64:79]
  ds_read_b128 v[224:227], v3 offset:8800
  ds_read_b128 v[228:231], v4 offset:352
  v_cvt_pk_bf16_f32 v188, v40, v41
  v_cvt_pk_bf16_f32 v189, v42, v43
  v_cvt_pk_bf16_f32 v190, v44, v45
  v_cvt_pk_bf16_f32 v191, v46, v47
  v_mfma_f32_32x32x16_bf16 v[80:95], v[196:199], v[184:187], v[80:95]
  ds_read_b128 v[232:235], v3 offset:13600
  ds_read_b128 v[236:239], v4 offset:544
  v_exp_f32 v48, v48
  v_exp_f32 v49, v49
  v_mfma_f32_32x32x16_bf16 v[96:111], v[200:203], v[184:187], v[96:111]
  v_exp_f32 v50, v50
  v_exp_f32 v51, v51
  v_exp_f32_e64 v52, v52
  v_mfma_f32_32x32x16_bf16 v[64:79], v[204:207], v[188:191], v[64:79]
  v_exp_f32 v53, v53
  v_exp_f32 v54, v54
  v_exp_f32_e64 v55, v55
  v_mfma_f32_32x32x16_bf16 v[80:95], v[208:211], v[188:191], v[80:95]
  ds_read_b128 a[204:207], v0 offset:3072
  ds_read_b128 a[208:211], v0 offset:4096
  ds_read_b128 a[212:215], v0 offset:5120
  v_exp_f32 v56, v56
  v_exp_f32 v57, v57
  v_mfma_f32_32x32x16_bf16 v[96:111], v[212:215], v[188:191], v[96:111]
  s_waitcnt lgkmcnt(3)
  v_exp_f32 v58, v58
  v_exp_f32 v59, v59
  v_exp_f32 v60, v60
  v_exp_f32 v61, v61
  v_exp_f32 v62, v62
  v_exp_f32_e64 v63, v63
  v_pk_add_f32 v[12:13], v[12:13], v[148:149]
  v_pk_fma_f32 v[14:15], v[148:149], v[148:149], v[14:15]
  v_pk_add_f32 v[12:13], v[12:13], v[150:151]
  v_pk_fma_f32 v[14:15], v[150:151], v[150:151], v[14:15]
  v_pk_fma_f32 v[48:49], v[48:49], s[22:23], s[22:23]
  v_pk_fma_f32 v[50:51], v[50:51], s[22:23], s[22:23]
  v_pk_fma_f32 v[52:53], v[52:53], s[22:23], s[22:23]
  v_pk_fma_f32 v[54:55], v[54:55], s[22:23], s[22:23]
  v_pk_fma_f32 v[56:57], v[56:57], s[22:23], s[22:23]
  v_pk_fma_f32 v[58:59], v[58:59], s[22:23], s[22:23]
  v_pk_fma_f32 v[60:61], v[60:61], s[22:23], s[22:23]
  v_pk_fma_f32 v[62:63], v[62:63], s[22:23], s[22:23]
  v_mfma_f32_32x32x16_bf16 v[32:47], a[144:147], v[160:163], 0
  ds_read_b128 v[192:195], v0 offset:36864
  ds_read_b128 v[196:199], v0 offset:37888
  v_rcp_f32 v48, v48
  v_rcp_f32 v49, v49
  v_mfma_f32_16x16x32_bf16 v[152:155], v[216:219], v[220:223], 0
  ds_read_b128 v[216:219], v3 offset:4400
  ds_read_b128 v[220:223], v4 offset:176
  v_mfma_f32_32x32x16_bf16 v[32:47], a[148:151], v[164:167], v[32:47]
  ds_read_b128 v[200:203], v0 offset:38912
  ds_read_b128 v[204:207], v0 offset:39936
  v_rcp_f32 v50, v50
  v_rcp_f32 v51, v51
  v_mfma_f32_16x16x32_bf16 v[152:155], v[224:227], v[228:231], v[152:155]
  ds_read_b128 v[224:227], v3 offset:9200
  ds_read_b128 v[228:231], v4 offset:368
  v_mfma_f32_32x32x16_bf16 v[32:47], a[152:155], v[168:171], v[32:47]
  ds_read_b128 v[208:211], v0 offset:40960
  ds_read_b128 v[212:215], v0 offset:41984
  v_rcp_f32 v52, v52
  v_rcp_f32 v53, v53
  v_mfma_f32_16x16x32_bf16 v[152:155], v[232:235], v[236:239], v[152:155]
  ds_read_b128 v[232:235], v3 offset:14000
  ds_read_b128 v[236:239], v4 offset:560
  v_mfma_f32_32x32x16_bf16 v[32:47], a[156:159], v[172:175], v[32:47]
  v_rcp_f32 v54, v54
  v_rcp_f32 v55, v55
  v_rcp_f32_e64 v56, v56
  v_mfma_f32_32x32x16_bf16 v[32:47], a[160:163], v[176:179], v[32:47]
  ds_read_b128 a[216:219], v0 offset:6144
  ds_read_b128 a[220:223], v0 offset:7168
  ds_read_b128 a[224:227], v0 offset:8192
  v_rcp_f32 v57, v57
  v_rcp_f32 v58, v58
  v_mfma_f32_32x32x16_bf16 v[32:47], a[164:167], v[180:183], v[32:47]
  s_waitcnt lgkmcnt(3)
  v_rcp_f32 v59, v59
  v_rcp_f32 v60, v60
  v_rcp_f32 v61, v61
  v_rcp_f32 v62, v62
  v_rcp_f32 v63, v63
  v_pk_mul_f32 v[16:17], v[16:17], v[48:49]
  v_pk_mul_f32 v[18:19], v[18:19], v[50:51]
  v_pk_mul_f32 v[20:21], v[20:21], v[52:53]
  v_pk_mul_f32 v[22:23], v[22:23], v[54:55]
  v_pk_mul_f32 v[24:25], v[24:25], v[56:57]
  v_pk_mul_f32 v[26:27], v[26:27], v[58:59]
  v_pk_mul_f32 v[28:29], v[28:29], v[60:61]
  v_pk_mul_f32 v[30:31], v[30:31], v[62:63]
  v_pk_add_f32 v[12:13], v[12:13], v[152:153]
  v_pk_fma_f32 v[14:15], v[152:153], v[152:153], v[14:15]
  v_pk_add_f32 v[12:13], v[12:13], v[154:155]
  v_pk_fma_f32 v[14:15], v[154:155], v[154:155], v[14:15]
  v_pk_fma_f32 v[48:49], v[32:33], v[32:33], s[20:21] neg_lo:[1,0,1] neg_hi:[1,0,1]
  v_pk_fma_f32 v[50:51], v[34:35], v[34:35], s[20:21] neg_lo:[1,0,1] neg_hi:[1,0,1]
  v_pk_fma_f32 v[52:53], v[36:37], v[36:37], s[20:21] neg_lo:[1,0,1] neg_hi:[1,0,1]
  v_pk_fma_f32 v[54:55], v[38:39], v[38:39], s[20:21] neg_lo:[1,0,1] neg_hi:[1,0,1]
  v_pk_fma_f32 v[56:57], v[40:41], v[40:41], s[20:21] neg_lo:[1,0,1] neg_hi:[1,0,1]
  v_pk_fma_f32 v[58:59], v[42:43], v[42:43], s[20:21] neg_lo:[1,0,1] neg_hi:[1,0,1]
  v_pk_fma_f32 v[60:61], v[44:45], v[44:45], s[20:21] neg_lo:[1,0,1] neg_hi:[1,0,1]
  v_pk_fma_f32 v[62:63], v[46:47], v[46:47], s[20:21] neg_lo:[1,0,1] neg_hi:[1,0,1]
  v_pk_mul_f32 v[48:49], v[32:33], v[48:49]
  v_pk_mul_f32 v[50:51], v[34:35], v[50:51]
  v_pk_mul_f32 v[52:53], v[36:37], v[52:53]
  v_pk_mul_f32 v[54:55], v[38:39], v[54:55]
  v_pk_mul_f32 v[56:57], v[40:41], v[56:57]
  v_pk_mul_f32 v[58:59], v[42:43], v[58:59]
  v_pk_mul_f32 v[60:61], v[44:45], v[60:61]
  v_pk_mul_f32 v[62:63], v[46:47], v[62:63]
  v_mfma_f32_16x16x32_bf16 v[156:159], v[216:219], v[220:223], 0
  v_cvt_pk_bf16_f32 v184, v16, v17
  v_cvt_pk_bf16_f32 v185, v18, v19
  v_mfma_f32_16x16x32_bf16 v[156:159], v[224:227], v[228:231], v[156:159]
  v_cvt_pk_bf16_f32 v186, v20, v21
  v_cvt_pk_bf16_f32 v187, v22, v23
  v_mfma_f32_16x16x32_bf16 v[156:159], v[232:235], v[236:239], v[156:159]
  ds_read_b128 v[216:219], v3
  ds_read_b128 v[220:223], v4
  v_mfma_f32_32x32x16_bf16 v[64:79], v[192:195], v[184:187], v[64:79]
  ds_read_b128 v[224:227], v3 offset:4800
  ds_read_b128 v[228:231], v4 offset:192
  v_cvt_pk_bf16_f32 v188, v24, v25
  v_cvt_pk_bf16_f32 v189, v26, v27
  v_cvt_pk_bf16_f32 v190, v28, v29
  v_cvt_pk_bf16_f32 v191, v30, v31
  v_mfma_f32_32x32x16_bf16 v[80:95], v[196:199], v[184:187], v[80:95]
  ds_read_b128 v[232:235], v3 offset:9600
  ds_read_b128 v[236:239], v4 offset:384
  v_exp_f32 v48, v48
  v_exp_f32 v49, v49
  v_mfma_f32_32x32x16_bf16 v[96:111], v[200:203], v[184:187], v[96:111]
  v_exp_f32 v50, v50
  v_exp_f32 v51, v51
  v_exp_f32_e64 v52, v52
  v_mfma_f32_32x32x16_bf16 v[64:79], v[204:207], v[188:191], v[64:79]
  v_exp_f32 v53, v53
  v_exp_f32 v54, v54
  v_exp_f32_e64 v55, v55
  v_mfma_f32_32x32x16_bf16 v[80:95], v[208:211], v[188:191], v[80:95]
  ds_read_b128 a[228:231], v0 offset:9216
  ds_read_b128 a[232:235], v0 offset:10240
  ds_read_b128 a[236:239], v0 offset:11264
  v_exp_f32 v56, v56
  v_exp_f32 v57, v57
  v_mfma_f32_32x32x16_bf16 v[96:111], v[212:215], v[188:191], v[96:111]
  s_waitcnt lgkmcnt(3)
  v_exp_f32 v58, v58
  v_exp_f32 v59, v59
  v_exp_f32 v60, v60
  v_exp_f32 v61, v61
  v_exp_f32 v62, v62
  v_exp_f32_e64 v63, v63
  v_pk_add_f32 v[12:13], v[12:13], v[156:157]
  v_pk_fma_f32 v[14:15], v[156:157], v[156:157], v[14:15]
  v_pk_add_f32 v[12:13], v[12:13], v[158:159]
  v_pk_fma_f32 v[14:15], v[158:159], v[158:159], v[14:15]
  v_pk_fma_f32 v[48:49], v[48:49], s[22:23], s[22:23]
  v_pk_fma_f32 v[50:51], v[50:51], s[22:23], s[22:23]
  v_pk_fma_f32 v[52:53], v[52:53], s[22:23], s[22:23]
  v_pk_fma_f32 v[54:55], v[54:55], s[22:23], s[22:23]
  v_pk_fma_f32 v[56:57], v[56:57], s[22:23], s[22:23]
  v_pk_fma_f32 v[58:59], v[58:59], s[22:23], s[22:23]
  v_pk_fma_f32 v[60:61], v[60:61], s[22:23], s[22:23]
  v_pk_fma_f32 v[62:63], v[62:63], s[22:23], s[22:23]
  v_mfma_f32_32x32x16_bf16 v[16:31], a[168:171], v[160:163], 0
  ds_read_b128 v[192:195], v0 offset:43008
  ds_read_b128 v[196:199], v0 offset:44032
  v_rcp_f32 v48, v48
  v_rcp_f32 v49, v49
  v_mfma_f32_16x16x32_bf16 v[112:115], v[216:219], v[220:223], 0
  ds_read_b128 v[216:219], v3 offset:400
  ds_read_b128 v[220:223], v4 offset:16
  v_mfma_f32_32x32x16_bf16 v[16:31], a[172:175], v[164:167], v[16:31]
  ds_read_b128 v[200:203], v0 offset:45056
  ds_read_b128 v[204:207], v0 offset:46080
  v_rcp_f32 v50, v50
  v_rcp_f32 v51, v51
  v_mfma_f32_16x16x32_bf16 v[112:115], v[224:227], v[228:231], v[112:115]
  ds_read_b128 v[224:227], v3 offset:5200
  ds_read_b128 v[228:231], v4 offset:208
  v_mfma_f32_32x32x16_bf16 v[16:31], a[176:179], v[168:171], v[16:31]
  ds_read_b128 v[208:211], v0 offset:47104
  ds_read_b128 v[212:215], v0 offset:48128
  v_rcp_f32 v52, v52
  v_rcp_f32 v53, v53
  v_mfma_f32_16x16x32_bf16 v[112:115], v[232:235], v[236:239], v[112:115]
  ds_read_b128 v[232:235], v3 offset:10000
  ds_read_b128 v[236:239], v4 offset:400
  v_mfma_f32_32x32x16_bf16 v[16:31], a[180:183], v[172:175], v[16:31]
  v_rcp_f32 v54, v54
  v_rcp_f32 v55, v55
  v_rcp_f32_e64 v56, v56
  v_mfma_f32_32x32x16_bf16 v[16:31], a[184:187], v[176:179], v[16:31]
  v_rcp_f32 v57, v57
  v_rcp_f32 v58, v58
  v_rcp_f32_e64 v59, v59
  v_mfma_f32_32x32x16_bf16 v[16:31], a[188:191], v[180:183], v[16:31]
  s_waitcnt lgkmcnt(0)
  v_rcp_f32 v60, v60
  v_rcp_f32 v61, v61
  v_rcp_f32 v62, v62
  v_rcp_f32_e64 v63, v63
  v_pk_mul_f32 v[32:33], v[32:33], v[48:49]
  v_pk_mul_f32 v[34:35], v[34:35], v[50:51]
  v_pk_mul_f32 v[36:37], v[36:37], v[52:53]
  v_pk_mul_f32 v[38:39], v[38:39], v[54:55]
  v_pk_mul_f32 v[40:41], v[40:41], v[56:57]
  v_pk_mul_f32 v[42:43], v[42:43], v[58:59]
  v_pk_mul_f32 v[44:45], v[44:45], v[60:61]
  v_pk_mul_f32 v[46:47], v[46:47], v[62:63]
  v_pk_add_f32 v[12:13], v[12:13], v[112:113]
  v_pk_fma_f32 v[14:15], v[112:113], v[112:113], v[14:15]
  v_pk_add_f32 v[12:13], v[12:13], v[114:115]
  v_pk_fma_f32 v[14:15], v[114:115], v[114:115], v[14:15]
  v_pk_fma_f32 v[48:49], v[16:17], v[16:17], s[20:21] neg_lo:[1,0,1] neg_hi:[1,0,1]
  v_pk_fma_f32 v[50:51], v[18:19], v[18:19], s[20:21] neg_lo:[1,0,1] neg_hi:[1,0,1]
  v_pk_fma_f32 v[52:53], v[20:21], v[20:21], s[20:21] neg_lo:[1,0,1] neg_hi:[1,0,1]
  v_pk_fma_f32 v[54:55], v[22:23], v[22:23], s[20:21] neg_lo:[1,0,1] neg_hi:[1,0,1]
  v_pk_fma_f32 v[56:57], v[24:25], v[24:25], s[20:21] neg_lo:[1,0,1] neg_hi:[1,0,1]
  v_pk_fma_f32 v[58:59], v[26:27], v[26:27], s[20:21] neg_lo:[1,0,1] neg_hi:[1,0,1]
  v_pk_fma_f32 v[60:61], v[28:29], v[28:29], s[20:21] neg_lo:[1,0,1] neg_hi:[1,0,1]
  v_pk_fma_f32 v[62:63], v[30:31], v[30:31], s[20:21] neg_lo:[1,0,1] neg_hi:[1,0,1]
  v_pk_mul_f32 v[48:49], v[16:17], v[48:49]
  v_pk_mul_f32 v[50:51], v[18:19], v[50:51]
  v_pk_mul_f32 v[52:53], v[20:21], v[52:53]
  v_pk_mul_f32 v[54:55], v[22:23], v[54:55]
  v_pk_mul_f32 v[56:57], v[24:25], v[56:57]
  v_pk_mul_f32 v[58:59], v[26:27], v[58:59]
  v_pk_mul_f32 v[60:61], v[28:29], v[60:61]
  v_pk_mul_f32 v[62:63], v[30:31], v[62:63]
  v_mfma_f32_16x16x32_bf16 v[116:119], v[216:219], v[220:223], 0
  v_cvt_pk_bf16_f32 v184, v32, v33
  v_cvt_pk_bf16_f32 v185, v34, v35
  v_mfma_f32_16x16x32_bf16 v[116:119], v[224:227], v[228:231], v[116:119]
  v_cvt_pk_bf16_f32 v186, v36, v37
  v_cvt_pk_bf16_f32 v187, v38, v39
  v_mfma_f32_16x16x32_bf16 v[116:119], v[232:235], v[236:239], v[116:119]
  ds_read_b128 v[216:219], v3 offset:800
  ds_read_b128 v[220:223], v4 offset:32
  v_mfma_f32_32x32x16_bf16 v[64:79], v[192:195], v[184:187], v[64:79]
  ds_read_b128 v[224:227], v3 offset:5600
  ds_read_b128 v[228:231], v4 offset:224
  v_cvt_pk_bf16_f32 v188, v40, v41
  v_cvt_pk_bf16_f32 v189, v42, v43
  v_cvt_pk_bf16_f32 v190, v44, v45
  v_cvt_pk_bf16_f32 v191, v46, v47
  v_mfma_f32_32x32x16_bf16 v[80:95], v[196:199], v[184:187], v[80:95]
  ds_read_b128 v[232:235], v3 offset:10400
  ds_read_b128 v[236:239], v4 offset:416
  v_exp_f32 v48, v48
  v_exp_f32 v49, v49
  v_mfma_f32_32x32x16_bf16 v[96:111], v[200:203], v[184:187], v[96:111]
  v_exp_f32 v50, v50
  v_exp_f32 v51, v51
  v_exp_f32_e64 v52, v52
  v_mfma_f32_32x32x16_bf16 v[64:79], v[204:207], v[188:191], v[64:79]
  v_exp_f32 v53, v53
  v_exp_f32 v54, v54
  v_exp_f32_e64 v55, v55
  v_mfma_f32_32x32x16_bf16 v[80:95], v[208:211], v[188:191], v[80:95]
  v_exp_f32 v56, v56
  v_exp_f32 v57, v57
  v_exp_f32_e64 v58, v58
  v_mfma_f32_32x32x16_bf16 v[96:111], v[212:215], v[188:191], v[96:111]
  s_waitcnt lgkmcnt(0)
  v_exp_f32 v59, v59
  v_exp_f32 v60, v60
  v_exp_f32 v61, v61
  v_exp_f32 v62, v62
  v_exp_f32 v63, v63
  v_pk_add_f32 v[12:13], v[12:13], v[116:117]
  v_pk_fma_f32 v[14:15], v[116:117], v[116:117], v[14:15]
  v_pk_add_f32 v[12:13], v[12:13], v[118:119]
  v_pk_fma_f32 v[14:15], v[118:119], v[118:119], v[14:15]
  v_pk_fma_f32 v[48:49], v[48:49], s[22:23], s[22:23]
  v_pk_fma_f32 v[50:51], v[50:51], s[22:23], s[22:23]
  v_pk_fma_f32 v[52:53], v[52:53], s[22:23], s[22:23]
  v_pk_fma_f32 v[54:55], v[54:55], s[22:23], s[22:23]
  v_pk_fma_f32 v[56:57], v[56:57], s[22:23], s[22:23]
  v_pk_fma_f32 v[58:59], v[58:59], s[22:23], s[22:23]
  v_pk_fma_f32 v[60:61], v[60:61], s[22:23], s[22:23]
  v_pk_fma_f32 v[62:63], v[62:63], s[22:23], s[22:23]
  v_mfma_f32_32x32x16_bf16 v[32:47], a[192:195], v[160:163], 0
  ds_read_b128 v[192:195], v0 offset:49152
  ds_read_b128 v[196:199], v0 offset:50176
  v_rcp_f32 v48, v48
  v_rcp_f32 v49, v49
  v_mfma_f32_16x16x32_bf16 v[120:123], v[216:219], v[220:223], 0
  ds_read_b128 v[216:219], v3 offset:1200
  ds_read_b128 v[220:223], v4 offset:48
  v_mfma_f32_32x32x16_bf16 v[32:47], a[196:199], v[164:167], v[32:47]
  ds_read_b128 v[200:203], v0 offset:51200
  ds_read_b128 v[204:207], v0 offset:52224
  v_rcp_f32 v50, v50
  v_rcp_f32 v51, v51
  v_mfma_f32_16x16x32_bf16 v[120:123], v[224:227], v[228:231], v[120:123]
  ds_read_b128 v[224:227], v3 offset:6000
  ds_read_b128 v[228:231], v4 offset:240
  v_mfma_f32_32x32x16_bf16 v[32:47], a[200:203], v[168:171], v[32:47]
  ds_read_b128 v[208:211], v0 offset:53248
  ds_read_b128 v[212:215], v0 offset:54272
  v_rcp_f32 v52, v52
  v_rcp_f32 v53, v53
  v_mfma_f32_16x16x32_bf16 v[120:123], v[232:235], v[236:239], v[120:123]
  ds_read_b128 v[232:235], v3 offset:10800
  ds_read_b128 v[236:239], v4 offset:432
  v_mfma_f32_32x32x16_bf16 v[32:47], a[204:207], v[172:175], v[32:47]
  v_rcp_f32 v54, v54
  v_rcp_f32 v55, v55
  v_rcp_f32_e64 v56, v56
  v_mfma_f32_32x32x16_bf16 v[32:47], a[208:211], v[176:179], v[32:47]
  v_rcp_f32 v57, v57
  v_rcp_f32 v58, v58
  v_rcp_f32_e64 v59, v59
  v_mfma_f32_32x32x16_bf16 v[32:47], a[212:215], v[180:183], v[32:47]
  s_waitcnt lgkmcnt(0)
  v_rcp_f32 v60, v60
  v_rcp_f32 v61, v61
  v_rcp_f32 v62, v62
  v_rcp_f32_e64 v63, v63
  v_pk_mul_f32 v[16:17], v[16:17], v[48:49]
  v_pk_mul_f32 v[18:19], v[18:19], v[50:51]
  v_pk_mul_f32 v[20:21], v[20:21], v[52:53]
  v_pk_mul_f32 v[22:23], v[22:23], v[54:55]
  v_pk_mul_f32 v[24:25], v[24:25], v[56:57]
  v_pk_mul_f32 v[26:27], v[26:27], v[58:59]
  v_pk_mul_f32 v[28:29], v[28:29], v[60:61]
  v_pk_mul_f32 v[30:31], v[30:31], v[62:63]
  v_pk_add_f32 v[12:13], v[12:13], v[120:121]
  v_pk_fma_f32 v[14:15], v[120:121], v[120:121], v[14:15]
  v_pk_add_f32 v[12:13], v[12:13], v[122:123]
  v_pk_fma_f32 v[14:15], v[122:123], v[122:123], v[14:15]
  v_pk_fma_f32 v[48:49], v[32:33], v[32:33], s[20:21] neg_lo:[1,0,1] neg_hi:[1,0,1]
  v_pk_fma_f32 v[50:51], v[34:35], v[34:35], s[20:21] neg_lo:[1,0,1] neg_hi:[1,0,1]
  v_pk_fma_f32 v[52:53], v[36:37], v[36:37], s[20:21] neg_lo:[1,0,1] neg_hi:[1,0,1]
  v_pk_fma_f32 v[54:55], v[38:39], v[38:39], s[20:21] neg_lo:[1,0,1] neg_hi:[1,0,1]
  v_pk_fma_f32 v[56:57], v[40:41], v[40:41], s[20:21] neg_lo:[1,0,1] neg_hi:[1,0,1]
  v_pk_fma_f32 v[58:59], v[42:43], v[42:43], s[20:21] neg_lo:[1,0,1] neg_hi:[1,0,1]
  v_pk_fma_f32 v[60:61], v[44:45], v[44:45], s[20:21] neg_lo:[1,0,1] neg_hi:[1,0,1]
  v_pk_fma_f32 v[62:63], v[46:47], v[46:47], s[20:21] neg_lo:[1,0,1] neg_hi:[1,0,1]
  v_pk_mul_f32 v[48:49], v[32:33], v[48:49]
  v_pk_mul_f32 v[50:51], v[34:35], v[50:51]
  v_pk_mul_f32 v[52:53], v[36:37], v[52:53]
  v_pk_mul_f32 v[54:55], v[38:39], v[54:55]
  v_pk_mul_f32 v[56:57], v[40:41], v[56:57]
  v_pk_mul_f32 v[58:59], v[42:43], v[58:59]
  v_pk_mul_f32 v[60:61], v[44:45], v[60:61]
  v_pk_mul_f32 v[62:63], v[46:47], v[62:63]
  v_mfma_f32_16x16x32_bf16 v[124:127], v[216:219], v[220:223], 0
  v_cvt_pk_bf16_f32 v184, v16, v17
  v_cvt_pk_bf16_f32 v185, v18, v19
  v_mfma_f32_16x16x32_bf16 v[124:127], v[224:227], v[228:231], v[124:127]
  v_cvt_pk_bf16_f32 v186, v20, v21
  v_cvt_pk_bf16_f32 v187, v22, v23
  v_mfma_f32_16x16x32_bf16 v[124:127], v[232:235], v[236:239], v[124:127]
  ds_read_b128 v[216:219], v3 offset:1600
  ds_read_b128 v[220:223], v4 offset:64
  v_mfma_f32_32x32x16_bf16 v[64:79], v[192:195], v[184:187], v[64:79]
  ds_read_b128 v[224:227], v3 offset:6400
  ds_read_b128 v[228:231], v4 offset:256
  v_cvt_pk_bf16_f32 v188, v24, v25
  v_cvt_pk_bf16_f32 v189, v26, v27
  v_cvt_pk_bf16_f32 v190, v28, v29
  v_cvt_pk_bf16_f32 v191, v30, v31
  v_mfma_f32_32x32x16_bf16 v[80:95], v[196:199], v[184:187], v[80:95]
  ds_read_b128 v[232:235], v3 offset:11200
  ds_read_b128 v[236:239], v4 offset:448
  v_exp_f32 v48, v48
  v_exp_f32 v49, v49
  v_mfma_f32_32x32x16_bf16 v[96:111], v[200:203], v[184:187], v[96:111]
  v_exp_f32 v50, v50
  v_exp_f32 v51, v51
  v_exp_f32_e64 v52, v52
  v_mfma_f32_32x32x16_bf16 v[64:79], v[204:207], v[188:191], v[64:79]
  v_exp_f32 v53, v53
  v_exp_f32 v54, v54
  v_exp_f32_e64 v55, v55
  v_mfma_f32_32x32x16_bf16 v[80:95], v[208:211], v[188:191], v[80:95]
  v_exp_f32 v56, v56
  v_exp_f32 v57, v57
  v_exp_f32_e64 v58, v58
  v_mfma_f32_32x32x16_bf16 v[96:111], v[212:215], v[188:191], v[96:111]
  s_waitcnt lgkmcnt(0)
  v_exp_f32 v59, v59
  v_exp_f32 v60, v60
  v_exp_f32 v61, v61
  v_exp_f32 v62, v62
  v_exp_f32 v63, v63
  v_pk_add_f32 v[12:13], v[12:13], v[124:125]
  v_pk_fma_f32 v[14:15], v[124:125], v[124:125], v[14:15]
  v_pk_add_f32 v[12:13], v[12:13], v[126:127]
  v_pk_fma_f32 v[14:15], v[126:127], v[126:127], v[14:15]
  v_pk_fma_f32 v[48:49], v[48:49], s[22:23], s[22:23]
  v_pk_fma_f32 v[50:51], v[50:51], s[22:23], s[22:23]
  v_pk_fma_f32 v[52:53], v[52:53], s[22:23], s[22:23]
  v_pk_fma_f32 v[54:55], v[54:55], s[22:23], s[22:23]
  v_pk_fma_f32 v[56:57], v[56:57], s[22:23], s[22:23]
  v_pk_fma_f32 v[58:59], v[58:59], s[22:23], s[22:23]
  v_pk_fma_f32 v[60:61], v[60:61], s[22:23], s[22:23]
  v_pk_fma_f32 v[62:63], v[62:63], s[22:23], s[22:23]
  v_mfma_f32_32x32x16_bf16 v[16:31], a[216:219], v[160:163], 0
  ds_read_b128 v[192:195], v0 offset:55296
  ds_read_b128 v[196:199], v0 offset:56320
  v_rcp_f32 v48, v48
  v_rcp_f32 v49, v49
  v_mfma_f32_16x16x32_bf16 v[128:131], v[216:219], v[220:223], 0
  ds_read_b128 v[216:219], v3 offset:2000
  ds_read_b128 v[220:223], v4 offset:80
  v_mfma_f32_32x32x16_bf16 v[16:31], a[220:223], v[164:167], v[16:31]
  ds_read_b128 v[200:203], v0 offset:57344
  ds_read_b128 v[204:207], v0 offset:58368
  v_rcp_f32 v50, v50
  v_rcp_f32 v51, v51
  v_mfma_f32_16x16x32_bf16 v[128:131], v[224:227], v[228:231], v[128:131]
  ds_read_b128 v[224:227], v3 offset:6800
  ds_read_b128 v[228:231], v4 offset:272
  v_mfma_f32_32x32x16_bf16 v[16:31], a[224:227], v[168:171], v[16:31]
  ds_read_b128 v[208:211], v0 offset:59392
  ds_read_b128 v[212:215], v0 offset:60416
  v_rcp_f32 v52, v52
  v_rcp_f32 v53, v53
  v_mfma_f32_16x16x32_bf16 v[128:131], v[232:235], v[236:239], v[128:131]
  ds_read_b128 v[232:235], v3 offset:11600
  ds_read_b128 v[236:239], v4 offset:464
  v_mfma_f32_32x32x16_bf16 v[16:31], a[228:231], v[172:175], v[16:31]
  v_rcp_f32 v54, v54
  v_rcp_f32 v55, v55
  v_rcp_f32_e64 v56, v56
  v_mfma_f32_32x32x16_bf16 v[16:31], a[232:235], v[176:179], v[16:31]
  v_rcp_f32 v57, v57
  v_rcp_f32 v58, v58
  v_rcp_f32_e64 v59, v59
  v_mfma_f32_32x32x16_bf16 v[16:31], a[236:239], v[180:183], v[16:31]
  s_waitcnt lgkmcnt(0)
  v_rcp_f32 v60, v60
  v_rcp_f32 v61, v61
  v_rcp_f32 v62, v62
  v_rcp_f32_e64 v63, v63
  v_pk_mul_f32 v[32:33], v[32:33], v[48:49]
  v_pk_mul_f32 v[34:35], v[34:35], v[50:51]
  v_pk_mul_f32 v[36:37], v[36:37], v[52:53]
  v_pk_mul_f32 v[38:39], v[38:39], v[54:55]
  v_pk_mul_f32 v[40:41], v[40:41], v[56:57]
  v_pk_mul_f32 v[42:43], v[42:43], v[58:59]
  v_pk_mul_f32 v[44:45], v[44:45], v[60:61]
  v_pk_mul_f32 v[46:47], v[46:47], v[62:63]
  v_pk_add_f32 v[12:13], v[12:13], v[128:129]
  v_pk_fma_f32 v[14:15], v[128:129], v[128:129], v[14:15]
  v_pk_add_f32 v[12:13], v[12:13], v[130:131]
  v_pk_fma_f32 v[14:15], v[130:131], v[130:131], v[14:15]
  v_pk_fma_f32 v[48:49], v[16:17], v[16:17], s[20:21] neg_lo:[1,0,1] neg_hi:[1,0,1]
  v_pk_fma_f32 v[50:51], v[18:19], v[18:19], s[20:21] neg_lo:[1,0,1] neg_hi:[1,0,1]
  v_pk_fma_f32 v[52:53], v[20:21], v[20:21], s[20:21] neg_lo:[1,0,1] neg_hi:[1,0,1]
  v_pk_fma_f32 v[54:55], v[22:23], v[22:23], s[20:21] neg_lo:[1,0,1] neg_hi:[1,0,1]
  v_pk_fma_f32 v[56:57], v[24:25], v[24:25], s[20:21] neg_lo:[1,0,1] neg_hi:[1,0,1]
  v_pk_fma_f32 v[58:59], v[26:27], v[26:27], s[20:21] neg_lo:[1,0,1] neg_hi:[1,0,1]
  v_pk_fma_f32 v[60:61], v[28:29], v[28:29], s[20:21] neg_lo:[1,0,1] neg_hi:[1,0,1]
  v_pk_fma_f32 v[62:63], v[30:31], v[30:31], s[20:21] neg_lo:[1,0,1] neg_hi:[1,0,1]
  v_pk_mul_f32 v[48:49], v[16:17], v[48:49]
  v_pk_mul_f32 v[50:51], v[18:19], v[50:51]
  v_pk_mul_f32 v[52:53], v[20:21], v[52:53]
  v_pk_mul_f32 v[54:55], v[22:23], v[54:55]
  v_pk_mul_f32 v[56:57], v[24:25], v[56:57]
  v_pk_mul_f32 v[58:59], v[26:27], v[58:59]
  v_pk_mul_f32 v[60:61], v[28:29], v[60:61]
  v_pk_mul_f32 v[62:63], v[30:31], v[62:63]
  v_mfma_f32_16x16x32_bf16 v[132:135], v[216:219], v[220:223], 0
  v_cvt_pk_bf16_f32 v184, v32, v33
  v_cvt_pk_bf16_f32 v185, v34, v35
  v_mfma_f32_16x16x32_bf16 v[132:135], v[224:227], v[228:231], v[132:135]
  v_cvt_pk_bf16_f32 v186, v36, v37
  v_cvt_pk_bf16_f32 v187, v38, v39
  v_mfma_f32_16x16x32_bf16 v[132:135], v[232:235], v[236:239], v[132:135]
  ds_read_b128 v[216:219], v0 offset:12288
  ds_read_b128 v[220:223], v0 offset:13312
  v_mfma_f32_32x32x16_bf16 v[64:79], v[192:195], v[184:187], v[64:79]
  ds_read_b128 v[224:227], v0 offset:14336
  ds_read_b128 v[228:231], v0 offset:15360
  v_cvt_pk_bf16_f32 v188, v40, v41
  v_cvt_pk_bf16_f32 v189, v42, v43
  v_cvt_pk_bf16_f32 v190, v44, v45
  v_cvt_pk_bf16_f32 v191, v46, v47
  v_mfma_f32_32x32x16_bf16 v[80:95], v[196:199], v[184:187], v[80:95]
  ds_read_b128 v[232:235], v0 offset:16384
  ds_read_b128 v[236:239], v0 offset:17408
  v_exp_f32 v48, v48
  v_exp_f32 v49, v49
  v_mfma_f32_32x32x16_bf16 v[96:111], v[200:203], v[184:187], v[96:111]
  v_exp_f32 v50, v50
  v_exp_f32 v51, v51
  v_exp_f32_e64 v52, v52
  v_mfma_f32_32x32x16_bf16 v[64:79], v[204:207], v[188:191], v[64:79]
  s_mov_b32 s28, s34
  v_exp_f32 v53, v53
  v_exp_f32 v54, v54
  v_exp_f32 v55, v55
  v_mfma_f32_32x32x16_bf16 v[80:95], v[208:211], v[188:191], v[80:95]
  s_add_u32 s34, s34, 0x60000
  v_exp_f32 v56, v56
  v_exp_f32 v57, v57
  v_exp_f32_e64 v58, v58
  v_mfma_f32_32x32x16_bf16 v[96:111], v[212:215], v[188:191], v[96:111]
  s_waitcnt lgkmcnt(0)
  v_exp_f32 v59, v59
  v_exp_f32 v60, v60
  v_exp_f32 v61, v61
  v_exp_f32 v62, v62
  v_exp_f32 v63, v63
  v_pk_add_f32 v[12:13], v[12:13], v[132:133]
  v_pk_fma_f32 v[14:15], v[132:133], v[132:133], v[14:15]
  v_pk_add_f32 v[12:13], v[12:13], v[134:135]
  v_pk_fma_f32 v[14:15], v[134:135], v[134:135], v[14:15]
  v_pk_fma_f32 v[48:49], v[48:49], s[22:23], s[22:23]
  v_pk_fma_f32 v[50:51], v[50:51], s[22:23], s[22:23]
  v_pk_fma_f32 v[52:53], v[52:53], s[22:23], s[22:23]
  v_pk_fma_f32 v[54:55], v[54:55], s[22:23], s[22:23]
  v_pk_fma_f32 v[56:57], v[56:57], s[22:23], s[22:23]
  v_pk_fma_f32 v[58:59], v[58:59], s[22:23], s[22:23]
  v_pk_fma_f32 v[60:61], v[60:61], s[22:23], s[22:23]
  v_pk_fma_f32 v[62:63], v[62:63], s[22:23], s[22:23]
  v_mfma_f32_32x32x16_bf16 v[32:47], v[216:219], v[160:163], 0
  ds_read_b128 v[192:195], v0 offset:61440
  ds_read_b128 v[196:199], v0 offset:62464
  v_rcp_f32 v48, v48
  v_rcp_f32 v49, v49
  v_add_f32_e64 v12, v12, v13
  v_mfma_f32_32x32x16_bf16 v[32:47], v[220:223], v[164:167], v[32:47]
  ds_read_b128 v[200:203], v0 offset:63488
  ds_read_b128 v[204:207], v0 offset:64512
  v_rcp_f32 v50, v50
  v_add_f32 v14, v14, v15
  v_rcp_f32_e64 v51, v51
  v_mfma_f32_32x32x16_bf16 v[32:47], v[224:227], v[168:171], v[32:47]
  ds_read_b128 v[208:211], v1
  ds_read_b128 v[212:215], v1 offset:1024
  v_permlane32_swap_b32 v12, v14
  v_rcp_f32 v52, v52
  v_add_f32 v12, v12, v14
  v_rcp_f32 v53, v53
  v_mfma_f32_32x32x16_bf16 v[32:47], v[228:231], v[172:175], v[32:47]
  v_mov_b32 v14, v12
  v_rcp_f32 v54, v54
  s_nop 0
  v_permlane32_swap_b32 v12, v14
  v_rcp_f32 v55, v55
  v_mul_f32 v12, s24, v12
  v_mfma_f32_32x32x16_bf16 v[32:47], v[232:235], v[176:179], v[32:47]
  v_rcp_f32 v56, v56
  v_rcp_f32 v57, v57
  v_mul_f32 v13, s24, v14
  v_rcp_f32 v58, v58
  v_fma_f32 v13, -v12, v12, v13
  v_mfma_f32_32x32x16_bf16 v[32:47], v[236:239], v[180:183], v[32:47]
  s_waitcnt lgkmcnt(0)
  v_rcp_f32 v59, v59
  v_max_f32 v13, 0, v13
  v_rcp_f32 v60, v60
  v_add_f32 v13, s25, v13
  v_rcp_f32 v61, v61
  v_rsq_f32 v13, v13
  v_rcp_f32 v62, v62
  v_mul_f32 v14, s22, v13
  v_rcp_f32 v63, v63
  v_mul_f32_e64 v12, -v12, v14
  v_pk_mul_f32 v[16:17], v[16:17], v[48:49]
  v_pk_mul_f32 v[18:19], v[18:19], v[50:51]
  v_pk_mul_f32 v[20:21], v[20:21], v[52:53]
  v_pk_mul_f32 v[22:23], v[22:23], v[54:55]
  v_pk_mul_f32 v[24:25], v[24:25], v[56:57]
  v_pk_mul_f32 v[26:27], v[26:27], v[58:59]
  v_pk_mul_f32 v[28:29], v[28:29], v[60:61]
  v_pk_mul_f32 v[30:31], v[30:31], v[62:63]
  v_pk_fma_f32 v[112:113], v[112:113], v[14:15], v[12:13] op_sel_hi:[1,0,0]
  v_pk_fma_f32 v[114:115], v[114:115], v[14:15], v[12:13] op_sel_hi:[1,0,0]
  v_pk_fma_f32 v[116:117], v[116:117], v[14:15], v[12:13] op_sel_hi:[1,0,0]
  v_pk_fma_f32 v[118:119], v[118:119], v[14:15], v[12:13] op_sel_hi:[1,0,0]
  v_pk_fma_f32 v[120:121], v[120:121], v[14:15], v[12:13] op_sel_hi:[1,0,0]
  v_pk_fma_f32 v[122:123], v[122:123], v[14:15], v[12:13] op_sel_hi:[1,0,0]
  v_pk_fma_f32 v[124:125], v[124:125], v[14:15], v[12:13] op_sel_hi:[1,0,0]
  v_pk_fma_f32 v[126:127], v[126:127], v[14:15], v[12:13] op_sel_hi:[1,0,0]
  v_pk_fma_f32 v[128:129], v[128:129], v[14:15], v[12:13] op_sel_hi:[1,0,0]
  v_pk_fma_f32 v[130:131], v[130:131], v[14:15], v[12:13] op_sel_hi:[1,0,0]
  v_pk_fma_f32 v[132:133], v[132:133], v[14:15], v[12:13] op_sel_hi:[1,0,0]
  v_pk_fma_f32 v[134:135], v[134:135], v[14:15], v[12:13] op_sel_hi:[1,0,0]
  v_pk_fma_f32 v[136:137], v[136:137], v[14:15], v[12:13] op_sel_hi:[1,0,0]
  v_pk_fma_f32 v[138:139], v[138:139], v[14:15], v[12:13] op_sel_hi:[1,0,0]
  v_pk_fma_f32 v[140:141], v[140:141], v[14:15], v[12:13] op_sel_hi:[1,0,0]
  v_pk_fma_f32 v[142:143], v[142:143], v[14:15], v[12:13] op_sel_hi:[1,0,0]
  v_pk_fma_f32 v[144:145], v[144:145], v[14:15], v[12:13] op_sel_hi:[1,0,0]
  v_pk_fma_f32 v[146:147], v[146:147], v[14:15], v[12:13] op_sel_hi:[1,0,0]
  v_pk_fma_f32 v[148:149], v[148:149], v[14:15], v[12:13] op_sel_hi:[1,0,0]
  v_pk_fma_f32 v[150:151], v[150:151], v[14:15], v[12:13] op_sel_hi:[1,0,0]
  v_pk_fma_f32 v[152:153], v[152:153], v[14:15], v[12:13] op_sel_hi:[1,0,0]
  v_pk_fma_f32 v[154:155], v[154:155], v[14:15], v[12:13] op_sel_hi:[1,0,0]
  v_pk_fma_f32 v[156:157], v[156:157], v[14:15], v[12:13] op_sel_hi:[1,0,0]
  v_pk_fma_f32 v[158:159], v[158:159], v[14:15], v[12:13] op_sel_hi:[1,0,0]
  v_pk_fma_f32 v[48:49], v[32:33], v[32:33], s[20:21] neg_lo:[1,0,1] neg_hi:[1,0,1]
  v_pk_fma_f32 v[50:51], v[34:35], v[34:35], s[20:21] neg_lo:[1,0,1] neg_hi:[1,0,1]
  v_pk_fma_f32 v[52:53], v[36:37], v[36:37], s[20:21] neg_lo:[1,0,1] neg_hi:[1,0,1]
  v_pk_fma_f32 v[54:55], v[38:39], v[38:39], s[20:21] neg_lo:[1,0,1] neg_hi:[1,0,1]
  v_pk_fma_f32 v[56:57], v[40:41], v[40:41], s[20:21] neg_lo:[1,0,1] neg_hi:[1,0,1]
  v_pk_fma_f32 v[58:59], v[42:43], v[42:43], s[20:21] neg_lo:[1,0,1] neg_hi:[1,0,1]
  v_pk_fma_f32 v[60:61], v[44:45], v[44:45], s[20:21] neg_lo:[1,0,1] neg_hi:[1,0,1]
  v_pk_fma_f32 v[62:63], v[46:47], v[46:47], s[20:21] neg_lo:[1,0,1] neg_hi:[1,0,1]
  v_pk_mul_f32 v[48:49], v[32:33], v[48:49]
  v_pk_mul_f32 v[50:51], v[34:35], v[50:51]
  v_pk_mul_f32 v[52:53], v[36:37], v[52:53]
  v_pk_mul_f32 v[54:55], v[38:39], v[54:55]
  v_pk_mul_f32 v[56:57], v[40:41], v[56:57]
  v_cvt_pk_bf16_f32 v184, v16, v17
  v_cvt_pk_bf16_f32 v185, v18, v19
  v_cvt_pk_bf16_f32 v186, v20, v21
  v_cvt_pk_bf16_f32 v187, v22, v23
  v_pk_mul_f32 v[58:59], v[42:43], v[58:59]
  v_pk_mul_f32 v[60:61], v[44:45], v[60:61]
  v_pk_mul_f32 v[62:63], v[46:47], v[62:63]
  v_mfma_f32_32x32x16_bf16 v[64:79], v[192:195], v[184:187], v[64:79]
  ds_read_b128 v[216:219], v0 offset:18432
  ds_read_b128 v[220:223], v0 offset:19456
  v_cvt_pk_bf16_f32 v188, v24, v25
  v_cvt_pk_bf16_f32 v189, v26, v27
  v_cvt_pk_bf16_f32 v190, v28, v29
  v_cvt_pk_bf16_f32 v191, v30, v31
  v_exp_f32_e64 v48, v48
  v_cndmask_b32 v159, v159, v250, s[12:13]
  v_mfma_f32_32x32x16_bf16 v[80:95], v[196:199], v[184:187], v[80:95]
  ds_read_b128 v[224:227], v0 offset:20480
  ds_read_b128 v[228:231], v0 offset:21504
  v_exp_f32_e64 v49, v49
  v_cvt_pk_bf16_f32 v160, v112, v113
  v_cvt_pk_bf16_f32 v161, v114, v115
  v_exp_f32_e64 v50, v50
  v_cvt_pk_bf16_f32 v162, v116, v117
  v_mfma_f32_32x32x16_bf16 v[96:111], v[200:203], v[184:187], v[96:111]
  ds_read_b128 v[232:235], v0 offset:22528
  ds_read_b128 v[236:239], v0 offset:23552
  v_exp_f32_e64 v51, v51
  v_cvt_pk_bf16_f32 v163, v118, v119
  v_cvt_pk_bf16_f32 v164, v120, v121
  v_exp_f32_e64 v52, v52
  v_cvt_pk_bf16_f32 v165, v122, v123
  v_mfma_f32_32x32x16_bf16 v[64:79], v[204:207], v[188:191], v[64:79]
  v_exp_f32_e64 v53, v53
  v_cvt_pk_bf16_f32 v166, v124, v125
  v_cvt_pk_bf16_f32 v167, v126, v127
  v_exp_f32_e64 v54, v54
  v_cvt_pk_bf16_f32 v168, v128, v129
  v_exp_f32_e64 v55, v55
  v_cvt_pk_bf16_f32 v169, v130, v131
  v_cvt_pk_bf16_f32 v170, v132, v133
  v_mfma_f32_32x32x16_bf16 v[80:95], v[208:211], v[188:191], v[80:95]
  v_exp_f32_e64 v56, v56
  v_cvt_pk_bf16_f32 v171, v134, v135
  v_cvt_pk_bf16_f32 v172, v136, v137
  v_exp_f32_e64 v57, v57
  v_cvt_pk_bf16_f32 v173, v138, v139
  v_exp_f32_e64 v58, v58
  v_cvt_pk_bf16_f32 v174, v140, v141
  v_cvt_pk_bf16_f32 v175, v142, v143
  v_mfma_f32_32x32x16_bf16 v[96:111], v[212:215], v[188:191], v[96:111]
  s_waitcnt lgkmcnt(0)
  v_exp_f32 v59, v59
  v_cvt_pk_bf16_f32 v176, v144, v145
  v_exp_f32_e64 v60, v60
  v_cvt_pk_bf16_f32 v177, v146, v147
  v_cvt_pk_bf16_f32 v178, v148, v149
  v_exp_f32_e64 v61, v61
  v_cvt_pk_bf16_f32 v179, v150, v151
  v_exp_f32_e64 v62, v62
  v_cvt_pk_bf16_f32 v180, v152, v153
  v_cvt_pk_bf16_f32 v181, v154, v155
  v_exp_f32_e64 v63, v63
  v_cvt_pk_bf16_f32 v182, v156, v157
  v_cvt_pk_bf16_f32 v183, v158, v159
  v_pk_fma_f32 v[48:49], v[48:49], s[22:23], s[22:23]
  v_pk_fma_f32 v[50:51], v[50:51], s[22:23], s[22:23]
  v_pk_fma_f32 v[52:53], v[52:53], s[22:23], s[22:23]
  v_pk_fma_f32 v[54:55], v[54:55], s[22:23], s[22:23]
  v_pk_fma_f32 v[56:57], v[56:57], s[22:23], s[22:23]
  v_pk_fma_f32 v[58:59], v[58:59], s[22:23], s[22:23]
  v_pk_fma_f32 v[60:61], v[60:61], s[22:23], s[22:23]
  v_pk_fma_f32 v[62:63], v[62:63], s[22:23], s[22:23]
  s_mov_b32 s26, 6
  .p2align 6
  s_nop 0
  s_waitcnt vmcnt(0)
S_loop:
  v_mfma_f32_32x32x16_bf16 v[16:31], v[216:219], v[160:163], 0
  ds_read_b128 v[192:195], v1 offset:2048
  ds_read_b128 v[196:199], v1 offset:3072
  ds_read_b128 v[200:203], v1 offset:4096
  v_rcp_f32 v48, v48
  v_rcp_f32 v49, v49
  v_mfma_f32_32x32x16_bf16 v[16:31], v[220:223], v[164:167], v[16:31]
  ds_read_b128 v[204:207], v1 offset:5120
  ds_read_b128 v[208:211], v1 offset:6144
  ds_read_b128 v[212:215], v1 offset:7168
  v_rcp_f32 v50, v50
  v_rcp_f32 v51, v51
  v_mfma_f32_32x32x16_bf16 v[16:31], v[224:227], v[168:171], v[16:31]
  ds_read_b128 v[136:139], v5
  ds_read_b128 v[140:143], v5 offset:32
  ds_read_b128 v[144:147], v5 offset:64
  v_rcp_f32 v52, v52
  v_rcp_f32 v53, v53
  v_mfma_f32_32x32x16_bf16 v[16:31], v[228:231], v[172:175], v[16:31]
  ds_read_b128 v[148:151], v5 offset:96
  ds_read_b128 v[152:155], v5 offset:128
  ds_read_b128 v[156:159], v5 offset:160
  v_rcp_f32 v54, v54
  v_rcp_f32 v55, v55
  v_mfma_f32_32x32x16_bf16 v[16:31], v[232:235], v[176:179], v[16:31]
  v_rcp_f32 v56, v56
  v_rcp_f32 v57, v57
  v_rcp_f32_e64 v58, v58
  v_mfma_f32_32x32x16_bf16 v[16:31], v[236:239], v[180:183], v[16:31]
  s_waitcnt lgkmcnt(0)
  v_rcp_f32 v59, v59
  v_rcp_f32 v60, v60
  v_rcp_f32 v61, v61
  v_rcp_f32 v62, v62
  v_rcp_f32 v63, v63
  v_pk_mul_f32 v[32:33], v[32:33], v[48:49]
  v_pk_mul_f32 v[34:35], v[34:35], v[50:51]
  v_pk_mul_f32 v[36:37], v[36:37], v[52:53]
  v_pk_mul_f32 v[38:39], v[38:39], v[54:55]
  v_pk_mul_f32 v[40:41], v[40:41], v[56:57]
  v_pk_mul_f32 v[42:43], v[42:43], v[58:59]
  v_pk_mul_f32 v[44:45], v[44:45], v[60:61]
  v_pk_mul_f32 v[46:47], v[46:47], v[62:63]
  v_pk_fma_f32 v[48:49], v[16:17], v[16:17], s[20:21] neg_lo:[1,0,1] neg_hi:[1,0,1]
  v_pk_fma_f32 v[50:51], v[18:19], v[18:19], s[20:21] neg_lo:[1,0,1] neg_hi:[1,0,1]
  v_pk_fma_f32 v[52:53], v[20:21], v[20:21], s[20:21] neg_lo:[1,0,1] neg_hi:[1,0,1]
  v_pk_fma_f32 v[54:55], v[22:23], v[22:23], s[20:21] neg_lo:[1,0,1] neg_hi:[1,0,1]
  v_pk_fma_f32 v[56:57], v[24:25], v[24:25], s[20:21] neg_lo:[1,0,1] neg_hi:[1,0,1]
  v_pk_fma_f32 v[58:59], v[26:27], v[26:27], s[20:21] neg_lo:[1,0,1] neg_hi:[1,0,1]
  v_pk_fma_f32 v[60:61], v[28:29], v[28:29], s[20:21] neg_lo:[1,0,1] neg_hi:[1,0,1]
  v_pk_fma_f32 v[62:63], v[30:31], v[30:31], s[20:21] neg_lo:[1,0,1] neg_hi:[1,0,1]
  v_pk_mul_f32 v[48:49], v[16:17], v[48:49]
  v_pk_mul_f32 v[50:51], v[18:19], v[50:51]
  v_pk_mul_f32 v[52:53], v[20:21], v[52:53]
  v_pk_mul_f32 v[54:55], v[22:23], v[54:55]
  v_pk_mul_f32 v[56:57], v[24:25], v[56:57]
  v_cvt_pk_bf16_f32 v184, v32, v33
  v_cvt_pk_bf16_f32 v185, v34, v35
  v_cvt_pk_bf16_f32 v186, v36, v37
  v_cvt_pk_bf16_f32 v187, v38, v39
  v_pk_mul_f32 v[58:59], v[26:27], v[58:59]
  v_pk_mul_f32 v[60:61], v[28:29], v[60:61]
  v_pk_mul_f32 v[62:63], v[30:31], v[62:63]
  v_mfma_f32_32x32x16_bf16 v[64:79], v[192:195], v[184:187], v[64:79]
  s_mov_b32 m0, s30
  v_cvt_pk_bf16_f32 v188, v40, v41
  v_cvt_pk_bf16_f32 v189, v42, v43
  v_cvt_pk_bf16_f32 v190, v44, v45
  v_cvt_pk_bf16_f32 v191, v46, v47
  v_exp_f32 v48, v48
  v_mfma_f32_32x32x16_bf16 v[80:95], v[196:199], v[184:187], v[80:95]
  buffer_load_dwordx4 v6, s[4:7], s29 offen lds
  v_exp_f32 v49, v49
  v_exp_f32 v50, v50
  v_exp_f32_e64 v51, v51
  v_mfma_f32_32x32x16_bf16 v[96:111], v[200:203], v[184:187], v[96:111]
  buffer_load_dwordx4 v7, s[4:7], s29 offen offset:1024 lds
  v_exp_f32 v52, v52
  v_exp_f32 v53, v53
  v_mfma_f32_32x32x16_bf16 v[64:79], v[204:207], v[188:191], v[64:79]
  buffer_load_dwordx4 v8, s[4:7], s29 offen offset:2048 lds
  v_exp_f32 v54, v54
  v_exp_f32 v55, v55
  v_exp_f32_e64 v56, v56
  v_mfma_f32_32x32x16_bf16 v[80:95], v[208:211], v[188:191], v[80:95]
  buffer_load_dwordx4 v9, s[4:7], s29 offen offset:3072 lds
  v_exp_f32 v57, v57
  v_exp_f32 v58, v58
  v_mfma_f32_32x32x16_bf16 v[96:111], v[212:215], v[188:191], v[96:111]
  v_exp_f32 v59, v59
  v_exp_f32 v60, v60
  v_exp_f32 v61, v61
  v_exp_f32 v62, v62
  v_exp_f32_e64 v63, v63
  v_pk_fma_f32 v[48:49], v[48:49], s[22:23], s[22:23]
  v_pk_fma_f32 v[50:51], v[50:51], s[22:23], s[22:23]
  v_pk_fma_f32 v[52:53], v[52:53], s[22:23], s[22:23]
  v_pk_fma_f32 v[54:55], v[54:55], s[22:23], s[22:23]
  v_pk_fma_f32 v[56:57], v[56:57], s[22:23], s[22:23]
  v_pk_fma_f32 v[58:59], v[58:59], s[22:23], s[22:23]
  v_pk_fma_f32 v[60:61], v[60:61], s[22:23], s[22:23]
  v_pk_fma_f32 v[62:63], v[62:63], s[22:23], s[22:23]
  v_mfma_f32_32x32x16_bf16 v[32:47], a[0:3], v[160:163], 0
  v_cvt_pk_bf16_f32 v112, v64, v65
  v_cvt_pk_bf16_f32 v113, v66, v67
  v_cvt_pk_bf16_f32 v114, v68, v69
  v_cvt_pk_bf16_f32 v115, v70, v71
  v_cvt_pk_bf16_f32 v116, v72, v73
  v_cvt_pk_bf16_f32 v117, v74, v75
  v_mfma_f32_32x32x16_bf16 v[32:47], a[4:7], v[164:167], v[32:47]
  v_cvt_pk_bf16_f32 v118, v76, v77
  v_cvt_pk_bf16_f32 v119, v78, v79
  v_cvt_pk_bf16_f32 v120, v80, v81
  v_cvt_pk_bf16_f32 v121, v82, v83
  v_cvt_pk_bf16_f32 v122, v84, v85
  v_cvt_pk_bf16_f32 v123, v86, v87
  v_mfma_f32_32x32x16_bf16 v[32:47], a[8:11], v[168:171], v[32:47]
  ds_read_b128 v[64:67], v2
  ds_read_b128 v[68:71], v2 offset:32
  ds_read_b128 v[72:75], v2 offset:64
  ds_read_b128 v[76:79], v2 offset:96
  v_cvt_pk_bf16_f32 v124, v88, v89
  v_cvt_pk_bf16_f32 v125, v90, v91
  v_mfma_f32_32x32x16_bf16 v[32:47], a[12:15], v[172:175], v[32:47]
  ds_read_b128 v[192:195], v1 offset:8192
  ds_read_b128 v[196:199], v1 offset:9216
  v_cvt_pk_bf16_f32 v126, v92, v93
  v_cvt_pk_bf16_f32 v127, v94, v95
  v_cvt_pk_bf16_f32 v128, v96, v97
  v_cvt_pk_bf16_f32 v129, v98, v99
  v_mfma_f32_32x32x16_bf16 v[32:47], a[16:19], v[176:179], v[32:47]
  ds_read_b128 v[80:83], v2 offset:128
  ds_read_b128 v[84:87], v2 offset:160
  ds_read_b128 v[88:91], v2 offset:192
  ds_read_b128 v[92:95], v2 offset:224
  v_cvt_pk_bf16_f32 v130, v100, v101
  v_cvt_pk_bf16_f32 v131, v102, v103
  v_mfma_f32_32x32x16_bf16 v[32:47], a[20:23], v[180:183], v[32:47]
  s_nop 0
  s_waitcnt lgkmcnt(6)
  ds_read_b128 v[200:203], v1 offset:10240
  ds_read_b128 v[204:207], v1 offset:11264
  v_cvt_pk_bf16_f32 v132, v104, v105
  v_cvt_pk_bf16_f32 v133, v106, v107
  v_cvt_pk_bf16_f32 v134, v108, v109
  v_cvt_pk_bf16_f32 v135, v110, v111
  v_mfma_f32_32x32x16_bf16 v[64:79], v[240:243], v[136:139], v[64:79]
  ds_read_b128 v[96:99], v2 offset:256
  ds_read_b128 v[100:103], v2 offset:288
  ds_read_b128 v[104:107], v2 offset:320
  ds_read_b128 v[108:111], v2 offset:352
  v_rcp_f32 v48, v48
  v_mfma_f32_32x32x16_bf16 v[64:79], v[244:247], v[140:143], v[64:79]
  s_waitcnt lgkmcnt(6)
  ds_read_b128 v[208:211], v1 offset:12288
  ds_read_b128 v[212:215], v1 offset:13312
  v_rcp_f32 v49, v49
  v_rcp_f32 v50, v50
  v_mfma_f32_32x32x16_bf16 v[80:95], v[240:243], v[144:147], v[80:95]
  v_rcp_f32 v51, v51
  v_rcp_f32 v52, v52
  v_rcp_f32_e64 v53, v53
  v_mfma_f32_32x32x16_bf16 v[80:95], v[244:247], v[148:151], v[80:95]
  s_waitcnt lgkmcnt(2)
  v_rcp_f32 v54, v54
  v_rcp_f32 v55, v55
  v_rcp_f32 v56, v56
  v_mfma_f32_32x32x16_bf16 v[96:111], v[240:243], v[152:155], v[96:111]
  v_rcp_f32 v57, v57
  v_rcp_f32 v58, v58
  v_rcp_f32_e64 v59, v59
  v_mfma_f32_32x32x16_bf16 v[96:111], v[244:247], v[156:159], v[96:111]
  s_waitcnt lgkmcnt(0)
  v_rcp_f32 v60, v60
  v_rcp_f32 v61, v61
  v_rcp_f32 v62, v62
  v_rcp_f32_e64 v63, v63
  v_pk_mul_f32 v[16:17], v[16:17], v[48:49]
  v_pk_mul_f32 v[18:19], v[18:19], v[50:51]
  v_pk_mul_f32 v[20:21], v[20:21], v[52:53]
  v_pk_mul_f32 v[22:23], v[22:23], v[54:55]
  v_pk_mul_f32 v[24:25], v[24:25], v[56:57]
  v_pk_mul_f32 v[26:27], v[26:27], v[58:59]
  v_pk_mul_f32 v[28:29], v[28:29], v[60:61]
  v_pk_mul_f32 v[30:31], v[30:31], v[62:63]
  v_pk_fma_f32 v[48:49], v[32:33], v[32:33], s[20:21] neg_lo:[1,0,1] neg_hi:[1,0,1]
  v_pk_fma_f32 v[50:51], v[34:35], v[34:35], s[20:21] neg_lo:[1,0,1] neg_hi:[1,0,1]
  v_pk_fma_f32 v[52:53], v[36:37], v[36:37], s[20:21] neg_lo:[1,0,1] neg_hi:[1,0,1]
  v_pk_fma_f32 v[54:55], v[38:39], v[38:39], s[20:21] neg_lo:[1,0,1] neg_hi:[1,0,1]
  v_pk_fma_f32 v[56:57], v[40:41], v[40:41], s[20:21] neg_lo:[1,0,1] neg_hi:[1,0,1]
  v_pk_fma_f32 v[58:59], v[42:43], v[42:43], s[20:21] neg_lo:[1,0,1] neg_hi:[1,0,1]
  v_pk_fma_f32 v[60:61], v[44:45], v[44:45], s[20:21] neg_lo:[1,0,1] neg_hi:[1,0,1]
  v_pk_fma_f32 v[62:63], v[46:47], v[46:47], s[20:21] neg_lo:[1,0,1] neg_hi:[1,0,1]
  v_pk_mul_f32 v[48:49], v[32:33], v[48:49]
  v_pk_mul_f32 v[50:51], v[34:35], v[50:51]
  v_pk_mul_f32 v[52:53], v[36:37], v[52:53]
  v_pk_mul_f32 v[54:55], v[38:39], v[54:55]
  v_pk_mul_f32 v[56:57], v[40:41], v[56:57]
  v_cvt_pk_bf16_f32 v184, v16, v17
  v_cvt_pk_bf16_f32 v185, v18, v19
  v_cvt_pk_bf16_f32 v186, v20, v21
  v_cvt_pk_bf16_f32 v187, v22, v23
  v_pk_mul_f32 v[58:59], v[42:43], v[58:59]
  v_pk_mul_f32 v[60:61], v[44:45], v[60:61]
  v_pk_mul_f32 v[62:63], v[46:47], v[62:63]
  v_mfma_f32_32x32x16_bf16 v[64:79], v[192:195], v[184:187], v[64:79]
  s_mov_b32 m0, s31
  v_cvt_pk_bf16_f32 v188, v24, v25
  v_cvt_pk_bf16_f32 v189, v26, v27
  v_cvt_pk_bf16_f32 v190, v28, v29
  v_cvt_pk_bf16_f32 v191, v30, v31
  v_exp_f32 v48, v48
  v_mfma_f32_32x32x16_bf16 v[80:95], v[196:199], v[184:187], v[80:95]
  buffer_load_dwordx4 v6, s[4:7], s52 offen lds
  v_exp_f32 v49, v49
  v_exp_f32 v50, v50
  v_exp_f32_e64 v51, v51
  v_mfma_f32_32x32x16_bf16 v[96:111], v[200:203], v[184:187], v[96:111]
  buffer_load_dwordx4 v7, s[4:7], s52 offen offset:1024 lds
  v_exp_f32 v52, v52
  v_exp_f32 v53, v53
  v_mfma_f32_32x32x16_bf16 v[64:79], v[204:207], v[188:191], v[64:79]
  buffer_load_dwordx4 v8, s[4:7], s52 offen offset:2048 lds
  v_exp_f32 v54, v54
  v_exp_f32 v55, v55
  v_exp_f32_e64 v56, v56
  v_mfma_f32_32x32x16_bf16 v[80:95], v[208:211], v[188:191], v[80:95]
  buffer_load_dwordx4 v9, s[4:7], s52 offen offset:3072 lds
  v_exp_f32 v57, v57
  v_exp_f32 v58, v58
  v_mfma_f32_32x32x16_bf16 v[96:111], v[212:215], v[188:191], v[96:111]
  v_exp_f32 v59, v59
  v_exp_f32 v60, v60
  v_exp_f32 v61, v61
  v_exp_f32 v62, v62
  v_exp_f32_e64 v63, v63
  v_pk_fma_f32 v[48:49], v[48:49], s[22:23], s[22:23]
  v_pk_fma_f32 v[50:51], v[50:51], s[22:23], s[22:23]
  v_pk_fma_f32 v[52:53], v[52:53], s[22:23], s[22:23]
  v_pk_fma_f32 v[54:55], v[54:55], s[22:23], s[22:23]
  v_pk_fma_f32 v[56:57], v[56:57], s[22:23], s[22:23]
  v_pk_fma_f32 v[58:59], v[58:59], s[22:23], s[22:23]
  v_pk_fma_f32 v[60:61], v[60:61], s[22:23], s[22:23]
  v_pk_fma_f32 v[62:63], v[62:63], s[22:23], s[22:23]
  v_mfma_f32_32x32x16_bf16 v[16:31], a[24:27], v[160:163], 0
  ds_read_b128 v[192:195], v1 offset:14336
  ds_read_b128 v[196:199], v1 offset:15360
  v_rcp_f32 v48, v48
  v_rcp_f32 v49, v49
  v_mfma_f32_32x32x16_bf16 v[16:31], a[28:31], v[164:167], v[16:31]
  ds_read_b128 v[200:203], v1 offset:16384
  ds_read_b128 v[204:207], v1 offset:17408
  v_rcp_f32 v50, v50
  v_rcp_f32 v51, v51
  v_mfma_f32_32x32x16_bf16 v[16:31], a[32:35], v[168:171], v[16:31]
  ds_read_b128 v[208:211], v1 offset:18432
  ds_read_b128 v[212:215], v1 offset:19456
  v_rcp_f32 v52, v52
  v_rcp_f32 v53, v53
  v_mfma_f32_32x32x16_bf16 v[16:31], a[36:39], v[172:175], v[16:31]
  buffer_store_dwordx4 v[112:115], v10, s[8:11], s28 offen
  v_rcp_f32 v54, v54
  v_rcp_f32 v55, v55
  v_mfma_f32_32x32x16_bf16 v[16:31], a[40:43], v[176:179], v[16:31]
  v_rcp_f32 v56, v56
  v_rcp_f32 v57, v57
  v_rcp_f32_e64 v58, v58
  v_mfma_f32_32x32x16_bf16 v[16:31], a[44:47], v[180:183], v[16:31]
  s_waitcnt lgkmcnt(0)
  v_rcp_f32 v59, v59
  v_rcp_f32 v60, v60
  v_rcp_f32 v61, v61
  v_rcp_f32 v62, v62
  v_rcp_f32 v63, v63
  v_pk_mul_f32 v[32:33], v[32:33], v[48:49]
  v_pk_mul_f32 v[34:35], v[34:35], v[50:51]
  v_pk_mul_f32 v[36:37], v[36:37], v[52:53]
  v_pk_mul_f32 v[38:39], v[38:39], v[54:55]
  v_pk_mul_f32 v[40:41], v[40:41], v[56:57]
  v_pk_mul_f32 v[42:43], v[42:43], v[58:59]
  v_pk_mul_f32 v[44:45], v[44:45], v[60:61]
  v_pk_mul_f32 v[46:47], v[46:47], v[62:63]
  v_pk_fma_f32 v[48:49], v[16:17], v[16:17], s[20:21] neg_lo:[1,0,1] neg_hi:[1,0,1]
  v_pk_fma_f32 v[50:51], v[18:19], v[18:19], s[20:21] neg_lo:[1,0,1] neg_hi:[1,0,1]
  v_pk_fma_f32 v[52:53], v[20:21], v[20:21], s[20:21] neg_lo:[1,0,1] neg_hi:[1,0,1]
  v_pk_fma_f32 v[54:55], v[22:23], v[22:23], s[20:21] neg_lo:[1,0,1] neg_hi:[1,0,1]
  v_pk_fma_f32 v[56:57], v[24:25], v[24:25], s[20:21] neg_lo:[1,0,1] neg_hi:[1,0,1]
  v_pk_fma_f32 v[58:59], v[26:27], v[26:27], s[20:21] neg_lo:[1,0,1] neg_hi:[1,0,1]
  v_pk_fma_f32 v[60:61], v[28:29], v[28:29], s[20:21] neg_lo:[1,0,1] neg_hi:[1,0,1]
  v_pk_fma_f32 v[62:63], v[30:31], v[30:31], s[20:21] neg_lo:[1,0,1] neg_hi:[1,0,1]
  v_pk_mul_f32 v[48:49], v[16:17], v[48:49]
  v_pk_mul_f32 v[50:51], v[18:19], v[50:51]
  v_pk_mul_f32 v[52:53], v[20:21], v[52:53]
  v_pk_mul_f32 v[54:55], v[22:23], v[54:55]
  v_pk_mul_f32 v[56:57], v[24:25], v[56:57]
  v_cvt_pk_bf16_f32 v184, v32, v33
  v_cvt_pk_bf16_f32 v185, v34, v35
  v_cvt_pk_bf16_f32 v186, v36, v37
  v_cvt_pk_bf16_f32 v187, v38, v39
  v_pk_mul_f32 v[58:59], v[26:27], v[58:59]
  v_pk_mul_f32 v[60:61], v[28:29], v[60:61]
  v_pk_mul_f32 v[62:63], v[30:31], v[62:63]
  v_mfma_f32_32x32x16_bf16 v[64:79], v[192:195], v[184:187], v[64:79]
  v_cvt_pk_bf16_f32 v188, v40, v41
  v_cvt_pk_bf16_f32 v189, v42, v43
  v_cvt_pk_bf16_f32 v190, v44, v45
  v_cvt_pk_bf16_f32 v191, v46, v47
  v_exp_f32_e64 v48, v48
  v_mfma_f32_32x32x16_bf16 v[80:95], v[196:199], v[184:187], v[80:95]
  v_exp_f32 v49, v49
  v_exp_f32 v50, v50
  v_exp_f32_e64 v51, v51
  v_mfma_f32_32x32x16_bf16 v[96:111], v[200:203], v[184:187], v[96:111]
  v_exp_f32 v52, v52
  v_exp_f32 v53, v53
  v_subrev_u32 v11, 0x4100, v5
  v_mfma_f32_32x32x16_bf16 v[64:79], v[204:207], v[188:191], v[64:79]
  v_exp_f32 v54, v54
  v_exp_f32 v55, v55
  v_exp_f32_e64 v56, v56
  v_mfma_f32_32x32x16_bf16 v[80:95], v[208:211], v[188:191], v[80:95]
  v_exp_f32 v57, v57
  v_exp_f32 v58, v58
  v_add_u32 v5, 0x8200, v5
  v_exp_f32_e64 v59, v59
  v_mfma_f32_32x32x16_bf16 v[96:111], v[212:215], v[188:191], v[96:111]
  v_exp_f32 v60, v60
  v_exp_f32 v61, v61
  v_exp_f32 v62, v62
  v_exp_f32 v63, v63
  v_min_u32_e64 v5, v11, v5
  v_pk_fma_f32 v[48:49], v[48:49], s[22:23], s[22:23]
  v_pk_fma_f32 v[50:51], v[50:51], s[22:23], s[22:23]
  v_pk_fma_f32 v[52:53], v[52:53], s[22:23], s[22:23]
  v_pk_fma_f32 v[54:55], v[54:55], s[22:23], s[22:23]
  v_pk_fma_f32 v[56:57], v[56:57], s[22:23], s[22:23]
  v_pk_fma_f32 v[58:59], v[58:59], s[22:23], s[22:23]
  v_pk_fma_f32 v[60:61], v[60:61], s[22:23], s[22:23]
  v_pk_fma_f32 v[62:63], v[62:63], s[22:23], s[22:23]
  v_mfma_f32_32x32x16_bf16 v[32:47], a[48:51], v[160:163], 0
  ds_read_b128 v[192:195], v1 offset:20480
  ds_read_b128 v[196:199], v1 offset:21504
  v_rcp_f32 v48, v48
  v_rcp_f32 v49, v49
  v_mfma_f32_32x32x16_bf16 v[32:47], a[52:55], v[164:167], v[32:47]
  ds_read_b128 v[200:203], v1 offset:22528
  ds_read_b128 v[204:207], v1 offset:23552
  v_rcp_f32 v50, v50
  v_rcp_f32 v51, v51
  v_mfma_f32_32x32x16_bf16 v[32:47], a[56:59], v[168:171], v[32:47]
  ds_read_b128 v[208:211], v1 offset:24576
  ds_read_b128 v[212:215], v1 offset:25600
  v_rcp_f32 v52, v52
  v_rcp_f32 v53, v53
  v_mfma_f32_32x32x16_bf16 v[32:47], a[60:63], v[172:175], v[32:47]
  buffer_store_dwordx4 v[116:119], v10, s[8:11], s28 offen offset:32
  v_rcp_f32 v54, v54
  v_rcp_f32 v55, v55
  v_mfma_f32_32x32x16_bf16 v[32:47], a[64:67], v[176:179], v[32:47]
  v_rcp_f32 v56, v56
  v_rcp_f32 v57, v57
  v_rcp_f32_e64 v58, v58
  v_mfma_f32_32x32x16_bf16 v[32:47], a[68:71], v[180:183], v[32:47]
  s_waitcnt lgkmcnt(0)
  v_rcp_f32 v59, v59
  v_rcp_f32 v60, v60
  v_rcp_f32 v61, v61
  v_rcp_f32 v62, v62
  v_rcp_f32 v63, v63
  v_pk_mul_f32 v[16:17], v[16:17], v[48:49]
  v_pk_mul_f32 v[18:19], v[18:19], v[50:51]
  v_pk_mul_f32 v[20:21], v[20:21], v[52:53]
  v_pk_mul_f32 v[22:23], v[22:23], v[54:55]
  v_pk_mul_f32 v[24:25], v[24:25], v[56:57]
  v_pk_mul_f32 v[26:27], v[26:27], v[58:59]
  v_pk_mul_f32 v[28:29], v[28:29], v[60:61]
  v_pk_mul_f32 v[30:31], v[30:31], v[62:63]
  v_pk_fma_f32 v[48:49], v[32:33], v[32:33], s[20:21] neg_lo:[1,0,1] neg_hi:[1,0,1]
  v_pk_fma_f32 v[50:51], v[34:35], v[34:35], s[20:21] neg_lo:[1,0,1] neg_hi:[1,0,1]
  v_pk_fma_f32 v[52:53], v[36:37], v[36:37], s[20:21] neg_lo:[1,0,1] neg_hi:[1,0,1]
  v_pk_fma_f32 v[54:55], v[38:39], v[38:39], s[20:21] neg_lo:[1,0,1] neg_hi:[1,0,1]
  v_pk_fma_f32 v[56:57], v[40:41], v[40:41], s[20:21] neg_lo:[1,0,1] neg_hi:[1,0,1]
  v_pk_fma_f32 v[58:59], v[42:43], v[42:43], s[20:21] neg_lo:[1,0,1] neg_hi:[1,0,1]
  v_pk_fma_f32 v[60:61], v[44:45], v[44:45], s[20:21] neg_lo:[1,0,1] neg_hi:[1,0,1]
  v_pk_fma_f32 v[62:63], v[46:47], v[46:47], s[20:21] neg_lo:[1,0,1] neg_hi:[1,0,1]
  v_pk_mul_f32 v[48:49], v[32:33], v[48:49]
  v_pk_mul_f32 v[50:51], v[34:35], v[50:51]
  v_pk_mul_f32 v[52:53], v[36:37], v[52:53]
  v_pk_mul_f32 v[54:55], v[38:39], v[54:55]
  v_pk_mul_f32 v[56:57], v[40:41], v[56:57]
  v_cvt_pk_bf16_f32 v184, v16, v17
  v_cvt_pk_bf16_f32 v185, v18, v19
  v_cvt_pk_bf16_f32 v186, v20, v21
  v_cvt_pk_bf16_f32 v187, v22, v23
  v_pk_mul_f32 v[58:59], v[42:43], v[58:59]
  v_pk_mul_f32 v[60:61], v[44:45], v[60:61]
  v_pk_mul_f32 v[62:63], v[46:47], v[62:63]
  v_mfma_f32_32x32x16_bf16 v[64:79], v[192:195], v[184:187], v[64:79]
  s_add_u32 s29, s29, 0x60000
  v_cvt_pk_bf16_f32 v188, v24, v25
  v_cvt_pk_bf16_f32 v189, v26, v27
  v_cvt_pk_bf16_f32 v190, v28, v29
  v_cvt_pk_bf16_f32 v191, v30, v31
  v_exp_f32_e64 v48, v48
  v_mfma_f32_32x32x16_bf16 v[80:95], v[196:199], v[184:187], v[80:95]
  s_add_u32 s52, s52, 0x60000
  v_exp_f32 v49, v49
  v_exp_f32 v50, v50
  v_exp_f32_e64 v51, v51
  v_mfma_f32_32x32x16_bf16 v[96:111], v[200:203], v[184:187], v[96:111]
  s_mov_b32 s32, s30
  v_exp_f32 v52, v52
  v_exp_f32_e64 v53, v53
  v_subrev_u32 v11, 0x4100, v4
  v_mfma_f32_32x32x16_bf16 v[64:79], v[204:207], v[188:191], v[64:79]
  s_add_u32 s30, s33, 32
  v_exp_f32 v54, v54
  v_exp_f32 v55, v55
  v_exp_f32 v56, v56
  v_mfma_f32_32x32x16_bf16 v[80:95], v[208:211], v[188:191], v[80:95]
  s_sub_u32 s33, s31, 0
  v_exp_f32 v57, v57
  v_exp_f32_e64 v58, v58
  v_add_u32 v4, 0x8200, v4
  v_exp_f32_e64 v59, v59
  v_mfma_f32_32x32x16_bf16 v[96:111], v[212:215], v[188:191], v[96:111]
  v_exp_f32 v60, v60
  v_exp_f32 v61, v61
  v_exp_f32 v62, v62
  v_exp_f32 v63, v63
  v_min_u32_e64 v4, v11, v4
  v_pk_fma_f32 v[48:49], v[48:49], s[22:23], s[22:23]
  v_pk_fma_f32 v[50:51], v[50:51], s[22:23], s[22:23]
  v_pk_fma_f32 v[52:53], v[52:53], s[22:23], s[22:23]
  v_pk_fma_f32 v[54:55], v[54:55], s[22:23], s[22:23]
  v_pk_fma_f32 v[56:57], v[56:57], s[22:23], s[22:23]
  v_pk_fma_f32 v[58:59], v[58:59], s[22:23], s[22:23]
  v_pk_fma_f32 v[60:61], v[60:61], s[22:23], s[22:23]
  v_pk_fma_f32 v[62:63], v[62:63], s[22:23], s[22:23]
  v_mfma_f32_32x32x16_bf16 v[16:31], a[72:75], v[160:163], 0
  ds_read_b128 v[192:195], v1 offset:26624
  ds_read_b128 v[196:199], v1 offset:27648
  v_rcp_f32 v48, v48
  v_rcp_f32 v49, v49
  v_mfma_f32_32x32x16_bf16 v[16:31], a[76:79], v[164:167], v[16:31]
  ds_read_b128 v[200:203], v1 offset:28672
  ds_read_b128 v[204:207], v1 offset:29696
  v_rcp_f32 v50, v50
  v_rcp_f32 v51, v51
  v_mfma_f32_32x32x16_bf16 v[16:31], a[80:83], v[168:171], v[16:31]
  ds_read_b128 v[208:211], v1 offset:30720
  ds_read_b128 v[212:215], v1 offset:31744
  v_rcp_f32 v52, v52
  v_rcp_f32 v53, v53
  v_mfma_f32_32x32x16_bf16 v[16:31], a[84:87], v[172:175], v[16:31]
  buffer_load_dword v249, v248, s[4:7], s29 offen
  v_rcp_f32 v54, v54
  v_rcp_f32 v55, v55
  v_mfma_f32_32x32x16_bf16 v[16:31], a[88:91], v[176:179], v[16:31]
  v_rcp_f32 v56, v56
  v_rcp_f32 v57, v57
  v_rcp_f32_e64 v58, v58
  v_mfma_f32_32x32x16_bf16 v[16:31], a[92:95], v[180:183], v[16:31]
  s_waitcnt lgkmcnt(0)
  v_rcp_f32 v59, v59
  v_rcp_f32 v60, v60
  v_rcp_f32 v61, v61
  v_rcp_f32 v62, v62
  v_rcp_f32 v63, v63
  v_pk_mul_f32 v[32:33], v[32:33], v[48:49]
  v_pk_mul_f32 v[34:35], v[34:35], v[50:51]
  v_pk_mul_f32 v[36:37], v[36:37], v[52:53]
  v_pk_mul_f32 v[38:39], v[38:39], v[54:55]
  v_pk_mul_f32 v[40:41], v[40:41], v[56:57]
  v_pk_mul_f32 v[42:43], v[42:43], v[58:59]
  v_pk_mul_f32 v[44:45], v[44:45], v[60:61]
  v_pk_mul_f32 v[46:47], v[46:47], v[62:63]
  v_pk_fma_f32 v[48:49], v[16:17], v[16:17], s[20:21] neg_lo:[1,0,1] neg_hi:[1,0,1]
  v_pk_fma_f32 v[50:51], v[18:19], v[18:19], s[20:21] neg_lo:[1,0,1] neg_hi:[1,0,1]
  v_pk_fma_f32 v[52:53], v[20:21], v[20:21], s[20:21] neg_lo:[1,0,1] neg_hi:[1,0,1]
  v_pk_fma_f32 v[54:55], v[22:23], v[22:23], s[20:21] neg_lo:[1,0,1] neg_hi:[1,0,1]
  v_pk_fma_f32 v[56:57], v[24:25], v[24:25], s[20:21] neg_lo:[1,0,1] neg_hi:[1,0,1]
  v_pk_fma_f32 v[58:59], v[26:27], v[26:27], s[20:21] neg_lo:[1,0,1] neg_hi:[1,0,1]
  v_pk_fma_f32 v[60:61], v[28:29], v[28:29], s[20:21] neg_lo:[1,0,1] neg_hi:[1,0,1]
  v_pk_fma_f32 v[62:63], v[30:31], v[30:31], s[20:21] neg_lo:[1,0,1] neg_hi:[1,0,1]
  v_pk_mul_f32 v[48:49], v[16:17], v[48:49]
  v_pk_mul_f32 v[50:51], v[18:19], v[50:51]
  v_pk_mul_f32 v[52:53], v[20:21], v[52:53]
  v_pk_mul_f32 v[54:55], v[22:23], v[54:55]
  v_pk_mul_f32 v[56:57], v[24:25], v[56:57]
  v_cvt_pk_bf16_f32 v184, v32, v33
  v_cvt_pk_bf16_f32 v185, v34, v35
  v_cvt_pk_bf16_f32 v186, v36, v37
  v_cvt_pk_bf16_f32 v187, v38, v39
  v_pk_mul_f32 v[58:59], v[26:27], v[58:59]
  v_pk_mul_f32 v[60:61], v[28:29], v[60:61]
  v_pk_mul_f32 v[62:63], v[30:31], v[62:63]
  v_mfma_f32_32x32x16_bf16 v[64:79], v[192:195], v[184:187], v[64:79]
  s_nop 0
  s_waitcnt vmcnt(3)
  ds_read_b128 v[220:223], v4 offset:96
  v_cvt_pk_bf16_f32 v188, v40, v41
  v_cvt_pk_bf16_f32 v189, v42, v43
  v_cvt_pk_bf16_f32 v190, v44, v45
  v_cvt_pk_bf16_f32 v191, v46, v47
  v_mfma_f32_32x32x16_bf16 v[80:95], v[196:199], v[184:187], v[80:95]
  ds_read_b128 v[228:231], v4 offset:288
  v_exp_f32 v48, v48
  v_exp_f32 v49, v49
  v_exp_f32_e64 v50, v50
  v_mfma_f32_32x32x16_bf16 v[96:111], v[200:203], v[184:187], v[96:111]
  ds_read_b128 v[236:239], v4 offset:480
  v_exp_f32 v51, v51
  v_exp_f32 v52, v52
  v_mfma_f32_32x32x16_bf16 v[64:79], v[204:207], v[188:191], v[64:79]
  v_exp_f32 v53, v53
  v_exp_f32 v54, v54
  v_exp_f32_e64 v55, v55
  v_mfma_f32_32x32x16_bf16 v[80:95], v[208:211], v[188:191], v[80:95]
  v_exp_f32 v56, v56
  v_exp_f32 v57, v57
  v_exp_f32_e64 v58, v58
  v_mfma_f32_32x32x16_bf16 v[96:111], v[212:215], v[188:191], v[96:111]
  s_waitcnt lgkmcnt(0)
  v_exp_f32 v59, v59
  v_exp_f32 v60, v60
  v_exp_f32 v61, v61
  v_exp_f32 v62, v62
  v_exp_f32 v63, v63
  v_pk_fma_f32 v[48:49], v[48:49], s[22:23], s[22:23]
  v_pk_fma_f32 v[50:51], v[50:51], s[22:23], s[22:23]
  v_pk_fma_f32 v[52:53], v[52:53], s[22:23], s[22:23]
  v_pk_fma_f32 v[54:55], v[54:55], s[22:23], s[22:23]
  v_pk_fma_f32 v[56:57], v[56:57], s[22:23], s[22:23]
  v_pk_fma_f32 v[58:59], v[58:59], s[22:23], s[22:23]
  v_pk_fma_f32 v[60:61], v[60:61], s[22:23], s[22:23]
  v_pk_fma_f32 v[62:63], v[62:63], s[22:23], s[22:23]
  v_mfma_f32_32x32x16_bf16 v[32:47], a[96:99], v[160:163], 0
  ds_read_b128 v[192:195], v0 offset:24576
  ds_read_b128 v[196:199], v0 offset:25600
  v_rcp_f32 v48, v48
  v_rcp_f32 v49, v49
  v_mfma_f32_16x16x32_bf16 v[136:139], a[240:243], v[220:223], 0
  ds_read_b128 v[216:219], v3 offset:2800
  ds_read_b128 v[220:223], v4 offset:112
  v_mfma_f32_32x32x16_bf16 v[32:47], a[100:103], v[164:167], v[32:47]
  ds_read_b128 v[200:203], v0 offset:26624
  ds_read_b128 v[204:207], v0 offset:27648
  v_rcp_f32 v50, v50
  v_rcp_f32 v51, v51
  v_mfma_f32_16x16x32_bf16 v[136:139], a[244:247], v[228:231], v[136:139]
  ds_read_b128 v[224:227], v3 offset:7600
  ds_read_b128 v[228:231], v4 offset:304
  v_mfma_f32_32x32x16_bf16 v[32:47], a[104:107], v[168:171], v[32:47]
  ds_read_b128 v[208:211], v0 offset:28672
  ds_read_b128 v[212:215], v0 offset:29696
  v_rcp_f32 v52, v52
  v_rcp_f32 v53, v53
  v_mfma_f32_16x16x32_bf16 v[136:139], a[248:251], v[236:239], v[136:139]
  ds_read_b128 v[232:235], v3 offset:12400
  ds_read_b128 v[236:239], v4 offset:496
  v_mfma_f32_32x32x16_bf16 v[32:47], a[108:111], v[172:175], v[32:47]
  buffer_store_dwordx4 v[120:123], v10, s[8:11], s28 offen offset:64
  v_rcp_f32 v54, v54
  v_rcp_f32 v55, v55
  v_mfma_f32_32x32x16_bf16 v[32:47], a[112:115], v[176:179], v[32:47]
  v_rcp_f32 v56, v56
  v_rcp_f32 v57, v57
  v_rcp_f32_e64 v58, v58
  v_mfma_f32_32x32x16_bf16 v[32:47], a[116:119], v[180:183], v[32:47]
  s_waitcnt lgkmcnt(0)
  v_rcp_f32 v59, v59
  v_rcp_f32 v60, v60
  v_rcp_f32 v61, v61
  v_rcp_f32 v62, v62
  v_rcp_f32 v63, v63
  v_pk_mul_f32 v[16:17], v[16:17], v[48:49]
  v_pk_mul_f32 v[18:19], v[18:19], v[50:51]
  v_pk_mul_f32 v[20:21], v[20:21], v[52:53]
  v_pk_mul_f32 v[22:23], v[22:23], v[54:55]
  v_pk_mul_f32 v[24:25], v[24:25], v[56:57]
  v_pk_mul_f32 v[26:27], v[26:27], v[58:59]
  v_pk_mul_f32 v[28:29], v[28:29], v[60:61]
  v_pk_mul_f32 v[30:31], v[30:31], v[62:63]
  v_pk_add_f32 v[12:13], v[136:137], v[138:139]
  v_pk_mul_f32 v[14:15], v[136:137], v[136:137]
  v_pk_fma_f32 v[14:15], v[138:139], v[138:139], v[14:15]
  v_pk_fma_f32 v[48:49], v[32:33], v[32:33], s[20:21] neg_lo:[1,0,1] neg_hi:[1,0,1]
  v_pk_fma_f32 v[50:51], v[34:35], v[34:35], s[20:21] neg_lo:[1,0,1] neg_hi:[1,0,1]
  v_pk_fma_f32 v[52:53], v[36:37], v[36:37], s[20:21] neg_lo:[1,0,1] neg_hi:[1,0,1]
  v_pk_fma_f32 v[54:55], v[38:39], v[38:39], s[20:21] neg_lo:[1,0,1] neg_hi:[1,0,1]
  v_pk_fma_f32 v[56:57], v[40:41], v[40:41], s[20:21] neg_lo:[1,0,1] neg_hi:[1,0,1]
  v_pk_fma_f32 v[58:59], v[42:43], v[42:43], s[20:21] neg_lo:[1,0,1] neg_hi:[1,0,1]
  v_pk_fma_f32 v[60:61], v[44:45], v[44:45], s[20:21] neg_lo:[1,0,1] neg_hi:[1,0,1]
  v_pk_fma_f32 v[62:63], v[46:47], v[46:47], s[20:21] neg_lo:[1,0,1] neg_hi:[1,0,1]
  v_pk_mul_f32 v[48:49], v[32:33], v[48:49]
  v_pk_mul_f32 v[50:51], v[34:35], v[50:51]
  v_pk_mul_f32 v[52:53], v[36:37], v[52:53]
  v_pk_mul_f32 v[54:55], v[38:39], v[54:55]
  v_pk_mul_f32 v[56:57], v[40:41], v[56:57]
  v_pk_mul_f32 v[58:59], v[42:43], v[58:59]
  v_pk_mul_f32 v[60:61], v[44:45], v[60:61]
  v_pk_mul_f32 v[62:63], v[46:47], v[62:63]
  v_mfma_f32_16x16x32_bf16 v[140:143], v[216:219], v[220:223], 0
  v_cvt_pk_bf16_f32 v184, v16, v17
  v_cvt_pk_bf16_f32 v185, v18, v19
  v_mfma_f32_16x16x32_bf16 v[140:143], v[224:227], v[228:231], v[140:143]
  v_cvt_pk_bf16_f32 v186, v20, v21
  v_cvt_pk_bf16_f32 v187, v22, v23
  v_mfma_f32_16x16x32_bf16 v[140:143], v[232:235], v[236:239], v[140:143]
  ds_read_b128 v[220:223], v4 offset:128
  v_mfma_f32_32x32x16_bf16 v[64:79], v[192:195], v[184:187], v[64:79]
  ds_read_b128 v[224:227], v3 offset:8000
  ds_read_b128 v[228:231], v4 offset:320
  v_cvt_pk_bf16_f32 v188, v24, v25
  v_cvt_pk_bf16_f32 v189, v26, v27
  v_cvt_pk_bf16_f32 v190, v28, v29
  v_cvt_pk_bf16_f32 v191, v30, v31
  v_mfma_f32_32x32x16_bf16 v[80:95], v[196:199], v[184:187], v[80:95]
  ds_read_b128 v[232:235], v3 offset:12800
  ds_read_b128 v[236:239], v4 offset:512
  v_exp_f32 v48, v48
  v_exp_f32 v49, v49
  v_mfma_f32_32x32x16_bf16 v[96:111], v[200:203], v[184:187], v[96:111]
  s_sub_u32 s31, s32, 32
  v_exp_f32 v50, v50
  v_exp_f32 v51, v51
  v_exp_f32 v52, v52
  v_mfma_f32_32x32x16_bf16 v[64:79], v[204:207], v[188:191], v[64:79]
  v_exp_f32 v53, v53
  v_exp_f32 v54, v54
  v_exp_f32_e64 v55, v55
  v_mfma_f32_32x32x16_bf16 v[80:95], v[208:211], v[188:191], v[80:95]
  v_exp_f32 v56, v56
  v_exp_f32 v57, v57
  v_exp_f32_e64 v58, v58
  v_mfma_f32_32x32x16_bf16 v[96:111], v[212:215], v[188:191], v[96:111]
  s_waitcnt lgkmcnt(0)
  v_exp_f32 v59, v59
  v_exp_f32 v60, v60
  v_exp_f32 v61, v61
  v_exp_f32 v62, v62
  v_exp_f32 v63, v63
  v_pk_add_f32 v[12:13], v[12:13], v[140:141]
  v_pk_fma_f32 v[14:15], v[140:141], v[140:141], v[14:15]
  v_pk_add_f32 v[12:13], v[12:13], v[142:143]
  v_pk_fma_f32 v[14:15], v[142:143], v[142:143], v[14:15]
  v_pk_fma_f32 v[48:49], v[48:49], s[22:23], s[22:23]
  v_pk_fma_f32 v[50:51], v[50:51], s[22:23], s[22:23]
  v_pk_fma_f32 v[52:53], v[52:53], s[22:23], s[22:23]
  v_pk_fma_f32 v[54:55], v[54:55], s[22:23], s[22:23]
  v_pk_fma_f32 v[56:57], v[56:57], s[22:23], s[22:23]
  v_pk_fma_f32 v[58:59], v[58:59], s[22:23], s[22:23]
  v_pk_fma_f32 v[60:61], v[60:61], s[22:23], s[22:23]
  v_pk_fma_f32 v[62:63], v[62:63], s[22:23], s[22:23]
  v_mfma_f32_32x32x16_bf16 v[16:31], a[120:123], v[160:163], 0
  ds_read_b128 v[192:195], v0 offset:30720
  ds_read_b128 v[196:199], v0 offset:31744
  v_rcp_f32 v48, v48
  v_rcp_f32 v49, v49
  v_mfma_f32_16x16x32_bf16 v[144:147], a[252:255], v[220:223], 0
  ds_read_b128 v[216:219], v3 offset:3600
  ds_read_b128 v[220:223], v4 offset:144
  v_mfma_f32_32x32x16_bf16 v[16:31], a[124:127], v[164:167], v[16:31]
  ds_read_b128 v[200:203], v0 offset:32768
  ds_read_b128 v[204:207], v0 offset:33792
  v_rcp_f32 v50, v50
  v_rcp_f32 v51, v51
  v_mfma_f32_16x16x32_bf16 v[144:147], v[224:227], v[228:231], v[144:147]
  ds_read_b128 v[224:227], v3 offset:8400
  ds_read_b128 v[228:231], v4 offset:336
  v_mfma_f32_32x32x16_bf16 v[16:31], a[128:131], v[168:171], v[16:31]
  ds_read_b128 v[208:211], v0 offset:34816
  ds_read_b128 v[212:215], v0 offset:35840
  v_rcp_f32 v52, v52
  v_rcp_f32 v53, v53
  v_mfma_f32_16x16x32_bf16 v[144:147], v[232:235], v[236:239], v[144:147]
  ds_read_b128 v[232:235], v3 offset:13200
  ds_read_b128 v[236:239], v4 offset:528
  v_mfma_f32_32x32x16_bf16 v[16:31], a[132:135], v[172:175], v[16:31]
  buffer_store_dwordx4 v[124:127], v10, s[8:11], s28 offen offset:96
  v_rcp_f32 v54, v54
  v_rcp_f32 v55, v55
  v_mfma_f32_32x32x16_bf16 v[16:31], a[136:139], v[176:179], v[16:31]
  v_rcp_f32 v56, v56
  v_rcp_f32 v57, v57
  v_rcp_f32_e64 v58, v58
  v_mfma_f32_32x32x16_bf16 v[16:31], a[140:143], v[180:183], v[16:31]
  s_waitcnt lgkmcnt(0)
  v_rcp_f32 v59, v59
  v_rcp_f32 v60, v60
  v_rcp_f32 v61, v61
  v_rcp_f32 v62, v62
  v_rcp_f32 v63, v63
  v_pk_mul_f32 v[32:33], v[32:33], v[48:49]
  v_pk_mul_f32 v[34:35], v[34:35], v[50:51]
  v_pk_mul_f32 v[36:37], v[36:37], v[52:53]
  v_pk_mul_f32 v[38:39], v[38:39], v[54:55]
  v_pk_mul_f32 v[40:41], v[40:41], v[56:57]
  v_pk_mul_f32 v[42:43], v[42:43], v[58:59]
  v_pk_mul_f32 v[44:45], v[44:45], v[60:61]
  v_pk_mul_f32 v[46:47], v[46:47], v[62:63]
  v_pk_add_f32 v[12:13], v[12:13], v[144:145]
  v_pk_fma_f32 v[14:15], v[144:145], v[144:145], v[14:15]
  v_pk_add_f32 v[12:13], v[12:13], v[146:147]
  v_pk_fma_f32 v[14:15], v[146:147], v[146:147], v[14:15]
  v_pk_fma_f32 v[48:49], v[16:17], v[16:17], s[20:21] neg_lo:[1,0,1] neg_hi:[1,0,1]
  v_pk_fma_f32 v[50:51], v[18:19], v[18:19], s[20:21] neg_lo:[1,0,1] neg_hi:[1,0,1]
  v_pk_fma_f32 v[52:53], v[20:21], v[20:21], s[20:21] neg_lo:[1,0,1] neg_hi:[1,0,1]
  v_pk_fma_f32 v[54:55], v[22:23], v[22:23], s[20:21] neg_lo:[1,0,1] neg_hi:[1,0,1]
  v_pk_fma_f32 v[56:57], v[24:25], v[24:25], s[20:21] neg_lo:[1,0,1] neg_hi:[1,0,1]
  v_pk_fma_f32 v[58:59], v[26:27], v[26:27], s[20:21] neg_lo:[1,0,1] neg_hi:[1,0,1]
  v_pk_fma_f32 v[60:61], v[28:29], v[28:29], s[20:21] neg_lo:[1,0,1] neg_hi:[1,0,1]
  v_pk_fma_f32 v[62:63], v[30:31], v[30:31], s[20:21] neg_lo:[1,0,1] neg_hi:[1,0,1]
  v_pk_mul_f32 v[48:49], v[16:17], v[48:49]
  v_pk_mul_f32 v[50:51], v[18:19], v[50:51]
  v_pk_mul_f32 v[52:53], v[20:21], v[52:53]
  v_pk_mul_f32 v[54:55], v[22:23], v[54:55]
  v_pk_mul_f32 v[56:57], v[24:25], v[56:57]
  v_pk_mul_f32 v[58:59], v[26:27], v[58:59]
  v_pk_mul_f32 v[60:61], v[28:29], v[60:61]
  v_pk_mul_f32 v[62:63], v[30:31], v[62:63]
  v_mfma_f32_16x16x32_bf16 v[148:151], v[216:219], v[220:223], 0
  v_cvt_pk_bf16_f32 v184, v32, v33
  v_cvt_pk_bf16_f32 v185, v34, v35
  v_mfma_f32_16x16x32_bf16 v[148:151], v[224:227], v[228:231], v[148:151]
  v_cvt_pk_bf16_f32 v186, v36, v37
  v_cvt_pk_bf16_f32 v187, v38, v39
  v_mfma_f32_16x16x32_bf16 v[148:151], v[232:235], v[236:239], v[148:151]
  ds_read_b128 v[216:219], v3 offset:4000
  ds_read_b128 v[220:223], v4 offset:160
  v_mfma_f32_32x32x16_bf16 v[64:79], v[192:195], v[184:187], v[64:79]
  ds_read_b128 v[224:227], v3 offset:8800
  ds_read_b128 v[228:231], v4 offset:352
  v_cvt_pk_bf16_f32 v188, v40, v41
  v_cvt_pk_bf16_f32 v189, v42, v43
  v_cvt_pk_bf16_f32 v190, v44, v45
  v_cvt_pk_bf16_f32 v191, v46, v47
  v_mfma_f32_32x32x16_bf16 v[80:95], v[196:199], v[184:187], v[80:95]
  ds_read_b128 v[232:235], v3 offset:13600
  ds_read_b128 v[236:239], v4 offset:544
  v_exp_f32 v48, v48
  v_exp_f32 v49, v49
  v_mfma_f32_32x32x16_bf16 v[96:111], v[200:203], v[184:187], v[96:111]
  v_exp_f32 v50, v50
  v_exp_f32 v51, v51
  v_exp_f32_e64 v52, v52
  v_mfma_f32_32x32x16_bf16 v[64:79], v[204:207], v[188:191], v[64:79]
  v_exp_f32 v53, v53
  v_exp_f32 v54, v54
  v_exp_f32_e64 v55, v55
  v_mfma_f32_32x32x16_bf16 v[80:95], v[208:211], v[188:191], v[80:95]
  v_exp_f32 v56, v56
  v_exp_f32 v57, v57
  v_exp_f32_e64 v58, v58
  v_mfma_f32_32x32x16_bf16 v[96:111], v[212:215], v[188:191], v[96:111]
  s_waitcnt lgkmcnt(0)
  v_exp_f32 v59, v59
  v_exp_f32 v60, v60
  v_exp_f32 v61, v61
  v_exp_f32 v62, v62
  v_exp_f32 v63, v63
  v_pk_add_f32 v[12:13], v[12:13], v[148:149]
  v_pk_fma_f32 v[14:15], v[148:149], v[148:149], v[14:15]
  v_pk_add_f32 v[12:13], v[12:13], v[150:151]
  v_pk_fma_f32 v[14:15], v[150:151], v[150:151], v[14:15]
  v_pk_fma_f32 v[48:49], v[48:49], s[22:23], s[22:23]
  v_pk_fma_f32 v[50:51], v[50:51], s[22:23], s[22:23]
  v_pk_fma_f32 v[52:53], v[52:53], s[22:23], s[22:23]
  v_pk_fma_f32 v[54:55], v[54:55], s[22:23], s[22:23]
  v_pk_fma_f32 v[56:57], v[56:57], s[22:23], s[22:23]
  v_pk_fma_f32 v[58:59], v[58:59], s[22:23], s[22:23]
  v_pk_fma_f32 v[60:61], v[60:61], s[22:23], s[22:23]
  v_pk_fma_f32 v[62:63], v[62:63], s[22:23], s[22:23]
  v_mfma_f32_32x32x16_bf16 v[32:47], a[144:147], v[160:163], 0
  ds_read_b128 v[192:195], v0 offset:36864
  ds_read_b128 v[196:199], v0 offset:37888
  v_rcp_f32 v48, v48
  v_rcp_f32 v49, v49
  v_mfma_f32_16x16x32_bf16 v[152:155], v[216:219], v[220:223], 0
  ds_read_b128 v[216:219], v3 offset:4400
  ds_read_b128 v[220:223], v4 offset:176
  v_mfma_f32_32x32x16_bf16 v[32:47], a[148:151], v[164:167], v[32:47]
  ds_read_b128 v[200:203], v0 offset:38912
  ds_read_b128 v[204:207], v0 offset:39936
  v_rcp_f32 v50, v50
  v_rcp_f32 v51, v51
  v_mfma_f32_16x16x32_bf16 v[152:155], v[224:227], v[228:231], v[152:155]
  ds_read_b128 v[224:227], v3 offset:9200
  ds_read_b128 v[228:231], v4 offset:368
  v_mfma_f32_32x32x16_bf16 v[32:47], a[152:155], v[168:171], v[32:47]
  ds_read_b128 v[208:211], v0 offset:40960
  ds_read_b128 v[212:215], v0 offset:41984
  v_rcp_f32 v52, v52
  v_rcp_f32 v53, v53
  v_mfma_f32_16x16x32_bf16 v[152:155], v[232:235], v[236:239], v[152:155]
  ds_read_b128 v[232:235], v3 offset:14000
  ds_read_b128 v[236:239], v4 offset:560
  v_mfma_f32_32x32x16_bf16 v[32:47], a[156:159], v[172:175], v[32:47]
  v_rcp_f32 v54, v54
  v_rcp_f32 v55, v55
  v_rcp_f32_e64 v56, v56
  v_mfma_f32_32x32x16_bf16 v[32:47], a[160:163], v[176:179], v[32:47]
  v_rcp_f32 v57, v57
  v_rcp_f32 v58, v58
  v_rcp_f32_e64 v59, v59
  v_mfma_f32_32x32x16_bf16 v[32:47], a[164:167], v[180:183], v[32:47]
  s_waitcnt lgkmcnt(0)
  v_rcp_f32 v60, v60
  v_rcp_f32 v61, v61
  v_rcp_f32 v62, v62
  v_rcp_f32_e64 v63, v63
  v_pk_mul_f32 v[16:17], v[16:17], v[48:49]
  v_pk_mul_f32 v[18:19], v[18:19], v[50:51]
  v_pk_mul_f32 v[20:21], v[20:21], v[52:53]
  v_pk_mul_f32 v[22:23], v[22:23], v[54:55]
  v_pk_mul_f32 v[24:25], v[24:25], v[56:57]
  v_pk_mul_f32 v[26:27], v[26:27], v[58:59]
  v_pk_mul_f32 v[28:29], v[28:29], v[60:61]
  v_pk_mul_f32 v[30:31], v[30:31], v[62:63]
  v_pk_add_f32 v[12:13], v[12:13], v[152:153]
  v_pk_fma_f32 v[14:15], v[152:153], v[152:153], v[14:15]
  v_pk_add_f32 v[12:13], v[12:13], v[154:155]
  v_pk_fma_f32 v[14:15], v[154:155], v[154:155], v[14:15]
  v_pk_fma_f32 v[48:49], v[32:33], v[32:33], s[20:21] neg_lo:[1,0,1] neg_hi:[1,0,1]
  v_pk_fma_f32 v[50:51], v[34:35], v[34:35], s[20:21] neg_lo:[1,0,1] neg_hi:[1,0,1]
  v_pk_fma_f32 v[52:53], v[36:37], v[36:37], s[20:21] neg_lo:[1,0,1] neg_hi:[1,0,1]
  v_pk_fma_f32 v[54:55], v[38:39], v[38:39], s[20:21] neg_lo:[1,0,1] neg_hi:[1,0,1]
  v_pk_fma_f32 v[56:57], v[40:41], v[40:41], s[20:21] neg_lo:[1,0,1] neg_hi:[1,0,1]
  v_pk_fma_f32 v[58:59], v[42:43], v[42:43], s[20:21] neg_lo:[1,0,1] neg_hi:[1,0,1]
  v_pk_fma_f32 v[60:61], v[44:45], v[44:45], s[20:21] neg_lo:[1,0,1] neg_hi:[1,0,1]
  v_pk_fma_f32 v[62:63], v[46:47], v[46:47], s[20:21] neg_lo:[1,0,1] neg_hi:[1,0,1]
  v_pk_mul_f32 v[48:49], v[32:33], v[48:49]
  v_pk_mul_f32 v[50:51], v[34:35], v[50:51]
  v_pk_mul_f32 v[52:53], v[36:37], v[52:53]
  v_pk_mul_f32 v[54:55], v[38:39], v[54:55]
  v_pk_mul_f32 v[56:57], v[40:41], v[56:57]
  v_pk_mul_f32 v[58:59], v[42:43], v[58:59]
  v_pk_mul_f32 v[60:61], v[44:45], v[60:61]
  v_pk_mul_f32 v[62:63], v[46:47], v[62:63]
  v_mfma_f32_16x16x32_bf16 v[156:159], v[216:219], v[220:223], 0
  v_cvt_pk_bf16_f32 v184, v16, v17
  v_cvt_pk_bf16_f32 v185, v18, v19
  v_mfma_f32_16x16x32_bf16 v[156:159], v[224:227], v[228:231], v[156:159]
  v_cvt_pk_bf16_f32 v186, v20, v21
  v_cvt_pk_bf16_f32 v187, v22, v23
  v_mfma_f32_16x16x32_bf16 v[156:159], v[232:235], v[236:239], v[156:159]
  ds_read_b128 v[216:219], v3
  ds_read_b128 v[220:223], v4
  v_mfma_f32_32x32x16_bf16 v[64:79], v[192:195], v[184:187], v[64:79]
  ds_read_b128 v[224:227], v3 offset:4800
  ds_read_b128 v[228:231], v4 offset:192
  v_cvt_pk_bf16_f32 v188, v24, v25
  v_cvt_pk_bf16_f32 v189, v26, v27
  v_cvt_pk_bf16_f32 v190, v28, v29
  v_cvt_pk_bf16_f32 v191, v30, v31
  v_mfma_f32_32x32x16_bf16 v[80:95], v[196:199], v[184:187], v[80:95]
  ds_read_b128 v[232:235], v3 offset:9600
  ds_read_b128 v[236:239], v4 offset:384
  v_exp_f32 v48, v48
  v_exp_f32 v49, v49
  v_mfma_f32_32x32x16_bf16 v[96:111], v[200:203], v[184:187], v[96:111]
  v_exp_f32 v50, v50
  v_exp_f32 v51, v51
  v_exp_f32_e64 v52, v52
  v_mfma_f32_32x32x16_bf16 v[64:79], v[204:207], v[188:191], v[64:79]
  v_exp_f32 v53, v53
  v_exp_f32 v54, v54
  v_exp_f32_e64 v55, v55
  v_mfma_f32_32x32x16_bf16 v[80:95], v[208:211], v[188:191], v[80:95]
  v_exp_f32 v56, v56
  v_exp_f32 v57, v57
  v_exp_f32_e64 v58, v58
  v_mfma_f32_32x32x16_bf16 v[96:111], v[212:215], v[188:191], v[96:111]
  s_waitcnt lgkmcnt(0)
  v_exp_f32 v59, v59
  v_exp_f32 v60, v60
  v_exp_f32 v61, v61
  v_exp_f32 v62, v62
  v_exp_f32 v63, v63
  v_pk_add_f32 v[12:13], v[12:13], v[156:157]
  v_pk_fma_f32 v[14:15], v[156:157], v[156:157], v[14:15]
  v_pk_add_f32 v[12:13], v[12:13], v[158:159]
  v_pk_fma_f32 v[14:15], v[158:159], v[158:159], v[14:15]
  v_pk_fma_f32 v[48:49], v[48:49], s[22:23], s[22:23]
  v_pk_fma_f32 v[50:51], v[50:51], s[22:23], s[22:23]
  v_pk_fma_f32 v[52:53], v[52:53], s[22:23], s[22:23]
  v_pk_fma_f32 v[54:55], v[54:55], s[22:23], s[22:23]
  v_pk_fma_f32 v[56:57], v[56:57], s[22:23], s[22:23]
  v_pk_fma_f32 v[58:59], v[58:59], s[22:23], s[22:23]
  v_pk_fma_f32 v[60:61], v[60:61], s[22:23], s[22:23]
  v_pk_fma_f32 v[62:63], v[62:63], s[22:23], s[22:23]
  v_mfma_f32_32x32x16_bf16 v[16:31], a[168:171], v[160:163], 0
  ds_read_b128 v[192:195], v0 offset:43008
  ds_read_b128 v[196:199], v0 offset:44032
  v_rcp_f32 v48, v48
  v_rcp_f32 v49, v49
  v_mfma_f32_16x16x32_bf16 v[112:115], v[216:219], v[220:223], 0
  ds_read_b128 v[216:219], v3 offset:400
  ds_read_b128 v[220:223], v4 offset:16
  v_mfma_f32_32x32x16_bf16 v[16:31], a[172:175], v[164:167], v[16:31]
  ds_read_b128 v[200:203], v0 offset:45056
  ds_read_b128 v[204:207], v0 offset:46080
  v_rcp_f32 v50, v50
  v_rcp_f32 v51, v51
  v_mfma_f32_16x16x32_bf16 v[112:115], v[224:227], v[228:231], v[112:115]
  ds_read_b128 v[224:227], v3 offset:5200
  ds_read_b128 v[228:231], v4 offset:208
  v_mfma_f32_32x32x16_bf16 v[16:31], a[176:179], v[168:171], v[16:31]
  ds_read_b128 v[208:211], v0 offset:47104
  ds_read_b128 v[212:215], v0 offset:48128
  v_rcp_f32 v52, v52
  v_rcp_f32 v53, v53
  v_mfma_f32_16x16x32_bf16 v[112:115], v[232:235], v[236:239], v[112:115]
  ds_read_b128 v[232:235], v3 offset:10000
  ds_read_b128 v[236:239], v4 offset:400
  v_mfma_f32_32x32x16_bf16 v[16:31], a[180:183], v[172:175], v[16:31]
  buffer_store_dwordx4 v[128:131], v10, s[8:11], s28 offen offset:128
  v_rcp_f32 v54, v54
  v_rcp_f32 v55, v55
  v_mfma_f32_32x32x16_bf16 v[16:31], a[184:187], v[176:179], v[16:31]
  v_rcp_f32 v56, v56
  v_rcp_f32 v57, v57
  v_rcp_f32_e64 v58, v58
  v_mfma_f32_32x32x16_bf16 v[16:31], a[188:191], v[180:183], v[16:31]
  s_waitcnt lgkmcnt(0)
  v_rcp_f32 v59, v59
  v_rcp_f32 v60, v60
  v_rcp_f32 v61, v61
  v_rcp_f32 v62, v62
  v_rcp_f32 v63, v63
  v_pk_mul_f32 v[32:33], v[32:33], v[48:49]
  v_pk_mul_f32 v[34:35], v[34:35], v[50:51]
  v_pk_mul_f32 v[36:37], v[36:37], v[52:53]
  v_pk_mul_f32 v[38:39], v[38:39], v[54:55]
  v_pk_mul_f32 v[40:41], v[40:41], v[56:57]
  v_pk_mul_f32 v[42:43], v[42:43], v[58:59]
  v_pk_mul_f32 v[44:45], v[44:45], v[60:61]
  v_pk_mul_f32 v[46:47], v[46:47], v[62:63]
  v_pk_add_f32 v[12:13], v[12:13], v[112:113]
  v_pk_fma_f32 v[14:15], v[112:113], v[112:113], v[14:15]
  v_pk_add_f32 v[12:13], v[12:13], v[114:115]
  v_pk_fma_f32 v[14:15], v[114:115], v[114:115], v[14:15]
  v_pk_fma_f32 v[48:49], v[16:17], v[16:17], s[20:21] neg_lo:[1,0,1] neg_hi:[1,0,1]
  v_pk_fma_f32 v[50:51], v[18:19], v[18:19], s[20:21] neg_lo:[1,0,1] neg_hi:[1,0,1]
  v_pk_fma_f32 v[52:53], v[20:21], v[20:21], s[20:21] neg_lo:[1,0,1] neg_hi:[1,0,1]
  v_pk_fma_f32 v[54:55], v[22:23], v[22:23], s[20:21] neg_lo:[1,0,1] neg_hi:[1,0,1]
  v_pk_fma_f32 v[56:57], v[24:25], v[24:25], s[20:21] neg_lo:[1,0,1] neg_hi:[1,0,1]
  v_pk_fma_f32 v[58:59], v[26:27], v[26:27], s[20:21] neg_lo:[1,0,1] neg_hi:[1,0,1]
  v_pk_fma_f32 v[60:61], v[28:29], v[28:29], s[20:21] neg_lo:[1,0,1] neg_hi:[1,0,1]
  v_pk_fma_f32 v[62:63], v[30:31], v[30:31], s[20:21] neg_lo:[1,0,1] neg_hi:[1,0,1]
  v_pk_mul_f32 v[48:49], v[16:17], v[48:49]
  v_pk_mul_f32 v[50:51], v[18:19], v[50:51]
  v_pk_mul_f32 v[52:53], v[20:21], v[52:53]
  v_pk_mul_f32 v[54:55], v[22:23], v[54:55]
  v_pk_mul_f32 v[56:57], v[24:25], v[56:57]
  v_pk_mul_f32 v[58:59], v[26:27], v[58:59]
  v_pk_mul_f32 v[60:61], v[28:29], v[60:61]
  v_pk_mul_f32 v[62:63], v[30:31], v[62:63]
  v_mfma_f32_16x16x32_bf16 v[116:119], v[216:219], v[220:223], 0
  v_cvt_pk_bf16_f32 v184, v32, v33
  v_cvt_pk_bf16_f32 v185, v34, v35
  v_mfma_f32_16x16x32_bf16 v[116:119], v[224:227], v[228:231], v[116:119]
  v_cvt_pk_bf16_f32 v186, v36, v37
  v_cvt_pk_bf16_f32 v187, v38, v39
  v_mfma_f32_16x16x32_bf16 v[116:119], v[232:235], v[236:239], v[116:119]
  ds_read_b128 v[216:219], v3 offset:800
  ds_read_b128 v[220:223], v4 offset:32
  v_mfma_f32_32x32x16_bf16 v[64:79], v[192:195], v[184:187], v[64:79]
  ds_read_b128 v[224:227], v3 offset:5600
  ds_read_b128 v[228:231], v4 offset:224
  v_cvt_pk_bf16_f32 v188, v40, v41
  v_cvt_pk_bf16_f32 v189, v42, v43
  v_cvt_pk_bf16_f32 v190, v44, v45
  v_cvt_pk_bf16_f32 v191, v46, v47
  v_mfma_f32_32x32x16_bf16 v[80:95], v[196:199], v[184:187], v[80:95]
  ds_read_b128 v[232:235], v3 offset:10400
  ds_read_b128 v[236:239], v4 offset:416
  v_exp_f32 v48, v48
  v_exp_f32 v49, v49
  v_mfma_f32_32x32x16_bf16 v[96:111], v[200:203], v[184:187], v[96:111]
  v_exp_f32 v50, v50
  v_exp_f32 v51, v51
  v_exp_f32_e64 v52, v52
  v_mfma_f32_32x32x16_bf16 v[64:79], v[204:207], v[188:191], v[64:79]
  v_exp_f32 v53, v53
  v_exp_f32 v54, v54
  v_exp_f32_e64 v55, v55
  v_mfma_f32_32x32x16_bf16 v[80:95], v[208:211], v[188:191], v[80:95]
  v_exp_f32 v56, v56
  v_exp_f32 v57, v57
  v_exp_f32_e64 v58, v58
  v_mfma_f32_32x32x16_bf16 v[96:111], v[212:215], v[188:191], v[96:111]
  s_waitcnt lgkmcnt(0)
  v_exp_f32 v59, v59
  v_exp_f32 v60, v60
  v_exp_f32 v61, v61
  v_exp_f32 v62, v62
  v_exp_f32 v63, v63
  v_pk_add_f32 v[12:13], v[12:13], v[116:117]
  v_pk_fma_f32 v[14:15], v[116:117], v[116:117], v[14:15]
  v_pk_add_f32 v[12:13], v[12:13], v[118:119]
  v_pk_fma_f32 v[14:15], v[118:119], v[118:119], v[14:15]
  v_pk_fma_f32 v[48:49], v[48:49], s[22:23], s[22:23]
  v_pk_fma_f32 v[50:51], v[50:51], s[22:23], s[22:23]
  v_pk_fma_f32 v[52:53], v[52:53], s[22:23], s[22:23]
  v_pk_fma_f32 v[54:55], v[54:55], s[22:23], s[22:23]
  v_pk_fma_f32 v[56:57], v[56:57], s[22:23], s[22:23]
  v_pk_fma_f32 v[58:59], v[58:59], s[22:23], s[22:23]
  v_pk_fma_f32 v[60:61], v[60:61], s[22:23], s[22:23]
  v_pk_fma_f32 v[62:63], v[62:63], s[22:23], s[22:23]
  v_mfma_f32_32x32x16_bf16 v[32:47], a[192:195], v[160:163], 0
  ds_read_b128 v[192:195], v0 offset:49152
  ds_read_b128 v[196:199], v0 offset:50176
  v_rcp_f32 v48, v48
  v_rcp_f32 v49, v49
  v_mfma_f32_16x16x32_bf16 v[120:123], v[216:219], v[220:223], 0
  ds_read_b128 v[216:219], v3 offset:1200
  ds_read_b128 v[220:223], v4 offset:48
  v_mfma_f32_32x32x16_bf16 v[32:47], a[196:199], v[164:167], v[32:47]
  ds_read_b128 v[200:203], v0 offset:51200
  ds_read_b128 v[204:207], v0 offset:52224
  v_rcp_f32 v50, v50
  v_rcp_f32 v51, v51
  v_mfma_f32_16x16x32_bf16 v[120:123], v[224:227], v[228:231], v[120:123]
  ds_read_b128 v[224:227], v3 offset:6000
  ds_read_b128 v[228:231], v4 offset:240
  v_mfma_f32_32x32x16_bf16 v[32:47], a[200:203], v[168:171], v[32:47]
  ds_read_b128 v[208:211], v0 offset:53248
  ds_read_b128 v[212:215], v0 offset:54272
  v_rcp_f32 v52, v52
  v_rcp_f32 v53, v53
  v_mfma_f32_16x16x32_bf16 v[120:123], v[232:235], v[236:239], v[120:123]
  ds_read_b128 v[232:235], v3 offset:10800
  ds_read_b128 v[236:239], v4 offset:432
  v_mfma_f32_32x32x16_bf16 v[32:47], a[204:207], v[172:175], v[32:47]
  buffer_store_dwordx4 v[132:135], v10, s[8:11], s28 offen offset:160
  v_rcp_f32 v54, v54
  v_rcp_f32 v55, v55
  v_mfma_f32_32x32x16_bf16 v[32:47], a[208:211], v[176:179], v[32:47]
  v_rcp_f32 v56, v56
  v_rcp_f32 v57, v57
  v_rcp_f32_e64 v58, v58
  v_mfma_f32_32x32x16_bf16 v[32:47], a[212:215], v[180:183], v[32:47]
  s_waitcnt lgkmcnt(0)
  v_rcp_f32 v59, v59
  v_rcp_f32 v60, v60
  v_rcp_f32 v61, v61
  v_rcp_f32 v62, v62
  v_rcp_f32 v63, v63
  v_pk_mul_f32 v[16:17], v[16:17], v[48:49]
  v_pk_mul_f32 v[18:19], v[18:19], v[50:51]
  v_pk_mul_f32 v[20:21], v[20:21], v[52:53]
  v_pk_mul_f32 v[22:23], v[22:23], v[54:55]
  v_pk_mul_f32 v[24:25], v[24:25], v[56:57]
  v_pk_mul_f32 v[26:27], v[26:27], v[58:59]
  v_pk_mul_f32 v[28:29], v[28:29], v[60:61]
  v_pk_mul_f32 v[30:31], v[30:31], v[62:63]
  v_pk_add_f32 v[12:13], v[12:13], v[120:121]
  v_pk_fma_f32 v[14:15], v[120:121], v[120:121], v[14:15]
  v_pk_add_f32 v[12:13], v[12:13], v[122:123]
  v_pk_fma_f32 v[14:15], v[122:123], v[122:123], v[14:15]
  v_pk_fma_f32 v[48:49], v[32:33], v[32:33], s[20:21] neg_lo:[1,0,1] neg_hi:[1,0,1]
  v_pk_fma_f32 v[50:51], v[34:35], v[34:35], s[20:21] neg_lo:[1,0,1] neg_hi:[1,0,1]
  v_pk_fma_f32 v[52:53], v[36:37], v[36:37], s[20:21] neg_lo:[1,0,1] neg_hi:[1,0,1]
  v_pk_fma_f32 v[54:55], v[38:39], v[38:39], s[20:21] neg_lo:[1,0,1] neg_hi:[1,0,1]
  v_pk_fma_f32 v[56:57], v[40:41], v[40:41], s[20:21] neg_lo:[1,0,1] neg_hi:[1,0,1]
  v_pk_fma_f32 v[58:59], v[42:43], v[42:43], s[20:21] neg_lo:[1,0,1] neg_hi:[1,0,1]
  v_pk_fma_f32 v[60:61], v[44:45], v[44:45], s[20:21] neg_lo:[1,0,1] neg_hi:[1,0,1]
  v_pk_fma_f32 v[62:63], v[46:47], v[46:47], s[20:21] neg_lo:[1,0,1] neg_hi:[1,0,1]
  v_pk_mul_f32 v[48:49], v[32:33], v[48:49]
  v_pk_mul_f32 v[50:51], v[34:35], v[50:51]
  v_pk_mul_f32 v[52:53], v[36:37], v[52:53]
  v_pk_mul_f32 v[54:55], v[38:39], v[54:55]
  v_pk_mul_f32 v[56:57], v[40:41], v[56:57]
  v_pk_mul_f32 v[58:59], v[42:43], v[58:59]
  v_pk_mul_f32 v[60:61], v[44:45], v[60:61]
  v_pk_mul_f32 v[62:63], v[46:47], v[62:63]
  v_mfma_f32_16x16x32_bf16 v[124:127], v[216:219], v[220:223], 0
  v_cvt_pk_bf16_f32 v184, v16, v17
  v_cvt_pk_bf16_f32 v185, v18, v19
  v_mfma_f32_16x16x32_bf16 v[124:127], v[224:227], v[228:231], v[124:127]
  v_cvt_pk_bf16_f32 v186, v20, v21
  v_cvt_pk_bf16_f32 v187, v22, v23
  v_mfma_f32_16x16x32_bf16 v[124:127], v[232:235], v[236:239], v[124:127]
  ds_read_b128 v[216:219], v3 offset:1600
  ds_read_b128 v[220:223], v4 offset:64
  v_mfma_f32_32x32x16_bf16 v[64:79], v[192:195], v[184:187], v[64:79]
  ds_read_b128 v[224:227], v3 offset:6400
  ds_read_b128 v[228:231], v4 offset:256
  v_cvt_pk_bf16_f32 v188, v24, v25
  v_cvt_pk_bf16_f32 v189, v26, v27
  v_cvt_pk_bf16_f32 v190, v28, v29
  v_cvt_pk_bf16_f32 v191, v30, v31
  v_mfma_f32_32x32x16_bf16 v[80:95], v[196:199], v[184:187], v[80:95]
  ds_read_b128 v[232:235], v3 offset:11200
  ds_read_b128 v[236:239], v4 offset:448
  v_exp_f32 v48, v48
  v_exp_f32 v49, v49
  v_mfma_f32_32x32x16_bf16 v[96:111], v[200:203], v[184:187], v[96:111]
  v_exp_f32 v50, v50
  v_exp_f32 v51, v51
  v_exp_f32_e64 v52, v52
  v_mfma_f32_32x32x16_bf16 v[64:79], v[204:207], v[188:191], v[64:79]
  v_exp_f32 v53, v53
  v_exp_f32 v54, v54
  v_exp_f32_e64 v55, v55
  v_mfma_f32_32x32x16_bf16 v[80:95], v[208:211], v[188:191], v[80:95]
  v_exp_f32 v56, v56
  v_exp_f32 v57, v57
  v_exp_f32_e64 v58, v58
  v_mfma_f32_32x32x16_bf16 v[96:111], v[212:215], v[188:191], v[96:111]
  s_waitcnt lgkmcnt(0)
  v_exp_f32 v59, v59
  v_exp_f32 v60, v60
  v_exp_f32 v61, v61
  v_exp_f32 v62, v62
  v_exp_f32 v63, v63
  v_pk_add_f32 v[12:13], v[12:13], v[124:125]
  v_pk_fma_f32 v[14:15], v[124:125], v[124:125], v[14:15]
  v_pk_add_f32 v[12:13], v[12:13], v[126:127]
  v_pk_fma_f32 v[14:15], v[126:127], v[126:127], v[14:15]
  v_pk_fma_f32 v[48:49], v[48:49], s[22:23], s[22:23]
  v_pk_fma_f32 v[50:51], v[50:51], s[22:23], s[22:23]
  v_pk_fma_f32 v[52:53], v[52:53], s[22:23], s[22:23]
  v_pk_fma_f32 v[54:55], v[54:55], s[22:23], s[22:23]
  v_pk_fma_f32 v[56:57], v[56:57], s[22:23], s[22:23]
  v_pk_fma_f32 v[58:59], v[58:59], s[22:23], s[22:23]
  v_pk_fma_f32 v[60:61], v[60:61], s[22:23], s[22:23]
  v_pk_fma_f32 v[62:63], v[62:63], s[22:23], s[22:23]
  v_mfma_f32_32x32x16_bf16 v[16:31], a[216:219], v[160:163], 0
  ds_read_b128 v[192:195], v0 offset:55296
  ds_read_b128 v[196:199], v0 offset:56320
  v_rcp_f32 v48, v48
  v_rcp_f32 v49, v49
  v_mfma_f32_16x16x32_bf16 v[128:131], v[216:219], v[220:223], 0
  ds_read_b128 v[216:219], v3 offset:2000
  ds_read_b128 v[220:223], v4 offset:80
  v_mfma_f32_32x32x16_bf16 v[16:31], a[220:223], v[164:167], v[16:31]
  ds_read_b128 v[200:203], v0 offset:57344
  ds_read_b128 v[204:207], v0 offset:58368
  v_rcp_f32 v50, v50
  v_rcp_f32 v51, v51
  v_mfma_f32_16x16x32_bf16 v[128:131], v[224:227], v[228:231], v[128:131]
  ds_read_b128 v[224:227], v3 offset:6800
  ds_read_b128 v[228:231], v4 offset:272
  v_mfma_f32_32x32x16_bf16 v[16:31], a[224:227], v[168:171], v[16:31]
  ds_read_b128 v[208:211], v0 offset:59392
  ds_read_b128 v[212:215], v0 offset:60416
  v_rcp_f32 v52, v52
  v_rcp_f32 v53, v53
  v_mfma_f32_16x16x32_bf16 v[128:131], v[232:235], v[236:239], v[128:131]
  ds_read_b128 v[232:235], v3 offset:11600
  ds_read_b128 v[236:239], v4 offset:464
  v_mfma_f32_32x32x16_bf16 v[16:31], a[228:231], v[172:175], v[16:31]
  v_rcp_f32 v54, v54
  v_rcp_f32 v55, v55
  v_rcp_f32_e64 v56, v56
  v_mfma_f32_32x32x16_bf16 v[16:31], a[232:235], v[176:179], v[16:31]
  v_rcp_f32 v57, v57
  v_rcp_f32 v58, v58
  v_rcp_f32_e64 v59, v59
  v_mfma_f32_32x32x16_bf16 v[16:31], a[236:239], v[180:183], v[16:31]
  s_waitcnt lgkmcnt(0)
  v_rcp_f32 v60, v60
  v_rcp_f32 v61, v61
  v_rcp_f32 v62, v62
  v_rcp_f32_e64 v63, v63
  v_pk_mul_f32 v[32:33], v[32:33], v[48:49]
  v_pk_mul_f32 v[34:35], v[34:35], v[50:51]
  v_pk_mul_f32 v[36:37], v[36:37], v[52:53]
  v_pk_mul_f32 v[38:39], v[38:39], v[54:55]
  v_pk_mul_f32 v[40:41], v[40:41], v[56:57]
  v_pk_mul_f32 v[42:43], v[42:43], v[58:59]
  v_pk_mul_f32 v[44:45], v[44:45], v[60:61]
  v_pk_mul_f32 v[46:47], v[46:47], v[62:63]
  v_pk_add_f32 v[12:13], v[12:13], v[128:129]
  v_pk_fma_f32 v[14:15], v[128:129], v[128:129], v[14:15]
  v_pk_add_f32 v[12:13], v[12:13], v[130:131]
  v_pk_fma_f32 v[14:15], v[130:131], v[130:131], v[14:15]
  v_pk_fma_f32 v[48:49], v[16:17], v[16:17], s[20:21] neg_lo:[1,0,1] neg_hi:[1,0,1]
  v_pk_fma_f32 v[50:51], v[18:19], v[18:19], s[20:21] neg_lo:[1,0,1] neg_hi:[1,0,1]
  v_pk_fma_f32 v[52:53], v[20:21], v[20:21], s[20:21] neg_lo:[1,0,1] neg_hi:[1,0,1]
  v_pk_fma_f32 v[54:55], v[22:23], v[22:23], s[20:21] neg_lo:[1,0,1] neg_hi:[1,0,1]
  v_pk_fma_f32 v[56:57], v[24:25], v[24:25], s[20:21] neg_lo:[1,0,1] neg_hi:[1,0,1]
  v_pk_fma_f32 v[58:59], v[26:27], v[26:27], s[20:21] neg_lo:[1,0,1] neg_hi:[1,0,1]
  v_pk_fma_f32 v[60:61], v[28:29], v[28:29], s[20:21] neg_lo:[1,0,1] neg_hi:[1,0,1]
  v_pk_fma_f32 v[62:63], v[30:31], v[30:31], s[20:21] neg_lo:[1,0,1] neg_hi:[1,0,1]
  v_pk_mul_f32 v[48:49], v[16:17], v[48:49]
  v_pk_mul_f32 v[50:51], v[18:19], v[50:51]
  v_pk_mul_f32 v[52:53], v[20:21], v[52:53]
  v_pk_mul_f32 v[54:55], v[22:23], v[54:55]
  v_pk_mul_f32 v[56:57], v[24:25], v[56:57]
  v_pk_mul_f32 v[58:59], v[26:27], v[58:59]
  v_pk_mul_f32 v[60:61], v[28:29], v[60:61]
  v_pk_mul_f32 v[62:63], v[30:31], v[62:63]
  v_mfma_f32_16x16x32_bf16 v[132:135], v[216:219], v[220:223], 0
  v_cvt_pk_bf16_f32 v184, v32, v33
  v_cvt_pk_bf16_f32 v185, v34, v35
  v_mfma_f32_16x16x32_bf16 v[132:135], v[224:227], v[228:231], v[132:135]
  v_cvt_pk_bf16_f32 v186, v36, v37
  v_cvt_pk_bf16_f32 v187, v38, v39
  v_mfma_f32_16x16x32_bf16 v[132:135], v[232:235], v[236:239], v[132:135]
  ds_read_b128 v[216:219], v0 offset:12288
  ds_read_b128 v[220:223], v0 offset:13312
  v_mfma_f32_32x32x16_bf16 v[64:79], v[192:195], v[184:187], v[64:79]
  ds_read_b128 v[224:227], v0 offset:14336
  ds_read_b128 v[228:231], v0 offset:15360
  v_cvt_pk_bf16_f32 v188, v40, v41
  v_cvt_pk_bf16_f32 v189, v42, v43
  v_cvt_pk_bf16_f32 v190, v44, v45
  v_cvt_pk_bf16_f32 v191, v46, v47
  v_mfma_f32_32x32x16_bf16 v[80:95], v[196:199], v[184:187], v[80:95]
  ds_read_b128 v[232:235], v0 offset:16384
  ds_read_b128 v[236:239], v0 offset:17408
  v_exp_f32 v48, v48
  v_exp_f32 v49, v49
  v_mfma_f32_32x32x16_bf16 v[96:111], v[200:203], v[184:187], v[96:111]
  v_exp_f32 v50, v50
  v_exp_f32 v51, v51
  v_exp_f32_e64 v52, v52
  v_mfma_f32_32x32x16_bf16 v[64:79], v[204:207], v[188:191], v[64:79]
  s_mov_b32 s28, s34
  v_exp_f32 v53, v53
  v_exp_f32 v54, v54
  v_exp_f32 v55, v55
  v_mfma_f32_32x32x16_bf16 v[80:95], v[208:211], v[188:191], v[80:95]
  s_add_u32 s34, s34, 0x60000
  v_exp_f32 v56, v56
  v_exp_f32 v57, v57
  v_exp_f32_e64 v58, v58
  v_mfma_f32_32x32x16_bf16 v[96:111], v[212:215], v[188:191], v[96:111]
  s_waitcnt lgkmcnt(0)
  v_exp_f32 v59, v59
  v_exp_f32 v60, v60
  v_exp_f32 v61, v61
  v_exp_f32 v62, v62
  v_exp_f32 v63, v63
  v_pk_add_f32 v[12:13], v[12:13], v[132:133]
  v_pk_fma_f32 v[14:15], v[132:133], v[132:133], v[14:15]
  v_pk_add_f32 v[12:13], v[12:13], v[134:135]
  v_pk_fma_f32 v[14:15], v[134:135], v[134:135], v[14:15]
  v_pk_fma_f32 v[48:49], v[48:49], s[22:23], s[22:23]
  v_pk_fma_f32 v[50:51], v[50:51], s[22:23], s[22:23]
  v_pk_fma_f32 v[52:53], v[52:53], s[22:23], s[22:23]
  v_pk_fma_f32 v[54:55], v[54:55], s[22:23], s[22:23]
  v_pk_fma_f32 v[56:57], v[56:57], s[22:23], s[22:23]
  v_pk_fma_f32 v[58:59], v[58:59], s[22:23], s[22:23]
  v_pk_fma_f32 v[60:61], v[60:61], s[22:23], s[22:23]
  v_pk_fma_f32 v[62:63], v[62:63], s[22:23], s[22:23]
  v_mfma_f32_32x32x16_bf16 v[32:47], v[216:219], v[160:163], 0
  ds_read_b128 v[192:195], v0 offset:61440
  ds_read_b128 v[196:199], v0 offset:62464
  v_rcp_f32 v48, v48
  v_rcp_f32 v49, v49
  v_add_f32_e64 v12, v12, v13
  v_mfma_f32_32x32x16_bf16 v[32:47], v[220:223], v[164:167], v[32:47]
  ds_read_b128 v[200:203], v0 offset:63488
  ds_read_b128 v[204:207], v0 offset:64512
  v_rcp_f32 v50, v50
  v_add_f32 v14, v14, v15
  v_rcp_f32_e64 v51, v51
  v_mfma_f32_32x32x16_bf16 v[32:47], v[224:227], v[168:171], v[32:47]
  ds_read_b128 v[208:211], v1
  ds_read_b128 v[212:215], v1 offset:1024
  v_permlane32_swap_b32 v12, v14
  v_rcp_f32 v52, v52
  v_add_f32 v12, v12, v14
  v_rcp_f32 v53, v53
  v_mfma_f32_32x32x16_bf16 v[32:47], v[228:231], v[172:175], v[32:47]
  v_mov_b32 v14, v12
  v_rcp_f32 v54, v54
  s_nop 0
  v_permlane32_swap_b32 v12, v14
  v_rcp_f32 v55, v55
  v_mul_f32 v12, s24, v12
  v_mfma_f32_32x32x16_bf16 v[32:47], v[232:235], v[176:179], v[32:47]
  v_rcp_f32 v56, v56
  v_rcp_f32 v57, v57
  v_mul_f32 v13, s24, v14
  v_rcp_f32 v58, v58
  v_fma_f32 v13, -v12, v12, v13
  v_mfma_f32_32x32x16_bf16 v[32:47], v[236:239], v[180:183], v[32:47]
  s_waitcnt lgkmcnt(0)
  v_rcp_f32 v59, v59
  v_max_f32 v13, 0, v13
  v_rcp_f32 v60, v60
  v_add_f32 v13, s25, v13
  v_rcp_f32 v61, v61
  v_rsq_f32 v13, v13
  v_rcp_f32 v62, v62
  v_mul_f32 v14, s22, v13
  v_rcp_f32 v63, v63
  v_mul_f32_e64 v12, -v12, v14
  v_pk_mul_f32 v[16:17], v[16:17], v[48:49]
  v_pk_mul_f32 v[18:19], v[18:19], v[50:51]
  v_pk_mul_f32 v[20:21], v[20:21], v[52:53]
  v_pk_mul_f32 v[22:23], v[22:23], v[54:55]
  v_pk_mul_f32 v[24:25], v[24:25], v[56:57]
  v_pk_mul_f32 v[26:27], v[26:27], v[58:59]
  v_pk_mul_f32 v[28:29], v[28:29], v[60:61]
  v_pk_mul_f32 v[30:31], v[30:31], v[62:63]
  v_pk_fma_f32 v[112:113], v[112:113], v[14:15], v[12:13] op_sel_hi:[1,0,0]
  v_pk_fma_f32 v[114:115], v[114:115], v[14:15], v[12:13] op_sel_hi:[1,0,0]
  v_pk_fma_f32 v[116:117], v[116:117], v[14:15], v[12:13] op_sel_hi:[1,0,0]
  v_pk_fma_f32 v[118:119], v[118:119], v[14:15], v[12:13] op_sel_hi:[1,0,0]
  v_pk_fma_f32 v[120:121], v[120:121], v[14:15], v[12:13] op_sel_hi:[1,0,0]
  v_pk_fma_f32 v[122:123], v[122:123], v[14:15], v[12:13] op_sel_hi:[1,0,0]
  v_pk_fma_f32 v[124:125], v[124:125], v[14:15], v[12:13] op_sel_hi:[1,0,0]
  v_pk_fma_f32 v[126:127], v[126:127], v[14:15], v[12:13] op_sel_hi:[1,0,0]
  v_pk_fma_f32 v[128:129], v[128:129], v[14:15], v[12:13] op_sel_hi:[1,0,0]
  v_pk_fma_f32 v[130:131], v[130:131], v[14:15], v[12:13] op_sel_hi:[1,0,0]
  v_pk_fma_f32 v[132:133], v[132:133], v[14:15], v[12:13] op_sel_hi:[1,0,0]
  v_pk_fma_f32 v[134:135], v[134:135], v[14:15], v[12:13] op_sel_hi:[1,0,0]
  v_pk_fma_f32 v[136:137], v[136:137], v[14:15], v[12:13] op_sel_hi:[1,0,0]
  v_pk_fma_f32 v[138:139], v[138:139], v[14:15], v[12:13] op_sel_hi:[1,0,0]
  v_pk_fma_f32 v[140:141], v[140:141], v[14:15], v[12:13] op_sel_hi:[1,0,0]
  v_pk_fma_f32 v[142:143], v[142:143], v[14:15], v[12:13] op_sel_hi:[1,0,0]
  v_pk_fma_f32 v[144:145], v[144:145], v[14:15], v[12:13] op_sel_hi:[1,0,0]
  v_pk_fma_f32 v[146:147], v[146:147], v[14:15], v[12:13] op_sel_hi:[1,0,0]
  v_pk_fma_f32 v[148:149], v[148:149], v[14:15], v[12:13] op_sel_hi:[1,0,0]
  v_pk_fma_f32 v[150:151], v[150:151], v[14:15], v[12:13] op_sel_hi:[1,0,0]
  v_pk_fma_f32 v[152:153], v[152:153], v[14:15], v[12:13] op_sel_hi:[1,0,0]
  v_pk_fma_f32 v[154:155], v[154:155], v[14:15], v[12:13] op_sel_hi:[1,0,0]
  v_pk_fma_f32 v[156:157], v[156:157], v[14:15], v[12:13] op_sel_hi:[1,0,0]
  v_pk_fma_f32 v[158:159], v[158:159], v[14:15], v[12:13] op_sel_hi:[1,0,0]
  v_pk_fma_f32 v[48:49], v[32:33], v[32:33], s[20:21] neg_lo:[1,0,1] neg_hi:[1,0,1]
  v_pk_fma_f32 v[50:51], v[34:35], v[34:35], s[20:21] neg_lo:[1,0,1] neg_hi:[1,0,1]
  v_pk_fma_f32 v[52:53], v[36:37], v[36:37], s[20:21] neg_lo:[1,0,1] neg_hi:[1,0,1]
  v_pk_fma_f32 v[54:55], v[38:39], v[38:39], s[20:21] neg_lo:[1,0,1] neg_hi:[1,0,1]
  v_pk_fma_f32 v[56:57], v[40:41], v[40:41], s[20:21] neg_lo:[1,0,1] neg_hi:[1,0,1]
  v_pk_fma_f32 v[58:59], v[42:43], v[42:43], s[20:21] neg_lo:[1,0,1] neg_hi:[1,0,1]
  v_pk_fma_f32 v[60:61], v[44:45], v[44:45], s[20:21] neg_lo:[1,0,1] neg_hi:[1,0,1]
  v_pk_fma_f32 v[62:63], v[46:47], v[46:47], s[20:21] neg_lo:[1,0,1] neg_hi:[1,0,1]
  v_pk_mul_f32 v[48:49], v[32:33], v[48:49]
  v_pk_mul_f32 v[50:51], v[34:35], v[50:51]
  v_pk_mul_f32 v[52:53], v[36:37], v[52:53]
  v_pk_mul_f32 v[54:55], v[38:39], v[54:55]
  v_pk_mul_f32 v[56:57], v[40:41], v[56:57]
  v_cvt_pk_bf16_f32 v184, v16, v17
  v_cvt_pk_bf16_f32 v185, v18, v19
  v_cvt_pk_bf16_f32 v186, v20, v21
  v_cvt_pk_bf16_f32 v187, v22, v23
  v_pk_mul_f32 v[58:59], v[42:43], v[58:59]
  v_pk_mul_f32 v[60:61], v[44:45], v[60:61]
  v_pk_mul_f32 v[62:63], v[46:47], v[62:63]
  v_mfma_f32_32x32x16_bf16 v[64:79], v[192:195], v[184:187], v[64:79]
  ds_read_b128 v[216:219], v0 offset:18432
  ds_read_b128 v[220:223], v0 offset:19456
  v_cvt_pk_bf16_f32 v188, v24, v25
  v_cvt_pk_bf16_f32 v189, v26, v27
  v_cvt_pk_bf16_f32 v190, v28, v29
  v_cvt_pk_bf16_f32 v191, v30, v31
  v_exp_f32_e64 v48, v48
  v_cndmask_b32 v159, v159, v250, s[12:13]
  v_mfma_f32_32x32x16_bf16 v[80:95], v[196:199], v[184:187], v[80:95]
  ds_read_b128 v[224:227], v0 offset:20480
  ds_read_b128 v[228:231], v0 offset:21504
  v_exp_f32_e64 v49, v49
  v_cvt_pk_bf16_f32 v160, v112, v113
  v_cvt_pk_bf16_f32 v161, v114, v115
  v_exp_f32_e64 v50, v50
  v_cvt_pk_bf16_f32 v162, v116, v117
  v_mfma_f32_32x32x16_bf16 v[96:111], v[200:203], v[184:187], v[96:111]
  ds_read_b128 v[232:235], v0 offset:22528
  ds_read_b128 v[236:239], v0 offset:23552
  v_exp_f32_e64 v51, v51
  v_cvt_pk_bf16_f32 v163, v118, v119
  v_cvt_pk_bf16_f32 v164, v120, v121
  v_exp_f32_e64 v52, v52
  v_cvt_pk_bf16_f32 v165, v122, v123
  v_mfma_f32_32x32x16_bf16 v[64:79], v[204:207], v[188:191], v[64:79]
  v_exp_f32_e64 v53, v53
  v_cvt_pk_bf16_f32 v166, v124, v125
  v_cvt_pk_bf16_f32 v167, v126, v127
  v_exp_f32_e64 v54, v54
  v_cvt_pk_bf16_f32 v168, v128, v129
  v_exp_f32_e64 v55, v55
  v_cvt_pk_bf16_f32 v169, v130, v131
  v_cvt_pk_bf16_f32 v170, v132, v133
  v_mfma_f32_32x32x16_bf16 v[80:95], v[208:211], v[188:191], v[80:95]
  v_exp_f32_e64 v56, v56
  v_cvt_pk_bf16_f32 v171, v134, v135
  v_cvt_pk_bf16_f32 v172, v136, v137
  v_exp_f32_e64 v57, v57
  v_cvt_pk_bf16_f32 v173, v138, v139
  v_exp_f32_e64 v58, v58
  v_cvt_pk_bf16_f32 v174, v140, v141
  v_cvt_pk_bf16_f32 v175, v142, v143
  v_mfma_f32_32x32x16_bf16 v[96:111], v[212:215], v[188:191], v[96:111]
  s_waitcnt lgkmcnt(0)
  v_exp_f32 v59, v59
  v_cvt_pk_bf16_f32 v176, v144, v145
  v_exp_f32_e64 v60, v60
  v_cvt_pk_bf16_f32 v177, v146, v147
  v_cvt_pk_bf16_f32 v178, v148, v149
  v_exp_f32_e64 v61, v61
  v_cvt_pk_bf16_f32 v179, v150, v151
  v_exp_f32_e64 v62, v62
  v_cvt_pk_bf16_f32 v180, v152, v153
  v_cvt_pk_bf16_f32 v181, v154, v155
  v_exp_f32_e64 v63, v63
  v_cvt_pk_bf16_f32 v182, v156, v157
  v_cvt_pk_bf16_f32 v183, v158, v159
  v_pk_fma_f32 v[48:49], v[48:49], s[22:23], s[22:23]
  v_pk_fma_f32 v[50:51], v[50:51], s[22:23], s[22:23]
  v_pk_fma_f32 v[52:53], v[52:53], s[22:23], s[22:23]
  v_pk_fma_f32 v[54:55], v[54:55], s[22:23], s[22:23]
  v_pk_fma_f32 v[56:57], v[56:57], s[22:23], s[22:23]
  v_pk_fma_f32 v[58:59], v[58:59], s[22:23], s[22:23]
  v_pk_fma_f32 v[60:61], v[60:61], s[22:23], s[22:23]
  v_pk_fma_f32 v[62:63], v[62:63], s[22:23], s[22:23]
  s_sub_u32 s26, s26, 1
  s_cmp_lg_u32 s26, 0
  s_waitcnt vmcnt(4)
  s_cbranch_scc1 S_loop
  v_mfma_f32_32x32x16_bf16 v[16:31], v[216:219], v[160:163], 0
  ds_read_b128 v[192:195], v1 offset:2048
  ds_read_b128 v[196:199], v1 offset:3072
  ds_read_b128 v[200:203], v1 offset:4096
  v_rcp_f32 v48, v48
  v_rcp_f32 v49, v49
  v_mfma_f32_32x32x16_bf16 v[16:31], v[220:223], v[164:167], v[16:31]
  ds_read_b128 v[204:207], v1 offset:5120
  ds_read_b128 v[208:211], v1 offset:6144
  ds_read_b128 v[212:215], v1 offset:7168
  v_rcp_f32 v50, v50
  v_rcp_f32 v51, v51
  v_mfma_f32_32x32x16_bf16 v[16:31], v[224:227], v[168:171], v[16:31]
  ds_read_b128 v[136:139], v5
  ds_read_b128 v[140:143], v5 offset:32
  ds_read_b128 v[144:147], v5 offset:64
  v_rcp_f32 v52, v52
  v_rcp_f32 v53, v53
  v_mfma_f32_32x32x16_bf16 v[16:31], v[228:231], v[172:175], v[16:31]
  ds_read_b128 v[148:151], v5 offset:96
  ds_read_b128 v[152:155], v5 offset:128
  ds_read_b128 v[156:159], v5 offset:160
  v_rcp_f32 v54, v54
  v_rcp_f32 v55, v55
  v_mfma_f32_32x32x16_bf16 v[16:31], v[232:235], v[176:179], v[16:31]
  v_rcp_f32 v56, v56
  v_rcp_f32 v57, v57
  v_rcp_f32_e64 v58, v58
  v_mfma_f32_32x32x16_bf16 v[16:31], v[236:239], v[180:183], v[16:31]
  s_waitcnt lgkmcnt(0)
  v_rcp_f32 v59, v59
  v_rcp_f32 v60, v60
  v_rcp_f32 v61, v61
  v_rcp_f32 v62, v62
  v_rcp_f32 v63, v63
  v_pk_mul_f32 v[32:33], v[32:33], v[48:49]
  v_pk_mul_f32 v[34:35], v[34:35], v[50:51]
  v_pk_mul_f32 v[36:37], v[36:37], v[52:53]
  v_pk_mul_f32 v[38:39], v[38:39], v[54:55]
  v_pk_mul_f32 v[40:41], v[40:41], v[56:57]
  v_pk_mul_f32 v[42:43], v[42:43], v[58:59]
  v_pk_mul_f32 v[44:45], v[44:45], v[60:61]
  v_pk_mul_f32 v[46:47], v[46:47], v[62:63]
  v_pk_fma_f32 v[48:49], v[16:17], v[16:17], s[20:21] neg_lo:[1,0,1] neg_hi:[1,0,1]
  v_pk_fma_f32 v[50:51], v[18:19], v[18:19], s[20:21] neg_lo:[1,0,1] neg_hi:[1,0,1]
  v_pk_fma_f32 v[52:53], v[20:21], v[20:21], s[20:21] neg_lo:[1,0,1] neg_hi:[1,0,1]
  v_pk_fma_f32 v[54:55], v[22:23], v[22:23], s[20:21] neg_lo:[1,0,1] neg_hi:[1,0,1]
  v_pk_fma_f32 v[56:57], v[24:25], v[24:25], s[20:21] neg_lo:[1,0,1] neg_hi:[1,0,1]
  v_pk_fma_f32 v[58:59], v[26:27], v[26:27], s[20:21] neg_lo:[1,0,1] neg_hi:[1,0,1]
  v_pk_fma_f32 v[60:61], v[28:29], v[28:29], s[20:21] neg_lo:[1,0,1] neg_hi:[1,0,1]
  v_pk_fma_f32 v[62:63], v[30:31], v[30:31], s[20:21] neg_lo:[1,0,1] neg_hi:[1,0,1]
  v_pk_mul_f32 v[48:49], v[16:17], v[48:49]
  v_pk_mul_f32 v[50:51], v[18:19], v[50:51]
  v_pk_mul_f32 v[52:53], v[20:21], v[52:53]
  v_pk_mul_f32 v[54:55], v[22:23], v[54:55]
  v_pk_mul_f32 v[56:57], v[24:25], v[56:57]
  v_cvt_pk_bf16_f32 v184, v32, v33
  v_cvt_pk_bf16_f32 v185, v34, v35
  v_cvt_pk_bf16_f32 v186, v36, v37
  v_cvt_pk_bf16_f32 v187, v38, v39
  v_pk_mul_f32 v[58:59], v[26:27], v[58:59]
  v_pk_mul_f32 v[60:61], v[28:29], v[60:61]
  v_pk_mul_f32 v[62:63], v[30:31], v[62:63]
  v_mfma_f32_32x32x16_bf16 v[64:79], v[192:195], v[184:187], v[64:79]
  v_cvt_pk_bf16_f32 v188, v40, v41
  v_cvt_pk_bf16_f32 v189, v42, v43
  v_cvt_pk_bf16_f32 v190, v44, v45
  v_cvt_pk_bf16_f32 v191, v46, v47
  v_exp_f32_e64 v48, v48
  v_mfma_f32_32x32x16_bf16 v[80:95], v[196:199], v[184:187], v[80:95]
  v_exp_f32 v49, v49
  v_exp_f32 v50, v50
  v_exp_f32_e64 v51, v51
  v_mfma_f32_32x32x16_bf16 v[96:111], v[200:203], v[184:187], v[96:111]
  v_exp_f32 v52, v52
  v_exp_f32 v53, v53
  v_exp_f32_e64 v54, v54
  v_mfma_f32_32x32x16_bf16 v[64:79], v[204:207], v[188:191], v[64:79]
  v_exp_f32 v55, v55
  v_exp_f32 v56, v56
  v_exp_f32_e64 v57, v57
  v_mfma_f32_32x32x16_bf16 v[80:95], v[208:211], v[188:191], v[80:95]
  v_exp_f32 v58, v58
  v_exp_f32 v59, v59
  v_exp_f32_e64 v60, v60
  v_mfma_f32_32x32x16_bf16 v[96:111], v[212:215], v[188:191], v[96:111]
  v_exp_f32 v61, v61
  v_exp_f32 v62, v62
  v_exp_f32_e64 v63, v63
  v_pk_fma_f32 v[48:49], v[48:49], s[22:23], s[22:23]
  v_pk_fma_f32 v[50:51], v[50:51], s[22:23], s[22:23]
  v_pk_fma_f32 v[52:53], v[52:53], s[22:23], s[22:23]
  v_pk_fma_f32 v[54:55], v[54:55], s[22:23], s[22:23]
  v_pk_fma_f32 v[56:57], v[56:57], s[22:23], s[22:23]
  v_pk_fma_f32 v[58:59], v[58:59], s[22:23], s[22:23]
  v_pk_fma_f32 v[60:61], v[60:61], s[22:23], s[22:23]
  v_pk_fma_f32 v[62:63], v[62:63], s[22:23], s[22:23]
  v_mfma_f32_32x32x16_bf16 v[32:47], a[0:3], v[160:163], 0
  v_cvt_pk_bf16_f32 v112, v64, v65
  v_cvt_pk_bf16_f32 v113, v66, v67
  v_cvt_pk_bf16_f32 v114, v68, v69
  v_cvt_pk_bf16_f32 v115, v70, v71
  v_cvt_pk_bf16_f32 v116, v72, v73
  v_cvt_pk_bf16_f32 v117, v74, v75
  v_mfma_f32_32x32x16_bf16 v[32:47], a[4:7], v[164:167], v[32:47]
  v_cvt_pk_bf16_f32 v118, v76, v77
  v_cvt_pk_bf16_f32 v119, v78, v79
  v_cvt_pk_bf16_f32 v120, v80, v81
  v_cvt_pk_bf16_f32 v121, v82, v83
  v_cvt_pk_bf16_f32 v122, v84, v85
  v_cvt_pk_bf16_f32 v123, v86, v87
  v_mfma_f32_32x32x16_bf16 v[32:47], a[8:11], v[168:171], v[32:47]
  ds_read_b128 v[64:67], v2
  ds_read_b128 v[68:71], v2 offset:32
  ds_read_b128 v[72:75], v2 offset:64
  ds_read_b128 v[76:79], v2 offset:96
  v_cvt_pk_bf16_f32 v124, v88, v89
  v_cvt_pk_bf16_f32 v125, v90, v91
  v_mfma_f32_32x32x16_bf16 v[32:47], a[12:15], v[172:175], v[32:47]
  ds_read_b128 v[192:195], v1 offset:8192
  ds_read_b128 v[196:199], v1 offset:9216
  v_cvt_pk_bf16_f32 v126, v92, v93
  v_cvt_pk_bf16_f32 v127, v94, v95
  v_cvt_pk_bf16_f32 v128, v96, v97
  v_cvt_pk_bf16_f32 v129, v98, v99
  v_mfma_f32_32x32x16_bf16 v[32:47], a[16:19], v[176:179], v[32:47]
  ds_read_b128 v[80:83], v2 offset:128
  ds_read_b128 v[84:87], v2 offset:160
  ds_read_b128 v[88:91], v2 offset:192
  ds_read_b128 v[92:95], v2 offset:224
  v_cvt_pk_bf16_f32 v130, v100, v101
  v_cvt_pk_bf16_f32 v131, v102, v103
  v_mfma_f32_32x32x16_bf16 v[32:47], a[20:23], v[180:183], v[32:47]
  s_nop 0
  s_waitcnt lgkmcnt(6)
  ds_read_b128 v[200:203], v1 offset:10240
  ds_read_b128 v[204:207], v1 offset:11264
  v_cvt_pk_bf16_f32 v132, v104, v105
  v_cvt_pk_bf16_f32 v133, v106, v107
  v_cvt_pk_bf16_f32 v134, v108, v109
  v_cvt_pk_bf16_f32 v135, v110, v111
  v_mfma_f32_32x32x16_bf16 v[64:79], v[240:243], v[136:139], v[64:79]
  ds_read_b128 v[96:99], v2 offset:256
  ds_read_b128 v[100:103], v2 offset:288
  ds_read_b128 v[104:107], v2 offset:320
  ds_read_b128 v[108:111], v2 offset:352
  v_rcp_f32 v48, v48
  v_mfma_f32_32x32x16_bf16 v[64:79], v[244:247], v[140:143], v[64:79]
  s_waitcnt lgkmcnt(6)
  ds_read_b128 v[208:211], v1 offset:12288
  ds_read_b128 v[212:215], v1 offset:13312
  v_rcp_f32 v49, v49
  v_rcp_f32 v50, v50
  v_mfma_f32_32x32x16_bf16 v[80:95], v[240:243], v[144:147], v[80:95]
  v_rcp_f32 v51, v51
  v_rcp_f32 v52, v52
  v_rcp_f32_e64 v53, v53
  v_mfma_f32_32x32x16_bf16 v[80:95], v[244:247], v[148:151], v[80:95]
  s_waitcnt lgkmcnt(2)
  v_rcp_f32 v54, v54
  v_rcp_f32 v55, v55
  v_rcp_f32 v56, v56
  v_mfma_f32_32x32x16_bf16 v[96:111], v[240:243], v[152:155], v[96:111]
  v_rcp_f32 v57, v57
  v_rcp_f32 v58, v58
  v_rcp_f32_e64 v59, v59
  v_mfma_f32_32x32x16_bf16 v[96:111], v[244:247], v[156:159], v[96:111]
  s_waitcnt lgkmcnt(0)
  v_rcp_f32 v60, v60
  v_rcp_f32 v61, v61
  v_rcp_f32 v62, v62
  v_rcp_f32_e64 v63, v63
  v_pk_mul_f32 v[16:17], v[16:17], v[48:49]
  v_pk_mul_f32 v[18:19], v[18:19], v[50:51]
  v_pk_mul_f32 v[20:21], v[20:21], v[52:53]
  v_pk_mul_f32 v[22:23], v[22:23], v[54:55]
  v_pk_mul_f32 v[24:25], v[24:25], v[56:57]
  v_pk_mul_f32 v[26:27], v[26:27], v[58:59]
  v_pk_mul_f32 v[28:29], v[28:29], v[60:61]
  v_pk_mul_f32 v[30:31], v[30:31], v[62:63]
  v_pk_fma_f32 v[48:49], v[32:33], v[32:33], s[20:21] neg_lo:[1,0,1] neg_hi:[1,0,1]
  v_pk_fma_f32 v[50:51], v[34:35], v[34:35], s[20:21] neg_lo:[1,0,1] neg_hi:[1,0,1]
  v_pk_fma_f32 v[52:53], v[36:37], v[36:37], s[20:21] neg_lo:[1,0,1] neg_hi:[1,0,1]
  v_pk_fma_f32 v[54:55], v[38:39], v[38:39], s[20:21] neg_lo:[1,0,1] neg_hi:[1,0,1]
  v_pk_fma_f32 v[56:57], v[40:41], v[40:41], s[20:21] neg_lo:[1,0,1] neg_hi:[1,0,1]
  v_pk_fma_f32 v[58:59], v[42:43], v[42:43], s[20:21] neg_lo:[1,0,1] neg_hi:[1,0,1]
  v_pk_fma_f32 v[60:61], v[44:45], v[44:45], s[20:21] neg_lo:[1,0,1] neg_hi:[1,0,1]
  v_pk_fma_f32 v[62:63], v[46:47], v[46:47], s[20:21] neg_lo:[1,0,1] neg_hi:[1,0,1]
  v_pk_mul_f32 v[48:49], v[32:33], v[48:49]
  v_pk_mul_f32 v[50:51], v[34:35], v[50:51]
  v_pk_mul_f32 v[52:53], v[36:37], v[52:53]
  v_pk_mul_f32 v[54:55], v[38:39], v[54:55]
  v_pk_mul_f32 v[56:57], v[40:41], v[56:57]
  v_cvt_pk_bf16_f32 v184, v16, v17
  v_cvt_pk_bf16_f32 v185, v18, v19
  v_cvt_pk_bf16_f32 v186, v20, v21
  v_cvt_pk_bf16_f32 v187, v22, v23
  v_pk_mul_f32 v[58:59], v[42:43], v[58:59]
  v_pk_mul_f32 v[60:61], v[44:45], v[60:61]
  v_pk_mul_f32 v[62:63], v[46:47], v[62:63]
  v_mfma_f32_32x32x16_bf16 v[64:79], v[192:195], v[184:187], v[64:79]
  v_cvt_pk_bf16_f32 v188, v24, v25
  v_cvt_pk_bf16_f32 v189, v26, v27
  v_cvt_pk_bf16_f32 v190, v28, v29
  v_cvt_pk_bf16_f32 v191, v30, v31
  v_exp_f32_e64 v48, v48
  v_mfma_f32_32x32x16_bf16 v[80:95], v[196:199], v[184:187], v[80:95]
  v_exp_f32 v49, v49
  v_exp_f32 v50, v50
  v_exp_f32_e64 v51, v51
  v_mfma_f32_32x32x16_bf16 v[96:111], v[200:203], v[184:187], v[96:111]
  v_exp_f32 v52, v52
  v_exp_f32 v53, v53
  v_exp_f32_e64 v54, v54
  v_mfma_f32_32x32x16_bf16 v[64:79], v[204:207], v[188:191], v[64:79]
  v_exp_f32 v55, v55
  v_exp_f32 v56, v56
  v_exp_f32_e64 v57, v57
  v_mfma_f32_32x32x16_bf16 v[80:95], v[208:211], v[188:191], v[80:95]
  v_exp_f32 v58, v58
  v_exp_f32 v59, v59
  v_exp_f32_e64 v60, v60
  v_mfma_f32_32x32x16_bf16 v[96:111], v[212:215], v[188:191], v[96:111]
  v_exp_f32 v61, v61
  v_exp_f32 v62, v62
  v_exp_f32_e64 v63, v63
  v_pk_fma_f32 v[48:49], v[48:49], s[22:23], s[22:23]
  v_pk_fma_f32 v[50:51], v[50:51], s[22:23], s[22:23]
  v_pk_fma_f32 v[52:53], v[52:53], s[22:23], s[22:23]
  v_pk_fma_f32 v[54:55], v[54:55], s[22:23], s[22:23]
  v_pk_fma_f32 v[56:57], v[56:57], s[22:23], s[22:23]
  v_pk_fma_f32 v[58:59], v[58:59], s[22:23], s[22:23]
  v_pk_fma_f32 v[60:61], v[60:61], s[22:23], s[22:23]
  v_pk_fma_f32 v[62:63], v[62:63], s[22:23], s[22:23]
  v_mfma_f32_32x32x16_bf16 v[16:31], a[24:27], v[160:163], 0
  ds_read_b128 v[192:195], v1 offset:14336
  ds_read_b128 v[196:199], v1 offset:15360
  v_rcp_f32 v48, v48
  v_rcp_f32 v49, v49
  v_mfma_f32_32x32x16_bf16 v[16:31], a[28:31], v[164:167], v[16:31]
  ds_read_b128 v[200:203], v1 offset:16384
  ds_read_b128 v[204:207], v1 offset:17408
  v_rcp_f32 v50, v50
  v_rcp_f32 v51, v51
  v_mfma_f32_32x32x16_bf16 v[16:31], a[32:35], v[168:171], v[16:31]
  ds_read_b128 v[208:211], v1 offset:18432
  ds_read_b128 v[212:215], v1 offset:19456
  v_rcp_f32 v52, v52
  v_rcp_f32 v53, v53
  v_mfma_f32_32x32x16_bf16 v[16:31], a[36:39], v[172:175], v[16:31]
  buffer_store_dwordx4 v[112:115], v10, s[8:11], s28 offen
  v_rcp_f32 v54, v54
  v_rcp_f32 v55, v55
  v_mfma_f32_32x32x16_bf16 v[16:31], a[40:43], v[176:179], v[16:31]
  v_rcp_f32 v56, v56
  v_rcp_f32 v57, v57
  v_rcp_f32_e64 v58, v58
  v_mfma_f32_32x32x16_bf16 v[16:31], a[44:47], v[180:183], v[16:31]
  s_waitcnt lgkmcnt(0)
  v_rcp_f32 v59, v59
  v_rcp_f32 v60, v60
  v_rcp_f32 v61, v61
  v_rcp_f32 v62, v62
  v_rcp_f32 v63, v63
  v_pk_mul_f32 v[32:33], v[32:33], v[48:49]
  v_pk_mul_f32 v[34:35], v[34:35], v[50:51]
  v_pk_mul_f32 v[36:37], v[36:37], v[52:53]
  v_pk_mul_f32 v[38:39], v[38:39], v[54:55]
  v_pk_mul_f32 v[40:41], v[40:41], v[56:57]
  v_pk_mul_f32 v[42:43], v[42:43], v[58:59]
  v_pk_mul_f32 v[44:45], v[44:45], v[60:61]
  v_pk_mul_f32 v[46:47], v[46:47], v[62:63]
  v_pk_fma_f32 v[48:49], v[16:17], v[16:17], s[20:21] neg_lo:[1,0,1] neg_hi:[1,0,1]
  v_pk_fma_f32 v[50:51], v[18:19], v[18:19], s[20:21] neg_lo:[1,0,1] neg_hi:[1,0,1]
  v_pk_fma_f32 v[52:53], v[20:21], v[20:21], s[20:21] neg_lo:[1,0,1] neg_hi:[1,0,1]
  v_pk_fma_f32 v[54:55], v[22:23], v[22:23], s[20:21] neg_lo:[1,0,1] neg_hi:[1,0,1]
  v_pk_fma_f32 v[56:57], v[24:25], v[24:25], s[20:21] neg_lo:[1,0,1] neg_hi:[1,0,1]
  v_pk_fma_f32 v[58:59], v[26:27], v[26:27], s[20:21] neg_lo:[1,0,1] neg_hi:[1,0,1]
  v_pk_fma_f32 v[60:61], v[28:29], v[28:29], s[20:21] neg_lo:[1,0,1] neg_hi:[1,0,1]
  v_pk_fma_f32 v[62:63], v[30:31], v[30:31], s[20:21] neg_lo:[1,0,1] neg_hi:[1,0,1]
  v_pk_mul_f32 v[48:49], v[16:17], v[48:49]
  v_pk_mul_f32 v[50:51], v[18:19], v[50:51]
  v_pk_mul_f32 v[52:53], v[20:21], v[52:53]
  v_pk_mul_f32 v[54:55], v[22:23], v[54:55]
  v_pk_mul_f32 v[56:57], v[24:25], v[56:57]
  v_cvt_pk_bf16_f32 v184, v32, v33
  v_cvt_pk_bf16_f32 v185, v34, v35
  v_cvt_pk_bf16_f32 v186, v36, v37
  v_cvt_pk_bf16_f32 v187, v38, v39
  v_pk_mul_f32 v[58:59], v[26:27], v[58:59]
  v_pk_mul_f32 v[60:61], v[28:29], v[60:61]
  v_pk_mul_f32 v[62:63], v[30:31], v[62:63]
  v_mfma_f32_32x32x16_bf16 v[64:79], v[192:195], v[184:187], v[64:79]
  v_cvt_pk_bf16_f32 v188, v40, v41
  v_cvt_pk_bf16_f32 v189, v42, v43
  v_cvt_pk_bf16_f32 v190, v44, v45
  v_cvt_pk_bf16_f32 v191, v46, v47
  v_exp_f32_e64 v48, v48
  v_mfma_f32_32x32x16_bf16 v[80:95], v[196:199], v[184:187], v[80:95]
  v_exp_f32 v49, v49
  v_exp_f32 v50, v50
  v_exp_f32_e64 v51, v51
  v_mfma_f32_32x32x16_bf16 v[96:111], v[200:203], v[184:187], v[96:111]
  v_exp_f32 v52, v52
  v_exp_f32 v53, v53
  v_exp_f32_e64 v54, v54
  v_mfma_f32_32x32x16_bf16 v[64:79], v[204:207], v[188:191], v[64:79]
  v_exp_f32 v55, v55
  v_exp_f32 v56, v56
  v_exp_f32_e64 v57, v57
  v_mfma_f32_32x32x16_bf16 v[80:95], v[208:211], v[188:191], v[80:95]
  v_exp_f32 v58, v58
  v_exp_f32 v59, v59
  v_exp_f32_e64 v60, v60
  v_mfma_f32_32x32x16_bf16 v[96:111], v[212:215], v[188:191], v[96:111]
  v_exp_f32 v61, v61
  v_exp_f32 v62, v62
  v_exp_f32_e64 v63, v63
  v_pk_fma_f32 v[48:49], v[48:49], s[22:23], s[22:23]
  v_pk_fma_f32 v[50:51], v[50:51], s[22:23], s[22:23]
  v_pk_fma_f32 v[52:53], v[52:53], s[22:23], s[22:23]
  v_pk_fma_f32 v[54:55], v[54:55], s[22:23], s[22:23]
  v_pk_fma_f32 v[56:57], v[56:57], s[22:23], s[22:23]
  v_pk_fma_f32 v[58:59], v[58:59], s[22:23], s[22:23]
  v_pk_fma_f32 v[60:61], v[60:61], s[22:23], s[22:23]
  v_pk_fma_f32 v[62:63], v[62:63], s[22:23], s[22:23]
  v_mfma_f32_32x32x16_bf16 v[32:47], a[48:51], v[160:163], 0
  ds_read_b128 v[192:195], v1 offset:20480
  ds_read_b128 v[196:199], v1 offset:21504
  v_rcp_f32 v48, v48
  v_rcp_f32 v49, v49
  v_mfma_f32_32x32x16_bf16 v[32:47], a[52:55], v[164:167], v[32:47]
  ds_read_b128 v[200:203], v1 offset:22528
  ds_read_b128 v[204:207], v1 offset:23552
  v_rcp_f32 v50, v50
  v_rcp_f32 v51, v51
  v_mfma_f32_32x32x16_bf16 v[32:47], a[56:59], v[168:171], v[32:47]
  ds_read_b128 v[208:211], v1 offset:24576
  ds_read_b128 v[212:215], v1 offset:25600
  v_rcp_f32 v52, v52
  v_rcp_f32 v53, v53
  v_mfma_f32_32x32x16_bf16 v[32:47], a[60:63], v[172:175], v[32:47]
  buffer_store_dwordx4 v[116:119], v10, s[8:11], s28 offen offset:32
  v_rcp_f32 v54, v54
  v_rcp_f32 v55, v55
  v_mfma_f32_32x32x16_bf16 v[32:47], a[64:67], v[176:179], v[32:47]
  v_rcp_f32 v56, v56
  v_rcp_f32 v57, v57
  v_rcp_f32_e64 v58, v58
  v_mfma_f32_32x32x16_bf16 v[32:47], a[68:71], v[180:183], v[32:47]
  s_waitcnt lgkmcnt(0)
  v_rcp_f32 v59, v59
  v_rcp_f32 v60, v60
  v_rcp_f32 v61, v61
  v_rcp_f32 v62, v62
  v_rcp_f32 v63, v63
  v_pk_mul_f32 v[16:17], v[16:17], v[48:49]
  v_pk_mul_f32 v[18:19], v[18:19], v[50:51]
  v_pk_mul_f32 v[20:21], v[20:21], v[52:53]
  v_pk_mul_f32 v[22:23], v[22:23], v[54:55]
  v_pk_mul_f32 v[24:25], v[24:25], v[56:57]
  v_pk_mul_f32 v[26:27], v[26:27], v[58:59]
  v_pk_mul_f32 v[28:29], v[28:29], v[60:61]
  v_pk_mul_f32 v[30:31], v[30:31], v[62:63]
  v_pk_fma_f32 v[48:49], v[32:33], v[32:33], s[20:21] neg_lo:[1,0,1] neg_hi:[1,0,1]
  v_pk_fma_f32 v[50:51], v[34:35], v[34:35], s[20:21] neg_lo:[1,0,1] neg_hi:[1,0,1]
  v_pk_fma_f32 v[52:53], v[36:37], v[36:37], s[20:21] neg_lo:[1,0,1] neg_hi:[1,0,1]
  v_pk_fma_f32 v[54:55], v[38:39], v[38:39], s[20:21] neg_lo:[1,0,1] neg_hi:[1,0,1]
  v_pk_fma_f32 v[56:57], v[40:41], v[40:41], s[20:21] neg_lo:[1,0,1] neg_hi:[1,0,1]
  v_pk_fma_f32 v[58:59], v[42:43], v[42:43], s[20:21] neg_lo:[1,0,1] neg_hi:[1,0,1]
  v_pk_fma_f32 v[60:61], v[44:45], v[44:45], s[20:21] neg_lo:[1,0,1] neg_hi:[1,0,1]
  v_pk_fma_f32 v[62:63], v[46:47], v[46:47], s[20:21] neg_lo:[1,0,1] neg_hi:[1,0,1]
  v_pk_mul_f32 v[48:49], v[32:33], v[48:49]
  v_pk_mul_f32 v[50:51], v[34:35], v[50:51]
  v_pk_mul_f32 v[52:53], v[36:37], v[52:53]
  v_pk_mul_f32 v[54:55], v[38:39], v[54:55]
  v_pk_mul_f32 v[56:57], v[40:41], v[56:57]
  v_cvt_pk_bf16_f32 v184, v16, v17
  v_cvt_pk_bf16_f32 v185, v18, v19
  v_cvt_pk_bf16_f32 v186, v20, v21
  v_cvt_pk_bf16_f32 v187, v22, v23
  v_pk_mul_f32 v[58:59], v[42:43], v[58:59]
  v_pk_mul_f32 v[60:61], v[44:45], v[60:61]
  v_pk_mul_f32 v[62:63], v[46:47], v[62:63]
  v_mfma_f32_32x32x16_bf16 v[64:79], v[192:195], v[184:187], v[64:79]
  v_cvt_pk_bf16_f32 v188, v24, v25
  v_cvt_pk_bf16_f32 v189, v26, v27
  v_cvt_pk_bf16_f32 v190, v28, v29
  v_cvt_pk_bf16_f32 v191, v30, v31
  v_exp_f32_e64 v48, v48
  v_mfma_f32_32x32x16_bf16 v[80:95], v[196:199], v[184:187], v[80:95]
  v_exp_f32 v49, v49
  v_exp_f32 v50, v50
  v_exp_f32_e64 v51, v51
  v_mfma_f32_32x32x16_bf16 v[96:111], v[200:203], v[184:187], v[96:111]
  v_exp_f32 v52, v52
  v_exp_f32 v53, v53
  v_exp_f32_e64 v54, v54
  v_mfma_f32_32x32x16_bf16 v[64:79], v[204:207], v[188:191], v[64:79]
  v_exp_f32 v55, v55
  v_exp_f32 v56, v56
  v_exp_f32_e64 v57, v57
  v_mfma_f32_32x32x16_bf16 v[80:95], v[208:211], v[188:191], v[80:95]
  v_exp_f32 v58, v58
  v_exp_f32 v59, v59
  v_exp_f32_e64 v60, v60
  v_mfma_f32_32x32x16_bf16 v[96:111], v[212:215], v[188:191], v[96:111]
  v_exp_f32 v61, v61
  v_exp_f32 v62, v62
  v_exp_f32_e64 v63, v63
  v_pk_fma_f32 v[48:49], v[48:49], s[22:23], s[22:23]
  v_pk_fma_f32 v[50:51], v[50:51], s[22:23], s[22:23]
  v_pk_fma_f32 v[52:53], v[52:53], s[22:23], s[22:23]
  v_pk_fma_f32 v[54:55], v[54:55], s[22:23], s[22:23]
  v_pk_fma_f32 v[56:57], v[56:57], s[22:23], s[22:23]
  v_pk_fma_f32 v[58:59], v[58:59], s[22:23], s[22:23]
  v_pk_fma_f32 v[60:61], v[60:61], s[22:23], s[22:23]
  v_pk_fma_f32 v[62:63], v[62:63], s[22:23], s[22:23]
  v_mfma_f32_32x32x16_bf16 v[16:31], a[72:75], v[160:163], 0
  ds_read_b128 v[192:195], v1 offset:26624
  ds_read_b128 v[196:199], v1 offset:27648
  v_rcp_f32 v48, v48
  v_rcp_f32 v49, v49
  v_mfma_f32_32x32x16_bf16 v[16:31], a[76:79], v[164:167], v[16:31]
  ds_read_b128 v[200:203], v1 offset:28672
  ds_read_b128 v[204:207], v1 offset:29696
  v_rcp_f32 v50, v50
  v_rcp_f32 v51, v51
  v_mfma_f32_32x32x16_bf16 v[16:31], a[80:83], v[168:171], v[16:31]
  ds_read_b128 v[208:211], v1 offset:30720
  ds_read_b128 v[212:215], v1 offset:31744
  v_rcp_f32 v52, v52
  v_rcp_f32 v53, v53
  v_mfma_f32_32x32x16_bf16 v[16:31], a[84:87], v[172:175], v[16:31]
  v_rcp_f32 v54, v54
  v_rcp_f32 v55, v55
  v_rcp_f32_e64 v56, v56
  v_mfma_f32_32x32x16_bf16 v[16:31], a[88:91], v[176:179], v[16:31]
  v_rcp_f32 v57, v57
  v_rcp_f32 v58, v58
  v_rcp_f32_e64 v59, v59
  v_mfma_f32_32x32x16_bf16 v[16:31], a[92:95], v[180:183], v[16:31]
  s_waitcnt lgkmcnt(0)
  v_rcp_f32 v60, v60
  v_rcp_f32 v61, v61
  v_rcp_f32 v62, v62
  v_rcp_f32_e64 v63, v63
  v_pk_mul_f32 v[32:33], v[32:33], v[48:49]
  v_pk_mul_f32 v[34:35], v[34:35], v[50:51]
  v_pk_mul_f32 v[36:37], v[36:37], v[52:53]
  v_pk_mul_f32 v[38:39], v[38:39], v[54:55]
  v_pk_mul_f32 v[40:41], v[40:41], v[56:57]
  v_pk_mul_f32 v[42:43], v[42:43], v[58:59]
  v_pk_mul_f32 v[44:45], v[44:45], v[60:61]
  v_pk_mul_f32 v[46:47], v[46:47], v[62:63]
  v_pk_fma_f32 v[48:49], v[16:17], v[16:17], s[20:21] neg_lo:[1,0,1] neg_hi:[1,0,1]
  v_pk_fma_f32 v[50:51], v[18:19], v[18:19], s[20:21] neg_lo:[1,0,1] neg_hi:[1,0,1]
  v_pk_fma_f32 v[52:53], v[20:21], v[20:21], s[20:21] neg_lo:[1,0,1] neg_hi:[1,0,1]
  v_pk_fma_f32 v[54:55], v[22:23], v[22:23], s[20:21] neg_lo:[1,0,1] neg_hi:[1,0,1]
  v_pk_fma_f32 v[56:57], v[24:25], v[24:25], s[20:21] neg_lo:[1,0,1] neg_hi:[1,0,1]
  v_pk_fma_f32 v[58:59], v[26:27], v[26:27], s[20:21] neg_lo:[1,0,1] neg_hi:[1,0,1]
  v_pk_fma_f32 v[60:61], v[28:29], v[28:29], s[20:21] neg_lo:[1,0,1] neg_hi:[1,0,1]
  v_pk_fma_f32 v[62:63], v[30:31], v[30:31], s[20:21] neg_lo:[1,0,1] neg_hi:[1,0,1]
  v_pk_mul_f32 v[48:49], v[16:17], v[48:49]
  v_pk_mul_f32 v[50:51], v[18:19], v[50:51]
  v_pk_mul_f32 v[52:53], v[20:21], v[52:53]
  v_pk_mul_f32 v[54:55], v[22:23], v[54:55]
  v_pk_mul_f32 v[56:57], v[24:25], v[56:57]
  v_cvt_pk_bf16_f32 v184, v32, v33
  v_cvt_pk_bf16_f32 v185, v34, v35
  v_cvt_pk_bf16_f32 v186, v36, v37
  v_cvt_pk_bf16_f32 v187, v38, v39
  v_pk_mul_f32 v[58:59], v[26:27], v[58:59]
  v_pk_mul_f32 v[60:61], v[28:29], v[60:61]
  v_pk_mul_f32 v[62:63], v[30:31], v[62:63]
  v_mfma_f32_32x32x16_bf16 v[64:79], v[192:195], v[184:187], v[64:79]
  v_cvt_pk_bf16_f32 v188, v40, v41
  v_cvt_pk_bf16_f32 v189, v42, v43
  v_cvt_pk_bf16_f32 v190, v44, v45
  v_cvt_pk_bf16_f32 v191, v46, v47
  v_exp_f32_e64 v48, v48
  v_mfma_f32_32x32x16_bf16 v[80:95], v[196:199], v[184:187], v[80:95]
  v_exp_f32 v49, v49
  v_exp_f32 v50, v50
  v_exp_f32_e64 v51, v51
  v_mfma_f32_32x32x16_bf16 v[96:111], v[200:203], v[184:187], v[96:111]
  v_exp_f32 v52, v52
  v_exp_f32 v53, v53
  v_exp_f32_e64 v54, v54
  v_mfma_f32_32x32x16_bf16 v[64:79], v[204:207], v[188:191], v[64:79]
  v_exp_f32 v55, v55
  v_exp_f32 v56, v56
  v_exp_f32_e64 v57, v57
  v_mfma_f32_32x32x16_bf16 v[80:95], v[208:211], v[188:191], v[80:95]
  v_exp_f32 v58, v58
  v_exp_f32 v59, v59
  v_exp_f32_e64 v60, v60
  v_mfma_f32_32x32x16_bf16 v[96:111], v[212:215], v[188:191], v[96:111]
  v_exp_f32 v61, v61
  v_exp_f32 v62, v62
  v_exp_f32_e64 v63, v63
  v_pk_fma_f32 v[48:49], v[48:49], s[22:23], s[22:23]
  v_pk_fma_f32 v[50:51], v[50:51], s[22:23], s[22:23]
  v_pk_fma_f32 v[52:53], v[52:53], s[22:23], s[22:23]
  v_pk_fma_f32 v[54:55], v[54:55], s[22:23], s[22:23]
  v_pk_fma_f32 v[56:57], v[56:57], s[22:23], s[22:23]
  v_pk_fma_f32 v[58:59], v[58:59], s[22:23], s[22:23]
  v_pk_fma_f32 v[60:61], v[60:61], s[22:23], s[22:23]
  v_pk_fma_f32 v[62:63], v[62:63], s[22:23], s[22:23]
  v_mfma_f32_32x32x16_bf16 v[32:47], a[96:99], v[160:163], 0
  ds_read_b128 v[192:195], v0 offset:24576
  ds_read_b128 v[196:199], v0 offset:25600
  v_rcp_f32 v48, v48
  v_rcp_f32 v49, v49
  v_mfma_f32_32x32x16_bf16 v[32:47], a[100:103], v[164:167], v[32:47]
  ds_read_b128 v[200:203], v0 offset:26624
  ds_read_b128 v[204:207], v0 offset:27648
  v_rcp_f32 v50, v50
  v_rcp_f32 v51, v51
  v_mfma_f32_32x32x16_bf16 v[32:47], a[104:107], v[168:171], v[32:47]
  ds_read_b128 v[208:211], v0 offset:28672
  ds_read_b128 v[212:215], v0 offset:29696
  v_rcp_f32 v52, v52
  v_rcp_f32 v53, v53
  v_mfma_f32_32x32x16_bf16 v[32:47], a[108:111], v[172:175], v[32:47]
  buffer_store_dwordx4 v[120:123], v10, s[8:11], s28 offen offset:64
  v_rcp_f32 v54, v54
  v_rcp_f32 v55, v55
  v_mfma_f32_32x32x16_bf16 v[32:47], a[112:115], v[176:179], v[32:47]
  v_rcp_f32 v56, v56
  v_rcp_f32 v57, v57
  v_rcp_f32_e64 v58, v58
  v_mfma_f32_32x32x16_bf16 v[32:47], a[116:119], v[180:183], v[32:47]
  s_waitcnt lgkmcnt(0)
  v_rcp_f32 v59, v59
  v_rcp_f32 v60, v60
  v_rcp_f32 v61, v61
  v_rcp_f32 v62, v62
  v_rcp_f32 v63, v63
  v_pk_mul_f32 v[16:17], v[16:17], v[48:49]
  v_pk_mul_f32 v[18:19], v[18:19], v[50:51]
  v_pk_mul_f32 v[20:21], v[20:21], v[52:53]
  v_pk_mul_f32 v[22:23], v[22:23], v[54:55]
  v_pk_mul_f32 v[24:25], v[24:25], v[56:57]
  v_pk_mul_f32 v[26:27], v[26:27], v[58:59]
  v_pk_mul_f32 v[28:29], v[28:29], v[60:61]
  v_pk_mul_f32 v[30:31], v[30:31], v[62:63]
  v_pk_fma_f32 v[48:49], v[32:33], v[32:33], s[20:21] neg_lo:[1,0,1] neg_hi:[1,0,1]
  v_pk_fma_f32 v[50:51], v[34:35], v[34:35], s[20:21] neg_lo:[1,0,1] neg_hi:[1,0,1]
  v_pk_fma_f32 v[52:53], v[36:37], v[36:37], s[20:21] neg_lo:[1,0,1] neg_hi:[1,0,1]
  v_pk_fma_f32 v[54:55], v[38:39], v[38:39], s[20:21] neg_lo:[1,0,1] neg_hi:[1,0,1]
  v_pk_fma_f32 v[56:57], v[40:41], v[40:41], s[20:21] neg_lo:[1,0,1] neg_hi:[1,0,1]
  v_pk_fma_f32 v[58:59], v[42:43], v[42:43], s[20:21] neg_lo:[1,0,1] neg_hi:[1,0,1]
  v_pk_fma_f32 v[60:61], v[44:45], v[44:45], s[20:21] neg_lo:[1,0,1] neg_hi:[1,0,1]
  v_pk_fma_f32 v[62:63], v[46:47], v[46:47], s[20:21] neg_lo:[1,0,1] neg_hi:[1,0,1]
  v_pk_mul_f32 v[48:49], v[32:33], v[48:49]
  v_pk_mul_f32 v[50:51], v[34:35], v[50:51]
  v_pk_mul_f32 v[52:53], v[36:37], v[52:53]
  v_pk_mul_f32 v[54:55], v[38:39], v[54:55]
  v_pk_mul_f32 v[56:57], v[40:41], v[56:57]
  v_cvt_pk_bf16_f32 v184, v16, v17
  v_cvt_pk_bf16_f32 v185, v18, v19
  v_cvt_pk_bf16_f32 v186, v20, v21
  v_cvt_pk_bf16_f32 v187, v22, v23
  v_pk_mul_f32 v[58:59], v[42:43], v[58:59]
  v_pk_mul_f32 v[60:61], v[44:45], v[60:61]
  v_pk_mul_f32 v[62:63], v[46:47], v[62:63]
  v_mfma_f32_32x32x16_bf16 v[64:79], v[192:195], v[184:187], v[64:79]
  v_cvt_pk_bf16_f32 v188, v24, v25
  v_cvt_pk_bf16_f32 v189, v26, v27
  v_cvt_pk_bf16_f32 v190, v28, v29
  v_cvt_pk_bf16_f32 v191, v30, v31
  v_exp_f32_e64 v48, v48
  v_mfma_f32_32x32x16_bf16 v[80:95], v[196:199], v[184:187], v[80:95]
  v_exp_f32 v49, v49
  v_exp_f32 v50, v50
  v_exp_f32_e64 v51, v51
  v_mfma_f32_32x32x16_bf16 v[96:111], v[200:203], v[184:187], v[96:111]
  v_exp_f32 v52, v52
  v_exp_f32 v53, v53
  v_exp_f32_e64 v54, v54
  v_mfma_f32_32x32x16_bf16 v[64:79], v[204:207], v[188:191], v[64:79]
  v_exp_f32 v55, v55
  v_exp_f32 v56, v56
  v_exp_f32_e64 v57, v57
  v_mfma_f32_32x32x16_bf16 v[80:95], v[208:211], v[188:191], v[80:95]
  v_exp_f32 v58, v58
  v_exp_f32 v59, v59
  v_exp_f32_e64 v60, v60
  v_mfma_f32_32x32x16_bf16 v[96:111], v[212:215], v[188:191], v[96:111]
  v_exp_f32 v61, v61
  v_exp_f32 v62, v62
  v_exp_f32_e64 v63, v63
  v_pk_fma_f32 v[48:49], v[48:49], s[22:23], s[22:23]
  v_pk_fma_f32 v[50:51], v[50:51], s[22:23], s[22:23]
  v_pk_fma_f32 v[52:53], v[52:53], s[22:23], s[22:23]
  v_pk_fma_f32 v[54:55], v[54:55], s[22:23], s[22:23]
  v_pk_fma_f32 v[56:57], v[56:57], s[22:23], s[22:23]
  v_pk_fma_f32 v[58:59], v[58:59], s[22:23], s[22:23]
  v_pk_fma_f32 v[60:61], v[60:61], s[22:23], s[22:23]
  v_pk_fma_f32 v[62:63], v[62:63], s[22:23], s[22:23]
  v_mfma_f32_32x32x16_bf16 v[16:31], a[120:123], v[160:163], 0
  ds_read_b128 v[192:195], v0 offset:30720
  ds_read_b128 v[196:199], v0 offset:31744
  v_rcp_f32 v48, v48
  v_rcp_f32 v49, v49
  v_mfma_f32_32x32x16_bf16 v[16:31], a[124:127], v[164:167], v[16:31]
  ds_read_b128 v[200:203], v0 offset:32768
  ds_read_b128 v[204:207], v0 offset:33792
  v_rcp_f32 v50, v50
  v_rcp_f32 v51, v51
  v_mfma_f32_32x32x16_bf16 v[16:31], a[128:131], v[168:171], v[16:31]
  ds_read_b128 v[208:211], v0 offset:34816
  ds_read_b128 v[212:215], v0 offset:35840
  v_rcp_f32 v52, v52
  v_rcp_f32 v53, v53
  v_mfma_f32_32x32x16_bf16 v[16:31], a[132:135], v[172:175], v[16:31]
  buffer_store_dwordx4 v[124:127], v10, s[8:11], s28 offen offset:96
  v_rcp_f32 v54, v54
  v_rcp_f32 v55, v55
  v_mfma_f32_32x32x16_bf16 v[16:31], a[136:139], v[176:179], v[16:31]
  v_rcp_f32 v56, v56
  v_rcp_f32 v57, v57
  v_rcp_f32_e64 v58, v58
  v_mfma_f32_32x32x16_bf16 v[16:31], a[140:143], v[180:183], v[16:31]
  s_waitcnt lgkmcnt(0)
  v_rcp_f32 v59, v59
  v_rcp_f32 v60, v60
  v_rcp_f32 v61, v61
  v_rcp_f32 v62, v62
  v_rcp_f32 v63, v63
  v_pk_mul_f32 v[32:33], v[32:33], v[48:49]
  v_pk_mul_f32 v[34:35], v[34:35], v[50:51]
  v_pk_mul_f32 v[36:37], v[36:37], v[52:53]
  v_pk_mul_f32 v[38:39], v[38:39], v[54:55]
  v_pk_mul_f32 v[40:41], v[40:41], v[56:57]
  v_pk_mul_f32 v[42:43], v[42:43], v[58:59]
  v_pk_mul_f32 v[44:45], v[44:45], v[60:61]
  v_pk_mul_f32 v[46:47], v[46:47], v[62:63]
  v_pk_fma_f32 v[48:49], v[16:17], v[16:17], s[20:21] neg_lo:[1,0,1] neg_hi:[1,0,1]
  v_pk_fma_f32 v[50:51], v[18:19], v[18:19], s[20:21] neg_lo:[1,0,1] neg_hi:[1,0,1]
  v_pk_fma_f32 v[52:53], v[20:21], v[20:21], s[20:21] neg_lo:[1,0,1] neg_hi:[1,0,1]
  v_pk_fma_f32 v[54:55], v[22:23], v[22:23], s[20:21] neg_lo:[1,0,1] neg_hi:[1,0,1]
  v_pk_fma_f32 v[56:57], v[24:25], v[24:25], s[20:21] neg_lo:[1,0,1] neg_hi:[1,0,1]
  v_pk_fma_f32 v[58:59], v[26:27], v[26:27], s[20:21] neg_lo:[1,0,1] neg_hi:[1,0,1]
  v_pk_fma_f32 v[60:61], v[28:29], v[28:29], s[20:21] neg_lo:[1,0,1] neg_hi:[1,0,1]
  v_pk_fma_f32 v[62:63], v[30:31], v[30:31], s[20:21] neg_lo:[1,0,1] neg_hi:[1,0,1]
  v_pk_mul_f32 v[48:49], v[16:17], v[48:49]
  v_pk_mul_f32 v[50:51], v[18:19], v[50:51]
  v_pk_mul_f32 v[52:53], v[20:21], v[52:53]
  v_pk_mul_f32 v[54:55], v[22:23], v[54:55]
  v_pk_mul_f32 v[56:57], v[24:25], v[56:57]
  v_cvt_pk_bf16_f32 v184, v32, v33
  v_cvt_pk_bf16_f32 v185, v34, v35
  v_cvt_pk_bf16_f32 v186, v36, v37
  v_cvt_pk_bf16_f32 v187, v38, v39
  v_pk_mul_f32 v[58:59], v[26:27], v[58:59]
  v_pk_mul_f32 v[60:61], v[28:29], v[60:61]
  v_pk_mul_f32 v[62:63], v[30:31], v[62:63]
  v_mfma_f32_32x32x16_bf16 v[64:79], v[192:195], v[184:187], v[64:79]
  v_cvt_pk_bf16_f32 v188, v40, v41
  v_cvt_pk_bf16_f32 v189, v42, v43
  v_cvt_pk_bf16_f32 v190, v44, v45
  v_cvt_pk_bf16_f32 v191, v46, v47
  v_exp_f32_e64 v48, v48
  v_mfma_f32_32x32x16_bf16 v[80:95], v[196:199], v[184:187], v[80:95]
  v_exp_f32 v49, v49
  v_exp_f32 v50, v50
  v_exp_f32_e64 v51, v51
  v_mfma_f32_32x32x16_bf16 v[96:111], v[200:203], v[184:187], v[96:111]
  v_exp_f32 v52, v52
  v_exp_f32 v53, v53
  v_exp_f32_e64 v54, v54
  v_mfma_f32_32x32x16_bf16 v[64:79], v[204:207], v[188:191], v[64:79]
  v_exp_f32 v55, v55
  v_exp_f32 v56, v56
  v_exp_f32_e64 v57, v57
  v_mfma_f32_32x32x16_bf16 v[80:95], v[208:211], v[188:191], v[80:95]
  v_exp_f32 v58, v58
  v_exp_f32 v59, v59
  v_exp_f32_e64 v60, v60
  v_mfma_f32_32x32x16_bf16 v[96:111], v[212:215], v[188:191], v[96:111]
  v_exp_f32 v61, v61
  v_exp_f32 v62, v62
  v_exp_f32_e64 v63, v63
  v_pk_fma_f32 v[48:49], v[48:49], s[22:23], s[22:23]
  v_pk_fma_f32 v[50:51], v[50:51], s[22:23], s[22:23]
  v_pk_fma_f32 v[52:53], v[52:53], s[22:23], s[22:23]
  v_pk_fma_f32 v[54:55], v[54:55], s[22:23], s[22:23]
  v_pk_fma_f32 v[56:57], v[56:57], s[22:23], s[22:23]
  v_pk_fma_f32 v[58:59], v[58:59], s[22:23], s[22:23]
  v_pk_fma_f32 v[60:61], v[60:61], s[22:23], s[22:23]
  v_pk_fma_f32 v[62:63], v[62:63], s[22:23], s[22:23]
  v_mfma_f32_32x32x16_bf16 v[32:47], a[144:147], v[160:163], 0
  ds_read_b128 v[192:195], v0 offset:36864
  ds_read_b128 v[196:199], v0 offset:37888
  v_rcp_f32 v48, v48
  v_rcp_f32 v49, v49
  v_mfma_f32_32x32x16_bf16 v[32:47], a[148:151], v[164:167], v[32:47]
  ds_read_b128 v[200:203], v0 offset:38912
  ds_read_b128 v[204:207], v0 offset:39936
  v_rcp_f32 v50, v50
  v_rcp_f32 v51, v51
  v_mfma_f32_32x32x16_bf16 v[32:47], a[152:155], v[168:171], v[32:47]
  ds_read_b128 v[208:211], v0 offset:40960
  ds_read_b128 v[212:215], v0 offset:41984
  v_rcp_f32 v52, v52
  v_rcp_f32 v53, v53
  v_mfma_f32_32x32x16_bf16 v[32:47], a[156:159], v[172:175], v[32:47]
  v_rcp_f32 v54, v54
  v_rcp_f32 v55, v55
  v_rcp_f32_e64 v56, v56
  v_mfma_f32_32x32x16_bf16 v[32:47], a[160:163], v[176:179], v[32:47]
  v_rcp_f32 v57, v57
  v_rcp_f32 v58, v58
  v_rcp_f32_e64 v59, v59
  v_mfma_f32_32x32x16_bf16 v[32:47], a[164:167], v[180:183], v[32:47]
  s_waitcnt lgkmcnt(0)
  v_rcp_f32 v60, v60
  v_rcp_f32 v61, v61
  v_rcp_f32 v62, v62
  v_rcp_f32_e64 v63, v63
  v_pk_mul_f32 v[16:17], v[16:17], v[48:49]
  v_pk_mul_f32 v[18:19], v[18:19], v[50:51]
  v_pk_mul_f32 v[20:21], v[20:21], v[52:53]
  v_pk_mul_f32 v[22:23], v[22:23], v[54:55]
  v_pk_mul_f32 v[24:25], v[24:25], v[56:57]
  v_pk_mul_f32 v[26:27], v[26:27], v[58:59]
  v_pk_mul_f32 v[28:29], v[28:29], v[60:61]
  v_pk_mul_f32 v[30:31], v[30:31], v[62:63]
  v_pk_fma_f32 v[48:49], v[32:33], v[32:33], s[20:21] neg_lo:[1,0,1] neg_hi:[1,0,1]
  v_pk_fma_f32 v[50:51], v[34:35], v[34:35], s[20:21] neg_lo:[1,0,1] neg_hi:[1,0,1]
  v_pk_fma_f32 v[52:53], v[36:37], v[36:37], s[20:21] neg_lo:[1,0,1] neg_hi:[1,0,1]
  v_pk_fma_f32 v[54:55], v[38:39], v[38:39], s[20:21] neg_lo:[1,0,1] neg_hi:[1,0,1]
  v_pk_fma_f32 v[56:57], v[40:41], v[40:41], s[20:21] neg_lo:[1,0,1] neg_hi:[1,0,1]
  v_pk_fma_f32 v[58:59], v[42:43], v[42:43], s[20:21] neg_lo:[1,0,1] neg_hi:[1,0,1]
  v_pk_fma_f32 v[60:61], v[44:45], v[44:45], s[20:21] neg_lo:[1,0,1] neg_hi:[1,0,1]
  v_pk_fma_f32 v[62:63], v[46:47], v[46:47], s[20:21] neg_lo:[1,0,1] neg_hi:[1,0,1]
  v_pk_mul_f32 v[48:49], v[32:33], v[48:49]
  v_pk_mul_f32 v[50:51], v[34:35], v[50:51]
  v_pk_mul_f32 v[52:53], v[36:37], v[52:53]
  v_pk_mul_f32 v[54:55], v[38:39], v[54:55]
  v_pk_mul_f32 v[56:57], v[40:41], v[56:57]
  v_cvt_pk_bf16_f32 v184, v16, v17
  v_cvt_pk_bf16_f32 v185, v18, v19
  v_cvt_pk_bf16_f32 v186, v20, v21
  v_cvt_pk_bf16_f32 v187, v22, v23
  v_pk_mul_f32 v[58:59], v[42:43], v[58:59]
  v_pk_mul_f32 v[60:61], v[44:45], v[60:61]
  v_pk_mul_f32 v[62:63], v[46:47], v[62:63]
  v_mfma_f32_32x32x16_bf16 v[64:79], v[192:195], v[184:187], v[64:79]
  v_cvt_pk_bf16_f32 v188, v24, v25
  v_cvt_pk_bf16_f32 v189, v26, v27
  v_cvt_pk_bf16_f32 v190, v28, v29
  v_cvt_pk_bf16_f32 v191, v30, v31
  v_exp_f32_e64 v48, v48
  v_mfma_f32_32x32x16_bf16 v[80:95], v[196:199], v[184:187], v[80:95]
  v_exp_f32 v49, v49
  v_exp_f32 v50, v50
  v_exp_f32_e64 v51, v51
  v_mfma_f32_32x32x16_bf16 v[96:111], v[200:203], v[184:187], v[96:111]
  v_exp_f32 v52, v52
  v_exp_f32 v53, v53
  v_exp_f32_e64 v54, v54
  v_mfma_f32_32x32x16_bf16 v[64:79], v[204:207], v[188:191], v[64:79]
  v_exp_f32 v55, v55
  v_exp_f32 v56, v56
  v_exp_f32_e64 v57, v57
  v_mfma_f32_32x32x16_bf16 v[80:95], v[208:211], v[188:191], v[80:95]
  v_exp_f32 v58, v58
  v_exp_f32 v59, v59
  v_exp_f32_e64 v60, v60
  v_mfma_f32_32x32x16_bf16 v[96:111], v[212:215], v[188:191], v[96:111]
  v_exp_f32 v61, v61
  v_exp_f32 v62, v62
  v_exp_f32_e64 v63, v63
  v_pk_fma_f32 v[48:49], v[48:49], s[22:23], s[22:23]
  v_pk_fma_f32 v[50:51], v[50:51], s[22:23], s[22:23]
  v_pk_fma_f32 v[52:53], v[52:53], s[22:23], s[22:23]
  v_pk_fma_f32 v[54:55], v[54:55], s[22:23], s[22:23]
  v_pk_fma_f32 v[56:57], v[56:57], s[22:23], s[22:23]
  v_pk_fma_f32 v[58:59], v[58:59], s[22:23], s[22:23]
  v_pk_fma_f32 v[60:61], v[60:61], s[22:23], s[22:23]
  v_pk_fma_f32 v[62:63], v[62:63], s[22:23], s[22:23]
  v_mfma_f32_32x32x16_bf16 v[16:31], a[168:171], v[160:163], 0
  ds_read_b128 v[192:195], v0 offset:43008
  ds_read_b128 v[196:199], v0 offset:44032
  v_rcp_f32 v48, v48
  v_rcp_f32 v49, v49
  v_mfma_f32_32x32x16_bf16 v[16:31], a[172:175], v[164:167], v[16:31]
  ds_read_b128 v[200:203], v0 offset:45056
  ds_read_b128 v[204:207], v0 offset:46080
  v_rcp_f32 v50, v50
  v_rcp_f32 v51, v51
  v_mfma_f32_32x32x16_bf16 v[16:31], a[176:179], v[168:171], v[16:31]
  ds_read_b128 v[208:211], v0 offset:47104
  ds_read_b128 v[212:215], v0 offset:48128
  v_rcp_f32 v52, v52
  v_rcp_f32 v53, v53
  v_mfma_f32_32x32x16_bf16 v[16:31], a[180:183], v[172:175], v[16:31]
  buffer_store_dwordx4 v[128:131], v10, s[8:11], s28 offen offset:128
  v_rcp_f32 v54, v54
  v_rcp_f32 v55, v55
  v_mfma_f32_32x32x16_bf16 v[16:31], a[184:187], v[176:179], v[16:31]
  v_rcp_f32 v56, v56
  v_rcp_f32 v57, v57
  v_rcp_f32_e64 v58, v58
  v_mfma_f32_32x32x16_bf16 v[16:31], a[188:191], v[180:183], v[16:31]
  s_waitcnt lgkmcnt(0)
  v_rcp_f32 v59, v59
  v_rcp_f32 v60, v60
  v_rcp_f32 v61, v61
  v_rcp_f32 v62, v62
  v_rcp_f32 v63, v63
  v_pk_mul_f32 v[32:33], v[32:33], v[48:49]
  v_pk_mul_f32 v[34:35], v[34:35], v[50:51]
  v_pk_mul_f32 v[36:37], v[36:37], v[52:53]
  v_pk_mul_f32 v[38:39], v[38:39], v[54:55]
  v_pk_mul_f32 v[40:41], v[40:41], v[56:57]
  v_pk_mul_f32 v[42:43], v[42:43], v[58:59]
  v_pk_mul_f32 v[44:45], v[44:45], v[60:61]
  v_pk_mul_f32 v[46:47], v[46:47], v[62:63]
  v_pk_fma_f32 v[48:49], v[16:17], v[16:17], s[20:21] neg_lo:[1,0,1] neg_hi:[1,0,1]
  v_pk_fma_f32 v[50:51], v[18:19], v[18:19], s[20:21] neg_lo:[1,0,1] neg_hi:[1,0,1]
  v_pk_fma_f32 v[52:53], v[20:21], v[20:21], s[20:21] neg_lo:[1,0,1] neg_hi:[1,0,1]
  v_pk_fma_f32 v[54:55], v[22:23], v[22:23], s[20:21] neg_lo:[1,0,1] neg_hi:[1,0,1]
  v_pk_fma_f32 v[56:57], v[24:25], v[24:25], s[20:21] neg_lo:[1,0,1] neg_hi:[1,0,1]
  v_pk_fma_f32 v[58:59], v[26:27], v[26:27], s[20:21] neg_lo:[1,0,1] neg_hi:[1,0,1]
  v_pk_fma_f32 v[60:61], v[28:29], v[28:29], s[20:21] neg_lo:[1,0,1] neg_hi:[1,0,1]
  v_pk_fma_f32 v[62:63], v[30:31], v[30:31], s[20:21] neg_lo:[1,0,1] neg_hi:[1,0,1]
  v_pk_mul_f32 v[48:49], v[16:17], v[48:49]
  v_pk_mul_f32 v[50:51], v[18:19], v[50:51]
  v_pk_mul_f32 v[52:53], v[20:21], v[52:53]
  v_pk_mul_f32 v[54:55], v[22:23], v[54:55]
  v_pk_mul_f32 v[56:57], v[24:25], v[56:57]
  v_cvt_pk_bf16_f32 v184, v32, v33
  v_cvt_pk_bf16_f32 v185, v34, v35
  v_cvt_pk_bf16_f32 v186, v36, v37
  v_cvt_pk_bf16_f32 v187, v38, v39
  v_pk_mul_f32 v[58:59], v[26:27], v[58:59]
  v_pk_mul_f32 v[60:61], v[28:29], v[60:61]
  v_pk_mul_f32 v[62:63], v[30:31], v[62:63]
  v_mfma_f32_32x32x16_bf16 v[64:79], v[192:195], v[184:187], v[64:79]
  v_cvt_pk_bf16_f32 v188, v40, v41
  v_cvt_pk_bf16_f32 v189, v42, v43
  v_cvt_pk_bf16_f32 v190, v44, v45
  v_cvt_pk_bf16_f32 v191, v46, v47
  v_exp_f32_e64 v48, v48
  v_mfma_f32_32x32x16_bf16 v[80:95], v[196:199], v[184:187], v[80:95]
  v_exp_f32 v49, v49
  v_exp_f32 v50, v50
  v_exp_f32_e64 v51, v51
  v_mfma_f32_32x32x16_bf16 v[96:111], v[200:203], v[184:187], v[96:111]
  v_exp_f32 v52, v52
  v_exp_f32 v53, v53
  v_exp_f32_e64 v54, v54
  v_mfma_f32_32x32x16_bf16 v[64:79], v[204:207], v[188:191], v[64:79]
  v_exp_f32 v55, v55
  v_exp_f32 v56, v56
  v_exp_f32_e64 v57, v57
  v_mfma_f32_32x32x16_bf16 v[80:95], v[208:211], v[188:191], v[80:95]
  v_exp_f32 v58, v58
  v_exp_f32 v59, v59
  v_exp_f32_e64 v60, v60
  v_mfma_f32_32x32x16_bf16 v[96:111], v[212:215], v[188:191], v[96:111]
  v_exp_f32 v61, v61
  v_exp_f32 v62, v62
  v_exp_f32_e64 v63, v63
  v_pk_fma_f32 v[48:49], v[48:49], s[22:23], s[22:23]
  v_pk_fma_f32 v[50:51], v[50:51], s[22:23], s[22:23]
  v_pk_fma_f32 v[52:53], v[52:53], s[22:23], s[22:23]
  v_pk_fma_f32 v[54:55], v[54:55], s[22:23], s[22:23]
  v_pk_fma_f32 v[56:57], v[56:57], s[22:23], s[22:23]
  v_pk_fma_f32 v[58:59], v[58:59], s[22:23], s[22:23]
  v_pk_fma_f32 v[60:61], v[60:61], s[22:23], s[22:23]
  v_pk_fma_f32 v[62:63], v[62:63], s[22:23], s[22:23]
  v_mfma_f32_32x32x16_bf16 v[32:47], a[192:195], v[160:163], 0
  ds_read_b128 v[192:195], v0 offset:49152
  ds_read_b128 v[196:199], v0 offset:50176
  v_rcp_f32 v48, v48
  v_rcp_f32 v49, v49
  v_mfma_f32_32x32x16_bf16 v[32:47], a[196:199], v[164:167], v[32:47]
  ds_read_b128 v[200:203], v0 offset:51200
  ds_read_b128 v[204:207], v0 offset:52224
  v_rcp_f32 v50, v50
  v_rcp_f32 v51, v51
  v_mfma_f32_32x32x16_bf16 v[32:47], a[200:203], v[168:171], v[32:47]
  ds_read_b128 v[208:211], v0 offset:53248
  ds_read_b128 v[212:215], v0 offset:54272
  v_rcp_f32 v52, v52
  v_rcp_f32 v53, v53
  v_mfma_f32_32x32x16_bf16 v[32:47], a[204:207], v[172:175], v[32:47]
  buffer_store_dwordx4 v[132:135], v10, s[8:11], s28 offen offset:160
  v_rcp_f32 v54, v54
  v_rcp_f32 v55, v55
  v_mfma_f32_32x32x16_bf16 v[32:47], a[208:211], v[176:179], v[32:47]
  v_rcp_f32 v56, v56
  v_rcp_f32 v57, v57
  v_rcp_f32_e64 v58, v58
  v_mfma_f32_32x32x16_bf16 v[32:47], a[212:215], v[180:183], v[32:47]
  s_waitcnt lgkmcnt(0)
  v_rcp_f32 v59, v59
  v_rcp_f32 v60, v60
  v_rcp_f32 v61, v61
  v_rcp_f32 v62, v62
  v_rcp_f32 v63, v63
  v_pk_mul_f32 v[16:17], v[16:17], v[48:49]
  v_pk_mul_f32 v[18:19], v[18:19], v[50:51]
  v_pk_mul_f32 v[20:21], v[20:21], v[52:53]
  v_pk_mul_f32 v[22:23], v[22:23], v[54:55]
  v_pk_mul_f32 v[24:25], v[24:25], v[56:57]
  v_pk_mul_f32 v[26:27], v[26:27], v[58:59]
  v_pk_mul_f32 v[28:29], v[28:29], v[60:61]
  v_pk_mul_f32 v[30:31], v[30:31], v[62:63]
  v_pk_fma_f32 v[48:49], v[32:33], v[32:33], s[20:21] neg_lo:[1,0,1] neg_hi:[1,0,1]
  v_pk_fma_f32 v[50:51], v[34:35], v[34:35], s[20:21] neg_lo:[1,0,1] neg_hi:[1,0,1]
  v_pk_fma_f32 v[52:53], v[36:37], v[36:37], s[20:21] neg_lo:[1,0,1] neg_hi:[1,0,1]
  v_pk_fma_f32 v[54:55], v[38:39], v[38:39], s[20:21] neg_lo:[1,0,1] neg_hi:[1,0,1]
  v_pk_fma_f32 v[56:57], v[40:41], v[40:41], s[20:21] neg_lo:[1,0,1] neg_hi:[1,0,1]
  v_pk_fma_f32 v[58:59], v[42:43], v[42:43], s[20:21] neg_lo:[1,0,1] neg_hi:[1,0,1]
  v_pk_fma_f32 v[60:61], v[44:45], v[44:45], s[20:21] neg_lo:[1,0,1] neg_hi:[1,0,1]
  v_pk_fma_f32 v[62:63], v[46:47], v[46:47], s[20:21] neg_lo:[1,0,1] neg_hi:[1,0,1]
  v_pk_mul_f32 v[48:49], v[32:33], v[48:49]
  v_pk_mul_f32 v[50:51], v[34:35], v[50:51]
  v_pk_mul_f32 v[52:53], v[36:37], v[52:53]
  v_pk_mul_f32 v[54:55], v[38:39], v[54:55]
  v_pk_mul_f32 v[56:57], v[40:41], v[56:57]
  v_cvt_pk_bf16_f32 v184, v16, v17
  v_cvt_pk_bf16_f32 v185, v18, v19
  v_cvt_pk_bf16_f32 v186, v20, v21
  v_cvt_pk_bf16_f32 v187, v22, v23
  v_pk_mul_f32 v[58:59], v[42:43], v[58:59]
  v_pk_mul_f32 v[60:61], v[44:45], v[60:61]
  v_pk_mul_f32 v[62:63], v[46:47], v[62:63]
  v_mfma_f32_32x32x16_bf16 v[64:79], v[192:195], v[184:187], v[64:79]
  v_cvt_pk_bf16_f32 v188, v24, v25
  v_cvt_pk_bf16_f32 v189, v26, v27
  v_cvt_pk_bf16_f32 v190, v28, v29
  v_cvt_pk_bf16_f32 v191, v30, v31
  v_exp_f32_e64 v48, v48
  v_mfma_f32_32x32x16_bf16 v[80:95], v[196:199], v[184:187], v[80:95]
  v_exp_f32 v49, v49
  v_exp_f32 v50, v50
  v_exp_f32_e64 v51, v51
  v_mfma_f32_32x32x16_bf16 v[96:111], v[200:203], v[184:187], v[96:111]
  v_exp_f32 v52, v52
  v_exp_f32 v53, v53
  v_exp_f32_e64 v54, v54
  v_mfma_f32_32x32x16_bf16 v[64:79], v[204:207], v[188:191], v[64:79]
  v_exp_f32 v55, v55
  v_exp_f32 v56, v56
  v_exp_f32_e64 v57, v57
  v_mfma_f32_32x32x16_bf16 v[80:95], v[208:211], v[188:191], v[80:95]
  v_exp_f32 v58, v58
  v_exp_f32 v59, v59
  v_exp_f32_e64 v60, v60
  v_mfma_f32_32x32x16_bf16 v[96:111], v[212:215], v[188:191], v[96:111]
  v_exp_f32 v61, v61
  v_exp_f32 v62, v62
  v_exp_f32_e64 v63, v63
  v_pk_fma_f32 v[48:49], v[48:49], s[22:23], s[22:23]
  v_pk_fma_f32 v[50:51], v[50:51], s[22:23], s[22:23]
  v_pk_fma_f32 v[52:53], v[52:53], s[22:23], s[22:23]
  v_pk_fma_f32 v[54:55], v[54:55], s[22:23], s[22:23]
  v_pk_fma_f32 v[56:57], v[56:57], s[22:23], s[22:23]
  v_pk_fma_f32 v[58:59], v[58:59], s[22:23], s[22:23]
  v_pk_fma_f32 v[60:61], v[60:61], s[22:23], s[22:23]
  v_pk_fma_f32 v[62:63], v[62:63], s[22:23], s[22:23]
  v_mfma_f32_32x32x16_bf16 v[16:31], a[216:219], v[160:163], 0
  ds_read_b128 v[192:195], v0 offset:55296
  ds_read_b128 v[196:199], v0 offset:56320
  v_rcp_f32 v48, v48
  v_rcp_f32 v49, v49
  v_mfma_f32_32x32x16_bf16 v[16:31], a[220:223], v[164:167], v[16:31]
  ds_read_b128 v[200:203], v0 offset:57344
  ds_read_b128 v[204:207], v0 offset:58368
  v_rcp_f32 v50, v50
  v_rcp_f32 v51, v51
  v_mfma_f32_32x32x16_bf16 v[16:31], a[224:227], v[168:171], v[16:31]
  ds_read_b128 v[208:211], v0 offset:59392
  ds_read_b128 v[212:215], v0 offset:60416
  v_rcp_f32 v52, v52
  v_rcp_f32 v53, v53
  v_mfma_f32_32x32x16_bf16 v[16:31], a[228:231], v[172:175], v[16:31]
  v_rcp_f32 v54, v54
  v_rcp_f32 v55, v55
  v_rcp_f32_e64 v56, v56
  v_mfma_f32_32x32x16_bf16 v[16:31], a[232:235], v[176:179], v[16:31]
  v_rcp_f32 v57, v57
  v_rcp_f32 v58, v58
  v_rcp_f32_e64 v59, v59
  v_mfma_f32_32x32x16_bf16 v[16:31], a[236:239], v[180:183], v[16:31]
  s_waitcnt lgkmcnt(0)
  v_rcp_f32 v60, v60
  v_rcp_f32 v61, v61
  v_rcp_f32 v62, v62
  v_rcp_f32_e64 v63, v63
  v_pk_mul_f32 v[32:33], v[32:33], v[48:49]
  v_pk_mul_f32 v[34:35], v[34:35], v[50:51]
  v_pk_mul_f32 v[36:37], v[36:37], v[52:53]
  v_pk_mul_f32 v[38:39], v[38:39], v[54:55]
  v_pk_mul_f32 v[40:41], v[40:41], v[56:57]
  v_pk_mul_f32 v[42:43], v[42:43], v[58:59]
  v_pk_mul_f32 v[44:45], v[44:45], v[60:61]
  v_pk_mul_f32 v[46:47], v[46:47], v[62:63]
  v_pk_fma_f32 v[48:49], v[16:17], v[16:17], s[20:21] neg_lo:[1,0,1] neg_hi:[1,0,1]
  v_pk_fma_f32 v[50:51], v[18:19], v[18:19], s[20:21] neg_lo:[1,0,1] neg_hi:[1,0,1]
  v_pk_fma_f32 v[52:53], v[20:21], v[20:21], s[20:21] neg_lo:[1,0,1] neg_hi:[1,0,1]
  v_pk_fma_f32 v[54:55], v[22:23], v[22:23], s[20:21] neg_lo:[1,0,1] neg_hi:[1,0,1]
  v_pk_fma_f32 v[56:57], v[24:25], v[24:25], s[20:21] neg_lo:[1,0,1] neg_hi:[1,0,1]
  v_pk_fma_f32 v[58:59], v[26:27], v[26:27], s[20:21] neg_lo:[1,0,1] neg_hi:[1,0,1]
  v_pk_fma_f32 v[60:61], v[28:29], v[28:29], s[20:21] neg_lo:[1,0,1] neg_hi:[1,0,1]
  v_pk_fma_f32 v[62:63], v[30:31], v[30:31], s[20:21] neg_lo:[1,0,1] neg_hi:[1,0,1]
  v_pk_mul_f32 v[48:49], v[16:17], v[48:49]
  v_pk_mul_f32 v[50:51], v[18:19], v[50:51]
  v_pk_mul_f32 v[52:53], v[20:21], v[52:53]
  v_pk_mul_f32 v[54:55], v[22:23], v[54:55]
  v_pk_mul_f32 v[56:57], v[24:25], v[56:57]
  v_cvt_pk_bf16_f32 v184, v32, v33
  v_cvt_pk_bf16_f32 v185, v34, v35
  v_cvt_pk_bf16_f32 v186, v36, v37
  v_cvt_pk_bf16_f32 v187, v38, v39
  v_pk_mul_f32 v[58:59], v[26:27], v[58:59]
  v_pk_mul_f32 v[60:61], v[28:29], v[60:61]
  v_pk_mul_f32 v[62:63], v[30:31], v[62:63]
  v_mfma_f32_32x32x16_bf16 v[64:79], v[192:195], v[184:187], v[64:79]
  ds_read_b128 v[216:219], v0 offset:12288
  ds_read_b128 v[220:223], v0 offset:13312
  v_cvt_pk_bf16_f32 v188, v40, v41
  v_cvt_pk_bf16_f32 v189, v42, v43
  v_cvt_pk_bf16_f32 v190, v44, v45
  v_cvt_pk_bf16_f32 v191, v46, v47
  v_mfma_f32_32x32x16_bf16 v[80:95], v[196:199], v[184:187], v[80:95]
  ds_read_b128 v[224:227], v0 offset:14336
  ds_read_b128 v[228:231], v0 offset:15360
  v_exp_f32 v48, v48
  v_exp_f32 v49, v49
  v_mfma_f32_32x32x16_bf16 v[96:111], v[200:203], v[184:187], v[96:111]
  ds_read_b128 v[232:235], v0 offset:16384
  ds_read_b128 v[236:239], v0 offset:17408
  v_exp_f32 v50, v50
  v_exp_f32 v51, v51
  v_mfma_f32_32x32x16_bf16 v[64:79], v[204:207], v[188:191], v[64:79]
  s_mov_b32 s28, s34
  v_exp_f32 v52, v52
  v_exp_f32 v53, v53
  v_exp_f32 v54, v54
  v_mfma_f32_32x32x16_bf16 v[80:95], v[208:211], v[188:191], v[80:95]
  s_add_u32 s34, s34, 0x60000
  v_exp_f32 v55, v55
  v_exp_f32 v56, v56
  v_exp_f32_e64 v57, v57
  v_mfma_f32_32x32x16_bf16 v[96:111], v[212:215], v[188:191], v[96:111]
  s_waitcnt lgkmcnt(0)
  v_exp_f32 v58, v58
  v_exp_f32 v59, v59
  v_exp_f32 v60, v60
  v_exp_f32 v61, v61
  v_exp_f32 v62, v62
  v_exp_f32_e64 v63, v63
  v_pk_fma_f32 v[48:49], v[48:49], s[22:23], s[22:23]
  v_pk_fma_f32 v[50:51], v[50:51], s[22:23], s[22:23]
  v_pk_fma_f32 v[52:53], v[52:53], s[22:23], s[22:23]
  v_pk_fma_f32 v[54:55], v[54:55], s[22:23], s[22:23]
  v_pk_fma_f32 v[56:57], v[56:57], s[22:23], s[22:23]
  v_pk_fma_f32 v[58:59], v[58:59], s[22:23], s[22:23]
  v_pk_fma_f32 v[60:61], v[60:61], s[22:23], s[22:23]
  v_pk_fma_f32 v[62:63], v[62:63], s[22:23], s[22:23]
  v_mfma_f32_32x32x16_bf16 v[32:47], v[216:219], v[160:163], 0
  ds_read_b128 v[192:195], v0 offset:61440
  ds_read_b128 v[196:199], v0 offset:62464
  v_rcp_f32 v48, v48
  v_rcp_f32 v49, v49
  v_mfma_f32_32x32x16_bf16 v[32:47], v[220:223], v[164:167], v[32:47]
  ds_read_b128 v[200:203], v0 offset:63488
  ds_read_b128 v[204:207], v0 offset:64512
  v_rcp_f32 v50, v50
  v_rcp_f32 v51, v51
  v_mfma_f32_32x32x16_bf16 v[32:47], v[224:227], v[168:171], v[32:47]
  ds_read_b128 v[208:211], v1
  ds_read_b128 v[212:215], v1 offset:1024
  v_rcp_f32 v52, v52
  v_rcp_f32 v53, v53
  v_mfma_f32_32x32x16_bf16 v[32:47], v[228:231], v[172:175], v[32:47]
  v_rcp_f32 v54, v54
  v_rcp_f32 v55, v55
  v_rcp_f32_e64 v56, v56
  v_mfma_f32_32x32x16_bf16 v[32:47], v[232:235], v[176:179], v[32:47]
  v_rcp_f32 v57, v57
  v_rcp_f32 v58, v58
  v_rcp_f32_e64 v59, v59
  v_mfma_f32_32x32x16_bf16 v[32:47], v[236:239], v[180:183], v[32:47]
  s_waitcnt lgkmcnt(0)
  v_rcp_f32 v60, v60
  v_rcp_f32 v61, v61
  v_rcp_f32 v62, v62
  v_rcp_f32_e64 v63, v63
  v_pk_mul_f32 v[16:17], v[16:17], v[48:49]
  v_pk_mul_f32 v[18:19], v[18:19], v[50:51]
  v_pk_mul_f32 v[20:21], v[20:21], v[52:53]
  v_pk_mul_f32 v[22:23], v[22:23], v[54:55]
  v_pk_mul_f32 v[24:25], v[24:25], v[56:57]
  v_pk_mul_f32 v[26:27], v[26:27], v[58:59]
  v_pk_mul_f32 v[28:29], v[28:29], v[60:61]
  v_pk_mul_f32 v[30:31], v[30:31], v[62:63]
  v_pk_fma_f32 v[48:49], v[32:33], v[32:33], s[20:21] neg_lo:[1,0,1] neg_hi:[1,0,1]
  v_pk_fma_f32 v[50:51], v[34:35], v[34:35], s[20:21] neg_lo:[1,0,1] neg_hi:[1,0,1]
  v_pk_fma_f32 v[52:53], v[36:37], v[36:37], s[20:21] neg_lo:[1,0,1] neg_hi:[1,0,1]
  v_pk_fma_f32 v[54:55], v[38:39], v[38:39], s[20:21] neg_lo:[1,0,1] neg_hi:[1,0,1]
  v_pk_fma_f32 v[56:57], v[40:41], v[40:41], s[20:21] neg_lo:[1,0,1] neg_hi:[1,0,1]
  v_pk_fma_f32 v[58:59], v[42:43], v[42:43], s[20:21] neg_lo:[1,0,1] neg_hi:[1,0,1]
  v_pk_fma_f32 v[60:61], v[44:45], v[44:45], s[20:21] neg_lo:[1,0,1] neg_hi:[1,0,1]
  v_pk_fma_f32 v[62:63], v[46:47], v[46:47], s[20:21] neg_lo:[1,0,1] neg_hi:[1,0,1]
  v_pk_mul_f32 v[48:49], v[32:33], v[48:49]
  v_pk_mul_f32 v[50:51], v[34:35], v[50:51]
  v_pk_mul_f32 v[52:53], v[36:37], v[52:53]
  v_pk_mul_f32 v[54:55], v[38:39], v[54:55]
  v_pk_mul_f32 v[56:57], v[40:41], v[56:57]
  v_cvt_pk_bf16_f32 v184, v16, v17
  v_cvt_pk_bf16_f32 v185, v18, v19
  v_cvt_pk_bf16_f32 v186, v20, v21
  v_cvt_pk_bf16_f32 v187, v22, v23
  v_pk_mul_f32 v[58:59], v[42:43], v[58:59]
  v_pk_mul_f32 v[60:61], v[44:45], v[60:61]
  v_pk_mul_f32 v[62:63], v[46:47], v[62:63]
  v_mfma_f32_32x32x16_bf16 v[64:79], v[192:195], v[184:187], v[64:79]
  v_cvt_pk_bf16_f32 v188, v24, v25
  v_cvt_pk_bf16_f32 v189, v26, v27
  v_cvt_pk_bf16_f32 v190, v28, v29
  v_cvt_pk_bf16_f32 v191, v30, v31
  v_exp_f32_e64 v48, v48
  v_mfma_f32_32x32x16_bf16 v[80:95], v[196:199], v[184:187], v[80:95]
  v_exp_f32 v49, v49
  v_exp_f32 v50, v50
  v_exp_f32_e64 v51, v51
  v_mfma_f32_32x32x16_bf16 v[96:111], v[200:203], v[184:187], v[96:111]
  v_exp_f32 v52, v52
  v_exp_f32 v53, v53
  v_exp_f32_e64 v54, v54
  v_mfma_f32_32x32x16_bf16 v[64:79], v[204:207], v[188:191], v[64:79]
  v_exp_f32 v55, v55
  v_exp_f32 v56, v56
  v_exp_f32_e64 v57, v57
  v_mfma_f32_32x32x16_bf16 v[80:95], v[208:211], v[188:191], v[80:95]
  v_exp_f32 v58, v58
  v_exp_f32 v59, v59
  v_exp_f32_e64 v60, v60
  v_mfma_f32_32x32x16_bf16 v[96:111], v[212:215], v[188:191], v[96:111]
  v_exp_f32 v61, v61
  v_exp_f32 v62, v62
  v_exp_f32_e64 v63, v63
  v_pk_fma_f32 v[48:49], v[48:49], s[22:23], s[22:23]
  v_pk_fma_f32 v[50:51], v[50:51], s[22:23], s[22:23]
  v_pk_fma_f32 v[52:53], v[52:53], s[22:23], s[22:23]
  v_pk_fma_f32 v[54:55], v[54:55], s[22:23], s[22:23]
  v_pk_fma_f32 v[56:57], v[56:57], s[22:23], s[22:23]
  v_pk_fma_f32 v[58:59], v[58:59], s[22:23], s[22:23]
  v_pk_fma_f32 v[60:61], v[60:61], s[22:23], s[22:23]
  v_pk_fma_f32 v[62:63], v[62:63], s[22:23], s[22:23]
  ds_read_b128 v[192:195], v1 offset:2048
  ds_read_b128 v[196:199], v1 offset:3072
  ds_read_b128 v[200:203], v1 offset:4096
  ds_read_b128 v[204:207], v1 offset:5120
  ds_read_b128 v[208:211], v1 offset:6144
  ds_read_b128 v[212:215], v1 offset:7168
  v_rcp_f32 v48, v48
  v_rcp_f32 v49, v49
  v_rcp_f32 v50, v50
  v_rcp_f32 v51, v51
  v_rcp_f32 v52, v52
  v_rcp_f32 v53, v53
  v_rcp_f32 v54, v54
  v_rcp_f32 v55, v55
  v_rcp_f32 v56, v56
  v_rcp_f32 v57, v57
  v_rcp_f32 v58, v58
  v_rcp_f32 v59, v59
  v_rcp_f32 v60, v60
  v_rcp_f32 v61, v61
  v_rcp_f32 v62, v62
  v_rcp_f32 v63, v63
  v_pk_mul_f32 v[32:33], v[32:33], v[48:49]
  v_pk_mul_f32 v[34:35], v[34:35], v[50:51]
  v_pk_mul_f32 v[36:37], v[36:37], v[52:53]
  v_pk_mul_f32 v[38:39], v[38:39], v[54:55]
  v_pk_mul_f32 v[40:41], v[40:41], v[56:57]
  v_pk_mul_f32 v[42:43], v[42:43], v[58:59]
  v_pk_mul_f32 v[44:45], v[44:45], v[60:61]
  v_pk_mul_f32 v[46:47], v[46:47], v[62:63]
  v_cvt_pk_bf16_f32 v184, v32, v33
  v_cvt_pk_bf16_f32 v185, v34, v35
  v_cvt_pk_bf16_f32 v186, v36, v37
  v_cvt_pk_bf16_f32 v187, v38, v39
  v_cvt_pk_bf16_f32 v188, v40, v41
  v_cvt_pk_bf16_f32 v189, v42, v43
  v_cvt_pk_bf16_f32 v190, v44, v45
  v_cvt_pk_bf16_f32 v191, v46, v47
  s_waitcnt lgkmcnt(5)
  v_mfma_f32_32x32x16_bf16 v[64:79], v[192:195], v[184:187], v[64:79]
  s_waitcnt lgkmcnt(2)
  v_mfma_f32_32x32x16_bf16 v[64:79], v[204:207], v[188:191], v[64:79]
  v_mfma_f32_32x32x16_bf16 v[80:95], v[196:199], v[184:187], v[80:95]
  s_nop 0
  s_waitcnt lgkmcnt(1)
  v_mfma_f32_32x32x16_bf16 v[80:95], v[208:211], v[188:191], v[80:95]
  v_mfma_f32_32x32x16_bf16 v[96:111], v[200:203], v[184:187], v[96:111]
  s_waitcnt lgkmcnt(0)
  v_mfma_f32_32x32x16_bf16 v[96:111], v[212:215], v[188:191], v[96:111]
  s_nop 5
  v_cvt_pk_bf16_f32 v112, v64, v65
  v_cvt_pk_bf16_f32 v113, v66, v67
  v_cvt_pk_bf16_f32 v114, v68, v69
  v_cvt_pk_bf16_f32 v115, v70, v71
  buffer_store_dwordx4 v[112:115], v10, s[8:11], s28 offen
  v_cvt_pk_bf16_f32 v116, v72, v73
  v_cvt_pk_bf16_f32 v117, v74, v75
  v_cvt_pk_bf16_f32 v118, v76, v77
  v_cvt_pk_bf16_f32 v119, v78, v79
  buffer_store_dwordx4 v[116:119], v10, s[8:11], s28 offen offset:32
  v_cvt_pk_bf16_f32 v120, v80, v81
  v_cvt_pk_bf16_f32 v121, v82, v83
  v_cvt_pk_bf16_f32 v122, v84, v85
  v_cvt_pk_bf16_f32 v123, v86, v87
  buffer_store_dwordx4 v[120:123], v10, s[8:11], s28 offen offset:64
  v_cvt_pk_bf16_f32 v124, v88, v89
  v_cvt_pk_bf16_f32 v125, v90, v91
  v_cvt_pk_bf16_f32 v126, v92, v93
  v_cvt_pk_bf16_f32 v127, v94, v95
  buffer_store_dwordx4 v[124:127], v10, s[8:11], s28 offen offset:96
  v_cvt_pk_bf16_f32 v128, v96, v97
  v_cvt_pk_bf16_f32 v129, v98, v99
  v_cvt_pk_bf16_f32 v130, v100, v101
  v_cvt_pk_bf16_f32 v131, v102, v103
  buffer_store_dwordx4 v[128:131], v10, s[8:11], s28 offen offset:128
  v_cvt_pk_bf16_f32 v132, v104, v105
  v_cvt_pk_bf16_f32 v133, v106, v107
  v_cvt_pk_bf16_f32 v134, v108, v109
  v_cvt_pk_bf16_f32 v135, v110, v111
  buffer_store_dwordx4 v[132:135], v10, s[8:11], s28 offen offset:160
S_end:
  s_endpgm
.section .rodata,"a"
.p2align 6
.amdhsa_kernel standalone__modern_conv_block_convnext__vision_kernel
  .amdhsa_next_free_vgpr 512
  .amdhsa_next_free_sgpr 102
  .amdhsa_accum_offset 256
  .amdhsa_group_segment_fixed_size 0
  .amdhsa_kernarg_size 80
  .amdhsa_user_sgpr_count 2
  .amdhsa_user_sgpr_kernarg_segment_ptr 1
  .amdhsa_system_sgpr_workgroup_id_x 1
.end_amdhsa_kernel
```

```asm
; @launch grid=(256,1,1) block=(256,1,1) lds=163840
.amdgcn_target "amdgcn-amd-amdhsa--gfx950"
.text
.globl standalone__modern_conv_block_convnext__vision_kernel
.p2align 8
.type standalone__modern_conv_block_convnext__vision_kernel,@function
standalone__modern_conv_block_convnext__vision_kernel:
  s_cmp_ge_u32 s2, 0x100
  s_nop 0
  s_cbranch_scc1 L_end
  s_load_dwordx2 s[4:5], s[0:1], 0
  s_load_dwordx2 s[60:61], s[0:1], 8
  s_load_dwordx2 s[64:65], s[0:1], 16
  s_load_dwordx2 s[68:69], s[0:1], 24
  s_load_dwordx2 s[72:73], s[0:1], 32
  s_load_dwordx2 s[76:77], s[0:1], 40
  s_load_dwordx2 s[80:81], s[0:1], 48
  s_load_dwordx2 s[8:9], s[0:1], 56
  s_getpc_b64 s[40:41]
L_pc:
  s_lshl_b32 s32, s2, 9
  s_and_b32 s32, s32, 0xf000
  v_lshl_add_u32 v249, v0, 4, s32
  v_lshrrev_b32_e64 v112, 6, v0
  v_min_u32 v249, L_end-L_pc-12, v249
  v_and_b32 v113, 63, v0
  global_load_dwordx4 v[108:111], v249, s[40:41]
  v_readfirstlane_b32 s27, v112
  s_mov_b32 s62, 0x6c0
  s_mov_b32 s63, 0x20000
  s_mov_b32 s82, 0xc0
  s_mov_b32 s83, 0x20000
  s_mov_b32 s78, 0xc0
  s_mov_b32 s79, 0x20000
  s_mov_b32 s66, 0x12000
  s_mov_b32 s67, 0x20000
  s_mov_b32 s74, 0x12000
  s_mov_b32 s75, 0x20000
  v_bfe_u32 v114, v113, 3, 1
  v_bfe_u32 v115, v113, 4, 1
  v_bfe_u32 v116, v113, 2, 1
  v_and_b32 v117, 3, v113
  v_lshlrev_b32 v118, 4, v113
  s_min_u32 s44, s27, 2
  s_lshl_b32 s45, s44, 6
  s_mul_i32 s46, s44, 0x240
  v_lshlrev_b32 v119, 1, v113
  v_and_b32 v120, 31, v113
  v_lshlrev_b32 v121, 1, v120
  v_lshlrev_b32 v122, 4, v115
  v_lshl_add_u32 v122, v116, 3, v122
  v_lshl_add_u32 v122, v114, 2, v122
  v_add_u32 v122, v122, v117
  v_lshlrev_b32 v123, 1, v122
  s_lshr_b32 s35, s2, 3
  s_lshl_b32 s35, s35, 2
  s_add_u32 s35, s35, s27
  s_sub_u32 s55, s35, 0x48
  s_min_u32 s35, s35, s55
  s_lshl_b32 s47, s35, 10
  s_and_b32 s54, s2, 6
  s_lshl_b32 s54, s54, 1
  s_lshr_b32 s32, s2, 6
  s_add_u32 s54, s54, s32
  s_mul_i32 s59, s54, 0x300000
  s_and_b32 s53, s2, 1
  s_lshl_b32 s53, s53, 8
  s_and_b32 s32, s2, 56
  s_lshl_b32 s32, s32, 2
  s_add_u32 s53, s53, s32
  s_lshl_b32 s32, s27, 3
  s_add_u32 s53, s53, s32
  s_mul_i32 s3, s53, 0xc0
  s_add_u32 s3, s3, 0xf40
  s_mov_b32 s6, 0x3000000
  s_mov_b32 s7, 0x20000
  s_cmp_eq_u32 s53, 0
  s_cselect_b32 s35, 12, 0
  s_sub_u32 s55, 0x78, s35
  s_cmp_eq_u32 s53, 0x1f8
  s_cselect_b32 s55, 0x6c, s55
  s_mul_i32 s15, s27, 0x1040
  s_add_u32 s48, s59, 0x17000
  s_add_u32 s49, s59, 0x47000
  s_waitcnt lgkmcnt(0)
  v_add_u32 v124, 64, v113
  buffer_load_dwordx4 v[108:111], v118, s[64:67], s47 offen
  v_subrev_u32 v127, 57, v113
  v_cmp_le_u32 vcc, 57, v113
  buffer_load_dwordx4 v[108:111], v118, s[72:75], s47 offen
  v_add_u32_e64 v125, 7, v113
  v_add_u32 v126, 0x47, v113
  buffer_load_ushort v129, v119, s[60:63], s46 offen
  v_mov_b32 v199, 0x17c00
  v_cndmask_b32_e64 v124, v124, v127, vcc
  buffer_load_ushort v130, v119, s[60:63], s46 offen offset:128
  v_mov_b32 v127, 0xfffffc00
  v_cndmask_b32 v199, v127, v199, vcc
  v_add_u32 v198, s3, v118
  buffer_load_ushort v131, v119, s[60:63], s46 offen offset:256
  v_lshl_add_u32 v199, v124, 4, v199
  v_add_u32_e64 v199, s3, v199
  buffer_load_ushort v132, v119, s[60:63], s46 offen offset:384
  v_add_u32 v200, 0x17870, v198
  v_add_u32 v201, 0x17870, v198
  buffer_load_ushort v133, v121, s[60:63], s46 offen offset:512
  v_mov_b32 v128, 0x80000000
  v_subrev_u32_e64 v6, s35, v113
  buffer_load_ushort v137, v123, s[80:83], s45 offen
  v_cmp_gt_u32 s[36:37], s55, v6
  v_subrev_u32_e64 v7, s35, v124
  v_cmp_gt_u32 s[38:39], s55, v7
  buffer_load_ushort v138, v123, s[76:79], s45 offen
  v_subrev_u32_e64 v8, s35, v125
  v_cmp_gt_u32 s[40:41], s55, v8
  buffer_load_ushort v134, v123, s[80:83], 0 offen
  v_subrev_u32_e64 v9, s35, v126
  v_cmp_gt_u32 s[42:43], s55, v9
  buffer_load_ushort v135, v123, s[80:83], 0 offen offset:64
  v_cndmask_b32 v6, v128, v198, s[36:37]
  v_cndmask_b32 v7, v128, v199, s[38:39]
  buffer_load_ushort v136, v123, s[80:83], 0 offen offset:128
  v_cndmask_b32 v8, v128, v200, s[40:41]
  v_cndmask_b32 v9, v128, v201, s[42:43]
  s_add_u32 m0, s15, 0x4120
  s_nop 0
  s_nop 0
  buffer_load_dwordx4 v6, s[4:7], s48 offen lds
  buffer_load_dwordx4 v7, s[4:7], s48 offen offset:1024 lds
  buffer_load_dwordx4 v8, s[4:7], s48 offen offset:2048 lds
  buffer_load_dwordx4 v9, s[4:7], s48 offen offset:3072 lds
  s_sub_u32 s56, s59, 0x19000
  v_add_u32_e64 v198, s56, v6
  s_add_u32 s56, s56, 0x400
  v_add_u32_e64 v199, s56, v7
  s_add_u32 s56, s56, 0x400
  v_add_u32_e64 v200, s56, v8
  s_add_u32 s56, s56, 0x400
  v_add_u32 v201, s56, v9
  v_lshrrev_b32 v139, 5, v113
  v_lshlrev_b32_e64 v202, 4, v117
  v_lshl_add_u32 v202, v139, 6, v202
  v_bfe_u32 v124, v113, 3, 2
  v_lshl_add_u32 v124, v116, 2, v124
  v_cmp_eq_u32_e64 vcc, 7, v124
  v_mul_u32_u24 v203, 0x300, v124
  v_add_u32 v203, v203, v202
  v_cndmask_b32 v204, v128, v202, vcc
  s_mov_b32 s70, 0x300
  s_mov_b32 s71, 0x20000
  s_mov_b32 s10, 0x3000000
  s_mov_b32 s11, 0x20000
  s_and_b32 s36, s27, 2
  s_add_u32 s37, s27, 1
  s_lshr_b32 s37, s37, 1
  s_and_b32 s38, s37, 1
  s_cmp_eq_u32 s27, 1
  s_cselect_b32 s39, 0, 3
  s_cselect_b32 s51, 0x1000, 0
  s_lshl_b32 s32, s36, 8
  s_lshl_b32 s33, s37, 8
  s_add_u32 s43, s32, 0x11d00
  s_add_u32 s50, s33, 0x11d00
  s_add_u32 s51, s51, s33
  s_mul_i32 s40, s38, 0x6000
  s_add_u32 s40, s40, s32
  s_mul_i32 s41, s38, 0x1800
  s_add_u32 s41, s41, s32
  s_add_u32 s41, s41, 0x3000
  s_mul_i32 s42, s39, 0x3000
  s_add_u32 s42, s42, s33
  s_mul_i32 s32, s36, 0x6000
  s_lshl_b32 s33, s38, 11
  s_add_u32 s33, s33, s32
  s_add_u32 s33, s33, 0x10000
  v_add_u32_e64 v195, s33, v118
  s_lshl_b32 s33, s38, 3
  s_add_u32 s33, s33, s32
  s_add_u32 s33, s33, 0x10400
  v_add_u32_e64 v196, s33, v118
  s_mul_i32 s32, s37, 0x6000
  s_lshl_b32 s33, s39, 10
  s_add_u32 s33, s33, s32
  s_add_u32 s33, s33, 0x10000
  v_add_u32 v197, s33, v118
  v_add_u32 v125, 16, v113
  v_lshrrev_b32_e64 v125, 6, v125
  buffer_load_dwordx4 a[72:75], v202, s[64:67], s43 offen
  v_lshlrev_b32 v125, 4, v125
  v_xor_b32 v254, v125, v118
  v_lshl_add_u32 v125, v139, 4, 16
  v_xor_b32_e64 v255, v125, v118
  v_mul_u32_u24 v125, 0x1200, v139
  v_add_u32_e64 v255, v125, v255
  v_add_u32 v125, 0xb0, v113
  v_lshrrev_b32 v125, 6, v125
  v_lshlrev_b32 v125, 4, v125
  v_xor_b32_e64 v194, v125, v118
  v_add_u32 v194, 0x1200, v194
  s_mul_i32 s14, s27, 0x1800
  s_add_u32 s32, s27, 3
  s_and_b32 s32, s32, 3
  s_mul_i32 s32, s32, 0x600
  s_cmp_eq_u32 s27, 0
  s_cselect_b32 s57, 0, 3
  s_cselect_b32 s53, 3, 6
  s_cselect_b32 s55, 6, 0
  s_lshl_b32 s57, s57, 13
  s_add_u32 s57, s57, s32
  s_add_u32 s58, s57, 0x3000
  s_lshl_b32 s53, s53, 13
  s_add_u32 s53, s53, s32
  s_add_u32 s54, s53, 0x3000
  s_lshl_b32 s55, s55, 13
  s_add_u32 s55, s55, s32
  s_add_u32 s56, s55, 0x3000
  v_and_b32_e64 v145, 7, v113
  buffer_load_dwordx4 a[76:79], v202, s[64:67], s43 offen offset:128
  v_lshrrev_b32 v146, 4, v113
  v_lshlrev_b32 v147, 4, v139
  v_and_b32 v141, 1, v113
  v_lshlrev_b32 v141, 4, v141
  v_mov_b32 v127, 0xffff
  v_lshlrev_b32_e64 v127, v141, v127
  buffer_load_dwordx4 a[80:83], v202, s[64:67], s50 offen
  v_bfe_u32 v125, v113, 1, 2
  v_lshlrev_b32 v125, v125, 1
  v_bfe_i32 v56, v125, 0, 1
  v_mov_b32 v60, 0
  v_and_b32 v56, v56, v127
  v_bfe_i32 v57, v125, 1, 1
  v_mov_b32 v61, 0
  v_and_b32 v57, v57, v127
  v_bfe_i32 v58, v125, 2, 1
  v_mov_b32 v62, 0
  v_and_b32 v58, v58, v127
  v_bfe_i32 v59, v125, 3, 1
  v_mov_b32 v63, 0
  v_and_b32 v59, v59, v127
  v_min_u32_e64 v125, 35, v113
  v_mul_u32_u24 v125, 0x190, v125
  ds_write_b128 v125, v[60:63] offset:50304
  s_lshl_b32 s32, s44, 7
  v_lshrrev_b32 v142, 3, v113
  buffer_load_dwordx4 a[84:87], v202, s[64:67], s50 offen offset:128
  v_mul_u32_u24 v142, 0x190, v142
  v_lshl_add_u32 v142, v145, 4, v142
  v_add_u32 v142, s32, v142
  v_lshrrev_b32 v143, 3, v120
  v_mul_u32_u24 v143, 0x190, v143
  v_lshl_add_u32 v143, v145, 4, v143
  v_add_u32_e64 v143, s32, v143
  v_lshl_add_u32 v144, v120, 2, s32
  v_sub_u32_e64 v125, v146, v116
  v_lshl_add_u32 v126, v114, 2, v117
  v_lshl_add_u32 v126, v125, 3, v126
  v_min_u32 v126, 24, v126
  v_lshlrev_b32 v126, 4, v126
  v_add_u32 v3, 0xc300, v126
  v_lshlrev_b32_e64 v148, 2, v115
  v_lshl_add_u32 v148, v114, 1, v148
  buffer_load_dwordx4 a[88:91], v204, s[68:71], s51 offen
  v_bfe_u32 v126, v113, 1, 1
  v_add_u32 v148, v148, v126
  v_xor_b32 v126, v116, v139
  v_lshl_add_u32 v148, v126, 3, v148
  v_lshlrev_b32 v148, v148, 1
  v_mov_b32 v126, 0x3f80
  v_lshlrev_b32_e64 v126, v141, v126
  v_mov_b32 v125, 0xbf80
  v_lshlrev_b32_e64 v125, v141, v125
  v_bfe_i32 v160, v148, 0, 1
  v_and_b32 v240, v160, v126
  v_and_b32 v184, v160, v125
  v_bfe_i32 v161, v148, 1, 1
  v_and_b32 v241, v161, v126
  v_and_b32 v185, v161, v125
  v_bfe_i32 v162, v148, 2, 1
  v_and_b32 v242, v162, v126
  v_and_b32 v186, v162, v125
  buffer_load_dwordx4 a[92:95], v204, s[68:71], s51 offen offset:128
  v_bfe_i32 v163, v148, 3, 1
  v_and_b32 v243, v163, v126
  v_and_b32 v187, v163, v125
  v_bfe_i32 v164, v148, 4, 1
  v_and_b32 v244, v164, v126
  v_and_b32 v188, v164, v125
  v_bfe_i32 v165, v148, 5, 1
  v_and_b32 v245, v165, v126
  v_and_b32 v189, v165, v125
  v_bfe_i32 v166, v148, 6, 1
  v_and_b32 v246, v166, v126
  v_and_b32 v190, v166, v125
  v_bfe_i32 v167, v148, 7, 1
  v_and_b32 v247, v167, v126
  v_and_b32 v191, v167, v125
  s_mov_b32 s22, 0x3e800000
  s_mov_b32 s24, 0x3c2aaaab
  s_mov_b32 s25, 0x3727c5ac
  s_mov_b32 s20, 0xb010bb47
  s_mov_b32 s21, 0x395c3a9f
  s_mov_b32 s12, 0
  s_mov_b32 s13, -1
  s_add_u32 s29, s59, 0x77000
  s_add_u32 s52, s59, 0xa7000
  v_mul_u32_u24 v149, 0xc0, v145
  buffer_load_dwordx4 a[0:3], v203, s[64:67], s40 offen
  v_add_u32_e64 v127, s15, v149
  v_lshl_add_u32 v150, v114, 1, v146
  v_lshrrev_b32_e64 v125, 1, v150
  v_mul_u32_u24 v140, 0x4100, v125
  v_and_b32_e64 v125, 1, v125
  v_lshl_add_u32 v140, v125, 5, v140
  v_and_b32_e64 v125, 1, v150
  v_mul_u32_u24 v125, 0x790, v125
  v_add3_u32 v4, v140, v125, v127
  v_lshl_add_u32 v151, v114, 1, v115
  buffer_load_dwordx4 a[4:7], v203, s[64:67], s40 offen offset:128
  s_add_u32 s40, s40, 0x1800
  v_add_u32_e64 v150, 1, v151
  v_add_u32 v127, 0xc0, v127
  v_add_u32 v127, v127, v147
  v_lshrrev_b32 v125, 1, v150
  v_mul_u32_u24 v140, 0x4100, v125
  v_and_b32_e64 v125, 1, v125
  v_lshl_add_u32 v140, v125, 5, v140
  v_and_b32_e64 v125, 1, v150
  v_mul_u32_u24 v125, 0x790, v125
  v_add3_u32 v5, v140, v125, v127
  v_mul_u32_u24 v125, 0x18000, v151
  v_add3_u32 v10, v125, v147, v149
  s_sub_u32 s32, s3, 0xf40
  v_add_u32_e64 v10, s32, v10
  v_add_u32 v2, 0xfb40, v147
  v_add_u32 v0, 0x10000, v118
  v_add_u32 v1, 0x20000, v118
  v_and_b32_e64 v125, 15, v113
  buffer_load_dwordx4 a[8:11], v203, s[64:67], s40 offen
  v_lshlrev_b32 v125, 7, v125
  v_mul_u32_u24 v126, 0x18000, v146
  s_sub_u32 s32, s3, 64
  v_add3_u32 v248, v125, v126, s32
  v_mov_b32 v250, 0x3e800000
  s_add_u32 s32, s14, 0x16000
  v_add_u32_e64 v253, s32, v118
  v_bfe_u32 v125, v122, 2, 2
  v_xor_b32_e64 v125, v125, v139
  v_lshl_add_u32 v125, v125, 4, s32
  v_mul_u32_u24 v126, 0xc0, v122
  v_add_u32 v251, v125, v126
  v_xor_b32 v252, 32, v251
  s_add_u32 s30, s15, 32
  s_add_u32 s31, s15, 0x4100
  s_mov_b32 s34, s59
  s_mov_b32 s28, 0x80000000
  s_add_u32 s33, s15, 0x8200
  buffer_load_dwordx4 a[12:15], v203, s[64:67], s40 offen offset:128
  buffer_load_dwordx4 a[16:19], v203, s[64:67], s41 offen
  buffer_load_dwordx4 a[20:23], v203, s[64:67], s41 offen offset:128
  s_waitcnt vmcnt(25)
  v_lshl_or_b32 v129, v129, 16, v129
  v_and_b32 v16, v56, v129
  v_and_b32 v17, v57, v129
  v_and_b32 v18, v58, v129
  v_and_b32 v19, v59, v129
  ds_write_b128 v142, v[16:19] offset:49920
  s_waitcnt vmcnt(24)
  v_lshl_or_b32 v130, v130, 16, v130
  v_and_b32 v20, v56, v130
  v_and_b32 v21, v57, v130
  v_and_b32 v22, v58, v130
  v_and_b32 v23, v59, v130
  ds_write_b128 v142, v[20:23] offset:53120
  s_waitcnt vmcnt(23)
  v_lshl_or_b32 v131, v131, 16, v131
  v_and_b32 v24, v56, v131
  v_and_b32 v25, v57, v131
  v_and_b32 v26, v58, v131
  v_and_b32 v27, v59, v131
  ds_write_b128 v142, v[24:27] offset:56320
  s_waitcnt vmcnt(22)
  v_lshl_or_b32 v132, v132, 16, v132
  v_and_b32 v28, v56, v132
  v_and_b32 v29, v57, v132
  v_and_b32 v30, v58, v132
  v_and_b32 v31, v59, v132
  ds_write_b128 v142, v[28:31] offset:59520
  s_waitcnt vmcnt(21)
  v_lshl_or_b32 v133, v133, 16, v133
  v_and_b32 v16, v56, v133
  v_and_b32 v17, v57, v133
  v_and_b32 v18, v58, v133
  v_and_b32_e64 v19, v59, v133
  ds_write_b128 v143, v[16:19] offset:62720
  s_waitcnt vmcnt(20)
  v_lshlrev_b32 v137, 16, v137
  s_waitcnt vmcnt(19)
  v_lshlrev_b32 v138, 16, v138
  v_mul_f32 v138, v137, v138
  s_waitcnt vmcnt(18)
  v_lshlrev_b32 v134, 16, v134
  s_waitcnt vmcnt(17)
  v_lshlrev_b32 v135, 16, v135
  s_waitcnt vmcnt(16)
  v_lshlrev_b32 v136, 16, v136
  v_xor_b32 v141, 16, v141
  v_mul_f32 v134, 4.0, v134
  v_mul_f32 v135, 4.0, v135
  v_mul_f32 v136, 4.0, v136
  v_lshrrev_b32 v134, v141, v134
  v_lshrrev_b32 v135, v141, v135
  v_lshrrev_b32 v136, v141, v136
  ds_write_b32 v144, v138 offset:64320
  s_waitcnt lgkmcnt(0)
  s_barrier
  ds_read_b128 a[96:99], v3
  ds_read_b128 a[100:103], v3 offset:4800
  ds_read_b128 a[104:107], v3 offset:9600
  ds_read_b128 a[108:111], v3 offset:400
  ds_read_b128 a[112:115], v3 offset:5200
  ds_read_b128 a[116:119], v3 offset:10000
  v_and_b32 v125, v160, v134
  v_and_b32 v126, v161, v134
  v_and_b32_e64 v127, v162, v134
  buffer_load_dwordx4 a[24:27], v203, s[64:67], s42 offen
  v_and_b32_e64 v140, v163, v134
  v_accvgpr_write_b32 a192, v125
  v_accvgpr_write_b32 a193, v126
  v_accvgpr_write_b32 a194, v127
  v_accvgpr_write_b32 a195, v140
  ds_read_b128 a[120:123], v3 offset:800
  ds_read_b128 a[124:127], v3 offset:5600
  ds_read_b128 a[128:131], v3 offset:10400
  ds_read_b128 a[132:135], v3 offset:1200
  ds_read_b128 a[136:139], v3 offset:6000
  ds_read_b128 a[140:143], v3 offset:10800
  buffer_load_dwordx4 a[28:31], v203, s[64:67], s42 offen offset:128
  s_add_u32 s42, s42, 0x1800
  v_and_b32 v125, v164, v134
  v_and_b32 v126, v165, v134
  v_and_b32 v127, v166, v134
  v_and_b32 v140, v167, v134
  v_accvgpr_write_b32 a196, v125
  v_accvgpr_write_b32 a197, v126
  v_accvgpr_write_b32 a198, v127
  v_accvgpr_write_b32 a199, v140
  ds_read_b128 a[144:147], v3 offset:1600
  ds_read_b128 a[148:151], v3 offset:6400
  buffer_load_dwordx4 a[32:35], v203, s[64:67], s42 offen
  ds_read_b128 a[152:155], v3 offset:11200
  ds_read_b128 a[156:159], v3 offset:2000
  ds_read_b128 a[160:163], v3 offset:6800
  ds_read_b128 a[164:167], v3 offset:11600
  v_and_b32 v125, v160, v135
  v_and_b32 v126, v161, v135
  v_and_b32 v127, v162, v135
  v_and_b32 v140, v163, v135
  v_accvgpr_write_b32 a200, v125
  v_accvgpr_write_b32 a201, v126
  v_accvgpr_write_b32 a202, v127
  buffer_load_dwordx4 a[36:39], v203, s[64:67], s42 offen offset:128
  s_add_u32 s42, s42, 0x1800
  v_accvgpr_write_b32 a203, v140
  ds_read_b128 a[240:243], v3 offset:2400
  ds_read_b128 a[244:247], v3 offset:7200
  ds_read_b128 a[248:251], v3 offset:12000
  ds_read_b128 a[168:171], v3 offset:2800
  ds_read_b128 a[172:175], v3 offset:7600
  ds_read_b128 a[176:179], v3 offset:12400
  v_and_b32 v125, v164, v135
  v_and_b32 v126, v165, v135
  v_and_b32 v127, v166, v135
  v_and_b32 v140, v167, v135
  buffer_load_dwordx4 a[40:43], v203, s[64:67], s42 offen
  v_accvgpr_write_b32 a204, v125
  v_accvgpr_write_b32 a205, v126
  v_accvgpr_write_b32 a206, v127
  v_accvgpr_write_b32 a207, v140
  ds_read_b128 a[252:255], v3 offset:3200
  ds_read_b128 a[180:183], v3 offset:8000
  ds_read_b128 a[184:187], v3 offset:12800
  ds_read_b128 a[188:191], v3 offset:3600
  ds_read_b128 a[216:219], v3 offset:8400
  ds_read_b128 a[220:223], v3 offset:13200
  buffer_load_dwordx4 a[44:47], v203, s[64:67], s42 offen offset:128
  s_add_u32 s42, s42, 0x1800
  v_and_b32 v125, v160, v136
  v_and_b32 v126, v161, v136
  v_and_b32 v127, v162, v136
  v_and_b32 v140, v163, v136
  v_accvgpr_write_b32 a208, v125
  v_accvgpr_write_b32 a209, v126
  v_accvgpr_write_b32 a210, v127
  v_accvgpr_write_b32 a211, v140
  ds_read_b128 a[224:227], v3 offset:4000
  ds_read_b128 a[228:231], v3 offset:8800
  ds_read_b128 a[232:235], v3 offset:13600
  buffer_load_dwordx4 a[48:51], v203, s[64:67], s42 offen
  ds_read_b128 a[236:239], v3 offset:4400
  ds_read_b128 v[208:211], v3 offset:9200
  ds_read_b128 v[212:215], v3 offset:14000
  v_and_b32 v125, v164, v136
  v_and_b32 v126, v165, v136
  v_and_b32 v127, v166, v136
  v_and_b32 v140, v167, v136
  v_accvgpr_write_b32 a212, v125
  v_accvgpr_write_b32 a213, v126
  v_accvgpr_write_b32 a214, v127
  buffer_load_dwordx4 a[52:55], v203, s[64:67], s42 offen offset:128
  s_add_u32 s42, s42, 0x1800
  v_accvgpr_write_b32 a215, v140
  s_waitcnt vmcnt(19)
  v_mfma_f32_32x32x16_bf16 v[16:31], a[72:75], v[184:187], 0
  buffer_load_dwordx4 a[56:59], v203, s[64:67], s42 offen
  s_waitcnt vmcnt(19)
  v_mfma_f32_32x32x16_bf16 v[16:31], a[76:79], v[188:191], v[16:31]
  s_waitcnt vmcnt(18)
  v_mfma_f32_32x32x16_bf16 v[32:47], a[80:83], v[184:187], 0
  buffer_load_dwordx4 a[60:63], v203, s[64:67], s42 offen offset:128
  s_add_u32 s42, s42, 0x1800
  s_waitcnt vmcnt(15)
  v_mfma_f32_32x32x16_bf16 v[48:63], a[0:3], v[240:243], v[16:31]
  buffer_load_dwordx4 a[64:67], v203, s[64:67], s42 offen
  v_mfma_f32_32x32x16_bf16 v[32:47], a[84:87], v[188:191], v[32:47]
  s_waitcnt vmcnt(15)
  v_mfma_f32_32x32x16_bf16 v[48:63], a[4:7], v[244:247], v[48:63]
  buffer_load_dwordx4 a[68:71], v203, s[64:67], s42 offen offset:128
  s_waitcnt vmcnt(15)
  v_mfma_f32_32x32x16_bf16 v[216:231], a[8:11], v[240:243], v[16:31]
  s_add_u32 m0, s15, 0x8200
  s_nop 0
  buffer_load_dwordx4 v6, s[4:7], s49 offen lds
  s_waitcnt vmcnt(15)
  v_mfma_f32_32x32x16_bf16 v[216:231], a[12:15], v[244:247], v[216:231]
  buffer_load_dwordx4 v7, s[4:7], s49 offen offset:1024 lds
  s_nop 0
  s_nop 2
  v_cvt_pk_bf16_f32 v64, v48, v52
  v_cvt_pk_bf16_f32 v65, v56, v60
  v_cvt_pk_bf16_f32 v68, v49, v53
  v_cvt_pk_bf16_f32 v69, v57, v61
  v_max3_f32 v236, |v48|, |v52|, |v56|
  v_max_f32_e64 v236, |v60|, v236
  v_max3_f32 v236, |v49|, |v53|, v236
  v_max3_f32 v236, |v57|, |v61|, v236
  s_nop 0
  s_waitcnt vmcnt(15)
  v_mfma_f32_32x32x16_bf16 v[96:111], a[16:19], v[240:243], v[16:31]
  buffer_load_dwordx4 v8, s[4:7], s49 offen offset:2048 lds
  v_cvt_pk_bf16_f32 v72, v50, v54
  v_cvt_pk_bf16_f32 v73, v58, v62
  v_cvt_pk_bf16_f32 v76, v51, v55
  v_cvt_pk_bf16_f32 v77, v59, v63
  v_max3_f32 v236, |v50|, |v54|, v236
  v_max3_f32 v236, |v58|, |v62|, v236
  v_max3_f32 v236, |v51|, |v55|, v236
  v_max3_f32 v236, |v59|, |v63|, v236
  s_nop 0
  s_waitcnt vmcnt(15)
  v_mfma_f32_32x32x16_bf16 v[96:111], a[20:23], v[244:247], v[96:111]
  buffer_load_dwordx4 v9, s[4:7], s49 offen offset:3072 lds
  v_cvt_pk_bf16_f32 v66, v216, v220
  v_cvt_pk_bf16_f32 v67, v224, v228
  v_cvt_pk_bf16_f32 v70, v217, v221
  v_cvt_pk_bf16_f32 v71, v225, v229
  v_max3_f32 v236, |v216|, |v220|, v236
  v_max3_f32 v236, |v224|, |v228|, v236
  v_max3_f32 v236, |v217|, |v221|, v236
  v_max3_f32 v236, |v225|, |v229|, v236
  ds_write_b128 v195, v[64:67]
  s_nop 0
  s_waitcnt vmcnt(15)
  v_mfma_f32_32x32x16_bf16 v[48:63], a[24:27], v[240:243], v[32:47]
  s_add_u32 m0, s15, 0
  s_nop 0
  buffer_load_dwordx4 v198, s[4:7], 0 offen lds
  ds_write_b128 v195, v[68:71] offset:6144
  v_cvt_pk_bf16_f32 v74, v218, v222
  v_cvt_pk_bf16_f32 v75, v226, v230
  v_cvt_pk_bf16_f32 v78, v219, v223
  v_cvt_pk_bf16_f32 v79, v227, v231
  v_max3_f32 v236, |v218|, |v222|, v236
  v_max3_f32 v236, |v226|, |v230|, v236
  v_max3_f32 v236, |v219|, |v223|, v236
  v_max3_f32 v236, |v227|, |v231|, v236
  s_waitcnt vmcnt(15)
  v_mfma_f32_32x32x16_bf16 v[48:63], a[28:31], v[244:247], v[48:63]
  s_add_u32 m0, s15, 0x400
  s_nop 0
  buffer_load_dwordx4 v199, s[4:7], 0 offen lds
  ds_write_b128 v195, v[72:75] offset:12288
  v_cvt_pk_bf16_f32 v80, v96, v100
  v_cvt_pk_bf16_f32 v81, v104, v108
  v_cvt_pk_bf16_f32 v84, v97, v101
  v_cvt_pk_bf16_f32 v85, v105, v109
  v_max3_f32 v236, |v96|, |v100|, v236
  v_max3_f32 v236, |v104|, |v108|, v236
  v_max3_f32 v236, |v97|, |v101|, v236
  v_max3_f32 v236, |v105|, |v109|, v236
  s_waitcnt vmcnt(15)
  v_mfma_f32_32x32x16_bf16 v[216:231], a[32:35], v[240:243], v[32:47]
  s_add_u32 m0, s15, 0x800
  s_nop 0
  buffer_load_dwordx4 v200, s[4:7], 0 offen lds
  ds_write_b128 v195, v[76:79] offset:18432
  v_cvt_pk_bf16_f32 v88, v98, v102
  v_cvt_pk_bf16_f32 v89, v106, v110
  v_cvt_pk_bf16_f32 v92, v99, v103
  v_cvt_pk_bf16_f32 v93, v107, v111
  v_max3_f32 v236, |v98|, |v102|, v236
  v_max3_f32 v236, |v106|, |v110|, v236
  v_max3_f32 v236, |v99|, |v103|, v236
  v_max3_f32 v236, |v107|, |v111|, v236
  s_waitcnt vmcnt(15)
  v_mfma_f32_32x32x16_bf16 v[216:231], a[36:39], v[244:247], v[216:231]
  s_add_u32 m0, s15, 0xc00
  s_nop 0
  buffer_load_dwordx4 v201, s[4:7], 0 offen lds
  ds_write_b64 v196, v[80:81]
  ds_write_b64 v196, v[84:85] offset:6144
  v_cvt_pk_bf16_f32 v64, v48, v52
  v_cvt_pk_bf16_f32 v65, v56, v60
  v_cvt_pk_bf16_f32 v68, v49, v53
  v_cvt_pk_bf16_f32 v69, v57, v61
  v_max3_f32 v232, |v48|, |v52|, |v56|
  v_max_f32_e64 v232, |v60|, v232
  v_max3_f32 v233, |v49|, |v53|, |v57|
  v_max_f32_e64 v233, |v61|, v233
  s_waitcnt vmcnt(15)
  v_mfma_f32_32x32x16_bf16 v[96:111], a[40:43], v[240:243], v[32:47]
  s_add_u32 m0, s14, 0x22000
  s_nop 0
  buffer_load_dwordx4 v254, s[72:75], s57 offen lds
  ds_write_b64 v196, v[88:89] offset:12288
  ds_write_b64 v196, v[92:93] offset:18432
  v_cvt_pk_bf16_f32 v72, v50, v54
  v_cvt_pk_bf16_f32 v73, v58, v62
  v_cvt_pk_bf16_f32 v76, v51, v55
  v_cvt_pk_bf16_f32 v77, v59, v63
  v_max3_f32 v234, |v50|, |v54|, |v58|
  v_max_f32_e64 v234, |v62|, v234
  v_max3_f32 v235, |v51|, |v55|, |v59|
  v_max_f32_e64 v235, |v63|, v235
  s_nop 0
  s_waitcnt vmcnt(15)
  v_mfma_f32_32x32x16_bf16 v[96:111], a[44:47], v[244:247], v[96:111]
  buffer_load_dwordx4 v255, s[72:75], s57 offen offset:1024 lds
  v_cvt_pk_bf16_f32 v66, v216, v220
  v_cvt_pk_bf16_f32 v67, v224, v228
  v_cvt_pk_bf16_f32 v70, v217, v221
  v_cvt_pk_bf16_f32 v71, v225, v229
  v_max3_f32 v232, |v216|, |v220|, v232
  v_max3_f32 v232, |v224|, |v228|, v232
  v_max3_f32 v233, |v217|, |v221|, v233
  v_max3_f32 v233, |v225|, |v229|, v233
  ds_write_b128 v197, v[64:67]
  s_nop 0
  s_waitcnt vmcnt(15)
  v_mfma_f32_32x32x16_bf16 v[48:63], a[48:51], v[240:243], v[32:47]
  buffer_load_dwordx4 v194, s[72:75], s57 offen offset:2048 lds
  ds_write_b128 v197, v[68:71] offset:6144
  v_cvt_pk_bf16_f32 v74, v218, v222
  v_cvt_pk_bf16_f32 v75, v226, v230
  v_cvt_pk_bf16_f32 v78, v219, v223
  v_cvt_pk_bf16_f32 v79, v227, v231
  v_max3_f32 v234, |v218|, |v222|, v234
  v_max3_f32 v234, |v226|, |v230|, v234
  v_max3_f32 v235, |v219|, |v223|, v235
  v_max3_f32 v235, |v227|, |v231|, v235
  s_waitcnt vmcnt(15)
  v_mfma_f32_32x32x16_bf16 v[48:63], a[52:55], v[244:247], v[48:63]
  s_add_u32 m0, s14, 0x22c00
  s_nop 0
  buffer_load_dwordx4 v254, s[72:75], s58 offen lds
  ds_write_b128 v197, v[72:75] offset:12288
  v_cvt_pk_bf16_f32 v80, v96, v100
  v_cvt_pk_bf16_f32 v81, v104, v108
  v_cvt_pk_bf16_f32 v84, v97, v101
  v_cvt_pk_bf16_f32 v85, v105, v109
  v_max3_f32 v232, |v96|, |v100|, v232
  v_max3_f32 v232, |v104|, |v108|, v232
  v_max3_f32 v233, |v97|, |v101|, v233
  v_max3_f32 v233, |v105|, |v109|, v233
  s_nop 0
  s_waitcnt vmcnt(15)
  v_mfma_f32_32x32x16_bf16 v[216:231], a[56:59], v[240:243], v[32:47]
  buffer_load_dwordx4 v255, s[72:75], s58 offen offset:1024 lds
  ds_write_b128 v197, v[76:79] offset:18432
  v_cvt_pk_bf16_f32 v88, v98, v102
  v_cvt_pk_bf16_f32 v89, v106, v110
  v_cvt_pk_bf16_f32 v92, v99, v103
  v_cvt_pk_bf16_f32 v93, v107, v111
  v_max3_f32 v234, |v98|, |v102|, v234
  v_max3_f32 v234, |v106|, |v110|, v234
  v_max3_f32 v235, |v99|, |v103|, v235
  v_max3_f32 v235, |v107|, |v111|, v235
  v_mfma_f32_32x32x16_bf16 v[96:111], a[88:91], v[240:243], v[32:47]
  s_nop 0
  s_waitcnt vmcnt(15)
  v_mfma_f32_32x32x16_bf16 v[216:231], a[60:63], v[244:247], v[216:231]
  buffer_load_dwordx4 v194, s[72:75], s58 offen offset:2048 lds
  v_cvt_pk_bf16_f32 v82, v48, v52
  v_cvt_pk_bf16_f32 v83, v56, v60
  v_cvt_pk_bf16_f32 v86, v49, v53
  v_cvt_pk_bf16_f32 v87, v57, v61
  v_max3_f32 v232, |v48|, |v52|, v232
  v_max3_f32 v232, |v56|, |v60|, v232
  v_max3_f32 v233, |v49|, |v53|, v233
  v_max3_f32 v233, |v57|, |v61|, v233
  ds_write_b128 v197, v[80:83] offset:1024
  v_mfma_f32_32x32x16_bf16 v[96:111], a[92:95], v[244:247], v[96:111]
  s_nop 0
  s_waitcnt vmcnt(15)
  v_mfma_f32_32x32x16_bf16 v[96:111], a[64:67], v[240:243], v[96:111]
  ds_write_b128 v197, v[84:87] offset:7168
  v_cvt_pk_bf16_f32 v90, v50, v54
  v_cvt_pk_bf16_f32 v91, v58, v62
  v_cvt_pk_bf16_f32 v94, v51, v55
  v_cvt_pk_bf16_f32 v95, v59, v63
  v_max3_f32 v234, |v50|, |v54|, v234
  v_max3_f32 v234, |v58|, |v62|, v234
  v_max3_f32 v235, |v51|, |v55|, v235
  v_max3_f32 v235, |v59|, |v63|, v235
  s_nop 0
  s_waitcnt vmcnt(14)
  v_mfma_f32_32x32x16_bf16 v[96:111], a[68:71], v[244:247], v[96:111]
  ds_write_b128 v197, v[88:91] offset:13312
  v_cvt_pk_bf16_f32 v64, v216, v220
  v_cvt_pk_bf16_f32 v65, v224, v228
  v_cvt_pk_bf16_f32 v68, v217, v221
  v_cvt_pk_bf16_f32 v69, v225, v229
  v_max3_f32 v232, |v216|, |v220|, v232
  v_max3_f32 v232, |v224|, |v228|, v232
  v_max3_f32 v233, |v217|, |v221|, v233
  v_max3_f32 v233, |v225|, |v229|, v233
  ds_write_b128 v197, v[92:95] offset:19456
  v_cvt_pk_bf16_f32 v72, v218, v222
  v_cvt_pk_bf16_f32 v73, v226, v230
  v_cvt_pk_bf16_f32 v76, v219, v223
  v_cvt_pk_bf16_f32 v77, v227, v231
  v_max3_f32 v234, |v218|, |v222|, v234
  v_max3_f32 v234, |v226|, |v230|, v234
  v_max3_f32 v235, |v219|, |v223|, v235
  v_max3_f32 v235, |v227|, |v231|, v235
  v_cvt_pk_bf16_f32 v66, v96, v100
  v_cvt_pk_bf16_f32 v67, v104, v108
  v_cvt_pk_bf16_f32 v70, v97, v101
  v_cvt_pk_bf16_f32 v71, v105, v109
  v_max3_f32 v232, |v96|, |v100|, v232
  v_max3_f32 v232, |v104|, |v108|, v232
  v_max3_f32 v233, |v97|, |v101|, v233
  v_max3_f32 v233, |v105|, |v109|, v233
  ds_write_b128 v197, v[64:67] offset:2048
  ds_write_b128 v197, v[68:71] offset:8192
  v_cvt_pk_bf16_f32 v74, v98, v102
  v_cvt_pk_bf16_f32 v75, v106, v110
  v_cvt_pk_bf16_f32 v78, v99, v103
  v_cvt_pk_bf16_f32 v79, v107, v111
  v_max3_f32 v234, |v98|, |v102|, v234
  v_max3_f32 v234, |v106|, |v110|, v234
  v_max3_f32 v235, |v99|, |v103|, v235
  v_max3_f32 v235, |v107|, |v111|, v235
  ds_write_b128 v197, v[72:75] offset:14336
  ds_write_b128 v197, v[76:79] offset:20480
  s_waitcnt lgkmcnt(0)
  s_barrier
  v_max3_f32 v236, v236, v232, v233
  v_min3_f32 v232, v232, v233, v234
  v_max3_f32 v236, v236, v234, v235
  v_min_f32_e64 v232, v232, v235
  v_cmp_le_u32 vcc, 0x43800000, v236
  s_nop 0
  s_cmp_lg_u64 vcc, 0
  s_cselect_b32 s3, 1, 0
  v_cmp_gt_u32 vcc, 0x3a000000, v232
  s_nop 0
  s_cmp_lg_u64 vcc, 0
  s_cselect_b32 s3, 1, s3
  ds_read_b128 a[0:3], v0 offset:24576
  ds_read_b128 a[4:7], v0 offset:25600
  ds_read_b128 a[8:11], v0 offset:26624
  ds_read_b128 a[12:15], v0 offset:27648
  ds_read_b128 a[16:19], v0 offset:28672
  ds_read_b128 a[20:23], v0 offset:29696
  ds_read_b128 a[24:27], v0 offset:30720
  ds_read_b128 a[28:31], v0 offset:31744
  ds_read_b128 a[32:35], v0 offset:32768
  ds_read_b128 a[36:39], v0 offset:33792
  ds_read_b128 a[40:43], v0 offset:34816
  ds_read_b128 a[44:47], v0 offset:35840
  ds_read_b128 a[48:51], v0 offset:36864
  ds_read_b128 a[52:55], v0 offset:37888
  ds_read_b128 a[56:59], v0 offset:38912
  ds_read_b128 a[60:63], v0 offset:39936
  ds_read_b128 a[64:67], v0 offset:40960
  ds_read_b128 a[68:71], v0 offset:41984
  ds_read_b128 a[72:75], v0 offset:43008
  ds_read_b128 a[76:79], v0 offset:44032
  ds_read_b128 a[80:83], v0 offset:45056
  ds_read_b128 a[84:87], v0 offset:46080
  ds_read_b128 a[88:91], v0 offset:47104
  ds_read_b128 a[92:95], v0 offset:48128
  s_nop 0
  s_waitcnt vmcnt(6)
  ds_read_b128 v[216:219], v4
  ds_read_b128 v[220:223], v4 offset:16
  ds_read_b128 v[224:227], v4 offset:192
  ds_read_b128 v[228:231], v4 offset:208
  ds_read_b128 v[232:235], v4 offset:384
  ds_read_b128 v[236:239], v4 offset:400
  ds_read_b128 v[160:163], v4 offset:32
  ds_read_b128 v[164:167], v4 offset:48
  ds_read_b128 v[168:171], v4 offset:224
  ds_read_b128 v[172:175], v4 offset:240
  ds_read_b128 v[176:179], v4 offset:416
  s_waitcnt lgkmcnt(10)
  v_mfma_f32_16x16x32_bf16 v[112:115], a[96:99], v[216:219], 0
  s_waitcnt lgkmcnt(9)
  ds_read_b128 v[180:183], v4 offset:432
  v_mfma_f32_16x16x32_bf16 v[116:119], a[108:111], v[220:223], 0
  s_waitcnt lgkmcnt(9)
  ds_read_b128 v[216:219], v4 offset:64
  v_mfma_f32_16x16x32_bf16 v[112:115], a[100:103], v[224:227], v[112:115]
  s_waitcnt lgkmcnt(9)
  ds_read_b128 v[220:223], v4 offset:80
  v_mfma_f32_16x16x32_bf16 v[116:119], a[112:115], v[228:231], v[116:119]
  s_waitcnt lgkmcnt(9)
  ds_read_b128 v[224:227], v4 offset:256
  v_mfma_f32_16x16x32_bf16 v[112:115], a[104:107], v[232:235], v[112:115]
  s_waitcnt lgkmcnt(9)
  ds_read_b128 v[228:231], v4 offset:272
  v_mfma_f32_16x16x32_bf16 v[116:119], a[116:119], v[236:239], v[116:119]
  s_waitcnt lgkmcnt(9)
  ds_read_b128 v[232:235], v4 offset:448
  v_mfma_f32_16x16x32_bf16 v[120:123], a[120:123], v[160:163], 0
  s_waitcnt lgkmcnt(9)
  ds_read_b128 v[236:239], v4 offset:464
  v_mfma_f32_16x16x32_bf16 v[124:127], a[132:135], v[164:167], 0
  s_waitcnt lgkmcnt(9)
  ds_read_b128 v[160:163], v4 offset:96
  v_mfma_f32_16x16x32_bf16 v[120:123], a[124:127], v[168:171], v[120:123]
  s_waitcnt lgkmcnt(9)
  ds_read_b128 v[164:167], v4 offset:112
  v_mfma_f32_16x16x32_bf16 v[124:127], a[136:139], v[172:175], v[124:127]
  s_waitcnt lgkmcnt(9)
  ds_read_b128 v[168:171], v4 offset:288
  v_mfma_f32_16x16x32_bf16 v[120:123], a[128:131], v[176:179], v[120:123]
  s_waitcnt lgkmcnt(9)
  ds_read_b128 v[172:175], v4 offset:304
  v_mfma_f32_16x16x32_bf16 v[124:127], a[140:143], v[180:183], v[124:127]
  s_waitcnt lgkmcnt(9)
  ds_read_b128 v[176:179], v4 offset:480
  v_mfma_f32_16x16x32_bf16 v[128:131], a[144:147], v[216:219], 0
  s_waitcnt lgkmcnt(9)
  ds_read_b128 v[180:183], v4 offset:496
  v_mfma_f32_16x16x32_bf16 v[132:135], a[156:159], v[220:223], 0
  s_waitcnt lgkmcnt(9)
  ds_read_b128 v[216:219], v4 offset:128
  v_mfma_f32_16x16x32_bf16 v[128:131], a[148:151], v[224:227], v[128:131]
  s_waitcnt lgkmcnt(9)
  ds_read_b128 v[220:223], v4 offset:144
  v_mfma_f32_16x16x32_bf16 v[132:135], a[160:163], v[228:231], v[132:135]
  s_waitcnt lgkmcnt(9)
  ds_read_b128 v[224:227], v4 offset:320
  v_mfma_f32_16x16x32_bf16 v[128:131], a[152:155], v[232:235], v[128:131]
  s_waitcnt lgkmcnt(9)
  ds_read_b128 v[228:231], v4 offset:336
  v_mfma_f32_16x16x32_bf16 v[132:135], a[164:167], v[236:239], v[132:135]
  s_waitcnt lgkmcnt(9)
  ds_read_b128 v[232:235], v4 offset:512
  v_mfma_f32_16x16x32_bf16 v[136:139], a[240:243], v[160:163], 0
  s_waitcnt lgkmcnt(9)
  ds_read_b128 v[236:239], v4 offset:528
  v_mfma_f32_16x16x32_bf16 v[140:143], a[168:171], v[164:167], 0
  s_waitcnt lgkmcnt(9)
  ds_read_b128 v[160:163], v4 offset:160
  v_mfma_f32_16x16x32_bf16 v[136:139], a[244:247], v[168:171], v[136:139]
  s_waitcnt lgkmcnt(9)
  ds_read_b128 v[164:167], v4 offset:176
  v_mfma_f32_16x16x32_bf16 v[140:143], a[172:175], v[172:175], v[140:143]
  s_waitcnt lgkmcnt(9)
  ds_read_b128 v[168:171], v4 offset:352
  v_mfma_f32_16x16x32_bf16 v[136:139], a[248:251], v[176:179], v[136:139]
  s_waitcnt lgkmcnt(9)
  ds_read_b128 v[172:175], v4 offset:368
  v_mfma_f32_16x16x32_bf16 v[140:143], a[176:179], v[180:183], v[140:143]
  s_waitcnt lgkmcnt(9)
  ds_read_b128 v[176:179], v4 offset:544
  v_mfma_f32_16x16x32_bf16 v[144:147], a[252:255], v[216:219], 0
  s_waitcnt lgkmcnt(9)
  ds_read_b128 v[180:183], v4 offset:560
  v_mfma_f32_16x16x32_bf16 v[148:151], a[188:191], v[220:223], 0
  s_waitcnt lgkmcnt(9)
  v_mfma_f32_16x16x32_bf16 v[144:147], a[180:183], v[224:227], v[144:147]
  s_waitcnt lgkmcnt(8)
  v_mfma_f32_16x16x32_bf16 v[148:151], a[216:219], v[228:231], v[148:151]
  s_waitcnt lgkmcnt(7)
  v_mfma_f32_16x16x32_bf16 v[144:147], a[184:187], v[232:235], v[144:147]
  s_waitcnt lgkmcnt(6)
  v_mfma_f32_16x16x32_bf16 v[148:151], a[220:223], v[236:239], v[148:151]
  s_waitcnt lgkmcnt(5)
  v_mfma_f32_16x16x32_bf16 v[152:155], a[224:227], v[160:163], 0
  s_waitcnt lgkmcnt(4)
  v_mfma_f32_16x16x32_bf16 v[156:159], a[236:239], v[164:167], 0
  s_waitcnt lgkmcnt(3)
  v_mfma_f32_16x16x32_bf16 v[152:155], a[228:231], v[168:171], v[152:155]
  s_waitcnt lgkmcnt(2)
  v_mfma_f32_16x16x32_bf16 v[156:159], v[208:211], v[172:175], v[156:159]
  s_waitcnt lgkmcnt(1)
  v_mfma_f32_16x16x32_bf16 v[152:155], a[232:235], v[176:179], v[152:155]
  s_waitcnt lgkmcnt(0)
  v_mfma_f32_16x16x32_bf16 v[156:159], v[212:215], v[180:183], v[156:159]
  buffer_load_dword v249, v248, s[4:7], s29 offen
  v_pk_add_f32 v[12:13], v[112:113], v[114:115]
  v_pk_mul_f32 v[14:15], v[112:113], v[112:113]
  v_pk_fma_f32 v[14:15], v[114:115], v[114:115], v[14:15]
  v_pk_add_f32 v[12:13], v[12:13], v[116:117]
  v_pk_fma_f32 v[14:15], v[116:117], v[116:117], v[14:15]
  v_pk_add_f32 v[12:13], v[12:13], v[118:119]
  v_pk_fma_f32 v[14:15], v[118:119], v[118:119], v[14:15]
  v_pk_add_f32 v[12:13], v[12:13], v[120:121]
  v_pk_fma_f32 v[14:15], v[120:121], v[120:121], v[14:15]
  v_pk_add_f32 v[12:13], v[12:13], v[122:123]
  v_pk_fma_f32 v[14:15], v[122:123], v[122:123], v[14:15]
  v_pk_add_f32 v[12:13], v[12:13], v[124:125]
  ds_read_b128 v[216:219], v0 offset:18432
  ds_read_b128 v[220:223], v0 offset:19456
  ds_read_b128 v[224:227], v0 offset:20480
  ds_read_b128 v[228:231], v0 offset:21504
  v_pk_fma_f32 v[14:15], v[124:125], v[124:125], v[14:15]
  v_pk_add_f32 v[12:13], v[12:13], v[126:127]
  v_pk_fma_f32 v[14:15], v[126:127], v[126:127], v[14:15]
  v_pk_add_f32 v[12:13], v[12:13], v[128:129]
  v_pk_fma_f32 v[14:15], v[128:129], v[128:129], v[14:15]
  v_pk_add_f32 v[12:13], v[12:13], v[130:131]
  v_pk_fma_f32 v[14:15], v[130:131], v[130:131], v[14:15]
  v_pk_add_f32 v[12:13], v[12:13], v[132:133]
  v_pk_fma_f32 v[14:15], v[132:133], v[132:133], v[14:15]
  v_pk_add_f32 v[12:13], v[12:13], v[134:135]
  v_pk_fma_f32 v[14:15], v[134:135], v[134:135], v[14:15]
  v_pk_add_f32 v[12:13], v[12:13], v[136:137]
  ds_read_b128 v[232:235], v0 offset:22528
  ds_read_b128 v[236:239], v0 offset:23552
  ds_read_b128 a[96:99], v0 offset:49152
  ds_read_b128 a[100:103], v0 offset:50176
  v_pk_fma_f32 v[14:15], v[136:137], v[136:137], v[14:15]
  v_pk_add_f32 v[12:13], v[12:13], v[138:139]
  v_pk_fma_f32 v[14:15], v[138:139], v[138:139], v[14:15]
  v_pk_add_f32 v[12:13], v[12:13], v[140:141]
  v_pk_fma_f32 v[14:15], v[140:141], v[140:141], v[14:15]
  v_pk_add_f32 v[12:13], v[12:13], v[142:143]
  v_pk_fma_f32 v[14:15], v[142:143], v[142:143], v[14:15]
  v_pk_add_f32 v[12:13], v[12:13], v[144:145]
  v_pk_fma_f32 v[14:15], v[144:145], v[144:145], v[14:15]
  v_pk_add_f32 v[12:13], v[12:13], v[146:147]
  v_pk_fma_f32 v[14:15], v[146:147], v[146:147], v[14:15]
  v_pk_add_f32 v[12:13], v[12:13], v[148:149]
  ds_read_b128 a[104:107], v0 offset:51200
  ds_read_b128 a[108:111], v0 offset:52224
  ds_read_b128 a[112:115], v0 offset:53248
  ds_read_b128 a[116:119], v0 offset:54272
  v_pk_fma_f32 v[14:15], v[148:149], v[148:149], v[14:15]
  v_pk_add_f32 v[12:13], v[12:13], v[150:151]
  v_pk_fma_f32 v[14:15], v[150:151], v[150:151], v[14:15]
  v_pk_add_f32 v[12:13], v[12:13], v[152:153]
  v_pk_fma_f32 v[14:15], v[152:153], v[152:153], v[14:15]
  v_pk_add_f32 v[12:13], v[12:13], v[154:155]
  v_pk_fma_f32 v[14:15], v[154:155], v[154:155], v[14:15]
  v_pk_add_f32 v[12:13], v[12:13], v[156:157]
  v_pk_fma_f32 v[14:15], v[156:157], v[156:157], v[14:15]
  v_pk_add_f32 v[12:13], v[12:13], v[158:159]
  v_pk_fma_f32 v[14:15], v[158:159], v[158:159], v[14:15]
  v_add_f32_e64 v12, v12, v13
  ds_read_b128 a[120:123], v0 offset:55296
  ds_read_b128 a[124:127], v0 offset:56320
  ds_read_b128 a[128:131], v0 offset:57344
  ds_read_b128 a[132:135], v0 offset:58368
  v_add_f32 v14, v14, v15
  s_nop 1
  v_permlane32_swap_b32 v12, v14
  v_add_f32 v12, v12, v14
  v_mov_b32 v14, v12
  s_nop 1
  v_permlane32_swap_b32 v12, v14
  v_mul_f32 v12, s24, v12
  v_mul_f32_e64 v13, s24, v14
  v_fma_f32 v13, -v12, v12, v13
  v_max_f32 v13, 0, v13
  v_add_f32 v13, s25, v13
  v_rsq_f32 v13, v13
  s_nop 0
  v_mul_f32_e64 v14, s22, v13
  ds_read_b128 a[136:139], v0 offset:59392
  ds_read_b128 a[140:143], v0 offset:60416
  ds_read_b128 a[144:147], v0 offset:61440
  ds_read_b128 a[148:151], v0 offset:62464
  v_mul_f32_e64 v12, -v12, v14
  v_pk_fma_f32 v[112:113], v[112:113], v[14:15], v[12:13] op_sel_hi:[1,0,0]
  v_pk_fma_f32 v[114:115], v[114:115], v[14:15], v[12:13] op_sel_hi:[1,0,0]
  v_pk_fma_f32 v[116:117], v[116:117], v[14:15], v[12:13] op_sel_hi:[1,0,0]
  v_pk_fma_f32 v[118:119], v[118:119], v[14:15], v[12:13] op_sel_hi:[1,0,0]
  v_pk_fma_f32 v[120:121], v[120:121], v[14:15], v[12:13] op_sel_hi:[1,0,0]
  v_pk_fma_f32 v[122:123], v[122:123], v[14:15], v[12:13] op_sel_hi:[1,0,0]
  v_pk_fma_f32 v[124:125], v[124:125], v[14:15], v[12:13] op_sel_hi:[1,0,0]
  v_pk_fma_f32 v[126:127], v[126:127], v[14:15], v[12:13] op_sel_hi:[1,0,0]
  v_pk_fma_f32 v[128:129], v[128:129], v[14:15], v[12:13] op_sel_hi:[1,0,0]
  v_pk_fma_f32 v[130:131], v[130:131], v[14:15], v[12:13] op_sel_hi:[1,0,0]
  v_pk_fma_f32 v[132:133], v[132:133], v[14:15], v[12:13] op_sel_hi:[1,0,0]
  ds_read_b128 a[152:155], v0 offset:63488
  ds_read_b128 a[156:159], v0 offset:64512
  ds_read_b128 a[160:163], v1
  ds_read_b128 a[164:167], v1 offset:1024
  v_pk_fma_f32 v[134:135], v[134:135], v[14:15], v[12:13] op_sel_hi:[1,0,0]
  v_pk_fma_f32 v[136:137], v[136:137], v[14:15], v[12:13] op_sel_hi:[1,0,0]
  v_pk_fma_f32 v[138:139], v[138:139], v[14:15], v[12:13] op_sel_hi:[1,0,0]
  v_pk_fma_f32 v[140:141], v[140:141], v[14:15], v[12:13] op_sel_hi:[1,0,0]
  v_pk_fma_f32 v[142:143], v[142:143], v[14:15], v[12:13] op_sel_hi:[1,0,0]
  v_pk_fma_f32 v[144:145], v[144:145], v[14:15], v[12:13] op_sel_hi:[1,0,0]
  v_pk_fma_f32 v[146:147], v[146:147], v[14:15], v[12:13] op_sel_hi:[1,0,0]
  v_pk_fma_f32 v[148:149], v[148:149], v[14:15], v[12:13] op_sel_hi:[1,0,0]
  v_pk_fma_f32 v[150:151], v[150:151], v[14:15], v[12:13] op_sel_hi:[1,0,0]
  v_pk_fma_f32 v[152:153], v[152:153], v[14:15], v[12:13] op_sel_hi:[1,0,0]
  v_pk_fma_f32 v[154:155], v[154:155], v[14:15], v[12:13] op_sel_hi:[1,0,0]
  v_pk_fma_f32 v[156:157], v[156:157], v[14:15], v[12:13] op_sel_hi:[1,0,0]
  ds_read_b128 a[168:171], v1 offset:2048
  ds_read_b128 a[172:175], v1 offset:3072
  ds_read_b128 a[176:179], v1 offset:4096
  ds_read_b128 a[180:183], v1 offset:5120
  v_pk_fma_f32 v[158:159], v[158:159], v[14:15], v[12:13] op_sel_hi:[1,0,0]
  v_cndmask_b32 v159, v159, v250, s[12:13]
  v_cvt_pk_bf16_f32 v160, v112, v113
  v_cvt_pk_bf16_f32 v161, v114, v115
  v_cvt_pk_bf16_f32 v162, v116, v117
  v_cvt_pk_bf16_f32 v163, v118, v119
  v_cvt_pk_bf16_f32 v164, v120, v121
  v_cvt_pk_bf16_f32 v165, v122, v123
  v_cvt_pk_bf16_f32 v166, v124, v125
  v_cvt_pk_bf16_f32 v167, v126, v127
  v_cvt_pk_bf16_f32 v168, v128, v129
  v_cvt_pk_bf16_f32 v169, v130, v131
  ds_read_b128 a[184:187], v1 offset:6144
  ds_read_b128 a[188:191], v1 offset:7168
  v_cvt_pk_bf16_f32 v170, v132, v133
  v_cvt_pk_bf16_f32 v171, v134, v135
  v_cvt_pk_bf16_f32 v172, v136, v137
  v_cvt_pk_bf16_f32 v173, v138, v139
  v_cvt_pk_bf16_f32 v174, v140, v141
  v_cvt_pk_bf16_f32 v175, v142, v143
  v_cvt_pk_bf16_f32 v176, v144, v145
  v_cvt_pk_bf16_f32 v177, v146, v147
  v_cvt_pk_bf16_f32 v178, v148, v149
  v_cvt_pk_bf16_f32 v179, v150, v151
  v_cvt_pk_bf16_f32 v180, v152, v153
  v_cvt_pk_bf16_f32 v181, v154, v155
  v_cvt_pk_bf16_f32 v182, v156, v157
  v_cvt_pk_bf16_f32 v183, v158, v159
  s_nop 0
  s_waitcnt lgkmcnt(15)
  v_mfma_f32_32x32x16_bf16 v[16:31], v[216:219], v[160:163], 0
  ds_read_b128 v[136:139], v5
  ds_read_b128 v[140:143], v5 offset:32
  ds_read_b128 v[144:147], v5 offset:64
  v_mfma_f32_32x32x16_bf16 v[16:31], v[220:223], v[164:167], v[16:31]
  ds_read_b128 v[148:151], v5 offset:96
  ds_read_b128 v[152:155], v5 offset:128
  ds_read_b128 v[156:159], v5 offset:160
  v_mfma_f32_32x32x16_bf16 v[16:31], v[224:227], v[168:171], v[16:31]
  s_nop 0
  s_waitcnt vmcnt(1)
  ds_read_b128 a[216:219], v251 offset:49152
  ds_read_b128 a[220:223], v252 offset:49152
  v_mfma_f32_32x32x16_bf16 v[16:31], v[228:231], v[172:175], v[16:31]
  ds_read_b128 a[224:227], v251 offset:49216
  ds_read_b128 a[228:231], v252 offset:49216
  ds_read_b128 a[232:235], v251 offset:49280
  v_mfma_f32_32x32x16_bf16 v[16:31], v[232:235], v[176:179], v[16:31]
  ds_read_b128 a[236:239], v252 offset:49280
  v_mfma_f32_32x32x16_bf16 v[16:31], v[236:239], v[180:183], v[16:31]
  s_waitcnt lgkmcnt(5)
  v_mfma_f32_32x32x16_bf16 v[64:79], a[216:219], a[192:195], 0
  s_mov_b32 m0, s30
  s_waitcnt lgkmcnt(4)
  v_mfma_f32_32x32x16_bf16 v[64:79], a[220:223], a[196:199], v[64:79]
  buffer_load_dwordx4 v6, s[4:7], s29 offen lds
  s_nop 5
  v_cvt_pk_f16_f32 v48, v16, v17
  v_cvt_pk_f16_f32 v49, v18, v19
  v_cvt_pk_f16_f32 v50, v20, v21
  v_cvt_pk_f16_f32 v51, v22, v23
  v_cvt_pk_f16_f32 v52, v24, v25
  s_waitcnt lgkmcnt(3)
  v_mfma_f32_32x32x16_bf16 v[80:95], a[224:227], a[200:203], 0
  buffer_load_dwordx4 v7, s[4:7], s29 offen offset:1024 lds
  v_cvt_pk_f16_f32 v53, v26, v27
  v_cvt_pk_f16_f32 v54, v28, v29
  v_cvt_pk_f16_f32 v55, v30, v31
  v_pk_fma_f16 v56, v48, v48, s20 op_sel_hi:[1,1,0]
  v_pk_fma_f16 v57, v49, v49, s20 op_sel_hi:[1,1,0]
  s_waitcnt lgkmcnt(2)
  v_mfma_f32_32x32x16_bf16 v[80:95], a[228:231], a[204:207], v[80:95]
  buffer_load_dwordx4 v8, s[4:7], s29 offen offset:2048 lds
  v_cvt_pk_f16_f32 v112, v64, v65
  v_cvt_pk_f16_f32 v113, v66, v67
  v_cvt_pk_f16_f32 v114, v68, v69
  v_cvt_pk_f16_f32 v115, v70, v71
  v_pk_fma_f16 v58, v50, v50, s20 op_sel_hi:[1,1,0]
  s_waitcnt lgkmcnt(1)
  v_mfma_f32_32x32x16_bf16 v[96:111], a[232:235], a[208:211], 0
  buffer_load_dwordx4 v9, s[4:7], s29 offen offset:3072 lds
  ds_write_b128 v253, v[112:115] offset:49152
  v_cvt_pk_f16_f32 v116, v72, v73
  v_cvt_pk_f16_f32 v117, v74, v75
  v_cvt_pk_f16_f32 v118, v76, v77
  v_cvt_pk_f16_f32 v119, v78, v79
  s_waitcnt lgkmcnt(1)
  v_mfma_f32_32x32x16_bf16 v[96:111], a[236:239], a[212:215], v[96:111]
  ds_write_b128 v253, v[116:119] offset:52224
  v_cvt_pk_f16_f32 v120, v80, v81
  v_cvt_pk_f16_f32 v121, v82, v83
  v_cvt_pk_f16_f32 v122, v84, v85
  v_cvt_pk_f16_f32 v123, v86, v87
  ds_write_b128 v253, v[120:123] offset:50176
  v_cvt_pk_f16_f32 v124, v88, v89
  v_cvt_pk_f16_f32 v125, v90, v91
  v_cvt_pk_f16_f32 v126, v92, v93
  v_cvt_pk_f16_f32 v127, v94, v95
  ds_write_b128 v253, v[124:127] offset:53248
  s_nop 0
  s_nop 0
  v_cvt_pk_f16_f32 v128, v96, v97
  v_cvt_pk_f16_f32 v129, v98, v99
  v_cvt_pk_f16_f32 v130, v100, v101
  v_cvt_pk_f16_f32 v131, v102, v103
  ds_write_b128 v253, v[128:131] offset:51200
  v_cvt_pk_f16_f32 v132, v104, v105
  v_cvt_pk_f16_f32 v133, v106, v107
  v_cvt_pk_f16_f32 v134, v108, v109
  v_cvt_pk_f16_f32 v135, v110, v111
  ds_write_b128 v253, v[132:135] offset:54272
  s_waitcnt lgkmcnt(0)
  s_barrier
  v_mfma_f32_32x32x16_bf16 v[16:31], a[0:3], v[160:163], 0
  ds_read_b128 v[64:67], v2
  ds_read_b128 v[68:71], v2 offset:32
  ds_read_b128 v[72:75], v2 offset:64
  s_add_u32 m0, s14, 0x16000
  v_pk_fma_f16 v59, v51, v51, s20 op_sel_hi:[1,1,0]
  v_pk_fma_f16 v56, v56, v56, s20 op_sel:[0,0,1]
  v_mfma_f32_32x32x16_bf16 v[16:31], a[4:7], v[164:167], v[16:31]
  ds_read_b128 v[76:79], v2 offset:96
  ds_read_b128 v[80:83], v2 offset:128
  ds_read_b128 v[84:87], v2 offset:160
  buffer_load_dwordx4 v254, s[72:75], s53 offen lds
  v_pk_fma_f16 v57, v57, v57, s20 op_sel:[0,0,1]
  v_pk_fma_f16 v58, v58, v58, s20 op_sel:[0,0,1]
  v_mfma_f32_32x32x16_bf16 v[16:31], a[8:11], v[168:171], v[16:31]
  ds_read_b128 v[88:91], v2 offset:192
  ds_read_b128 v[92:95], v2 offset:224
  ds_read_b128 v[96:99], v2 offset:256
  buffer_load_dwordx4 v255, s[72:75], s53 offen offset:1024 lds
  v_pk_fma_f16 v59, v59, v59, s20 op_sel:[0,0,1]
  v_pk_fma_f16 v184, v56, v56, s21 op_sel_hi:[1,1,0]
  v_mfma_f32_32x32x16_bf16 v[16:31], a[12:15], v[172:175], v[16:31]
  ds_read_b128 v[100:103], v2 offset:288
  ds_read_b128 v[104:107], v2 offset:320
  ds_read_b128 v[108:111], v2 offset:352
  v_pk_fma_f16 v185, v57, v57, s21 op_sel_hi:[1,1,0]
  v_pk_fma_f16 v186, v58, v58, s21 op_sel_hi:[1,1,0]
  v_pk_fma_f16 v187, v59, v59, s21 op_sel_hi:[1,1,0]
  v_mfma_f32_32x32x16_bf16 v[16:31], a[16:19], v[176:179], v[16:31]
  buffer_load_dwordx4 v194, s[72:75], s53 offen offset:2048 lds
  s_add_u32 m0, s14, 0x16c00
  v_pk_fma_f16 v184, v184, v56, s21 op_sel:[0,0,1]
  v_pk_fma_f16 v185, v185, v57, s21 op_sel:[0,0,1]
  v_pk_fma_f16 v186, v186, v58, s21 op_sel:[0,0,1]
  v_pk_fma_f16 v187, v187, v59, s21 op_sel:[0,0,1]
  v_mfma_f32_32x32x16_bf16 v[16:31], a[20:23], v[180:183], v[16:31]
  s_nop 0
  s_waitcnt lgkmcnt(0)
  buffer_load_dwordx4 v254, s[72:75], s54 offen lds
  v_pk_fma_f16 v184, v184, v48, 0.5 op_sel_hi:[1,1,0] clamp
  v_pk_fma_f16 v185, v185, v49, 0.5 op_sel_hi:[1,1,0] clamp
  v_pk_fma_f16 v186, v186, v50, 0.5 op_sel_hi:[1,1,0] clamp
  v_pk_fma_f16 v187, v187, v51, 0.5 op_sel_hi:[1,1,0] clamp
  v_pk_mul_f16 v184, v184, v48
  v_mfma_f32_32x32x16_bf16 v[64:79], v[240:243], v[136:139], v[64:79]
  v_pk_mul_f16 v185, v185, v49
  v_pk_mul_f16 v186, v186, v50
  v_pk_mul_f16 v187, v187, v51
  v_pk_fma_f16 v56, v52, v52, s20 op_sel_hi:[1,1,0]
  v_pk_fma_f16 v57, v53, v53, s20 op_sel_hi:[1,1,0]
  v_mov_b32_e64 v15, v194
  v_mfma_f32_32x32x16_bf16 v[64:79], v[244:247], v[140:143], v[64:79]
  buffer_load_dwordx4 v255, s[72:75], s54 offen offset:1024 lds
  v_pk_fma_f16 v58, v54, v54, s20 op_sel_hi:[1,1,0]
  v_pk_fma_f16 v59, v55, v55, s20 op_sel_hi:[1,1,0]
  v_pk_fma_f16 v56, v56, v56, s20 op_sel:[0,0,1]
  v_pk_fma_f16 v57, v57, v57, s20 op_sel:[0,0,1]
  v_pk_fma_f16 v58, v58, v58, s20 op_sel:[0,0,1]
  v_mfma_f32_32x32x16_bf16 v[80:95], v[240:243], v[144:147], v[80:95]
  buffer_load_dwordx4 v194, s[72:75], s54 offen offset:2048 lds
  v_or_b32_e64 v12, v112, v113
  v_or3_b32 v12, v114, v115, v12
  v_or3_b32 v12, v116, v117, v12
  v_or3_b32 v12, v118, v119, v12
  v_pk_fma_f16 v59, v59, v59, s20 op_sel:[0,0,1]
  v_mfma_f32_32x32x16_bf16 v[80:95], v[244:247], v[148:151], v[80:95]
  ds_read_b128 v[192:195], v1 offset:8192
  ds_read_b128 v[196:199], v1 offset:9216
  v_or3_b32 v12, v120, v121, v12
  v_or3_b32 v12, v122, v123, v12
  v_or3_b32 v12, v124, v125, v12
  v_or3_b32 v12, v126, v127, v12
  v_mfma_f32_32x32x16_bf16 v[96:111], v[240:243], v[152:155], v[96:111]
  ds_read_b128 v[200:203], v1 offset:10240
  ds_read_b128 v[204:207], v1 offset:11264
  v_or3_b32 v12, v128, v129, v12
  v_or3_b32 v12, v130, v131, v12
  v_or3_b32 v12, v132, v133, v12
  v_or3_b32 v12, v134, v135, v12
  v_mfma_f32_32x32x16_bf16 v[96:111], v[244:247], v[156:159], v[96:111]
  s_waitcnt lgkmcnt(0)
  ds_read_b128 v[208:211], v1 offset:12288
  ds_read_b128 v[212:215], v1 offset:13312
  v_pk_fma_f16 v188, v56, v56, s21 op_sel_hi:[1,1,0]
  v_pk_fma_f16 v189, v57, v57, s21 op_sel_hi:[1,1,0]
  v_pk_fma_f16 v190, v58, v58, s21 op_sel_hi:[1,1,0]
  v_pk_fma_f16 v191, v59, v59, s21 op_sel_hi:[1,1,0]
  v_mfma_f32_32x32x16_f16 v[64:79], v[192:195], v[184:187], v[64:79]
  s_mov_b32 m0, s31
  v_pk_fma_f16 v188, v188, v56, s21 op_sel:[0,0,1]
  v_pk_fma_f16 v189, v189, v57, s21 op_sel:[0,0,1]
  v_pk_fma_f16 v190, v190, v58, s21 op_sel:[0,0,1]
  v_pk_fma_f16 v191, v191, v59, s21 op_sel:[0,0,1]
  v_pk_fma_f16 v188, v188, v52, 0.5 op_sel_hi:[1,1,0] clamp
  v_pk_fma_f16 v189, v189, v53, 0.5 op_sel_hi:[1,1,0] clamp
  v_mfma_f32_32x32x16_f16 v[80:95], v[196:199], v[184:187], v[80:95]
  buffer_load_dwordx4 v6, s[4:7], s52 offen lds
  v_pk_fma_f16 v190, v190, v54, 0.5 op_sel_hi:[1,1,0] clamp
  v_pk_fma_f16 v191, v191, v55, 0.5 op_sel_hi:[1,1,0] clamp
  v_pk_mul_f16 v188, v188, v52
  v_pk_mul_f16 v189, v189, v53
  v_pk_mul_f16 v190, v190, v54
  v_mfma_f32_32x32x16_f16 v[96:111], v[200:203], v[184:187], v[96:111]
  buffer_load_dwordx4 v7, s[4:7], s52 offen offset:1024 lds
  v_pk_mul_f16 v191, v191, v55
  v_cvt_pk_f16_f32 v48, v16, v17
  v_cvt_pk_f16_f32 v49, v18, v19
  v_cvt_pk_f16_f32 v50, v20, v21
  v_cvt_pk_f16_f32 v51, v22, v23
  v_mfma_f32_32x32x16_f16 v[64:79], v[204:207], v[188:191], v[64:79]
  buffer_load_dwordx4 v8, s[4:7], s52 offen offset:2048 lds
  v_cvt_pk_f16_f32 v52, v24, v25
  v_cvt_pk_f16_f32 v53, v26, v27
  v_cvt_pk_f16_f32 v54, v28, v29
  v_cvt_pk_f16_f32 v55, v30, v31
  v_pk_fma_f16 v56, v48, v48, s20 op_sel_hi:[1,1,0]
  s_waitcnt lgkmcnt(1)
  v_mfma_f32_32x32x16_f16 v[80:95], v[208:211], v[188:191], v[80:95]
  buffer_load_dwordx4 v9, s[4:7], s52 offen offset:3072 lds
  v_pk_fma_f16 v57, v49, v49, s20 op_sel_hi:[1,1,0]
  v_pk_fma_f16 v58, v50, v50, s20 op_sel_hi:[1,1,0]
  v_pk_fma_f16 v59, v51, v51, s20 op_sel_hi:[1,1,0]
  v_pk_fma_f16 v56, v56, v56, s20 op_sel:[0,0,1]
  v_pk_fma_f16 v57, v57, v57, s20 op_sel:[0,0,1]
  s_waitcnt lgkmcnt(0)
  v_mfma_f32_32x32x16_f16 v[96:111], v[212:215], v[188:191], v[96:111]
  v_pk_fma_f16 v58, v58, v58, s20 op_sel:[0,0,1]
  v_pk_fma_f16 v59, v59, v59, s20 op_sel:[0,0,1]
  v_pk_fma_f16 v184, v56, v56, s21 op_sel_hi:[1,1,0]
  v_pk_fma_f16 v185, v57, v57, s21 op_sel_hi:[1,1,0]
  v_pk_fma_f16 v186, v58, v58, s21 op_sel_hi:[1,1,0]
  v_pk_fma_f16 v187, v59, v59, s21 op_sel_hi:[1,1,0]
  v_mfma_f32_32x32x16_bf16 v[16:31], a[24:27], v[160:163], 0
  ds_read_b128 v[192:195], v1 offset:14336
  ds_read_b128 v[196:199], v1 offset:15360
  s_add_u32 m0, s14, 0x1c000
  v_pk_fma_f16 v184, v184, v56, s21 op_sel:[0,0,1]
  v_pk_fma_f16 v185, v185, v57, s21 op_sel:[0,0,1]
  v_pk_fma_f16 v186, v186, v58, s21 op_sel:[0,0,1]
  v_mfma_f32_32x32x16_bf16 v[16:31], a[28:31], v[164:167], v[16:31]
  ds_read_b128 v[200:203], v1 offset:16384
  ds_read_b128 v[204:207], v1 offset:17408
  buffer_load_dwordx4 v254, s[72:75], s55 offen lds
  v_pk_fma_f16 v187, v187, v59, s21 op_sel:[0,0,1]
  v_pk_fma_f16 v184, v184, v48, 0.5 op_sel_hi:[1,1,0] clamp
  v_pk_fma_f16 v185, v185, v49, 0.5 op_sel_hi:[1,1,0] clamp
  v_mfma_f32_32x32x16_bf16 v[16:31], a[32:35], v[168:171], v[16:31]
  ds_read_b128 v[208:211], v1 offset:18432
  ds_read_b128 v[212:215], v1 offset:19456
  v_pk_fma_f16 v186, v186, v50, 0.5 op_sel_hi:[1,1,0] clamp
  v_pk_fma_f16 v187, v187, v51, 0.5 op_sel_hi:[1,1,0] clamp
  v_pk_mul_f16 v184, v184, v48
  v_pk_mul_f16 v185, v185, v49
  v_mfma_f32_32x32x16_bf16 v[16:31], a[36:39], v[172:175], v[16:31]
  buffer_load_dwordx4 v255, s[72:75], s55 offen offset:1024 lds
  v_pk_mul_f16 v186, v186, v50
  v_pk_mul_f16 v187, v187, v51
  v_pk_fma_f16 v56, v52, v52, s20 op_sel_hi:[1,1,0]
  v_pk_fma_f16 v57, v53, v53, s20 op_sel_hi:[1,1,0]
  v_pk_fma_f16 v58, v54, v54, s20 op_sel_hi:[1,1,0]
  v_mfma_f32_32x32x16_bf16 v[16:31], a[40:43], v[176:179], v[16:31]
  v_pk_fma_f16 v59, v55, v55, s20 op_sel_hi:[1,1,0]
  v_pk_fma_f16 v56, v56, v56, s20 op_sel:[0,0,1]
  v_pk_fma_f16 v57, v57, v57, s20 op_sel:[0,0,1]
  v_pk_fma_f16 v58, v58, v58, s20 op_sel:[0,0,1]
  v_pk_fma_f16 v59, v59, v59, s20 op_sel:[0,0,1]
  v_pk_fma_f16 v188, v56, v56, s21 op_sel_hi:[1,1,0]
  v_mfma_f32_32x32x16_bf16 v[16:31], a[44:47], v[180:183], v[16:31]
  s_nop 0
  s_waitcnt lgkmcnt(0)
  buffer_load_dwordx4 v15, s[72:75], s55 offen offset:2048 lds
  v_pk_fma_f16 v189, v57, v57, s21 op_sel_hi:[1,1,0]
  v_pk_fma_f16 v190, v58, v58, s21 op_sel_hi:[1,1,0]
  v_pk_fma_f16 v191, v59, v59, s21 op_sel_hi:[1,1,0]
  v_pk_fma_f16 v188, v188, v56, s21 op_sel:[0,0,1]
  v_pk_fma_f16 v189, v189, v57, s21 op_sel:[0,0,1]
  v_mfma_f32_32x32x16_f16 v[64:79], v[192:195], v[184:187], v[64:79]
  s_add_u32 m0, s14, 0x1cc00
  v_pk_fma_f16 v190, v190, v58, s21 op_sel:[0,0,1]
  v_pk_fma_f16 v191, v191, v59, s21 op_sel:[0,0,1]
  v_pk_fma_f16 v188, v188, v52, 0.5 op_sel_hi:[1,1,0] clamp
  v_pk_fma_f16 v189, v189, v53, 0.5 op_sel_hi:[1,1,0] clamp
  v_pk_fma_f16 v190, v190, v54, 0.5 op_sel_hi:[1,1,0] clamp
  v_pk_fma_f16 v191, v191, v55, 0.5 op_sel_hi:[1,1,0] clamp
  v_mfma_f32_32x32x16_f16 v[80:95], v[196:199], v[184:187], v[80:95]
  buffer_load_dwordx4 v254, s[72:75], s56 offen lds
  v_pk_mul_f16 v188, v188, v52
  v_pk_mul_f16 v189, v189, v53
  v_pk_mul_f16 v190, v190, v54
  v_pk_mul_f16 v191, v191, v55
  v_cvt_pk_f16_f32 v48, v16, v17
  v_mfma_f32_32x32x16_f16 v[96:111], v[200:203], v[184:187], v[96:111]
  s_nop 0
  s_waitcnt vmcnt(8)
  ds_read_b128 a[216:219], v251
  ds_read_b128 a[220:223], v252
  ds_read_b128 a[224:227], v251 offset:64
  v_cvt_pk_f16_f32 v49, v18, v19
  v_cvt_pk_f16_f32 v50, v20, v21
  v_subrev_u32 v11, 0x4100, v5
  v_mfma_f32_32x32x16_f16 v[64:79], v[204:207], v[188:191], v[64:79]
  ds_read_b128 a[228:231], v252 offset:64
  ds_read_b128 a[232:235], v251 offset:128
  ds_read_b128 a[236:239], v252 offset:128
  buffer_load_dwordx4 v255, s[72:75], s56 offen offset:1024 lds
  v_add_u32 v5, 0x8200, v5
  v_cvt_pk_f16_f32 v51, v22, v23
  v_mfma_f32_32x32x16_f16 v[80:95], v[208:211], v[188:191], v[80:95]
  v_cvt_pk_f16_f32 v52, v24, v25
  v_cvt_pk_f16_f32 v53, v26, v27
  v_cvt_pk_f16_f32 v54, v28, v29
  v_cvt_pk_f16_f32 v55, v30, v31
  v_pk_fma_f16 v56, v48, v48, s20 op_sel_hi:[1,1,0]
  v_min_u32 v5, v11, v5
  v_mfma_f32_32x32x16_f16 v[96:111], v[212:215], v[188:191], v[96:111]
  s_waitcnt lgkmcnt(0)
  buffer_load_dwordx4 v15, s[72:75], s56 offen offset:2048 lds
  v_pk_fma_f16 v57, v49, v49, s20 op_sel_hi:[1,1,0]
  v_pk_fma_f16 v58, v50, v50, s20 op_sel_hi:[1,1,0]
  v_pk_fma_f16 v59, v51, v51, s20 op_sel_hi:[1,1,0]
  v_pk_fma_f16 v56, v56, v56, s20 op_sel:[0,0,1]
  v_pk_fma_f16 v57, v57, v57, s20 op_sel:[0,0,1]
  v_mfma_f32_32x32x16_bf16 v[112:127], a[216:219], a[192:195], 0
  ds_read_b128 v[192:195], v1 offset:20480
  ds_read_b128 v[196:199], v1 offset:21504
  v_pk_fma_f16 v58, v58, v58, s20 op_sel:[0,0,1]
  v_pk_fma_f16 v59, v59, v59, s20 op_sel:[0,0,1]
  v_pk_fma_f16 v184, v56, v56, s21 op_sel_hi:[1,1,0]
  v_pk_fma_f16 v185, v57, v57, s21 op_sel_hi:[1,1,0]
  v_mfma_f32_32x32x16_bf16 v[112:127], a[220:223], a[196:199], v[112:127]
  ds_read_b128 v[200:203], v1 offset:22528
  ds_read_b128 v[204:207], v1 offset:23552
  v_pk_fma_f16 v186, v58, v58, s21 op_sel_hi:[1,1,0]
  v_pk_fma_f16 v187, v59, v59, s21 op_sel_hi:[1,1,0]
  v_pk_fma_f16 v184, v184, v56, s21 op_sel:[0,0,1]
  v_pk_fma_f16 v185, v185, v57, s21 op_sel:[0,0,1]
  v_mfma_f32_32x32x16_bf16 v[128:143], a[224:227], a[200:203], 0
  ds_read_b128 v[208:211], v1 offset:24576
  ds_read_b128 v[212:215], v1 offset:25600
  v_pk_fma_f16 v186, v186, v58, s21 op_sel:[0,0,1]
  v_pk_fma_f16 v187, v187, v59, s21 op_sel:[0,0,1]
  v_pk_fma_f16 v184, v184, v48, 0.5 op_sel_hi:[1,1,0] clamp
  v_pk_fma_f16 v185, v185, v49, 0.5 op_sel_hi:[1,1,0] clamp
  v_mfma_f32_32x32x16_bf16 v[128:143], a[228:231], a[204:207], v[128:143]
  v_cvt_pk_f16_f32 v112, v112, v113
  v_cvt_pk_f16_f32 v113, v114, v115
  v_pk_fma_f16 v186, v186, v50, 0.5 op_sel_hi:[1,1,0] clamp
  v_cvt_pk_f16_f32 v114, v116, v117
  v_cvt_pk_f16_f32 v115, v118, v119
  v_pk_fma_f16 v187, v187, v51, 0.5 op_sel_hi:[1,1,0] clamp
  v_mfma_f32_32x32x16_bf16 v[144:159], a[232:235], a[208:211], 0
  ds_write_b128 v253, v[112:115]
  v_cvt_pk_f16_f32 v116, v120, v121
  v_cvt_pk_f16_f32 v117, v122, v123
  v_cvt_pk_f16_f32 v118, v124, v125
  v_cvt_pk_f16_f32 v119, v126, v127
  v_mfma_f32_32x32x16_bf16 v[144:159], a[236:239], a[212:215], v[144:159]
  ds_write_b128 v253, v[116:119] offset:3072
  v_cvt_pk_f16_f32 v128, v128, v129
  v_cvt_pk_f16_f32 v129, v130, v131
  v_cvt_pk_f16_f32 v130, v132, v133
  v_cvt_pk_f16_f32 v131, v134, v135
  v_mfma_f32_32x32x16_bf16 v[16:31], a[48:51], v[160:163], 0
  ds_write_b128 v253, v[128:131] offset:1024
  v_cvt_pk_f16_f32 v132, v136, v137
  v_cvt_pk_f16_f32 v133, v138, v139
  v_cvt_pk_f16_f32 v134, v140, v141
  v_cvt_pk_f16_f32 v135, v142, v143
  v_mfma_f32_32x32x16_bf16 v[16:31], a[52:55], v[164:167], v[16:31]
  ds_write_b128 v253, v[132:135] offset:4096
  v_cvt_pk_f16_f32 v144, v144, v145
  v_cvt_pk_f16_f32 v145, v146, v147
  v_cvt_pk_f16_f32 v146, v148, v149
  v_cvt_pk_f16_f32 v147, v150, v151
  v_mfma_f32_32x32x16_bf16 v[16:31], a[56:59], v[168:171], v[16:31]
  ds_write_b128 v253, v[144:147] offset:2048
  v_cvt_pk_f16_f32 v148, v152, v153
  v_cvt_pk_f16_f32 v149, v154, v155
  v_cvt_pk_f16_f32 v150, v156, v157
  v_cvt_pk_f16_f32 v151, v158, v159
  v_mfma_f32_32x32x16_bf16 v[16:31], a[60:63], v[172:175], v[16:31]
  ds_write_b128 v253, v[148:151] offset:5120
  v_or3_b32 v12, v112, v113, v12
  v_or3_b32 v12, v114, v115, v12
  v_or3_b32 v12, v116, v117, v12
  v_or3_b32 v12, v118, v119, v12
  v_mfma_f32_32x32x16_bf16 v[16:31], a[64:67], v[176:179], v[16:31]
  v_or3_b32 v12, v128, v129, v12
  v_or3_b32 v12, v130, v131, v12
  v_pk_mul_f16 v184, v184, v48
  v_or3_b32 v12, v132, v133, v12
  v_or3_b32 v12, v134, v135, v12
  v_pk_mul_f16 v185, v185, v49
  v_mfma_f32_32x32x16_bf16 v[16:31], a[68:71], v[180:183], v[16:31]
  s_waitcnt lgkmcnt(6)
  v_or3_b32 v12, v144, v145, v12
  v_or3_b32 v12, v146, v147, v12
  v_pk_mul_f16 v186, v186, v50
  v_or3_b32 v12, v148, v149, v12
  v_or3_b32 v12, v150, v151, v12
  v_pk_mul_f16 v187, v187, v51
  s_nop 1
  v_mfma_f32_32x32x16_f16 v[64:79], v[192:195], v[184:187], v[64:79]
  s_add_u32 s29, s29, 0x60000
  v_pk_fma_f16 v56, v52, v52, s20 op_sel_hi:[1,1,0]
  v_pk_fma_f16 v57, v53, v53, s20 op_sel_hi:[1,1,0]
  v_pk_fma_f16 v58, v54, v54, s20 op_sel_hi:[1,1,0]
  v_pk_fma_f16 v59, v55, v55, s20 op_sel_hi:[1,1,0]
  v_pk_fma_f16 v56, v56, v56, s20 op_sel:[0,0,1]
  v_pk_fma_f16 v57, v57, v57, s20 op_sel:[0,0,1]
  v_mfma_f32_32x32x16_f16 v[80:95], v[196:199], v[184:187], v[80:95]
  s_add_u32 s52, s52, 0x60000
  v_pk_fma_f16 v58, v58, v58, s20 op_sel:[0,0,1]
  v_pk_fma_f16 v59, v59, v59, s20 op_sel:[0,0,1]
  v_pk_fma_f16 v188, v56, v56, s21 op_sel_hi:[1,1,0]
  v_pk_fma_f16 v189, v57, v57, s21 op_sel_hi:[1,1,0]
  v_pk_fma_f16 v190, v58, v58, s21 op_sel_hi:[1,1,0]
  v_pk_fma_f16 v191, v59, v59, s21 op_sel_hi:[1,1,0]
  v_mfma_f32_32x32x16_f16 v[96:111], v[200:203], v[184:187], v[96:111]
  s_mov_b32 s32, s30
  s_waitcnt vmcnt(0)
  ds_read_b128 a[216:219], v251 offset:24576
  ds_read_b128 a[220:223], v252 offset:24576
  ds_read_b128 a[224:227], v251 offset:24640
  v_pk_fma_f16 v188, v188, v56, s21 op_sel:[0,0,1]
  v_pk_fma_f16 v189, v189, v57, s21 op_sel:[0,0,1]
  v_pk_fma_f16 v190, v190, v58, s21 op_sel:[0,0,1]
  v_pk_fma_f16 v191, v191, v59, s21 op_sel:[0,0,1]
  v_pk_fma_f16 v188, v188, v52, 0.5 op_sel_hi:[1,1,0] clamp
  v_pk_fma_f16 v189, v189, v53, 0.5 op_sel_hi:[1,1,0] clamp
  v_pk_fma_f16 v190, v190, v54, 0.5 op_sel_hi:[1,1,0] clamp
  v_pk_fma_f16 v191, v191, v55, 0.5 op_sel_hi:[1,1,0] clamp
  v_pk_mul_f16 v188, v188, v52
  v_pk_mul_f16 v189, v189, v53
  v_pk_mul_f16 v190, v190, v54
  v_pk_mul_f16 v191, v191, v55
  v_subrev_u32 v11, 0x4100, v4
  s_nop 0
  v_mfma_f32_32x32x16_f16 v[64:79], v[204:207], v[188:191], v[64:79]
  s_add_u32 s30, s33, 32
  ds_read_b128 a[228:231], v252 offset:24640
  ds_read_b128 a[232:235], v251 offset:24704
  ds_read_b128 a[236:239], v252 offset:24704
  v_cvt_pk_f16_f32 v48, v16, v17
  v_cvt_pk_f16_f32 v49, v18, v19
  v_add_u32 v4, 0x8200, v4
  v_mfma_f32_32x32x16_f16 v[80:95], v[208:211], v[188:191], v[80:95]
  s_nop 0
  s_sub_u32 s33, s31, 0
  v_cvt_pk_f16_f32 v50, v20, v21
  v_cvt_pk_f16_f32 v51, v22, v23
  v_cvt_pk_f16_f32 v52, v24, v25
  v_cvt_pk_f16_f32 v53, v26, v27
  v_cvt_pk_f16_f32 v54, v28, v29
  v_min_u32 v4, v11, v4
  v_mfma_f32_32x32x16_f16 v[96:111], v[212:215], v[188:191], v[96:111]
  s_waitcnt lgkmcnt(0)
  v_cvt_pk_f16_f32 v55, v30, v31
  v_pk_fma_f16 v56, v48, v48, s20 op_sel_hi:[1,1,0]
  v_pk_fma_f16 v57, v49, v49, s20 op_sel_hi:[1,1,0]
  v_pk_fma_f16 v58, v50, v50, s20 op_sel_hi:[1,1,0]
  v_pk_fma_f16 v59, v51, v51, s20 op_sel_hi:[1,1,0]
  v_pk_fma_f16 v56, v56, v56, s20 op_sel:[0,0,1]
  v_mfma_f32_32x32x16_bf16 v[112:127], a[216:219], a[192:195], 0
  ds_read_b128 v[192:195], v1 offset:26624
  ds_read_b128 v[196:199], v1 offset:27648
  v_pk_fma_f16 v57, v57, v57, s20 op_sel:[0,0,1]
  v_pk_fma_f16 v58, v58, v58, s20 op_sel:[0,0,1]
  v_pk_fma_f16 v59, v59, v59, s20 op_sel:[0,0,1]
  v_pk_fma_f16 v184, v56, v56, s21 op_sel_hi:[1,1,0]
  v_mfma_f32_32x32x16_bf16 v[112:127], a[220:223], a[196:199], v[112:127]
  ds_read_b128 v[200:203], v1 offset:28672
  ds_read_b128 v[204:207], v1 offset:29696
  v_pk_fma_f16 v185, v57, v57, s21 op_sel_hi:[1,1,0]
  v_pk_fma_f16 v186, v58, v58, s21 op_sel_hi:[1,1,0]
  v_pk_fma_f16 v187, v59, v59, s21 op_sel_hi:[1,1,0]
  v_pk_fma_f16 v184, v184, v56, s21 op_sel:[0,0,1]
  v_mfma_f32_32x32x16_bf16 v[128:143], a[224:227], a[200:203], 0
  ds_read_b128 v[208:211], v1 offset:30720
  ds_read_b128 v[212:215], v1 offset:31744
  v_pk_fma_f16 v185, v185, v57, s21 op_sel:[0,0,1]
  v_pk_fma_f16 v186, v186, v58, s21 op_sel:[0,0,1]
  v_pk_fma_f16 v187, v187, v59, s21 op_sel:[0,0,1]
  v_pk_fma_f16 v184, v184, v48, 0.5 op_sel_hi:[1,1,0] clamp
  v_mfma_f32_32x32x16_bf16 v[128:143], a[228:231], a[204:207], v[128:143]
  v_cvt_pk_f16_f32 v112, v112, v113
  v_cvt_pk_f16_f32 v113, v114, v115
  v_pk_fma_f16 v185, v185, v49, 0.5 op_sel_hi:[1,1,0] clamp
  v_cvt_pk_f16_f32 v114, v116, v117
  v_cvt_pk_f16_f32 v115, v118, v119
  v_pk_fma_f16 v186, v186, v50, 0.5 op_sel_hi:[1,1,0] clamp
  v_mfma_f32_32x32x16_bf16 v[144:159], a[232:235], a[208:211], 0
  ds_write_b128 v253, v[112:115] offset:24576
  v_cvt_pk_f16_f32 v116, v120, v121
  v_cvt_pk_f16_f32 v117, v122, v123
  v_cvt_pk_f16_f32 v118, v124, v125
  v_cvt_pk_f16_f32 v119, v126, v127
  v_mfma_f32_32x32x16_bf16 v[144:159], a[236:239], a[212:215], v[144:159]
  ds_write_b128 v253, v[116:119] offset:27648
  v_cvt_pk_f16_f32 v128, v128, v129
  v_cvt_pk_f16_f32 v129, v130, v131
  v_cvt_pk_f16_f32 v130, v132, v133
  v_cvt_pk_f16_f32 v131, v134, v135
  v_mfma_f32_32x32x16_bf16 v[16:31], a[72:75], v[160:163], 0
  ds_write_b128 v253, v[128:131] offset:25600
  v_cvt_pk_f16_f32 v132, v136, v137
  v_cvt_pk_f16_f32 v133, v138, v139
  v_cvt_pk_f16_f32 v134, v140, v141
  v_cvt_pk_f16_f32 v135, v142, v143
  v_mfma_f32_32x32x16_bf16 v[16:31], a[76:79], v[164:167], v[16:31]
  ds_write_b128 v253, v[132:135] offset:28672
  v_cvt_pk_f16_f32 v144, v144, v145
  v_cvt_pk_f16_f32 v145, v146, v147
  v_cvt_pk_f16_f32 v146, v148, v149
  v_cvt_pk_f16_f32 v147, v150, v151
  v_mfma_f32_32x32x16_bf16 v[16:31], a[80:83], v[168:171], v[16:31]
  ds_write_b128 v253, v[144:147] offset:26624
  v_cvt_pk_f16_f32 v148, v152, v153
  v_cvt_pk_f16_f32 v149, v154, v155
  v_cvt_pk_f16_f32 v150, v156, v157
  v_cvt_pk_f16_f32 v151, v158, v159
  v_mfma_f32_32x32x16_bf16 v[16:31], a[84:87], v[172:175], v[16:31]
  ds_write_b128 v253, v[148:151] offset:29696
  buffer_load_dword v249, v248, s[4:7], s29 offen
  v_or3_b32 v12, v112, v113, v12
  v_or3_b32 v12, v114, v115, v12
  v_or3_b32 v12, v116, v117, v12
  v_or3_b32 v12, v118, v119, v12
  v_mfma_f32_32x32x16_bf16 v[16:31], a[88:91], v[176:179], v[16:31]
  v_or3_b32 v12, v128, v129, v12
  v_or3_b32 v12, v130, v131, v12
  v_pk_fma_f16 v187, v187, v51, 0.5 op_sel_hi:[1,1,0] clamp
  v_or3_b32 v12, v132, v133, v12
  v_or3_b32 v12, v134, v135, v12
  v_pk_mul_f16 v184, v184, v48
  v_mfma_f32_32x32x16_bf16 v[16:31], a[92:95], v[180:183], v[16:31]
  s_waitcnt lgkmcnt(6)
  v_or3_b32 v12, v144, v145, v12
  v_or3_b32 v12, v146, v147, v12
  v_pk_mul_f16 v185, v185, v49
  v_or3_b32 v12, v148, v149, v12
  v_pk_mul_f16 v186, v186, v50
  v_or3_b32 v12, v150, v151, v12
  v_pk_mul_f16 v187, v187, v51
  s_nop 1
  v_mfma_f32_32x32x16_f16 v[64:79], v[192:195], v[184:187], v[64:79]
  ds_read_b128 v[220:223], v4 offset:96
  v_and_b32 v13, 0x40004000, v12
  v_and_b32 v12, 0x30003000, v12
  v_pk_fma_f16 v56, v52, v52, s20 op_sel_hi:[1,1,0]
  v_cmp_ne_u32_e64 vcc, 0, v13
  v_pk_fma_f16 v57, v53, v53, s20 op_sel_hi:[1,1,0]
  v_mfma_f32_32x32x16_f16 v[80:95], v[196:199], v[184:187], v[80:95]
  s_cmp_lg_u64 vcc, 0
  s_cselect_b32 s3, 1, s3
  ds_read_b128 v[228:231], v4 offset:288
  v_cmp_ne_u32_e64 vcc, 0, v12
  v_pk_fma_f16 v58, v54, v54, s20 op_sel_hi:[1,1,0]
  v_lshl_add_u32 v13, s27, 2, v2
  v_pk_fma_f16 v59, v55, v55, s20 op_sel_hi:[1,1,0]
  v_mfma_f32_32x32x16_f16 v[96:111], v[200:203], v[184:187], v[96:111]
  s_cmp_eq_u64 vcc, 0
  s_cselect_b32 s3, 1, s3
  ds_read_b128 v[236:239], v4 offset:480
  v_pk_fma_f16 v56, v56, v56, s20 op_sel:[0,0,1]
  v_pk_fma_f16 v57, v57, v57, s20 op_sel:[0,0,1]
  v_pk_fma_f16 v58, v58, v58, s20 op_sel:[0,0,1]
  v_pk_fma_f16 v59, v59, v59, s20 op_sel:[0,0,1]
  v_pk_fma_f16 v188, v56, v56, s21 op_sel_hi:[1,1,0]
  v_pk_fma_f16 v189, v57, v57, s21 op_sel_hi:[1,1,0]
  v_pk_fma_f16 v190, v58, v58, s21 op_sel_hi:[1,1,0]
  v_pk_fma_f16 v191, v59, v59, s21 op_sel_hi:[1,1,0]
  v_pk_fma_f16 v188, v188, v56, s21 op_sel:[0,0,1]
  v_pk_fma_f16 v189, v189, v57, s21 op_sel:[0,0,1]
  v_pk_fma_f16 v190, v190, v58, s21 op_sel:[0,0,1]
  v_pk_fma_f16 v191, v191, v59, s21 op_sel:[0,0,1]
  v_pk_fma_f16 v188, v188, v52, 0.5 op_sel_hi:[1,1,0] clamp
  v_pk_fma_f16 v189, v189, v53, 0.5 op_sel_hi:[1,1,0] clamp
  v_pk_fma_f16 v190, v190, v54, 0.5 op_sel_hi:[1,1,0] clamp
  v_pk_fma_f16 v191, v191, v55, 0.5 op_sel_hi:[1,1,0] clamp
  v_pk_mul_f16 v188, v188, v52
  v_pk_mul_f16 v189, v189, v53
  v_pk_mul_f16 v190, v190, v54
  v_pk_mul_f16 v191, v191, v55
  v_mov_b32 v12, s3
  s_nop 0
  v_mfma_f32_32x32x16_f16 v[64:79], v[204:207], v[188:191], v[64:79]
  ds_write_b32 v13, v12 offset:384
  v_cvt_pk_f16_f32 v48, v16, v17
  v_cvt_pk_f16_f32 v49, v18, v19
  v_cvt_pk_f16_f32 v50, v20, v21
  v_cvt_pk_f16_f32 v51, v22, v23
  v_mfma_f32_32x32x16_f16 v[80:95], v[208:211], v[188:191], v[80:95]
  v_cvt_pk_f16_f32 v52, v24, v25
  v_cvt_pk_f16_f32 v53, v26, v27
  v_cvt_pk_f16_f32 v54, v28, v29
  v_cvt_pk_f16_f32 v55, v30, v31
  v_pk_fma_f16 v56, v48, v48, s20 op_sel_hi:[1,1,0]
  v_pk_fma_f16 v57, v49, v49, s20 op_sel_hi:[1,1,0]
  v_mfma_f32_32x32x16_f16 v[96:111], v[212:215], v[188:191], v[96:111]
  s_nop 0
  s_waitcnt lgkmcnt(1)
  v_pk_fma_f16 v58, v50, v50, s20 op_sel_hi:[1,1,0]
  v_pk_fma_f16 v59, v51, v51, s20 op_sel_hi:[1,1,0]
  v_pk_fma_f16 v56, v56, v56, s20 op_sel:[0,0,1]
  v_pk_fma_f16 v57, v57, v57, s20 op_sel:[0,0,1]
  v_pk_fma_f16 v58, v58, v58, s20 op_sel:[0,0,1]
  s_waitcnt lgkmcnt(0)
  s_barrier
  v_mfma_f32_32x32x16_bf16 v[16:31], a[96:99], v[160:163], 0
  ds_read_b128 v[192:195], v0 offset:24576
  ds_read_b128 v[196:199], v0 offset:25600
  v_pk_fma_f16 v59, v59, v59, s20 op_sel:[0,0,1]
  v_pk_fma_f16 v184, v56, v56, s21 op_sel_hi:[1,1,0]
  v_pk_fma_f16 v185, v57, v57, s21 op_sel_hi:[1,1,0]
  v_pk_fma_f16 v186, v58, v58, s21 op_sel_hi:[1,1,0]
  v_mfma_f32_16x16x32_bf16 v[136:139], a[240:243], v[220:223], 0
  ds_read_b128 v[216:219], v3 offset:2800
  ds_read_b128 v[220:223], v4 offset:112
  v_mfma_f32_32x32x16_bf16 v[16:31], a[100:103], v[164:167], v[16:31]
  ds_read_b128 v[200:203], v0 offset:26624
  ds_read_b128 v[204:207], v0 offset:27648
  v_pk_fma_f16 v187, v59, v59, s21 op_sel_hi:[1,1,0]
  v_pk_fma_f16 v184, v184, v56, s21 op_sel:[0,0,1]
  v_pk_fma_f16 v185, v185, v57, s21 op_sel:[0,0,1]
  v_pk_fma_f16 v186, v186, v58, s21 op_sel:[0,0,1]
  v_mfma_f32_16x16x32_bf16 v[136:139], a[244:247], v[228:231], v[136:139]
  ds_read_b128 v[224:227], v3 offset:7600
  ds_read_b128 v[228:231], v4 offset:304
  v_mfma_f32_32x32x16_bf16 v[16:31], a[104:107], v[168:171], v[16:31]
  ds_read_b128 v[208:211], v0 offset:28672
  ds_read_b128 v[212:215], v0 offset:29696
  v_pk_fma_f16 v187, v187, v59, s21 op_sel:[0,0,1]
  v_pk_fma_f16 v184, v184, v48, 0.5 op_sel_hi:[1,1,0] clamp
  v_pk_fma_f16 v185, v185, v49, 0.5 op_sel_hi:[1,1,0] clamp
  v_pk_fma_f16 v186, v186, v50, 0.5 op_sel_hi:[1,1,0] clamp
  v_mfma_f32_16x16x32_bf16 v[136:139], a[248:251], v[236:239], v[136:139]
  ds_read_b128 v[232:235], v3 offset:12400
  ds_read_b128 v[236:239], v4 offset:496
  v_mfma_f32_32x32x16_bf16 v[16:31], a[108:111], v[172:175], v[16:31]
  v_pk_fma_f16 v187, v187, v51, 0.5 op_sel_hi:[1,1,0] clamp
  v_pk_mul_f16 v184, v184, v48
  v_pk_mul_f16 v185, v185, v49
  v_pk_mul_f16 v186, v186, v50
  v_pk_mul_f16 v187, v187, v51
  v_pk_fma_f16 v56, v52, v52, s20 op_sel_hi:[1,1,0]
  v_mfma_f32_32x32x16_bf16 v[16:31], a[112:115], v[176:179], v[16:31]
  ds_read_b128 v[12:15], v2 offset:384
  v_pk_fma_f16 v57, v53, v53, s20 op_sel_hi:[1,1,0]
  v_pk_fma_f16 v58, v54, v54, s20 op_sel_hi:[1,1,0]
  v_pk_fma_f16 v59, v55, v55, s20 op_sel_hi:[1,1,0]
  v_pk_fma_f16 v56, v56, v56, s20 op_sel:[0,0,1]
  v_pk_fma_f16 v57, v57, v57, s20 op_sel:[0,0,1]
  v_mfma_f32_32x32x16_bf16 v[16:31], a[116:119], v[180:183], v[16:31]
  s_nop 0
  s_waitcnt lgkmcnt(1)
  v_pk_fma_f16 v58, v58, v58, s20 op_sel:[0,0,1]
  v_pk_fma_f16 v59, v59, v59, s20 op_sel:[0,0,1]
  v_pk_fma_f16 v188, v56, v56, s21 op_sel_hi:[1,1,0]
  v_pk_fma_f16 v189, v57, v57, s21 op_sel_hi:[1,1,0]
  v_pk_fma_f16 v190, v58, v58, s21 op_sel_hi:[1,1,0]
  v_pk_fma_f16 v191, v59, v59, s21 op_sel_hi:[1,1,0]
  v_mfma_f32_32x32x16_f16 v[64:79], v[192:195], v[184:187], v[64:79]
  v_pk_fma_f16 v188, v188, v56, s21 op_sel:[0,0,1]
  v_pk_fma_f16 v189, v189, v57, s21 op_sel:[0,0,1]
  v_pk_fma_f16 v190, v190, v58, s21 op_sel:[0,0,1]
  v_pk_fma_f16 v191, v191, v59, s21 op_sel:[0,0,1]
  v_pk_fma_f16 v188, v188, v52, 0.5 op_sel_hi:[1,1,0] clamp
  v_pk_fma_f16 v189, v189, v53, 0.5 op_sel_hi:[1,1,0] clamp
  v_mfma_f32_16x16x32_bf16 v[140:143], v[216:219], v[220:223], 0
  ds_read_b128 v[220:223], v4 offset:128
  v_pk_fma_f16 v190, v190, v54, 0.5 op_sel_hi:[1,1,0] clamp
  v_mfma_f32_32x32x16_f16 v[80:95], v[196:199], v[184:187], v[80:95]
  v_pk_fma_f16 v191, v191, v55, 0.5 op_sel_hi:[1,1,0] clamp
  v_pk_mul_f16 v188, v188, v52
  v_pk_mul_f16 v189, v189, v53
  v_pk_mul_f16 v190, v190, v54
  v_pk_mul_f16 v191, v191, v55
  v_cvt_pk_f16_f32 v48, v16, v17
  v_mfma_f32_16x16x32_bf16 v[140:143], v[224:227], v[228:231], v[140:143]
  ds_read_b128 v[224:227], v3 offset:8000
  ds_read_b128 v[228:231], v4 offset:320
  v_mfma_f32_32x32x16_f16 v[96:111], v[200:203], v[184:187], v[96:111]
  s_nop 0
  s_sub_u32 s31, s32, 32
  v_cvt_pk_f16_f32 v49, v18, v19
  v_cvt_pk_f16_f32 v50, v20, v21
  v_cvt_pk_f16_f32 v51, v22, v23
  v_cvt_pk_f16_f32 v52, v24, v25
  v_cvt_pk_f16_f32 v53, v26, v27
  v_cvt_pk_f16_f32 v54, v28, v29
  v_mfma_f32_16x16x32_bf16 v[140:143], v[232:235], v[236:239], v[140:143]
  ds_read_b128 v[232:235], v3 offset:12800
  ds_read_b128 v[236:239], v4 offset:512
  v_mfma_f32_32x32x16_f16 v[64:79], v[204:207], v[188:191], v[64:79]
  s_waitcnt lgkmcnt(5)
  v_or3_b32 v12, v12, v13, v14
  v_cvt_pk_f16_f32 v55, v30, v31
  v_or_b32 v12, v12, v15
  v_pk_fma_f16 v56, v48, v48, s20 op_sel_hi:[1,1,0]
  v_cmp_ne_u32 vcc, 0, v12
  v_pk_fma_f16 v57, v49, v49, s20 op_sel_hi:[1,1,0]
  v_mfma_f32_32x32x16_f16 v[80:95], v[208:211], v[188:191], v[80:95]
  s_cbranch_vccnz L_slow
  v_pk_fma_f16 v58, v50, v50, s20 op_sel_hi:[1,1,0]
  v_pk_fma_f16 v59, v51, v51, s20 op_sel_hi:[1,1,0]
  v_pk_fma_f16 v56, v56, v56, s20 op_sel:[0,0,1]
  v_pk_fma_f16 v57, v57, v57, s20 op_sel:[0,0,1]
  v_pk_fma_f16 v58, v58, v58, s20 op_sel:[0,0,1]
  v_mfma_f32_32x32x16_f16 v[96:111], v[212:215], v[188:191], v[96:111]
  s_nop 0
  s_waitcnt lgkmcnt(0)
  v_pk_fma_f16 v59, v59, v59, s20 op_sel:[0,0,1]
  v_pk_fma_f16 v184, v56, v56, s21 op_sel_hi:[1,1,0]
  v_pk_fma_f16 v185, v57, v57, s21 op_sel_hi:[1,1,0]
  v_pk_fma_f16 v186, v58, v58, s21 op_sel_hi:[1,1,0]
  v_pk_fma_f16 v187, v59, v59, s21 op_sel_hi:[1,1,0]
  v_pk_fma_f16 v184, v184, v56, s21 op_sel:[0,0,1]
  v_mfma_f32_32x32x16_bf16 v[16:31], a[120:123], v[160:163], 0
  ds_read_b128 v[192:195], v0 offset:30720
  ds_read_b128 v[196:199], v0 offset:31744
  v_pk_fma_f16 v185, v185, v57, s21 op_sel:[0,0,1]
  v_pk_fma_f16 v186, v186, v58, s21 op_sel:[0,0,1]
  v_pk_fma_f16 v187, v187, v59, s21 op_sel:[0,0,1]
  v_pk_fma_f16 v184, v184, v48, 0.5 op_sel_hi:[1,1,0] clamp
  v_mfma_f32_16x16x32_bf16 v[144:147], a[252:255], v[220:223], 0
  ds_read_b128 v[216:219], v3 offset:3600
  ds_read_b128 v[220:223], v4 offset:144
  v_mfma_f32_32x32x16_bf16 v[16:31], a[124:127], v[164:167], v[16:31]
  ds_read_b128 v[200:203], v0 offset:32768
  ds_read_b128 v[204:207], v0 offset:33792
  v_pk_fma_f16 v185, v185, v49, 0.5 op_sel_hi:[1,1,0] clamp
  v_pk_fma_f16 v186, v186, v50, 0.5 op_sel_hi:[1,1,0] clamp
  v_pk_fma_f16 v187, v187, v51, 0.5 op_sel_hi:[1,1,0] clamp
  v_pk_mul_f16 v184, v184, v48
  v_mfma_f32_16x16x32_bf16 v[144:147], v[224:227], v[228:231], v[144:147]
  ds_read_b128 v[224:227], v3 offset:8400
  ds_read_b128 v[228:231], v4 offset:336
  v_mfma_f32_32x32x16_bf16 v[16:31], a[128:131], v[168:171], v[16:31]
  ds_read_b128 v[208:211], v0 offset:34816
  ds_read_b128 v[212:215], v0 offset:35840
  v_pk_mul_f16 v185, v185, v49
  v_pk_mul_f16 v186, v186, v50
  v_pk_mul_f16 v187, v187, v51
  v_pk_fma_f16 v56, v52, v52, s20 op_sel_hi:[1,1,0]
  v_mfma_f32_16x16x32_bf16 v[144:147], v[232:235], v[236:239], v[144:147]
  ds_read_b128 v[232:235], v3 offset:13200
  ds_read_b128 v[236:239], v4 offset:528
  v_mfma_f32_32x32x16_bf16 v[16:31], a[132:135], v[172:175], v[16:31]
  v_pk_fma_f16 v57, v53, v53, s20 op_sel_hi:[1,1,0]
  v_pk_fma_f16 v58, v54, v54, s20 op_sel_hi:[1,1,0]
  v_pk_fma_f16 v59, v55, v55, s20 op_sel_hi:[1,1,0]
  v_pk_fma_f16 v56, v56, v56, s20 op_sel:[0,0,1]
  v_pk_fma_f16 v57, v57, v57, s20 op_sel:[0,0,1]
  v_pk_fma_f16 v58, v58, v58, s20 op_sel:[0,0,1]
  v_mfma_f32_32x32x16_bf16 v[16:31], a[136:139], v[176:179], v[16:31]
  ds_read_b128 a[192:195], v0
  ds_read_b128 a[196:199], v0 offset:1024
  ds_read_b128 a[200:203], v0 offset:2048
  v_pk_fma_f16 v59, v59, v59, s20 op_sel:[0,0,1]
  v_pk_fma_f16 v188, v56, v56, s21 op_sel_hi:[1,1,0]
  v_pk_fma_f16 v189, v57, v57, s21 op_sel_hi:[1,1,0]
  v_mfma_f32_32x32x16_bf16 v[16:31], a[140:143], v[180:183], v[16:31]
  s_nop 0
  s_waitcnt lgkmcnt(3)
  v_pk_fma_f16 v190, v58, v58, s21 op_sel_hi:[1,1,0]
  v_pk_fma_f16 v191, v59, v59, s21 op_sel_hi:[1,1,0]
  v_pk_fma_f16 v188, v188, v56, s21 op_sel:[0,0,1]
  v_pk_fma_f16 v189, v189, v57, s21 op_sel:[0,0,1]
  v_pk_fma_f16 v190, v190, v58, s21 op_sel:[0,0,1]
  v_pk_fma_f16 v191, v191, v59, s21 op_sel:[0,0,1]
  v_mfma_f32_32x32x16_f16 v[64:79], v[192:195], v[184:187], v[64:79]
  v_pk_fma_f16 v188, v188, v52, 0.5 op_sel_hi:[1,1,0] clamp
  v_pk_fma_f16 v189, v189, v53, 0.5 op_sel_hi:[1,1,0] clamp
  v_pk_fma_f16 v190, v190, v54, 0.5 op_sel_hi:[1,1,0] clamp
  v_pk_fma_f16 v191, v191, v55, 0.5 op_sel_hi:[1,1,0] clamp
  v_pk_mul_f16 v188, v188, v52
  v_pk_mul_f16 v189, v189, v53
  v_mfma_f32_16x16x32_bf16 v[148:151], v[216:219], v[220:223], 0
  ds_read_b128 v[216:219], v3 offset:4000
  ds_read_b128 v[220:223], v4 offset:160
  v_mfma_f32_32x32x16_f16 v[80:95], v[196:199], v[184:187], v[80:95]
  v_pk_mul_f16 v190, v190, v54
  v_pk_mul_f16 v191, v191, v55
  v_cvt_pk_f16_f32 v48, v16, v17
  v_cvt_pk_f16_f32 v49, v18, v19
  v_cvt_pk_f16_f32 v50, v20, v21
  v_cvt_pk_f16_f32 v51, v22, v23
  v_mfma_f32_16x16x32_bf16 v[148:151], v[224:227], v[228:231], v[148:151]
  ds_read_b128 v[224:227], v3 offset:8800
  ds_read_b128 v[228:231], v4 offset:352
  v_mfma_f32_32x32x16_f16 v[96:111], v[200:203], v[184:187], v[96:111]
  v_cvt_pk_f16_f32 v52, v24, v25
  v_cvt_pk_f16_f32 v53, v26, v27
  v_cvt_pk_f16_f32 v54, v28, v29
  v_cvt_pk_f16_f32 v55, v30, v31
  v_pk_fma_f16 v56, v48, v48, s20 op_sel_hi:[1,1,0]
  v_pk_fma_f16 v57, v49, v49, s20 op_sel_hi:[1,1,0]
  v_mfma_f32_16x16x32_bf16 v[148:151], v[232:235], v[236:239], v[148:151]
  ds_read_b128 v[232:235], v3 offset:13600
  ds_read_b128 v[236:239], v4 offset:544
  v_mfma_f32_32x32x16_f16 v[64:79], v[204:207], v[188:191], v[64:79]
  v_pk_fma_f16 v58, v50, v50, s20 op_sel_hi:[1,1,0]
  v_pk_fma_f16 v59, v51, v51, s20 op_sel_hi:[1,1,0]
  v_pk_fma_f16 v56, v56, v56, s20 op_sel:[0,0,1]
  v_pk_fma_f16 v57, v57, v57, s20 op_sel:[0,0,1]
  v_pk_fma_f16 v58, v58, v58, s20 op_sel:[0,0,1]
  v_pk_fma_f16 v59, v59, v59, s20 op_sel:[0,0,1]
  v_mfma_f32_32x32x16_f16 v[80:95], v[208:211], v[188:191], v[80:95]
  ds_read_b128 a[204:207], v0 offset:3072
  ds_read_b128 a[208:211], v0 offset:4096
  ds_read_b128 a[212:215], v0 offset:5120
  v_pk_fma_f16 v184, v56, v56, s21 op_sel_hi:[1,1,0]
  v_pk_fma_f16 v185, v57, v57, s21 op_sel_hi:[1,1,0]
  v_pk_fma_f16 v186, v58, v58, s21 op_sel_hi:[1,1,0]
  v_mfma_f32_32x32x16_f16 v[96:111], v[212:215], v[188:191], v[96:111]
  s_nop 0
  s_waitcnt lgkmcnt(3)
  v_pk_fma_f16 v187, v59, v59, s21 op_sel_hi:[1,1,0]
  v_pk_fma_f16 v184, v184, v56, s21 op_sel:[0,0,1]
  v_pk_fma_f16 v185, v185, v57, s21 op_sel:[0,0,1]
  v_pk_fma_f16 v186, v186, v58, s21 op_sel:[0,0,1]
  v_pk_fma_f16 v187, v187, v59, s21 op_sel:[0,0,1]
  v_pk_fma_f16 v184, v184, v48, 0.5 op_sel_hi:[1,1,0] clamp
  v_mfma_f32_32x32x16_bf16 v[16:31], a[144:147], v[160:163], 0
  ds_read_b128 v[192:195], v0 offset:36864
  ds_read_b128 v[196:199], v0 offset:37888
  v_pk_fma_f16 v185, v185, v49, 0.5 op_sel_hi:[1,1,0] clamp
  v_pk_fma_f16 v186, v186, v50, 0.5 op_sel_hi:[1,1,0] clamp
  v_pk_fma_f16 v187, v187, v51, 0.5 op_sel_hi:[1,1,0] clamp
  v_pk_mul_f16 v184, v184, v48
  v_mfma_f32_16x16x32_bf16 v[152:155], v[216:219], v[220:223], 0
  ds_read_b128 v[216:219], v3 offset:4400
  ds_read_b128 v[220:223], v4 offset:176
  v_mfma_f32_32x32x16_bf16 v[16:31], a[148:151], v[164:167], v[16:31]
  ds_read_b128 v[200:203], v0 offset:38912
  ds_read_b128 v[204:207], v0 offset:39936
  v_pk_mul_f16 v185, v185, v49
  v_pk_mul_f16 v186, v186, v50
  v_pk_mul_f16 v187, v187, v51
  v_pk_fma_f16 v56, v52, v52, s20 op_sel_hi:[1,1,0]
  v_mfma_f32_16x16x32_bf16 v[152:155], v[224:227], v[228:231], v[152:155]
  ds_read_b128 v[224:227], v3 offset:9200
  ds_read_b128 v[228:231], v4 offset:368
  v_mfma_f32_32x32x16_bf16 v[16:31], a[152:155], v[168:171], v[16:31]
  ds_read_b128 v[208:211], v0 offset:40960
  ds_read_b128 v[212:215], v0 offset:41984
  v_pk_fma_f16 v57, v53, v53, s20 op_sel_hi:[1,1,0]
  v_pk_fma_f16 v58, v54, v54, s20 op_sel_hi:[1,1,0]
  v_pk_fma_f16 v59, v55, v55, s20 op_sel_hi:[1,1,0]
  v_pk_fma_f16 v56, v56, v56, s20 op_sel:[0,0,1]
  v_mfma_f32_16x16x32_bf16 v[152:155], v[232:235], v[236:239], v[152:155]
  ds_read_b128 v[232:235], v3 offset:14000
  ds_read_b128 v[236:239], v4 offset:560
  v_mfma_f32_32x32x16_bf16 v[16:31], a[156:159], v[172:175], v[16:31]
  v_pk_fma_f16 v57, v57, v57, s20 op_sel:[0,0,1]
  v_pk_fma_f16 v58, v58, v58, s20 op_sel:[0,0,1]
  v_pk_fma_f16 v59, v59, v59, s20 op_sel:[0,0,1]
  v_pk_fma_f16 v188, v56, v56, s21 op_sel_hi:[1,1,0]
  v_pk_fma_f16 v189, v57, v57, s21 op_sel_hi:[1,1,0]
  v_pk_fma_f16 v190, v58, v58, s21 op_sel_hi:[1,1,0]
  v_mfma_f32_32x32x16_bf16 v[16:31], a[160:163], v[176:179], v[16:31]
  ds_read_b128 a[216:219], v0 offset:6144
  ds_read_b128 a[220:223], v0 offset:7168
  ds_read_b128 a[224:227], v0 offset:8192
  v_pk_fma_f16 v191, v59, v59, s21 op_sel_hi:[1,1,0]
  v_pk_fma_f16 v188, v188, v56, s21 op_sel:[0,0,1]
  v_pk_fma_f16 v189, v189, v57, s21 op_sel:[0,0,1]
  v_mfma_f32_32x32x16_bf16 v[16:31], a[164:167], v[180:183], v[16:31]
  s_nop 0
  s_waitcnt lgkmcnt(3)
  v_pk_fma_f16 v190, v190, v58, s21 op_sel:[0,0,1]
  v_pk_fma_f16 v191, v191, v59, s21 op_sel:[0,0,1]
  v_pk_fma_f16 v188, v188, v52, 0.5 op_sel_hi:[1,1,0] clamp
  v_pk_fma_f16 v189, v189, v53, 0.5 op_sel_hi:[1,1,0] clamp
  v_pk_fma_f16 v190, v190, v54, 0.5 op_sel_hi:[1,1,0] clamp
  v_pk_fma_f16 v191, v191, v55, 0.5 op_sel_hi:[1,1,0] clamp
  v_mfma_f32_32x32x16_f16 v[64:79], v[192:195], v[184:187], v[64:79]
  v_pk_mul_f16 v188, v188, v52
  v_pk_mul_f16 v189, v189, v53
  v_add_f32_e64 v12, v136, v138
  v_pk_mul_f16 v190, v190, v54
  v_pk_mul_f16 v191, v191, v55
  v_add_f32_e64 v13, v137, v139
  v_mfma_f32_16x16x32_bf16 v[156:159], v[216:219], v[220:223], 0
  ds_read_b128 v[216:219], v3
  ds_read_b128 v[220:223], v4
  v_mfma_f32_32x32x16_f16 v[80:95], v[196:199], v[184:187], v[80:95]
  v_cvt_pk_f16_f32 v48, v16, v17
  v_cvt_pk_f16_f32 v49, v18, v19
  v_cvt_pk_f16_f32 v50, v20, v21
  v_cvt_pk_f16_f32 v51, v22, v23
  v_cvt_pk_f16_f32 v52, v24, v25
  v_cvt_pk_f16_f32 v53, v26, v27
  v_mfma_f32_16x16x32_bf16 v[156:159], v[224:227], v[228:231], v[156:159]
  ds_read_b128 v[224:227], v3 offset:4800
  ds_read_b128 v[228:231], v4 offset:192
  v_mfma_f32_32x32x16_f16 v[96:111], v[200:203], v[184:187], v[96:111]
  v_cvt_pk_f16_f32 v54, v28, v29
  v_cvt_pk_f16_f32 v55, v30, v31
  v_pk_fma_f16 v56, v48, v48, s20 op_sel_hi:[1,1,0]
  v_pk_fma_f16 v57, v49, v49, s20 op_sel_hi:[1,1,0]
  v_pk_fma_f16 v58, v50, v50, s20 op_sel_hi:[1,1,0]
  v_pk_fma_f16 v59, v51, v51, s20 op_sel_hi:[1,1,0]
  v_mfma_f32_16x16x32_bf16 v[156:159], v[232:235], v[236:239], v[156:159]
  ds_read_b128 v[232:235], v3 offset:9600
  ds_read_b128 v[236:239], v4 offset:384
  v_mfma_f32_32x32x16_f16 v[64:79], v[204:207], v[188:191], v[64:79]
  v_pk_fma_f16 v56, v56, v56, s20 op_sel:[0,0,1]
  v_pk_fma_f16 v57, v57, v57, s20 op_sel:[0,0,1]
  v_pk_fma_f16 v58, v58, v58, s20 op_sel:[0,0,1]
  v_pk_fma_f16 v59, v59, v59, s20 op_sel:[0,0,1]
  v_pk_fma_f16 v184, v56, v56, s21 op_sel_hi:[1,1,0]
  v_pk_fma_f16 v185, v57, v57, s21 op_sel_hi:[1,1,0]
  v_mfma_f32_32x32x16_f16 v[80:95], v[208:211], v[188:191], v[80:95]
  ds_read_b128 a[228:231], v0 offset:9216
  ds_read_b128 a[232:235], v0 offset:10240
  ds_read_b128 a[236:239], v0 offset:11264
  v_pk_fma_f16 v186, v58, v58, s21 op_sel_hi:[1,1,0]
  v_pk_fma_f16 v187, v59, v59, s21 op_sel_hi:[1,1,0]
  v_pk_fma_f16 v184, v184, v56, s21 op_sel:[0,0,1]
  v_mfma_f32_32x32x16_f16 v[96:111], v[212:215], v[188:191], v[96:111]
  s_nop 0
  s_waitcnt lgkmcnt(3)
  v_pk_fma_f16 v185, v185, v57, s21 op_sel:[0,0,1]
  v_pk_fma_f16 v186, v186, v58, s21 op_sel:[0,0,1]
  v_pk_fma_f16 v187, v187, v59, s21 op_sel:[0,0,1]
  v_pk_fma_f16 v184, v184, v48, 0.5 op_sel_hi:[1,1,0] clamp
  v_pk_fma_f16 v185, v185, v49, 0.5 op_sel_hi:[1,1,0] clamp
  v_pk_fma_f16 v186, v186, v50, 0.5 op_sel_hi:[1,1,0] clamp
  v_mfma_f32_32x32x16_bf16 v[16:31], a[168:171], v[160:163], 0
  ds_read_b128 v[192:195], v0 offset:43008
  ds_read_b128 v[196:199], v0 offset:44032
  v_pk_fma_f16 v187, v187, v51, 0.5 op_sel_hi:[1,1,0] clamp
  v_pk_mul_f16 v184, v184, v48
  v_pk_mul_f16 v185, v185, v49
  v_pk_mul_f16 v186, v186, v50
  v_mfma_f32_16x16x32_bf16 v[112:115], v[216:219], v[220:223], 0
  ds_read_b128 v[216:219], v3 offset:400
  ds_read_b128 v[220:223], v4 offset:16
  v_mfma_f32_32x32x16_bf16 v[16:31], a[172:175], v[164:167], v[16:31]
  ds_read_b128 v[200:203], v0 offset:45056
  ds_read_b128 v[204:207], v0 offset:46080
  v_pk_mul_f16 v187, v187, v51
  v_pk_fma_f16 v56, v52, v52, s20 op_sel_hi:[1,1,0]
  v_pk_fma_f16 v57, v53, v53, s20 op_sel_hi:[1,1,0]
  v_pk_fma_f16 v58, v54, v54, s20 op_sel_hi:[1,1,0]
  v_mfma_f32_16x16x32_bf16 v[112:115], v[224:227], v[228:231], v[112:115]
  ds_read_b128 v[224:227], v3 offset:5200
  ds_read_b128 v[228:231], v4 offset:208
  v_mfma_f32_32x32x16_bf16 v[16:31], a[176:179], v[168:171], v[16:31]
  ds_read_b128 v[208:211], v0 offset:47104
  ds_read_b128 v[212:215], v0 offset:48128
  v_pk_fma_f16 v59, v55, v55, s20 op_sel_hi:[1,1,0]
  v_pk_fma_f16 v56, v56, v56, s20 op_sel:[0,0,1]
  v_pk_fma_f16 v57, v57, v57, s20 op_sel:[0,0,1]
  v_pk_fma_f16 v58, v58, v58, s20 op_sel:[0,0,1]
  v_mfma_f32_16x16x32_bf16 v[112:115], v[232:235], v[236:239], v[112:115]
  ds_read_b128 v[232:235], v3 offset:10000
  ds_read_b128 v[236:239], v4 offset:400
  v_mfma_f32_32x32x16_bf16 v[16:31], a[180:183], v[172:175], v[16:31]
  v_pk_fma_f16 v59, v59, v59, s20 op_sel:[0,0,1]
  v_pk_fma_f16 v188, v56, v56, s21 op_sel_hi:[1,1,0]
  v_pk_fma_f16 v189, v57, v57, s21 op_sel_hi:[1,1,0]
  v_pk_fma_f16 v190, v58, v58, s21 op_sel_hi:[1,1,0]
  v_pk_fma_f16 v191, v59, v59, s21 op_sel_hi:[1,1,0]
  v_pk_fma_f16 v188, v188, v56, s21 op_sel:[0,0,1]
  v_mfma_f32_32x32x16_bf16 v[16:31], a[184:187], v[176:179], v[16:31]
  ds_read_b128 v[32:35], v0 offset:12288
  ds_read_b128 v[36:39], v0 offset:13312
  ds_read_b128 v[40:43], v0 offset:14336
  v_pk_fma_f16 v189, v189, v57, s21 op_sel:[0,0,1]
  v_pk_fma_f16 v190, v190, v58, s21 op_sel:[0,0,1]
  v_pk_fma_f16 v191, v191, v59, s21 op_sel:[0,0,1]
  v_mfma_f32_32x32x16_bf16 v[16:31], a[188:191], v[180:183], v[16:31]
  s_nop 0
  s_waitcnt lgkmcnt(3)
  v_pk_fma_f16 v188, v188, v52, 0.5 op_sel_hi:[1,1,0] clamp
  v_pk_fma_f16 v189, v189, v53, 0.5 op_sel_hi:[1,1,0] clamp
  v_pk_fma_f16 v190, v190, v54, 0.5 op_sel_hi:[1,1,0] clamp
  v_pk_fma_f16 v191, v191, v55, 0.5 op_sel_hi:[1,1,0] clamp
  v_pk_mul_f16 v188, v188, v52
  v_pk_mul_f16 v189, v189, v53
  v_mfma_f32_32x32x16_f16 v[64:79], v[192:195], v[184:187], v[64:79]
  v_mul_f32 v14, v136, v136
  v_mul_f32 v15, v137, v137
  v_pk_mul_f16 v190, v190, v54
  v_fmac_f32 v14, v138, v138
  v_fmac_f32 v15, v139, v139
  v_pk_mul_f16 v191, v191, v55
  v_mfma_f32_16x16x32_bf16 v[116:119], v[216:219], v[220:223], 0
  ds_read_b128 v[216:219], v3 offset:800
  ds_read_b128 v[220:223], v4 offset:32
  v_mfma_f32_32x32x16_f16 v[80:95], v[196:199], v[184:187], v[80:95]
  v_cvt_pk_f16_f32 v48, v16, v17
  v_cvt_pk_f16_f32 v49, v18, v19
  v_cvt_pk_f16_f32 v50, v20, v21
  v_cvt_pk_f16_f32 v51, v22, v23
  v_cvt_pk_f16_f32 v52, v24, v25
  v_cvt_pk_f16_f32 v53, v26, v27
  v_mfma_f32_16x16x32_bf16 v[116:119], v[224:227], v[228:231], v[116:119]
  ds_read_b128 v[224:227], v3 offset:5600
  ds_read_b128 v[228:231], v4 offset:224
  v_mfma_f32_32x32x16_f16 v[96:111], v[200:203], v[184:187], v[96:111]
  v_cvt_pk_f16_f32 v54, v28, v29
  v_cvt_pk_f16_f32 v55, v30, v31
  v_pk_fma_f16 v56, v48, v48, s20 op_sel_hi:[1,1,0]
  v_pk_fma_f16 v57, v49, v49, s20 op_sel_hi:[1,1,0]
  v_pk_fma_f16 v58, v50, v50, s20 op_sel_hi:[1,1,0]
  v_pk_fma_f16 v59, v51, v51, s20 op_sel_hi:[1,1,0]
  v_mfma_f32_16x16x32_bf16 v[116:119], v[232:235], v[236:239], v[116:119]
  ds_read_b128 v[232:235], v3 offset:10400
  ds_read_b128 v[236:239], v4 offset:416
  v_mfma_f32_32x32x16_f16 v[64:79], v[204:207], v[188:191], v[64:79]
  v_pk_fma_f16 v56, v56, v56, s20 op_sel:[0,0,1]
  v_pk_fma_f16 v57, v57, v57, s20 op_sel:[0,0,1]
  v_pk_fma_f16 v58, v58, v58, s20 op_sel:[0,0,1]
  v_pk_fma_f16 v59, v59, v59, s20 op_sel:[0,0,1]
  v_pk_fma_f16 v184, v56, v56, s21 op_sel_hi:[1,1,0]
  v_pk_fma_f16 v185, v57, v57, s21 op_sel_hi:[1,1,0]
  v_mfma_f32_32x32x16_f16 v[80:95], v[208:211], v[188:191], v[80:95]
  ds_read_b128 v[44:47], v0 offset:15360
  ds_read_b128 v[60:63], v0 offset:16384
  v_pk_fma_f16 v186, v58, v58, s21 op_sel_hi:[1,1,0]
  v_pk_fma_f16 v187, v59, v59, s21 op_sel_hi:[1,1,0]
  v_pk_fma_f16 v184, v184, v56, s21 op_sel:[0,0,1]
  v_pk_fma_f16 v185, v185, v57, s21 op_sel:[0,0,1]
  v_mfma_f32_32x32x16_f16 v[96:111], v[212:215], v[188:191], v[96:111]
  s_nop 0
  s_waitcnt lgkmcnt(2)
  v_pk_fma_f16 v186, v186, v58, s21 op_sel:[0,0,1]
  v_pk_fma_f16 v187, v187, v59, s21 op_sel:[0,0,1]
  v_pk_fma_f16 v184, v184, v48, 0.5 op_sel_hi:[1,1,0] clamp
  v_pk_fma_f16 v185, v185, v49, 0.5 op_sel_hi:[1,1,0] clamp
  v_pk_fma_f16 v186, v186, v50, 0.5 op_sel_hi:[1,1,0] clamp
  v_pk_fma_f16 v187, v187, v51, 0.5 op_sel_hi:[1,1,0] clamp
  v_mfma_f32_32x32x16_bf16 v[16:31], a[192:195], v[160:163], 0
  ds_read_b128 v[192:195], v0 offset:49152
  ds_read_b128 v[196:199], v0 offset:50176
  v_pk_mul_f16 v184, v184, v48
  v_pk_mul_f16 v185, v185, v49
  v_pk_mul_f16 v186, v186, v50
  v_pk_mul_f16 v187, v187, v51
  v_mfma_f32_16x16x32_bf16 v[120:123], v[216:219], v[220:223], 0
  ds_read_b128 v[216:219], v3 offset:1200
  ds_read_b128 v[220:223], v4 offset:48
  v_mfma_f32_32x32x16_bf16 v[16:31], a[196:199], v[164:167], v[16:31]
  ds_read_b128 v[200:203], v0 offset:51200
  ds_read_b128 v[204:207], v0 offset:52224
  v_pk_fma_f16 v56, v52, v52, s20 op_sel_hi:[1,1,0]
  v_pk_fma_f16 v57, v53, v53, s20 op_sel_hi:[1,1,0]
  v_pk_fma_f16 v58, v54, v54, s20 op_sel_hi:[1,1,0]
  v_pk_fma_f16 v59, v55, v55, s20 op_sel_hi:[1,1,0]
  v_mfma_f32_16x16x32_bf16 v[120:123], v[224:227], v[228:231], v[120:123]
  ds_read_b128 v[224:227], v3 offset:6000
  ds_read_b128 v[228:231], v4 offset:240
  v_mfma_f32_32x32x16_bf16 v[16:31], a[200:203], v[168:171], v[16:31]
  ds_read_b128 v[208:211], v0 offset:53248
  ds_read_b128 v[212:215], v0 offset:54272
  v_pk_fma_f16 v56, v56, v56, s20 op_sel:[0,0,1]
  v_pk_fma_f16 v57, v57, v57, s20 op_sel:[0,0,1]
  v_pk_fma_f16 v58, v58, v58, s20 op_sel:[0,0,1]
  v_pk_fma_f16 v59, v59, v59, s20 op_sel:[0,0,1]
  v_mfma_f32_16x16x32_bf16 v[120:123], v[232:235], v[236:239], v[120:123]
  ds_read_b128 v[232:235], v3 offset:10800
  ds_read_b128 v[236:239], v4 offset:432
  v_mfma_f32_32x32x16_bf16 v[16:31], a[204:207], v[172:175], v[16:31]
  v_pk_fma_f16 v188, v56, v56, s21 op_sel_hi:[1,1,0]
  v_pk_fma_f16 v189, v57, v57, s21 op_sel_hi:[1,1,0]
  v_pk_fma_f16 v190, v58, v58, s21 op_sel_hi:[1,1,0]
  v_pk_fma_f16 v191, v59, v59, s21 op_sel_hi:[1,1,0]
  v_pk_fma_f16 v188, v188, v56, s21 op_sel:[0,0,1]
  v_pk_fma_f16 v189, v189, v57, s21 op_sel:[0,0,1]
  v_mfma_f32_32x32x16_bf16 v[16:31], a[208:211], v[176:179], v[16:31]
  v_add_f32 v12, v12, v140
  v_add_f32 v13, v13, v141
  v_pk_fma_f16 v190, v190, v58, s21 op_sel:[0,0,1]
  v_fmac_f32_e64 v14, v140, v140
  v_fmac_f32 v15, v141, v141
  v_pk_fma_f16 v191, v191, v59, s21 op_sel:[0,0,1]
  v_mfma_f32_32x32x16_bf16 v[16:31], a[212:215], v[180:183], v[16:31]
  s_waitcnt lgkmcnt(0)
  v_pk_fma_f16 v188, v188, v52, 0.5 op_sel_hi:[1,1,0] clamp
  v_pk_fma_f16 v189, v189, v53, 0.5 op_sel_hi:[1,1,0] clamp
  v_pk_fma_f16 v190, v190, v54, 0.5 op_sel_hi:[1,1,0] clamp
  v_pk_fma_f16 v191, v191, v55, 0.5 op_sel_hi:[1,1,0] clamp
  v_pk_mul_f16 v188, v188, v52
  v_pk_mul_f16 v189, v189, v53
  v_mfma_f32_32x32x16_f16 v[64:79], v[192:195], v[184:187], v[64:79]
  v_add_f32 v12, v12, v142
  v_add_f32 v13, v13, v143
  v_pk_mul_f16 v190, v190, v54
  v_fmac_f32 v14, v142, v142
  v_fmac_f32 v15, v143, v143
  v_pk_mul_f16 v191, v191, v55
  v_mfma_f32_16x16x32_bf16 v[124:127], v[216:219], v[220:223], 0
  ds_read_b128 v[216:219], v3 offset:1600
  ds_read_b128 v[220:223], v4 offset:64
  v_mfma_f32_32x32x16_f16 v[80:95], v[196:199], v[184:187], v[80:95]
  v_cvt_pk_f16_f32 v48, v16, v17
  v_cvt_pk_f16_f32 v49, v18, v19
  v_cvt_pk_f16_f32 v50, v20, v21
  v_cvt_pk_f16_f32 v51, v22, v23
  v_cvt_pk_f16_f32 v52, v24, v25
  v_cvt_pk_f16_f32 v53, v26, v27
  v_mfma_f32_16x16x32_bf16 v[124:127], v[224:227], v[228:231], v[124:127]
  ds_read_b128 v[224:227], v3 offset:6400
  ds_read_b128 v[228:231], v4 offset:256
  v_mfma_f32_32x32x16_f16 v[96:111], v[200:203], v[184:187], v[96:111]
  v_cvt_pk_f16_f32 v54, v28, v29
  v_cvt_pk_f16_f32 v55, v30, v31
  v_pk_fma_f16 v56, v48, v48, s20 op_sel_hi:[1,1,0]
  v_pk_fma_f16 v57, v49, v49, s20 op_sel_hi:[1,1,0]
  v_pk_fma_f16 v58, v50, v50, s20 op_sel_hi:[1,1,0]
  v_pk_fma_f16 v59, v51, v51, s20 op_sel_hi:[1,1,0]
  v_mfma_f32_16x16x32_bf16 v[124:127], v[232:235], v[236:239], v[124:127]
  ds_read_b128 v[232:235], v3 offset:11200
  ds_read_b128 v[236:239], v4 offset:448
  v_mfma_f32_32x32x16_f16 v[64:79], v[204:207], v[188:191], v[64:79]
  v_pk_fma_f16 v56, v56, v56, s20 op_sel:[0,0,1]
  v_pk_fma_f16 v57, v57, v57, s20 op_sel:[0,0,1]
  v_pk_fma_f16 v58, v58, v58, s20 op_sel:[0,0,1]
  v_pk_fma_f16 v59, v59, v59, s20 op_sel:[0,0,1]
  v_pk_fma_f16 v184, v56, v56, s21 op_sel_hi:[1,1,0]
  v_pk_fma_f16 v185, v57, v57, s21 op_sel_hi:[1,1,0]
  v_mfma_f32_32x32x16_f16 v[80:95], v[208:211], v[188:191], v[80:95]
  v_pk_fma_f16 v186, v58, v58, s21 op_sel_hi:[1,1,0]
  v_pk_fma_f16 v187, v59, v59, s21 op_sel_hi:[1,1,0]
  v_pk_fma_f16 v184, v184, v56, s21 op_sel:[0,0,1]
  v_pk_fma_f16 v185, v185, v57, s21 op_sel:[0,0,1]
  v_pk_fma_f16 v186, v186, v58, s21 op_sel:[0,0,1]
  v_pk_fma_f16 v187, v187, v59, s21 op_sel:[0,0,1]
  v_mfma_f32_32x32x16_f16 v[96:111], v[212:215], v[188:191], v[96:111]
  s_nop 0
  s_waitcnt lgkmcnt(0)
  v_pk_fma_f16 v184, v184, v48, 0.5 op_sel_hi:[1,1,0] clamp
  v_pk_fma_f16 v185, v185, v49, 0.5 op_sel_hi:[1,1,0] clamp
  v_pk_fma_f16 v186, v186, v50, 0.5 op_sel_hi:[1,1,0] clamp
  v_pk_fma_f16 v187, v187, v51, 0.5 op_sel_hi:[1,1,0] clamp
  v_pk_mul_f16 v184, v184, v48
  v_pk_mul_f16 v185, v185, v49
  v_mfma_f32_32x32x16_bf16 v[16:31], a[216:219], v[160:163], 0
  ds_read_b128 v[192:195], v0 offset:55296
  ds_read_b128 v[196:199], v0 offset:56320
  v_pk_mul_f16 v186, v186, v50
  v_pk_mul_f16 v187, v187, v51
  v_pk_fma_f16 v56, v52, v52, s20 op_sel_hi:[1,1,0]
  v_pk_fma_f16 v57, v53, v53, s20 op_sel_hi:[1,1,0]
  v_mfma_f32_16x16x32_bf16 v[128:131], v[216:219], v[220:223], 0
  ds_read_b128 v[216:219], v3 offset:2000
  ds_read_b128 v[220:223], v4 offset:80
  v_mfma_f32_32x32x16_bf16 v[16:31], a[220:223], v[164:167], v[16:31]
  ds_read_b128 v[200:203], v0 offset:57344
  ds_read_b128 v[204:207], v0 offset:58368
  v_pk_fma_f16 v58, v54, v54, s20 op_sel_hi:[1,1,0]
  v_pk_fma_f16 v59, v55, v55, s20 op_sel_hi:[1,1,0]
  v_pk_fma_f16 v56, v56, v56, s20 op_sel:[0,0,1]
  v_pk_fma_f16 v57, v57, v57, s20 op_sel:[0,0,1]
  v_mfma_f32_16x16x32_bf16 v[128:131], v[224:227], v[228:231], v[128:131]
  ds_read_b128 v[224:227], v3 offset:6800
  ds_read_b128 v[228:231], v4 offset:272
  v_mfma_f32_32x32x16_bf16 v[16:31], a[224:227], v[168:171], v[16:31]
  ds_read_b128 v[208:211], v0 offset:59392
  ds_read_b128 v[212:215], v0 offset:60416
  v_pk_fma_f16 v58, v58, v58, s20 op_sel:[0,0,1]
  v_pk_fma_f16 v59, v59, v59, s20 op_sel:[0,0,1]
  v_pk_fma_f16 v188, v56, v56, s21 op_sel_hi:[1,1,0]
  v_pk_fma_f16 v189, v57, v57, s21 op_sel_hi:[1,1,0]
  v_mfma_f32_16x16x32_bf16 v[128:131], v[232:235], v[236:239], v[128:131]
  ds_read_b128 v[232:235], v3 offset:11600
  ds_read_b128 v[236:239], v4 offset:464
  v_mfma_f32_32x32x16_bf16 v[16:31], a[228:231], v[172:175], v[16:31]
  v_pk_fma_f16 v190, v58, v58, s21 op_sel_hi:[1,1,0]
  v_pk_fma_f16 v191, v59, v59, s21 op_sel_hi:[1,1,0]
  v_add_f32_e64 v12, v12, v144
  v_pk_fma_f16 v188, v188, v56, s21 op_sel:[0,0,1]
  v_pk_fma_f16 v189, v189, v57, s21 op_sel:[0,0,1]
  v_add_f32_e64 v13, v13, v145
  v_mfma_f32_32x32x16_bf16 v[16:31], a[232:235], v[176:179], v[16:31]
  v_fmac_f32 v14, v144, v144
  v_fmac_f32 v15, v145, v145
  v_add_f32 v12, v12, v146
  v_add_f32 v13, v13, v147
  v_fmac_f32_e64 v14, v146, v146
  v_fmac_f32 v15, v147, v147
  v_mfma_f32_32x32x16_bf16 v[16:31], a[236:239], v[180:183], v[16:31]
  s_waitcnt lgkmcnt(0)
  v_pk_fma_f16 v190, v190, v58, s21 op_sel:[0,0,1]
  v_pk_fma_f16 v191, v191, v59, s21 op_sel:[0,0,1]
  v_pk_fma_f16 v188, v188, v52, 0.5 op_sel_hi:[1,1,0] clamp
  v_pk_fma_f16 v189, v189, v53, 0.5 op_sel_hi:[1,1,0] clamp
  v_pk_fma_f16 v190, v190, v54, 0.5 op_sel_hi:[1,1,0] clamp
  v_pk_fma_f16 v191, v191, v55, 0.5 op_sel_hi:[1,1,0] clamp
  v_mfma_f32_32x32x16_f16 v[64:79], v[192:195], v[184:187], v[64:79]
  v_pk_mul_f16 v188, v188, v52
  v_pk_mul_f16 v189, v189, v53
  v_add_f32_e64 v12, v12, v148
  v_pk_mul_f16 v190, v190, v54
  v_pk_mul_f16 v191, v191, v55
  v_add_f32_e64 v13, v13, v149
  v_mfma_f32_16x16x32_bf16 v[132:135], v[216:219], v[220:223], 0
  v_cvt_pk_f16_f32 v48, v16, v17
  v_cvt_pk_f16_f32 v49, v18, v19
  v_mfma_f32_32x32x16_f16 v[80:95], v[196:199], v[184:187], v[80:95]
  v_cvt_pk_f16_f32 v50, v20, v21
  v_cvt_pk_f16_f32 v51, v22, v23
  v_cvt_pk_f16_f32 v52, v24, v25
  v_cvt_pk_f16_f32 v53, v26, v27
  v_cvt_pk_f16_f32 v54, v28, v29
  v_cvt_pk_f16_f32 v55, v30, v31
  v_mfma_f32_16x16x32_bf16 v[132:135], v[224:227], v[228:231], v[132:135]
  v_pk_fma_f16 v56, v48, v48, s20 op_sel_hi:[1,1,0]
  v_pk_fma_f16 v57, v49, v49, s20 op_sel_hi:[1,1,0]
  v_mfma_f32_32x32x16_f16 v[96:111], v[200:203], v[184:187], v[96:111]
  v_pk_fma_f16 v58, v50, v50, s20 op_sel_hi:[1,1,0]
  v_pk_fma_f16 v59, v51, v51, s20 op_sel_hi:[1,1,0]
  v_pk_fma_f16 v56, v56, v56, s20 op_sel:[0,0,1]
  v_pk_fma_f16 v57, v57, v57, s20 op_sel:[0,0,1]
  v_pk_fma_f16 v58, v58, v58, s20 op_sel:[0,0,1]
  v_pk_fma_f16 v59, v59, v59, s20 op_sel:[0,0,1]
  v_mfma_f32_16x16x32_bf16 v[132:135], v[232:235], v[236:239], v[132:135]
  ds_read_b128 v[236:239], v0 offset:17408
  v_pk_fma_f16 v184, v56, v56, s21 op_sel_hi:[1,1,0]
  v_mfma_f32_32x32x16_f16 v[64:79], v[204:207], v[188:191], v[64:79]
  s_nop 0
  s_mov_b32 s28, s34
  v_pk_fma_f16 v185, v57, v57, s21 op_sel_hi:[1,1,0]
  v_pk_fma_f16 v186, v58, v58, s21 op_sel_hi:[1,1,0]
  v_pk_fma_f16 v187, v59, v59, s21 op_sel_hi:[1,1,0]
  v_pk_fma_f16 v184, v184, v56, s21 op_sel:[0,0,1]
  v_pk_fma_f16 v185, v185, v57, s21 op_sel:[0,0,1]
  v_pk_fma_f16 v186, v186, v58, s21 op_sel:[0,0,1]
  v_mfma_f32_32x32x16_f16 v[80:95], v[208:211], v[188:191], v[80:95]
  s_add_u32 s34, s34, 0x60000
  v_pk_fma_f16 v187, v187, v59, s21 op_sel:[0,0,1]
  v_pk_fma_f16 v184, v184, v48, 0.5 op_sel_hi:[1,1,0] clamp
  v_pk_fma_f16 v185, v185, v49, 0.5 op_sel_hi:[1,1,0] clamp
  v_pk_fma_f16 v186, v186, v50, 0.5 op_sel_hi:[1,1,0] clamp
  v_pk_fma_f16 v187, v187, v51, 0.5 op_sel_hi:[1,1,0] clamp
  v_pk_mul_f16 v184, v184, v48
  v_mfma_f32_32x32x16_f16 v[96:111], v[212:215], v[188:191], v[96:111]
  s_nop 0
  s_waitcnt lgkmcnt(0)
  v_pk_mul_f16 v185, v185, v49
  v_pk_mul_f16 v186, v186, v50
  v_pk_mul_f16 v187, v187, v51
  v_pk_fma_f16 v56, v52, v52, s20 op_sel_hi:[1,1,0]
  v_pk_fma_f16 v57, v53, v53, s20 op_sel_hi:[1,1,0]
  v_pk_fma_f16 v58, v54, v54, s20 op_sel_hi:[1,1,0]
  v_mfma_f32_32x32x16_bf16 v[16:31], v[32:35], v[160:163], 0
  ds_read_b128 v[192:195], v0 offset:61440
  ds_read_b128 v[196:199], v0 offset:62464
  v_pk_fma_f16 v59, v55, v55, s20 op_sel_hi:[1,1,0]
  v_pk_fma_f16 v56, v56, v56, s20 op_sel:[0,0,1]
  v_pk_fma_f16 v57, v57, v57, s20 op_sel:[0,0,1]
  v_pk_fma_f16 v58, v58, v58, s20 op_sel:[0,0,1]
  v_pk_fma_f16 v59, v59, v59, s20 op_sel:[0,0,1]
  v_pk_fma_f16 v188, v56, v56, s21 op_sel_hi:[1,1,0]
  v_pk_fma_f16 v189, v57, v57, s21 op_sel_hi:[1,1,0]
  v_pk_fma_f32 v[14:15], v[148:149], v[148:149], v[14:15]
  v_pk_add_f32 v[12:13], v[12:13], v[150:151]
  v_pk_fma_f32 v[14:15], v[150:151], v[150:151], v[14:15]
  v_pk_add_f32 v[12:13], v[12:13], v[152:153]
  v_pk_fma_f32 v[14:15], v[152:153], v[152:153], v[14:15]
  v_pk_add_f32 v[12:13], v[12:13], v[154:155]
  v_pk_fma_f32 v[14:15], v[154:155], v[154:155], v[14:15]
  v_pk_add_f32 v[12:13], v[12:13], v[156:157]
  v_pk_fma_f32 v[14:15], v[156:157], v[156:157], v[14:15]
  v_pk_add_f32 v[12:13], v[12:13], v[158:159]
  v_pk_fma_f32 v[14:15], v[158:159], v[158:159], v[14:15]
  v_pk_add_f32 v[12:13], v[12:13], v[112:113]
  v_pk_fma_f32 v[14:15], v[112:113], v[112:113], v[14:15]
  v_pk_add_f32 v[12:13], v[12:13], v[114:115]
  v_pk_fma_f32 v[14:15], v[114:115], v[114:115], v[14:15]
  v_pk_add_f32 v[12:13], v[12:13], v[116:117]
  v_pk_fma_f32 v[14:15], v[116:117], v[116:117], v[14:15]
  v_pk_add_f32 v[12:13], v[12:13], v[118:119]
  v_pk_fma_f32 v[14:15], v[118:119], v[118:119], v[14:15]
  v_pk_add_f32 v[12:13], v[12:13], v[120:121]
  v_pk_fma_f32 v[14:15], v[120:121], v[120:121], v[14:15]
  v_pk_add_f32 v[12:13], v[12:13], v[122:123]
  v_pk_fma_f32 v[14:15], v[122:123], v[122:123], v[14:15]
  v_pk_add_f32 v[12:13], v[12:13], v[124:125]
  v_pk_fma_f32 v[14:15], v[124:125], v[124:125], v[14:15]
  v_pk_add_f32 v[12:13], v[12:13], v[126:127]
  v_pk_fma_f32 v[14:15], v[126:127], v[126:127], v[14:15]
  v_pk_add_f32 v[12:13], v[12:13], v[128:129]
  v_pk_fma_f32 v[14:15], v[128:129], v[128:129], v[14:15]
  v_pk_add_f32 v[12:13], v[12:13], v[130:131]
  v_pk_fma_f32 v[14:15], v[130:131], v[130:131], v[14:15]
  v_pk_add_f32 v[12:13], v[12:13], v[132:133]
  v_pk_fma_f32 v[14:15], v[132:133], v[132:133], v[14:15]
  v_pk_add_f32 v[12:13], v[12:13], v[134:135]
  v_pk_fma_f32 v[14:15], v[134:135], v[134:135], v[14:15]
  v_mfma_f32_32x32x16_bf16 v[16:31], v[36:39], v[164:167], v[16:31]
  ds_read_b128 v[200:203], v0 offset:63488
  ds_read_b128 v[204:207], v0 offset:64512
  v_add_f32 v12, v12, v13
  v_add_f32 v14, v14, v15
  s_nop 1
  v_permlane32_swap_b32 v12, v14
  v_mfma_f32_32x32x16_bf16 v[16:31], v[40:43], v[168:171], v[16:31]
  ds_read_b128 v[208:211], v1
  ds_read_b128 v[212:215], v1 offset:1024
  v_add_f32 v12, v12, v14
  v_mov_b32 v14, v12
  s_nop 1
  v_permlane32_swap_b32 v12, v14
  v_mul_f32_e64 v12, s24, v12
  v_mfma_f32_32x32x16_bf16 v[16:31], v[44:47], v[172:175], v[16:31]
  v_mul_f32_e64 v13, s24, v14
  v_pk_fma_f16 v190, v58, v58, s21 op_sel_hi:[1,1,0]
  v_fma_f32 v13, -v12, v12, v13
  v_pk_fma_f16 v191, v59, v59, s21 op_sel_hi:[1,1,0]
  v_max_f32_e64 v13, 0, v13
  v_pk_fma_f16 v188, v188, v56, s21 op_sel:[0,0,1]
  v_mfma_f32_32x32x16_bf16 v[16:31], v[60:63], v[176:179], v[16:31]
  v_add_f32_e64 v13, s25, v13
  v_rsq_f32 v13, v13
  s_nop 0
  v_mul_f32 v14, s22, v13
  v_mul_f32_e64 v12, -v12, v14
  v_pk_fma_f16 v189, v189, v57, s21 op_sel:[0,0,1]
  v_mfma_f32_32x32x16_bf16 v[16:31], v[236:239], v[180:183], v[16:31]
  s_waitcnt lgkmcnt(0)
  v_pk_fma_f16 v190, v190, v58, s21 op_sel:[0,0,1]
  v_pk_fma_f16 v191, v191, v59, s21 op_sel:[0,0,1]
  v_pk_fma_f16 v188, v188, v52, 0.5 op_sel_hi:[1,1,0] clamp
  v_pk_fma_f16 v189, v189, v53, 0.5 op_sel_hi:[1,1,0] clamp
  v_pk_fma_f16 v190, v190, v54, 0.5 op_sel_hi:[1,1,0] clamp
  v_pk_fma_f16 v191, v191, v55, 0.5 op_sel_hi:[1,1,0] clamp
  v_pk_mul_f16 v188, v188, v52
  v_pk_mul_f16 v189, v189, v53
  v_pk_mul_f16 v190, v190, v54
  v_pk_fma_f32 v[112:113], v[112:113], v[14:15], v[12:13] op_sel_hi:[1,0,0]
  v_pk_fma_f32 v[114:115], v[114:115], v[14:15], v[12:13] op_sel_hi:[1,0,0]
  v_pk_fma_f32 v[116:117], v[116:117], v[14:15], v[12:13] op_sel_hi:[1,0,0]
  v_pk_fma_f32 v[118:119], v[118:119], v[14:15], v[12:13] op_sel_hi:[1,0,0]
  v_pk_fma_f32 v[120:121], v[120:121], v[14:15], v[12:13] op_sel_hi:[1,0,0]
  v_pk_fma_f32 v[122:123], v[122:123], v[14:15], v[12:13] op_sel_hi:[1,0,0]
  v_pk_fma_f32 v[124:125], v[124:125], v[14:15], v[12:13] op_sel_hi:[1,0,0]
  v_pk_fma_f32 v[126:127], v[126:127], v[14:15], v[12:13] op_sel_hi:[1,0,0]
  v_pk_fma_f32 v[128:129], v[128:129], v[14:15], v[12:13] op_sel_hi:[1,0,0]
  v_pk_fma_f32 v[130:131], v[130:131], v[14:15], v[12:13] op_sel_hi:[1,0,0]
  v_pk_fma_f32 v[132:133], v[132:133], v[14:15], v[12:13] op_sel_hi:[1,0,0]
  v_pk_fma_f32 v[134:135], v[134:135], v[14:15], v[12:13] op_sel_hi:[1,0,0]
  v_pk_fma_f32 v[136:137], v[136:137], v[14:15], v[12:13] op_sel_hi:[1,0,0]
  v_pk_fma_f32 v[138:139], v[138:139], v[14:15], v[12:13] op_sel_hi:[1,0,0]
  v_pk_fma_f32 v[140:141], v[140:141], v[14:15], v[12:13] op_sel_hi:[1,0,0]
  v_pk_fma_f32 v[142:143], v[142:143], v[14:15], v[12:13] op_sel_hi:[1,0,0]
  v_pk_fma_f32 v[144:145], v[144:145], v[14:15], v[12:13] op_sel_hi:[1,0,0]
  v_pk_fma_f32 v[146:147], v[146:147], v[14:15], v[12:13] op_sel_hi:[1,0,0]
  v_pk_fma_f32 v[148:149], v[148:149], v[14:15], v[12:13] op_sel_hi:[1,0,0]
  v_pk_fma_f32 v[150:151], v[150:151], v[14:15], v[12:13] op_sel_hi:[1,0,0]
  v_pk_fma_f32 v[152:153], v[152:153], v[14:15], v[12:13] op_sel_hi:[1,0,0]
  v_pk_fma_f32 v[154:155], v[154:155], v[14:15], v[12:13] op_sel_hi:[1,0,0]
  v_pk_fma_f32 v[156:157], v[156:157], v[14:15], v[12:13] op_sel_hi:[1,0,0]
  v_pk_fma_f32 v[158:159], v[158:159], v[14:15], v[12:13] op_sel_hi:[1,0,0]
  v_mfma_f32_32x32x16_f16 v[64:79], v[192:195], v[184:187], v[64:79]
  ds_read_b128 v[216:219], v0 offset:18432
  ds_read_b128 v[220:223], v0 offset:19456
  v_cndmask_b32 v159, v159, v250, s[12:13]
  v_cvt_pk_bf16_f32 v160, v112, v113
  v_cvt_pk_bf16_f32 v161, v114, v115
  v_cvt_pk_bf16_f32 v162, v116, v117
  v_mfma_f32_32x32x16_f16 v[80:95], v[196:199], v[184:187], v[80:95]
  ds_read_b128 v[224:227], v0 offset:20480
  ds_read_b128 v[228:231], v0 offset:21504
  v_cvt_pk_bf16_f32 v163, v118, v119
  v_cvt_pk_bf16_f32 v164, v120, v121
  v_cvt_pk_bf16_f32 v165, v122, v123
  v_cvt_pk_bf16_f32 v166, v124, v125
  v_mfma_f32_32x32x16_f16 v[96:111], v[200:203], v[184:187], v[96:111]
  ds_read_b128 v[232:235], v0 offset:22528
  ds_read_b128 v[236:239], v0 offset:23552
  v_cvt_pk_bf16_f32 v167, v126, v127
  v_cvt_pk_bf16_f32 v168, v128, v129
  v_cvt_pk_bf16_f32 v169, v130, v131
  v_cvt_pk_bf16_f32 v170, v132, v133
  v_pk_mul_f16 v191, v191, v55
  s_nop 0
  s_nop 1
  v_mfma_f32_32x32x16_f16 v[64:79], v[204:207], v[188:191], v[64:79]
  v_cvt_pk_bf16_f32 v171, v134, v135
  v_cvt_pk_bf16_f32 v172, v136, v137
  v_cvt_pk_f16_f32 v48, v16, v17
  v_cvt_pk_bf16_f32 v173, v138, v139
  v_cvt_pk_bf16_f32 v174, v140, v141
  v_cvt_pk_f16_f32 v49, v18, v19
  v_mfma_f32_32x32x16_f16 v[80:95], v[208:211], v[188:191], v[80:95]
  v_cvt_pk_bf16_f32 v175, v142, v143
  v_cvt_pk_bf16_f32 v176, v144, v145
  v_cvt_pk_f16_f32 v50, v20, v21
  v_cvt_pk_bf16_f32 v177, v146, v147
  v_cvt_pk_bf16_f32 v178, v148, v149
  v_cvt_pk_f16_f32 v51, v22, v23
  v_mfma_f32_32x32x16_f16 v[96:111], v[212:215], v[188:191], v[96:111]
  s_nop 0
  s_waitcnt lgkmcnt(0)
  v_cvt_pk_f16_f32 v52, v24, v25
  v_cvt_pk_f16_f32 v53, v26, v27
  v_cvt_pk_bf16_f32 v179, v150, v151
  v_cvt_pk_f16_f32 v54, v28, v29
  v_cvt_pk_f16_f32 v55, v30, v31
  v_cvt_pk_bf16_f32 v180, v152, v153
  v_pk_fma_f16 v56, v48, v48, s20 op_sel_hi:[1,1,0]
  v_cvt_pk_bf16_f32 v181, v154, v155
  v_pk_fma_f16 v57, v49, v49, s20 op_sel_hi:[1,1,0]
  v_pk_fma_f16 v58, v50, v50, s20 op_sel_hi:[1,1,0]
  v_cvt_pk_bf16_f32 v182, v156, v157
  v_pk_fma_f16 v59, v51, v51, s20 op_sel_hi:[1,1,0]
  v_cvt_pk_bf16_f32 v183, v158, v159
  s_mov_b32 s26, 6
  .p2align 6
  s_nop 0
  s_waitcnt vmcnt(0)
L_loop:
  v_mfma_f32_32x32x16_bf16 v[16:31], v[216:219], v[160:163], 0
  ds_read_b128 v[192:195], v1 offset:2048
  ds_read_b128 v[196:199], v1 offset:3072
  ds_read_b128 v[200:203], v1 offset:4096
  v_pk_fma_f16 v56, v56, v56, s20 op_sel:[0,0,1]
  v_pk_fma_f16 v57, v57, v57, s20 op_sel:[0,0,1]
  v_pk_fma_f16 v58, v58, v58, s20 op_sel:[0,0,1]
  v_mfma_f32_32x32x16_bf16 v[16:31], v[220:223], v[164:167], v[16:31]
  ds_read_b128 v[204:207], v1 offset:5120
  ds_read_b128 v[208:211], v1 offset:6144
  ds_read_b128 v[212:215], v1 offset:7168
  v_pk_fma_f16 v59, v59, v59, s20 op_sel:[0,0,1]
  v_pk_fma_f16 v184, v56, v56, s21 op_sel_hi:[1,1,0]
  v_pk_fma_f16 v185, v57, v57, s21 op_sel_hi:[1,1,0]
  v_mfma_f32_32x32x16_bf16 v[16:31], v[224:227], v[168:171], v[16:31]
  ds_read_b128 v[136:139], v5
  ds_read_b128 v[140:143], v5 offset:32
  ds_read_b128 v[144:147], v5 offset:64
  v_pk_fma_f16 v186, v58, v58, s21 op_sel_hi:[1,1,0]
  v_pk_fma_f16 v187, v59, v59, s21 op_sel_hi:[1,1,0]
  v_pk_fma_f16 v184, v184, v56, s21 op_sel:[0,0,1]
  v_mfma_f32_32x32x16_bf16 v[16:31], v[228:231], v[172:175], v[16:31]
  ds_read_b128 v[148:151], v5 offset:96
  ds_read_b128 v[152:155], v5 offset:128
  ds_read_b128 v[156:159], v5 offset:160
  v_pk_fma_f16 v185, v185, v57, s21 op_sel:[0,0,1]
  v_pk_fma_f16 v186, v186, v58, s21 op_sel:[0,0,1]
  v_pk_fma_f16 v187, v187, v59, s21 op_sel:[0,0,1]
  v_mfma_f32_32x32x16_bf16 v[16:31], v[232:235], v[176:179], v[16:31]
  v_pk_fma_f16 v184, v184, v48, 0.5 op_sel_hi:[1,1,0] clamp
  v_pk_fma_f16 v185, v185, v49, 0.5 op_sel_hi:[1,1,0] clamp
  v_pk_fma_f16 v186, v186, v50, 0.5 op_sel_hi:[1,1,0] clamp
  v_pk_fma_f16 v187, v187, v51, 0.5 op_sel_hi:[1,1,0] clamp
  v_pk_mul_f16 v184, v184, v48
  v_pk_mul_f16 v185, v185, v49
  v_mfma_f32_32x32x16_bf16 v[16:31], v[236:239], v[180:183], v[16:31]
  s_waitcnt lgkmcnt(0)
  v_pk_mul_f16 v186, v186, v50
  v_pk_mul_f16 v187, v187, v51
  v_pk_fma_f16 v56, v52, v52, s20 op_sel_hi:[1,1,0]
  v_pk_fma_f16 v57, v53, v53, s20 op_sel_hi:[1,1,0]
  v_pk_fma_f16 v58, v54, v54, s20 op_sel_hi:[1,1,0]
  v_pk_fma_f16 v59, v55, v55, s20 op_sel_hi:[1,1,0]
  v_mfma_f32_32x32x16_f16 v[64:79], v[192:195], v[184:187], v[64:79]
  s_mov_b32 m0, s30
  v_pk_fma_f16 v56, v56, v56, s20 op_sel:[0,0,1]
  v_pk_fma_f16 v57, v57, v57, s20 op_sel:[0,0,1]
  v_pk_fma_f16 v58, v58, v58, s20 op_sel:[0,0,1]
  v_pk_fma_f16 v59, v59, v59, s20 op_sel:[0,0,1]
  v_pk_fma_f16 v188, v56, v56, s21 op_sel_hi:[1,1,0]
  v_pk_fma_f16 v189, v57, v57, s21 op_sel_hi:[1,1,0]
  v_mfma_f32_32x32x16_f16 v[80:95], v[196:199], v[184:187], v[80:95]
  buffer_load_dwordx4 v6, s[4:7], s29 offen lds
  v_pk_fma_f16 v190, v58, v58, s21 op_sel_hi:[1,1,0]
  v_pk_fma_f16 v191, v59, v59, s21 op_sel_hi:[1,1,0]
  v_pk_fma_f16 v188, v188, v56, s21 op_sel:[0,0,1]
  v_pk_fma_f16 v189, v189, v57, s21 op_sel:[0,0,1]
  v_pk_fma_f16 v190, v190, v58, s21 op_sel:[0,0,1]
  v_mfma_f32_32x32x16_f16 v[96:111], v[200:203], v[184:187], v[96:111]
  buffer_load_dwordx4 v7, s[4:7], s29 offen offset:1024 lds
  v_pk_fma_f16 v191, v191, v59, s21 op_sel:[0,0,1]
  v_pk_fma_f16 v188, v188, v52, 0.5 op_sel_hi:[1,1,0] clamp
  v_pk_fma_f16 v189, v189, v53, 0.5 op_sel_hi:[1,1,0] clamp
  v_pk_fma_f16 v190, v190, v54, 0.5 op_sel_hi:[1,1,0] clamp
  v_pk_fma_f16 v191, v191, v55, 0.5 op_sel_hi:[1,1,0] clamp
  v_pk_mul_f16 v188, v188, v52
  v_pk_mul_f16 v189, v189, v53
  v_pk_mul_f16 v190, v190, v54
  v_pk_mul_f16 v191, v191, v55
  s_nop 0
  s_nop 1
  v_mfma_f32_32x32x16_f16 v[64:79], v[204:207], v[188:191], v[64:79]
  buffer_load_dwordx4 v8, s[4:7], s29 offen offset:2048 lds
  v_cvt_pk_f16_f32 v48, v16, v17
  v_cvt_pk_f16_f32 v49, v18, v19
  v_cvt_pk_f16_f32 v50, v20, v21
  v_cvt_pk_f16_f32 v51, v22, v23
  v_cvt_pk_f16_f32 v52, v24, v25
  v_mfma_f32_32x32x16_f16 v[80:95], v[208:211], v[188:191], v[80:95]
  buffer_load_dwordx4 v9, s[4:7], s29 offen offset:3072 lds
  v_cvt_pk_f16_f32 v53, v26, v27
  v_cvt_pk_f16_f32 v54, v28, v29
  v_cvt_pk_f16_f32 v55, v30, v31
  v_pk_fma_f16 v56, v48, v48, s20 op_sel_hi:[1,1,0]
  v_pk_fma_f16 v57, v49, v49, s20 op_sel_hi:[1,1,0]
  v_mfma_f32_32x32x16_f16 v[96:111], v[212:215], v[188:191], v[96:111]
  v_pk_fma_f16 v58, v50, v50, s20 op_sel_hi:[1,1,0]
  v_pk_fma_f16 v59, v51, v51, s20 op_sel_hi:[1,1,0]
  v_pk_fma_f16 v56, v56, v56, s20 op_sel:[0,0,1]
  v_pk_fma_f16 v57, v57, v57, s20 op_sel:[0,0,1]
  v_pk_fma_f16 v58, v58, v58, s20 op_sel:[0,0,1]
  v_pk_fma_f16 v59, v59, v59, s20 op_sel:[0,0,1]
  v_mfma_f32_32x32x16_bf16 v[16:31], a[0:3], v[160:163], 0
  v_cvt_pk_bf16_f32 v112, v64, v65
  v_cvt_pk_bf16_f32 v113, v66, v67
  v_cvt_pk_bf16_f32 v114, v68, v69
  v_cvt_pk_bf16_f32 v115, v70, v71
  v_cvt_pk_bf16_f32 v116, v72, v73
  v_cvt_pk_bf16_f32 v117, v74, v75
  v_mfma_f32_32x32x16_bf16 v[16:31], a[4:7], v[164:167], v[16:31]
  v_cvt_pk_bf16_f32 v118, v76, v77
  v_cvt_pk_bf16_f32 v119, v78, v79
  v_cvt_pk_bf16_f32 v120, v80, v81
  v_cvt_pk_bf16_f32 v121, v82, v83
  v_cvt_pk_bf16_f32 v122, v84, v85
  v_cvt_pk_bf16_f32 v123, v86, v87
  v_mfma_f32_32x32x16_bf16 v[16:31], a[8:11], v[168:171], v[16:31]
  ds_read_b128 v[64:67], v2
  ds_read_b128 v[68:71], v2 offset:32
  ds_read_b128 v[72:75], v2 offset:64
  ds_read_b128 v[76:79], v2 offset:96
  v_cvt_pk_bf16_f32 v124, v88, v89
  v_cvt_pk_bf16_f32 v125, v90, v91
  v_mfma_f32_32x32x16_bf16 v[16:31], a[12:15], v[172:175], v[16:31]
  ds_read_b128 v[192:195], v1 offset:8192
  ds_read_b128 v[196:199], v1 offset:9216
  v_cvt_pk_bf16_f32 v126, v92, v93
  v_cvt_pk_bf16_f32 v127, v94, v95
  v_cvt_pk_bf16_f32 v128, v96, v97
  v_cvt_pk_bf16_f32 v129, v98, v99
  v_mfma_f32_32x32x16_bf16 v[16:31], a[16:19], v[176:179], v[16:31]
  ds_read_b128 v[80:83], v2 offset:128
  ds_read_b128 v[84:87], v2 offset:160
  ds_read_b128 v[88:91], v2 offset:192
  ds_read_b128 v[92:95], v2 offset:224
  v_cvt_pk_bf16_f32 v130, v100, v101
  v_cvt_pk_bf16_f32 v131, v102, v103
  v_mfma_f32_32x32x16_bf16 v[16:31], a[20:23], v[180:183], v[16:31]
  s_nop 0
  s_waitcnt lgkmcnt(6)
  ds_read_b128 v[200:203], v1 offset:10240
  ds_read_b128 v[204:207], v1 offset:11264
  v_cvt_pk_bf16_f32 v132, v104, v105
  v_cvt_pk_bf16_f32 v133, v106, v107
  v_cvt_pk_bf16_f32 v134, v108, v109
  v_cvt_pk_bf16_f32 v135, v110, v111
  v_mfma_f32_32x32x16_bf16 v[64:79], v[240:243], v[136:139], v[64:79]
  ds_read_b128 v[96:99], v2 offset:256
  ds_read_b128 v[100:103], v2 offset:288
  ds_read_b128 v[104:107], v2 offset:320
  ds_read_b128 v[108:111], v2 offset:352
  v_pk_fma_f16 v184, v56, v56, s21 op_sel_hi:[1,1,0]
  v_pk_fma_f16 v185, v57, v57, s21 op_sel_hi:[1,1,0]
  v_mfma_f32_32x32x16_bf16 v[64:79], v[244:247], v[140:143], v[64:79]
  s_nop 0
  s_waitcnt lgkmcnt(6)
  ds_read_b128 v[208:211], v1 offset:12288
  ds_read_b128 v[212:215], v1 offset:13312
  v_pk_fma_f16 v186, v58, v58, s21 op_sel_hi:[1,1,0]
  v_pk_fma_f16 v187, v59, v59, s21 op_sel_hi:[1,1,0]
  v_pk_fma_f16 v184, v184, v56, s21 op_sel:[0,0,1]
  v_pk_fma_f16 v185, v185, v57, s21 op_sel:[0,0,1]
  v_mfma_f32_32x32x16_bf16 v[80:95], v[240:243], v[144:147], v[80:95]
  v_pk_fma_f16 v186, v186, v58, s21 op_sel:[0,0,1]
  v_pk_fma_f16 v187, v187, v59, s21 op_sel:[0,0,1]
  v_pk_fma_f16 v184, v184, v48, 0.5 op_sel_hi:[1,1,0] clamp
  v_pk_fma_f16 v185, v185, v49, 0.5 op_sel_hi:[1,1,0] clamp
  v_pk_fma_f16 v186, v186, v50, 0.5 op_sel_hi:[1,1,0] clamp
  v_pk_fma_f16 v187, v187, v51, 0.5 op_sel_hi:[1,1,0] clamp
  v_mfma_f32_32x32x16_bf16 v[80:95], v[244:247], v[148:151], v[80:95]
  s_nop 0
  s_waitcnt lgkmcnt(2)
  v_pk_mul_f16 v184, v184, v48
  v_pk_mul_f16 v185, v185, v49
  v_pk_mul_f16 v186, v186, v50
  v_pk_mul_f16 v187, v187, v51
  v_pk_fma_f16 v56, v52, v52, s20 op_sel_hi:[1,1,0]
  v_pk_fma_f16 v57, v53, v53, s20 op_sel_hi:[1,1,0]
  v_mfma_f32_32x32x16_bf16 v[96:111], v[240:243], v[152:155], v[96:111]
  v_pk_fma_f16 v58, v54, v54, s20 op_sel_hi:[1,1,0]
  v_pk_fma_f16 v59, v55, v55, s20 op_sel_hi:[1,1,0]
  v_pk_fma_f16 v56, v56, v56, s20 op_sel:[0,0,1]
  v_pk_fma_f16 v57, v57, v57, s20 op_sel:[0,0,1]
  v_pk_fma_f16 v58, v58, v58, s20 op_sel:[0,0,1]
  v_pk_fma_f16 v59, v59, v59, s20 op_sel:[0,0,1]
  v_mfma_f32_32x32x16_bf16 v[96:111], v[244:247], v[156:159], v[96:111]
  s_waitcnt lgkmcnt(0)
  v_pk_fma_f16 v188, v56, v56, s21 op_sel_hi:[1,1,0]
  v_pk_fma_f16 v189, v57, v57, s21 op_sel_hi:[1,1,0]
  v_pk_fma_f16 v190, v58, v58, s21 op_sel_hi:[1,1,0]
  v_pk_fma_f16 v191, v59, v59, s21 op_sel_hi:[1,1,0]
  v_pk_fma_f16 v188, v188, v56, s21 op_sel:[0,0,1]
  v_pk_fma_f16 v189, v189, v57, s21 op_sel:[0,0,1]
  v_mfma_f32_32x32x16_f16 v[64:79], v[192:195], v[184:187], v[64:79]
  s_mov_b32 m0, s31
  v_pk_fma_f16 v190, v190, v58, s21 op_sel:[0,0,1]
  v_pk_fma_f16 v191, v191, v59, s21 op_sel:[0,0,1]
  v_pk_fma_f16 v188, v188, v52, 0.5 op_sel_hi:[1,1,0] clamp
  v_pk_fma_f16 v189, v189, v53, 0.5 op_sel_hi:[1,1,0] clamp
  v_pk_fma_f16 v190, v190, v54, 0.5 op_sel_hi:[1,1,0] clamp
  v_pk_fma_f16 v191, v191, v55, 0.5 op_sel_hi:[1,1,0] clamp
  v_mfma_f32_32x32x16_f16 v[80:95], v[196:199], v[184:187], v[80:95]
  buffer_load_dwordx4 v6, s[4:7], s52 offen lds
  v_pk_mul_f16 v188, v188, v52
  v_pk_mul_f16 v189, v189, v53
  v_pk_mul_f16 v190, v190, v54
  v_pk_mul_f16 v191, v191, v55
  v_cvt_pk_f16_f32 v48, v16, v17
  v_mfma_f32_32x32x16_f16 v[96:111], v[200:203], v[184:187], v[96:111]
  buffer_load_dwordx4 v7, s[4:7], s52 offen offset:1024 lds
  v_cvt_pk_f16_f32 v49, v18, v19
  v_cvt_pk_f16_f32 v50, v20, v21
  v_cvt_pk_f16_f32 v51, v22, v23
  v_cvt_pk_f16_f32 v52, v24, v25
  v_cvt_pk_f16_f32 v53, v26, v27
  v_mfma_f32_32x32x16_f16 v[64:79], v[204:207], v[188:191], v[64:79]
  buffer_load_dwordx4 v8, s[4:7], s52 offen offset:2048 lds
  v_cvt_pk_f16_f32 v54, v28, v29
  v_cvt_pk_f16_f32 v55, v30, v31
  v_pk_fma_f16 v56, v48, v48, s20 op_sel_hi:[1,1,0]
  v_pk_fma_f16 v57, v49, v49, s20 op_sel_hi:[1,1,0]
  v_pk_fma_f16 v58, v50, v50, s20 op_sel_hi:[1,1,0]
  v_mfma_f32_32x32x16_f16 v[80:95], v[208:211], v[188:191], v[80:95]
  buffer_load_dwordx4 v9, s[4:7], s52 offen offset:3072 lds
  v_pk_fma_f16 v59, v51, v51, s20 op_sel_hi:[1,1,0]
  v_pk_fma_f16 v56, v56, v56, s20 op_sel:[0,0,1]
  v_pk_fma_f16 v57, v57, v57, s20 op_sel:[0,0,1]
  v_pk_fma_f16 v58, v58, v58, s20 op_sel:[0,0,1]
  v_pk_fma_f16 v59, v59, v59, s20 op_sel:[0,0,1]
  v_mfma_f32_32x32x16_f16 v[96:111], v[212:215], v[188:191], v[96:111]
  v_pk_fma_f16 v184, v56, v56, s21 op_sel_hi:[1,1,0]
  v_pk_fma_f16 v185, v57, v57, s21 op_sel_hi:[1,1,0]
  v_pk_fma_f16 v186, v58, v58, s21 op_sel_hi:[1,1,0]
  v_pk_fma_f16 v187, v59, v59, s21 op_sel_hi:[1,1,0]
  v_pk_fma_f16 v184, v184, v56, s21 op_sel:[0,0,1]
  v_pk_fma_f16 v185, v185, v57, s21 op_sel:[0,0,1]
  v_mfma_f32_32x32x16_bf16 v[16:31], a[24:27], v[160:163], 0
  ds_read_b128 v[192:195], v1 offset:14336
  ds_read_b128 v[196:199], v1 offset:15360
  v_pk_fma_f16 v186, v186, v58, s21 op_sel:[0,0,1]
  v_pk_fma_f16 v187, v187, v59, s21 op_sel:[0,0,1]
  v_pk_fma_f16 v184, v184, v48, 0.5 op_sel_hi:[1,1,0] clamp
  v_pk_fma_f16 v185, v185, v49, 0.5 op_sel_hi:[1,1,0] clamp
  v_mfma_f32_32x32x16_bf16 v[16:31], a[28:31], v[164:167], v[16:31]
  ds_read_b128 v[200:203], v1 offset:16384
  ds_read_b128 v[204:207], v1 offset:17408
  v_pk_fma_f16 v186, v186, v50, 0.5 op_sel_hi:[1,1,0] clamp
  v_pk_fma_f16 v187, v187, v51, 0.5 op_sel_hi:[1,1,0] clamp
  v_pk_mul_f16 v184, v184, v48
  v_pk_mul_f16 v185, v185, v49
  v_mfma_f32_32x32x16_bf16 v[16:31], a[32:35], v[168:171], v[16:31]
  ds_read_b128 v[208:211], v1 offset:18432
  ds_read_b128 v[212:215], v1 offset:19456
  v_pk_mul_f16 v186, v186, v50
  v_pk_mul_f16 v187, v187, v51
  v_pk_fma_f16 v56, v52, v52, s20 op_sel_hi:[1,1,0]
  v_pk_fma_f16 v57, v53, v53, s20 op_sel_hi:[1,1,0]
  v_mfma_f32_32x32x16_bf16 v[16:31], a[36:39], v[172:175], v[16:31]
  buffer_store_dwordx4 v[112:115], v10, s[8:11], s28 offen
  v_pk_fma_f16 v58, v54, v54, s20 op_sel_hi:[1,1,0]
  v_pk_fma_f16 v59, v55, v55, s20 op_sel_hi:[1,1,0]
  v_pk_fma_f16 v56, v56, v56, s20 op_sel:[0,0,1]
  v_pk_fma_f16 v57, v57, v57, s20 op_sel:[0,0,1]
  v_pk_fma_f16 v58, v58, v58, s20 op_sel:[0,0,1]
  v_mfma_f32_32x32x16_bf16 v[16:31], a[40:43], v[176:179], v[16:31]
  v_pk_fma_f16 v59, v59, v59, s20 op_sel:[0,0,1]
  v_pk_fma_f16 v188, v56, v56, s21 op_sel_hi:[1,1,0]
  v_pk_fma_f16 v189, v57, v57, s21 op_sel_hi:[1,1,0]
  v_pk_fma_f16 v190, v58, v58, s21 op_sel_hi:[1,1,0]
  v_pk_fma_f16 v191, v59, v59, s21 op_sel_hi:[1,1,0]
  v_pk_fma_f16 v188, v188, v56, s21 op_sel:[0,0,1]
  v_mfma_f32_32x32x16_bf16 v[16:31], a[44:47], v[180:183], v[16:31]
  s_nop 0
  s_waitcnt lgkmcnt(0)
  v_pk_fma_f16 v189, v189, v57, s21 op_sel:[0,0,1]
  v_pk_fma_f16 v190, v190, v58, s21 op_sel:[0,0,1]
  v_pk_fma_f16 v191, v191, v59, s21 op_sel:[0,0,1]
  v_pk_fma_f16 v188, v188, v52, 0.5 op_sel_hi:[1,1,0] clamp
  v_pk_fma_f16 v189, v189, v53, 0.5 op_sel_hi:[1,1,0] clamp
  v_pk_fma_f16 v190, v190, v54, 0.5 op_sel_hi:[1,1,0] clamp
  v_mfma_f32_32x32x16_f16 v[64:79], v[192:195], v[184:187], v[64:79]
  v_pk_fma_f16 v191, v191, v55, 0.5 op_sel_hi:[1,1,0] clamp
  v_pk_mul_f16 v188, v188, v52
  v_pk_mul_f16 v189, v189, v53
  v_pk_mul_f16 v190, v190, v54
  v_pk_mul_f16 v191, v191, v55
  v_mfma_f32_32x32x16_f16 v[80:95], v[196:199], v[184:187], v[80:95]
  v_cvt_pk_f16_f32 v48, v16, v17
  v_cvt_pk_f16_f32 v49, v18, v19
  v_cvt_pk_f16_f32 v50, v20, v21
  v_cvt_pk_f16_f32 v51, v22, v23
  v_cvt_pk_f16_f32 v52, v24, v25
  v_cvt_pk_f16_f32 v53, v26, v27
  v_mfma_f32_32x32x16_f16 v[96:111], v[200:203], v[184:187], v[96:111]
  v_cvt_pk_f16_f32 v54, v28, v29
  v_cvt_pk_f16_f32 v55, v30, v31
  v_pk_fma_f16 v56, v48, v48, s20 op_sel_hi:[1,1,0]
  v_pk_fma_f16 v57, v49, v49, s20 op_sel_hi:[1,1,0]
  v_pk_fma_f16 v58, v50, v50, s20 op_sel_hi:[1,1,0]
  v_subrev_u32 v11, 0x4100, v5
  v_mfma_f32_32x32x16_f16 v[64:79], v[204:207], v[188:191], v[64:79]
  v_pk_fma_f16 v59, v51, v51, s20 op_sel_hi:[1,1,0]
  v_pk_fma_f16 v56, v56, v56, s20 op_sel:[0,0,1]
  v_pk_fma_f16 v57, v57, v57, s20 op_sel:[0,0,1]
  v_pk_fma_f16 v58, v58, v58, s20 op_sel:[0,0,1]
  v_pk_fma_f16 v59, v59, v59, s20 op_sel:[0,0,1]
  v_add_u32 v5, 0x8200, v5
  v_mfma_f32_32x32x16_f16 v[80:95], v[208:211], v[188:191], v[80:95]
  v_pk_fma_f16 v184, v56, v56, s21 op_sel_hi:[1,1,0]
  v_pk_fma_f16 v185, v57, v57, s21 op_sel_hi:[1,1,0]
  v_pk_fma_f16 v186, v58, v58, s21 op_sel_hi:[1,1,0]
  v_pk_fma_f16 v187, v59, v59, s21 op_sel_hi:[1,1,0]
  v_pk_fma_f16 v184, v184, v56, s21 op_sel:[0,0,1]
  v_min_u32_e64 v5, v11, v5
  v_mfma_f32_32x32x16_f16 v[96:111], v[212:215], v[188:191], v[96:111]
  v_pk_fma_f16 v185, v185, v57, s21 op_sel:[0,0,1]
  v_pk_fma_f16 v186, v186, v58, s21 op_sel:[0,0,1]
  v_pk_fma_f16 v187, v187, v59, s21 op_sel:[0,0,1]
  v_pk_fma_f16 v184, v184, v48, 0.5 op_sel_hi:[1,1,0] clamp
  v_pk_fma_f16 v185, v185, v49, 0.5 op_sel_hi:[1,1,0] clamp
  v_pk_fma_f16 v186, v186, v50, 0.5 op_sel_hi:[1,1,0] clamp
  v_mfma_f32_32x32x16_bf16 v[16:31], a[48:51], v[160:163], 0
  ds_read_b128 v[192:195], v1 offset:20480
  ds_read_b128 v[196:199], v1 offset:21504
  v_pk_fma_f16 v187, v187, v51, 0.5 op_sel_hi:[1,1,0] clamp
  v_pk_mul_f16 v184, v184, v48
  v_pk_mul_f16 v185, v185, v49
  v_pk_mul_f16 v186, v186, v50
  v_mfma_f32_32x32x16_bf16 v[16:31], a[52:55], v[164:167], v[16:31]
  ds_read_b128 v[200:203], v1 offset:22528
  ds_read_b128 v[204:207], v1 offset:23552
  v_pk_mul_f16 v187, v187, v51
  v_pk_fma_f16 v56, v52, v52, s20 op_sel_hi:[1,1,0]
  v_pk_fma_f16 v57, v53, v53, s20 op_sel_hi:[1,1,0]
  v_pk_fma_f16 v58, v54, v54, s20 op_sel_hi:[1,1,0]
  v_mfma_f32_32x32x16_bf16 v[16:31], a[56:59], v[168:171], v[16:31]
  ds_read_b128 v[208:211], v1 offset:24576
  ds_read_b128 v[212:215], v1 offset:25600
  v_pk_fma_f16 v59, v55, v55, s20 op_sel_hi:[1,1,0]
  v_pk_fma_f16 v56, v56, v56, s20 op_sel:[0,0,1]
  v_pk_fma_f16 v57, v57, v57, s20 op_sel:[0,0,1]
  v_pk_fma_f16 v58, v58, v58, s20 op_sel:[0,0,1]
  v_mfma_f32_32x32x16_bf16 v[16:31], a[60:63], v[172:175], v[16:31]
  buffer_store_dwordx4 v[116:119], v10, s[8:11], s28 offen offset:32
  v_pk_fma_f16 v59, v59, v59, s20 op_sel:[0,0,1]
  v_pk_fma_f16 v188, v56, v56, s21 op_sel_hi:[1,1,0]
  v_pk_fma_f16 v189, v57, v57, s21 op_sel_hi:[1,1,0]
  v_pk_fma_f16 v190, v58, v58, s21 op_sel_hi:[1,1,0]
  v_pk_fma_f16 v191, v59, v59, s21 op_sel_hi:[1,1,0]
  v_mfma_f32_32x32x16_bf16 v[16:31], a[64:67], v[176:179], v[16:31]
  v_pk_fma_f16 v188, v188, v56, s21 op_sel:[0,0,1]
  v_pk_fma_f16 v189, v189, v57, s21 op_sel:[0,0,1]
  v_pk_fma_f16 v190, v190, v58, s21 op_sel:[0,0,1]
  v_pk_fma_f16 v191, v191, v59, s21 op_sel:[0,0,1]
  v_mfma_f32_32x32x16_bf16 v[16:31], a[68:71], v[180:183], v[16:31]
  s_nop 0
  s_waitcnt lgkmcnt(0)
  v_pk_fma_f16 v188, v188, v52, 0.5 op_sel_hi:[1,1,0] clamp
  v_pk_fma_f16 v189, v189, v53, 0.5 op_sel_hi:[1,1,0] clamp
  v_pk_fma_f16 v190, v190, v54, 0.5 op_sel_hi:[1,1,0] clamp
  v_pk_fma_f16 v191, v191, v55, 0.5 op_sel_hi:[1,1,0] clamp
  v_pk_mul_f16 v188, v188, v52
  v_pk_mul_f16 v189, v189, v53
  v_mfma_f32_32x32x16_f16 v[64:79], v[192:195], v[184:187], v[64:79]
  s_add_u32 s29, s29, 0x60000
  v_pk_mul_f16 v190, v190, v54
  v_pk_mul_f16 v191, v191, v55
  v_mfma_f32_32x32x16_f16 v[80:95], v[196:199], v[184:187], v[80:95]
  s_add_u32 s52, s52, 0x60000
  v_cvt_pk_f16_f32 v48, v16, v17
  v_cvt_pk_f16_f32 v49, v18, v19
  v_cvt_pk_f16_f32 v50, v20, v21
  v_cvt_pk_f16_f32 v51, v22, v23
  v_cvt_pk_f16_f32 v52, v24, v25
  v_cvt_pk_f16_f32 v53, v26, v27
  v_mfma_f32_32x32x16_f16 v[96:111], v[200:203], v[184:187], v[96:111]
  s_mov_b32 s32, s30
  v_cvt_pk_f16_f32 v54, v28, v29
  v_cvt_pk_f16_f32 v55, v30, v31
  v_pk_fma_f16 v56, v48, v48, s20 op_sel_hi:[1,1,0]
  v_pk_fma_f16 v57, v49, v49, s20 op_sel_hi:[1,1,0]
  v_pk_fma_f16 v58, v50, v50, s20 op_sel_hi:[1,1,0]
  v_subrev_u32 v11, 0x4100, v4
  v_mfma_f32_32x32x16_f16 v[64:79], v[204:207], v[188:191], v[64:79]
  s_add_u32 s30, s33, 32
  v_pk_fma_f16 v59, v51, v51, s20 op_sel_hi:[1,1,0]
  v_pk_fma_f16 v56, v56, v56, s20 op_sel:[0,0,1]
  v_pk_fma_f16 v57, v57, v57, s20 op_sel:[0,0,1]
  v_pk_fma_f16 v58, v58, v58, s20 op_sel:[0,0,1]
  v_pk_fma_f16 v59, v59, v59, s20 op_sel:[0,0,1]
  v_add_u32 v4, 0x8200, v4
  v_mfma_f32_32x32x16_f16 v[80:95], v[208:211], v[188:191], v[80:95]
  s_nop 0
  s_sub_u32 s33, s31, 0
  v_pk_fma_f16 v184, v56, v56, s21 op_sel_hi:[1,1,0]
  v_pk_fma_f16 v185, v57, v57, s21 op_sel_hi:[1,1,0]
  v_pk_fma_f16 v186, v58, v58, s21 op_sel_hi:[1,1,0]
  v_pk_fma_f16 v187, v59, v59, s21 op_sel_hi:[1,1,0]
  v_pk_fma_f16 v184, v184, v56, s21 op_sel:[0,0,1]
  v_min_u32_e64 v4, v11, v4
  v_mfma_f32_32x32x16_f16 v[96:111], v[212:215], v[188:191], v[96:111]
  v_pk_fma_f16 v185, v185, v57, s21 op_sel:[0,0,1]
  v_pk_fma_f16 v186, v186, v58, s21 op_sel:[0,0,1]
  v_pk_fma_f16 v187, v187, v59, s21 op_sel:[0,0,1]
  v_pk_fma_f16 v184, v184, v48, 0.5 op_sel_hi:[1,1,0] clamp
  v_pk_fma_f16 v185, v185, v49, 0.5 op_sel_hi:[1,1,0] clamp
  v_pk_fma_f16 v186, v186, v50, 0.5 op_sel_hi:[1,1,0] clamp
  v_mfma_f32_32x32x16_bf16 v[16:31], a[72:75], v[160:163], 0
  ds_read_b128 v[192:195], v1 offset:26624
  ds_read_b128 v[196:199], v1 offset:27648
  v_pk_fma_f16 v187, v187, v51, 0.5 op_sel_hi:[1,1,0] clamp
  v_pk_mul_f16 v184, v184, v48
  v_pk_mul_f16 v185, v185, v49
  v_pk_mul_f16 v186, v186, v50
  v_mfma_f32_32x32x16_bf16 v[16:31], a[76:79], v[164:167], v[16:31]
  ds_read_b128 v[200:203], v1 offset:28672
  ds_read_b128 v[204:207], v1 offset:29696
  v_pk_mul_f16 v187, v187, v51
  v_pk_fma_f16 v56, v52, v52, s20 op_sel_hi:[1,1,0]
  v_pk_fma_f16 v57, v53, v53, s20 op_sel_hi:[1,1,0]
  v_pk_fma_f16 v58, v54, v54, s20 op_sel_hi:[1,1,0]
  v_mfma_f32_32x32x16_bf16 v[16:31], a[80:83], v[168:171], v[16:31]
  ds_read_b128 v[208:211], v1 offset:30720
  ds_read_b128 v[212:215], v1 offset:31744
  v_pk_fma_f16 v59, v55, v55, s20 op_sel_hi:[1,1,0]
  v_pk_fma_f16 v56, v56, v56, s20 op_sel:[0,0,1]
  v_pk_fma_f16 v57, v57, v57, s20 op_sel:[0,0,1]
  v_pk_fma_f16 v58, v58, v58, s20 op_sel:[0,0,1]
  v_mfma_f32_32x32x16_bf16 v[16:31], a[84:87], v[172:175], v[16:31]
  buffer_load_dword v249, v248, s[4:7], s29 offen
  v_pk_fma_f16 v59, v59, v59, s20 op_sel:[0,0,1]
  v_pk_fma_f16 v188, v56, v56, s21 op_sel_hi:[1,1,0]
  v_pk_fma_f16 v189, v57, v57, s21 op_sel_hi:[1,1,0]
  v_pk_fma_f16 v190, v58, v58, s21 op_sel_hi:[1,1,0]
  v_pk_fma_f16 v191, v59, v59, s21 op_sel_hi:[1,1,0]
  v_mfma_f32_32x32x16_bf16 v[16:31], a[88:91], v[176:179], v[16:31]
  v_pk_fma_f16 v188, v188, v56, s21 op_sel:[0,0,1]
  v_pk_fma_f16 v189, v189, v57, s21 op_sel:[0,0,1]
  v_pk_fma_f16 v190, v190, v58, s21 op_sel:[0,0,1]
  v_pk_fma_f16 v191, v191, v59, s21 op_sel:[0,0,1]
  v_mfma_f32_32x32x16_bf16 v[16:31], a[92:95], v[180:183], v[16:31]
  s_waitcnt lgkmcnt(0)
  v_pk_fma_f16 v188, v188, v52, 0.5 op_sel_hi:[1,1,0] clamp
  v_pk_fma_f16 v189, v189, v53, 0.5 op_sel_hi:[1,1,0] clamp
  v_pk_fma_f16 v190, v190, v54, 0.5 op_sel_hi:[1,1,0] clamp
  v_pk_fma_f16 v191, v191, v55, 0.5 op_sel_hi:[1,1,0] clamp
  v_pk_mul_f16 v188, v188, v52
  v_pk_mul_f16 v189, v189, v53
  v_mfma_f32_32x32x16_f16 v[64:79], v[192:195], v[184:187], v[64:79]
  s_waitcnt vmcnt(3)
  ds_read_b128 v[220:223], v4 offset:96
  v_pk_mul_f16 v190, v190, v54
  v_pk_mul_f16 v191, v191, v55
  v_mfma_f32_32x32x16_f16 v[80:95], v[196:199], v[184:187], v[80:95]
  ds_read_b128 v[228:231], v4 offset:288
  v_cvt_pk_f16_f32 v48, v16, v17
  v_cvt_pk_f16_f32 v49, v18, v19
  v_cvt_pk_f16_f32 v50, v20, v21
  v_cvt_pk_f16_f32 v51, v22, v23
  v_cvt_pk_f16_f32 v52, v24, v25
  v_mfma_f32_32x32x16_f16 v[96:111], v[200:203], v[184:187], v[96:111]
  ds_read_b128 v[236:239], v4 offset:480
  v_cvt_pk_f16_f32 v53, v26, v27
  v_cvt_pk_f16_f32 v54, v28, v29
  v_cvt_pk_f16_f32 v55, v30, v31
  v_pk_fma_f16 v56, v48, v48, s20 op_sel_hi:[1,1,0]
  v_pk_fma_f16 v57, v49, v49, s20 op_sel_hi:[1,1,0]
  v_mfma_f32_32x32x16_f16 v[64:79], v[204:207], v[188:191], v[64:79]
  v_pk_fma_f16 v58, v50, v50, s20 op_sel_hi:[1,1,0]
  v_pk_fma_f16 v59, v51, v51, s20 op_sel_hi:[1,1,0]
  v_pk_fma_f16 v56, v56, v56, s20 op_sel:[0,0,1]
  v_pk_fma_f16 v57, v57, v57, s20 op_sel:[0,0,1]
  v_pk_fma_f16 v58, v58, v58, s20 op_sel:[0,0,1]
  v_pk_fma_f16 v59, v59, v59, s20 op_sel:[0,0,1]
  v_mfma_f32_32x32x16_f16 v[80:95], v[208:211], v[188:191], v[80:95]
  v_pk_fma_f16 v184, v56, v56, s21 op_sel_hi:[1,1,0]
  v_pk_fma_f16 v185, v57, v57, s21 op_sel_hi:[1,1,0]
  v_pk_fma_f16 v186, v58, v58, s21 op_sel_hi:[1,1,0]
  v_pk_fma_f16 v187, v59, v59, s21 op_sel_hi:[1,1,0]
  v_pk_fma_f16 v184, v184, v56, s21 op_sel:[0,0,1]
  v_pk_fma_f16 v185, v185, v57, s21 op_sel:[0,0,1]
  v_mfma_f32_32x32x16_f16 v[96:111], v[212:215], v[188:191], v[96:111]
  s_nop 0
  s_waitcnt lgkmcnt(0)
  v_pk_fma_f16 v186, v186, v58, s21 op_sel:[0,0,1]
  v_pk_fma_f16 v187, v187, v59, s21 op_sel:[0,0,1]
  v_pk_fma_f16 v184, v184, v48, 0.5 op_sel_hi:[1,1,0] clamp
  v_pk_fma_f16 v185, v185, v49, 0.5 op_sel_hi:[1,1,0] clamp
  v_pk_fma_f16 v186, v186, v50, 0.5 op_sel_hi:[1,1,0] clamp
  v_pk_fma_f16 v187, v187, v51, 0.5 op_sel_hi:[1,1,0] clamp
  v_mfma_f32_32x32x16_bf16 v[16:31], a[96:99], v[160:163], 0
  ds_read_b128 v[192:195], v0 offset:24576
  ds_read_b128 v[196:199], v0 offset:25600
  v_pk_mul_f16 v184, v184, v48
  v_pk_mul_f16 v185, v185, v49
  v_pk_mul_f16 v186, v186, v50
  v_pk_mul_f16 v187, v187, v51
  v_mfma_f32_16x16x32_bf16 v[136:139], a[240:243], v[220:223], 0
  ds_read_b128 v[216:219], v3 offset:2800
  ds_read_b128 v[220:223], v4 offset:112
  v_mfma_f32_32x32x16_bf16 v[16:31], a[100:103], v[164:167], v[16:31]
  ds_read_b128 v[200:203], v0 offset:26624
  ds_read_b128 v[204:207], v0 offset:27648
  v_pk_fma_f16 v56, v52, v52, s20 op_sel_hi:[1,1,0]
  v_pk_fma_f16 v57, v53, v53, s20 op_sel_hi:[1,1,0]
  v_pk_fma_f16 v58, v54, v54, s20 op_sel_hi:[1,1,0]
  v_pk_fma_f16 v59, v55, v55, s20 op_sel_hi:[1,1,0]
  v_mfma_f32_16x16x32_bf16 v[136:139], a[244:247], v[228:231], v[136:139]
  ds_read_b128 v[224:227], v3 offset:7600
  ds_read_b128 v[228:231], v4 offset:304
  v_mfma_f32_32x32x16_bf16 v[16:31], a[104:107], v[168:171], v[16:31]
  ds_read_b128 v[208:211], v0 offset:28672
  ds_read_b128 v[212:215], v0 offset:29696
  v_pk_fma_f16 v56, v56, v56, s20 op_sel:[0,0,1]
  v_pk_fma_f16 v57, v57, v57, s20 op_sel:[0,0,1]
  v_pk_fma_f16 v58, v58, v58, s20 op_sel:[0,0,1]
  v_pk_fma_f16 v59, v59, v59, s20 op_sel:[0,0,1]
  v_mfma_f32_16x16x32_bf16 v[136:139], a[248:251], v[236:239], v[136:139]
  ds_read_b128 v[232:235], v3 offset:12400
  ds_read_b128 v[236:239], v4 offset:496
  v_mfma_f32_32x32x16_bf16 v[16:31], a[108:111], v[172:175], v[16:31]
  buffer_store_dwordx4 v[120:123], v10, s[8:11], s28 offen offset:64
  v_pk_fma_f16 v188, v56, v56, s21 op_sel_hi:[1,1,0]
  v_pk_fma_f16 v189, v57, v57, s21 op_sel_hi:[1,1,0]
  v_pk_fma_f16 v190, v58, v58, s21 op_sel_hi:[1,1,0]
  v_pk_fma_f16 v191, v59, v59, s21 op_sel_hi:[1,1,0]
  v_pk_fma_f16 v188, v188, v56, s21 op_sel:[0,0,1]
  v_mfma_f32_32x32x16_bf16 v[16:31], a[112:115], v[176:179], v[16:31]
  v_add_f32 v12, v136, v138
  v_add_f32 v13, v137, v139
  v_pk_fma_f16 v189, v189, v57, s21 op_sel:[0,0,1]
  v_mul_f32_e64 v14, v136, v136
  v_mul_f32 v15, v137, v137
  v_pk_fma_f16 v190, v190, v58, s21 op_sel:[0,0,1]
  v_mfma_f32_32x32x16_bf16 v[16:31], a[116:119], v[180:183], v[16:31]
  s_waitcnt lgkmcnt(0)
  v_pk_fma_f16 v191, v191, v59, s21 op_sel:[0,0,1]
  v_pk_fma_f16 v188, v188, v52, 0.5 op_sel_hi:[1,1,0] clamp
  v_pk_fma_f16 v189, v189, v53, 0.5 op_sel_hi:[1,1,0] clamp
  v_pk_fma_f16 v190, v190, v54, 0.5 op_sel_hi:[1,1,0] clamp
  v_pk_fma_f16 v191, v191, v55, 0.5 op_sel_hi:[1,1,0] clamp
  v_pk_mul_f16 v188, v188, v52
  v_mfma_f32_32x32x16_f16 v[64:79], v[192:195], v[184:187], v[64:79]
  v_pk_mul_f16 v189, v189, v53
  v_pk_mul_f16 v190, v190, v54
  v_fmac_f32_e64 v14, v138, v138
  v_pk_mul_f16 v191, v191, v55
  v_fmac_f32_e64 v15, v139, v139
  v_mfma_f32_16x16x32_bf16 v[140:143], v[216:219], v[220:223], 0
  ds_read_b128 v[220:223], v4 offset:128
  v_cvt_pk_f16_f32 v48, v16, v17
  v_mfma_f32_32x32x16_f16 v[80:95], v[196:199], v[184:187], v[80:95]
  v_cvt_pk_f16_f32 v49, v18, v19
  v_cvt_pk_f16_f32 v50, v20, v21
  v_cvt_pk_f16_f32 v51, v22, v23
  v_cvt_pk_f16_f32 v52, v24, v25
  v_cvt_pk_f16_f32 v53, v26, v27
  v_cvt_pk_f16_f32 v54, v28, v29
  v_mfma_f32_16x16x32_bf16 v[140:143], v[224:227], v[228:231], v[140:143]
  ds_read_b128 v[224:227], v3 offset:8000
  ds_read_b128 v[228:231], v4 offset:320
  v_mfma_f32_32x32x16_f16 v[96:111], v[200:203], v[184:187], v[96:111]
  s_nop 0
  s_sub_u32 s31, s32, 32
  v_cvt_pk_f16_f32 v55, v30, v31
  v_pk_fma_f16 v56, v48, v48, s20 op_sel_hi:[1,1,0]
  v_pk_fma_f16 v57, v49, v49, s20 op_sel_hi:[1,1,0]
  v_pk_fma_f16 v58, v50, v50, s20 op_sel_hi:[1,1,0]
  v_pk_fma_f16 v59, v51, v51, s20 op_sel_hi:[1,1,0]
  v_pk_fma_f16 v56, v56, v56, s20 op_sel:[0,0,1]
  v_mfma_f32_16x16x32_bf16 v[140:143], v[232:235], v[236:239], v[140:143]
  ds_read_b128 v[232:235], v3 offset:12800
  ds_read_b128 v[236:239], v4 offset:512
  v_mfma_f32_32x32x16_f16 v[64:79], v[204:207], v[188:191], v[64:79]
  v_pk_fma_f16 v57, v57, v57, s20 op_sel:[0,0,1]
  v_pk_fma_f16 v58, v58, v58, s20 op_sel:[0,0,1]
  v_pk_fma_f16 v59, v59, v59, s20 op_sel:[0,0,1]
  v_pk_fma_f16 v184, v56, v56, s21 op_sel_hi:[1,1,0]
  v_pk_fma_f16 v185, v57, v57, s21 op_sel_hi:[1,1,0]
  v_pk_fma_f16 v186, v58, v58, s21 op_sel_hi:[1,1,0]
  v_mfma_f32_32x32x16_f16 v[80:95], v[208:211], v[188:191], v[80:95]
  v_pk_fma_f16 v187, v59, v59, s21 op_sel_hi:[1,1,0]
  v_pk_fma_f16 v184, v184, v56, s21 op_sel:[0,0,1]
  v_pk_fma_f16 v185, v185, v57, s21 op_sel:[0,0,1]
  v_pk_fma_f16 v186, v186, v58, s21 op_sel:[0,0,1]
  v_pk_fma_f16 v187, v187, v59, s21 op_sel:[0,0,1]
  v_pk_fma_f16 v184, v184, v48, 0.5 op_sel_hi:[1,1,0] clamp
  v_mfma_f32_32x32x16_f16 v[96:111], v[212:215], v[188:191], v[96:111]
  s_nop 0
  s_waitcnt lgkmcnt(0)
  v_pk_fma_f16 v185, v185, v49, 0.5 op_sel_hi:[1,1,0] clamp
  v_pk_fma_f16 v186, v186, v50, 0.5 op_sel_hi:[1,1,0] clamp
  v_pk_fma_f16 v187, v187, v51, 0.5 op_sel_hi:[1,1,0] clamp
  v_pk_mul_f16 v184, v184, v48
  v_pk_mul_f16 v185, v185, v49
  v_pk_mul_f16 v186, v186, v50
  v_mfma_f32_32x32x16_bf16 v[16:31], a[120:123], v[160:163], 0
  ds_read_b128 v[192:195], v0 offset:30720
  ds_read_b128 v[196:199], v0 offset:31744
  v_pk_mul_f16 v187, v187, v51
  v_pk_fma_f16 v56, v52, v52, s20 op_sel_hi:[1,1,0]
  v_pk_fma_f16 v57, v53, v53, s20 op_sel_hi:[1,1,0]
  v_pk_fma_f16 v58, v54, v54, s20 op_sel_hi:[1,1,0]
  v_mfma_f32_16x16x32_bf16 v[144:147], a[252:255], v[220:223], 0
  ds_read_b128 v[216:219], v3 offset:3600
  ds_read_b128 v[220:223], v4 offset:144
  v_mfma_f32_32x32x16_bf16 v[16:31], a[124:127], v[164:167], v[16:31]
  ds_read_b128 v[200:203], v0 offset:32768
  ds_read_b128 v[204:207], v0 offset:33792
  v_pk_fma_f16 v59, v55, v55, s20 op_sel_hi:[1,1,0]
  v_pk_fma_f16 v56, v56, v56, s20 op_sel:[0,0,1]
  v_pk_fma_f16 v57, v57, v57, s20 op_sel:[0,0,1]
  v_pk_fma_f16 v58, v58, v58, s20 op_sel:[0,0,1]
  v_mfma_f32_16x16x32_bf16 v[144:147], v[224:227], v[228:231], v[144:147]
  ds_read_b128 v[224:227], v3 offset:8400
  ds_read_b128 v[228:231], v4 offset:336
  v_mfma_f32_32x32x16_bf16 v[16:31], a[128:131], v[168:171], v[16:31]
  ds_read_b128 v[208:211], v0 offset:34816
  ds_read_b128 v[212:215], v0 offset:35840
  v_pk_fma_f16 v59, v59, v59, s20 op_sel:[0,0,1]
  v_pk_fma_f16 v188, v56, v56, s21 op_sel_hi:[1,1,0]
  v_pk_fma_f16 v189, v57, v57, s21 op_sel_hi:[1,1,0]
  v_pk_fma_f16 v190, v58, v58, s21 op_sel_hi:[1,1,0]
  v_mfma_f32_16x16x32_bf16 v[144:147], v[232:235], v[236:239], v[144:147]
  ds_read_b128 v[232:235], v3 offset:13200
  ds_read_b128 v[236:239], v4 offset:528
  v_mfma_f32_32x32x16_bf16 v[16:31], a[132:135], v[172:175], v[16:31]
  buffer_store_dwordx4 v[124:127], v10, s[8:11], s28 offen offset:96
  v_pk_fma_f16 v191, v59, v59, s21 op_sel_hi:[1,1,0]
  v_pk_fma_f16 v188, v188, v56, s21 op_sel:[0,0,1]
  v_pk_fma_f16 v189, v189, v57, s21 op_sel:[0,0,1]
  v_pk_fma_f16 v190, v190, v58, s21 op_sel:[0,0,1]
  v_pk_fma_f16 v191, v191, v59, s21 op_sel:[0,0,1]
  v_mfma_f32_32x32x16_bf16 v[16:31], a[136:139], v[176:179], v[16:31]
  v_add_f32 v12, v12, v140
  v_add_f32 v13, v13, v141
  v_fmac_f32 v14, v140, v140
  v_fmac_f32 v15, v141, v141
  v_add_f32_e64 v12, v12, v142
  v_add_f32 v13, v13, v143
  v_mfma_f32_32x32x16_bf16 v[16:31], a[140:143], v[180:183], v[16:31]
  s_waitcnt lgkmcnt(0)
  v_pk_fma_f16 v188, v188, v52, 0.5 op_sel_hi:[1,1,0] clamp
  v_pk_fma_f16 v189, v189, v53, 0.5 op_sel_hi:[1,1,0] clamp
  v_pk_fma_f16 v190, v190, v54, 0.5 op_sel_hi:[1,1,0] clamp
  v_pk_fma_f16 v191, v191, v55, 0.5 op_sel_hi:[1,1,0] clamp
  v_pk_mul_f16 v188, v188, v52
  v_pk_mul_f16 v189, v189, v53
  v_mfma_f32_32x32x16_f16 v[64:79], v[192:195], v[184:187], v[64:79]
  v_fmac_f32 v14, v142, v142
  v_fmac_f32 v15, v143, v143
  v_pk_mul_f16 v190, v190, v54
  v_add_f32 v12, v12, v144
  v_add_f32 v13, v13, v145
  v_pk_mul_f16 v191, v191, v55
  v_mfma_f32_16x16x32_bf16 v[148:151], v[216:219], v[220:223], 0
  ds_read_b128 v[216:219], v3 offset:4000
  ds_read_b128 v[220:223], v4 offset:160
  v_mfma_f32_32x32x16_f16 v[80:95], v[196:199], v[184:187], v[80:95]
  v_cvt_pk_f16_f32 v48, v16, v17
  v_cvt_pk_f16_f32 v49, v18, v19
  v_cvt_pk_f16_f32 v50, v20, v21
  v_cvt_pk_f16_f32 v51, v22, v23
  v_cvt_pk_f16_f32 v52, v24, v25
  v_cvt_pk_f16_f32 v53, v26, v27
  v_mfma_f32_16x16x32_bf16 v[148:151], v[224:227], v[228:231], v[148:151]
  ds_read_b128 v[224:227], v3 offset:8800
  ds_read_b128 v[228:231], v4 offset:352
  v_mfma_f32_32x32x16_f16 v[96:111], v[200:203], v[184:187], v[96:111]
  v_cvt_pk_f16_f32 v54, v28, v29
  v_cvt_pk_f16_f32 v55, v30, v31
  v_pk_fma_f16 v56, v48, v48, s20 op_sel_hi:[1,1,0]
  v_pk_fma_f16 v57, v49, v49, s20 op_sel_hi:[1,1,0]
  v_pk_fma_f16 v58, v50, v50, s20 op_sel_hi:[1,1,0]
  v_pk_fma_f16 v59, v51, v51, s20 op_sel_hi:[1,1,0]
  v_mfma_f32_16x16x32_bf16 v[148:151], v[232:235], v[236:239], v[148:151]
  ds_read_b128 v[232:235], v3 offset:13600
  ds_read_b128 v[236:239], v4 offset:544
  v_mfma_f32_32x32x16_f16 v[64:79], v[204:207], v[188:191], v[64:79]
  v_pk_fma_f16 v56, v56, v56, s20 op_sel:[0,0,1]
  v_pk_fma_f16 v57, v57, v57, s20 op_sel:[0,0,1]
  v_pk_fma_f16 v58, v58, v58, s20 op_sel:[0,0,1]
  v_pk_fma_f16 v59, v59, v59, s20 op_sel:[0,0,1]
  v_pk_fma_f16 v184, v56, v56, s21 op_sel_hi:[1,1,0]
  v_pk_fma_f16 v185, v57, v57, s21 op_sel_hi:[1,1,0]
  v_mfma_f32_32x32x16_f16 v[80:95], v[208:211], v[188:191], v[80:95]
  v_pk_fma_f16 v186, v58, v58, s21 op_sel_hi:[1,1,0]
  v_pk_fma_f16 v187, v59, v59, s21 op_sel_hi:[1,1,0]
  v_pk_fma_f16 v184, v184, v56, s21 op_sel:[0,0,1]
  v_pk_fma_f16 v185, v185, v57, s21 op_sel:[0,0,1]
  v_pk_fma_f16 v186, v186, v58, s21 op_sel:[0,0,1]
  v_pk_fma_f16 v187, v187, v59, s21 op_sel:[0,0,1]
  v_mfma_f32_32x32x16_f16 v[96:111], v[212:215], v[188:191], v[96:111]
  s_nop 0
  s_waitcnt lgkmcnt(0)
  v_pk_fma_f16 v184, v184, v48, 0.5 op_sel_hi:[1,1,0] clamp
  v_pk_fma_f16 v185, v185, v49, 0.5 op_sel_hi:[1,1,0] clamp
  v_pk_fma_f16 v186, v186, v50, 0.5 op_sel_hi:[1,1,0] clamp
  v_pk_fma_f16 v187, v187, v51, 0.5 op_sel_hi:[1,1,0] clamp
  v_pk_mul_f16 v184, v184, v48
  v_pk_mul_f16 v185, v185, v49
  v_mfma_f32_32x32x16_bf16 v[16:31], a[144:147], v[160:163], 0
  ds_read_b128 v[192:195], v0 offset:36864
  ds_read_b128 v[196:199], v0 offset:37888
  v_pk_mul_f16 v186, v186, v50
  v_pk_mul_f16 v187, v187, v51
  v_pk_fma_f16 v56, v52, v52, s20 op_sel_hi:[1,1,0]
  v_pk_fma_f16 v57, v53, v53, s20 op_sel_hi:[1,1,0]
  v_mfma_f32_16x16x32_bf16 v[152:155], v[216:219], v[220:223], 0
  ds_read_b128 v[216:219], v3 offset:4400
  ds_read_b128 v[220:223], v4 offset:176
  v_mfma_f32_32x32x16_bf16 v[16:31], a[148:151], v[164:167], v[16:31]
  ds_read_b128 v[200:203], v0 offset:38912
  ds_read_b128 v[204:207], v0 offset:39936
  v_pk_fma_f16 v58, v54, v54, s20 op_sel_hi:[1,1,0]
  v_pk_fma_f16 v59, v55, v55, s20 op_sel_hi:[1,1,0]
  v_pk_fma_f16 v56, v56, v56, s20 op_sel:[0,0,1]
  v_pk_fma_f16 v57, v57, v57, s20 op_sel:[0,0,1]
  v_mfma_f32_16x16x32_bf16 v[152:155], v[224:227], v[228:231], v[152:155]
  ds_read_b128 v[224:227], v3 offset:9200
  ds_read_b128 v[228:231], v4 offset:368
  v_mfma_f32_32x32x16_bf16 v[16:31], a[152:155], v[168:171], v[16:31]
  ds_read_b128 v[208:211], v0 offset:40960
  ds_read_b128 v[212:215], v0 offset:41984
  v_pk_fma_f16 v58, v58, v58, s20 op_sel:[0,0,1]
  v_pk_fma_f16 v59, v59, v59, s20 op_sel:[0,0,1]
  v_pk_fma_f16 v188, v56, v56, s21 op_sel_hi:[1,1,0]
  v_pk_fma_f16 v189, v57, v57, s21 op_sel_hi:[1,1,0]
  v_mfma_f32_16x16x32_bf16 v[152:155], v[232:235], v[236:239], v[152:155]
  ds_read_b128 v[232:235], v3 offset:14000
  ds_read_b128 v[236:239], v4 offset:560
  v_mfma_f32_32x32x16_bf16 v[16:31], a[156:159], v[172:175], v[16:31]
  v_pk_fma_f16 v190, v58, v58, s21 op_sel_hi:[1,1,0]
  v_pk_fma_f16 v191, v59, v59, s21 op_sel_hi:[1,1,0]
  v_pk_fma_f16 v188, v188, v56, s21 op_sel:[0,0,1]
  v_pk_fma_f16 v189, v189, v57, s21 op_sel:[0,0,1]
  v_pk_fma_f16 v190, v190, v58, s21 op_sel:[0,0,1]
  v_pk_fma_f16 v191, v191, v59, s21 op_sel:[0,0,1]
  v_mfma_f32_32x32x16_bf16 v[16:31], a[160:163], v[176:179], v[16:31]
  v_fmac_f32 v14, v144, v144
  v_fmac_f32 v15, v145, v145
  v_add_f32 v12, v12, v146
  v_add_f32 v13, v13, v147
  v_fmac_f32_e64 v14, v146, v146
  v_fmac_f32 v15, v147, v147
  v_mfma_f32_32x32x16_bf16 v[16:31], a[164:167], v[180:183], v[16:31]
  s_waitcnt lgkmcnt(0)
  v_pk_fma_f16 v188, v188, v52, 0.5 op_sel_hi:[1,1,0] clamp
  v_pk_fma_f16 v189, v189, v53, 0.5 op_sel_hi:[1,1,0] clamp
  v_pk_fma_f16 v190, v190, v54, 0.5 op_sel_hi:[1,1,0] clamp
  v_pk_fma_f16 v191, v191, v55, 0.5 op_sel_hi:[1,1,0] clamp
  v_pk_mul_f16 v188, v188, v52
  v_pk_mul_f16 v189, v189, v53
  v_mfma_f32_32x32x16_f16 v[64:79], v[192:195], v[184:187], v[64:79]
  v_add_f32 v12, v12, v148
  v_add_f32 v13, v13, v149
  v_pk_mul_f16 v190, v190, v54
  v_fmac_f32 v14, v148, v148
  v_fmac_f32 v15, v149, v149
  v_pk_mul_f16 v191, v191, v55
  v_mfma_f32_16x16x32_bf16 v[156:159], v[216:219], v[220:223], 0
  ds_read_b128 v[216:219], v3
  ds_read_b128 v[220:223], v4
  v_mfma_f32_32x32x16_f16 v[80:95], v[196:199], v[184:187], v[80:95]
  v_cvt_pk_f16_f32 v48, v16, v17
  v_cvt_pk_f16_f32 v49, v18, v19
  v_cvt_pk_f16_f32 v50, v20, v21
  v_cvt_pk_f16_f32 v51, v22, v23
  v_cvt_pk_f16_f32 v52, v24, v25
  v_cvt_pk_f16_f32 v53, v26, v27
  v_mfma_f32_16x16x32_bf16 v[156:159], v[224:227], v[228:231], v[156:159]
  ds_read_b128 v[224:227], v3 offset:4800
  ds_read_b128 v[228:231], v4 offset:192
  v_mfma_f32_32x32x16_f16 v[96:111], v[200:203], v[184:187], v[96:111]
  v_cvt_pk_f16_f32 v54, v28, v29
  v_cvt_pk_f16_f32 v55, v30, v31
  v_pk_fma_f16 v56, v48, v48, s20 op_sel_hi:[1,1,0]
  v_pk_fma_f16 v57, v49, v49, s20 op_sel_hi:[1,1,0]
  v_pk_fma_f16 v58, v50, v50, s20 op_sel_hi:[1,1,0]
  v_pk_fma_f16 v59, v51, v51, s20 op_sel_hi:[1,1,0]
  v_mfma_f32_16x16x32_bf16 v[156:159], v[232:235], v[236:239], v[156:159]
  ds_read_b128 v[232:235], v3 offset:9600
  ds_read_b128 v[236:239], v4 offset:384
  v_mfma_f32_32x32x16_f16 v[64:79], v[204:207], v[188:191], v[64:79]
  v_pk_fma_f16 v56, v56, v56, s20 op_sel:[0,0,1]
  v_pk_fma_f16 v57, v57, v57, s20 op_sel:[0,0,1]
  v_pk_fma_f16 v58, v58, v58, s20 op_sel:[0,0,1]
  v_pk_fma_f16 v59, v59, v59, s20 op_sel:[0,0,1]
  v_pk_fma_f16 v184, v56, v56, s21 op_sel_hi:[1,1,0]
  v_pk_fma_f16 v185, v57, v57, s21 op_sel_hi:[1,1,0]
  v_mfma_f32_32x32x16_f16 v[80:95], v[208:211], v[188:191], v[80:95]
  v_pk_fma_f16 v186, v58, v58, s21 op_sel_hi:[1,1,0]
  v_pk_fma_f16 v187, v59, v59, s21 op_sel_hi:[1,1,0]
  v_pk_fma_f16 v184, v184, v56, s21 op_sel:[0,0,1]
  v_pk_fma_f16 v185, v185, v57, s21 op_sel:[0,0,1]
  v_pk_fma_f16 v186, v186, v58, s21 op_sel:[0,0,1]
  v_pk_fma_f16 v187, v187, v59, s21 op_sel:[0,0,1]
  v_mfma_f32_32x32x16_f16 v[96:111], v[212:215], v[188:191], v[96:111]
  s_nop 0
  s_waitcnt lgkmcnt(0)
  v_pk_fma_f16 v184, v184, v48, 0.5 op_sel_hi:[1,1,0] clamp
  v_pk_fma_f16 v185, v185, v49, 0.5 op_sel_hi:[1,1,0] clamp
  v_pk_fma_f16 v186, v186, v50, 0.5 op_sel_hi:[1,1,0] clamp
  v_pk_fma_f16 v187, v187, v51, 0.5 op_sel_hi:[1,1,0] clamp
  v_pk_mul_f16 v184, v184, v48
  v_pk_mul_f16 v185, v185, v49
  v_mfma_f32_32x32x16_bf16 v[16:31], a[168:171], v[160:163], 0
  ds_read_b128 v[192:195], v0 offset:43008
  ds_read_b128 v[196:199], v0 offset:44032
  v_pk_mul_f16 v186, v186, v50
  v_pk_mul_f16 v187, v187, v51
  v_pk_fma_f16 v56, v52, v52, s20 op_sel_hi:[1,1,0]
  v_pk_fma_f16 v57, v53, v53, s20 op_sel_hi:[1,1,0]
  v_mfma_f32_16x16x32_bf16 v[112:115], v[216:219], v[220:223], 0
  ds_read_b128 v[216:219], v3 offset:400
  ds_read_b128 v[220:223], v4 offset:16
  v_mfma_f32_32x32x16_bf16 v[16:31], a[172:175], v[164:167], v[16:31]
  ds_read_b128 v[200:203], v0 offset:45056
  ds_read_b128 v[204:207], v0 offset:46080
  v_pk_fma_f16 v58, v54, v54, s20 op_sel_hi:[1,1,0]
  v_pk_fma_f16 v59, v55, v55, s20 op_sel_hi:[1,1,0]
  v_pk_fma_f16 v56, v56, v56, s20 op_sel:[0,0,1]
  v_pk_fma_f16 v57, v57, v57, s20 op_sel:[0,0,1]
  v_mfma_f32_16x16x32_bf16 v[112:115], v[224:227], v[228:231], v[112:115]
  ds_read_b128 v[224:227], v3 offset:5200
  ds_read_b128 v[228:231], v4 offset:208
  v_mfma_f32_32x32x16_bf16 v[16:31], a[176:179], v[168:171], v[16:31]
  ds_read_b128 v[208:211], v0 offset:47104
  ds_read_b128 v[212:215], v0 offset:48128
  v_pk_fma_f16 v58, v58, v58, s20 op_sel:[0,0,1]
  v_pk_fma_f16 v59, v59, v59, s20 op_sel:[0,0,1]
  v_pk_fma_f16 v188, v56, v56, s21 op_sel_hi:[1,1,0]
  v_pk_fma_f16 v189, v57, v57, s21 op_sel_hi:[1,1,0]
  v_mfma_f32_16x16x32_bf16 v[112:115], v[232:235], v[236:239], v[112:115]
  ds_read_b128 v[232:235], v3 offset:10000
  ds_read_b128 v[236:239], v4 offset:400
  v_mfma_f32_32x32x16_bf16 v[16:31], a[180:183], v[172:175], v[16:31]
  buffer_store_dwordx4 v[128:131], v10, s[8:11], s28 offen offset:128
  v_pk_fma_f16 v190, v58, v58, s21 op_sel_hi:[1,1,0]
  v_pk_fma_f16 v191, v59, v59, s21 op_sel_hi:[1,1,0]
  v_pk_fma_f16 v188, v188, v56, s21 op_sel:[0,0,1]
  v_pk_fma_f16 v189, v189, v57, s21 op_sel:[0,0,1]
  v_pk_fma_f16 v190, v190, v58, s21 op_sel:[0,0,1]
  v_mfma_f32_32x32x16_bf16 v[16:31], a[184:187], v[176:179], v[16:31]
  v_add_f32 v12, v12, v150
  v_add_f32 v13, v13, v151
  v_fmac_f32 v14, v150, v150
  v_fmac_f32 v15, v151, v151
  v_add_f32 v12, v12, v152
  v_pk_fma_f16 v191, v191, v59, s21 op_sel:[0,0,1]
  v_mfma_f32_32x32x16_bf16 v[16:31], a[188:191], v[180:183], v[16:31]
  s_waitcnt lgkmcnt(0)
  v_pk_fma_f16 v188, v188, v52, 0.5 op_sel_hi:[1,1,0] clamp
  v_pk_fma_f16 v189, v189, v53, 0.5 op_sel_hi:[1,1,0] clamp
  v_pk_fma_f16 v190, v190, v54, 0.5 op_sel_hi:[1,1,0] clamp
  v_pk_fma_f16 v191, v191, v55, 0.5 op_sel_hi:[1,1,0] clamp
  v_pk_mul_f16 v188, v188, v52
  v_pk_mul_f16 v189, v189, v53
  v_mfma_f32_32x32x16_f16 v[64:79], v[192:195], v[184:187], v[64:79]
  v_add_f32 v13, v13, v153
  v_fmac_f32 v14, v152, v152
  v_pk_mul_f16 v190, v190, v54
  v_fmac_f32 v15, v153, v153
  v_add_f32 v12, v12, v154
  v_pk_mul_f16 v191, v191, v55
  v_mfma_f32_16x16x32_bf16 v[116:119], v[216:219], v[220:223], 0
  ds_read_b128 v[216:219], v3 offset:800
  ds_read_b128 v[220:223], v4 offset:32
  v_mfma_f32_32x32x16_f16 v[80:95], v[196:199], v[184:187], v[80:95]
  v_cvt_pk_f16_f32 v48, v16, v17
  v_cvt_pk_f16_f32 v49, v18, v19
  v_cvt_pk_f16_f32 v50, v20, v21
  v_cvt_pk_f16_f32 v51, v22, v23
  v_cvt_pk_f16_f32 v52, v24, v25
  v_cvt_pk_f16_f32 v53, v26, v27
  v_mfma_f32_16x16x32_bf16 v[116:119], v[224:227], v[228:231], v[116:119]
  ds_read_b128 v[224:227], v3 offset:5600
  ds_read_b128 v[228:231], v4 offset:224
  v_mfma_f32_32x32x16_f16 v[96:111], v[200:203], v[184:187], v[96:111]
  v_cvt_pk_f16_f32 v54, v28, v29
  v_cvt_pk_f16_f32 v55, v30, v31
  v_pk_fma_f16 v56, v48, v48, s20 op_sel_hi:[1,1,0]
  v_pk_fma_f16 v57, v49, v49, s20 op_sel_hi:[1,1,0]
  v_pk_fma_f16 v58, v50, v50, s20 op_sel_hi:[1,1,0]
  v_pk_fma_f16 v59, v51, v51, s20 op_sel_hi:[1,1,0]
  v_mfma_f32_16x16x32_bf16 v[116:119], v[232:235], v[236:239], v[116:119]
  ds_read_b128 v[232:235], v3 offset:10400
  ds_read_b128 v[236:239], v4 offset:416
  v_mfma_f32_32x32x16_f16 v[64:79], v[204:207], v[188:191], v[64:79]
  v_pk_fma_f16 v56, v56, v56, s20 op_sel:[0,0,1]
  v_pk_fma_f16 v57, v57, v57, s20 op_sel:[0,0,1]
  v_pk_fma_f16 v58, v58, v58, s20 op_sel:[0,0,1]
  v_pk_fma_f16 v59, v59, v59, s20 op_sel:[0,0,1]
  v_pk_fma_f16 v184, v56, v56, s21 op_sel_hi:[1,1,0]
  v_pk_fma_f16 v185, v57, v57, s21 op_sel_hi:[1,1,0]
  v_mfma_f32_32x32x16_f16 v[80:95], v[208:211], v[188:191], v[80:95]
  v_pk_fma_f16 v186, v58, v58, s21 op_sel_hi:[1,1,0]
  v_pk_fma_f16 v187, v59, v59, s21 op_sel_hi:[1,1,0]
  v_pk_fma_f16 v184, v184, v56, s21 op_sel:[0,0,1]
  v_pk_fma_f16 v185, v185, v57, s21 op_sel:[0,0,1]
  v_pk_fma_f16 v186, v186, v58, s21 op_sel:[0,0,1]
  v_pk_fma_f16 v187, v187, v59, s21 op_sel:[0,0,1]
  v_mfma_f32_32x32x16_f16 v[96:111], v[212:215], v[188:191], v[96:111]
  s_nop 0
  s_waitcnt lgkmcnt(0)
  v_pk_fma_f16 v184, v184, v48, 0.5 op_sel_hi:[1,1,0] clamp
  v_pk_fma_f16 v185, v185, v49, 0.5 op_sel_hi:[1,1,0] clamp
  v_pk_fma_f16 v186, v186, v50, 0.5 op_sel_hi:[1,1,0] clamp
  v_pk_fma_f16 v187, v187, v51, 0.5 op_sel_hi:[1,1,0] clamp
  v_pk_mul_f16 v184, v184, v48
  v_pk_mul_f16 v185, v185, v49
  v_mfma_f32_32x32x16_bf16 v[16:31], a[192:195], v[160:163], 0
  ds_read_b128 v[192:195], v0 offset:49152
  ds_read_b128 v[196:199], v0 offset:50176
  v_pk_mul_f16 v186, v186, v50
  v_pk_mul_f16 v187, v187, v51
  v_pk_fma_f16 v56, v52, v52, s20 op_sel_hi:[1,1,0]
  v_pk_fma_f16 v57, v53, v53, s20 op_sel_hi:[1,1,0]
  v_mfma_f32_16x16x32_bf16 v[120:123], v[216:219], v[220:223], 0
  ds_read_b128 v[216:219], v3 offset:1200
  ds_read_b128 v[220:223], v4 offset:48
  v_mfma_f32_32x32x16_bf16 v[16:31], a[196:199], v[164:167], v[16:31]
  ds_read_b128 v[200:203], v0 offset:51200
  ds_read_b128 v[204:207], v0 offset:52224
  v_pk_fma_f16 v58, v54, v54, s20 op_sel_hi:[1,1,0]
  v_pk_fma_f16 v59, v55, v55, s20 op_sel_hi:[1,1,0]
  v_pk_fma_f16 v56, v56, v56, s20 op_sel:[0,0,1]
  v_pk_fma_f16 v57, v57, v57, s20 op_sel:[0,0,1]
  v_mfma_f32_16x16x32_bf16 v[120:123], v[224:227], v[228:231], v[120:123]
  ds_read_b128 v[224:227], v3 offset:6000
  ds_read_b128 v[228:231], v4 offset:240
  v_mfma_f32_32x32x16_bf16 v[16:31], a[200:203], v[168:171], v[16:31]
  ds_read_b128 v[208:211], v0 offset:53248
  ds_read_b128 v[212:215], v0 offset:54272
  v_pk_fma_f16 v58, v58, v58, s20 op_sel:[0,0,1]
  v_pk_fma_f16 v59, v59, v59, s20 op_sel:[0,0,1]
  v_pk_fma_f16 v188, v56, v56, s21 op_sel_hi:[1,1,0]
  v_pk_fma_f16 v189, v57, v57, s21 op_sel_hi:[1,1,0]
  v_mfma_f32_16x16x32_bf16 v[120:123], v[232:235], v[236:239], v[120:123]
  ds_read_b128 v[232:235], v3 offset:10800
  ds_read_b128 v[236:239], v4 offset:432
  v_mfma_f32_32x32x16_bf16 v[16:31], a[204:207], v[172:175], v[16:31]
  buffer_store_dwordx4 v[132:135], v10, s[8:11], s28 offen offset:160
  v_pk_fma_f16 v190, v58, v58, s21 op_sel_hi:[1,1,0]
  v_pk_fma_f16 v191, v59, v59, s21 op_sel_hi:[1,1,0]
  v_pk_fma_f16 v188, v188, v56, s21 op_sel:[0,0,1]
  v_pk_fma_f16 v189, v189, v57, s21 op_sel:[0,0,1]
  v_pk_fma_f16 v190, v190, v58, s21 op_sel:[0,0,1]
  v_mfma_f32_32x32x16_bf16 v[16:31], a[208:211], v[176:179], v[16:31]
  v_add_f32 v13, v13, v155
  v_fmac_f32 v14, v154, v154
  v_fmac_f32 v15, v155, v155
  v_add_f32 v12, v12, v156
  v_add_f32 v13, v13, v157
  v_pk_fma_f16 v191, v191, v59, s21 op_sel:[0,0,1]
  v_mfma_f32_32x32x16_bf16 v[16:31], a[212:215], v[180:183], v[16:31]
  s_waitcnt lgkmcnt(0)
  v_pk_fma_f16 v188, v188, v52, 0.5 op_sel_hi:[1,1,0] clamp
  v_pk_fma_f16 v189, v189, v53, 0.5 op_sel_hi:[1,1,0] clamp
  v_pk_fma_f16 v190, v190, v54, 0.5 op_sel_hi:[1,1,0] clamp
  v_pk_fma_f16 v191, v191, v55, 0.5 op_sel_hi:[1,1,0] clamp
  v_pk_mul_f16 v188, v188, v52
  v_pk_mul_f16 v189, v189, v53
  v_mfma_f32_32x32x16_f16 v[64:79], v[192:195], v[184:187], v[64:79]
  v_fmac_f32 v14, v156, v156
  v_fmac_f32 v15, v157, v157
  v_pk_mul_f16 v190, v190, v54
  v_add_f32 v12, v12, v158
  v_add_f32 v13, v13, v159
  v_pk_mul_f16 v191, v191, v55
  v_mfma_f32_16x16x32_bf16 v[124:127], v[216:219], v[220:223], 0
  ds_read_b128 v[216:219], v3 offset:1600
  ds_read_b128 v[220:223], v4 offset:64
  v_mfma_f32_32x32x16_f16 v[80:95], v[196:199], v[184:187], v[80:95]
  v_cvt_pk_f16_f32 v48, v16, v17
  v_cvt_pk_f16_f32 v49, v18, v19
  v_cvt_pk_f16_f32 v50, v20, v21
  v_cvt_pk_f16_f32 v51, v22, v23
  v_cvt_pk_f16_f32 v52, v24, v25
  v_cvt_pk_f16_f32 v53, v26, v27
  v_mfma_f32_16x16x32_bf16 v[124:127], v[224:227], v[228:231], v[124:127]
  ds_read_b128 v[224:227], v3 offset:6400
  ds_read_b128 v[228:231], v4 offset:256
  v_mfma_f32_32x32x16_f16 v[96:111], v[200:203], v[184:187], v[96:111]
  v_cvt_pk_f16_f32 v54, v28, v29
  v_cvt_pk_f16_f32 v55, v30, v31
  v_pk_fma_f16 v56, v48, v48, s20 op_sel_hi:[1,1,0]
  v_pk_fma_f16 v57, v49, v49, s20 op_sel_hi:[1,1,0]
  v_pk_fma_f16 v58, v50, v50, s20 op_sel_hi:[1,1,0]
  v_pk_fma_f16 v59, v51, v51, s20 op_sel_hi:[1,1,0]
  v_mfma_f32_16x16x32_bf16 v[124:127], v[232:235], v[236:239], v[124:127]
  ds_read_b128 v[232:235], v3 offset:11200
  ds_read_b128 v[236:239], v4 offset:448
  v_mfma_f32_32x32x16_f16 v[64:79], v[204:207], v[188:191], v[64:79]
  v_pk_fma_f16 v56, v56, v56, s20 op_sel:[0,0,1]
  v_pk_fma_f16 v57, v57, v57, s20 op_sel:[0,0,1]
  v_pk_fma_f16 v58, v58, v58, s20 op_sel:[0,0,1]
  v_pk_fma_f16 v59, v59, v59, s20 op_sel:[0,0,1]
  v_pk_fma_f16 v184, v56, v56, s21 op_sel_hi:[1,1,0]
  v_pk_fma_f16 v185, v57, v57, s21 op_sel_hi:[1,1,0]
  v_mfma_f32_32x32x16_f16 v[80:95], v[208:211], v[188:191], v[80:95]
  v_pk_fma_f16 v186, v58, v58, s21 op_sel_hi:[1,1,0]
  v_pk_fma_f16 v187, v59, v59, s21 op_sel_hi:[1,1,0]
  v_pk_fma_f16 v184, v184, v56, s21 op_sel:[0,0,1]
  v_pk_fma_f16 v185, v185, v57, s21 op_sel:[0,0,1]
  v_pk_fma_f16 v186, v186, v58, s21 op_sel:[0,0,1]
  v_pk_fma_f16 v187, v187, v59, s21 op_sel:[0,0,1]
  v_mfma_f32_32x32x16_f16 v[96:111], v[212:215], v[188:191], v[96:111]
  s_nop 0
  s_waitcnt lgkmcnt(0)
  v_pk_fma_f16 v184, v184, v48, 0.5 op_sel_hi:[1,1,0] clamp
  v_pk_fma_f16 v185, v185, v49, 0.5 op_sel_hi:[1,1,0] clamp
  v_pk_fma_f16 v186, v186, v50, 0.5 op_sel_hi:[1,1,0] clamp
  v_pk_fma_f16 v187, v187, v51, 0.5 op_sel_hi:[1,1,0] clamp
  v_pk_mul_f16 v184, v184, v48
  v_pk_mul_f16 v185, v185, v49
  v_mfma_f32_32x32x16_bf16 v[16:31], a[216:219], v[160:163], 0
  ds_read_b128 v[192:195], v0 offset:55296
  ds_read_b128 v[196:199], v0 offset:56320
  v_pk_mul_f16 v186, v186, v50
  v_pk_mul_f16 v187, v187, v51
  v_pk_fma_f16 v56, v52, v52, s20 op_sel_hi:[1,1,0]
  v_pk_fma_f16 v57, v53, v53, s20 op_sel_hi:[1,1,0]
  v_mfma_f32_16x16x32_bf16 v[128:131], v[216:219], v[220:223], 0
  ds_read_b128 v[216:219], v3 offset:2000
  ds_read_b128 v[220:223], v4 offset:80
  v_mfma_f32_32x32x16_bf16 v[16:31], a[220:223], v[164:167], v[16:31]
  ds_read_b128 v[200:203], v0 offset:57344
  ds_read_b128 v[204:207], v0 offset:58368
  v_pk_fma_f16 v58, v54, v54, s20 op_sel_hi:[1,1,0]
  v_pk_fma_f16 v59, v55, v55, s20 op_sel_hi:[1,1,0]
  v_pk_fma_f16 v56, v56, v56, s20 op_sel:[0,0,1]
  v_pk_fma_f16 v57, v57, v57, s20 op_sel:[0,0,1]
  v_mfma_f32_16x16x32_bf16 v[128:131], v[224:227], v[228:231], v[128:131]
  ds_read_b128 v[224:227], v3 offset:6800
  ds_read_b128 v[228:231], v4 offset:272
  v_mfma_f32_32x32x16_bf16 v[16:31], a[224:227], v[168:171], v[16:31]
  ds_read_b128 v[208:211], v0 offset:59392
  ds_read_b128 v[212:215], v0 offset:60416
  v_pk_fma_f16 v58, v58, v58, s20 op_sel:[0,0,1]
  v_pk_fma_f16 v59, v59, v59, s20 op_sel:[0,0,1]
  v_pk_fma_f16 v188, v56, v56, s21 op_sel_hi:[1,1,0]
  v_pk_fma_f16 v189, v57, v57, s21 op_sel_hi:[1,1,0]
  v_mfma_f32_16x16x32_bf16 v[128:131], v[232:235], v[236:239], v[128:131]
  ds_read_b128 v[232:235], v3 offset:11600
  ds_read_b128 v[236:239], v4 offset:464
  v_mfma_f32_32x32x16_bf16 v[16:31], a[228:231], v[172:175], v[16:31]
  v_pk_fma_f16 v190, v58, v58, s21 op_sel_hi:[1,1,0]
  v_pk_fma_f16 v191, v59, v59, s21 op_sel_hi:[1,1,0]
  v_fmac_f32_e64 v14, v158, v158
  v_pk_fma_f16 v188, v188, v56, s21 op_sel:[0,0,1]
  v_pk_fma_f16 v189, v189, v57, s21 op_sel:[0,0,1]
  v_fmac_f32_e64 v15, v159, v159
  v_mfma_f32_32x32x16_bf16 v[16:31], a[232:235], v[176:179], v[16:31]
  v_add_f32 v12, v12, v112
  v_add_f32 v13, v13, v113
  v_fmac_f32 v14, v112, v112
  v_fmac_f32 v15, v113, v113
  v_add_f32_e64 v12, v12, v114
  v_add_f32 v13, v13, v115
  v_mfma_f32_32x32x16_bf16 v[16:31], a[236:239], v[180:183], v[16:31]
  s_waitcnt lgkmcnt(0)
  v_pk_fma_f16 v190, v190, v58, s21 op_sel:[0,0,1]
  v_pk_fma_f16 v191, v191, v59, s21 op_sel:[0,0,1]
  v_pk_fma_f16 v188, v188, v52, 0.5 op_sel_hi:[1,1,0] clamp
  v_pk_fma_f16 v189, v189, v53, 0.5 op_sel_hi:[1,1,0] clamp
  v_pk_fma_f16 v190, v190, v54, 0.5 op_sel_hi:[1,1,0] clamp
  v_pk_fma_f16 v191, v191, v55, 0.5 op_sel_hi:[1,1,0] clamp
  v_mfma_f32_32x32x16_f16 v[64:79], v[192:195], v[184:187], v[64:79]
  v_pk_mul_f16 v188, v188, v52
  v_pk_mul_f16 v189, v189, v53
  v_fmac_f32_e64 v14, v114, v114
  v_pk_mul_f16 v190, v190, v54
  v_pk_mul_f16 v191, v191, v55
  v_fmac_f32_e64 v15, v115, v115
  v_mfma_f32_16x16x32_bf16 v[132:135], v[216:219], v[220:223], 0
  v_cvt_pk_f16_f32 v48, v16, v17
  v_cvt_pk_f16_f32 v49, v18, v19
  v_mfma_f32_32x32x16_f16 v[80:95], v[196:199], v[184:187], v[80:95]
  v_cvt_pk_f16_f32 v50, v20, v21
  v_cvt_pk_f16_f32 v51, v22, v23
  v_cvt_pk_f16_f32 v52, v24, v25
  v_cvt_pk_f16_f32 v53, v26, v27
  v_cvt_pk_f16_f32 v54, v28, v29
  v_cvt_pk_f16_f32 v55, v30, v31
  v_mfma_f32_16x16x32_bf16 v[132:135], v[224:227], v[228:231], v[132:135]
  v_pk_fma_f16 v56, v48, v48, s20 op_sel_hi:[1,1,0]
  v_pk_fma_f16 v57, v49, v49, s20 op_sel_hi:[1,1,0]
  v_mfma_f32_32x32x16_f16 v[96:111], v[200:203], v[184:187], v[96:111]
  v_pk_fma_f16 v58, v50, v50, s20 op_sel_hi:[1,1,0]
  v_pk_fma_f16 v59, v51, v51, s20 op_sel_hi:[1,1,0]
  v_pk_fma_f16 v56, v56, v56, s20 op_sel:[0,0,1]
  v_pk_fma_f16 v57, v57, v57, s20 op_sel:[0,0,1]
  v_pk_fma_f16 v58, v58, v58, s20 op_sel:[0,0,1]
  v_pk_fma_f16 v59, v59, v59, s20 op_sel:[0,0,1]
  v_mfma_f32_16x16x32_bf16 v[132:135], v[232:235], v[236:239], v[132:135]
  ds_read_b128 v[236:239], v0 offset:17408
  v_pk_fma_f16 v184, v56, v56, s21 op_sel_hi:[1,1,0]
  v_mfma_f32_32x32x16_f16 v[64:79], v[204:207], v[188:191], v[64:79]
  s_nop 0
  s_mov_b32 s28, s34
  v_pk_fma_f16 v185, v57, v57, s21 op_sel_hi:[1,1,0]
  v_pk_fma_f16 v186, v58, v58, s21 op_sel_hi:[1,1,0]
  v_pk_fma_f16 v187, v59, v59, s21 op_sel_hi:[1,1,0]
  v_pk_fma_f16 v184, v184, v56, s21 op_sel:[0,0,1]
  v_pk_fma_f16 v185, v185, v57, s21 op_sel:[0,0,1]
  v_pk_fma_f16 v186, v186, v58, s21 op_sel:[0,0,1]
  v_mfma_f32_32x32x16_f16 v[80:95], v[208:211], v[188:191], v[80:95]
  s_add_u32 s34, s34, 0x60000
  v_pk_fma_f16 v187, v187, v59, s21 op_sel:[0,0,1]
  v_pk_fma_f16 v184, v184, v48, 0.5 op_sel_hi:[1,1,0] clamp
  v_pk_fma_f16 v185, v185, v49, 0.5 op_sel_hi:[1,1,0] clamp
  v_pk_fma_f16 v186, v186, v50, 0.5 op_sel_hi:[1,1,0] clamp
  v_pk_fma_f16 v187, v187, v51, 0.5 op_sel_hi:[1,1,0] clamp
  v_pk_mul_f16 v184, v184, v48
  v_mfma_f32_32x32x16_f16 v[96:111], v[212:215], v[188:191], v[96:111]
  s_nop 0
  s_waitcnt lgkmcnt(0)
  v_pk_mul_f16 v185, v185, v49
  v_pk_mul_f16 v186, v186, v50
  v_pk_mul_f16 v187, v187, v51
  v_pk_fma_f16 v56, v52, v52, s20 op_sel_hi:[1,1,0]
  v_pk_fma_f16 v57, v53, v53, s20 op_sel_hi:[1,1,0]
  v_pk_fma_f16 v58, v54, v54, s20 op_sel_hi:[1,1,0]
  v_mfma_f32_32x32x16_bf16 v[16:31], v[32:35], v[160:163], 0
  ds_read_b128 v[192:195], v0 offset:61440
  ds_read_b128 v[196:199], v0 offset:62464
  v_pk_fma_f16 v59, v55, v55, s20 op_sel_hi:[1,1,0]
  v_pk_fma_f16 v56, v56, v56, s20 op_sel:[0,0,1]
  v_pk_fma_f16 v57, v57, v57, s20 op_sel:[0,0,1]
  v_pk_fma_f16 v58, v58, v58, s20 op_sel:[0,0,1]
  v_pk_fma_f16 v59, v59, v59, s20 op_sel:[0,0,1]
  v_pk_fma_f16 v188, v56, v56, s21 op_sel_hi:[1,1,0]
  v_pk_fma_f16 v189, v57, v57, s21 op_sel_hi:[1,1,0]
  v_pk_add_f32 v[12:13], v[12:13], v[116:117]
  v_pk_fma_f32 v[14:15], v[116:117], v[116:117], v[14:15]
  v_pk_add_f32 v[12:13], v[12:13], v[118:119]
  v_pk_fma_f32 v[14:15], v[118:119], v[118:119], v[14:15]
  v_pk_add_f32 v[12:13], v[12:13], v[120:121]
  v_pk_fma_f32 v[14:15], v[120:121], v[120:121], v[14:15]
  v_pk_add_f32 v[12:13], v[12:13], v[122:123]
  v_pk_fma_f32 v[14:15], v[122:123], v[122:123], v[14:15]
  v_pk_add_f32 v[12:13], v[12:13], v[124:125]
  v_pk_fma_f32 v[14:15], v[124:125], v[124:125], v[14:15]
  v_pk_add_f32 v[12:13], v[12:13], v[126:127]
  v_pk_fma_f32 v[14:15], v[126:127], v[126:127], v[14:15]
  v_pk_add_f32 v[12:13], v[12:13], v[128:129]
  v_pk_fma_f32 v[14:15], v[128:129], v[128:129], v[14:15]
  v_pk_add_f32 v[12:13], v[12:13], v[130:131]
  v_pk_fma_f32 v[14:15], v[130:131], v[130:131], v[14:15]
  v_pk_add_f32 v[12:13], v[12:13], v[132:133]
  v_pk_fma_f32 v[14:15], v[132:133], v[132:133], v[14:15]
  v_pk_add_f32 v[12:13], v[12:13], v[134:135]
  v_pk_fma_f32 v[14:15], v[134:135], v[134:135], v[14:15]
  v_mfma_f32_32x32x16_bf16 v[16:31], v[36:39], v[164:167], v[16:31]
  ds_read_b128 v[200:203], v0 offset:63488
  ds_read_b128 v[204:207], v0 offset:64512
  v_add_f32 v12, v12, v13
  v_add_f32 v14, v14, v15
  s_nop 1
  v_permlane32_swap_b32 v12, v14
  v_mfma_f32_32x32x16_bf16 v[16:31], v[40:43], v[168:171], v[16:31]
  ds_read_b128 v[208:211], v1
  ds_read_b128 v[212:215], v1 offset:1024
  v_add_f32 v12, v12, v14
  v_mov_b32 v14, v12
  s_nop 1
  v_permlane32_swap_b32 v12, v14
  v_mul_f32_e64 v12, s24, v12
  v_mfma_f32_32x32x16_bf16 v[16:31], v[44:47], v[172:175], v[16:31]
  v_mul_f32_e64 v13, s24, v14
  v_pk_fma_f16 v190, v58, v58, s21 op_sel_hi:[1,1,0]
  v_fma_f32 v13, -v12, v12, v13
  v_pk_fma_f16 v191, v59, v59, s21 op_sel_hi:[1,1,0]
  v_max_f32_e64 v13, 0, v13
  v_pk_fma_f16 v188, v188, v56, s21 op_sel:[0,0,1]
  v_mfma_f32_32x32x16_bf16 v[16:31], v[60:63], v[176:179], v[16:31]
  v_add_f32_e64 v13, s25, v13
  v_rsq_f32 v13, v13
  s_nop 0
  v_mul_f32 v14, s22, v13
  v_mul_f32_e64 v12, -v12, v14
  v_pk_fma_f16 v189, v189, v57, s21 op_sel:[0,0,1]
  v_mfma_f32_32x32x16_bf16 v[16:31], v[236:239], v[180:183], v[16:31]
  s_waitcnt lgkmcnt(0)
  v_pk_fma_f16 v190, v190, v58, s21 op_sel:[0,0,1]
  v_pk_fma_f16 v191, v191, v59, s21 op_sel:[0,0,1]
  v_pk_fma_f16 v188, v188, v52, 0.5 op_sel_hi:[1,1,0] clamp
  v_pk_fma_f16 v189, v189, v53, 0.5 op_sel_hi:[1,1,0] clamp
  v_pk_fma_f16 v190, v190, v54, 0.5 op_sel_hi:[1,1,0] clamp
  v_pk_fma_f16 v191, v191, v55, 0.5 op_sel_hi:[1,1,0] clamp
  v_pk_mul_f16 v188, v188, v52
  v_pk_mul_f16 v189, v189, v53
  v_pk_mul_f16 v190, v190, v54
  v_pk_fma_f32 v[112:113], v[112:113], v[14:15], v[12:13] op_sel_hi:[1,0,0]
  v_pk_fma_f32 v[114:115], v[114:115], v[14:15], v[12:13] op_sel_hi:[1,0,0]
  v_pk_fma_f32 v[116:117], v[116:117], v[14:15], v[12:13] op_sel_hi:[1,0,0]
  v_pk_fma_f32 v[118:119], v[118:119], v[14:15], v[12:13] op_sel_hi:[1,0,0]
  v_pk_fma_f32 v[120:121], v[120:121], v[14:15], v[12:13] op_sel_hi:[1,0,0]
  v_pk_fma_f32 v[122:123], v[122:123], v[14:15], v[12:13] op_sel_hi:[1,0,0]
  v_pk_fma_f32 v[124:125], v[124:125], v[14:15], v[12:13] op_sel_hi:[1,0,0]
  v_pk_fma_f32 v[126:127], v[126:127], v[14:15], v[12:13] op_sel_hi:[1,0,0]
  v_pk_fma_f32 v[128:129], v[128:129], v[14:15], v[12:13] op_sel_hi:[1,0,0]
  v_pk_fma_f32 v[130:131], v[130:131], v[14:15], v[12:13] op_sel_hi:[1,0,0]
  v_pk_fma_f32 v[132:133], v[132:133], v[14:15], v[12:13] op_sel_hi:[1,0,0]
  v_pk_fma_f32 v[134:135], v[134:135], v[14:15], v[12:13] op_sel_hi:[1,0,0]
  v_pk_fma_f32 v[136:137], v[136:137], v[14:15], v[12:13] op_sel_hi:[1,0,0]
  v_pk_fma_f32 v[138:139], v[138:139], v[14:15], v[12:13] op_sel_hi:[1,0,0]
  v_pk_fma_f32 v[140:141], v[140:141], v[14:15], v[12:13] op_sel_hi:[1,0,0]
  v_pk_fma_f32 v[142:143], v[142:143], v[14:15], v[12:13] op_sel_hi:[1,0,0]
  v_pk_fma_f32 v[144:145], v[144:145], v[14:15], v[12:13] op_sel_hi:[1,0,0]
  v_pk_fma_f32 v[146:147], v[146:147], v[14:15], v[12:13] op_sel_hi:[1,0,0]
  v_pk_fma_f32 v[148:149], v[148:149], v[14:15], v[12:13] op_sel_hi:[1,0,0]
  v_pk_fma_f32 v[150:151], v[150:151], v[14:15], v[12:13] op_sel_hi:[1,0,0]
  v_pk_fma_f32 v[152:153], v[152:153], v[14:15], v[12:13] op_sel_hi:[1,0,0]
  v_pk_fma_f32 v[154:155], v[154:155], v[14:15], v[12:13] op_sel_hi:[1,0,0]
  v_pk_fma_f32 v[156:157], v[156:157], v[14:15], v[12:13] op_sel_hi:[1,0,0]
  v_pk_fma_f32 v[158:159], v[158:159], v[14:15], v[12:13] op_sel_hi:[1,0,0]
  v_mfma_f32_32x32x16_f16 v[64:79], v[192:195], v[184:187], v[64:79]
  ds_read_b128 v[216:219], v0 offset:18432
  ds_read_b128 v[220:223], v0 offset:19456
  v_cndmask_b32 v159, v159, v250, s[12:13]
  v_cvt_pk_bf16_f32 v160, v112, v113
  v_cvt_pk_bf16_f32 v161, v114, v115
  v_cvt_pk_bf16_f32 v162, v116, v117
  v_mfma_f32_32x32x16_f16 v[80:95], v[196:199], v[184:187], v[80:95]
  ds_read_b128 v[224:227], v0 offset:20480
  ds_read_b128 v[228:231], v0 offset:21504
  v_cvt_pk_bf16_f32 v163, v118, v119
  v_cvt_pk_bf16_f32 v164, v120, v121
  v_cvt_pk_bf16_f32 v165, v122, v123
  v_cvt_pk_bf16_f32 v166, v124, v125
  v_mfma_f32_32x32x16_f16 v[96:111], v[200:203], v[184:187], v[96:111]
  ds_read_b128 v[232:235], v0 offset:22528
  ds_read_b128 v[236:239], v0 offset:23552
  v_cvt_pk_bf16_f32 v167, v126, v127
  v_cvt_pk_bf16_f32 v168, v128, v129
  v_cvt_pk_bf16_f32 v169, v130, v131
  v_cvt_pk_bf16_f32 v170, v132, v133
  v_pk_mul_f16 v191, v191, v55
  s_nop 0
  s_nop 1
  v_mfma_f32_32x32x16_f16 v[64:79], v[204:207], v[188:191], v[64:79]
  v_cvt_pk_bf16_f32 v171, v134, v135
  v_cvt_pk_bf16_f32 v172, v136, v137
  v_cvt_pk_f16_f32 v48, v16, v17
  v_cvt_pk_bf16_f32 v173, v138, v139
  v_cvt_pk_bf16_f32 v174, v140, v141
  v_cvt_pk_f16_f32 v49, v18, v19
  v_mfma_f32_32x32x16_f16 v[80:95], v[208:211], v[188:191], v[80:95]
  v_cvt_pk_bf16_f32 v175, v142, v143
  v_cvt_pk_bf16_f32 v176, v144, v145
  v_cvt_pk_f16_f32 v50, v20, v21
  v_cvt_pk_bf16_f32 v177, v146, v147
  v_cvt_pk_bf16_f32 v178, v148, v149
  v_cvt_pk_f16_f32 v51, v22, v23
  v_mfma_f32_32x32x16_f16 v[96:111], v[212:215], v[188:191], v[96:111]
  s_nop 0
  s_waitcnt lgkmcnt(0)
  v_cvt_pk_f16_f32 v52, v24, v25
  v_cvt_pk_f16_f32 v53, v26, v27
  v_cvt_pk_bf16_f32 v179, v150, v151
  v_cvt_pk_f16_f32 v54, v28, v29
  v_cvt_pk_f16_f32 v55, v30, v31
  v_cvt_pk_bf16_f32 v180, v152, v153
  v_pk_fma_f16 v56, v48, v48, s20 op_sel_hi:[1,1,0]
  v_cvt_pk_bf16_f32 v181, v154, v155
  v_pk_fma_f16 v57, v49, v49, s20 op_sel_hi:[1,1,0]
  v_pk_fma_f16 v58, v50, v50, s20 op_sel_hi:[1,1,0]
  v_cvt_pk_bf16_f32 v182, v156, v157
  v_pk_fma_f16 v59, v51, v51, s20 op_sel_hi:[1,1,0]
  v_cvt_pk_bf16_f32 v183, v158, v159
  s_sub_u32 s26, s26, 1
  s_cmp_lg_u32 s26, 0
  s_waitcnt vmcnt(4)
  s_cbranch_scc1 L_loop
  v_mfma_f32_32x32x16_bf16 v[16:31], v[216:219], v[160:163], 0
  ds_read_b128 v[192:195], v1 offset:2048
  ds_read_b128 v[196:199], v1 offset:3072
  ds_read_b128 v[200:203], v1 offset:4096
  v_pk_fma_f16 v56, v56, v56, s20 op_sel:[0,0,1]
  v_pk_fma_f16 v57, v57, v57, s20 op_sel:[0,0,1]
  v_pk_fma_f16 v58, v58, v58, s20 op_sel:[0,0,1]
  v_mfma_f32_32x32x16_bf16 v[16:31], v[220:223], v[164:167], v[16:31]
  ds_read_b128 v[204:207], v1 offset:5120
  ds_read_b128 v[208:211], v1 offset:6144
  ds_read_b128 v[212:215], v1 offset:7168
  v_pk_fma_f16 v59, v59, v59, s20 op_sel:[0,0,1]
  v_pk_fma_f16 v184, v56, v56, s21 op_sel_hi:[1,1,0]
  v_pk_fma_f16 v185, v57, v57, s21 op_sel_hi:[1,1,0]
  v_mfma_f32_32x32x16_bf16 v[16:31], v[224:227], v[168:171], v[16:31]
  ds_read_b128 v[136:139], v5
  ds_read_b128 v[140:143], v5 offset:32
  ds_read_b128 v[144:147], v5 offset:64
  v_pk_fma_f16 v186, v58, v58, s21 op_sel_hi:[1,1,0]
  v_pk_fma_f16 v187, v59, v59, s21 op_sel_hi:[1,1,0]
  v_pk_fma_f16 v184, v184, v56, s21 op_sel:[0,0,1]
  v_mfma_f32_32x32x16_bf16 v[16:31], v[228:231], v[172:175], v[16:31]
  ds_read_b128 v[148:151], v5 offset:96
  ds_read_b128 v[152:155], v5 offset:128
  ds_read_b128 v[156:159], v5 offset:160
  v_pk_fma_f16 v185, v185, v57, s21 op_sel:[0,0,1]
  v_pk_fma_f16 v186, v186, v58, s21 op_sel:[0,0,1]
  v_pk_fma_f16 v187, v187, v59, s21 op_sel:[0,0,1]
  v_mfma_f32_32x32x16_bf16 v[16:31], v[232:235], v[176:179], v[16:31]
  v_pk_fma_f16 v184, v184, v48, 0.5 op_sel_hi:[1,1,0] clamp
  v_pk_fma_f16 v185, v185, v49, 0.5 op_sel_hi:[1,1,0] clamp
  v_pk_fma_f16 v186, v186, v50, 0.5 op_sel_hi:[1,1,0] clamp
  v_pk_fma_f16 v187, v187, v51, 0.5 op_sel_hi:[1,1,0] clamp
  v_pk_mul_f16 v184, v184, v48
  v_pk_mul_f16 v185, v185, v49
  v_mfma_f32_32x32x16_bf16 v[16:31], v[236:239], v[180:183], v[16:31]
  s_nop 0
  s_waitcnt lgkmcnt(0)
  v_pk_mul_f16 v186, v186, v50
  v_pk_mul_f16 v187, v187, v51
  v_pk_fma_f16 v56, v52, v52, s20 op_sel_hi:[1,1,0]
  v_pk_fma_f16 v57, v53, v53, s20 op_sel_hi:[1,1,0]
  v_pk_fma_f16 v58, v54, v54, s20 op_sel_hi:[1,1,0]
  v_pk_fma_f16 v59, v55, v55, s20 op_sel_hi:[1,1,0]
  v_mfma_f32_32x32x16_f16 v[64:79], v[192:195], v[184:187], v[64:79]
  v_pk_fma_f16 v56, v56, v56, s20 op_sel:[0,0,1]
  v_pk_fma_f16 v57, v57, v57, s20 op_sel:[0,0,1]
  v_pk_fma_f16 v58, v58, v58, s20 op_sel:[0,0,1]
  v_pk_fma_f16 v59, v59, v59, s20 op_sel:[0,0,1]
  v_pk_fma_f16 v188, v56, v56, s21 op_sel_hi:[1,1,0]
  v_pk_fma_f16 v189, v57, v57, s21 op_sel_hi:[1,1,0]
  v_mfma_f32_32x32x16_f16 v[80:95], v[196:199], v[184:187], v[80:95]
  v_pk_fma_f16 v190, v58, v58, s21 op_sel_hi:[1,1,0]
  v_pk_fma_f16 v191, v59, v59, s21 op_sel_hi:[1,1,0]
  v_pk_fma_f16 v188, v188, v56, s21 op_sel:[0,0,1]
  v_pk_fma_f16 v189, v189, v57, s21 op_sel:[0,0,1]
  v_pk_fma_f16 v190, v190, v58, s21 op_sel:[0,0,1]
  v_pk_fma_f16 v191, v191, v59, s21 op_sel:[0,0,1]
  v_mfma_f32_32x32x16_f16 v[96:111], v[200:203], v[184:187], v[96:111]
  v_pk_fma_f16 v188, v188, v52, 0.5 op_sel_hi:[1,1,0] clamp
  v_pk_fma_f16 v189, v189, v53, 0.5 op_sel_hi:[1,1,0] clamp
  v_pk_fma_f16 v190, v190, v54, 0.5 op_sel_hi:[1,1,0] clamp
  v_pk_fma_f16 v191, v191, v55, 0.5 op_sel_hi:[1,1,0] clamp
  v_pk_mul_f16 v188, v188, v52
  v_pk_mul_f16 v189, v189, v53
  v_pk_mul_f16 v190, v190, v54
  v_pk_mul_f16 v191, v191, v55
  s_nop 0
  s_nop 1
  v_mfma_f32_32x32x16_f16 v[64:79], v[204:207], v[188:191], v[64:79]
  v_cvt_pk_f16_f32 v48, v16, v17
  v_cvt_pk_f16_f32 v49, v18, v19
  v_cvt_pk_f16_f32 v50, v20, v21
  v_cvt_pk_f16_f32 v51, v22, v23
  v_cvt_pk_f16_f32 v52, v24, v25
  v_cvt_pk_f16_f32 v53, v26, v27
  v_mfma_f32_32x32x16_f16 v[80:95], v[208:211], v[188:191], v[80:95]
  v_cvt_pk_f16_f32 v54, v28, v29
  v_cvt_pk_f16_f32 v55, v30, v31
  v_pk_fma_f16 v56, v48, v48, s20 op_sel_hi:[1,1,0]
  v_pk_fma_f16 v57, v49, v49, s20 op_sel_hi:[1,1,0]
  v_pk_fma_f16 v58, v50, v50, s20 op_sel_hi:[1,1,0]
  v_pk_fma_f16 v59, v51, v51, s20 op_sel_hi:[1,1,0]
  v_mfma_f32_32x32x16_f16 v[96:111], v[212:215], v[188:191], v[96:111]
  v_pk_fma_f16 v56, v56, v56, s20 op_sel:[0,0,1]
  v_pk_fma_f16 v57, v57, v57, s20 op_sel:[0,0,1]
  v_pk_fma_f16 v58, v58, v58, s20 op_sel:[0,0,1]
  v_pk_fma_f16 v59, v59, v59, s20 op_sel:[0,0,1]
  v_pk_fma_f16 v184, v56, v56, s21 op_sel_hi:[1,1,0]
  v_pk_fma_f16 v185, v57, v57, s21 op_sel_hi:[1,1,0]
  v_mfma_f32_32x32x16_bf16 v[16:31], a[0:3], v[160:163], 0
  v_cvt_pk_bf16_f32 v112, v64, v65
  v_cvt_pk_bf16_f32 v113, v66, v67
  v_cvt_pk_bf16_f32 v114, v68, v69
  v_cvt_pk_bf16_f32 v115, v70, v71
  v_cvt_pk_bf16_f32 v116, v72, v73
  v_cvt_pk_bf16_f32 v117, v74, v75
  v_mfma_f32_32x32x16_bf16 v[16:31], a[4:7], v[164:167], v[16:31]
  v_cvt_pk_bf16_f32 v118, v76, v77
  v_cvt_pk_bf16_f32 v119, v78, v79
  v_cvt_pk_bf16_f32 v120, v80, v81
  v_cvt_pk_bf16_f32 v121, v82, v83
  v_cvt_pk_bf16_f32 v122, v84, v85
  v_cvt_pk_bf16_f32 v123, v86, v87
  v_mfma_f32_32x32x16_bf16 v[16:31], a[8:11], v[168:171], v[16:31]
  ds_read_b128 v[64:67], v2
  ds_read_b128 v[68:71], v2 offset:32
  ds_read_b128 v[72:75], v2 offset:64
  ds_read_b128 v[76:79], v2 offset:96
  v_cvt_pk_bf16_f32 v124, v88, v89
  v_cvt_pk_bf16_f32 v125, v90, v91
  v_mfma_f32_32x32x16_bf16 v[16:31], a[12:15], v[172:175], v[16:31]
  ds_read_b128 v[192:195], v1 offset:8192
  ds_read_b128 v[196:199], v1 offset:9216
  v_cvt_pk_bf16_f32 v126, v92, v93
  v_cvt_pk_bf16_f32 v127, v94, v95
  v_cvt_pk_bf16_f32 v128, v96, v97
  v_cvt_pk_bf16_f32 v129, v98, v99
  v_mfma_f32_32x32x16_bf16 v[16:31], a[16:19], v[176:179], v[16:31]
  ds_read_b128 v[80:83], v2 offset:128
  ds_read_b128 v[84:87], v2 offset:160
  ds_read_b128 v[88:91], v2 offset:192
  ds_read_b128 v[92:95], v2 offset:224
  v_cvt_pk_bf16_f32 v130, v100, v101
  v_cvt_pk_bf16_f32 v131, v102, v103
  v_mfma_f32_32x32x16_bf16 v[16:31], a[20:23], v[180:183], v[16:31]
  s_nop 0
  s_waitcnt lgkmcnt(6)
  ds_read_b128 v[200:203], v1 offset:10240
  ds_read_b128 v[204:207], v1 offset:11264
  v_cvt_pk_bf16_f32 v132, v104, v105
  v_cvt_pk_bf16_f32 v133, v106, v107
  v_cvt_pk_bf16_f32 v134, v108, v109
  v_cvt_pk_bf16_f32 v135, v110, v111
  v_mfma_f32_32x32x16_bf16 v[64:79], v[240:243], v[136:139], v[64:79]
  ds_read_b128 v[96:99], v2 offset:256
  ds_read_b128 v[100:103], v2 offset:288
  ds_read_b128 v[104:107], v2 offset:320
  ds_read_b128 v[108:111], v2 offset:352
  v_pk_fma_f16 v186, v58, v58, s21 op_sel_hi:[1,1,0]
  v_pk_fma_f16 v187, v59, v59, s21 op_sel_hi:[1,1,0]
  v_mfma_f32_32x32x16_bf16 v[64:79], v[244:247], v[140:143], v[64:79]
  s_nop 0
  s_waitcnt lgkmcnt(6)
  ds_read_b128 v[208:211], v1 offset:12288
  ds_read_b128 v[212:215], v1 offset:13312
  v_pk_fma_f16 v184, v184, v56, s21 op_sel:[0,0,1]
  v_pk_fma_f16 v185, v185, v57, s21 op_sel:[0,0,1]
  v_pk_fma_f16 v186, v186, v58, s21 op_sel:[0,0,1]
  v_pk_fma_f16 v187, v187, v59, s21 op_sel:[0,0,1]
  v_mfma_f32_32x32x16_bf16 v[80:95], v[240:243], v[144:147], v[80:95]
  v_pk_fma_f16 v184, v184, v48, 0.5 op_sel_hi:[1,1,0] clamp
  v_pk_fma_f16 v185, v185, v49, 0.5 op_sel_hi:[1,1,0] clamp
  v_pk_fma_f16 v186, v186, v50, 0.5 op_sel_hi:[1,1,0] clamp
  v_pk_fma_f16 v187, v187, v51, 0.5 op_sel_hi:[1,1,0] clamp
  v_pk_mul_f16 v184, v184, v48
  v_pk_mul_f16 v185, v185, v49
  v_mfma_f32_32x32x16_bf16 v[80:95], v[244:247], v[148:151], v[80:95]
  s_nop 0
  s_waitcnt lgkmcnt(2)
  v_pk_mul_f16 v186, v186, v50
  v_pk_mul_f16 v187, v187, v51
  v_pk_fma_f16 v56, v52, v52, s20 op_sel_hi:[1,1,0]
  v_pk_fma_f16 v57, v53, v53, s20 op_sel_hi:[1,1,0]
  v_pk_fma_f16 v58, v54, v54, s20 op_sel_hi:[1,1,0]
  v_pk_fma_f16 v59, v55, v55, s20 op_sel_hi:[1,1,0]
  v_mfma_f32_32x32x16_bf16 v[96:111], v[240:243], v[152:155], v[96:111]
  v_pk_fma_f16 v56, v56, v56, s20 op_sel:[0,0,1]
  v_pk_fma_f16 v57, v57, v57, s20 op_sel:[0,0,1]
  v_pk_fma_f16 v58, v58, v58, s20 op_sel:[0,0,1]
  v_pk_fma_f16 v59, v59, v59, s20 op_sel:[0,0,1]
  v_pk_fma_f16 v188, v56, v56, s21 op_sel_hi:[1,1,0]
  v_pk_fma_f16 v189, v57, v57, s21 op_sel_hi:[1,1,0]
  v_mfma_f32_32x32x16_bf16 v[96:111], v[244:247], v[156:159], v[96:111]
  s_nop 0
  s_waitcnt lgkmcnt(0)
  v_pk_fma_f16 v190, v58, v58, s21 op_sel_hi:[1,1,0]
  v_pk_fma_f16 v191, v59, v59, s21 op_sel_hi:[1,1,0]
  v_pk_fma_f16 v188, v188, v56, s21 op_sel:[0,0,1]
  v_pk_fma_f16 v189, v189, v57, s21 op_sel:[0,0,1]
  v_pk_fma_f16 v190, v190, v58, s21 op_sel:[0,0,1]
  v_pk_fma_f16 v191, v191, v59, s21 op_sel:[0,0,1]
  v_mfma_f32_32x32x16_f16 v[64:79], v[192:195], v[184:187], v[64:79]
  v_pk_fma_f16 v188, v188, v52, 0.5 op_sel_hi:[1,1,0] clamp
  v_pk_fma_f16 v189, v189, v53, 0.5 op_sel_hi:[1,1,0] clamp
  v_pk_fma_f16 v190, v190, v54, 0.5 op_sel_hi:[1,1,0] clamp
  v_pk_fma_f16 v191, v191, v55, 0.5 op_sel_hi:[1,1,0] clamp
  v_pk_mul_f16 v188, v188, v52
  v_pk_mul_f16 v189, v189, v53
  v_mfma_f32_32x32x16_f16 v[80:95], v[196:199], v[184:187], v[80:95]
  v_pk_mul_f16 v190, v190, v54
  v_pk_mul_f16 v191, v191, v55
  v_cvt_pk_f16_f32 v48, v16, v17
  v_cvt_pk_f16_f32 v49, v18, v19
  v_cvt_pk_f16_f32 v50, v20, v21
  v_cvt_pk_f16_f32 v51, v22, v23
  v_mfma_f32_32x32x16_f16 v[96:111], v[200:203], v[184:187], v[96:111]
  v_cvt_pk_f16_f32 v52, v24, v25
  v_cvt_pk_f16_f32 v53, v26, v27
  v_cvt_pk_f16_f32 v54, v28, v29
  v_cvt_pk_f16_f32 v55, v30, v31
  v_pk_fma_f16 v56, v48, v48, s20 op_sel_hi:[1,1,0]
  v_pk_fma_f16 v57, v49, v49, s20 op_sel_hi:[1,1,0]
  v_mfma_f32_32x32x16_f16 v[64:79], v[204:207], v[188:191], v[64:79]
  v_pk_fma_f16 v58, v50, v50, s20 op_sel_hi:[1,1,0]
  v_pk_fma_f16 v59, v51, v51, s20 op_sel_hi:[1,1,0]
  v_pk_fma_f16 v56, v56, v56, s20 op_sel:[0,0,1]
  v_pk_fma_f16 v57, v57, v57, s20 op_sel:[0,0,1]
  v_pk_fma_f16 v58, v58, v58, s20 op_sel:[0,0,1]
  v_pk_fma_f16 v59, v59, v59, s20 op_sel:[0,0,1]
  v_mfma_f32_32x32x16_f16 v[80:95], v[208:211], v[188:191], v[80:95]
  v_pk_fma_f16 v184, v56, v56, s21 op_sel_hi:[1,1,0]
  v_pk_fma_f16 v185, v57, v57, s21 op_sel_hi:[1,1,0]
  v_pk_fma_f16 v186, v58, v58, s21 op_sel_hi:[1,1,0]
  v_pk_fma_f16 v187, v59, v59, s21 op_sel_hi:[1,1,0]
  v_pk_fma_f16 v184, v184, v56, s21 op_sel:[0,0,1]
  v_pk_fma_f16 v185, v185, v57, s21 op_sel:[0,0,1]
  v_mfma_f32_32x32x16_f16 v[96:111], v[212:215], v[188:191], v[96:111]
  v_pk_fma_f16 v186, v186, v58, s21 op_sel:[0,0,1]
  v_pk_fma_f16 v187, v187, v59, s21 op_sel:[0,0,1]
  v_pk_fma_f16 v184, v184, v48, 0.5 op_sel_hi:[1,1,0] clamp
  v_pk_fma_f16 v185, v185, v49, 0.5 op_sel_hi:[1,1,0] clamp
  v_pk_fma_f16 v186, v186, v50, 0.5 op_sel_hi:[1,1,0] clamp
  v_pk_fma_f16 v187, v187, v51, 0.5 op_sel_hi:[1,1,0] clamp
  v_mfma_f32_32x32x16_bf16 v[16:31], a[24:27], v[160:163], 0
  ds_read_b128 v[192:195], v1 offset:14336
  ds_read_b128 v[196:199], v1 offset:15360
  v_pk_mul_f16 v184, v184, v48
  v_pk_mul_f16 v185, v185, v49
  v_pk_mul_f16 v186, v186, v50
  v_pk_mul_f16 v187, v187, v51
  v_mfma_f32_32x32x16_bf16 v[16:31], a[28:31], v[164:167], v[16:31]
  ds_read_b128 v[200:203], v1 offset:16384
  ds_read_b128 v[204:207], v1 offset:17408
  v_pk_fma_f16 v56, v52, v52, s20 op_sel_hi:[1,1,0]
  v_pk_fma_f16 v57, v53, v53, s20 op_sel_hi:[1,1,0]
  v_pk_fma_f16 v58, v54, v54, s20 op_sel_hi:[1,1,0]
  v_pk_fma_f16 v59, v55, v55, s20 op_sel_hi:[1,1,0]
  v_mfma_f32_32x32x16_bf16 v[16:31], a[32:35], v[168:171], v[16:31]
  ds_read_b128 v[208:211], v1 offset:18432
  ds_read_b128 v[212:215], v1 offset:19456
  v_pk_fma_f16 v56, v56, v56, s20 op_sel:[0,0,1]
  v_pk_fma_f16 v57, v57, v57, s20 op_sel:[0,0,1]
  v_pk_fma_f16 v58, v58, v58, s20 op_sel:[0,0,1]
  v_pk_fma_f16 v59, v59, v59, s20 op_sel:[0,0,1]
  v_mfma_f32_32x32x16_bf16 v[16:31], a[36:39], v[172:175], v[16:31]
  buffer_store_dwordx4 v[112:115], v10, s[8:11], s28 offen
  v_pk_fma_f16 v188, v56, v56, s21 op_sel_hi:[1,1,0]
  v_pk_fma_f16 v189, v57, v57, s21 op_sel_hi:[1,1,0]
  v_pk_fma_f16 v190, v58, v58, s21 op_sel_hi:[1,1,0]
  v_pk_fma_f16 v191, v59, v59, s21 op_sel_hi:[1,1,0]
  v_pk_fma_f16 v188, v188, v56, s21 op_sel:[0,0,1]
  v_mfma_f32_32x32x16_bf16 v[16:31], a[40:43], v[176:179], v[16:31]
  v_pk_fma_f16 v189, v189, v57, s21 op_sel:[0,0,1]
  v_mfma_f32_32x32x16_bf16 v[16:31], a[44:47], v[180:183], v[16:31]
  s_nop 0
  s_waitcnt lgkmcnt(0)
  v_pk_fma_f16 v190, v190, v58, s21 op_sel:[0,0,1]
  v_pk_fma_f16 v191, v191, v59, s21 op_sel:[0,0,1]
  v_pk_fma_f16 v188, v188, v52, 0.5 op_sel_hi:[1,1,0] clamp
  v_pk_fma_f16 v189, v189, v53, 0.5 op_sel_hi:[1,1,0] clamp
  v_pk_fma_f16 v190, v190, v54, 0.5 op_sel_hi:[1,1,0] clamp
  v_pk_fma_f16 v191, v191, v55, 0.5 op_sel_hi:[1,1,0] clamp
  v_mfma_f32_32x32x16_f16 v[64:79], v[192:195], v[184:187], v[64:79]
  v_pk_mul_f16 v188, v188, v52
  v_pk_mul_f16 v189, v189, v53
  v_pk_mul_f16 v190, v190, v54
  v_pk_mul_f16 v191, v191, v55
  v_mfma_f32_32x32x16_f16 v[80:95], v[196:199], v[184:187], v[80:95]
  v_cvt_pk_f16_f32 v48, v16, v17
  v_cvt_pk_f16_f32 v49, v18, v19
  v_cvt_pk_f16_f32 v50, v20, v21
  v_cvt_pk_f16_f32 v51, v22, v23
  v_cvt_pk_f16_f32 v52, v24, v25
  v_cvt_pk_f16_f32 v53, v26, v27
  v_mfma_f32_32x32x16_f16 v[96:111], v[200:203], v[184:187], v[96:111]
  v_cvt_pk_f16_f32 v54, v28, v29
  v_cvt_pk_f16_f32 v55, v30, v31
  v_pk_fma_f16 v56, v48, v48, s20 op_sel_hi:[1,1,0]
  v_pk_fma_f16 v57, v49, v49, s20 op_sel_hi:[1,1,0]
  v_pk_fma_f16 v58, v50, v50, s20 op_sel_hi:[1,1,0]
  v_pk_fma_f16 v59, v51, v51, s20 op_sel_hi:[1,1,0]
  v_mfma_f32_32x32x16_f16 v[64:79], v[204:207], v[188:191], v[64:79]
  v_pk_fma_f16 v56, v56, v56, s20 op_sel:[0,0,1]
  v_pk_fma_f16 v57, v57, v57, s20 op_sel:[0,0,1]
  v_pk_fma_f16 v58, v58, v58, s20 op_sel:[0,0,1]
  v_pk_fma_f16 v59, v59, v59, s20 op_sel:[0,0,1]
  v_pk_fma_f16 v184, v56, v56, s21 op_sel_hi:[1,1,0]
  v_pk_fma_f16 v185, v57, v57, s21 op_sel_hi:[1,1,0]
  v_mfma_f32_32x32x16_f16 v[80:95], v[208:211], v[188:191], v[80:95]
  v_pk_fma_f16 v186, v58, v58, s21 op_sel_hi:[1,1,0]
  v_pk_fma_f16 v187, v59, v59, s21 op_sel_hi:[1,1,0]
  v_pk_fma_f16 v184, v184, v56, s21 op_sel:[0,0,1]
  v_pk_fma_f16 v185, v185, v57, s21 op_sel:[0,0,1]
  v_pk_fma_f16 v186, v186, v58, s21 op_sel:[0,0,1]
  v_pk_fma_f16 v187, v187, v59, s21 op_sel:[0,0,1]
  v_mfma_f32_32x32x16_f16 v[96:111], v[212:215], v[188:191], v[96:111]
  v_pk_fma_f16 v184, v184, v48, 0.5 op_sel_hi:[1,1,0] clamp
  v_pk_fma_f16 v185, v185, v49, 0.5 op_sel_hi:[1,1,0] clamp
  v_pk_fma_f16 v186, v186, v50, 0.5 op_sel_hi:[1,1,0] clamp
  v_pk_fma_f16 v187, v187, v51, 0.5 op_sel_hi:[1,1,0] clamp
  v_pk_mul_f16 v184, v184, v48
  v_pk_mul_f16 v185, v185, v49
  v_mfma_f32_32x32x16_bf16 v[16:31], a[48:51], v[160:163], 0
  ds_read_b128 v[192:195], v1 offset:20480
  ds_read_b128 v[196:199], v1 offset:21504
  v_pk_mul_f16 v186, v186, v50
  v_pk_mul_f16 v187, v187, v51
  v_pk_fma_f16 v56, v52, v52, s20 op_sel_hi:[1,1,0]
  v_pk_fma_f16 v57, v53, v53, s20 op_sel_hi:[1,1,0]
  v_mfma_f32_32x32x16_bf16 v[16:31], a[52:55], v[164:167], v[16:31]
  ds_read_b128 v[200:203], v1 offset:22528
  ds_read_b128 v[204:207], v1 offset:23552
  v_pk_fma_f16 v58, v54, v54, s20 op_sel_hi:[1,1,0]
  v_pk_fma_f16 v59, v55, v55, s20 op_sel_hi:[1,1,0]
  v_pk_fma_f16 v56, v56, v56, s20 op_sel:[0,0,1]
  v_pk_fma_f16 v57, v57, v57, s20 op_sel:[0,0,1]
  v_mfma_f32_32x32x16_bf16 v[16:31], a[56:59], v[168:171], v[16:31]
  ds_read_b128 v[208:211], v1 offset:24576
  ds_read_b128 v[212:215], v1 offset:25600
  v_pk_fma_f16 v58, v58, v58, s20 op_sel:[0,0,1]
  v_pk_fma_f16 v59, v59, v59, s20 op_sel:[0,0,1]
  v_pk_fma_f16 v188, v56, v56, s21 op_sel_hi:[1,1,0]
  v_pk_fma_f16 v189, v57, v57, s21 op_sel_hi:[1,1,0]
  v_mfma_f32_32x32x16_bf16 v[16:31], a[60:63], v[172:175], v[16:31]
  buffer_store_dwordx4 v[116:119], v10, s[8:11], s28 offen offset:32
  v_pk_fma_f16 v190, v58, v58, s21 op_sel_hi:[1,1,0]
  v_pk_fma_f16 v191, v59, v59, s21 op_sel_hi:[1,1,0]
  v_pk_fma_f16 v188, v188, v56, s21 op_sel:[0,0,1]
  v_pk_fma_f16 v189, v189, v57, s21 op_sel:[0,0,1]
  v_mfma_f32_32x32x16_bf16 v[16:31], a[64:67], v[176:179], v[16:31]
  v_mfma_f32_32x32x16_bf16 v[16:31], a[68:71], v[180:183], v[16:31]
  s_nop 0
  s_waitcnt lgkmcnt(0)
  v_pk_fma_f16 v190, v190, v58, s21 op_sel:[0,0,1]
  v_pk_fma_f16 v191, v191, v59, s21 op_sel:[0,0,1]
  v_pk_fma_f16 v188, v188, v52, 0.5 op_sel_hi:[1,1,0] clamp
  v_pk_fma_f16 v189, v189, v53, 0.5 op_sel_hi:[1,1,0] clamp
  v_pk_fma_f16 v190, v190, v54, 0.5 op_sel_hi:[1,1,0] clamp
  v_pk_fma_f16 v191, v191, v55, 0.5 op_sel_hi:[1,1,0] clamp
  v_mfma_f32_32x32x16_f16 v[64:79], v[192:195], v[184:187], v[64:79]
  v_pk_mul_f16 v188, v188, v52
  v_pk_mul_f16 v189, v189, v53
  v_pk_mul_f16 v190, v190, v54
  v_pk_mul_f16 v191, v191, v55
  v_mfma_f32_32x32x16_f16 v[80:95], v[196:199], v[184:187], v[80:95]
  v_cvt_pk_f16_f32 v48, v16, v17
  v_cvt_pk_f16_f32 v49, v18, v19
  v_cvt_pk_f16_f32 v50, v20, v21
  v_cvt_pk_f16_f32 v51, v22, v23
  v_cvt_pk_f16_f32 v52, v24, v25
  v_cvt_pk_f16_f32 v53, v26, v27
  v_mfma_f32_32x32x16_f16 v[96:111], v[200:203], v[184:187], v[96:111]
  v_cvt_pk_f16_f32 v54, v28, v29
  v_cvt_pk_f16_f32 v55, v30, v31
  v_pk_fma_f16 v56, v48, v48, s20 op_sel_hi:[1,1,0]
  v_pk_fma_f16 v57, v49, v49, s20 op_sel_hi:[1,1,0]
  v_pk_fma_f16 v58, v50, v50, s20 op_sel_hi:[1,1,0]
  v_pk_fma_f16 v59, v51, v51, s20 op_sel_hi:[1,1,0]
  v_mfma_f32_32x32x16_f16 v[64:79], v[204:207], v[188:191], v[64:79]
  v_pk_fma_f16 v56, v56, v56, s20 op_sel:[0,0,1]
  v_pk_fma_f16 v57, v57, v57, s20 op_sel:[0,0,1]
  v_pk_fma_f16 v58, v58, v58, s20 op_sel:[0,0,1]
  v_pk_fma_f16 v59, v59, v59, s20 op_sel:[0,0,1]
  v_pk_fma_f16 v184, v56, v56, s21 op_sel_hi:[1,1,0]
  v_pk_fma_f16 v185, v57, v57, s21 op_sel_hi:[1,1,0]
  v_mfma_f32_32x32x16_f16 v[80:95], v[208:211], v[188:191], v[80:95]
  v_pk_fma_f16 v186, v58, v58, s21 op_sel_hi:[1,1,0]
  v_pk_fma_f16 v187, v59, v59, s21 op_sel_hi:[1,1,0]
  v_pk_fma_f16 v184, v184, v56, s21 op_sel:[0,0,1]
  v_pk_fma_f16 v185, v185, v57, s21 op_sel:[0,0,1]
  v_pk_fma_f16 v186, v186, v58, s21 op_sel:[0,0,1]
  v_pk_fma_f16 v187, v187, v59, s21 op_sel:[0,0,1]
  v_mfma_f32_32x32x16_f16 v[96:111], v[212:215], v[188:191], v[96:111]
  v_pk_fma_f16 v184, v184, v48, 0.5 op_sel_hi:[1,1,0] clamp
  v_pk_fma_f16 v185, v185, v49, 0.5 op_sel_hi:[1,1,0] clamp
  v_pk_fma_f16 v186, v186, v50, 0.5 op_sel_hi:[1,1,0] clamp
  v_pk_fma_f16 v187, v187, v51, 0.5 op_sel_hi:[1,1,0] clamp
  v_pk_mul_f16 v184, v184, v48
  v_pk_mul_f16 v185, v185, v49
  v_mfma_f32_32x32x16_bf16 v[16:31], a[72:75], v[160:163], 0
  ds_read_b128 v[192:195], v1 offset:26624
  ds_read_b128 v[196:199], v1 offset:27648
  v_pk_mul_f16 v186, v186, v50
  v_pk_mul_f16 v187, v187, v51
  v_pk_fma_f16 v56, v52, v52, s20 op_sel_hi:[1,1,0]
  v_pk_fma_f16 v57, v53, v53, s20 op_sel_hi:[1,1,0]
  v_mfma_f32_32x32x16_bf16 v[16:31], a[76:79], v[164:167], v[16:31]
  ds_read_b128 v[200:203], v1 offset:28672
  ds_read_b128 v[204:207], v1 offset:29696
  v_pk_fma_f16 v58, v54, v54, s20 op_sel_hi:[1,1,0]
  v_pk_fma_f16 v59, v55, v55, s20 op_sel_hi:[1,1,0]
  v_pk_fma_f16 v56, v56, v56, s20 op_sel:[0,0,1]
  v_pk_fma_f16 v57, v57, v57, s20 op_sel:[0,0,1]
  v_mfma_f32_32x32x16_bf16 v[16:31], a[80:83], v[168:171], v[16:31]
  ds_read_b128 v[208:211], v1 offset:30720
  ds_read_b128 v[212:215], v1 offset:31744
  v_pk_fma_f16 v58, v58, v58, s20 op_sel:[0,0,1]
  v_pk_fma_f16 v59, v59, v59, s20 op_sel:[0,0,1]
  v_pk_fma_f16 v188, v56, v56, s21 op_sel_hi:[1,1,0]
  v_pk_fma_f16 v189, v57, v57, s21 op_sel_hi:[1,1,0]
  v_mfma_f32_32x32x16_bf16 v[16:31], a[84:87], v[172:175], v[16:31]
  v_pk_fma_f16 v190, v58, v58, s21 op_sel_hi:[1,1,0]
  v_pk_fma_f16 v191, v59, v59, s21 op_sel_hi:[1,1,0]
  v_pk_fma_f16 v188, v188, v56, s21 op_sel:[0,0,1]
  v_pk_fma_f16 v189, v189, v57, s21 op_sel:[0,0,1]
  v_mfma_f32_32x32x16_bf16 v[16:31], a[88:91], v[176:179], v[16:31]
  v_mfma_f32_32x32x16_bf16 v[16:31], a[92:95], v[180:183], v[16:31]
  s_nop 0
  s_waitcnt lgkmcnt(0)
  v_pk_fma_f16 v190, v190, v58, s21 op_sel:[0,0,1]
  v_pk_fma_f16 v191, v191, v59, s21 op_sel:[0,0,1]
  v_pk_fma_f16 v188, v188, v52, 0.5 op_sel_hi:[1,1,0] clamp
  v_pk_fma_f16 v189, v189, v53, 0.5 op_sel_hi:[1,1,0] clamp
  v_pk_fma_f16 v190, v190, v54, 0.5 op_sel_hi:[1,1,0] clamp
  v_pk_fma_f16 v191, v191, v55, 0.5 op_sel_hi:[1,1,0] clamp
  v_mfma_f32_32x32x16_f16 v[64:79], v[192:195], v[184:187], v[64:79]
  v_pk_mul_f16 v188, v188, v52
  v_pk_mul_f16 v189, v189, v53
  v_pk_mul_f16 v190, v190, v54
  v_pk_mul_f16 v191, v191, v55
  v_mfma_f32_32x32x16_f16 v[80:95], v[196:199], v[184:187], v[80:95]
  v_cvt_pk_f16_f32 v48, v16, v17
  v_cvt_pk_f16_f32 v49, v18, v19
  v_cvt_pk_f16_f32 v50, v20, v21
  v_cvt_pk_f16_f32 v51, v22, v23
  v_cvt_pk_f16_f32 v52, v24, v25
  v_cvt_pk_f16_f32 v53, v26, v27
  v_mfma_f32_32x32x16_f16 v[96:111], v[200:203], v[184:187], v[96:111]
  v_cvt_pk_f16_f32 v54, v28, v29
  v_cvt_pk_f16_f32 v55, v30, v31
  v_pk_fma_f16 v56, v48, v48, s20 op_sel_hi:[1,1,0]
  v_pk_fma_f16 v57, v49, v49, s20 op_sel_hi:[1,1,0]
  v_pk_fma_f16 v58, v50, v50, s20 op_sel_hi:[1,1,0]
  v_pk_fma_f16 v59, v51, v51, s20 op_sel_hi:[1,1,0]
  v_mfma_f32_32x32x16_f16 v[64:79], v[204:207], v[188:191], v[64:79]
  v_pk_fma_f16 v56, v56, v56, s20 op_sel:[0,0,1]
  v_pk_fma_f16 v57, v57, v57, s20 op_sel:[0,0,1]
  v_pk_fma_f16 v58, v58, v58, s20 op_sel:[0,0,1]
  v_pk_fma_f16 v59, v59, v59, s20 op_sel:[0,0,1]
  v_pk_fma_f16 v184, v56, v56, s21 op_sel_hi:[1,1,0]
  v_pk_fma_f16 v185, v57, v57, s21 op_sel_hi:[1,1,0]
  v_mfma_f32_32x32x16_f16 v[80:95], v[208:211], v[188:191], v[80:95]
  v_pk_fma_f16 v186, v58, v58, s21 op_sel_hi:[1,1,0]
  v_pk_fma_f16 v187, v59, v59, s21 op_sel_hi:[1,1,0]
  v_pk_fma_f16 v184, v184, v56, s21 op_sel:[0,0,1]
  v_pk_fma_f16 v185, v185, v57, s21 op_sel:[0,0,1]
  v_pk_fma_f16 v186, v186, v58, s21 op_sel:[0,0,1]
  v_pk_fma_f16 v187, v187, v59, s21 op_sel:[0,0,1]
  v_mfma_f32_32x32x16_f16 v[96:111], v[212:215], v[188:191], v[96:111]
  v_pk_fma_f16 v184, v184, v48, 0.5 op_sel_hi:[1,1,0] clamp
  v_pk_fma_f16 v185, v185, v49, 0.5 op_sel_hi:[1,1,0] clamp
  v_pk_fma_f16 v186, v186, v50, 0.5 op_sel_hi:[1,1,0] clamp
  v_pk_fma_f16 v187, v187, v51, 0.5 op_sel_hi:[1,1,0] clamp
  v_pk_mul_f16 v184, v184, v48
  v_pk_mul_f16 v185, v185, v49
  v_mfma_f32_32x32x16_bf16 v[16:31], a[96:99], v[160:163], 0
  ds_read_b128 v[192:195], v0 offset:24576
  ds_read_b128 v[196:199], v0 offset:25600
  v_pk_mul_f16 v186, v186, v50
  v_pk_mul_f16 v187, v187, v51
  v_pk_fma_f16 v56, v52, v52, s20 op_sel_hi:[1,1,0]
  v_pk_fma_f16 v57, v53, v53, s20 op_sel_hi:[1,1,0]
  v_mfma_f32_32x32x16_bf16 v[16:31], a[100:103], v[164:167], v[16:31]
  ds_read_b128 v[200:203], v0 offset:26624
  ds_read_b128 v[204:207], v0 offset:27648
  v_pk_fma_f16 v58, v54, v54, s20 op_sel_hi:[1,1,0]
  v_pk_fma_f16 v59, v55, v55, s20 op_sel_hi:[1,1,0]
  v_pk_fma_f16 v56, v56, v56, s20 op_sel:[0,0,1]
  v_pk_fma_f16 v57, v57, v57, s20 op_sel:[0,0,1]
  v_mfma_f32_32x32x16_bf16 v[16:31], a[104:107], v[168:171], v[16:31]
  ds_read_b128 v[208:211], v0 offset:28672
  ds_read_b128 v[212:215], v0 offset:29696
  v_pk_fma_f16 v58, v58, v58, s20 op_sel:[0,0,1]
  v_pk_fma_f16 v59, v59, v59, s20 op_sel:[0,0,1]
  v_pk_fma_f16 v188, v56, v56, s21 op_sel_hi:[1,1,0]
  v_pk_fma_f16 v189, v57, v57, s21 op_sel_hi:[1,1,0]
  v_mfma_f32_32x32x16_bf16 v[16:31], a[108:111], v[172:175], v[16:31]
  buffer_store_dwordx4 v[120:123], v10, s[8:11], s28 offen offset:64
  v_pk_fma_f16 v190, v58, v58, s21 op_sel_hi:[1,1,0]
  v_pk_fma_f16 v191, v59, v59, s21 op_sel_hi:[1,1,0]
  v_pk_fma_f16 v188, v188, v56, s21 op_sel:[0,0,1]
  v_pk_fma_f16 v189, v189, v57, s21 op_sel:[0,0,1]
  v_mfma_f32_32x32x16_bf16 v[16:31], a[112:115], v[176:179], v[16:31]
  v_mfma_f32_32x32x16_bf16 v[16:31], a[116:119], v[180:183], v[16:31]
  s_nop 0
  s_waitcnt lgkmcnt(0)
  v_pk_fma_f16 v190, v190, v58, s21 op_sel:[0,0,1]
  v_pk_fma_f16 v191, v191, v59, s21 op_sel:[0,0,1]
  v_pk_fma_f16 v188, v188, v52, 0.5 op_sel_hi:[1,1,0] clamp
  v_pk_fma_f16 v189, v189, v53, 0.5 op_sel_hi:[1,1,0] clamp
  v_pk_fma_f16 v190, v190, v54, 0.5 op_sel_hi:[1,1,0] clamp
  v_pk_fma_f16 v191, v191, v55, 0.5 op_sel_hi:[1,1,0] clamp
  v_mfma_f32_32x32x16_f16 v[64:79], v[192:195], v[184:187], v[64:79]
  v_pk_mul_f16 v188, v188, v52
  v_pk_mul_f16 v189, v189, v53
  v_pk_mul_f16 v190, v190, v54
  v_pk_mul_f16 v191, v191, v55
  v_mfma_f32_32x32x16_f16 v[80:95], v[196:199], v[184:187], v[80:95]
  v_cvt_pk_f16_f32 v48, v16, v17
  v_cvt_pk_f16_f32 v49, v18, v19
  v_cvt_pk_f16_f32 v50, v20, v21
  v_cvt_pk_f16_f32 v51, v22, v23
  v_cvt_pk_f16_f32 v52, v24, v25
  v_cvt_pk_f16_f32 v53, v26, v27
  v_mfma_f32_32x32x16_f16 v[96:111], v[200:203], v[184:187], v[96:111]
  v_cvt_pk_f16_f32 v54, v28, v29
  v_cvt_pk_f16_f32 v55, v30, v31
  v_pk_fma_f16 v56, v48, v48, s20 op_sel_hi:[1,1,0]
  v_pk_fma_f16 v57, v49, v49, s20 op_sel_hi:[1,1,0]
  v_pk_fma_f16 v58, v50, v50, s20 op_sel_hi:[1,1,0]
  v_pk_fma_f16 v59, v51, v51, s20 op_sel_hi:[1,1,0]
  v_mfma_f32_32x32x16_f16 v[64:79], v[204:207], v[188:191], v[64:79]
  v_pk_fma_f16 v56, v56, v56, s20 op_sel:[0,0,1]
  v_pk_fma_f16 v57, v57, v57, s20 op_sel:[0,0,1]
  v_pk_fma_f16 v58, v58, v58, s20 op_sel:[0,0,1]
  v_pk_fma_f16 v59, v59, v59, s20 op_sel:[0,0,1]
  v_pk_fma_f16 v184, v56, v56, s21 op_sel_hi:[1,1,0]
  v_pk_fma_f16 v185, v57, v57, s21 op_sel_hi:[1,1,0]
  v_mfma_f32_32x32x16_f16 v[80:95], v[208:211], v[188:191], v[80:95]
  v_pk_fma_f16 v186, v58, v58, s21 op_sel_hi:[1,1,0]
  v_pk_fma_f16 v187, v59, v59, s21 op_sel_hi:[1,1,0]
  v_pk_fma_f16 v184, v184, v56, s21 op_sel:[0,0,1]
  v_pk_fma_f16 v185, v185, v57, s21 op_sel:[0,0,1]
  v_pk_fma_f16 v186, v186, v58, s21 op_sel:[0,0,1]
  v_pk_fma_f16 v187, v187, v59, s21 op_sel:[0,0,1]
  v_mfma_f32_32x32x16_f16 v[96:111], v[212:215], v[188:191], v[96:111]
  v_pk_fma_f16 v184, v184, v48, 0.5 op_sel_hi:[1,1,0] clamp
  v_pk_fma_f16 v185, v185, v49, 0.5 op_sel_hi:[1,1,0] clamp
  v_pk_fma_f16 v186, v186, v50, 0.5 op_sel_hi:[1,1,0] clamp
  v_pk_fma_f16 v187, v187, v51, 0.5 op_sel_hi:[1,1,0] clamp
  v_pk_mul_f16 v184, v184, v48
  v_pk_mul_f16 v185, v185, v49
  v_mfma_f32_32x32x16_bf16 v[16:31], a[120:123], v[160:163], 0
  ds_read_b128 v[192:195], v0 offset:30720
  ds_read_b128 v[196:199], v0 offset:31744
  v_pk_mul_f16 v186, v186, v50
  v_pk_mul_f16 v187, v187, v51
  v_pk_fma_f16 v56, v52, v52, s20 op_sel_hi:[1,1,0]
  v_pk_fma_f16 v57, v53, v53, s20 op_sel_hi:[1,1,0]
  v_mfma_f32_32x32x16_bf16 v[16:31], a[124:127], v[164:167], v[16:31]
  ds_read_b128 v[200:203], v0 offset:32768
  ds_read_b128 v[204:207], v0 offset:33792
  v_pk_fma_f16 v58, v54, v54, s20 op_sel_hi:[1,1,0]
  v_pk_fma_f16 v59, v55, v55, s20 op_sel_hi:[1,1,0]
  v_pk_fma_f16 v56, v56, v56, s20 op_sel:[0,0,1]
  v_pk_fma_f16 v57, v57, v57, s20 op_sel:[0,0,1]
  v_mfma_f32_32x32x16_bf16 v[16:31], a[128:131], v[168:171], v[16:31]
  ds_read_b128 v[208:211], v0 offset:34816
  ds_read_b128 v[212:215], v0 offset:35840
  v_pk_fma_f16 v58, v58, v58, s20 op_sel:[0,0,1]
  v_pk_fma_f16 v59, v59, v59, s20 op_sel:[0,0,1]
  v_pk_fma_f16 v188, v56, v56, s21 op_sel_hi:[1,1,0]
  v_pk_fma_f16 v189, v57, v57, s21 op_sel_hi:[1,1,0]
  v_mfma_f32_32x32x16_bf16 v[16:31], a[132:135], v[172:175], v[16:31]
  buffer_store_dwordx4 v[124:127], v10, s[8:11], s28 offen offset:96
  v_pk_fma_f16 v190, v58, v58, s21 op_sel_hi:[1,1,0]
  v_pk_fma_f16 v191, v59, v59, s21 op_sel_hi:[1,1,0]
  v_pk_fma_f16 v188, v188, v56, s21 op_sel:[0,0,1]
  v_pk_fma_f16 v189, v189, v57, s21 op_sel:[0,0,1]
  v_mfma_f32_32x32x16_bf16 v[16:31], a[136:139], v[176:179], v[16:31]
  v_mfma_f32_32x32x16_bf16 v[16:31], a[140:143], v[180:183], v[16:31]
  s_nop 0
  s_waitcnt lgkmcnt(0)
  v_pk_fma_f16 v190, v190, v58, s21 op_sel:[0,0,1]
  v_pk_fma_f16 v191, v191, v59, s21 op_sel:[0,0,1]
  v_pk_fma_f16 v188, v188, v52, 0.5 op_sel_hi:[1,1,0] clamp
  v_pk_fma_f16 v189, v189, v53, 0.5 op_sel_hi:[1,1,0] clamp
  v_pk_fma_f16 v190, v190, v54, 0.5 op_sel_hi:[1,1,0] clamp
  v_pk_fma_f16 v191, v191, v55, 0.5 op_sel_hi:[1,1,0] clamp
  v_mfma_f32_32x32x16_f16 v[64:79], v[192:195], v[184:187], v[64:79]
  v_pk_mul_f16 v188, v188, v52
  v_pk_mul_f16 v189, v189, v53
  v_pk_mul_f16 v190, v190, v54
  v_pk_mul_f16 v191, v191, v55
  v_mfma_f32_32x32x16_f16 v[80:95], v[196:199], v[184:187], v[80:95]
  v_cvt_pk_f16_f32 v48, v16, v17
  v_cvt_pk_f16_f32 v49, v18, v19
  v_cvt_pk_f16_f32 v50, v20, v21
  v_cvt_pk_f16_f32 v51, v22, v23
  v_cvt_pk_f16_f32 v52, v24, v25
  v_cvt_pk_f16_f32 v53, v26, v27
  v_mfma_f32_32x32x16_f16 v[96:111], v[200:203], v[184:187], v[96:111]
  v_cvt_pk_f16_f32 v54, v28, v29
  v_cvt_pk_f16_f32 v55, v30, v31
  v_pk_fma_f16 v56, v48, v48, s20 op_sel_hi:[1,1,0]
  v_pk_fma_f16 v57, v49, v49, s20 op_sel_hi:[1,1,0]
  v_pk_fma_f16 v58, v50, v50, s20 op_sel_hi:[1,1,0]
  v_pk_fma_f16 v59, v51, v51, s20 op_sel_hi:[1,1,0]
  v_mfma_f32_32x32x16_f16 v[64:79], v[204:207], v[188:191], v[64:79]
  v_pk_fma_f16 v56, v56, v56, s20 op_sel:[0,0,1]
  v_pk_fma_f16 v57, v57, v57, s20 op_sel:[0,0,1]
  v_pk_fma_f16 v58, v58, v58, s20 op_sel:[0,0,1]
  v_pk_fma_f16 v59, v59, v59, s20 op_sel:[0,0,1]
  v_pk_fma_f16 v184, v56, v56, s21 op_sel_hi:[1,1,0]
  v_pk_fma_f16 v185, v57, v57, s21 op_sel_hi:[1,1,0]
  v_mfma_f32_32x32x16_f16 v[80:95], v[208:211], v[188:191], v[80:95]
  v_pk_fma_f16 v186, v58, v58, s21 op_sel_hi:[1,1,0]
  v_pk_fma_f16 v187, v59, v59, s21 op_sel_hi:[1,1,0]
  v_pk_fma_f16 v184, v184, v56, s21 op_sel:[0,0,1]
  v_pk_fma_f16 v185, v185, v57, s21 op_sel:[0,0,1]
  v_pk_fma_f16 v186, v186, v58, s21 op_sel:[0,0,1]
  v_pk_fma_f16 v187, v187, v59, s21 op_sel:[0,0,1]
  v_mfma_f32_32x32x16_f16 v[96:111], v[212:215], v[188:191], v[96:111]
  v_pk_fma_f16 v184, v184, v48, 0.5 op_sel_hi:[1,1,0] clamp
  v_pk_fma_f16 v185, v185, v49, 0.5 op_sel_hi:[1,1,0] clamp
  v_pk_fma_f16 v186, v186, v50, 0.5 op_sel_hi:[1,1,0] clamp
  v_pk_fma_f16 v187, v187, v51, 0.5 op_sel_hi:[1,1,0] clamp
  v_pk_mul_f16 v184, v184, v48
  v_pk_mul_f16 v185, v185, v49
  v_mfma_f32_32x32x16_bf16 v[16:31], a[144:147], v[160:163], 0
  ds_read_b128 v[192:195], v0 offset:36864
  ds_read_b128 v[196:199], v0 offset:37888
  v_pk_mul_f16 v186, v186, v50
  v_pk_mul_f16 v187, v187, v51
  v_pk_fma_f16 v56, v52, v52, s20 op_sel_hi:[1,1,0]
  v_pk_fma_f16 v57, v53, v53, s20 op_sel_hi:[1,1,0]
  v_mfma_f32_32x32x16_bf16 v[16:31], a[148:151], v[164:167], v[16:31]
  ds_read_b128 v[200:203], v0 offset:38912
  ds_read_b128 v[204:207], v0 offset:39936
  v_pk_fma_f16 v58, v54, v54, s20 op_sel_hi:[1,1,0]
  v_pk_fma_f16 v59, v55, v55, s20 op_sel_hi:[1,1,0]
  v_pk_fma_f16 v56, v56, v56, s20 op_sel:[0,0,1]
  v_pk_fma_f16 v57, v57, v57, s20 op_sel:[0,0,1]
  v_mfma_f32_32x32x16_bf16 v[16:31], a[152:155], v[168:171], v[16:31]
  ds_read_b128 v[208:211], v0 offset:40960
  ds_read_b128 v[212:215], v0 offset:41984
  v_pk_fma_f16 v58, v58, v58, s20 op_sel:[0,0,1]
  v_pk_fma_f16 v59, v59, v59, s20 op_sel:[0,0,1]
  v_pk_fma_f16 v188, v56, v56, s21 op_sel_hi:[1,1,0]
  v_pk_fma_f16 v189, v57, v57, s21 op_sel_hi:[1,1,0]
  v_mfma_f32_32x32x16_bf16 v[16:31], a[156:159], v[172:175], v[16:31]
  v_pk_fma_f16 v190, v58, v58, s21 op_sel_hi:[1,1,0]
  v_pk_fma_f16 v191, v59, v59, s21 op_sel_hi:[1,1,0]
  v_pk_fma_f16 v188, v188, v56, s21 op_sel:[0,0,1]
  v_pk_fma_f16 v189, v189, v57, s21 op_sel:[0,0,1]
  v_mfma_f32_32x32x16_bf16 v[16:31], a[160:163], v[176:179], v[16:31]
  v_mfma_f32_32x32x16_bf16 v[16:31], a[164:167], v[180:183], v[16:31]
  s_nop 0
  s_waitcnt lgkmcnt(0)
  v_pk_fma_f16 v190, v190, v58, s21 op_sel:[0,0,1]
  v_pk_fma_f16 v191, v191, v59, s21 op_sel:[0,0,1]
  v_pk_fma_f16 v188, v188, v52, 0.5 op_sel_hi:[1,1,0] clamp
  v_pk_fma_f16 v189, v189, v53, 0.5 op_sel_hi:[1,1,0] clamp
  v_pk_fma_f16 v190, v190, v54, 0.5 op_sel_hi:[1,1,0] clamp
  v_pk_fma_f16 v191, v191, v55, 0.5 op_sel_hi:[1,1,0] clamp
  v_mfma_f32_32x32x16_f16 v[64:79], v[192:195], v[184:187], v[64:79]
  v_pk_mul_f16 v188, v188, v52
  v_pk_mul_f16 v189, v189, v53
  v_pk_mul_f16 v190, v190, v54
  v_pk_mul_f16 v191, v191, v55
  v_mfma_f32_32x32x16_f16 v[80:95], v[196:199], v[184:187], v[80:95]
  v_cvt_pk_f16_f32 v48, v16, v17
  v_cvt_pk_f16_f32 v49, v18, v19
  v_cvt_pk_f16_f32 v50, v20, v21
  v_cvt_pk_f16_f32 v51, v22, v23
  v_cvt_pk_f16_f32 v52, v24, v25
  v_cvt_pk_f16_f32 v53, v26, v27
  v_mfma_f32_32x32x16_f16 v[96:111], v[200:203], v[184:187], v[96:111]
  v_cvt_pk_f16_f32 v54, v28, v29
  v_cvt_pk_f16_f32 v55, v30, v31
  v_pk_fma_f16 v56, v48, v48, s20 op_sel_hi:[1,1,0]
  v_pk_fma_f16 v57, v49, v49, s20 op_sel_hi:[1,1,0]
  v_pk_fma_f16 v58, v50, v50, s20 op_sel_hi:[1,1,0]
  v_pk_fma_f16 v59, v51, v51, s20 op_sel_hi:[1,1,0]
  v_mfma_f32_32x32x16_f16 v[64:79], v[204:207], v[188:191], v[64:79]
  v_pk_fma_f16 v56, v56, v56, s20 op_sel:[0,0,1]
  v_pk_fma_f16 v57, v57, v57, s20 op_sel:[0,0,1]
  v_pk_fma_f16 v58, v58, v58, s20 op_sel:[0,0,1]
  v_pk_fma_f16 v59, v59, v59, s20 op_sel:[0,0,1]
  v_pk_fma_f16 v184, v56, v56, s21 op_sel_hi:[1,1,0]
  v_pk_fma_f16 v185, v57, v57, s21 op_sel_hi:[1,1,0]
  v_mfma_f32_32x32x16_f16 v[80:95], v[208:211], v[188:191], v[80:95]
  v_pk_fma_f16 v186, v58, v58, s21 op_sel_hi:[1,1,0]
  v_pk_fma_f16 v187, v59, v59, s21 op_sel_hi:[1,1,0]
  v_pk_fma_f16 v184, v184, v56, s21 op_sel:[0,0,1]
  v_pk_fma_f16 v185, v185, v57, s21 op_sel:[0,0,1]
  v_pk_fma_f16 v186, v186, v58, s21 op_sel:[0,0,1]
  v_pk_fma_f16 v187, v187, v59, s21 op_sel:[0,0,1]
  v_mfma_f32_32x32x16_f16 v[96:111], v[212:215], v[188:191], v[96:111]
  v_pk_fma_f16 v184, v184, v48, 0.5 op_sel_hi:[1,1,0] clamp
  v_pk_fma_f16 v185, v185, v49, 0.5 op_sel_hi:[1,1,0] clamp
  v_pk_fma_f16 v186, v186, v50, 0.5 op_sel_hi:[1,1,0] clamp
  v_pk_fma_f16 v187, v187, v51, 0.5 op_sel_hi:[1,1,0] clamp
  v_pk_mul_f16 v184, v184, v48
  v_pk_mul_f16 v185, v185, v49
  v_mfma_f32_32x32x16_bf16 v[16:31], a[168:171], v[160:163], 0
  ds_read_b128 v[192:195], v0 offset:43008
  ds_read_b128 v[196:199], v0 offset:44032
  v_pk_mul_f16 v186, v186, v50
  v_pk_mul_f16 v187, v187, v51
  v_pk_fma_f16 v56, v52, v52, s20 op_sel_hi:[1,1,0]
  v_pk_fma_f16 v57, v53, v53, s20 op_sel_hi:[1,1,0]
  v_mfma_f32_32x32x16_bf16 v[16:31], a[172:175], v[164:167], v[16:31]
  ds_read_b128 v[200:203], v0 offset:45056
  ds_read_b128 v[204:207], v0 offset:46080
  v_pk_fma_f16 v58, v54, v54, s20 op_sel_hi:[1,1,0]
  v_pk_fma_f16 v59, v55, v55, s20 op_sel_hi:[1,1,0]
  v_pk_fma_f16 v56, v56, v56, s20 op_sel:[0,0,1]
  v_pk_fma_f16 v57, v57, v57, s20 op_sel:[0,0,1]
  v_mfma_f32_32x32x16_bf16 v[16:31], a[176:179], v[168:171], v[16:31]
  ds_read_b128 v[208:211], v0 offset:47104
  ds_read_b128 v[212:215], v0 offset:48128
  v_pk_fma_f16 v58, v58, v58, s20 op_sel:[0,0,1]
  v_pk_fma_f16 v59, v59, v59, s20 op_sel:[0,0,1]
  v_pk_fma_f16 v188, v56, v56, s21 op_sel_hi:[1,1,0]
  v_pk_fma_f16 v189, v57, v57, s21 op_sel_hi:[1,1,0]
  v_mfma_f32_32x32x16_bf16 v[16:31], a[180:183], v[172:175], v[16:31]
  buffer_store_dwordx4 v[128:131], v10, s[8:11], s28 offen offset:128
  v_pk_fma_f16 v190, v58, v58, s21 op_sel_hi:[1,1,0]
  v_pk_fma_f16 v191, v59, v59, s21 op_sel_hi:[1,1,0]
  v_pk_fma_f16 v188, v188, v56, s21 op_sel:[0,0,1]
  v_pk_fma_f16 v189, v189, v57, s21 op_sel:[0,0,1]
  v_mfma_f32_32x32x16_bf16 v[16:31], a[184:187], v[176:179], v[16:31]
  v_mfma_f32_32x32x16_bf16 v[16:31], a[188:191], v[180:183], v[16:31]
  s_nop 0
  s_waitcnt lgkmcnt(0)
  v_pk_fma_f16 v190, v190, v58, s21 op_sel:[0,0,1]
  v_pk_fma_f16 v191, v191, v59, s21 op_sel:[0,0,1]
  v_pk_fma_f16 v188, v188, v52, 0.5 op_sel_hi:[1,1,0] clamp
  v_pk_fma_f16 v189, v189, v53, 0.5 op_sel_hi:[1,1,0] clamp
  v_pk_fma_f16 v190, v190, v54, 0.5 op_sel_hi:[1,1,0] clamp
  v_pk_fma_f16 v191, v191, v55, 0.5 op_sel_hi:[1,1,0] clamp
  v_mfma_f32_32x32x16_f16 v[64:79], v[192:195], v[184:187], v[64:79]
  v_pk_mul_f16 v188, v188, v52
  v_pk_mul_f16 v189, v189, v53
  v_pk_mul_f16 v190, v190, v54
  v_pk_mul_f16 v191, v191, v55
  v_mfma_f32_32x32x16_f16 v[80:95], v[196:199], v[184:187], v[80:95]
  v_cvt_pk_f16_f32 v48, v16, v17
  v_cvt_pk_f16_f32 v49, v18, v19
  v_cvt_pk_f16_f32 v50, v20, v21
  v_cvt_pk_f16_f32 v51, v22, v23
  v_cvt_pk_f16_f32 v52, v24, v25
  v_cvt_pk_f16_f32 v53, v26, v27
  v_mfma_f32_32x32x16_f16 v[96:111], v[200:203], v[184:187], v[96:111]
  v_cvt_pk_f16_f32 v54, v28, v29
  v_cvt_pk_f16_f32 v55, v30, v31
  v_pk_fma_f16 v56, v48, v48, s20 op_sel_hi:[1,1,0]
  v_pk_fma_f16 v57, v49, v49, s20 op_sel_hi:[1,1,0]
  v_pk_fma_f16 v58, v50, v50, s20 op_sel_hi:[1,1,0]
  v_pk_fma_f16 v59, v51, v51, s20 op_sel_hi:[1,1,0]
  v_mfma_f32_32x32x16_f16 v[64:79], v[204:207], v[188:191], v[64:79]
  v_pk_fma_f16 v56, v56, v56, s20 op_sel:[0,0,1]
  v_pk_fma_f16 v57, v57, v57, s20 op_sel:[0,0,1]
  v_pk_fma_f16 v58, v58, v58, s20 op_sel:[0,0,1]
  v_pk_fma_f16 v59, v59, v59, s20 op_sel:[0,0,1]
  v_pk_fma_f16 v184, v56, v56, s21 op_sel_hi:[1,1,0]
  v_pk_fma_f16 v185, v57, v57, s21 op_sel_hi:[1,1,0]
  v_mfma_f32_32x32x16_f16 v[80:95], v[208:211], v[188:191], v[80:95]
  v_pk_fma_f16 v186, v58, v58, s21 op_sel_hi:[1,1,0]
  v_pk_fma_f16 v187, v59, v59, s21 op_sel_hi:[1,1,0]
  v_pk_fma_f16 v184, v184, v56, s21 op_sel:[0,0,1]
  v_pk_fma_f16 v185, v185, v57, s21 op_sel:[0,0,1]
  v_pk_fma_f16 v186, v186, v58, s21 op_sel:[0,0,1]
  v_pk_fma_f16 v187, v187, v59, s21 op_sel:[0,0,1]
  v_mfma_f32_32x32x16_f16 v[96:111], v[212:215], v[188:191], v[96:111]
  v_pk_fma_f16 v184, v184, v48, 0.5 op_sel_hi:[1,1,0] clamp
  v_pk_fma_f16 v185, v185, v49, 0.5 op_sel_hi:[1,1,0] clamp
  v_pk_fma_f16 v186, v186, v50, 0.5 op_sel_hi:[1,1,0] clamp
  v_pk_fma_f16 v187, v187, v51, 0.5 op_sel_hi:[1,1,0] clamp
  v_pk_mul_f16 v184, v184, v48
  v_pk_mul_f16 v185, v185, v49
  v_mfma_f32_32x32x16_bf16 v[16:31], a[192:195], v[160:163], 0
  ds_read_b128 v[192:195], v0 offset:49152
  ds_read_b128 v[196:199], v0 offset:50176
  v_pk_mul_f16 v186, v186, v50
  v_pk_mul_f16 v187, v187, v51
  v_pk_fma_f16 v56, v52, v52, s20 op_sel_hi:[1,1,0]
  v_pk_fma_f16 v57, v53, v53, s20 op_sel_hi:[1,1,0]
  v_mfma_f32_32x32x16_bf16 v[16:31], a[196:199], v[164:167], v[16:31]
  ds_read_b128 v[200:203], v0 offset:51200
  ds_read_b128 v[204:207], v0 offset:52224
  v_pk_fma_f16 v58, v54, v54, s20 op_sel_hi:[1,1,0]
  v_pk_fma_f16 v59, v55, v55, s20 op_sel_hi:[1,1,0]
  v_pk_fma_f16 v56, v56, v56, s20 op_sel:[0,0,1]
  v_pk_fma_f16 v57, v57, v57, s20 op_sel:[0,0,1]
  v_mfma_f32_32x32x16_bf16 v[16:31], a[200:203], v[168:171], v[16:31]
  ds_read_b128 v[208:211], v0 offset:53248
  ds_read_b128 v[212:215], v0 offset:54272
  v_pk_fma_f16 v58, v58, v58, s20 op_sel:[0,0,1]
  v_pk_fma_f16 v59, v59, v59, s20 op_sel:[0,0,1]
  v_pk_fma_f16 v188, v56, v56, s21 op_sel_hi:[1,1,0]
  v_pk_fma_f16 v189, v57, v57, s21 op_sel_hi:[1,1,0]
  v_mfma_f32_32x32x16_bf16 v[16:31], a[204:207], v[172:175], v[16:31]
  buffer_store_dwordx4 v[132:135], v10, s[8:11], s28 offen offset:160
  v_pk_fma_f16 v190, v58, v58, s21 op_sel_hi:[1,1,0]
  v_pk_fma_f16 v191, v59, v59, s21 op_sel_hi:[1,1,0]
  v_pk_fma_f16 v188, v188, v56, s21 op_sel:[0,0,1]
  v_pk_fma_f16 v189, v189, v57, s21 op_sel:[0,0,1]
  v_mfma_f32_32x32x16_bf16 v[16:31], a[208:211], v[176:179], v[16:31]
  v_mfma_f32_32x32x16_bf16 v[16:31], a[212:215], v[180:183], v[16:31]
  s_nop 0
  s_waitcnt lgkmcnt(0)
  v_pk_fma_f16 v190, v190, v58, s21 op_sel:[0,0,1]
  v_pk_fma_f16 v191, v191, v59, s21 op_sel:[0,0,1]
  v_pk_fma_f16 v188, v188, v52, 0.5 op_sel_hi:[1,1,0] clamp
  v_pk_fma_f16 v189, v189, v53, 0.5 op_sel_hi:[1,1,0] clamp
  v_pk_fma_f16 v190, v190, v54, 0.5 op_sel_hi:[1,1,0] clamp
  v_pk_fma_f16 v191, v191, v55, 0.5 op_sel_hi:[1,1,0] clamp
  v_mfma_f32_32x32x16_f16 v[64:79], v[192:195], v[184:187], v[64:79]
  v_pk_mul_f16 v188, v188, v52
  v_pk_mul_f16 v189, v189, v53
  v_pk_mul_f16 v190, v190, v54
  v_pk_mul_f16 v191, v191, v55
  v_mfma_f32_32x32x16_f16 v[80:95], v[196:199], v[184:187], v[80:95]
  v_cvt_pk_f16_f32 v48, v16, v17
  v_cvt_pk_f16_f32 v49, v18, v19
  v_cvt_pk_f16_f32 v50, v20, v21
  v_cvt_pk_f16_f32 v51, v22, v23
  v_cvt_pk_f16_f32 v52, v24, v25
  v_cvt_pk_f16_f32 v53, v26, v27
  v_mfma_f32_32x32x16_f16 v[96:111], v[200:203], v[184:187], v[96:111]
  v_cvt_pk_f16_f32 v54, v28, v29
  v_cvt_pk_f16_f32 v55, v30, v31
  v_pk_fma_f16 v56, v48, v48, s20 op_sel_hi:[1,1,0]
  v_pk_fma_f16 v57, v49, v49, s20 op_sel_hi:[1,1,0]
  v_pk_fma_f16 v58, v50, v50, s20 op_sel_hi:[1,1,0]
  v_pk_fma_f16 v59, v51, v51, s20 op_sel_hi:[1,1,0]
  v_mfma_f32_32x32x16_f16 v[64:79], v[204:207], v[188:191], v[64:79]
  v_pk_fma_f16 v56, v56, v56, s20 op_sel:[0,0,1]
  v_pk_fma_f16 v57, v57, v57, s20 op_sel:[0,0,1]
  v_pk_fma_f16 v58, v58, v58, s20 op_sel:[0,0,1]
  v_pk_fma_f16 v59, v59, v59, s20 op_sel:[0,0,1]
  v_pk_fma_f16 v184, v56, v56, s21 op_sel_hi:[1,1,0]
  v_pk_fma_f16 v185, v57, v57, s21 op_sel_hi:[1,1,0]
  v_mfma_f32_32x32x16_f16 v[80:95], v[208:211], v[188:191], v[80:95]
  v_pk_fma_f16 v186, v58, v58, s21 op_sel_hi:[1,1,0]
  v_pk_fma_f16 v187, v59, v59, s21 op_sel_hi:[1,1,0]
  v_pk_fma_f16 v184, v184, v56, s21 op_sel:[0,0,1]
  v_pk_fma_f16 v185, v185, v57, s21 op_sel:[0,0,1]
  v_pk_fma_f16 v186, v186, v58, s21 op_sel:[0,0,1]
  v_pk_fma_f16 v187, v187, v59, s21 op_sel:[0,0,1]
  v_mfma_f32_32x32x16_f16 v[96:111], v[212:215], v[188:191], v[96:111]
  v_pk_fma_f16 v184, v184, v48, 0.5 op_sel_hi:[1,1,0] clamp
  v_pk_fma_f16 v185, v185, v49, 0.5 op_sel_hi:[1,1,0] clamp
  v_pk_fma_f16 v186, v186, v50, 0.5 op_sel_hi:[1,1,0] clamp
  v_pk_fma_f16 v187, v187, v51, 0.5 op_sel_hi:[1,1,0] clamp
  v_pk_mul_f16 v184, v184, v48
  v_pk_mul_f16 v185, v185, v49
  v_mfma_f32_32x32x16_bf16 v[16:31], a[216:219], v[160:163], 0
  ds_read_b128 v[192:195], v0 offset:55296
  ds_read_b128 v[196:199], v0 offset:56320
  v_pk_mul_f16 v186, v186, v50
  v_pk_mul_f16 v187, v187, v51
  v_pk_fma_f16 v56, v52, v52, s20 op_sel_hi:[1,1,0]
  v_pk_fma_f16 v57, v53, v53, s20 op_sel_hi:[1,1,0]
  v_mfma_f32_32x32x16_bf16 v[16:31], a[220:223], v[164:167], v[16:31]
  ds_read_b128 v[200:203], v0 offset:57344
  ds_read_b128 v[204:207], v0 offset:58368
  v_pk_fma_f16 v58, v54, v54, s20 op_sel_hi:[1,1,0]
  v_pk_fma_f16 v59, v55, v55, s20 op_sel_hi:[1,1,0]
  v_pk_fma_f16 v56, v56, v56, s20 op_sel:[0,0,1]
  v_pk_fma_f16 v57, v57, v57, s20 op_sel:[0,0,1]
  v_mfma_f32_32x32x16_bf16 v[16:31], a[224:227], v[168:171], v[16:31]
  ds_read_b128 v[208:211], v0 offset:59392
  ds_read_b128 v[212:215], v0 offset:60416
  v_pk_fma_f16 v58, v58, v58, s20 op_sel:[0,0,1]
  v_pk_fma_f16 v59, v59, v59, s20 op_sel:[0,0,1]
  v_pk_fma_f16 v188, v56, v56, s21 op_sel_hi:[1,1,0]
  v_pk_fma_f16 v189, v57, v57, s21 op_sel_hi:[1,1,0]
  v_mfma_f32_32x32x16_bf16 v[16:31], a[228:231], v[172:175], v[16:31]
  v_pk_fma_f16 v190, v58, v58, s21 op_sel_hi:[1,1,0]
  v_pk_fma_f16 v191, v59, v59, s21 op_sel_hi:[1,1,0]
  v_pk_fma_f16 v188, v188, v56, s21 op_sel:[0,0,1]
  v_pk_fma_f16 v189, v189, v57, s21 op_sel:[0,0,1]
  v_pk_fma_f16 v190, v190, v58, s21 op_sel:[0,0,1]
  v_mfma_f32_32x32x16_bf16 v[16:31], a[232:235], v[176:179], v[16:31]
  v_mfma_f32_32x32x16_bf16 v[16:31], a[236:239], v[180:183], v[16:31]
  s_nop 0
  s_waitcnt lgkmcnt(0)
  v_pk_fma_f16 v191, v191, v59, s21 op_sel:[0,0,1]
  v_pk_fma_f16 v188, v188, v52, 0.5 op_sel_hi:[1,1,0] clamp
  v_pk_fma_f16 v189, v189, v53, 0.5 op_sel_hi:[1,1,0] clamp
  v_pk_fma_f16 v190, v190, v54, 0.5 op_sel_hi:[1,1,0] clamp
  v_pk_fma_f16 v191, v191, v55, 0.5 op_sel_hi:[1,1,0] clamp
  v_pk_mul_f16 v188, v188, v52
  v_mfma_f32_32x32x16_f16 v[64:79], v[192:195], v[184:187], v[64:79]
  ds_read_b128 v[236:239], v0 offset:17408
  v_pk_mul_f16 v189, v189, v53
  v_pk_mul_f16 v190, v190, v54
  v_pk_mul_f16 v191, v191, v55
  v_mfma_f32_32x32x16_f16 v[80:95], v[196:199], v[184:187], v[80:95]
  v_cvt_pk_f16_f32 v48, v16, v17
  v_cvt_pk_f16_f32 v49, v18, v19
  v_cvt_pk_f16_f32 v50, v20, v21
  v_cvt_pk_f16_f32 v51, v22, v23
  v_cvt_pk_f16_f32 v52, v24, v25
  v_cvt_pk_f16_f32 v53, v26, v27
  v_mfma_f32_32x32x16_f16 v[96:111], v[200:203], v[184:187], v[96:111]
  v_cvt_pk_f16_f32 v54, v28, v29
  v_cvt_pk_f16_f32 v55, v30, v31
  v_pk_fma_f16 v56, v48, v48, s20 op_sel_hi:[1,1,0]
  v_pk_fma_f16 v57, v49, v49, s20 op_sel_hi:[1,1,0]
  v_pk_fma_f16 v58, v50, v50, s20 op_sel_hi:[1,1,0]
  v_pk_fma_f16 v59, v51, v51, s20 op_sel_hi:[1,1,0]
  v_mfma_f32_32x32x16_f16 v[64:79], v[204:207], v[188:191], v[64:79]
  s_nop 0
  s_mov_b32 s28, s34
  v_pk_fma_f16 v56, v56, v56, s20 op_sel:[0,0,1]
  v_pk_fma_f16 v57, v57, v57, s20 op_sel:[0,0,1]
  v_pk_fma_f16 v58, v58, v58, s20 op_sel:[0,0,1]
  v_pk_fma_f16 v59, v59, v59, s20 op_sel:[0,0,1]
  v_pk_fma_f16 v184, v56, v56, s21 op_sel_hi:[1,1,0]
  v_pk_fma_f16 v185, v57, v57, s21 op_sel_hi:[1,1,0]
  v_mfma_f32_32x32x16_f16 v[80:95], v[208:211], v[188:191], v[80:95]
  s_add_u32 s34, s34, 0x60000
  v_pk_fma_f16 v186, v58, v58, s21 op_sel_hi:[1,1,0]
  v_pk_fma_f16 v187, v59, v59, s21 op_sel_hi:[1,1,0]
  v_pk_fma_f16 v184, v184, v56, s21 op_sel:[0,0,1]
  v_pk_fma_f16 v185, v185, v57, s21 op_sel:[0,0,1]
  v_pk_fma_f16 v186, v186, v58, s21 op_sel:[0,0,1]
  v_pk_fma_f16 v187, v187, v59, s21 op_sel:[0,0,1]
  v_mfma_f32_32x32x16_f16 v[96:111], v[212:215], v[188:191], v[96:111]
  s_nop 0
  s_waitcnt lgkmcnt(0)
  v_pk_fma_f16 v184, v184, v48, 0.5 op_sel_hi:[1,1,0] clamp
  v_pk_fma_f16 v185, v185, v49, 0.5 op_sel_hi:[1,1,0] clamp
  v_pk_fma_f16 v186, v186, v50, 0.5 op_sel_hi:[1,1,0] clamp
  v_pk_fma_f16 v187, v187, v51, 0.5 op_sel_hi:[1,1,0] clamp
  v_pk_mul_f16 v184, v184, v48
  v_pk_mul_f16 v185, v185, v49
  v_mfma_f32_32x32x16_bf16 v[16:31], v[32:35], v[160:163], 0
  ds_read_b128 v[192:195], v0 offset:61440
  ds_read_b128 v[196:199], v0 offset:62464
  v_pk_mul_f16 v186, v186, v50
  v_pk_mul_f16 v187, v187, v51
  v_pk_fma_f16 v56, v52, v52, s20 op_sel_hi:[1,1,0]
  v_pk_fma_f16 v57, v53, v53, s20 op_sel_hi:[1,1,0]
  v_mfma_f32_32x32x16_bf16 v[16:31], v[36:39], v[164:167], v[16:31]
  ds_read_b128 v[200:203], v0 offset:63488
  ds_read_b128 v[204:207], v0 offset:64512
  v_pk_fma_f16 v58, v54, v54, s20 op_sel_hi:[1,1,0]
  v_pk_fma_f16 v59, v55, v55, s20 op_sel_hi:[1,1,0]
  v_pk_fma_f16 v56, v56, v56, s20 op_sel:[0,0,1]
  v_pk_fma_f16 v57, v57, v57, s20 op_sel:[0,0,1]
  v_mfma_f32_32x32x16_bf16 v[16:31], v[40:43], v[168:171], v[16:31]
  ds_read_b128 v[208:211], v1
  ds_read_b128 v[212:215], v1 offset:1024
  v_pk_fma_f16 v58, v58, v58, s20 op_sel:[0,0,1]
  v_pk_fma_f16 v59, v59, v59, s20 op_sel:[0,0,1]
  v_pk_fma_f16 v188, v56, v56, s21 op_sel_hi:[1,1,0]
  v_pk_fma_f16 v189, v57, v57, s21 op_sel_hi:[1,1,0]
  v_mfma_f32_32x32x16_bf16 v[16:31], v[44:47], v[172:175], v[16:31]
  v_pk_fma_f16 v190, v58, v58, s21 op_sel_hi:[1,1,0]
  v_pk_fma_f16 v191, v59, v59, s21 op_sel_hi:[1,1,0]
  v_pk_fma_f16 v188, v188, v56, s21 op_sel:[0,0,1]
  v_pk_fma_f16 v189, v189, v57, s21 op_sel:[0,0,1]
  v_mfma_f32_32x32x16_bf16 v[16:31], v[60:63], v[176:179], v[16:31]
  v_mfma_f32_32x32x16_bf16 v[16:31], v[236:239], v[180:183], v[16:31]
  s_nop 0
  s_waitcnt lgkmcnt(0)
  v_pk_fma_f16 v190, v190, v58, s21 op_sel:[0,0,1]
  v_pk_fma_f16 v191, v191, v59, s21 op_sel:[0,0,1]
  v_pk_fma_f16 v188, v188, v52, 0.5 op_sel_hi:[1,1,0] clamp
  v_pk_fma_f16 v189, v189, v53, 0.5 op_sel_hi:[1,1,0] clamp
  v_pk_fma_f16 v190, v190, v54, 0.5 op_sel_hi:[1,1,0] clamp
  v_pk_fma_f16 v191, v191, v55, 0.5 op_sel_hi:[1,1,0] clamp
  v_mfma_f32_32x32x16_f16 v[64:79], v[192:195], v[184:187], v[64:79]
  v_pk_mul_f16 v188, v188, v52
  v_pk_mul_f16 v189, v189, v53
  v_pk_mul_f16 v190, v190, v54
  v_pk_mul_f16 v191, v191, v55
  v_mfma_f32_32x32x16_f16 v[80:95], v[196:199], v[184:187], v[80:95]
  v_cvt_pk_f16_f32 v48, v16, v17
  v_cvt_pk_f16_f32 v49, v18, v19
  v_cvt_pk_f16_f32 v50, v20, v21
  v_cvt_pk_f16_f32 v51, v22, v23
  v_cvt_pk_f16_f32 v52, v24, v25
  v_cvt_pk_f16_f32 v53, v26, v27
  v_mfma_f32_32x32x16_f16 v[96:111], v[200:203], v[184:187], v[96:111]
  v_cvt_pk_f16_f32 v54, v28, v29
  v_cvt_pk_f16_f32 v55, v30, v31
  v_pk_fma_f16 v56, v48, v48, s20 op_sel_hi:[1,1,0]
  v_pk_fma_f16 v57, v49, v49, s20 op_sel_hi:[1,1,0]
  v_pk_fma_f16 v58, v50, v50, s20 op_sel_hi:[1,1,0]
  v_pk_fma_f16 v59, v51, v51, s20 op_sel_hi:[1,1,0]
  v_mfma_f32_32x32x16_f16 v[64:79], v[204:207], v[188:191], v[64:79]
  v_pk_fma_f16 v56, v56, v56, s20 op_sel:[0,0,1]
  v_pk_fma_f16 v57, v57, v57, s20 op_sel:[0,0,1]
  v_pk_fma_f16 v58, v58, v58, s20 op_sel:[0,0,1]
  v_pk_fma_f16 v59, v59, v59, s20 op_sel:[0,0,1]
  v_pk_fma_f16 v184, v56, v56, s21 op_sel_hi:[1,1,0]
  v_pk_fma_f16 v185, v57, v57, s21 op_sel_hi:[1,1,0]
  v_mfma_f32_32x32x16_f16 v[80:95], v[208:211], v[188:191], v[80:95]
  v_pk_fma_f16 v186, v58, v58, s21 op_sel_hi:[1,1,0]
  v_pk_fma_f16 v187, v59, v59, s21 op_sel_hi:[1,1,0]
  v_pk_fma_f16 v184, v184, v56, s21 op_sel:[0,0,1]
  v_pk_fma_f16 v185, v185, v57, s21 op_sel:[0,0,1]
  v_pk_fma_f16 v186, v186, v58, s21 op_sel:[0,0,1]
  v_pk_fma_f16 v187, v187, v59, s21 op_sel:[0,0,1]
  v_mfma_f32_32x32x16_f16 v[96:111], v[212:215], v[188:191], v[96:111]
  ds_read_b128 v[192:195], v1 offset:2048
  ds_read_b128 v[196:199], v1 offset:3072
  ds_read_b128 v[200:203], v1 offset:4096
  ds_read_b128 v[204:207], v1 offset:5120
  ds_read_b128 v[208:211], v1 offset:6144
  ds_read_b128 v[212:215], v1 offset:7168
  v_pk_fma_f16 v184, v184, v48, 0.5 op_sel_hi:[1,1,0] clamp
  v_pk_fma_f16 v185, v185, v49, 0.5 op_sel_hi:[1,1,0] clamp
  v_pk_fma_f16 v186, v186, v50, 0.5 op_sel_hi:[1,1,0] clamp
  v_pk_fma_f16 v187, v187, v51, 0.5 op_sel_hi:[1,1,0] clamp
  v_pk_mul_f16 v184, v184, v48
  v_pk_mul_f16 v185, v185, v49
  v_pk_mul_f16 v186, v186, v50
  v_pk_mul_f16 v187, v187, v51
  s_waitcnt lgkmcnt(5)
  s_nop 0
  v_mfma_f32_32x32x16_f16 v[64:79], v[192:195], v[184:187], v[64:79]
  v_pk_fma_f16 v56, v52, v52, s20 op_sel_hi:[1,1,0]
  v_pk_fma_f16 v57, v53, v53, s20 op_sel_hi:[1,1,0]
  v_pk_fma_f16 v58, v54, v54, s20 op_sel_hi:[1,1,0]
  v_pk_fma_f16 v59, v55, v55, s20 op_sel_hi:[1,1,0]
  v_pk_fma_f16 v56, v56, v56, s20 op_sel:[0,0,1]
  v_pk_fma_f16 v57, v57, v57, s20 op_sel:[0,0,1]
  v_pk_fma_f16 v58, v58, v58, s20 op_sel:[0,0,1]
  v_pk_fma_f16 v59, v59, v59, s20 op_sel:[0,0,1]
  s_nop 0
  s_waitcnt lgkmcnt(4)
  v_mfma_f32_32x32x16_f16 v[80:95], v[196:199], v[184:187], v[80:95]
  v_pk_fma_f16 v188, v56, v56, s21 op_sel_hi:[1,1,0]
  v_pk_fma_f16 v189, v57, v57, s21 op_sel_hi:[1,1,0]
  v_pk_fma_f16 v190, v58, v58, s21 op_sel_hi:[1,1,0]
  v_pk_fma_f16 v191, v59, v59, s21 op_sel_hi:[1,1,0]
  v_pk_fma_f16 v188, v188, v56, s21 op_sel:[0,0,1]
  v_pk_fma_f16 v189, v189, v57, s21 op_sel:[0,0,1]
  v_pk_fma_f16 v190, v190, v58, s21 op_sel:[0,0,1]
  v_pk_fma_f16 v191, v191, v59, s21 op_sel:[0,0,1]
  s_nop 0
  s_waitcnt lgkmcnt(3)
  v_mfma_f32_32x32x16_f16 v[96:111], v[200:203], v[184:187], v[96:111]
  v_pk_fma_f16 v188, v188, v52, 0.5 op_sel_hi:[1,1,0] clamp
  v_pk_fma_f16 v189, v189, v53, 0.5 op_sel_hi:[1,1,0] clamp
  v_pk_fma_f16 v190, v190, v54, 0.5 op_sel_hi:[1,1,0] clamp
  v_pk_fma_f16 v191, v191, v55, 0.5 op_sel_hi:[1,1,0] clamp
  v_pk_mul_f16 v188, v188, v52
  v_pk_mul_f16 v189, v189, v53
  v_pk_mul_f16 v190, v190, v54
  v_pk_mul_f16 v191, v191, v55
  s_waitcnt lgkmcnt(2)
  s_nop 0
  v_mfma_f32_32x32x16_f16 v[64:79], v[204:207], v[188:191], v[64:79]
  s_waitcnt lgkmcnt(1)
  v_mfma_f32_32x32x16_f16 v[80:95], v[208:211], v[188:191], v[80:95]
  s_waitcnt lgkmcnt(0)
  v_mfma_f32_32x32x16_f16 v[96:111], v[212:215], v[188:191], v[96:111]
  s_nop 0
  s_nop 7
  v_cvt_pk_bf16_f32 v112, v64, v65
  v_cvt_pk_bf16_f32 v113, v66, v67
  v_cvt_pk_bf16_f32 v114, v68, v69
  v_cvt_pk_bf16_f32 v115, v70, v71
  buffer_store_dwordx4 v[112:115], v10, s[8:11], s28 offen
  v_cvt_pk_bf16_f32 v116, v72, v73
  v_cvt_pk_bf16_f32 v117, v74, v75
  v_cvt_pk_bf16_f32 v118, v76, v77
  v_cvt_pk_bf16_f32 v119, v78, v79
  buffer_store_dwordx4 v[116:119], v10, s[8:11], s28 offen offset:32
  v_cvt_pk_bf16_f32 v120, v80, v81
  v_cvt_pk_bf16_f32 v121, v82, v83
  v_cvt_pk_bf16_f32 v122, v84, v85
  v_cvt_pk_bf16_f32 v123, v86, v87
  buffer_store_dwordx4 v[120:123], v10, s[8:11], s28 offen offset:64
  v_cvt_pk_bf16_f32 v124, v88, v89
  v_cvt_pk_bf16_f32 v125, v90, v91
  v_cvt_pk_bf16_f32 v126, v92, v93
  v_cvt_pk_bf16_f32 v127, v94, v95
  buffer_store_dwordx4 v[124:127], v10, s[8:11], s28 offen offset:96
  v_cvt_pk_bf16_f32 v128, v96, v97
  v_cvt_pk_bf16_f32 v129, v98, v99
  v_cvt_pk_bf16_f32 v130, v100, v101
  v_cvt_pk_bf16_f32 v131, v102, v103
  buffer_store_dwordx4 v[128:131], v10, s[8:11], s28 offen offset:128
  v_cvt_pk_bf16_f32 v132, v104, v105
  v_cvt_pk_bf16_f32 v133, v106, v107
  v_cvt_pk_bf16_f32 v134, v108, v109
  v_cvt_pk_bf16_f32 v135, v110, v111
  buffer_store_dwordx4 v[132:135], v10, s[8:11], s28 offen offset:160
L_end:
  s_endpgm
L_slow:
  s_waitcnt vmcnt(0) lgkmcnt(0)
  s_nop 15
  s_nop 15
  s_barrier
  v_mbcnt_lo_u32_b32 v0, -1, 0
  v_mbcnt_hi_u32_b32 v0, -1, v0
  v_lshl_add_u32 v0, s27, 6, v0
  s_nop 4
  .p2align 7
  s_cmp_ge_u32 s2, 0x100
  s_nop 0
  s_cbranch_scc1 S_end
  s_load_dwordx2 s[4:5], s[0:1], 0
  s_load_dwordx2 s[60:61], s[0:1], 8
  s_load_dwordx2 s[64:65], s[0:1], 16
  s_load_dwordx2 s[68:69], s[0:1], 24
  s_load_dwordx2 s[72:73], s[0:1], 32
  s_load_dwordx2 s[76:77], s[0:1], 40
  s_load_dwordx2 s[80:81], s[0:1], 48
  s_load_dwordx2 s[8:9], s[0:1], 56
  s_getpc_b64 s[40:41]
S_pc:
  s_lshl_b32 s32, s2, 9
  s_and_b32 s32, s32, 0xf000
  v_lshl_add_u32 v249, v0, 4, s32
  v_lshrrev_b32_e64 v112, 6, v0
  v_min_u32 v249, S_end-S_pc-12, v249
  v_and_b32 v113, 63, v0
  global_load_dwordx4 v[108:111], v249, s[40:41]
  v_readfirstlane_b32 s27, v112
  s_mov_b32 s62, 0x6c0
  s_mov_b32 s63, 0x20000
  s_mov_b32 s82, 0xc0
  s_mov_b32 s83, 0x20000
  s_mov_b32 s78, 0xc0
  s_mov_b32 s79, 0x20000
  s_mov_b32 s66, 0x12000
  s_mov_b32 s67, 0x20000
  s_mov_b32 s74, 0x12000
  s_mov_b32 s75, 0x20000
  v_bfe_u32 v114, v113, 3, 1
  v_bfe_u32 v115, v113, 4, 1
  v_bfe_u32 v116, v113, 2, 1
  v_and_b32 v117, 3, v113
  v_lshlrev_b32 v118, 4, v113
  s_min_u32 s44, s27, 2
  s_lshl_b32 s45, s44, 6
  s_mul_i32 s46, s44, 0x240
  v_lshlrev_b32 v119, 1, v113
  v_and_b32 v120, 31, v113
  v_lshlrev_b32 v121, 1, v120
  v_lshlrev_b32 v122, 4, v115
  v_lshl_add_u32 v122, v116, 3, v122
  v_lshl_add_u32 v122, v114, 2, v122
  v_add_u32 v122, v122, v117
  v_lshlrev_b32 v123, 1, v122
  s_lshr_b32 s35, s2, 3
  s_lshl_b32 s35, s35, 2
  s_add_u32 s35, s35, s27
  s_sub_u32 s55, s35, 0x48
  s_min_u32 s35, s35, s55
  s_lshl_b32 s47, s35, 10
  s_and_b32 s54, s2, 6
  s_lshl_b32 s54, s54, 1
  s_lshr_b32 s32, s2, 6
  s_add_u32 s54, s54, s32
  s_mul_i32 s59, s54, 0x300000
  s_and_b32 s53, s2, 1
  s_lshl_b32 s53, s53, 8
  s_and_b32 s32, s2, 56
  s_lshl_b32 s32, s32, 2
  s_add_u32 s53, s53, s32
  s_lshl_b32 s32, s27, 3
  s_add_u32 s53, s53, s32
  s_mul_i32 s3, s53, 0xc0
  s_add_u32 s3, s3, 0xf40
  s_mov_b32 s6, 0x3000000
  s_mov_b32 s7, 0x20000
  s_cmp_eq_u32 s53, 0
  s_cselect_b32 s35, 12, 0
  s_sub_u32 s55, 0x78, s35
  s_cmp_eq_u32 s53, 0x1f8
  s_cselect_b32 s55, 0x6c, s55
  s_mul_i32 s15, s27, 0x1040
  s_add_u32 s48, s59, 0x17000
  s_add_u32 s49, s59, 0x47000
  s_waitcnt lgkmcnt(0)
  v_add_u32 v124, 64, v113
  buffer_load_dwordx4 v[108:111], v118, s[64:67], s47 offen
  v_subrev_u32 v127, 57, v113
  v_cmp_le_u32 vcc, 57, v113
  buffer_load_dwordx4 v[108:111], v118, s[72:75], s47 offen
  v_add_u32_e64 v125, 7, v113
  v_add_u32 v126, 0x47, v113
  buffer_load_ushort v129, v119, s[60:63], s46 offen
  v_mov_b32 v199, 0x17c00
  v_cndmask_b32_e64 v124, v124, v127, vcc
  buffer_load_ushort v130, v119, s[60:63], s46 offen offset:128
  v_mov_b32 v127, 0xfffffc00
  v_cndmask_b32 v199, v127, v199, vcc
  v_add_u32 v198, s3, v118
  buffer_load_ushort v131, v119, s[60:63], s46 offen offset:256
  v_lshl_add_u32 v199, v124, 4, v199
  v_add_u32_e64 v199, s3, v199
  buffer_load_ushort v132, v119, s[60:63], s46 offen offset:384
  v_add_u32 v200, 0x17870, v198
  v_add_u32 v201, 0x17870, v198
  buffer_load_ushort v133, v121, s[60:63], s46 offen offset:512
  v_mov_b32 v128, 0x80000000
  v_subrev_u32_e64 v6, s35, v113
  buffer_load_ushort v137, v123, s[80:83], s45 offen
  v_cmp_gt_u32 s[36:37], s55, v6
  v_subrev_u32_e64 v7, s35, v124
  v_cmp_gt_u32 s[38:39], s55, v7
  buffer_load_ushort v138, v123, s[76:79], s45 offen
  v_subrev_u32_e64 v8, s35, v125
  v_cmp_gt_u32 s[40:41], s55, v8
  buffer_load_ushort v134, v123, s[80:83], 0 offen
  v_subrev_u32_e64 v9, s35, v126
  v_cmp_gt_u32 s[42:43], s55, v9
  buffer_load_ushort v135, v123, s[80:83], 0 offen offset:64
  v_cndmask_b32 v6, v128, v198, s[36:37]
  v_cndmask_b32 v7, v128, v199, s[38:39]
  buffer_load_ushort v136, v123, s[80:83], 0 offen offset:128
  v_cndmask_b32 v8, v128, v200, s[40:41]
  v_cndmask_b32 v9, v128, v201, s[42:43]
  s_add_u32 m0, s15, 0x4120
  s_nop 0
  s_nop 0
  buffer_load_dwordx4 v6, s[4:7], s48 offen lds
  buffer_load_dwordx4 v7, s[4:7], s48 offen offset:1024 lds
  buffer_load_dwordx4 v8, s[4:7], s48 offen offset:2048 lds
  buffer_load_dwordx4 v9, s[4:7], s48 offen offset:3072 lds
  s_sub_u32 s56, s59, 0x19000
  v_add_u32_e64 v198, s56, v6
  s_add_u32 s56, s56, 0x400
  v_add_u32_e64 v199, s56, v7
  s_add_u32 s56, s56, 0x400
  v_add_u32_e64 v200, s56, v8
  s_add_u32 s56, s56, 0x400
  v_add_u32 v201, s56, v9
  v_lshrrev_b32 v139, 5, v113
  v_lshlrev_b32_e64 v202, 4, v117
  v_lshl_add_u32 v202, v139, 6, v202
  v_bfe_u32 v124, v113, 3, 2
  v_lshl_add_u32 v124, v116, 2, v124
  v_cmp_eq_u32_e64 vcc, 7, v124
  v_mul_u32_u24 v203, 0x300, v124
  v_add_u32 v203, v203, v202
  v_cndmask_b32 v204, v128, v202, vcc
  s_mov_b32 s70, 0x300
  s_mov_b32 s71, 0x20000
  s_mov_b32 s10, 0x3000000
  s_mov_b32 s11, 0x20000
  s_and_b32 s36, s27, 2
  s_add_u32 s37, s27, 1
  s_lshr_b32 s37, s37, 1
  s_and_b32 s38, s37, 1
  s_cmp_eq_u32 s27, 1
  s_cselect_b32 s39, 0, 3
  s_cselect_b32 s51, 0x1000, 0
  s_lshl_b32 s32, s36, 8
  s_lshl_b32 s33, s37, 8
  s_add_u32 s43, s32, 0x11d00
  s_add_u32 s50, s33, 0x11d00
  s_add_u32 s51, s51, s33
  s_mul_i32 s40, s38, 0x6000
  s_add_u32 s40, s40, s32
  s_mul_i32 s41, s38, 0x1800
  s_add_u32 s41, s41, s32
  s_add_u32 s41, s41, 0x3000
  s_mul_i32 s42, s39, 0x3000
  s_add_u32 s42, s42, s33
  s_mul_i32 s32, s36, 0x6000
  s_lshl_b32 s33, s38, 11
  s_add_u32 s33, s33, s32
  s_add_u32 s33, s33, 0x10000
  v_add_u32_e64 v195, s33, v118
  s_lshl_b32 s33, s38, 3
  s_add_u32 s33, s33, s32
  s_add_u32 s33, s33, 0x10400
  v_add_u32_e64 v196, s33, v118
  s_mul_i32 s32, s37, 0x6000
  s_lshl_b32 s33, s39, 10
  s_add_u32 s33, s33, s32
  s_add_u32 s33, s33, 0x10000
  v_add_u32 v197, s33, v118
  v_add_u32 v125, 16, v113
  v_lshrrev_b32_e64 v125, 6, v125
  buffer_load_dwordx4 a[72:75], v202, s[64:67], s43 offen
  v_lshlrev_b32 v125, 4, v125
  v_xor_b32 v254, v125, v118
  v_lshl_add_u32 v125, v139, 4, 16
  v_xor_b32_e64 v255, v125, v118
  v_mul_u32_u24 v125, 0x1200, v139
  v_add_u32_e64 v255, v125, v255
  v_add_u32 v125, 0xb0, v113
  v_lshrrev_b32 v125, 6, v125
  v_lshlrev_b32 v125, 4, v125
  v_xor_b32_e64 v194, v125, v118
  v_add_u32 v194, 0x1200, v194
  s_mul_i32 s14, s27, 0x1800
  s_add_u32 s32, s27, 3
  s_and_b32 s32, s32, 3
  s_mul_i32 s32, s32, 0x600
  s_cmp_eq_u32 s27, 0
  s_cselect_b32 s57, 0, 3
  s_cselect_b32 s53, 3, 6
  s_cselect_b32 s55, 6, 0
  s_lshl_b32 s57, s57, 13
  s_add_u32 s57, s57, s32
  s_add_u32 s58, s57, 0x3000
  s_lshl_b32 s53, s53, 13
  s_add_u32 s53, s53, s32
  s_add_u32 s54, s53, 0x3000
  s_lshl_b32 s55, s55, 13
  s_add_u32 s55, s55, s32
  s_add_u32 s56, s55, 0x3000
  v_and_b32_e64 v145, 7, v113
  buffer_load_dwordx4 a[76:79], v202, s[64:67], s43 offen offset:128
  v_lshrrev_b32 v146, 4, v113
  v_lshlrev_b32 v147, 4, v139
  v_and_b32 v141, 1, v113
  v_lshlrev_b32 v141, 4, v141
  v_mov_b32 v127, 0xffff
  v_lshlrev_b32_e64 v127, v141, v127
  v_bfe_u32 v125, v113, 1, 2
  buffer_load_dwordx4 a[80:83], v202, s[64:67], s50 offen
  v_lshlrev_b32 v125, v125, 1
  v_bfe_i32 v56, v125, 0, 1
  v_mov_b32 v60, 0
  v_and_b32 v56, v56, v127
  v_bfe_i32 v57, v125, 1, 1
  v_mov_b32 v61, 0
  v_and_b32 v57, v57, v127
  v_bfe_i32 v58, v125, 2, 1
  v_mov_b32 v62, 0
  v_and_b32 v58, v58, v127
  v_bfe_i32 v59, v125, 3, 1
  v_mov_b32 v63, 0
  v_and_b32 v59, v59, v127
  v_min_u32_e64 v125, 35, v113
  v_mul_u32_u24 v125, 0x190, v125
  ds_write_b128 v125, v[60:63] offset:50304
  s_lshl_b32 s32, s44, 7
  v_lshrrev_b32 v142, 3, v113
  buffer_load_dwordx4 a[84:87], v202, s[64:67], s50 offen offset:128
  v_mul_u32_u24 v142, 0x190, v142
  v_lshl_add_u32 v142, v145, 4, v142
  v_add_u32 v142, s32, v142
  v_lshrrev_b32 v143, 3, v120
  v_mul_u32_u24 v143, 0x190, v143
  v_lshl_add_u32 v143, v145, 4, v143
  v_add_u32_e64 v143, s32, v143
  v_lshl_add_u32 v144, v120, 2, s32
  v_sub_u32_e64 v125, v146, v116
  v_lshl_add_u32 v126, v114, 2, v117
  v_lshl_add_u32 v126, v125, 3, v126
  v_min_u32 v126, 24, v126
  v_lshlrev_b32 v126, 4, v126
  v_add_u32 v3, 0xc300, v126
  v_lshlrev_b32_e64 v148, 2, v115
  v_lshl_add_u32 v148, v114, 1, v148
  v_bfe_u32 v126, v113, 1, 1
  buffer_load_dwordx4 a[88:91], v204, s[68:71], s51 offen
  v_add_u32 v148, v148, v126
  v_xor_b32 v126, v116, v139
  v_lshl_add_u32 v148, v126, 3, v148
  v_lshlrev_b32 v148, v148, 1
  v_mov_b32 v126, 0x3f80
  v_lshlrev_b32_e64 v126, v141, v126
  v_mov_b32 v125, 0xbf80
  v_lshlrev_b32_e64 v125, v141, v125
  v_bfe_i32 v160, v148, 0, 1
  v_and_b32 v240, v160, v126
  v_and_b32 v184, v160, v125
  v_bfe_i32 v161, v148, 1, 1
  v_and_b32 v241, v161, v126
  v_and_b32 v185, v161, v125
  v_bfe_i32 v162, v148, 2, 1
  v_and_b32 v242, v162, v126
  v_and_b32 v186, v162, v125
  v_bfe_i32 v163, v148, 3, 1
  buffer_load_dwordx4 a[92:95], v204, s[68:71], s51 offen offset:128
  v_and_b32 v243, v163, v126
  v_and_b32 v187, v163, v125
  v_bfe_i32 v164, v148, 4, 1
  v_and_b32 v244, v164, v126
  v_and_b32 v188, v164, v125
  v_bfe_i32 v165, v148, 5, 1
  v_and_b32 v245, v165, v126
  v_and_b32 v189, v165, v125
  v_bfe_i32 v166, v148, 6, 1
  v_and_b32 v246, v166, v126
  v_and_b32 v190, v166, v125
  v_bfe_i32 v167, v148, 7, 1
  v_and_b32 v247, v167, v126
  v_and_b32 v191, v167, v125
  s_mov_b32 s22, 0x3eeff558
  s_mov_b32 s24, 0x3c2aaaab
  s_mov_b32 s25, 0x3727c5ac
  s_mov_b32 s20, 0x409d30fc
  s_mov_b32 s21, 0x409d30fc
  s_mov_b32 s23, 0x3eeff558
  s_mov_b32 s12, 0
  s_mov_b32 s13, -1
  s_add_u32 s29, s59, 0x77000
  s_add_u32 s52, s59, 0xa7000
  v_mul_u32_u24 v149, 0xc0, v145
  buffer_load_dwordx4 a[0:3], v203, s[64:67], s40 offen
  v_add_u32_e64 v127, s15, v149
  v_lshl_add_u32 v150, v114, 1, v146
  v_lshrrev_b32_e64 v125, 1, v150
  v_mul_u32_u24 v140, 0x4100, v125
  v_and_b32_e64 v125, 1, v125
  v_lshl_add_u32 v140, v125, 5, v140
  v_and_b32_e64 v125, 1, v150
  v_mul_u32_u24 v125, 0x790, v125
  v_add3_u32 v4, v140, v125, v127
  v_lshl_add_u32 v151, v114, 1, v115
  buffer_load_dwordx4 a[4:7], v203, s[64:67], s40 offen offset:128
  s_add_u32 s40, s40, 0x1800
  v_add_u32_e64 v150, 1, v151
  v_add_u32 v127, 0xc0, v127
  v_add_u32 v127, v127, v147
  v_lshrrev_b32 v125, 1, v150
  v_mul_u32_u24 v140, 0x4100, v125
  v_and_b32_e64 v125, 1, v125
  v_lshl_add_u32 v140, v125, 5, v140
  v_and_b32_e64 v125, 1, v150
  v_mul_u32_u24 v125, 0x790, v125
  v_add3_u32 v5, v140, v125, v127
  v_mul_u32_u24 v125, 0x18000, v151
  v_add3_u32 v10, v125, v147, v149
  s_sub_u32 s32, s3, 0xf40
  v_add_u32_e64 v10, s32, v10
  v_add_u32 v2, 0xfb40, v147
  v_add_u32 v0, 0x10000, v118
  v_add_u32 v1, 0x20000, v118
  v_and_b32_e64 v125, 15, v113
  buffer_load_dwordx4 a[8:11], v203, s[64:67], s40 offen
  v_lshlrev_b32 v125, 7, v125
  v_mul_u32_u24 v126, 0x18000, v146
  s_sub_u32 s32, s3, 64
  v_add3_u32 v248, v125, v126, s32
  v_mov_b32 v250, 0x3ef00000
  s_add_u32 s32, s14, 0x16000
  v_add_u32_e64 v253, s32, v118
  v_bfe_u32 v125, v122, 2, 2
  v_xor_b32_e64 v125, v125, v139
  v_lshl_add_u32 v125, v125, 4, s32
  v_mul_u32_u24 v126, 0xc0, v122
  v_add_u32 v251, v125, v126
  v_xor_b32 v252, 32, v251
  s_add_u32 s30, s15, 32
  s_add_u32 s31, s15, 0x4100
  s_mov_b32 s34, s59
  s_mov_b32 s28, 0x80000000
  s_add_u32 s33, s15, 0x8200
  buffer_load_dwordx4 a[12:15], v203, s[64:67], s40 offen offset:128
  buffer_load_dwordx4 a[16:19], v203, s[64:67], s41 offen
  buffer_load_dwordx4 a[20:23], v203, s[64:67], s41 offen offset:128
  s_waitcnt vmcnt(25)
  v_lshl_or_b32 v129, v129, 16, v129
  v_and_b32 v16, v56, v129
  v_and_b32 v17, v57, v129
  v_and_b32 v18, v58, v129
  v_and_b32 v19, v59, v129
  ds_write_b128 v142, v[16:19] offset:49920
  s_waitcnt vmcnt(24)
  v_lshl_or_b32 v130, v130, 16, v130
  v_and_b32 v20, v56, v130
  v_and_b32 v21, v57, v130
  v_and_b32 v22, v58, v130
  v_and_b32 v23, v59, v130
  ds_write_b128 v142, v[20:23] offset:53120
  s_waitcnt vmcnt(23)
  v_lshl_or_b32 v131, v131, 16, v131
  v_and_b32 v24, v56, v131
  v_and_b32 v25, v57, v131
  v_and_b32 v26, v58, v131
  v_and_b32 v27, v59, v131
  ds_write_b128 v142, v[24:27] offset:56320
  s_waitcnt vmcnt(22)
  v_lshl_or_b32 v132, v132, 16, v132
  v_and_b32 v28, v56, v132
  v_and_b32 v29, v57, v132
  v_and_b32 v30, v58, v132
  v_and_b32 v31, v59, v132
  ds_write_b128 v142, v[28:31] offset:59520
  s_waitcnt vmcnt(21)
  v_lshl_or_b32 v133, v133, 16, v133
  v_and_b32 v16, v56, v133
  v_and_b32 v17, v57, v133
  v_and_b32 v18, v58, v133
  v_and_b32_e64 v19, v59, v133
  ds_write_b128 v143, v[16:19] offset:62720
  s_waitcnt vmcnt(20)
  v_lshlrev_b32 v137, 16, v137
  s_waitcnt vmcnt(19)
  v_lshlrev_b32 v138, 16, v138
  v_mul_f32 v138, v137, v138
  s_waitcnt vmcnt(18)
  v_lshlrev_b32 v134, v141, v134
  s_waitcnt vmcnt(17)
  v_lshlrev_b32 v135, v141, v135
  s_waitcnt vmcnt(16)
  v_lshlrev_b32_e64 v136, v141, v136
  ds_write_b32 v144, v138 offset:64320
  s_waitcnt lgkmcnt(0)
  s_barrier
  ds_read_b128 a[96:99], v3
  ds_read_b128 a[100:103], v3 offset:4800
  ds_read_b128 a[104:107], v3 offset:9600
  ds_read_b128 a[108:111], v3 offset:400
  ds_read_b128 a[112:115], v3 offset:5200
  ds_read_b128 a[116:119], v3 offset:10000
  v_and_b32 v125, v160, v134
  v_and_b32 v126, v161, v134
  v_and_b32_e64 v127, v162, v134
  buffer_load_dwordx4 a[24:27], v203, s[64:67], s42 offen
  v_and_b32_e64 v140, v163, v134
  v_accvgpr_write_b32 a192, v125
  v_accvgpr_write_b32 a193, v126
  v_accvgpr_write_b32 a194, v127
  v_accvgpr_write_b32 a195, v140
  ds_read_b128 a[120:123], v3 offset:800
  ds_read_b128 a[124:127], v3 offset:5600
  ds_read_b128 a[128:131], v3 offset:10400
  ds_read_b128 a[132:135], v3 offset:1200
  ds_read_b128 a[136:139], v3 offset:6000
  ds_read_b128 a[140:143], v3 offset:10800
  buffer_load_dwordx4 a[28:31], v203, s[64:67], s42 offen offset:128
  s_add_u32 s42, s42, 0x1800
  v_and_b32 v125, v164, v134
  v_and_b32 v126, v165, v134
  v_and_b32 v127, v166, v134
  v_and_b32 v140, v167, v134
  v_accvgpr_write_b32 a196, v125
  v_accvgpr_write_b32 a197, v126
  v_accvgpr_write_b32 a198, v127
  v_accvgpr_write_b32 a199, v140
  ds_read_b128 a[144:147], v3 offset:1600
  ds_read_b128 a[148:151], v3 offset:6400
  buffer_load_dwordx4 a[32:35], v203, s[64:67], s42 offen
  ds_read_b128 a[152:155], v3 offset:11200
  ds_read_b128 a[156:159], v3 offset:2000
  ds_read_b128 a[160:163], v3 offset:6800
  ds_read_b128 a[164:167], v3 offset:11600
  v_and_b32 v125, v160, v135
  v_and_b32 v126, v161, v135
  v_and_b32 v127, v162, v135
  v_and_b32 v140, v163, v135
  v_accvgpr_write_b32 a200, v125
  v_accvgpr_write_b32 a201, v126
  v_accvgpr_write_b32 a202, v127
  buffer_load_dwordx4 a[36:39], v203, s[64:67], s42 offen offset:128
  s_add_u32 s42, s42, 0x1800
  v_accvgpr_write_b32 a203, v140
  ds_read_b128 a[240:243], v3 offset:2400
  ds_read_b128 a[244:247], v3 offset:7200
  ds_read_b128 a[248:251], v3 offset:12000
  ds_read_b128 a[168:171], v3 offset:2800
  ds_read_b128 a[172:175], v3 offset:7600
  ds_read_b128 a[176:179], v3 offset:12400
  v_and_b32 v125, v164, v135
  v_and_b32 v126, v165, v135
  v_and_b32 v127, v166, v135
  v_and_b32 v140, v167, v135
  buffer_load_dwordx4 a[40:43], v203, s[64:67], s42 offen
  v_accvgpr_write_b32 a204, v125
  v_accvgpr_write_b32 a205, v126
  v_accvgpr_write_b32 a206, v127
  v_accvgpr_write_b32 a207, v140
  ds_read_b128 a[252:255], v3 offset:3200
  ds_read_b128 a[180:183], v3 offset:8000
  ds_read_b128 a[184:187], v3 offset:12800
  ds_read_b128 a[188:191], v3 offset:3600
  ds_read_b128 a[216:219], v3 offset:8400
  ds_read_b128 a[220:223], v3 offset:13200
  buffer_load_dwordx4 a[44:47], v203, s[64:67], s42 offen offset:128
  s_add_u32 s42, s42, 0x1800
  v_and_b32 v125, v160, v136
  v_and_b32 v126, v161, v136
  v_and_b32 v127, v162, v136
  v_and_b32 v140, v163, v136
  v_accvgpr_write_b32 a208, v125
  v_accvgpr_write_b32 a209, v126
  v_accvgpr_write_b32 a210, v127
  v_accvgpr_write_b32 a211, v140
  ds_read_b128 a[224:227], v3 offset:4000
  ds_read_b128 a[228:231], v3 offset:8800
  ds_read_b128 a[232:235], v3 offset:13600
  buffer_load_dwordx4 a[48:51], v203, s[64:67], s42 offen
  ds_read_b128 a[236:239], v3 offset:4400
  ds_read_b128 v[208:211], v3 offset:9200
  ds_read_b128 v[212:215], v3 offset:14000
  v_and_b32 v125, v164, v136
  v_and_b32 v126, v165, v136
  v_and_b32 v127, v166, v136
  v_and_b32 v140, v167, v136
  v_accvgpr_write_b32 a212, v125
  v_accvgpr_write_b32 a213, v126
  v_accvgpr_write_b32 a214, v127
  buffer_load_dwordx4 a[52:55], v203, s[64:67], s42 offen offset:128
  s_add_u32 s42, s42, 0x1800
  v_accvgpr_write_b32 a215, v140
  s_waitcnt vmcnt(19)
  v_mfma_f32_32x32x16_bf16 v[16:31], a[72:75], v[184:187], 0
  buffer_load_dwordx4 a[56:59], v203, s[64:67], s42 offen
  s_waitcnt vmcnt(19)
  v_mfma_f32_32x32x16_bf16 v[16:31], a[76:79], v[188:191], v[16:31]
  s_waitcnt vmcnt(18)
  v_mfma_f32_32x32x16_bf16 v[32:47], a[80:83], v[184:187], 0
  buffer_load_dwordx4 a[60:63], v203, s[64:67], s42 offen offset:128
  s_add_u32 s42, s42, 0x1800
  s_waitcnt vmcnt(15)
  v_mfma_f32_32x32x16_bf16 v[48:63], a[0:3], v[240:243], v[16:31]
  buffer_load_dwordx4 a[64:67], v203, s[64:67], s42 offen
  v_mfma_f32_32x32x16_bf16 v[32:47], a[84:87], v[188:191], v[32:47]
  s_waitcnt vmcnt(15)
  v_mfma_f32_32x32x16_bf16 v[48:63], a[4:7], v[244:247], v[48:63]
  buffer_load_dwordx4 a[68:71], v203, s[64:67], s42 offen offset:128
  s_waitcnt vmcnt(15)
  v_mfma_f32_32x32x16_bf16 v[216:231], a[8:11], v[240:243], v[16:31]
  s_add_u32 m0, s15, 0x8200
  s_nop 0
  buffer_load_dwordx4 v6, s[4:7], s49 offen lds
  s_waitcnt vmcnt(15)
  v_mfma_f32_32x32x16_bf16 v[216:231], a[12:15], v[244:247], v[216:231]
  buffer_load_dwordx4 v7, s[4:7], s49 offen offset:1024 lds
  s_nop 2
  v_cvt_pk_bf16_f32 v64, v48, v52
  v_cvt_pk_bf16_f32 v65, v56, v60
  v_cvt_pk_bf16_f32 v68, v49, v53
  v_cvt_pk_bf16_f32 v69, v57, v61
  s_waitcnt vmcnt(15)
  v_mfma_f32_32x32x16_bf16 v[96:111], a[16:19], v[240:243], v[16:31]
  buffer_load_dwordx4 v8, s[4:7], s49 offen offset:2048 lds
  v_cvt_pk_bf16_f32 v72, v50, v54
  v_cvt_pk_bf16_f32 v73, v58, v62
  v_cvt_pk_bf16_f32 v76, v51, v55
  v_cvt_pk_bf16_f32 v77, v59, v63
  s_waitcnt vmcnt(15)
  v_mfma_f32_32x32x16_bf16 v[96:111], a[20:23], v[244:247], v[96:111]
  buffer_load_dwordx4 v9, s[4:7], s49 offen offset:3072 lds
  v_cvt_pk_bf16_f32 v66, v216, v220
  v_cvt_pk_bf16_f32 v67, v224, v228
  v_cvt_pk_bf16_f32 v70, v217, v221
  v_cvt_pk_bf16_f32 v71, v225, v229
  ds_write_b128 v195, v[64:67]
  s_waitcnt vmcnt(15)
  v_mfma_f32_32x32x16_bf16 v[48:63], a[24:27], v[240:243], v[32:47]
  s_add_u32 m0, s15, 0
  s_nop 0
  buffer_load_dwordx4 v198, s[4:7], 0 offen lds
  ds_write_b128 v195, v[68:71] offset:6144
  v_cvt_pk_bf16_f32 v74, v218, v222
  v_cvt_pk_bf16_f32 v75, v226, v230
  v_cvt_pk_bf16_f32 v78, v219, v223
  v_cvt_pk_bf16_f32 v79, v227, v231
  s_waitcnt vmcnt(15)
  v_mfma_f32_32x32x16_bf16 v[48:63], a[28:31], v[244:247], v[48:63]
  s_add_u32 m0, s15, 0x400
  s_nop 0
  buffer_load_dwordx4 v199, s[4:7], 0 offen lds
  ds_write_b128 v195, v[72:75] offset:12288
  v_cvt_pk_bf16_f32 v80, v96, v100
  v_cvt_pk_bf16_f32 v81, v104, v108
  v_cvt_pk_bf16_f32 v84, v97, v101
  v_cvt_pk_bf16_f32 v85, v105, v109
  s_waitcnt vmcnt(15)
  v_mfma_f32_32x32x16_bf16 v[216:231], a[32:35], v[240:243], v[32:47]
  s_add_u32 m0, s15, 0x800
  s_nop 0
  buffer_load_dwordx4 v200, s[4:7], 0 offen lds
  ds_write_b128 v195, v[76:79] offset:18432
  v_cvt_pk_bf16_f32 v88, v98, v102
  v_cvt_pk_bf16_f32 v89, v106, v110
  v_cvt_pk_bf16_f32 v92, v99, v103
  v_cvt_pk_bf16_f32 v93, v107, v111
  s_waitcnt vmcnt(15)
  v_mfma_f32_32x32x16_bf16 v[216:231], a[36:39], v[244:247], v[216:231]
  s_add_u32 m0, s15, 0xc00
  s_nop 0
  buffer_load_dwordx4 v201, s[4:7], 0 offen lds
  ds_write_b64 v196, v[80:81]
  ds_write_b64 v196, v[84:85] offset:6144
  v_cvt_pk_bf16_f32 v64, v48, v52
  v_cvt_pk_bf16_f32 v65, v56, v60
  v_cvt_pk_bf16_f32 v68, v49, v53
  v_cvt_pk_bf16_f32 v69, v57, v61
  s_waitcnt vmcnt(15)
  v_mfma_f32_32x32x16_bf16 v[96:111], a[40:43], v[240:243], v[32:47]
  s_add_u32 m0, s14, 0x22000
  s_nop 0
  buffer_load_dwordx4 v254, s[72:75], s57 offen lds
  ds_write_b64 v196, v[88:89] offset:12288
  ds_write_b64 v196, v[92:93] offset:18432
  v_cvt_pk_bf16_f32 v72, v50, v54
  v_cvt_pk_bf16_f32 v73, v58, v62
  v_cvt_pk_bf16_f32 v76, v51, v55
  v_cvt_pk_bf16_f32 v77, v59, v63
  s_waitcnt vmcnt(15)
  v_mfma_f32_32x32x16_bf16 v[96:111], a[44:47], v[244:247], v[96:111]
  buffer_load_dwordx4 v255, s[72:75], s57 offen offset:1024 lds
  v_cvt_pk_bf16_f32 v66, v216, v220
  v_cvt_pk_bf16_f32 v67, v224, v228
  v_cvt_pk_bf16_f32 v70, v217, v221
  v_cvt_pk_bf16_f32 v71, v225, v229
  ds_write_b128 v197, v[64:67]
  s_waitcnt vmcnt(15)
  v_mfma_f32_32x32x16_bf16 v[48:63], a[48:51], v[240:243], v[32:47]
  buffer_load_dwordx4 v194, s[72:75], s57 offen offset:2048 lds
  ds_write_b128 v197, v[68:71] offset:6144
  v_cvt_pk_bf16_f32 v74, v218, v222
  v_cvt_pk_bf16_f32 v75, v226, v230
  v_cvt_pk_bf16_f32 v78, v219, v223
  v_cvt_pk_bf16_f32 v79, v227, v231
  s_waitcnt vmcnt(15)
  v_mfma_f32_32x32x16_bf16 v[48:63], a[52:55], v[244:247], v[48:63]
  s_add_u32 m0, s14, 0x22c00
  s_nop 0
  buffer_load_dwordx4 v254, s[72:75], s58 offen lds
  ds_write_b128 v197, v[72:75] offset:12288
  v_cvt_pk_bf16_f32 v80, v96, v100
  v_cvt_pk_bf16_f32 v81, v104, v108
  v_cvt_pk_bf16_f32 v84, v97, v101
  v_cvt_pk_bf16_f32 v85, v105, v109
  s_nop 0
  s_waitcnt vmcnt(15)
  v_mfma_f32_32x32x16_bf16 v[216:231], a[56:59], v[240:243], v[32:47]
  buffer_load_dwordx4 v255, s[72:75], s58 offen offset:1024 lds
  ds_write_b128 v197, v[76:79] offset:18432
  v_cvt_pk_bf16_f32 v88, v98, v102
  v_cvt_pk_bf16_f32 v89, v106, v110
  v_cvt_pk_bf16_f32 v92, v99, v103
  v_cvt_pk_bf16_f32 v93, v107, v111
  v_mfma_f32_32x32x16_bf16 v[96:111], a[88:91], v[240:243], v[32:47]
  s_nop 0
  s_waitcnt vmcnt(15)
  v_mfma_f32_32x32x16_bf16 v[216:231], a[60:63], v[244:247], v[216:231]
  buffer_load_dwordx4 v194, s[72:75], s58 offen offset:2048 lds
  v_cvt_pk_bf16_f32 v82, v48, v52
  v_cvt_pk_bf16_f32 v83, v56, v60
  v_cvt_pk_bf16_f32 v86, v49, v53
  v_cvt_pk_bf16_f32 v87, v57, v61
  ds_write_b128 v197, v[80:83] offset:1024
  v_mfma_f32_32x32x16_bf16 v[96:111], a[92:95], v[244:247], v[96:111]
  s_waitcnt vmcnt(15)
  v_mfma_f32_32x32x16_bf16 v[96:111], a[64:67], v[240:243], v[96:111]
  ds_write_b128 v197, v[84:87] offset:7168
  v_cvt_pk_bf16_f32 v90, v50, v54
  v_cvt_pk_bf16_f32 v91, v58, v62
  v_cvt_pk_bf16_f32 v94, v51, v55
  v_cvt_pk_bf16_f32 v95, v59, v63
  s_waitcnt vmcnt(14)
  v_mfma_f32_32x32x16_bf16 v[96:111], a[68:71], v[244:247], v[96:111]
  ds_write_b128 v197, v[88:91] offset:13312
  v_cvt_pk_bf16_f32 v64, v216, v220
  v_cvt_pk_bf16_f32 v65, v224, v228
  v_cvt_pk_bf16_f32 v68, v217, v221
  v_cvt_pk_bf16_f32 v69, v225, v229
  ds_write_b128 v197, v[92:95] offset:19456
  v_cvt_pk_bf16_f32 v72, v218, v222
  v_cvt_pk_bf16_f32 v73, v226, v230
  v_cvt_pk_bf16_f32 v76, v219, v223
  v_cvt_pk_bf16_f32 v77, v227, v231
  s_nop 0
  s_nop 1
  v_cvt_pk_bf16_f32 v66, v96, v100
  v_cvt_pk_bf16_f32 v67, v104, v108
  v_cvt_pk_bf16_f32 v70, v97, v101
  v_cvt_pk_bf16_f32 v71, v105, v109
  ds_write_b128 v197, v[64:67] offset:2048
  ds_write_b128 v197, v[68:71] offset:8192
  v_cvt_pk_bf16_f32 v74, v98, v102
  v_cvt_pk_bf16_f32 v75, v106, v110
  v_cvt_pk_bf16_f32 v78, v99, v103
  v_cvt_pk_bf16_f32 v79, v107, v111
  ds_write_b128 v197, v[72:75] offset:14336
  ds_write_b128 v197, v[76:79] offset:20480
  s_waitcnt lgkmcnt(0)
  s_barrier
  ds_read_b128 a[0:3], v0 offset:24576
  ds_read_b128 a[4:7], v0 offset:25600
  ds_read_b128 a[8:11], v0 offset:26624
  ds_read_b128 a[12:15], v0 offset:27648
  ds_read_b128 a[16:19], v0 offset:28672
  ds_read_b128 a[20:23], v0 offset:29696
  ds_read_b128 a[24:27], v0 offset:30720
  ds_read_b128 a[28:31], v0 offset:31744
  ds_read_b128 a[32:35], v0 offset:32768
  ds_read_b128 a[36:39], v0 offset:33792
  ds_read_b128 a[40:43], v0 offset:34816
  ds_read_b128 a[44:47], v0 offset:35840
  ds_read_b128 a[48:51], v0 offset:36864
  ds_read_b128 a[52:55], v0 offset:37888
  ds_read_b128 a[56:59], v0 offset:38912
  ds_read_b128 a[60:63], v0 offset:39936
  ds_read_b128 a[64:67], v0 offset:40960
  ds_read_b128 a[68:71], v0 offset:41984
  ds_read_b128 a[72:75], v0 offset:43008
  ds_read_b128 a[76:79], v0 offset:44032
  ds_read_b128 a[80:83], v0 offset:45056
  ds_read_b128 a[84:87], v0 offset:46080
  ds_read_b128 a[88:91], v0 offset:47104
  ds_read_b128 a[92:95], v0 offset:48128
  s_nop 0
  s_waitcnt vmcnt(6)
  ds_read_b128 v[216:219], v4
  ds_read_b128 v[220:223], v4 offset:16
  ds_read_b128 v[224:227], v4 offset:192
  ds_read_b128 v[228:231], v4 offset:208
  ds_read_b128 v[232:235], v4 offset:384
  ds_read_b128 v[236:239], v4 offset:400
  ds_read_b128 v[160:163], v4 offset:32
  ds_read_b128 v[164:167], v4 offset:48
  ds_read_b128 v[168:171], v4 offset:224
  ds_read_b128 v[172:175], v4 offset:240
  ds_read_b128 v[176:179], v4 offset:416
  s_waitcnt lgkmcnt(10)
  v_mfma_f32_16x16x32_bf16 v[112:115], a[96:99], v[216:219], 0
  s_waitcnt lgkmcnt(9)
  ds_read_b128 v[180:183], v4 offset:432
  v_mfma_f32_16x16x32_bf16 v[116:119], a[108:111], v[220:223], 0
  s_waitcnt lgkmcnt(9)
  ds_read_b128 v[216:219], v4 offset:64
  v_mfma_f32_16x16x32_bf16 v[112:115], a[100:103], v[224:227], v[112:115]
  s_waitcnt lgkmcnt(9)
  ds_read_b128 v[220:223], v4 offset:80
  v_mfma_f32_16x16x32_bf16 v[116:119], a[112:115], v[228:231], v[116:119]
  s_waitcnt lgkmcnt(9)
  ds_read_b128 v[224:227], v4 offset:256
  v_mfma_f32_16x16x32_bf16 v[112:115], a[104:107], v[232:235], v[112:115]
  s_waitcnt lgkmcnt(9)
  ds_read_b128 v[228:231], v4 offset:272
  v_mfma_f32_16x16x32_bf16 v[116:119], a[116:119], v[236:239], v[116:119]
  s_waitcnt lgkmcnt(9)
  ds_read_b128 v[232:235], v4 offset:448
  v_mfma_f32_16x16x32_bf16 v[120:123], a[120:123], v[160:163], 0
  s_waitcnt lgkmcnt(9)
  ds_read_b128 v[236:239], v4 offset:464
  v_mfma_f32_16x16x32_bf16 v[124:127], a[132:135], v[164:167], 0
  s_waitcnt lgkmcnt(9)
  ds_read_b128 v[160:163], v4 offset:96
  v_mfma_f32_16x16x32_bf16 v[120:123], a[124:127], v[168:171], v[120:123]
  s_waitcnt lgkmcnt(9)
  ds_read_b128 v[164:167], v4 offset:112
  v_mfma_f32_16x16x32_bf16 v[124:127], a[136:139], v[172:175], v[124:127]
  s_waitcnt lgkmcnt(9)
  ds_read_b128 v[168:171], v4 offset:288
  v_mfma_f32_16x16x32_bf16 v[120:123], a[128:131], v[176:179], v[120:123]
  s_waitcnt lgkmcnt(9)
  ds_read_b128 v[172:175], v4 offset:304
  v_mfma_f32_16x16x32_bf16 v[124:127], a[140:143], v[180:183], v[124:127]
  s_waitcnt lgkmcnt(9)
  ds_read_b128 v[176:179], v4 offset:480
  v_mfma_f32_16x16x32_bf16 v[128:131], a[144:147], v[216:219], 0
  s_waitcnt lgkmcnt(9)
  ds_read_b128 v[180:183], v4 offset:496
  v_mfma_f32_16x16x32_bf16 v[132:135], a[156:159], v[220:223], 0
  s_waitcnt lgkmcnt(9)
  ds_read_b128 v[216:219], v4 offset:128
  v_mfma_f32_16x16x32_bf16 v[128:131], a[148:151], v[224:227], v[128:131]
  s_waitcnt lgkmcnt(9)
  ds_read_b128 v[220:223], v4 offset:144
  v_mfma_f32_16x16x32_bf16 v[132:135], a[160:163], v[228:231], v[132:135]
  s_waitcnt lgkmcnt(9)
  ds_read_b128 v[224:227], v4 offset:320
  v_mfma_f32_16x16x32_bf16 v[128:131], a[152:155], v[232:235], v[128:131]
  s_waitcnt lgkmcnt(9)
  ds_read_b128 v[228:231], v4 offset:336
  v_mfma_f32_16x16x32_bf16 v[132:135], a[164:167], v[236:239], v[132:135]
  s_waitcnt lgkmcnt(9)
  ds_read_b128 v[232:235], v4 offset:512
  v_mfma_f32_16x16x32_bf16 v[136:139], a[240:243], v[160:163], 0
  s_waitcnt lgkmcnt(9)
  ds_read_b128 v[236:239], v4 offset:528
  v_mfma_f32_16x16x32_bf16 v[140:143], a[168:171], v[164:167], 0
  s_waitcnt lgkmcnt(9)
  ds_read_b128 v[160:163], v4 offset:160
  v_mfma_f32_16x16x32_bf16 v[136:139], a[244:247], v[168:171], v[136:139]
  s_waitcnt lgkmcnt(9)
  ds_read_b128 v[164:167], v4 offset:176
  v_mfma_f32_16x16x32_bf16 v[140:143], a[172:175], v[172:175], v[140:143]
  s_waitcnt lgkmcnt(9)
  ds_read_b128 v[168:171], v4 offset:352
  v_mfma_f32_16x16x32_bf16 v[136:139], a[248:251], v[176:179], v[136:139]
  s_waitcnt lgkmcnt(9)
  ds_read_b128 v[172:175], v4 offset:368
  v_mfma_f32_16x16x32_bf16 v[140:143], a[176:179], v[180:183], v[140:143]
  s_waitcnt lgkmcnt(9)
  ds_read_b128 v[176:179], v4 offset:544
  v_mfma_f32_16x16x32_bf16 v[144:147], a[252:255], v[216:219], 0
  s_waitcnt lgkmcnt(9)
  ds_read_b128 v[180:183], v4 offset:560
  v_mfma_f32_16x16x32_bf16 v[148:151], a[188:191], v[220:223], 0
  s_waitcnt lgkmcnt(9)
  v_mfma_f32_16x16x32_bf16 v[144:147], a[180:183], v[224:227], v[144:147]
  s_waitcnt lgkmcnt(8)
  v_mfma_f32_16x16x32_bf16 v[148:151], a[216:219], v[228:231], v[148:151]
  s_waitcnt lgkmcnt(7)
  v_mfma_f32_16x16x32_bf16 v[144:147], a[184:187], v[232:235], v[144:147]
  s_waitcnt lgkmcnt(6)
  v_mfma_f32_16x16x32_bf16 v[148:151], a[220:223], v[236:239], v[148:151]
  s_waitcnt lgkmcnt(5)
  v_mfma_f32_16x16x32_bf16 v[152:155], a[224:227], v[160:163], 0
  s_waitcnt lgkmcnt(4)
  v_mfma_f32_16x16x32_bf16 v[156:159], a[236:239], v[164:167], 0
  s_waitcnt lgkmcnt(3)
  v_mfma_f32_16x16x32_bf16 v[152:155], a[228:231], v[168:171], v[152:155]
  s_waitcnt lgkmcnt(2)
  v_mfma_f32_16x16x32_bf16 v[156:159], v[208:211], v[172:175], v[156:159]
  s_waitcnt lgkmcnt(1)
  v_mfma_f32_16x16x32_bf16 v[152:155], a[232:235], v[176:179], v[152:155]
  s_waitcnt lgkmcnt(0)
  v_mfma_f32_16x16x32_bf16 v[156:159], v[212:215], v[180:183], v[156:159]
  buffer_load_dword v249, v248, s[4:7], s29 offen
  v_pk_add_f32 v[12:13], v[112:113], v[114:115]
  v_pk_mul_f32 v[14:15], v[112:113], v[112:113]
  v_pk_fma_f32 v[14:15], v[114:115], v[114:115], v[14:15]
  v_pk_add_f32 v[12:13], v[12:13], v[116:117]
  v_pk_fma_f32 v[14:15], v[116:117], v[116:117], v[14:15]
  v_pk_add_f32 v[12:13], v[12:13], v[118:119]
  v_pk_fma_f32 v[14:15], v[118:119], v[118:119], v[14:15]
  v_pk_add_f32 v[12:13], v[12:13], v[120:121]
  v_pk_fma_f32 v[14:15], v[120:121], v[120:121], v[14:15]
  v_pk_add_f32 v[12:13], v[12:13], v[122:123]
  v_pk_fma_f32 v[14:15], v[122:123], v[122:123], v[14:15]
  v_pk_add_f32 v[12:13], v[12:13], v[124:125]
  ds_read_b128 v[216:219], v0 offset:18432
  ds_read_b128 v[220:223], v0 offset:19456
  ds_read_b128 v[224:227], v0 offset:20480
  ds_read_b128 v[228:231], v0 offset:21504
  v_pk_fma_f32 v[14:15], v[124:125], v[124:125], v[14:15]
  v_pk_add_f32 v[12:13], v[12:13], v[126:127]
  v_pk_fma_f32 v[14:15], v[126:127], v[126:127], v[14:15]
  v_pk_add_f32 v[12:13], v[12:13], v[128:129]
  v_pk_fma_f32 v[14:15], v[128:129], v[128:129], v[14:15]
  v_pk_add_f32 v[12:13], v[12:13], v[130:131]
  v_pk_fma_f32 v[14:15], v[130:131], v[130:131], v[14:15]
  v_pk_add_f32 v[12:13], v[12:13], v[132:133]
  v_pk_fma_f32 v[14:15], v[132:133], v[132:133], v[14:15]
  v_pk_add_f32 v[12:13], v[12:13], v[134:135]
  v_pk_fma_f32 v[14:15], v[134:135], v[134:135], v[14:15]
  v_pk_add_f32 v[12:13], v[12:13], v[136:137]
  ds_read_b128 v[232:235], v0 offset:22528
  ds_read_b128 v[236:239], v0 offset:23552
  ds_read_b128 a[96:99], v0 offset:49152
  ds_read_b128 a[100:103], v0 offset:50176
  v_pk_fma_f32 v[14:15], v[136:137], v[136:137], v[14:15]
  v_pk_add_f32 v[12:13], v[12:13], v[138:139]
  v_pk_fma_f32 v[14:15], v[138:139], v[138:139], v[14:15]
  v_pk_add_f32 v[12:13], v[12:13], v[140:141]
  v_pk_fma_f32 v[14:15], v[140:141], v[140:141], v[14:15]
  v_pk_add_f32 v[12:13], v[12:13], v[142:143]
  v_pk_fma_f32 v[14:15], v[142:143], v[142:143], v[14:15]
  v_pk_add_f32 v[12:13], v[12:13], v[144:145]
  v_pk_fma_f32 v[14:15], v[144:145], v[144:145], v[14:15]
  v_pk_add_f32 v[12:13], v[12:13], v[146:147]
  v_pk_fma_f32 v[14:15], v[146:147], v[146:147], v[14:15]
  v_pk_add_f32 v[12:13], v[12:13], v[148:149]
  ds_read_b128 a[104:107], v0 offset:51200
  ds_read_b128 a[108:111], v0 offset:52224
  ds_read_b128 a[112:115], v0 offset:53248
  ds_read_b128 a[116:119], v0 offset:54272
  v_pk_fma_f32 v[14:15], v[148:149], v[148:149], v[14:15]
  v_pk_add_f32 v[12:13], v[12:13], v[150:151]
  v_pk_fma_f32 v[14:15], v[150:151], v[150:151], v[14:15]
  v_pk_add_f32 v[12:13], v[12:13], v[152:153]
  v_pk_fma_f32 v[14:15], v[152:153], v[152:153], v[14:15]
  v_pk_add_f32 v[12:13], v[12:13], v[154:155]
  v_pk_fma_f32 v[14:15], v[154:155], v[154:155], v[14:15]
  v_pk_add_f32 v[12:13], v[12:13], v[156:157]
  v_pk_fma_f32 v[14:15], v[156:157], v[156:157], v[14:15]
  v_pk_add_f32 v[12:13], v[12:13], v[158:159]
  v_pk_fma_f32 v[14:15], v[158:159], v[158:159], v[14:15]
  v_add_f32_e64 v12, v12, v13
  ds_read_b128 a[120:123], v0 offset:55296
  ds_read_b128 a[124:127], v0 offset:56320
  ds_read_b128 a[128:131], v0 offset:57344
  ds_read_b128 a[132:135], v0 offset:58368
  v_add_f32 v14, v14, v15
  s_nop 1
  v_permlane32_swap_b32 v12, v14
  v_add_f32 v12, v12, v14
  v_mov_b32 v14, v12
  s_nop 1
  v_permlane32_swap_b32 v12, v14
  v_mul_f32 v12, s24, v12
  v_mul_f32_e64 v13, s24, v14
  v_fma_f32 v13, -v12, v12, v13
  v_max_f32 v13, 0, v13
  v_add_f32 v13, s25, v13
  v_rsq_f32 v13, v13
  s_nop 0
  v_mul_f32_e64 v14, s22, v13
  ds_read_b128 a[136:139], v0 offset:59392
  ds_read_b128 a[140:143], v0 offset:60416
  ds_read_b128 a[144:147], v0 offset:61440
  ds_read_b128 a[148:151], v0 offset:62464
  v_mul_f32_e64 v12, -v12, v14
  v_pk_fma_f32 v[112:113], v[112:113], v[14:15], v[12:13] op_sel_hi:[1,0,0]
  v_pk_fma_f32 v[114:115], v[114:115], v[14:15], v[12:13] op_sel_hi:[1,0,0]
  v_pk_fma_f32 v[116:117], v[116:117], v[14:15], v[12:13] op_sel_hi:[1,0,0]
  v_pk_fma_f32 v[118:119], v[118:119], v[14:15], v[12:13] op_sel_hi:[1,0,0]
  v_pk_fma_f32 v[120:121], v[120:121], v[14:15], v[12:13] op_sel_hi:[1,0,0]
  v_pk_fma_f32 v[122:123], v[122:123], v[14:15], v[12:13] op_sel_hi:[1,0,0]
  v_pk_fma_f32 v[124:125], v[124:125], v[14:15], v[12:13] op_sel_hi:[1,0,0]
  v_pk_fma_f32 v[126:127], v[126:127], v[14:15], v[12:13] op_sel_hi:[1,0,0]
  v_pk_fma_f32 v[128:129], v[128:129], v[14:15], v[12:13] op_sel_hi:[1,0,0]
  v_pk_fma_f32 v[130:131], v[130:131], v[14:15], v[12:13] op_sel_hi:[1,0,0]
  v_pk_fma_f32 v[132:133], v[132:133], v[14:15], v[12:13] op_sel_hi:[1,0,0]
  ds_read_b128 a[152:155], v0 offset:63488
  ds_read_b128 a[156:159], v0 offset:64512
  ds_read_b128 a[160:163], v1
  ds_read_b128 a[164:167], v1 offset:1024
  v_pk_fma_f32 v[134:135], v[134:135], v[14:15], v[12:13] op_sel_hi:[1,0,0]
  v_pk_fma_f32 v[136:137], v[136:137], v[14:15], v[12:13] op_sel_hi:[1,0,0]
  v_pk_fma_f32 v[138:139], v[138:139], v[14:15], v[12:13] op_sel_hi:[1,0,0]
  v_pk_fma_f32 v[140:141], v[140:141], v[14:15], v[12:13] op_sel_hi:[1,0,0]
  v_pk_fma_f32 v[142:143], v[142:143], v[14:15], v[12:13] op_sel_hi:[1,0,0]
  v_pk_fma_f32 v[144:145], v[144:145], v[14:15], v[12:13] op_sel_hi:[1,0,0]
  v_pk_fma_f32 v[146:147], v[146:147], v[14:15], v[12:13] op_sel_hi:[1,0,0]
  v_pk_fma_f32 v[148:149], v[148:149], v[14:15], v[12:13] op_sel_hi:[1,0,0]
  v_pk_fma_f32 v[150:151], v[150:151], v[14:15], v[12:13] op_sel_hi:[1,0,0]
  v_pk_fma_f32 v[152:153], v[152:153], v[14:15], v[12:13] op_sel_hi:[1,0,0]
  v_pk_fma_f32 v[154:155], v[154:155], v[14:15], v[12:13] op_sel_hi:[1,0,0]
  v_pk_fma_f32 v[156:157], v[156:157], v[14:15], v[12:13] op_sel_hi:[1,0,0]
  ds_read_b128 a[168:171], v1 offset:2048
  ds_read_b128 a[172:175], v1 offset:3072
  ds_read_b128 a[176:179], v1 offset:4096
  ds_read_b128 a[180:183], v1 offset:5120
  v_pk_fma_f32 v[158:159], v[158:159], v[14:15], v[12:13] op_sel_hi:[1,0,0]
  v_cndmask_b32 v159, v159, v250, s[12:13]
  v_cvt_pk_bf16_f32 v160, v112, v113
  v_cvt_pk_bf16_f32 v161, v114, v115
  v_cvt_pk_bf16_f32 v162, v116, v117
  v_cvt_pk_bf16_f32 v163, v118, v119
  v_cvt_pk_bf16_f32 v164, v120, v121
  v_cvt_pk_bf16_f32 v165, v122, v123
  v_cvt_pk_bf16_f32 v166, v124, v125
  v_cvt_pk_bf16_f32 v167, v126, v127
  v_cvt_pk_bf16_f32 v168, v128, v129
  v_cvt_pk_bf16_f32 v169, v130, v131
  ds_read_b128 a[184:187], v1 offset:6144
  ds_read_b128 a[188:191], v1 offset:7168
  v_cvt_pk_bf16_f32 v170, v132, v133
  v_cvt_pk_bf16_f32 v171, v134, v135
  v_cvt_pk_bf16_f32 v172, v136, v137
  v_cvt_pk_bf16_f32 v173, v138, v139
  v_cvt_pk_bf16_f32 v174, v140, v141
  v_cvt_pk_bf16_f32 v175, v142, v143
  v_cvt_pk_bf16_f32 v176, v144, v145
  v_cvt_pk_bf16_f32 v177, v146, v147
  v_cvt_pk_bf16_f32 v178, v148, v149
  v_cvt_pk_bf16_f32 v179, v150, v151
  v_cvt_pk_bf16_f32 v180, v152, v153
  v_cvt_pk_bf16_f32 v181, v154, v155
  v_cvt_pk_bf16_f32 v182, v156, v157
  v_cvt_pk_bf16_f32 v183, v158, v159
  s_nop 0
  s_waitcnt lgkmcnt(15)
  v_mfma_f32_32x32x16_bf16 v[16:31], v[216:219], v[160:163], 0
  ds_read_b128 v[136:139], v5
  ds_read_b128 v[140:143], v5 offset:32
  ds_read_b128 v[144:147], v5 offset:64
  v_mfma_f32_32x32x16_bf16 v[16:31], v[220:223], v[164:167], v[16:31]
  ds_read_b128 v[148:151], v5 offset:96
  ds_read_b128 v[152:155], v5 offset:128
  ds_read_b128 v[156:159], v5 offset:160
  v_mfma_f32_32x32x16_bf16 v[16:31], v[224:227], v[168:171], v[16:31]
  s_nop 0
  s_waitcnt vmcnt(1)
  ds_read_b128 a[216:219], v251 offset:49152
  ds_read_b128 a[220:223], v252 offset:49152
  v_mfma_f32_32x32x16_bf16 v[16:31], v[228:231], v[172:175], v[16:31]
  ds_read_b128 a[224:227], v251 offset:49216
  ds_read_b128 a[228:231], v252 offset:49216
  ds_read_b128 a[232:235], v251 offset:49280
  v_mfma_f32_32x32x16_bf16 v[16:31], v[232:235], v[176:179], v[16:31]
  ds_read_b128 a[236:239], v252 offset:49280
  v_mfma_f32_32x32x16_bf16 v[16:31], v[236:239], v[180:183], v[16:31]
  s_nop 0
  s_nop 11
  v_pk_fma_f32 v[48:49], v[16:17], v[16:17], s[20:21] neg_lo:[1,0,1] neg_hi:[1,0,1]
  v_pk_fma_f32 v[50:51], v[18:19], v[18:19], s[20:21] neg_lo:[1,0,1] neg_hi:[1,0,1]
  v_pk_fma_f32 v[52:53], v[20:21], v[20:21], s[20:21] neg_lo:[1,0,1] neg_hi:[1,0,1]
  v_pk_fma_f32 v[54:55], v[22:23], v[22:23], s[20:21] neg_lo:[1,0,1] neg_hi:[1,0,1]
  v_pk_fma_f32 v[56:57], v[24:25], v[24:25], s[20:21] neg_lo:[1,0,1] neg_hi:[1,0,1]
  v_pk_fma_f32 v[58:59], v[26:27], v[26:27], s[20:21] neg_lo:[1,0,1] neg_hi:[1,0,1]
  v_pk_fma_f32 v[60:61], v[28:29], v[28:29], s[20:21] neg_lo:[1,0,1] neg_hi:[1,0,1]
  v_pk_fma_f32 v[62:63], v[30:31], v[30:31], s[20:21] neg_lo:[1,0,1] neg_hi:[1,0,1]
  v_pk_mul_f32 v[48:49], v[16:17], v[48:49]
  v_pk_mul_f32 v[50:51], v[18:19], v[50:51]
  v_pk_mul_f32 v[52:53], v[20:21], v[52:53]
  v_pk_mul_f32 v[54:55], v[22:23], v[54:55]
  v_pk_mul_f32 v[56:57], v[24:25], v[56:57]
  v_pk_mul_f32 v[58:59], v[26:27], v[58:59]
  v_pk_mul_f32 v[60:61], v[28:29], v[60:61]
  v_pk_mul_f32 v[62:63], v[30:31], v[62:63]
  s_waitcnt lgkmcnt(5)
  v_mfma_f32_32x32x16_bf16 v[64:79], a[216:219], a[192:195], 0
  s_mov_b32 m0, s30
  v_exp_f32 v48, v48
  v_exp_f32 v49, v49
  v_exp_f32 v50, v50
  v_exp_f32 v51, v51
  v_exp_f32 v52, v52
  s_waitcnt lgkmcnt(4)
  v_mfma_f32_32x32x16_bf16 v[64:79], a[220:223], a[196:199], v[64:79]
  buffer_load_dwordx4 v6, s[4:7], s29 offen lds
  v_exp_f32 v53, v53
  s_waitcnt lgkmcnt(3)
  v_mfma_f32_32x32x16_bf16 v[80:95], a[224:227], a[200:203], 0
  buffer_load_dwordx4 v7, s[4:7], s29 offen offset:1024 lds
  s_waitcnt lgkmcnt(2)
  v_mfma_f32_32x32x16_bf16 v[80:95], a[228:231], a[204:207], v[80:95]
  buffer_load_dwordx4 v8, s[4:7], s29 offen offset:2048 lds
  s_nop 3
  v_cvt_pk_bf16_f32 v64, v64, v65
  v_cvt_pk_bf16_f32 v65, v66, v67
  v_cvt_pk_bf16_f32 v66, v68, v69
  v_cvt_pk_bf16_f32 v67, v70, v71
  ds_write_b128 v253, v[64:67] offset:49152
  v_exp_f32 v54, v54
  v_exp_f32 v55, v55
  v_cvt_pk_bf16_f32 v68, v72, v73
  v_cvt_pk_bf16_f32 v69, v74, v75
  v_cvt_pk_bf16_f32 v70, v76, v77
  s_waitcnt lgkmcnt(2)
  v_mfma_f32_32x32x16_bf16 v[96:111], a[232:235], a[208:211], 0
  buffer_load_dwordx4 v9, s[4:7], s29 offen offset:3072 lds
  v_cvt_pk_bf16_f32 v71, v78, v79
  v_exp_f32 v56, v56
  v_exp_f32 v57, v57
  ds_write_b128 v253, v[68:71] offset:52224
  s_waitcnt lgkmcnt(2)
  v_mfma_f32_32x32x16_bf16 v[96:111], a[236:239], a[212:215], v[96:111]
  v_cvt_pk_bf16_f32 v80, v80, v81
  v_cvt_pk_bf16_f32 v81, v82, v83
  v_cvt_pk_bf16_f32 v82, v84, v85
  v_cvt_pk_bf16_f32 v83, v86, v87
  v_exp_f32 v58, v58
  v_exp_f32 v59, v59
  ds_write_b128 v253, v[80:83] offset:50176
  v_cvt_pk_bf16_f32 v84, v88, v89
  v_cvt_pk_bf16_f32 v85, v90, v91
  v_cvt_pk_bf16_f32 v86, v92, v93
  v_cvt_pk_bf16_f32 v87, v94, v95
  v_exp_f32 v60, v60
  v_exp_f32 v61, v61
  ds_write_b128 v253, v[84:87] offset:53248
  v_cvt_pk_bf16_f32 v96, v96, v97
  v_cvt_pk_bf16_f32 v97, v98, v99
  v_cvt_pk_bf16_f32 v98, v100, v101
  v_cvt_pk_bf16_f32 v99, v102, v103
  v_exp_f32 v62, v62
  v_exp_f32 v63, v63
  v_cvt_pk_bf16_f32 v100, v104, v105
  v_cvt_pk_bf16_f32 v101, v106, v107
  v_cvt_pk_bf16_f32 v102, v108, v109
  v_cvt_pk_bf16_f32 v103, v110, v111
  ds_write_b128 v253, v[96:99] offset:51200
  v_pk_fma_f32 v[48:49], v[48:49], s[22:23], s[22:23]
  v_pk_fma_f32 v[50:51], v[50:51], s[22:23], s[22:23]
  v_pk_fma_f32 v[52:53], v[52:53], s[22:23], s[22:23]
  v_pk_fma_f32 v[54:55], v[54:55], s[22:23], s[22:23]
  v_pk_fma_f32 v[56:57], v[56:57], s[22:23], s[22:23]
  v_pk_fma_f32 v[58:59], v[58:59], s[22:23], s[22:23]
  v_pk_fma_f32 v[60:61], v[60:61], s[22:23], s[22:23]
  v_pk_fma_f32 v[62:63], v[62:63], s[22:23], s[22:23]
  ds_write_b128 v253, v[100:103] offset:54272
  s_waitcnt lgkmcnt(0)
  s_barrier
  v_mfma_f32_32x32x16_bf16 v[32:47], a[0:3], v[160:163], 0
  ds_read_b128 v[64:67], v2
  ds_read_b128 v[68:71], v2 offset:32
  ds_read_b128 v[72:75], v2 offset:64
  s_add_u32 m0, s14, 0x16000
  v_rcp_f32_e64 v48, v48
  v_mfma_f32_32x32x16_bf16 v[32:47], a[4:7], v[164:167], v[32:47]
  ds_read_b128 v[76:79], v2 offset:96
  ds_read_b128 v[80:83], v2 offset:128
  ds_read_b128 v[84:87], v2 offset:160
  buffer_load_dwordx4 v254, s[72:75], s53 offen lds
  v_rcp_f32_e64 v49, v49
  v_mfma_f32_32x32x16_bf16 v[32:47], a[8:11], v[168:171], v[32:47]
  ds_read_b128 v[88:91], v2 offset:192
  ds_read_b128 v[92:95], v2 offset:224
  ds_read_b128 v[96:99], v2 offset:256
  buffer_load_dwordx4 v255, s[72:75], s53 offen offset:1024 lds
  v_rcp_f32_e64 v50, v50
  v_mfma_f32_32x32x16_bf16 v[32:47], a[12:15], v[172:175], v[32:47]
  ds_read_b128 v[100:103], v2 offset:288
  ds_read_b128 v[104:107], v2 offset:320
  ds_read_b128 v[108:111], v2 offset:352
  v_rcp_f32_e64 v51, v51
  v_mfma_f32_32x32x16_bf16 v[32:47], a[16:19], v[176:179], v[32:47]
  buffer_load_dwordx4 v194, s[72:75], s53 offen offset:2048 lds
  s_add_u32 m0, s14, 0x16c00
  v_rcp_f32 v52, v52
  v_rcp_f32 v53, v53
  v_mfma_f32_32x32x16_bf16 v[32:47], a[20:23], v[180:183], v[32:47]
  s_waitcnt lgkmcnt(0)
  buffer_load_dwordx4 v254, s[72:75], s54 offen lds
  v_rcp_f32 v54, v54
  v_rcp_f32_e64 v55, v55
  v_mfma_f32_32x32x16_bf16 v[64:79], v[240:243], v[136:139], v[64:79]
  v_mov_b32 v112, v194
  v_rcp_f32 v56, v56
  v_rcp_f32_e64 v57, v57
  v_mfma_f32_32x32x16_bf16 v[64:79], v[244:247], v[140:143], v[64:79]
  buffer_load_dwordx4 v255, s[72:75], s54 offen offset:1024 lds
  v_rcp_f32 v58, v58
  v_rcp_f32 v59, v59
  v_mfma_f32_32x32x16_bf16 v[80:95], v[240:243], v[144:147], v[80:95]
  buffer_load_dwordx4 v194, s[72:75], s54 offen offset:2048 lds
  v_rcp_f32 v60, v60
  v_rcp_f32 v61, v61
  v_mfma_f32_32x32x16_bf16 v[80:95], v[244:247], v[148:151], v[80:95]
  ds_read_b128 v[192:195], v1 offset:8192
  ds_read_b128 v[196:199], v1 offset:9216
  v_rcp_f32 v62, v62
  v_rcp_f32 v63, v63
  v_mfma_f32_32x32x16_bf16 v[96:111], v[240:243], v[152:155], v[96:111]
  ds_read_b128 v[200:203], v1 offset:10240
  ds_read_b128 v[204:207], v1 offset:11264
  v_mfma_f32_32x32x16_bf16 v[96:111], v[244:247], v[156:159], v[96:111]
  s_nop 0
  s_waitcnt lgkmcnt(0)
  ds_read_b128 v[208:211], v1 offset:12288
  ds_read_b128 v[212:215], v1 offset:13312
  v_pk_mul_f32 v[16:17], v[16:17], v[48:49]
  v_pk_mul_f32 v[18:19], v[18:19], v[50:51]
  v_pk_mul_f32 v[20:21], v[20:21], v[52:53]
  v_pk_mul_f32 v[22:23], v[22:23], v[54:55]
  v_pk_mul_f32 v[24:25], v[24:25], v[56:57]
  v_pk_mul_f32 v[26:27], v[26:27], v[58:59]
  v_pk_mul_f32 v[28:29], v[28:29], v[60:61]
  v_pk_mul_f32 v[30:31], v[30:31], v[62:63]
  v_pk_fma_f32 v[48:49], v[32:33], v[32:33], s[20:21] neg_lo:[1,0,1] neg_hi:[1,0,1]
  v_pk_fma_f32 v[50:51], v[34:35], v[34:35], s[20:21] neg_lo:[1,0,1] neg_hi:[1,0,1]
  v_pk_fma_f32 v[52:53], v[36:37], v[36:37], s[20:21] neg_lo:[1,0,1] neg_hi:[1,0,1]
  v_pk_fma_f32 v[54:55], v[38:39], v[38:39], s[20:21] neg_lo:[1,0,1] neg_hi:[1,0,1]
  v_pk_fma_f32 v[56:57], v[40:41], v[40:41], s[20:21] neg_lo:[1,0,1] neg_hi:[1,0,1]
  v_pk_fma_f32 v[58:59], v[42:43], v[42:43], s[20:21] neg_lo:[1,0,1] neg_hi:[1,0,1]
  v_pk_fma_f32 v[60:61], v[44:45], v[44:45], s[20:21] neg_lo:[1,0,1] neg_hi:[1,0,1]
  v_pk_fma_f32 v[62:63], v[46:47], v[46:47], s[20:21] neg_lo:[1,0,1] neg_hi:[1,0,1]
  v_pk_mul_f32 v[48:49], v[32:33], v[48:49]
  v_pk_mul_f32 v[50:51], v[34:35], v[50:51]
  v_pk_mul_f32 v[52:53], v[36:37], v[52:53]
  v_pk_mul_f32 v[54:55], v[38:39], v[54:55]
  v_pk_mul_f32 v[56:57], v[40:41], v[56:57]
  v_cvt_pk_bf16_f32 v184, v16, v17
  v_cvt_pk_bf16_f32 v185, v18, v19
  v_cvt_pk_bf16_f32 v186, v20, v21
  v_cvt_pk_bf16_f32 v187, v22, v23
  v_pk_mul_f32 v[58:59], v[42:43], v[58:59]
  v_pk_mul_f32 v[60:61], v[44:45], v[60:61]
  v_pk_mul_f32 v[62:63], v[46:47], v[62:63]
  v_mfma_f32_32x32x16_bf16 v[64:79], v[192:195], v[184:187], v[64:79]
  s_mov_b32 m0, s31
  v_cvt_pk_bf16_f32 v188, v24, v25
  v_cvt_pk_bf16_f32 v189, v26, v27
  v_cvt_pk_bf16_f32 v190, v28, v29
  v_cvt_pk_bf16_f32 v191, v30, v31
  v_exp_f32 v48, v48
  v_mfma_f32_32x32x16_bf16 v[80:95], v[196:199], v[184:187], v[80:95]
  buffer_load_dwordx4 v6, s[4:7], s52 offen lds
  v_exp_f32 v49, v49
  v_exp_f32 v50, v50
  v_exp_f32_e64 v51, v51
  v_mfma_f32_32x32x16_bf16 v[96:111], v[200:203], v[184:187], v[96:111]
  buffer_load_dwordx4 v7, s[4:7], s52 offen offset:1024 lds
  v_exp_f32 v52, v52
  v_exp_f32 v53, v53
  v_mfma_f32_32x32x16_bf16 v[64:79], v[204:207], v[188:191], v[64:79]
  buffer_load_dwordx4 v8, s[4:7], s52 offen offset:2048 lds
  v_exp_f32 v54, v54
  v_exp_f32 v55, v55
  v_exp_f32 v56, v56
  s_waitcnt lgkmcnt(1)
  v_mfma_f32_32x32x16_bf16 v[80:95], v[208:211], v[188:191], v[80:95]
  buffer_load_dwordx4 v9, s[4:7], s52 offen offset:3072 lds
  v_exp_f32_e64 v57, v57
  v_exp_f32 v58, v58
  s_waitcnt lgkmcnt(0)
  v_mfma_f32_32x32x16_bf16 v[96:111], v[212:215], v[188:191], v[96:111]
  v_exp_f32 v59, v59
  v_exp_f32 v60, v60
  v_exp_f32 v61, v61
  v_exp_f32 v62, v62
  v_exp_f32_e64 v63, v63
  v_pk_fma_f32 v[48:49], v[48:49], s[22:23], s[22:23]
  v_pk_fma_f32 v[50:51], v[50:51], s[22:23], s[22:23]
  v_pk_fma_f32 v[52:53], v[52:53], s[22:23], s[22:23]
  v_pk_fma_f32 v[54:55], v[54:55], s[22:23], s[22:23]
  v_pk_fma_f32 v[56:57], v[56:57], s[22:23], s[22:23]
  v_pk_fma_f32 v[58:59], v[58:59], s[22:23], s[22:23]
  v_pk_fma_f32 v[60:61], v[60:61], s[22:23], s[22:23]
  v_pk_fma_f32 v[62:63], v[62:63], s[22:23], s[22:23]
  v_mfma_f32_32x32x16_bf16 v[16:31], a[24:27], v[160:163], 0
  ds_read_b128 v[192:195], v1 offset:14336
  ds_read_b128 v[196:199], v1 offset:15360
  s_add_u32 m0, s14, 0x1c000
  v_rcp_f32 v48, v48
  v_rcp_f32 v49, v49
  v_mfma_f32_32x32x16_bf16 v[16:31], a[28:31], v[164:167], v[16:31]
  ds_read_b128 v[200:203], v1 offset:16384
  ds_read_b128 v[204:207], v1 offset:17408
  buffer_load_dwordx4 v254, s[72:75], s55 offen lds
  v_rcp_f32 v50, v50
  v_rcp_f32 v51, v51
  v_mfma_f32_32x32x16_bf16 v[16:31], a[32:35], v[168:171], v[16:31]
  ds_read_b128 v[208:211], v1 offset:18432
  ds_read_b128 v[212:215], v1 offset:19456
  v_rcp_f32 v52, v52
  v_rcp_f32 v53, v53
  v_mfma_f32_32x32x16_bf16 v[16:31], a[36:39], v[172:175], v[16:31]
  buffer_load_dwordx4 v255, s[72:75], s55 offen offset:1024 lds
  v_rcp_f32 v54, v54
  v_rcp_f32 v55, v55
  v_rcp_f32_e64 v56, v56
  v_mfma_f32_32x32x16_bf16 v[16:31], a[40:43], v[176:179], v[16:31]
  v_rcp_f32 v57, v57
  v_rcp_f32 v58, v58
  v_rcp_f32 v59, v59
  v_mfma_f32_32x32x16_bf16 v[16:31], a[44:47], v[180:183], v[16:31]
  s_waitcnt lgkmcnt(0)
  buffer_load_dwordx4 v112, s[72:75], s55 offen offset:2048 lds
  v_rcp_f32 v60, v60
  v_rcp_f32 v61, v61
  v_rcp_f32 v62, v62
  v_rcp_f32 v63, v63
  v_pk_mul_f32 v[32:33], v[32:33], v[48:49]
  v_pk_mul_f32 v[34:35], v[34:35], v[50:51]
  v_pk_mul_f32 v[36:37], v[36:37], v[52:53]
  v_pk_mul_f32 v[38:39], v[38:39], v[54:55]
  v_pk_mul_f32 v[40:41], v[40:41], v[56:57]
  v_pk_mul_f32 v[42:43], v[42:43], v[58:59]
  v_pk_mul_f32 v[44:45], v[44:45], v[60:61]
  v_pk_mul_f32 v[46:47], v[46:47], v[62:63]
  v_pk_fma_f32 v[48:49], v[16:17], v[16:17], s[20:21] neg_lo:[1,0,1] neg_hi:[1,0,1]
  v_pk_fma_f32 v[50:51], v[18:19], v[18:19], s[20:21] neg_lo:[1,0,1] neg_hi:[1,0,1]
  v_pk_fma_f32 v[52:53], v[20:21], v[20:21], s[20:21] neg_lo:[1,0,1] neg_hi:[1,0,1]
  v_pk_fma_f32 v[54:55], v[22:23], v[22:23], s[20:21] neg_lo:[1,0,1] neg_hi:[1,0,1]
  v_pk_fma_f32 v[56:57], v[24:25], v[24:25], s[20:21] neg_lo:[1,0,1] neg_hi:[1,0,1]
  v_pk_fma_f32 v[58:59], v[26:27], v[26:27], s[20:21] neg_lo:[1,0,1] neg_hi:[1,0,1]
  v_pk_fma_f32 v[60:61], v[28:29], v[28:29], s[20:21] neg_lo:[1,0,1] neg_hi:[1,0,1]
  v_pk_fma_f32 v[62:63], v[30:31], v[30:31], s[20:21] neg_lo:[1,0,1] neg_hi:[1,0,1]
  v_pk_mul_f32 v[48:49], v[16:17], v[48:49]
  v_pk_mul_f32 v[50:51], v[18:19], v[50:51]
  v_pk_mul_f32 v[52:53], v[20:21], v[52:53]
  v_pk_mul_f32 v[54:55], v[22:23], v[54:55]
  v_pk_mul_f32 v[56:57], v[24:25], v[56:57]
  v_cvt_pk_bf16_f32 v184, v32, v33
  v_cvt_pk_bf16_f32 v185, v34, v35
  v_cvt_pk_bf16_f32 v186, v36, v37
  v_cvt_pk_bf16_f32 v187, v38, v39
  v_pk_mul_f32 v[58:59], v[26:27], v[58:59]
  v_pk_mul_f32 v[60:61], v[28:29], v[60:61]
  v_pk_mul_f32 v[62:63], v[30:31], v[62:63]
  v_mfma_f32_32x32x16_bf16 v[64:79], v[192:195], v[184:187], v[64:79]
  s_add_u32 m0, s14, 0x1cc00
  v_cvt_pk_bf16_f32 v188, v40, v41
  v_cvt_pk_bf16_f32 v189, v42, v43
  v_cvt_pk_bf16_f32 v190, v44, v45
  v_cvt_pk_bf16_f32 v191, v46, v47
  v_exp_f32_e64 v48, v48
  v_mfma_f32_32x32x16_bf16 v[80:95], v[196:199], v[184:187], v[80:95]
  buffer_load_dwordx4 v254, s[72:75], s56 offen lds
  v_exp_f32 v49, v49
  v_exp_f32 v50, v50
  v_exp_f32 v51, v51
  v_mfma_f32_32x32x16_bf16 v[96:111], v[200:203], v[184:187], v[96:111]
  s_waitcnt vmcnt(8)
  ds_read_b128 a[216:219], v251
  ds_read_b128 a[220:223], v252
  ds_read_b128 a[224:227], v251 offset:64
  v_exp_f32 v52, v52
  v_exp_f32 v53, v53
  v_mfma_f32_32x32x16_bf16 v[64:79], v[204:207], v[188:191], v[64:79]
  ds_read_b128 a[228:231], v252 offset:64
  ds_read_b128 a[232:235], v251 offset:128
  ds_read_b128 a[236:239], v252 offset:128
  buffer_load_dwordx4 v255, s[72:75], s56 offen offset:1024 lds
  v_subrev_u32 v11, 0x4100, v5
  v_exp_f32_e64 v54, v54
  v_mfma_f32_32x32x16_bf16 v[80:95], v[208:211], v[188:191], v[80:95]
  v_exp_f32 v55, v55
  v_exp_f32 v56, v56
  v_exp_f32_e64 v57, v57
  v_exp_f32 v58, v58
  v_mfma_f32_32x32x16_bf16 v[96:111], v[212:215], v[188:191], v[96:111]
  s_waitcnt lgkmcnt(0)
  buffer_load_dwordx4 v112, s[72:75], s56 offen offset:2048 lds
  v_add_u32 v5, 0x8200, v5
  v_exp_f32 v59, v59
  v_exp_f32 v60, v60
  v_exp_f32 v61, v61
  v_exp_f32 v62, v62
  v_exp_f32 v63, v63
  v_min_u32 v5, v11, v5
  v_pk_fma_f32 v[48:49], v[48:49], s[22:23], s[22:23]
  v_pk_fma_f32 v[50:51], v[50:51], s[22:23], s[22:23]
  v_pk_fma_f32 v[52:53], v[52:53], s[22:23], s[22:23]
  v_pk_fma_f32 v[54:55], v[54:55], s[22:23], s[22:23]
  v_pk_fma_f32 v[56:57], v[56:57], s[22:23], s[22:23]
  v_pk_fma_f32 v[58:59], v[58:59], s[22:23], s[22:23]
  v_pk_fma_f32 v[60:61], v[60:61], s[22:23], s[22:23]
  v_pk_fma_f32 v[62:63], v[62:63], s[22:23], s[22:23]
  v_mfma_f32_32x32x16_bf16 v[112:127], a[216:219], a[192:195], 0
  ds_read_b128 v[192:195], v1 offset:20480
  ds_read_b128 v[196:199], v1 offset:21504
  v_rcp_f32 v48, v48
  v_rcp_f32 v49, v49
  v_mfma_f32_32x32x16_bf16 v[112:127], a[220:223], a[196:199], v[112:127]
  ds_read_b128 v[200:203], v1 offset:22528
  ds_read_b128 v[204:207], v1 offset:23552
  v_rcp_f32 v50, v50
  v_rcp_f32 v51, v51
  v_mfma_f32_32x32x16_bf16 v[128:143], a[224:227], a[200:203], 0
  ds_read_b128 v[208:211], v1 offset:24576
  ds_read_b128 v[212:215], v1 offset:25600
  v_rcp_f32_e64 v52, v52
  v_rcp_f32 v53, v53
  v_mfma_f32_32x32x16_bf16 v[128:143], a[228:231], a[204:207], v[128:143]
  s_nop 1
  v_cvt_pk_bf16_f32 v112, v112, v113
  v_cvt_pk_bf16_f32 v113, v114, v115
  v_cvt_pk_bf16_f32 v114, v116, v117
  v_cvt_pk_bf16_f32 v115, v118, v119
  v_rcp_f32_e64 v54, v54
  v_mfma_f32_32x32x16_bf16 v[144:159], a[232:235], a[208:211], 0
  ds_write_b128 v253, v[112:115]
  v_cvt_pk_bf16_f32 v116, v120, v121
  v_cvt_pk_bf16_f32 v117, v122, v123
  v_cvt_pk_bf16_f32 v118, v124, v125
  v_cvt_pk_bf16_f32 v119, v126, v127
  v_mfma_f32_32x32x16_bf16 v[144:159], a[236:239], a[212:215], v[144:159]
  ds_write_b128 v253, v[116:119] offset:3072
  v_cvt_pk_bf16_f32 v128, v128, v129
  v_cvt_pk_bf16_f32 v129, v130, v131
  v_cvt_pk_bf16_f32 v130, v132, v133
  v_cvt_pk_bf16_f32 v131, v134, v135
  v_mfma_f32_32x32x16_bf16 v[32:47], a[48:51], v[160:163], 0
  ds_write_b128 v253, v[128:131] offset:1024
  v_cvt_pk_bf16_f32 v132, v136, v137
  v_cvt_pk_bf16_f32 v133, v138, v139
  v_cvt_pk_bf16_f32 v134, v140, v141
  v_cvt_pk_bf16_f32 v135, v142, v143
  v_mfma_f32_32x32x16_bf16 v[32:47], a[52:55], v[164:167], v[32:47]
  ds_write_b128 v253, v[132:135] offset:4096
  v_cvt_pk_bf16_f32 v144, v144, v145
  v_cvt_pk_bf16_f32 v145, v146, v147
  v_cvt_pk_bf16_f32 v146, v148, v149
  v_cvt_pk_bf16_f32 v147, v150, v151
  v_mfma_f32_32x32x16_bf16 v[32:47], a[56:59], v[168:171], v[32:47]
  ds_write_b128 v253, v[144:147] offset:2048
  v_cvt_pk_bf16_f32 v148, v152, v153
  v_cvt_pk_bf16_f32 v149, v154, v155
  v_cvt_pk_bf16_f32 v150, v156, v157
  v_cvt_pk_bf16_f32 v151, v158, v159
  v_mfma_f32_32x32x16_bf16 v[32:47], a[60:63], v[172:175], v[32:47]
  ds_write_b128 v253, v[148:151] offset:5120
  v_rcp_f32 v55, v55
  v_rcp_f32 v56, v56
  v_mfma_f32_32x32x16_bf16 v[32:47], a[64:67], v[176:179], v[32:47]
  v_rcp_f32 v57, v57
  v_rcp_f32 v58, v58
  v_rcp_f32_e64 v59, v59
  v_mfma_f32_32x32x16_bf16 v[32:47], a[68:71], v[180:183], v[32:47]
  s_waitcnt lgkmcnt(6)
  v_rcp_f32 v60, v60
  v_rcp_f32 v61, v61
  v_rcp_f32 v62, v62
  v_rcp_f32_e64 v63, v63
  v_pk_mul_f32 v[16:17], v[16:17], v[48:49]
  v_pk_mul_f32 v[18:19], v[18:19], v[50:51]
  v_pk_mul_f32 v[20:21], v[20:21], v[52:53]
  v_pk_mul_f32 v[22:23], v[22:23], v[54:55]
  v_pk_mul_f32 v[24:25], v[24:25], v[56:57]
  v_pk_mul_f32 v[26:27], v[26:27], v[58:59]
  v_pk_mul_f32 v[28:29], v[28:29], v[60:61]
  v_pk_mul_f32 v[30:31], v[30:31], v[62:63]
  v_pk_fma_f32 v[48:49], v[32:33], v[32:33], s[20:21] neg_lo:[1,0,1] neg_hi:[1,0,1]
  v_pk_fma_f32 v[50:51], v[34:35], v[34:35], s[20:21] neg_lo:[1,0,1] neg_hi:[1,0,1]
  v_pk_fma_f32 v[52:53], v[36:37], v[36:37], s[20:21] neg_lo:[1,0,1] neg_hi:[1,0,1]
  v_pk_fma_f32 v[54:55], v[38:39], v[38:39], s[20:21] neg_lo:[1,0,1] neg_hi:[1,0,1]
  v_pk_fma_f32 v[56:57], v[40:41], v[40:41], s[20:21] neg_lo:[1,0,1] neg_hi:[1,0,1]
  v_pk_fma_f32 v[58:59], v[42:43], v[42:43], s[20:21] neg_lo:[1,0,1] neg_hi:[1,0,1]
  v_pk_fma_f32 v[60:61], v[44:45], v[44:45], s[20:21] neg_lo:[1,0,1] neg_hi:[1,0,1]
  v_pk_fma_f32 v[62:63], v[46:47], v[46:47], s[20:21] neg_lo:[1,0,1] neg_hi:[1,0,1]
  v_pk_mul_f32 v[48:49], v[32:33], v[48:49]
  v_pk_mul_f32 v[50:51], v[34:35], v[50:51]
  v_pk_mul_f32 v[52:53], v[36:37], v[52:53]
  v_pk_mul_f32 v[54:55], v[38:39], v[54:55]
  v_pk_mul_f32 v[56:57], v[40:41], v[56:57]
  v_cvt_pk_bf16_f32 v184, v16, v17
  v_cvt_pk_bf16_f32 v185, v18, v19
  v_cvt_pk_bf16_f32 v186, v20, v21
  v_cvt_pk_bf16_f32 v187, v22, v23
  v_pk_mul_f32 v[58:59], v[42:43], v[58:59]
  v_pk_mul_f32 v[60:61], v[44:45], v[60:61]
  v_pk_mul_f32 v[62:63], v[46:47], v[62:63]
  v_mfma_f32_32x32x16_bf16 v[64:79], v[192:195], v[184:187], v[64:79]
  s_add_u32 s29, s29, 0x60000
  v_cvt_pk_bf16_f32 v188, v24, v25
  v_cvt_pk_bf16_f32 v189, v26, v27
  v_cvt_pk_bf16_f32 v190, v28, v29
  v_cvt_pk_bf16_f32 v191, v30, v31
  v_exp_f32_e64 v48, v48
  v_mfma_f32_32x32x16_bf16 v[80:95], v[196:199], v[184:187], v[80:95]
  s_add_u32 s52, s52, 0x60000
  v_exp_f32 v49, v49
  v_exp_f32 v50, v50
  v_exp_f32_e64 v51, v51
  v_mfma_f32_32x32x16_bf16 v[96:111], v[200:203], v[184:187], v[96:111]
  s_mov_b32 s32, s30
  s_waitcnt vmcnt(0)
  ds_read_b128 a[216:219], v251 offset:24576
  ds_read_b128 a[220:223], v252 offset:24576
  ds_read_b128 a[224:227], v251 offset:24640
  v_exp_f32_e64 v52, v52
  v_exp_f32 v53, v53
  v_mfma_f32_32x32x16_bf16 v[64:79], v[204:207], v[188:191], v[64:79]
  s_add_u32 s30, s33, 32
  ds_read_b128 a[228:231], v252 offset:24640
  ds_read_b128 a[232:235], v251 offset:24704
  ds_read_b128 a[236:239], v252 offset:24704
  v_subrev_u32 v11, 0x4100, v4
  v_exp_f32_e64 v54, v54
  v_mfma_f32_32x32x16_bf16 v[80:95], v[208:211], v[188:191], v[80:95]
  s_sub_u32 s33, s31, 0
  v_exp_f32 v55, v55
  v_exp_f32 v56, v56
  v_exp_f32 v57, v57
  v_exp_f32 v58, v58
  v_mfma_f32_32x32x16_bf16 v[96:111], v[212:215], v[188:191], v[96:111]
  s_waitcnt lgkmcnt(0)
  v_add_u32 v4, 0x8200, v4
  v_exp_f32 v59, v59
  v_exp_f32 v60, v60
  v_exp_f32 v61, v61
  v_exp_f32 v62, v62
  v_exp_f32 v63, v63
  v_min_u32 v4, v11, v4
  v_pk_fma_f32 v[48:49], v[48:49], s[22:23], s[22:23]
  v_pk_fma_f32 v[50:51], v[50:51], s[22:23], s[22:23]
  v_pk_fma_f32 v[52:53], v[52:53], s[22:23], s[22:23]
  v_pk_fma_f32 v[54:55], v[54:55], s[22:23], s[22:23]
  v_pk_fma_f32 v[56:57], v[56:57], s[22:23], s[22:23]
  v_pk_fma_f32 v[58:59], v[58:59], s[22:23], s[22:23]
  v_pk_fma_f32 v[60:61], v[60:61], s[22:23], s[22:23]
  v_pk_fma_f32 v[62:63], v[62:63], s[22:23], s[22:23]
  v_mfma_f32_32x32x16_bf16 v[112:127], a[216:219], a[192:195], 0
  ds_read_b128 v[192:195], v1 offset:26624
  ds_read_b128 v[196:199], v1 offset:27648
  v_rcp_f32 v48, v48
  v_rcp_f32 v49, v49
  v_mfma_f32_32x32x16_bf16 v[112:127], a[220:223], a[196:199], v[112:127]
  ds_read_b128 v[200:203], v1 offset:28672
  ds_read_b128 v[204:207], v1 offset:29696
  v_rcp_f32 v50, v50
  v_rcp_f32 v51, v51
  v_mfma_f32_32x32x16_bf16 v[128:143], a[224:227], a[200:203], 0
  ds_read_b128 v[208:211], v1 offset:30720
  ds_read_b128 v[212:215], v1 offset:31744
  v_rcp_f32_e64 v52, v52
  v_rcp_f32 v53, v53
  v_mfma_f32_32x32x16_bf16 v[128:143], a[228:231], a[204:207], v[128:143]
  s_nop 1
  v_cvt_pk_bf16_f32 v112, v112, v113
  v_cvt_pk_bf16_f32 v113, v114, v115
  v_cvt_pk_bf16_f32 v114, v116, v117
  v_cvt_pk_bf16_f32 v115, v118, v119
  v_rcp_f32_e64 v54, v54
  v_mfma_f32_32x32x16_bf16 v[144:159], a[232:235], a[208:211], 0
  ds_write_b128 v253, v[112:115] offset:24576
  v_cvt_pk_bf16_f32 v116, v120, v121
  v_cvt_pk_bf16_f32 v117, v122, v123
  v_cvt_pk_bf16_f32 v118, v124, v125
  v_cvt_pk_bf16_f32 v119, v126, v127
  v_mfma_f32_32x32x16_bf16 v[144:159], a[236:239], a[212:215], v[144:159]
  ds_write_b128 v253, v[116:119] offset:27648
  v_cvt_pk_bf16_f32 v128, v128, v129
  v_cvt_pk_bf16_f32 v129, v130, v131
  v_cvt_pk_bf16_f32 v130, v132, v133
  v_cvt_pk_bf16_f32 v131, v134, v135
  v_mfma_f32_32x32x16_bf16 v[16:31], a[72:75], v[160:163], 0
  ds_write_b128 v253, v[128:131] offset:25600
  v_cvt_pk_bf16_f32 v132, v136, v137
  v_cvt_pk_bf16_f32 v133, v138, v139
  v_cvt_pk_bf16_f32 v134, v140, v141
  v_cvt_pk_bf16_f32 v135, v142, v143
  v_mfma_f32_32x32x16_bf16 v[16:31], a[76:79], v[164:167], v[16:31]
  ds_write_b128 v253, v[132:135] offset:28672
  v_cvt_pk_bf16_f32 v144, v144, v145
  v_cvt_pk_bf16_f32 v145, v146, v147
  v_cvt_pk_bf16_f32 v146, v148, v149
  v_cvt_pk_bf16_f32 v147, v150, v151
  v_mfma_f32_32x32x16_bf16 v[16:31], a[80:83], v[168:171], v[16:31]
  ds_write_b128 v253, v[144:147] offset:26624
  v_cvt_pk_bf16_f32 v148, v152, v153
  v_cvt_pk_bf16_f32 v149, v154, v155
  v_cvt_pk_bf16_f32 v150, v156, v157
  v_cvt_pk_bf16_f32 v151, v158, v159
  v_mfma_f32_32x32x16_bf16 v[16:31], a[84:87], v[172:175], v[16:31]
  ds_write_b128 v253, v[148:151] offset:29696
  buffer_load_dword v249, v248, s[4:7], s29 offen
  v_rcp_f32_e64 v55, v55
  v_mfma_f32_32x32x16_bf16 v[16:31], a[88:91], v[176:179], v[16:31]
  v_rcp_f32 v56, v56
  v_rcp_f32 v57, v57
  v_rcp_f32_e64 v58, v58
  v_mfma_f32_32x32x16_bf16 v[16:31], a[92:95], v[180:183], v[16:31]
  s_waitcnt lgkmcnt(6)
  v_rcp_f32 v59, v59
  v_rcp_f32 v60, v60
  v_rcp_f32 v61, v61
  v_rcp_f32 v62, v62
  v_rcp_f32 v63, v63
  v_pk_mul_f32 v[32:33], v[32:33], v[48:49]
  v_pk_mul_f32 v[34:35], v[34:35], v[50:51]
  v_pk_mul_f32 v[36:37], v[36:37], v[52:53]
  v_pk_mul_f32 v[38:39], v[38:39], v[54:55]
  v_pk_mul_f32 v[40:41], v[40:41], v[56:57]
  v_pk_mul_f32 v[42:43], v[42:43], v[58:59]
  v_pk_mul_f32 v[44:45], v[44:45], v[60:61]
  v_pk_mul_f32 v[46:47], v[46:47], v[62:63]
  v_pk_fma_f32 v[48:49], v[16:17], v[16:17], s[20:21] neg_lo:[1,0,1] neg_hi:[1,0,1]
  v_pk_fma_f32 v[50:51], v[18:19], v[18:19], s[20:21] neg_lo:[1,0,1] neg_hi:[1,0,1]
  v_pk_fma_f32 v[52:53], v[20:21], v[20:21], s[20:21] neg_lo:[1,0,1] neg_hi:[1,0,1]
  v_pk_fma_f32 v[54:55], v[22:23], v[22:23], s[20:21] neg_lo:[1,0,1] neg_hi:[1,0,1]
  v_pk_fma_f32 v[56:57], v[24:25], v[24:25], s[20:21] neg_lo:[1,0,1] neg_hi:[1,0,1]
  v_pk_fma_f32 v[58:59], v[26:27], v[26:27], s[20:21] neg_lo:[1,0,1] neg_hi:[1,0,1]
  v_pk_fma_f32 v[60:61], v[28:29], v[28:29], s[20:21] neg_lo:[1,0,1] neg_hi:[1,0,1]
  v_pk_fma_f32 v[62:63], v[30:31], v[30:31], s[20:21] neg_lo:[1,0,1] neg_hi:[1,0,1]
  v_pk_mul_f32 v[48:49], v[16:17], v[48:49]
  v_pk_mul_f32 v[50:51], v[18:19], v[50:51]
  v_pk_mul_f32 v[52:53], v[20:21], v[52:53]
  v_pk_mul_f32 v[54:55], v[22:23], v[54:55]
  v_pk_mul_f32 v[56:57], v[24:25], v[56:57]
  v_cvt_pk_bf16_f32 v184, v32, v33
  v_cvt_pk_bf16_f32 v185, v34, v35
  v_cvt_pk_bf16_f32 v186, v36, v37
  v_cvt_pk_bf16_f32 v187, v38, v39
  v_pk_mul_f32 v[58:59], v[26:27], v[58:59]
  v_pk_mul_f32 v[60:61], v[28:29], v[60:61]
  v_pk_mul_f32 v[62:63], v[30:31], v[62:63]
  v_mfma_f32_32x32x16_bf16 v[64:79], v[192:195], v[184:187], v[64:79]
  ds_read_b128 v[220:223], v4 offset:96
  v_cvt_pk_bf16_f32 v188, v40, v41
  v_cvt_pk_bf16_f32 v189, v42, v43
  v_cvt_pk_bf16_f32 v190, v44, v45
  v_cvt_pk_bf16_f32 v191, v46, v47
  v_mfma_f32_32x32x16_bf16 v[80:95], v[196:199], v[184:187], v[80:95]
  ds_read_b128 v[228:231], v4 offset:288
  v_exp_f32 v48, v48
  v_exp_f32 v49, v49
  v_exp_f32_e64 v50, v50
  v_mfma_f32_32x32x16_bf16 v[96:111], v[200:203], v[184:187], v[96:111]
  ds_read_b128 v[236:239], v4 offset:480
  v_exp_f32 v51, v51
  v_exp_f32 v52, v52
  v_mfma_f32_32x32x16_bf16 v[64:79], v[204:207], v[188:191], v[64:79]
  v_exp_f32 v53, v53
  v_exp_f32 v54, v54
  v_exp_f32_e64 v55, v55
  v_mfma_f32_32x32x16_bf16 v[80:95], v[208:211], v[188:191], v[80:95]
  v_exp_f32 v56, v56
  v_exp_f32 v57, v57
  v_exp_f32_e64 v58, v58
  v_mfma_f32_32x32x16_bf16 v[96:111], v[212:215], v[188:191], v[96:111]
  s_waitcnt lgkmcnt(0)
  v_exp_f32 v59, v59
  v_exp_f32 v60, v60
  v_exp_f32 v61, v61
  v_exp_f32 v62, v62
  v_exp_f32 v63, v63
  v_pk_fma_f32 v[48:49], v[48:49], s[22:23], s[22:23]
  v_pk_fma_f32 v[50:51], v[50:51], s[22:23], s[22:23]
  v_pk_fma_f32 v[52:53], v[52:53], s[22:23], s[22:23]
  v_pk_fma_f32 v[54:55], v[54:55], s[22:23], s[22:23]
  v_pk_fma_f32 v[56:57], v[56:57], s[22:23], s[22:23]
  v_pk_fma_f32 v[58:59], v[58:59], s[22:23], s[22:23]
  v_pk_fma_f32 v[60:61], v[60:61], s[22:23], s[22:23]
  v_pk_fma_f32 v[62:63], v[62:63], s[22:23], s[22:23]
  s_barrier
  v_mfma_f32_32x32x16_bf16 v[32:47], a[96:99], v[160:163], 0
  ds_read_b128 v[192:195], v0 offset:24576
  ds_read_b128 v[196:199], v0 offset:25600
  v_rcp_f32 v48, v48
  v_rcp_f32_e64 v49, v49
  v_mfma_f32_16x16x32_bf16 v[136:139], a[240:243], v[220:223], 0
  ds_read_b128 v[216:219], v3 offset:2800
  ds_read_b128 v[220:223], v4 offset:112
  v_mfma_f32_32x32x16_bf16 v[32:47], a[100:103], v[164:167], v[32:47]
  ds_read_b128 v[200:203], v0 offset:26624
  ds_read_b128 v[204:207], v0 offset:27648
  v_rcp_f32 v50, v50
  v_rcp_f32 v51, v51
  v_mfma_f32_16x16x32_bf16 v[136:139], a[244:247], v[228:231], v[136:139]
  ds_read_b128 v[224:227], v3 offset:7600
  ds_read_b128 v[228:231], v4 offset:304
  v_mfma_f32_32x32x16_bf16 v[32:47], a[104:107], v[168:171], v[32:47]
  ds_read_b128 v[208:211], v0 offset:28672
  ds_read_b128 v[212:215], v0 offset:29696
  v_rcp_f32 v52, v52
  v_rcp_f32 v53, v53
  v_mfma_f32_16x16x32_bf16 v[136:139], a[248:251], v[236:239], v[136:139]
  ds_read_b128 v[232:235], v3 offset:12400
  ds_read_b128 v[236:239], v4 offset:496
  v_mfma_f32_32x32x16_bf16 v[32:47], a[108:111], v[172:175], v[32:47]
  v_rcp_f32 v54, v54
  v_rcp_f32 v55, v55
  v_rcp_f32_e64 v56, v56
  v_mfma_f32_32x32x16_bf16 v[32:47], a[112:115], v[176:179], v[32:47]
  v_rcp_f32 v57, v57
  v_rcp_f32 v58, v58
  v_rcp_f32_e64 v59, v59
  v_mfma_f32_32x32x16_bf16 v[32:47], a[116:119], v[180:183], v[32:47]
  s_waitcnt lgkmcnt(0)
  v_rcp_f32 v60, v60
  v_rcp_f32 v61, v61
  v_rcp_f32 v62, v62
  v_rcp_f32_e64 v63, v63
  v_pk_mul_f32 v[16:17], v[16:17], v[48:49]
  v_pk_mul_f32 v[18:19], v[18:19], v[50:51]
  v_pk_mul_f32 v[20:21], v[20:21], v[52:53]
  v_pk_mul_f32 v[22:23], v[22:23], v[54:55]
  v_pk_mul_f32 v[24:25], v[24:25], v[56:57]
  v_pk_mul_f32 v[26:27], v[26:27], v[58:59]
  v_pk_mul_f32 v[28:29], v[28:29], v[60:61]
  v_pk_mul_f32 v[30:31], v[30:31], v[62:63]
  v_pk_add_f32 v[12:13], v[136:137], v[138:139]
  v_pk_mul_f32 v[14:15], v[136:137], v[136:137]
  v_pk_fma_f32 v[14:15], v[138:139], v[138:139], v[14:15]
  v_pk_fma_f32 v[48:49], v[32:33], v[32:33], s[20:21] neg_lo:[1,0,1] neg_hi:[1,0,1]
  v_pk_fma_f32 v[50:51], v[34:35], v[34:35], s[20:21] neg_lo:[1,0,1] neg_hi:[1,0,1]
  v_pk_fma_f32 v[52:53], v[36:37], v[36:37], s[20:21] neg_lo:[1,0,1] neg_hi:[1,0,1]
  v_pk_fma_f32 v[54:55], v[38:39], v[38:39], s[20:21] neg_lo:[1,0,1] neg_hi:[1,0,1]
  v_pk_fma_f32 v[56:57], v[40:41], v[40:41], s[20:21] neg_lo:[1,0,1] neg_hi:[1,0,1]
  v_pk_fma_f32 v[58:59], v[42:43], v[42:43], s[20:21] neg_lo:[1,0,1] neg_hi:[1,0,1]
  v_pk_fma_f32 v[60:61], v[44:45], v[44:45], s[20:21] neg_lo:[1,0,1] neg_hi:[1,0,1]
  v_pk_fma_f32 v[62:63], v[46:47], v[46:47], s[20:21] neg_lo:[1,0,1] neg_hi:[1,0,1]
  v_pk_mul_f32 v[48:49], v[32:33], v[48:49]
  v_pk_mul_f32 v[50:51], v[34:35], v[50:51]
  v_pk_mul_f32 v[52:53], v[36:37], v[52:53]
  v_pk_mul_f32 v[54:55], v[38:39], v[54:55]
  v_pk_mul_f32 v[56:57], v[40:41], v[56:57]
  v_pk_mul_f32 v[58:59], v[42:43], v[58:59]
  v_pk_mul_f32 v[60:61], v[44:45], v[60:61]
  v_pk_mul_f32 v[62:63], v[46:47], v[62:63]
  v_mfma_f32_16x16x32_bf16 v[140:143], v[216:219], v[220:223], 0
  v_cvt_pk_bf16_f32 v184, v16, v17
  v_cvt_pk_bf16_f32 v185, v18, v19
  v_mfma_f32_16x16x32_bf16 v[140:143], v[224:227], v[228:231], v[140:143]
  v_cvt_pk_bf16_f32 v186, v20, v21
  v_cvt_pk_bf16_f32 v187, v22, v23
  v_mfma_f32_16x16x32_bf16 v[140:143], v[232:235], v[236:239], v[140:143]
  ds_read_b128 v[220:223], v4 offset:128
  v_mfma_f32_32x32x16_bf16 v[64:79], v[192:195], v[184:187], v[64:79]
  ds_read_b128 v[224:227], v3 offset:8000
  ds_read_b128 v[228:231], v4 offset:320
  v_cvt_pk_bf16_f32 v188, v24, v25
  v_cvt_pk_bf16_f32 v189, v26, v27
  v_cvt_pk_bf16_f32 v190, v28, v29
  v_cvt_pk_bf16_f32 v191, v30, v31
  v_mfma_f32_32x32x16_bf16 v[80:95], v[196:199], v[184:187], v[80:95]
  ds_read_b128 v[232:235], v3 offset:12800
  ds_read_b128 v[236:239], v4 offset:512
  v_exp_f32 v48, v48
  v_exp_f32 v49, v49
  v_mfma_f32_32x32x16_bf16 v[96:111], v[200:203], v[184:187], v[96:111]
  s_sub_u32 s31, s32, 32
  v_exp_f32 v50, v50
  v_exp_f32 v51, v51
  v_exp_f32 v52, v52
  v_mfma_f32_32x32x16_bf16 v[64:79], v[204:207], v[188:191], v[64:79]
  v_exp_f32 v53, v53
  v_exp_f32 v54, v54
  v_exp_f32_e64 v55, v55
  v_mfma_f32_32x32x16_bf16 v[80:95], v[208:211], v[188:191], v[80:95]
  v_exp_f32 v56, v56
  v_exp_f32 v57, v57
  v_exp_f32_e64 v58, v58
  v_mfma_f32_32x32x16_bf16 v[96:111], v[212:215], v[188:191], v[96:111]
  s_waitcnt lgkmcnt(0)
  v_exp_f32 v59, v59
  v_exp_f32 v60, v60
  v_exp_f32 v61, v61
  v_exp_f32 v62, v62
  v_exp_f32 v63, v63
  v_pk_add_f32 v[12:13], v[12:13], v[140:141]
  v_pk_fma_f32 v[14:15], v[140:141], v[140:141], v[14:15]
  v_pk_add_f32 v[12:13], v[12:13], v[142:143]
  v_pk_fma_f32 v[14:15], v[142:143], v[142:143], v[14:15]
  v_pk_fma_f32 v[48:49], v[48:49], s[22:23], s[22:23]
  v_pk_fma_f32 v[50:51], v[50:51], s[22:23], s[22:23]
  v_pk_fma_f32 v[52:53], v[52:53], s[22:23], s[22:23]
  v_pk_fma_f32 v[54:55], v[54:55], s[22:23], s[22:23]
  v_pk_fma_f32 v[56:57], v[56:57], s[22:23], s[22:23]
  v_pk_fma_f32 v[58:59], v[58:59], s[22:23], s[22:23]
  v_pk_fma_f32 v[60:61], v[60:61], s[22:23], s[22:23]
  v_pk_fma_f32 v[62:63], v[62:63], s[22:23], s[22:23]
  v_mfma_f32_32x32x16_bf16 v[16:31], a[120:123], v[160:163], 0
  ds_read_b128 v[192:195], v0 offset:30720
  ds_read_b128 v[196:199], v0 offset:31744
  v_rcp_f32 v48, v48
  v_rcp_f32 v49, v49
  v_mfma_f32_16x16x32_bf16 v[144:147], a[252:255], v[220:223], 0
  ds_read_b128 v[216:219], v3 offset:3600
  ds_read_b128 v[220:223], v4 offset:144
  v_mfma_f32_32x32x16_bf16 v[16:31], a[124:127], v[164:167], v[16:31]
  ds_read_b128 v[200:203], v0 offset:32768
  ds_read_b128 v[204:207], v0 offset:33792
  v_rcp_f32 v50, v50
  v_rcp_f32 v51, v51
  v_mfma_f32_16x16x32_bf16 v[144:147], v[224:227], v[228:231], v[144:147]
  ds_read_b128 v[224:227], v3 offset:8400
  ds_read_b128 v[228:231], v4 offset:336
  v_mfma_f32_32x32x16_bf16 v[16:31], a[128:131], v[168:171], v[16:31]
  ds_read_b128 v[208:211], v0 offset:34816
  ds_read_b128 v[212:215], v0 offset:35840
  v_rcp_f32 v52, v52
  v_rcp_f32 v53, v53
  v_mfma_f32_16x16x32_bf16 v[144:147], v[232:235], v[236:239], v[144:147]
  ds_read_b128 v[232:235], v3 offset:13200
  ds_read_b128 v[236:239], v4 offset:528
  v_mfma_f32_32x32x16_bf16 v[16:31], a[132:135], v[172:175], v[16:31]
  v_rcp_f32 v54, v54
  v_rcp_f32 v55, v55
  v_rcp_f32_e64 v56, v56
  v_mfma_f32_32x32x16_bf16 v[16:31], a[136:139], v[176:179], v[16:31]
  ds_read_b128 a[192:195], v0
  ds_read_b128 a[196:199], v0 offset:1024
  ds_read_b128 a[200:203], v0 offset:2048
  v_rcp_f32 v57, v57
  v_rcp_f32 v58, v58
  v_mfma_f32_32x32x16_bf16 v[16:31], a[140:143], v[180:183], v[16:31]
  s_waitcnt lgkmcnt(3)
  v_rcp_f32 v59, v59
  v_rcp_f32 v60, v60
  v_rcp_f32 v61, v61
  v_rcp_f32 v62, v62
  v_rcp_f32 v63, v63
  v_pk_mul_f32 v[32:33], v[32:33], v[48:49]
  v_pk_mul_f32 v[34:35], v[34:35], v[50:51]
  v_pk_mul_f32 v[36:37], v[36:37], v[52:53]
  v_pk_mul_f32 v[38:39], v[38:39], v[54:55]
  v_pk_mul_f32 v[40:41], v[40:41], v[56:57]
  v_pk_mul_f32 v[42:43], v[42:43], v[58:59]
  v_pk_mul_f32 v[44:45], v[44:45], v[60:61]
  v_pk_mul_f32 v[46:47], v[46:47], v[62:63]
  v_pk_add_f32 v[12:13], v[12:13], v[144:145]
  v_pk_fma_f32 v[14:15], v[144:145], v[144:145], v[14:15]
  v_pk_add_f32 v[12:13], v[12:13], v[146:147]
  v_pk_fma_f32 v[14:15], v[146:147], v[146:147], v[14:15]
  v_pk_fma_f32 v[48:49], v[16:17], v[16:17], s[20:21] neg_lo:[1,0,1] neg_hi:[1,0,1]
  v_pk_fma_f32 v[50:51], v[18:19], v[18:19], s[20:21] neg_lo:[1,0,1] neg_hi:[1,0,1]
  v_pk_fma_f32 v[52:53], v[20:21], v[20:21], s[20:21] neg_lo:[1,0,1] neg_hi:[1,0,1]
  v_pk_fma_f32 v[54:55], v[22:23], v[22:23], s[20:21] neg_lo:[1,0,1] neg_hi:[1,0,1]
  v_pk_fma_f32 v[56:57], v[24:25], v[24:25], s[20:21] neg_lo:[1,0,1] neg_hi:[1,0,1]
  v_pk_fma_f32 v[58:59], v[26:27], v[26:27], s[20:21] neg_lo:[1,0,1] neg_hi:[1,0,1]
  v_pk_fma_f32 v[60:61], v[28:29], v[28:29], s[20:21] neg_lo:[1,0,1] neg_hi:[1,0,1]
  v_pk_fma_f32 v[62:63], v[30:31], v[30:31], s[20:21] neg_lo:[1,0,1] neg_hi:[1,0,1]
  v_pk_mul_f32 v[48:49], v[16:17], v[48:49]
  v_pk_mul_f32 v[50:51], v[18:19], v[50:51]
  v_pk_mul_f32 v[52:53], v[20:21], v[52:53]
  v_pk_mul_f32 v[54:55], v[22:23], v[54:55]
  v_pk_mul_f32 v[56:57], v[24:25], v[56:57]
  v_pk_mul_f32 v[58:59], v[26:27], v[58:59]
  v_pk_mul_f32 v[60:61], v[28:29], v[60:61]
  v_pk_mul_f32 v[62:63], v[30:31], v[62:63]
  v_mfma_f32_16x16x32_bf16 v[148:151], v[216:219], v[220:223], 0
  v_cvt_pk_bf16_f32 v184, v32, v33
  v_cvt_pk_bf16_f32 v185, v34, v35
  v_mfma_f32_16x16x32_bf16 v[148:151], v[224:227], v[228:231], v[148:151]
  v_cvt_pk_bf16_f32 v186, v36, v37
  v_cvt_pk_bf16_f32 v187, v38, v39
  v_mfma_f32_16x16x32_bf16 v[148:151], v[232:235], v[236:239], v[148:151]
  ds_read_b128 v[216:219], v3 offset:4000
  ds_read_b128 v[220:223], v4 offset:160
  v_mfma_f32_32x32x16_bf16 v[64:79], v[192:195], v[184:187], v[64:79]
  ds_read_b128 v[224:227], v3 offset:8800
  ds_read_b128 v[228:231], v4 offset:352
  v_cvt_pk_bf16_f32 v188, v40, v41
  v_cvt_pk_bf16_f32 v189, v42, v43
  v_cvt_pk_bf16_f32 v190, v44, v45
  v_cvt_pk_bf16_f32 v191, v46, v47
  v_mfma_f32_32x32x16_bf16 v[80:95], v[196:199], v[184:187], v[80:95]
  ds_read_b128 v[232:235], v3 offset:13600
  ds_read_b128 v[236:239], v4 offset:544
  v_exp_f32 v48, v48
  v_exp_f32 v49, v49
  v_mfma_f32_32x32x16_bf16 v[96:111], v[200:203], v[184:187], v[96:111]
  v_exp_f32 v50, v50
  v_exp_f32 v51, v51
  v_exp_f32_e64 v52, v52
  v_mfma_f32_32x32x16_bf16 v[64:79], v[204:207], v[188:191], v[64:79]
  v_exp_f32 v53, v53
  v_exp_f32 v54, v54
  v_exp_f32_e64 v55, v55
  v_mfma_f32_32x32x16_bf16 v[80:95], v[208:211], v[188:191], v[80:95]
  ds_read_b128 a[204:207], v0 offset:3072
  ds_read_b128 a[208:211], v0 offset:4096
  ds_read_b128 a[212:215], v0 offset:5120
  v_exp_f32 v56, v56
  v_exp_f32 v57, v57
  v_mfma_f32_32x32x16_bf16 v[96:111], v[212:215], v[188:191], v[96:111]
  s_waitcnt lgkmcnt(3)
  v_exp_f32 v58, v58
  v_exp_f32 v59, v59
  v_exp_f32 v60, v60
  v_exp_f32 v61, v61
  v_exp_f32 v62, v62
  v_exp_f32_e64 v63, v63
  v_pk_add_f32 v[12:13], v[12:13], v[148:149]
  v_pk_fma_f32 v[14:15], v[148:149], v[148:149], v[14:15]
  v_pk_add_f32 v[12:13], v[12:13], v[150:151]
  v_pk_fma_f32 v[14:15], v[150:151], v[150:151], v[14:15]
  v_pk_fma_f32 v[48:49], v[48:49], s[22:23], s[22:23]
  v_pk_fma_f32 v[50:51], v[50:51], s[22:23], s[22:23]
  v_pk_fma_f32 v[52:53], v[52:53], s[22:23], s[22:23]
  v_pk_fma_f32 v[54:55], v[54:55], s[22:23], s[22:23]
  v_pk_fma_f32 v[56:57], v[56:57], s[22:23], s[22:23]
  v_pk_fma_f32 v[58:59], v[58:59], s[22:23], s[22:23]
  v_pk_fma_f32 v[60:61], v[60:61], s[22:23], s[22:23]
  v_pk_fma_f32 v[62:63], v[62:63], s[22:23], s[22:23]
  v_mfma_f32_32x32x16_bf16 v[32:47], a[144:147], v[160:163], 0
  ds_read_b128 v[192:195], v0 offset:36864
  ds_read_b128 v[196:199], v0 offset:37888
  v_rcp_f32 v48, v48
  v_rcp_f32 v49, v49
  v_mfma_f32_16x16x32_bf16 v[152:155], v[216:219], v[220:223], 0
  ds_read_b128 v[216:219], v3 offset:4400
  ds_read_b128 v[220:223], v4 offset:176
  v_mfma_f32_32x32x16_bf16 v[32:47], a[148:151], v[164:167], v[32:47]
  ds_read_b128 v[200:203], v0 offset:38912
  ds_read_b128 v[204:207], v0 offset:39936
  v_rcp_f32 v50, v50
  v_rcp_f32 v51, v51
  v_mfma_f32_16x16x32_bf16 v[152:155], v[224:227], v[228:231], v[152:155]
  ds_read_b128 v[224:227], v3 offset:9200
  ds_read_b128 v[228:231], v4 offset:368
  v_mfma_f32_32x32x16_bf16 v[32:47], a[152:155], v[168:171], v[32:47]
  ds_read_b128 v[208:211], v0 offset:40960
  ds_read_b128 v[212:215], v0 offset:41984
  v_rcp_f32 v52, v52
  v_rcp_f32 v53, v53
  v_mfma_f32_16x16x32_bf16 v[152:155], v[232:235], v[236:239], v[152:155]
  ds_read_b128 v[232:235], v3 offset:14000
  ds_read_b128 v[236:239], v4 offset:560
  v_mfma_f32_32x32x16_bf16 v[32:47], a[156:159], v[172:175], v[32:47]
  v_rcp_f32 v54, v54
  v_rcp_f32 v55, v55
  v_rcp_f32_e64 v56, v56
  v_mfma_f32_32x32x16_bf16 v[32:47], a[160:163], v[176:179], v[32:47]
  ds_read_b128 a[216:219], v0 offset:6144
  ds_read_b128 a[220:223], v0 offset:7168
  ds_read_b128 a[224:227], v0 offset:8192
  v_rcp_f32 v57, v57
  v_rcp_f32 v58, v58
  v_mfma_f32_32x32x16_bf16 v[32:47], a[164:167], v[180:183], v[32:47]
  s_waitcnt lgkmcnt(3)
  v_rcp_f32 v59, v59
  v_rcp_f32 v60, v60
  v_rcp_f32 v61, v61
  v_rcp_f32 v62, v62
  v_rcp_f32 v63, v63
  v_pk_mul_f32 v[16:17], v[16:17], v[48:49]
  v_pk_mul_f32 v[18:19], v[18:19], v[50:51]
  v_pk_mul_f32 v[20:21], v[20:21], v[52:53]
  v_pk_mul_f32 v[22:23], v[22:23], v[54:55]
  v_pk_mul_f32 v[24:25], v[24:25], v[56:57]
  v_pk_mul_f32 v[26:27], v[26:27], v[58:59]
  v_pk_mul_f32 v[28:29], v[28:29], v[60:61]
  v_pk_mul_f32 v[30:31], v[30:31], v[62:63]
  v_pk_add_f32 v[12:13], v[12:13], v[152:153]
  v_pk_fma_f32 v[14:15], v[152:153], v[152:153], v[14:15]
  v_pk_add_f32 v[12:13], v[12:13], v[154:155]
  v_pk_fma_f32 v[14:15], v[154:155], v[154:155], v[14:15]
  v_pk_fma_f32 v[48:49], v[32:33], v[32:33], s[20:21] neg_lo:[1,0,1] neg_hi:[1,0,1]
  v_pk_fma_f32 v[50:51], v[34:35], v[34:35], s[20:21] neg_lo:[1,0,1] neg_hi:[1,0,1]
  v_pk_fma_f32 v[52:53], v[36:37], v[36:37], s[20:21] neg_lo:[1,0,1] neg_hi:[1,0,1]
  v_pk_fma_f32 v[54:55], v[38:39], v[38:39], s[20:21] neg_lo:[1,0,1] neg_hi:[1,0,1]
  v_pk_fma_f32 v[56:57], v[40:41], v[40:41], s[20:21] neg_lo:[1,0,1] neg_hi:[1,0,1]
  v_pk_fma_f32 v[58:59], v[42:43], v[42:43], s[20:21] neg_lo:[1,0,1] neg_hi:[1,0,1]
  v_pk_fma_f32 v[60:61], v[44:45], v[44:45], s[20:21] neg_lo:[1,0,1] neg_hi:[1,0,1]
  v_pk_fma_f32 v[62:63], v[46:47], v[46:47], s[20:21] neg_lo:[1,0,1] neg_hi:[1,0,1]
  v_pk_mul_f32 v[48:49], v[32:33], v[48:49]
  v_pk_mul_f32 v[50:51], v[34:35], v[50:51]
  v_pk_mul_f32 v[52:53], v[36:37], v[52:53]
  v_pk_mul_f32 v[54:55], v[38:39], v[54:55]
  v_pk_mul_f32 v[56:57], v[40:41], v[56:57]
  v_pk_mul_f32 v[58:59], v[42:43], v[58:59]
  v_pk_mul_f32 v[60:61], v[44:45], v[60:61]
  v_pk_mul_f32 v[62:63], v[46:47], v[62:63]
  v_mfma_f32_16x16x32_bf16 v[156:159], v[216:219], v[220:223], 0
  v_cvt_pk_bf16_f32 v184, v16, v17
  v_cvt_pk_bf16_f32 v185, v18, v19
  v_mfma_f32_16x16x32_bf16 v[156:159], v[224:227], v[228:231], v[156:159]
  v_cvt_pk_bf16_f32 v186, v20, v21
  v_cvt_pk_bf16_f32 v187, v22, v23
  v_mfma_f32_16x16x32_bf16 v[156:159], v[232:235], v[236:239], v[156:159]
  ds_read_b128 v[216:219], v3
  ds_read_b128 v[220:223], v4
  v_mfma_f32_32x32x16_bf16 v[64:79], v[192:195], v[184:187], v[64:79]
  ds_read_b128 v[224:227], v3 offset:4800
  ds_read_b128 v[228:231], v4 offset:192
  v_cvt_pk_bf16_f32 v188, v24, v25
  v_cvt_pk_bf16_f32 v189, v26, v27
  v_cvt_pk_bf16_f32 v190, v28, v29
  v_cvt_pk_bf16_f32 v191, v30, v31
  v_mfma_f32_32x32x16_bf16 v[80:95], v[196:199], v[184:187], v[80:95]
  ds_read_b128 v[232:235], v3 offset:9600
  ds_read_b128 v[236:239], v4 offset:384
  v_exp_f32 v48, v48
  v_exp_f32 v49, v49
  v_mfma_f32_32x32x16_bf16 v[96:111], v[200:203], v[184:187], v[96:111]
  v_exp_f32 v50, v50
  v_exp_f32 v51, v51
  v_exp_f32_e64 v52, v52
  v_mfma_f32_32x32x16_bf16 v[64:79], v[204:207], v[188:191], v[64:79]
  v_exp_f32 v53, v53
  v_exp_f32 v54, v54
  v_exp_f32_e64 v55, v55
  v_mfma_f32_32x32x16_bf16 v[80:95], v[208:211], v[188:191], v[80:95]
  ds_read_b128 a[228:231], v0 offset:9216
  ds_read_b128 a[232:235], v0 offset:10240
  ds_read_b128 a[236:239], v0 offset:11264
  v_exp_f32 v56, v56
  v_exp_f32 v57, v57
  v_mfma_f32_32x32x16_bf16 v[96:111], v[212:215], v[188:191], v[96:111]
  s_waitcnt lgkmcnt(3)
  v_exp_f32 v58, v58
  v_exp_f32 v59, v59
  v_exp_f32 v60, v60
  v_exp_f32 v61, v61
  v_exp_f32 v62, v62
  v_exp_f32_e64 v63, v63
  v_pk_add_f32 v[12:13], v[12:13], v[156:157]
  v_pk_fma_f32 v[14:15], v[156:157], v[156:157], v[14:15]
  v_pk_add_f32 v[12:13], v[12:13], v[158:159]
  v_pk_fma_f32 v[14:15], v[158:159], v[158:159], v[14:15]
  v_pk_fma_f32 v[48:49], v[48:49], s[22:23], s[22:23]
  v_pk_fma_f32 v[50:51], v[50:51], s[22:23], s[22:23]
  v_pk_fma_f32 v[52:53], v[52:53], s[22:23], s[22:23]
  v_pk_fma_f32 v[54:55], v[54:55], s[22:23], s[22:23]
  v_pk_fma_f32 v[56:57], v[56:57], s[22:23], s[22:23]
  v_pk_fma_f32 v[58:59], v[58:59], s[22:23], s[22:23]
  v_pk_fma_f32 v[60:61], v[60:61], s[22:23], s[22:23]
  v_pk_fma_f32 v[62:63], v[62:63], s[22:23], s[22:23]
  v_mfma_f32_32x32x16_bf16 v[16:31], a[168:171], v[160:163], 0
  ds_read_b128 v[192:195], v0 offset:43008
  ds_read_b128 v[196:199], v0 offset:44032
  v_rcp_f32 v48, v48
  v_rcp_f32 v49, v49
  v_mfma_f32_16x16x32_bf16 v[112:115], v[216:219], v[220:223], 0
  ds_read_b128 v[216:219], v3 offset:400
  ds_read_b128 v[220:223], v4 offset:16
  v_mfma_f32_32x32x16_bf16 v[16:31], a[172:175], v[164:167], v[16:31]
  ds_read_b128 v[200:203], v0 offset:45056
  ds_read_b128 v[204:207], v0 offset:46080
  v_rcp_f32 v50, v50
  v_rcp_f32 v51, v51
  v_mfma_f32_16x16x32_bf16 v[112:115], v[224:227], v[228:231], v[112:115]
  ds_read_b128 v[224:227], v3 offset:5200
  ds_read_b128 v[228:231], v4 offset:208
  v_mfma_f32_32x32x16_bf16 v[16:31], a[176:179], v[168:171], v[16:31]
  ds_read_b128 v[208:211], v0 offset:47104
  ds_read_b128 v[212:215], v0 offset:48128
  v_rcp_f32 v52, v52
  v_rcp_f32 v53, v53
  v_mfma_f32_16x16x32_bf16 v[112:115], v[232:235], v[236:239], v[112:115]
  ds_read_b128 v[232:235], v3 offset:10000
  ds_read_b128 v[236:239], v4 offset:400
  v_mfma_f32_32x32x16_bf16 v[16:31], a[180:183], v[172:175], v[16:31]
  v_rcp_f32 v54, v54
  v_rcp_f32 v55, v55
  v_rcp_f32_e64 v56, v56
  v_mfma_f32_32x32x16_bf16 v[16:31], a[184:187], v[176:179], v[16:31]
  v_rcp_f32 v57, v57
  v_rcp_f32 v58, v58
  v_rcp_f32_e64 v59, v59
  v_mfma_f32_32x32x16_bf16 v[16:31], a[188:191], v[180:183], v[16:31]
  s_waitcnt lgkmcnt(0)
  v_rcp_f32 v60, v60
  v_rcp_f32 v61, v61
  v_rcp_f32 v62, v62
  v_rcp_f32_e64 v63, v63
  v_pk_mul_f32 v[32:33], v[32:33], v[48:49]
  v_pk_mul_f32 v[34:35], v[34:35], v[50:51]
  v_pk_mul_f32 v[36:37], v[36:37], v[52:53]
  v_pk_mul_f32 v[38:39], v[38:39], v[54:55]
  v_pk_mul_f32 v[40:41], v[40:41], v[56:57]
  v_pk_mul_f32 v[42:43], v[42:43], v[58:59]
  v_pk_mul_f32 v[44:45], v[44:45], v[60:61]
  v_pk_mul_f32 v[46:47], v[46:47], v[62:63]
  v_pk_add_f32 v[12:13], v[12:13], v[112:113]
  v_pk_fma_f32 v[14:15], v[112:113], v[112:113], v[14:15]
  v_pk_add_f32 v[12:13], v[12:13], v[114:115]
  v_pk_fma_f32 v[14:15], v[114:115], v[114:115], v[14:15]
  v_pk_fma_f32 v[48:49], v[16:17], v[16:17], s[20:21] neg_lo:[1,0,1] neg_hi:[1,0,1]
  v_pk_fma_f32 v[50:51], v[18:19], v[18:19], s[20:21] neg_lo:[1,0,1] neg_hi:[1,0,1]
  v_pk_fma_f32 v[52:53], v[20:21], v[20:21], s[20:21] neg_lo:[1,0,1] neg_hi:[1,0,1]
  v_pk_fma_f32 v[54:55], v[22:23], v[22:23], s[20:21] neg_lo:[1,0,1] neg_hi:[1,0,1]
  v_pk_fma_f32 v[56:57], v[24:25], v[24:25], s[20:21] neg_lo:[1,0,1] neg_hi:[1,0,1]
  v_pk_fma_f32 v[58:59], v[26:27], v[26:27], s[20:21] neg_lo:[1,0,1] neg_hi:[1,0,1]
  v_pk_fma_f32 v[60:61], v[28:29], v[28:29], s[20:21] neg_lo:[1,0,1] neg_hi:[1,0,1]
  v_pk_fma_f32 v[62:63], v[30:31], v[30:31], s[20:21] neg_lo:[1,0,1] neg_hi:[1,0,1]
  v_pk_mul_f32 v[48:49], v[16:17], v[48:49]
  v_pk_mul_f32 v[50:51], v[18:19], v[50:51]
  v_pk_mul_f32 v[52:53], v[20:21], v[52:53]
  v_pk_mul_f32 v[54:55], v[22:23], v[54:55]
  v_pk_mul_f32 v[56:57], v[24:25], v[56:57]
  v_pk_mul_f32 v[58:59], v[26:27], v[58:59]
  v_pk_mul_f32 v[60:61], v[28:29], v[60:61]
  v_pk_mul_f32 v[62:63], v[30:31], v[62:63]
  v_mfma_f32_16x16x32_bf16 v[116:119], v[216:219], v[220:223], 0
  v_cvt_pk_bf16_f32 v184, v32, v33
  v_cvt_pk_bf16_f32 v185, v34, v35
  v_mfma_f32_16x16x32_bf16 v[116:119], v[224:227], v[228:231], v[116:119]
  v_cvt_pk_bf16_f32 v186, v36, v37
  v_cvt_pk_bf16_f32 v187, v38, v39
  v_mfma_f32_16x16x32_bf16 v[116:119], v[232:235], v[236:239], v[116:119]
  ds_read_b128 v[216:219], v3 offset:800
  ds_read_b128 v[220:223], v4 offset:32
  v_mfma_f32_32x32x16_bf16 v[64:79], v[192:195], v[184:187], v[64:79]
  ds_read_b128 v[224:227], v3 offset:5600
  ds_read_b128 v[228:231], v4 offset:224
  v_cvt_pk_bf16_f32 v188, v40, v41
  v_cvt_pk_bf16_f32 v189, v42, v43
  v_cvt_pk_bf16_f32 v190, v44, v45
  v_cvt_pk_bf16_f32 v191, v46, v47
  v_mfma_f32_32x32x16_bf16 v[80:95], v[196:199], v[184:187], v[80:95]
  ds_read_b128 v[232:235], v3 offset:10400
  ds_read_b128 v[236:239], v4 offset:416
  v_exp_f32 v48, v48
  v_exp_f32 v49, v49
  v_mfma_f32_32x32x16_bf16 v[96:111], v[200:203], v[184:187], v[96:111]
  v_exp_f32 v50, v50
  v_exp_f32 v51, v51
  v_exp_f32_e64 v52, v52
  v_mfma_f32_32x32x16_bf16 v[64:79], v[204:207], v[188:191], v[64:79]
  v_exp_f32 v53, v53
  v_exp_f32 v54, v54
  v_exp_f32_e64 v55, v55
  v_mfma_f32_32x32x16_bf16 v[80:95], v[208:211], v[188:191], v[80:95]
  v_exp_f32 v56, v56
  v_exp_f32 v57, v57
  v_exp_f32_e64 v58, v58
  v_mfma_f32_32x32x16_bf16 v[96:111], v[212:215], v[188:191], v[96:111]
  s_waitcnt lgkmcnt(0)
  v_exp_f32 v59, v59
  v_exp_f32 v60, v60
  v_exp_f32 v61, v61
  v_exp_f32 v62, v62
  v_exp_f32 v63, v63
  v_pk_add_f32 v[12:13], v[12:13], v[116:117]
  v_pk_fma_f32 v[14:15], v[116:117], v[116:117], v[14:15]
  v_pk_add_f32 v[12:13], v[12:13], v[118:119]
  v_pk_fma_f32 v[14:15], v[118:119], v[118:119], v[14:15]
  v_pk_fma_f32 v[48:49], v[48:49], s[22:23], s[22:23]
  v_pk_fma_f32 v[50:51], v[50:51], s[22:23], s[22:23]
  v_pk_fma_f32 v[52:53], v[52:53], s[22:23], s[22:23]
  v_pk_fma_f32 v[54:55], v[54:55], s[22:23], s[22:23]
  v_pk_fma_f32 v[56:57], v[56:57], s[22:23], s[22:23]
  v_pk_fma_f32 v[58:59], v[58:59], s[22:23], s[22:23]
  v_pk_fma_f32 v[60:61], v[60:61], s[22:23], s[22:23]
  v_pk_fma_f32 v[62:63], v[62:63], s[22:23], s[22:23]
  v_mfma_f32_32x32x16_bf16 v[32:47], a[192:195], v[160:163], 0
  ds_read_b128 v[192:195], v0 offset:49152
  ds_read_b128 v[196:199], v0 offset:50176
  v_rcp_f32 v48, v48
  v_rcp_f32 v49, v49
  v_mfma_f32_16x16x32_bf16 v[120:123], v[216:219], v[220:223], 0
  ds_read_b128 v[216:219], v3 offset:1200
  ds_read_b128 v[220:223], v4 offset:48
  v_mfma_f32_32x32x16_bf16 v[32:47], a[196:199], v[164:167], v[32:47]
  ds_read_b128 v[200:203], v0 offset:51200
  ds_read_b128 v[204:207], v0 offset:52224
  v_rcp_f32 v50, v50
  v_rcp_f32 v51, v51
  v_mfma_f32_16x16x32_bf16 v[120:123], v[224:227], v[228:231], v[120:123]
  ds_read_b128 v[224:227], v3 offset:6000
  ds_read_b128 v[228:231], v4 offset:240
  v_mfma_f32_32x32x16_bf16 v[32:47], a[200:203], v[168:171], v[32:47]
  ds_read_b128 v[208:211], v0 offset:53248
  ds_read_b128 v[212:215], v0 offset:54272
  v_rcp_f32 v52, v52
  v_rcp_f32 v53, v53
  v_mfma_f32_16x16x32_bf16 v[120:123], v[232:235], v[236:239], v[120:123]
  ds_read_b128 v[232:235], v3 offset:10800
  ds_read_b128 v[236:239], v4 offset:432
  v_mfma_f32_32x32x16_bf16 v[32:47], a[204:207], v[172:175], v[32:47]
  v_rcp_f32 v54, v54
  v_rcp_f32 v55, v55
  v_rcp_f32_e64 v56, v56
  v_mfma_f32_32x32x16_bf16 v[32:47], a[208:211], v[176:179], v[32:47]
  v_rcp_f32 v57, v57
  v_rcp_f32 v58, v58
  v_rcp_f32_e64 v59, v59
  v_mfma_f32_32x32x16_bf16 v[32:47], a[212:215], v[180:183], v[32:47]
  s_waitcnt lgkmcnt(0)
  v_rcp_f32 v60, v60
  v_rcp_f32 v61, v61
  v_rcp_f32 v62, v62
  v_rcp_f32_e64 v63, v63
  v_pk_mul_f32 v[16:17], v[16:17], v[48:49]
  v_pk_mul_f32 v[18:19], v[18:19], v[50:51]
  v_pk_mul_f32 v[20:21], v[20:21], v[52:53]
  v_pk_mul_f32 v[22:23], v[22:23], v[54:55]
  v_pk_mul_f32 v[24:25], v[24:25], v[56:57]
  v_pk_mul_f32 v[26:27], v[26:27], v[58:59]
  v_pk_mul_f32 v[28:29], v[28:29], v[60:61]
  v_pk_mul_f32 v[30:31], v[30:31], v[62:63]
  v_pk_add_f32 v[12:13], v[12:13], v[120:121]
  v_pk_fma_f32 v[14:15], v[120:121], v[120:121], v[14:15]
  v_pk_add_f32 v[12:13], v[12:13], v[122:123]
  v_pk_fma_f32 v[14:15], v[122:123], v[122:123], v[14:15]
  v_pk_fma_f32 v[48:49], v[32:33], v[32:33], s[20:21] neg_lo:[1,0,1] neg_hi:[1,0,1]
  v_pk_fma_f32 v[50:51], v[34:35], v[34:35], s[20:21] neg_lo:[1,0,1] neg_hi:[1,0,1]
  v_pk_fma_f32 v[52:53], v[36:37], v[36:37], s[20:21] neg_lo:[1,0,1] neg_hi:[1,0,1]
  v_pk_fma_f32 v[54:55], v[38:39], v[38:39], s[20:21] neg_lo:[1,0,1] neg_hi:[1,0,1]
  v_pk_fma_f32 v[56:57], v[40:41], v[40:41], s[20:21] neg_lo:[1,0,1] neg_hi:[1,0,1]
  v_pk_fma_f32 v[58:59], v[42:43], v[42:43], s[20:21] neg_lo:[1,0,1] neg_hi:[1,0,1]
  v_pk_fma_f32 v[60:61], v[44:45], v[44:45], s[20:21] neg_lo:[1,0,1] neg_hi:[1,0,1]
  v_pk_fma_f32 v[62:63], v[46:47], v[46:47], s[20:21] neg_lo:[1,0,1] neg_hi:[1,0,1]
  v_pk_mul_f32 v[48:49], v[32:33], v[48:49]
  v_pk_mul_f32 v[50:51], v[34:35], v[50:51]
  v_pk_mul_f32 v[52:53], v[36:37], v[52:53]
  v_pk_mul_f32 v[54:55], v[38:39], v[54:55]
  v_pk_mul_f32 v[56:57], v[40:41], v[56:57]
  v_pk_mul_f32 v[58:59], v[42:43], v[58:59]
  v_pk_mul_f32 v[60:61], v[44:45], v[60:61]
  v_pk_mul_f32 v[62:63], v[46:47], v[62:63]
  v_mfma_f32_16x16x32_bf16 v[124:127], v[216:219], v[220:223], 0
  v_cvt_pk_bf16_f32 v184, v16, v17
  v_cvt_pk_bf16_f32 v185, v18, v19
  v_mfma_f32_16x16x32_bf16 v[124:127], v[224:227], v[228:231], v[124:127]
  v_cvt_pk_bf16_f32 v186, v20, v21
  v_cvt_pk_bf16_f32 v187, v22, v23
  v_mfma_f32_16x16x32_bf16 v[124:127], v[232:235], v[236:239], v[124:127]
  ds_read_b128 v[216:219], v3 offset:1600
  ds_read_b128 v[220:223], v4 offset:64
  v_mfma_f32_32x32x16_bf16 v[64:79], v[192:195], v[184:187], v[64:79]
  ds_read_b128 v[224:227], v3 offset:6400
  ds_read_b128 v[228:231], v4 offset:256
  v_cvt_pk_bf16_f32 v188, v24, v25
  v_cvt_pk_bf16_f32 v189, v26, v27
  v_cvt_pk_bf16_f32 v190, v28, v29
  v_cvt_pk_bf16_f32 v191, v30, v31
  v_mfma_f32_32x32x16_bf16 v[80:95], v[196:199], v[184:187], v[80:95]
  ds_read_b128 v[232:235], v3 offset:11200
  ds_read_b128 v[236:239], v4 offset:448
  v_exp_f32 v48, v48
  v_exp_f32 v49, v49
  v_mfma_f32_32x32x16_bf16 v[96:111], v[200:203], v[184:187], v[96:111]
  v_exp_f32 v50, v50
  v_exp_f32 v51, v51
  v_exp_f32_e64 v52, v52
  v_mfma_f32_32x32x16_bf16 v[64:79], v[204:207], v[188:191], v[64:79]
  v_exp_f32 v53, v53
  v_exp_f32 v54, v54
  v_exp_f32_e64 v55, v55
  v_mfma_f32_32x32x16_bf16 v[80:95], v[208:211], v[188:191], v[80:95]
  v_exp_f32 v56, v56
  v_exp_f32 v57, v57
  v_exp_f32_e64 v58, v58
  v_mfma_f32_32x32x16_bf16 v[96:111], v[212:215], v[188:191], v[96:111]
  s_waitcnt lgkmcnt(0)
  v_exp_f32 v59, v59
  v_exp_f32 v60, v60
  v_exp_f32 v61, v61
  v_exp_f32 v62, v62
  v_exp_f32 v63, v63
  v_pk_add_f32 v[12:13], v[12:13], v[124:125]
  v_pk_fma_f32 v[14:15], v[124:125], v[124:125], v[14:15]
  v_pk_add_f32 v[12:13], v[12:13], v[126:127]
  v_pk_fma_f32 v[14:15], v[126:127], v[126:127], v[14:15]
  v_pk_fma_f32 v[48:49], v[48:49], s[22:23], s[22:23]
  v_pk_fma_f32 v[50:51], v[50:51], s[22:23], s[22:23]
  v_pk_fma_f32 v[52:53], v[52:53], s[22:23], s[22:23]
  v_pk_fma_f32 v[54:55], v[54:55], s[22:23], s[22:23]
  v_pk_fma_f32 v[56:57], v[56:57], s[22:23], s[22:23]
  v_pk_fma_f32 v[58:59], v[58:59], s[22:23], s[22:23]
  v_pk_fma_f32 v[60:61], v[60:61], s[22:23], s[22:23]
  v_pk_fma_f32 v[62:63], v[62:63], s[22:23], s[22:23]
  v_mfma_f32_32x32x16_bf16 v[16:31], a[216:219], v[160:163], 0
  ds_read_b128 v[192:195], v0 offset:55296
  ds_read_b128 v[196:199], v0 offset:56320
  v_rcp_f32 v48, v48
  v_rcp_f32 v49, v49
  v_mfma_f32_16x16x32_bf16 v[128:131], v[216:219], v[220:223], 0
  ds_read_b128 v[216:219], v3 offset:2000
  ds_read_b128 v[220:223], v4 offset:80
  v_mfma_f32_32x32x16_bf16 v[16:31], a[220:223], v[164:167], v[16:31]
  ds_read_b128 v[200:203], v0 offset:57344
  ds_read_b128 v[204:207], v0 offset:58368
  v_rcp_f32 v50, v50
  v_rcp_f32 v51, v51
  v_mfma_f32_16x16x32_bf16 v[128:131], v[224:227], v[228:231], v[128:131]
  ds_read_b128 v[224:227], v3 offset:6800
  ds_read_b128 v[228:231], v4 offset:272
  v_mfma_f32_32x32x16_bf16 v[16:31], a[224:227], v[168:171], v[16:31]
  ds_read_b128 v[208:211], v0 offset:59392
  ds_read_b128 v[212:215], v0 offset:60416
  v_rcp_f32 v52, v52
  v_rcp_f32 v53, v53
  v_mfma_f32_16x16x32_bf16 v[128:131], v[232:235], v[236:239], v[128:131]
  ds_read_b128 v[232:235], v3 offset:11600
  ds_read_b128 v[236:239], v4 offset:464
  v_mfma_f32_32x32x16_bf16 v[16:31], a[228:231], v[172:175], v[16:31]
  v_rcp_f32 v54, v54
  v_rcp_f32 v55, v55
  v_rcp_f32_e64 v56, v56
  v_mfma_f32_32x32x16_bf16 v[16:31], a[232:235], v[176:179], v[16:31]
  v_rcp_f32 v57, v57
  v_rcp_f32 v58, v58
  v_rcp_f32_e64 v59, v59
  v_mfma_f32_32x32x16_bf16 v[16:31], a[236:239], v[180:183], v[16:31]
  s_waitcnt lgkmcnt(0)
  v_rcp_f32 v60, v60
  v_rcp_f32 v61, v61
  v_rcp_f32 v62, v62
  v_rcp_f32_e64 v63, v63
  v_pk_mul_f32 v[32:33], v[32:33], v[48:49]
  v_pk_mul_f32 v[34:35], v[34:35], v[50:51]
  v_pk_mul_f32 v[36:37], v[36:37], v[52:53]
  v_pk_mul_f32 v[38:39], v[38:39], v[54:55]
  v_pk_mul_f32 v[40:41], v[40:41], v[56:57]
  v_pk_mul_f32 v[42:43], v[42:43], v[58:59]
  v_pk_mul_f32 v[44:45], v[44:45], v[60:61]
  v_pk_mul_f32 v[46:47], v[46:47], v[62:63]
  v_pk_add_f32 v[12:13], v[12:13], v[128:129]
  v_pk_fma_f32 v[14:15], v[128:129], v[128:129], v[14:15]
  v_pk_add_f32 v[12:13], v[12:13], v[130:131]
  v_pk_fma_f32 v[14:15], v[130:131], v[130:131], v[14:15]
  v_pk_fma_f32 v[48:49], v[16:17], v[16:17], s[20:21] neg_lo:[1,0,1] neg_hi:[1,0,1]
  v_pk_fma_f32 v[50:51], v[18:19], v[18:19], s[20:21] neg_lo:[1,0,1] neg_hi:[1,0,1]
  v_pk_fma_f32 v[52:53], v[20:21], v[20:21], s[20:21] neg_lo:[1,0,1] neg_hi:[1,0,1]
  v_pk_fma_f32 v[54:55], v[22:23], v[22:23], s[20:21] neg_lo:[1,0,1] neg_hi:[1,0,1]
  v_pk_fma_f32 v[56:57], v[24:25], v[24:25], s[20:21] neg_lo:[1,0,1] neg_hi:[1,0,1]
  v_pk_fma_f32 v[58:59], v[26:27], v[26:27], s[20:21] neg_lo:[1,0,1] neg_hi:[1,0,1]
  v_pk_fma_f32 v[60:61], v[28:29], v[28:29], s[20:21] neg_lo:[1,0,1] neg_hi:[1,0,1]
  v_pk_fma_f32 v[62:63], v[30:31], v[30:31], s[20:21] neg_lo:[1,0,1] neg_hi:[1,0,1]
  v_pk_mul_f32 v[48:49], v[16:17], v[48:49]
  v_pk_mul_f32 v[50:51], v[18:19], v[50:51]
  v_pk_mul_f32 v[52:53], v[20:21], v[52:53]
  v_pk_mul_f32 v[54:55], v[22:23], v[54:55]
  v_pk_mul_f32 v[56:57], v[24:25], v[56:57]
  v_pk_mul_f32 v[58:59], v[26:27], v[58:59]
  v_pk_mul_f32 v[60:61], v[28:29], v[60:61]
  v_pk_mul_f32 v[62:63], v[30:31], v[62:63]
  v_mfma_f32_16x16x32_bf16 v[132:135], v[216:219], v[220:223], 0
  v_cvt_pk_bf16_f32 v184, v32, v33
  v_cvt_pk_bf16_f32 v185, v34, v35
  v_mfma_f32_16x16x32_bf16 v[132:135], v[224:227], v[228:231], v[132:135]
  v_cvt_pk_bf16_f32 v186, v36, v37
  v_cvt_pk_bf16_f32 v187, v38, v39
  v_mfma_f32_16x16x32_bf16 v[132:135], v[232:235], v[236:239], v[132:135]
  ds_read_b128 v[216:219], v0 offset:12288
  ds_read_b128 v[220:223], v0 offset:13312
  v_mfma_f32_32x32x16_bf16 v[64:79], v[192:195], v[184:187], v[64:79]
  ds_read_b128 v[224:227], v0 offset:14336
  ds_read_b128 v[228:231], v0 offset:15360
  v_cvt_pk_bf16_f32 v188, v40, v41
  v_cvt_pk_bf16_f32 v189, v42, v43
  v_cvt_pk_bf16_f32 v190, v44, v45
  v_cvt_pk_bf16_f32 v191, v46, v47
  v_mfma_f32_32x32x16_bf16 v[80:95], v[196:199], v[184:187], v[80:95]
  ds_read_b128 v[232:235], v0 offset:16384
  ds_read_b128 v[236:239], v0 offset:17408
  v_exp_f32 v48, v48
  v_exp_f32 v49, v49
  v_mfma_f32_32x32x16_bf16 v[96:111], v[200:203], v[184:187], v[96:111]
  v_exp_f32 v50, v50
  v_exp_f32 v51, v51
  v_exp_f32_e64 v52, v52
  v_mfma_f32_32x32x16_bf16 v[64:79], v[204:207], v[188:191], v[64:79]
  s_mov_b32 s28, s34
  v_exp_f32 v53, v53
  v_exp_f32 v54, v54
  v_exp_f32 v55, v55
  v_mfma_f32_32x32x16_bf16 v[80:95], v[208:211], v[188:191], v[80:95]
  s_add_u32 s34, s34, 0x60000
  v_exp_f32 v56, v56
  v_exp_f32 v57, v57
  v_exp_f32_e64 v58, v58
  v_mfma_f32_32x32x16_bf16 v[96:111], v[212:215], v[188:191], v[96:111]
  s_waitcnt lgkmcnt(0)
  v_exp_f32 v59, v59
  v_exp_f32 v60, v60
  v_exp_f32 v61, v61
  v_exp_f32 v62, v62
  v_exp_f32 v63, v63
  v_pk_add_f32 v[12:13], v[12:13], v[132:133]
  v_pk_fma_f32 v[14:15], v[132:133], v[132:133], v[14:15]
  v_pk_add_f32 v[12:13], v[12:13], v[134:135]
  v_pk_fma_f32 v[14:15], v[134:135], v[134:135], v[14:15]
  v_pk_fma_f32 v[48:49], v[48:49], s[22:23], s[22:23]
  v_pk_fma_f32 v[50:51], v[50:51], s[22:23], s[22:23]
  v_pk_fma_f32 v[52:53], v[52:53], s[22:23], s[22:23]
  v_pk_fma_f32 v[54:55], v[54:55], s[22:23], s[22:23]
  v_pk_fma_f32 v[56:57], v[56:57], s[22:23], s[22:23]
  v_pk_fma_f32 v[58:59], v[58:59], s[22:23], s[22:23]
  v_pk_fma_f32 v[60:61], v[60:61], s[22:23], s[22:23]
  v_pk_fma_f32 v[62:63], v[62:63], s[22:23], s[22:23]
  v_mfma_f32_32x32x16_bf16 v[32:47], v[216:219], v[160:163], 0
  ds_read_b128 v[192:195], v0 offset:61440
  ds_read_b128 v[196:199], v0 offset:62464
  v_rcp_f32 v48, v48
  v_rcp_f32 v49, v49
  v_add_f32_e64 v12, v12, v13
  v_mfma_f32_32x32x16_bf16 v[32:47], v[220:223], v[164:167], v[32:47]
  ds_read_b128 v[200:203], v0 offset:63488
  ds_read_b128 v[204:207], v0 offset:64512
  v_rcp_f32 v50, v50
  v_add_f32 v14, v14, v15
  v_rcp_f32_e64 v51, v51
  v_mfma_f32_32x32x16_bf16 v[32:47], v[224:227], v[168:171], v[32:47]
  ds_read_b128 v[208:211], v1
  ds_read_b128 v[212:215], v1 offset:1024
  v_permlane32_swap_b32 v12, v14
  v_rcp_f32 v52, v52
  v_add_f32 v12, v12, v14
  v_rcp_f32 v53, v53
  v_mfma_f32_32x32x16_bf16 v[32:47], v[228:231], v[172:175], v[32:47]
  v_mov_b32 v14, v12
  v_rcp_f32 v54, v54
  s_nop 0
  v_permlane32_swap_b32 v12, v14
  v_rcp_f32 v55, v55
  v_mul_f32 v12, s24, v12
  v_mfma_f32_32x32x16_bf16 v[32:47], v[232:235], v[176:179], v[32:47]
  v_rcp_f32 v56, v56
  v_rcp_f32 v57, v57
  v_mul_f32 v13, s24, v14
  v_rcp_f32 v58, v58
  v_fma_f32 v13, -v12, v12, v13
  v_mfma_f32_32x32x16_bf16 v[32:47], v[236:239], v[180:183], v[32:47]
  s_waitcnt lgkmcnt(0)
  v_rcp_f32 v59, v59
  v_max_f32 v13, 0, v13
  v_rcp_f32 v60, v60
  v_add_f32 v13, s25, v13
  v_rcp_f32 v61, v61
  v_rsq_f32 v13, v13
  v_rcp_f32 v62, v62
  v_mul_f32 v14, s22, v13
  v_rcp_f32 v63, v63
  v_mul_f32_e64 v12, -v12, v14
  v_pk_mul_f32 v[16:17], v[16:17], v[48:49]
  v_pk_mul_f32 v[18:19], v[18:19], v[50:51]
  v_pk_mul_f32 v[20:21], v[20:21], v[52:53]
  v_pk_mul_f32 v[22:23], v[22:23], v[54:55]
  v_pk_mul_f32 v[24:25], v[24:25], v[56:57]
  v_pk_mul_f32 v[26:27], v[26:27], v[58:59]
  v_pk_mul_f32 v[28:29], v[28:29], v[60:61]
  v_pk_mul_f32 v[30:31], v[30:31], v[62:63]
  v_pk_fma_f32 v[112:113], v[112:113], v[14:15], v[12:13] op_sel_hi:[1,0,0]
  v_pk_fma_f32 v[114:115], v[114:115], v[14:15], v[12:13] op_sel_hi:[1,0,0]
  v_pk_fma_f32 v[116:117], v[116:117], v[14:15], v[12:13] op_sel_hi:[1,0,0]
  v_pk_fma_f32 v[118:119], v[118:119], v[14:15], v[12:13] op_sel_hi:[1,0,0]
  v_pk_fma_f32 v[120:121], v[120:121], v[14:15], v[12:13] op_sel_hi:[1,0,0]
  v_pk_fma_f32 v[122:123], v[122:123], v[14:15], v[12:13] op_sel_hi:[1,0,0]
  v_pk_fma_f32 v[124:125], v[124:125], v[14:15], v[12:13] op_sel_hi:[1,0,0]
  v_pk_fma_f32 v[126:127], v[126:127], v[14:15], v[12:13] op_sel_hi:[1,0,0]
  v_pk_fma_f32 v[128:129], v[128:129], v[14:15], v[12:13] op_sel_hi:[1,0,0]
  v_pk_fma_f32 v[130:131], v[130:131], v[14:15], v[12:13] op_sel_hi:[1,0,0]
  v_pk_fma_f32 v[132:133], v[132:133], v[14:15], v[12:13] op_sel_hi:[1,0,0]
  v_pk_fma_f32 v[134:135], v[134:135], v[14:15], v[12:13] op_sel_hi:[1,0,0]
  v_pk_fma_f32 v[136:137], v[136:137], v[14:15], v[12:13] op_sel_hi:[1,0,0]
  v_pk_fma_f32 v[138:139], v[138:139], v[14:15], v[12:13] op_sel_hi:[1,0,0]
  v_pk_fma_f32 v[140:141], v[140:141], v[14:15], v[12:13] op_sel_hi:[1,0,0]
  v_pk_fma_f32 v[142:143], v[142:143], v[14:15], v[12:13] op_sel_hi:[1,0,0]
  v_pk_fma_f32 v[144:145], v[144:145], v[14:15], v[12:13] op_sel_hi:[1,0,0]
  v_pk_fma_f32 v[146:147], v[146:147], v[14:15], v[12:13] op_sel_hi:[1,0,0]
  v_pk_fma_f32 v[148:149], v[148:149], v[14:15], v[12:13] op_sel_hi:[1,0,0]
  v_pk_fma_f32 v[150:151], v[150:151], v[14:15], v[12:13] op_sel_hi:[1,0,0]
  v_pk_fma_f32 v[152:153], v[152:153], v[14:15], v[12:13] op_sel_hi:[1,0,0]
  v_pk_fma_f32 v[154:155], v[154:155], v[14:15], v[12:13] op_sel_hi:[1,0,0]
  v_pk_fma_f32 v[156:157], v[156:157], v[14:15], v[12:13] op_sel_hi:[1,0,0]
  v_pk_fma_f32 v[158:159], v[158:159], v[14:15], v[12:13] op_sel_hi:[1,0,0]
  v_pk_fma_f32 v[48:49], v[32:33], v[32:33], s[20:21] neg_lo:[1,0,1] neg_hi:[1,0,1]
  v_pk_fma_f32 v[50:51], v[34:35], v[34:35], s[20:21] neg_lo:[1,0,1] neg_hi:[1,0,1]
  v_pk_fma_f32 v[52:53], v[36:37], v[36:37], s[20:21] neg_lo:[1,0,1] neg_hi:[1,0,1]
  v_pk_fma_f32 v[54:55], v[38:39], v[38:39], s[20:21] neg_lo:[1,0,1] neg_hi:[1,0,1]
  v_pk_fma_f32 v[56:57], v[40:41], v[40:41], s[20:21] neg_lo:[1,0,1] neg_hi:[1,0,1]
  v_pk_fma_f32 v[58:59], v[42:43], v[42:43], s[20:21] neg_lo:[1,0,1] neg_hi:[1,0,1]
  v_pk_fma_f32 v[60:61], v[44:45], v[44:45], s[20:21] neg_lo:[1,0,1] neg_hi:[1,0,1]
  v_pk_fma_f32 v[62:63], v[46:47], v[46:47], s[20:21] neg_lo:[1,0,1] neg_hi:[1,0,1]
  v_pk_mul_f32 v[48:49], v[32:33], v[48:49]
  v_pk_mul_f32 v[50:51], v[34:35], v[50:51]
  v_pk_mul_f32 v[52:53], v[36:37], v[52:53]
  v_pk_mul_f32 v[54:55], v[38:39], v[54:55]
  v_pk_mul_f32 v[56:57], v[40:41], v[56:57]
  v_cvt_pk_bf16_f32 v184, v16, v17
  v_cvt_pk_bf16_f32 v185, v18, v19
  v_cvt_pk_bf16_f32 v186, v20, v21
  v_cvt_pk_bf16_f32 v187, v22, v23
  v_pk_mul_f32 v[58:59], v[42:43], v[58:59]
  v_pk_mul_f32 v[60:61], v[44:45], v[60:61]
  v_pk_mul_f32 v[62:63], v[46:47], v[62:63]
  v_mfma_f32_32x32x16_bf16 v[64:79], v[192:195], v[184:187], v[64:79]
  ds_read_b128 v[216:219], v0 offset:18432
  ds_read_b128 v[220:223], v0 offset:19456
  v_cvt_pk_bf16_f32 v188, v24, v25
  v_cvt_pk_bf16_f32 v189, v26, v27
  v_cvt_pk_bf16_f32 v190, v28, v29
  v_cvt_pk_bf16_f32 v191, v30, v31
  v_exp_f32_e64 v48, v48
  v_cndmask_b32 v159, v159, v250, s[12:13]
  v_mfma_f32_32x32x16_bf16 v[80:95], v[196:199], v[184:187], v[80:95]
  ds_read_b128 v[224:227], v0 offset:20480
  ds_read_b128 v[228:231], v0 offset:21504
  v_exp_f32_e64 v49, v49
  v_cvt_pk_bf16_f32 v160, v112, v113
  v_cvt_pk_bf16_f32 v161, v114, v115
  v_exp_f32_e64 v50, v50
  v_cvt_pk_bf16_f32 v162, v116, v117
  v_mfma_f32_32x32x16_bf16 v[96:111], v[200:203], v[184:187], v[96:111]
  ds_read_b128 v[232:235], v0 offset:22528
  ds_read_b128 v[236:239], v0 offset:23552
  v_exp_f32_e64 v51, v51
  v_cvt_pk_bf16_f32 v163, v118, v119
  v_cvt_pk_bf16_f32 v164, v120, v121
  v_exp_f32_e64 v52, v52
  v_cvt_pk_bf16_f32 v165, v122, v123
  v_mfma_f32_32x32x16_bf16 v[64:79], v[204:207], v[188:191], v[64:79]
  v_exp_f32_e64 v53, v53
  v_cvt_pk_bf16_f32 v166, v124, v125
  v_cvt_pk_bf16_f32 v167, v126, v127
  v_exp_f32_e64 v54, v54
  v_cvt_pk_bf16_f32 v168, v128, v129
  v_exp_f32_e64 v55, v55
  v_cvt_pk_bf16_f32 v169, v130, v131
  v_cvt_pk_bf16_f32 v170, v132, v133
  v_mfma_f32_32x32x16_bf16 v[80:95], v[208:211], v[188:191], v[80:95]
  v_exp_f32_e64 v56, v56
  v_cvt_pk_bf16_f32 v171, v134, v135
  v_cvt_pk_bf16_f32 v172, v136, v137
  v_exp_f32_e64 v57, v57
  v_cvt_pk_bf16_f32 v173, v138, v139
  v_exp_f32_e64 v58, v58
  v_cvt_pk_bf16_f32 v174, v140, v141
  v_cvt_pk_bf16_f32 v175, v142, v143
  v_mfma_f32_32x32x16_bf16 v[96:111], v[212:215], v[188:191], v[96:111]
  s_waitcnt lgkmcnt(0)
  v_exp_f32 v59, v59
  v_cvt_pk_bf16_f32 v176, v144, v145
  v_exp_f32_e64 v60, v60
  v_cvt_pk_bf16_f32 v177, v146, v147
  v_cvt_pk_bf16_f32 v178, v148, v149
  v_exp_f32_e64 v61, v61
  v_cvt_pk_bf16_f32 v179, v150, v151
  v_exp_f32_e64 v62, v62
  v_cvt_pk_bf16_f32 v180, v152, v153
  v_cvt_pk_bf16_f32 v181, v154, v155
  v_exp_f32_e64 v63, v63
  v_cvt_pk_bf16_f32 v182, v156, v157
  v_cvt_pk_bf16_f32 v183, v158, v159
  v_pk_fma_f32 v[48:49], v[48:49], s[22:23], s[22:23]
  v_pk_fma_f32 v[50:51], v[50:51], s[22:23], s[22:23]
  v_pk_fma_f32 v[52:53], v[52:53], s[22:23], s[22:23]
  v_pk_fma_f32 v[54:55], v[54:55], s[22:23], s[22:23]
  v_pk_fma_f32 v[56:57], v[56:57], s[22:23], s[22:23]
  v_pk_fma_f32 v[58:59], v[58:59], s[22:23], s[22:23]
  v_pk_fma_f32 v[60:61], v[60:61], s[22:23], s[22:23]
  v_pk_fma_f32 v[62:63], v[62:63], s[22:23], s[22:23]
  s_mov_b32 s26, 6
  .p2align 6
  s_nop 0
  s_waitcnt vmcnt(0)
S_loop:
  v_mfma_f32_32x32x16_bf16 v[16:31], v[216:219], v[160:163], 0
  ds_read_b128 v[192:195], v1 offset:2048
  ds_read_b128 v[196:199], v1 offset:3072
  ds_read_b128 v[200:203], v1 offset:4096
  v_rcp_f32 v48, v48
  v_rcp_f32 v49, v49
  v_mfma_f32_32x32x16_bf16 v[16:31], v[220:223], v[164:167], v[16:31]
  ds_read_b128 v[204:207], v1 offset:5120
  ds_read_b128 v[208:211], v1 offset:6144
  ds_read_b128 v[212:215], v1 offset:7168
  v_rcp_f32 v50, v50
  v_rcp_f32 v51, v51
  v_mfma_f32_32x32x16_bf16 v[16:31], v[224:227], v[168:171], v[16:31]
  ds_read_b128 v[136:139], v5
  ds_read_b128 v[140:143], v5 offset:32
  ds_read_b128 v[144:147], v5 offset:64
  v_rcp_f32 v52, v52
  v_rcp_f32 v53, v53
  v_mfma_f32_32x32x16_bf16 v[16:31], v[228:231], v[172:175], v[16:31]
  ds_read_b128 v[148:151], v5 offset:96
  ds_read_b128 v[152:155], v5 offset:128
  ds_read_b128 v[156:159], v5 offset:160
  v_rcp_f32 v54, v54
  v_rcp_f32 v55, v55
  v_mfma_f32_32x32x16_bf16 v[16:31], v[232:235], v[176:179], v[16:31]
  v_rcp_f32 v56, v56
  v_rcp_f32 v57, v57
  v_rcp_f32_e64 v58, v58
  v_mfma_f32_32x32x16_bf16 v[16:31], v[236:239], v[180:183], v[16:31]
  s_waitcnt lgkmcnt(0)
  v_rcp_f32 v59, v59
  v_rcp_f32 v60, v60
  v_rcp_f32 v61, v61
  v_rcp_f32 v62, v62
  v_rcp_f32 v63, v63
  v_pk_mul_f32 v[32:33], v[32:33], v[48:49]
  v_pk_mul_f32 v[34:35], v[34:35], v[50:51]
  v_pk_mul_f32 v[36:37], v[36:37], v[52:53]
  v_pk_mul_f32 v[38:39], v[38:39], v[54:55]
  v_pk_mul_f32 v[40:41], v[40:41], v[56:57]
  v_pk_mul_f32 v[42:43], v[42:43], v[58:59]
  v_pk_mul_f32 v[44:45], v[44:45], v[60:61]
  v_pk_mul_f32 v[46:47], v[46:47], v[62:63]
  v_pk_fma_f32 v[48:49], v[16:17], v[16:17], s[20:21] neg_lo:[1,0,1] neg_hi:[1,0,1]
  v_pk_fma_f32 v[50:51], v[18:19], v[18:19], s[20:21] neg_lo:[1,0,1] neg_hi:[1,0,1]
  v_pk_fma_f32 v[52:53], v[20:21], v[20:21], s[20:21] neg_lo:[1,0,1] neg_hi:[1,0,1]
  v_pk_fma_f32 v[54:55], v[22:23], v[22:23], s[20:21] neg_lo:[1,0,1] neg_hi:[1,0,1]
  v_pk_fma_f32 v[56:57], v[24:25], v[24:25], s[20:21] neg_lo:[1,0,1] neg_hi:[1,0,1]
  v_pk_fma_f32 v[58:59], v[26:27], v[26:27], s[20:21] neg_lo:[1,0,1] neg_hi:[1,0,1]
  v_pk_fma_f32 v[60:61], v[28:29], v[28:29], s[20:21] neg_lo:[1,0,1] neg_hi:[1,0,1]
  v_pk_fma_f32 v[62:63], v[30:31], v[30:31], s[20:21] neg_lo:[1,0,1] neg_hi:[1,0,1]
  v_pk_mul_f32 v[48:49], v[16:17], v[48:49]
  v_pk_mul_f32 v[50:51], v[18:19], v[50:51]
  v_pk_mul_f32 v[52:53], v[20:21], v[52:53]
  v_pk_mul_f32 v[54:55], v[22:23], v[54:55]
  v_pk_mul_f32 v[56:57], v[24:25], v[56:57]
  v_cvt_pk_bf16_f32 v184, v32, v33
  v_cvt_pk_bf16_f32 v185, v34, v35
  v_cvt_pk_bf16_f32 v186, v36, v37
  v_cvt_pk_bf16_f32 v187, v38, v39
  v_pk_mul_f32 v[58:59], v[26:27], v[58:59]
  v_pk_mul_f32 v[60:61], v[28:29], v[60:61]
  v_pk_mul_f32 v[62:63], v[30:31], v[62:63]
  v_mfma_f32_32x32x16_bf16 v[64:79], v[192:195], v[184:187], v[64:79]
  s_mov_b32 m0, s30
  v_cvt_pk_bf16_f32 v188, v40, v41
  v_cvt_pk_bf16_f32 v189, v42, v43
  v_cvt_pk_bf16_f32 v190, v44, v45
  v_cvt_pk_bf16_f32 v191, v46, v47
  v_exp_f32 v48, v48
  v_mfma_f32_32x32x16_bf16 v[80:95], v[196:199], v[184:187], v[80:95]
  buffer_load_dwordx4 v6, s[4:7], s29 offen lds
  v_exp_f32 v49, v49
  v_exp_f32 v50, v50
  v_exp_f32_e64 v51, v51
  v_mfma_f32_32x32x16_bf16 v[96:111], v[200:203], v[184:187], v[96:111]
  buffer_load_dwordx4 v7, s[4:7], s29 offen offset:1024 lds
  v_exp_f32 v52, v52
  v_exp_f32 v53, v53
  v_mfma_f32_32x32x16_bf16 v[64:79], v[204:207], v[188:191], v[64:79]
  buffer_load_dwordx4 v8, s[4:7], s29 offen offset:2048 lds
  v_exp_f32 v54, v54
  v_exp_f32 v55, v55
  v_exp_f32_e64 v56, v56
  v_mfma_f32_32x32x16_bf16 v[80:95], v[208:211], v[188:191], v[80:95]
  buffer_load_dwordx4 v9, s[4:7], s29 offen offset:3072 lds
  v_exp_f32 v57, v57
  v_exp_f32 v58, v58
  v_mfma_f32_32x32x16_bf16 v[96:111], v[212:215], v[188:191], v[96:111]
  v_exp_f32 v59, v59
  v_exp_f32 v60, v60
  v_exp_f32 v61, v61
  v_exp_f32 v62, v62
  v_exp_f32_e64 v63, v63
  v_pk_fma_f32 v[48:49], v[48:49], s[22:23], s[22:23]
  v_pk_fma_f32 v[50:51], v[50:51], s[22:23], s[22:23]
  v_pk_fma_f32 v[52:53], v[52:53], s[22:23], s[22:23]
  v_pk_fma_f32 v[54:55], v[54:55], s[22:23], s[22:23]
  v_pk_fma_f32 v[56:57], v[56:57], s[22:23], s[22:23]
  v_pk_fma_f32 v[58:59], v[58:59], s[22:23], s[22:23]
  v_pk_fma_f32 v[60:61], v[60:61], s[22:23], s[22:23]
  v_pk_fma_f32 v[62:63], v[62:63], s[22:23], s[22:23]
  v_mfma_f32_32x32x16_bf16 v[32:47], a[0:3], v[160:163], 0
  v_cvt_pk_bf16_f32 v112, v64, v65
  v_cvt_pk_bf16_f32 v113, v66, v67
  v_cvt_pk_bf16_f32 v114, v68, v69
  v_cvt_pk_bf16_f32 v115, v70, v71
  v_cvt_pk_bf16_f32 v116, v72, v73
  v_cvt_pk_bf16_f32 v117, v74, v75
  v_mfma_f32_32x32x16_bf16 v[32:47], a[4:7], v[164:167], v[32:47]
  v_cvt_pk_bf16_f32 v118, v76, v77
  v_cvt_pk_bf16_f32 v119, v78, v79
  v_cvt_pk_bf16_f32 v120, v80, v81
  v_cvt_pk_bf16_f32 v121, v82, v83
  v_cvt_pk_bf16_f32 v122, v84, v85
  v_cvt_pk_bf16_f32 v123, v86, v87
  v_mfma_f32_32x32x16_bf16 v[32:47], a[8:11], v[168:171], v[32:47]
  ds_read_b128 v[64:67], v2
  ds_read_b128 v[68:71], v2 offset:32
  ds_read_b128 v[72:75], v2 offset:64
  ds_read_b128 v[76:79], v2 offset:96
  v_cvt_pk_bf16_f32 v124, v88, v89
  v_cvt_pk_bf16_f32 v125, v90, v91
  v_mfma_f32_32x32x16_bf16 v[32:47], a[12:15], v[172:175], v[32:47]
  ds_read_b128 v[192:195], v1 offset:8192
  ds_read_b128 v[196:199], v1 offset:9216
  v_cvt_pk_bf16_f32 v126, v92, v93
  v_cvt_pk_bf16_f32 v127, v94, v95
  v_cvt_pk_bf16_f32 v128, v96, v97
  v_cvt_pk_bf16_f32 v129, v98, v99
  v_mfma_f32_32x32x16_bf16 v[32:47], a[16:19], v[176:179], v[32:47]
  ds_read_b128 v[80:83], v2 offset:128
  ds_read_b128 v[84:87], v2 offset:160
  ds_read_b128 v[88:91], v2 offset:192
  ds_read_b128 v[92:95], v2 offset:224
  v_cvt_pk_bf16_f32 v130, v100, v101
  v_cvt_pk_bf16_f32 v131, v102, v103
  v_mfma_f32_32x32x16_bf16 v[32:47], a[20:23], v[180:183], v[32:47]
  s_nop 0
  s_waitcnt lgkmcnt(6)
  ds_read_b128 v[200:203], v1 offset:10240
  ds_read_b128 v[204:207], v1 offset:11264
  v_cvt_pk_bf16_f32 v132, v104, v105
  v_cvt_pk_bf16_f32 v133, v106, v107
  v_cvt_pk_bf16_f32 v134, v108, v109
  v_cvt_pk_bf16_f32 v135, v110, v111
  v_mfma_f32_32x32x16_bf16 v[64:79], v[240:243], v[136:139], v[64:79]
  ds_read_b128 v[96:99], v2 offset:256
  ds_read_b128 v[100:103], v2 offset:288
  ds_read_b128 v[104:107], v2 offset:320
  ds_read_b128 v[108:111], v2 offset:352
  v_rcp_f32 v48, v48
  v_mfma_f32_32x32x16_bf16 v[64:79], v[244:247], v[140:143], v[64:79]
  s_waitcnt lgkmcnt(6)
  ds_read_b128 v[208:211], v1 offset:12288
  ds_read_b128 v[212:215], v1 offset:13312
  v_rcp_f32 v49, v49
  v_rcp_f32 v50, v50
  v_mfma_f32_32x32x16_bf16 v[80:95], v[240:243], v[144:147], v[80:95]
  v_rcp_f32 v51, v51
  v_rcp_f32 v52, v52
  v_rcp_f32_e64 v53, v53
  v_mfma_f32_32x32x16_bf16 v[80:95], v[244:247], v[148:151], v[80:95]
  s_waitcnt lgkmcnt(2)
  v_rcp_f32 v54, v54
  v_rcp_f32 v55, v55
  v_rcp_f32 v56, v56
  v_mfma_f32_32x32x16_bf16 v[96:111], v[240:243], v[152:155], v[96:111]
  v_rcp_f32 v57, v57
  v_rcp_f32 v58, v58
  v_rcp_f32_e64 v59, v59
  v_mfma_f32_32x32x16_bf16 v[96:111], v[244:247], v[156:159], v[96:111]
  s_waitcnt lgkmcnt(0)
  v_rcp_f32 v60, v60
  v_rcp_f32 v61, v61
  v_rcp_f32 v62, v62
  v_rcp_f32_e64 v63, v63
  v_pk_mul_f32 v[16:17], v[16:17], v[48:49]
  v_pk_mul_f32 v[18:19], v[18:19], v[50:51]
  v_pk_mul_f32 v[20:21], v[20:21], v[52:53]
  v_pk_mul_f32 v[22:23], v[22:23], v[54:55]
  v_pk_mul_f32 v[24:25], v[24:25], v[56:57]
  v_pk_mul_f32 v[26:27], v[26:27], v[58:59]
  v_pk_mul_f32 v[28:29], v[28:29], v[60:61]
  v_pk_mul_f32 v[30:31], v[30:31], v[62:63]
  v_pk_fma_f32 v[48:49], v[32:33], v[32:33], s[20:21] neg_lo:[1,0,1] neg_hi:[1,0,1]
  v_pk_fma_f32 v[50:51], v[34:35], v[34:35], s[20:21] neg_lo:[1,0,1] neg_hi:[1,0,1]
  v_pk_fma_f32 v[52:53], v[36:37], v[36:37], s[20:21] neg_lo:[1,0,1] neg_hi:[1,0,1]
  v_pk_fma_f32 v[54:55], v[38:39], v[38:39], s[20:21] neg_lo:[1,0,1] neg_hi:[1,0,1]
  v_pk_fma_f32 v[56:57], v[40:41], v[40:41], s[20:21] neg_lo:[1,0,1] neg_hi:[1,0,1]
  v_pk_fma_f32 v[58:59], v[42:43], v[42:43], s[20:21] neg_lo:[1,0,1] neg_hi:[1,0,1]
  v_pk_fma_f32 v[60:61], v[44:45], v[44:45], s[20:21] neg_lo:[1,0,1] neg_hi:[1,0,1]
  v_pk_fma_f32 v[62:63], v[46:47], v[46:47], s[20:21] neg_lo:[1,0,1] neg_hi:[1,0,1]
  v_pk_mul_f32 v[48:49], v[32:33], v[48:49]
  v_pk_mul_f32 v[50:51], v[34:35], v[50:51]
  v_pk_mul_f32 v[52:53], v[36:37], v[52:53]
  v_pk_mul_f32 v[54:55], v[38:39], v[54:55]
  v_pk_mul_f32 v[56:57], v[40:41], v[56:57]
  v_cvt_pk_bf16_f32 v184, v16, v17
  v_cvt_pk_bf16_f32 v185, v18, v19
  v_cvt_pk_bf16_f32 v186, v20, v21
  v_cvt_pk_bf16_f32 v187, v22, v23
  v_pk_mul_f32 v[58:59], v[42:43], v[58:59]
  v_pk_mul_f32 v[60:61], v[44:45], v[60:61]
  v_pk_mul_f32 v[62:63], v[46:47], v[62:63]
  v_mfma_f32_32x32x16_bf16 v[64:79], v[192:195], v[184:187], v[64:79]
  s_mov_b32 m0, s31
  v_cvt_pk_bf16_f32 v188, v24, v25
  v_cvt_pk_bf16_f32 v189, v26, v27
  v_cvt_pk_bf16_f32 v190, v28, v29
  v_cvt_pk_bf16_f32 v191, v30, v31
  v_exp_f32 v48, v48
  v_mfma_f32_32x32x16_bf16 v[80:95], v[196:199], v[184:187], v[80:95]
  buffer_load_dwordx4 v6, s[4:7], s52 offen lds
  v_exp_f32 v49, v49
  v_exp_f32 v50, v50
  v_exp_f32_e64 v51, v51
  v_mfma_f32_32x32x16_bf16 v[96:111], v[200:203], v[184:187], v[96:111]
  buffer_load_dwordx4 v7, s[4:7], s52 offen offset:1024 lds
  v_exp_f32 v52, v52
  v_exp_f32 v53, v53
  v_mfma_f32_32x32x16_bf16 v[64:79], v[204:207], v[188:191], v[64:79]
  buffer_load_dwordx4 v8, s[4:7], s52 offen offset:2048 lds
  v_exp_f32 v54, v54
  v_exp_f32 v55, v55
  v_exp_f32_e64 v56, v56
  v_mfma_f32_32x32x16_bf16 v[80:95], v[208:211], v[188:191], v[80:95]
  buffer_load_dwordx4 v9, s[4:7], s52 offen offset:3072 lds
  v_exp_f32 v57, v57
  v_exp_f32 v58, v58
  v_mfma_f32_32x32x16_bf16 v[96:111], v[212:215], v[188:191], v[96:111]
  v_exp_f32 v59, v59
  v_exp_f32 v60, v60
  v_exp_f32 v61, v61
  v_exp_f32 v62, v62
  v_exp_f32_e64 v63, v63
  v_pk_fma_f32 v[48:49], v[48:49], s[22:23], s[22:23]
  v_pk_fma_f32 v[50:51], v[50:51], s[22:23], s[22:23]
  v_pk_fma_f32 v[52:53], v[52:53], s[22:23], s[22:23]
  v_pk_fma_f32 v[54:55], v[54:55], s[22:23], s[22:23]
  v_pk_fma_f32 v[56:57], v[56:57], s[22:23], s[22:23]
  v_pk_fma_f32 v[58:59], v[58:59], s[22:23], s[22:23]
  v_pk_fma_f32 v[60:61], v[60:61], s[22:23], s[22:23]
  v_pk_fma_f32 v[62:63], v[62:63], s[22:23], s[22:23]
  v_mfma_f32_32x32x16_bf16 v[16:31], a[24:27], v[160:163], 0
  ds_read_b128 v[192:195], v1 offset:14336
  ds_read_b128 v[196:199], v1 offset:15360
  v_rcp_f32 v48, v48
  v_rcp_f32 v49, v49
  v_mfma_f32_32x32x16_bf16 v[16:31], a[28:31], v[164:167], v[16:31]
  ds_read_b128 v[200:203], v1 offset:16384
  ds_read_b128 v[204:207], v1 offset:17408
  v_rcp_f32 v50, v50
  v_rcp_f32 v51, v51
  v_mfma_f32_32x32x16_bf16 v[16:31], a[32:35], v[168:171], v[16:31]
  ds_read_b128 v[208:211], v1 offset:18432
  ds_read_b128 v[212:215], v1 offset:19456
  v_rcp_f32 v52, v52
  v_rcp_f32 v53, v53
  v_mfma_f32_32x32x16_bf16 v[16:31], a[36:39], v[172:175], v[16:31]
  buffer_store_dwordx4 v[112:115], v10, s[8:11], s28 offen
  v_rcp_f32 v54, v54
  v_rcp_f32 v55, v55
  v_mfma_f32_32x32x16_bf16 v[16:31], a[40:43], v[176:179], v[16:31]
  v_rcp_f32 v56, v56
  v_rcp_f32 v57, v57
  v_rcp_f32_e64 v58, v58
  v_mfma_f32_32x32x16_bf16 v[16:31], a[44:47], v[180:183], v[16:31]
  s_waitcnt lgkmcnt(0)
  v_rcp_f32 v59, v59
  v_rcp_f32 v60, v60
  v_rcp_f32 v61, v61
  v_rcp_f32 v62, v62
  v_rcp_f32 v63, v63
  v_pk_mul_f32 v[32:33], v[32:33], v[48:49]
  v_pk_mul_f32 v[34:35], v[34:35], v[50:51]
  v_pk_mul_f32 v[36:37], v[36:37], v[52:53]
  v_pk_mul_f32 v[38:39], v[38:39], v[54:55]
  v_pk_mul_f32 v[40:41], v[40:41], v[56:57]
  v_pk_mul_f32 v[42:43], v[42:43], v[58:59]
  v_pk_mul_f32 v[44:45], v[44:45], v[60:61]
  v_pk_mul_f32 v[46:47], v[46:47], v[62:63]
  v_pk_fma_f32 v[48:49], v[16:17], v[16:17], s[20:21] neg_lo:[1,0,1] neg_hi:[1,0,1]
  v_pk_fma_f32 v[50:51], v[18:19], v[18:19], s[20:21] neg_lo:[1,0,1] neg_hi:[1,0,1]
  v_pk_fma_f32 v[52:53], v[20:21], v[20:21], s[20:21] neg_lo:[1,0,1] neg_hi:[1,0,1]
  v_pk_fma_f32 v[54:55], v[22:23], v[22:23], s[20:21] neg_lo:[1,0,1] neg_hi:[1,0,1]
  v_pk_fma_f32 v[56:57], v[24:25], v[24:25], s[20:21] neg_lo:[1,0,1] neg_hi:[1,0,1]
  v_pk_fma_f32 v[58:59], v[26:27], v[26:27], s[20:21] neg_lo:[1,0,1] neg_hi:[1,0,1]
  v_pk_fma_f32 v[60:61], v[28:29], v[28:29], s[20:21] neg_lo:[1,0,1] neg_hi:[1,0,1]
  v_pk_fma_f32 v[62:63], v[30:31], v[30:31], s[20:21] neg_lo:[1,0,1] neg_hi:[1,0,1]
  v_pk_mul_f32 v[48:49], v[16:17], v[48:49]
  v_pk_mul_f32 v[50:51], v[18:19], v[50:51]
  v_pk_mul_f32 v[52:53], v[20:21], v[52:53]
  v_pk_mul_f32 v[54:55], v[22:23], v[54:55]
  v_pk_mul_f32 v[56:57], v[24:25], v[56:57]
  v_cvt_pk_bf16_f32 v184, v32, v33
  v_cvt_pk_bf16_f32 v185, v34, v35
  v_cvt_pk_bf16_f32 v186, v36, v37
  v_cvt_pk_bf16_f32 v187, v38, v39
  v_pk_mul_f32 v[58:59], v[26:27], v[58:59]
  v_pk_mul_f32 v[60:61], v[28:29], v[60:61]
  v_pk_mul_f32 v[62:63], v[30:31], v[62:63]
  v_mfma_f32_32x32x16_bf16 v[64:79], v[192:195], v[184:187], v[64:79]
  v_cvt_pk_bf16_f32 v188, v40, v41
  v_cvt_pk_bf16_f32 v189, v42, v43
  v_cvt_pk_bf16_f32 v190, v44, v45
  v_cvt_pk_bf16_f32 v191, v46, v47
  v_exp_f32_e64 v48, v48
  v_mfma_f32_32x32x16_bf16 v[80:95], v[196:199], v[184:187], v[80:95]
  v_exp_f32 v49, v49
  v_exp_f32 v50, v50
  v_exp_f32_e64 v51, v51
  v_mfma_f32_32x32x16_bf16 v[96:111], v[200:203], v[184:187], v[96:111]
  v_exp_f32 v52, v52
  v_exp_f32 v53, v53
  v_subrev_u32 v11, 0x4100, v5
  v_mfma_f32_32x32x16_bf16 v[64:79], v[204:207], v[188:191], v[64:79]
  v_exp_f32 v54, v54
  v_exp_f32 v55, v55
  v_exp_f32_e64 v56, v56
  v_mfma_f32_32x32x16_bf16 v[80:95], v[208:211], v[188:191], v[80:95]
  v_exp_f32 v57, v57
  v_exp_f32 v58, v58
  v_add_u32 v5, 0x8200, v5
  v_exp_f32_e64 v59, v59
  v_mfma_f32_32x32x16_bf16 v[96:111], v[212:215], v[188:191], v[96:111]
  v_exp_f32 v60, v60
  v_exp_f32 v61, v61
  v_exp_f32 v62, v62
  v_exp_f32 v63, v63
  v_min_u32_e64 v5, v11, v5
  v_pk_fma_f32 v[48:49], v[48:49], s[22:23], s[22:23]
  v_pk_fma_f32 v[50:51], v[50:51], s[22:23], s[22:23]
  v_pk_fma_f32 v[52:53], v[52:53], s[22:23], s[22:23]
  v_pk_fma_f32 v[54:55], v[54:55], s[22:23], s[22:23]
  v_pk_fma_f32 v[56:57], v[56:57], s[22:23], s[22:23]
  v_pk_fma_f32 v[58:59], v[58:59], s[22:23], s[22:23]
  v_pk_fma_f32 v[60:61], v[60:61], s[22:23], s[22:23]
  v_pk_fma_f32 v[62:63], v[62:63], s[22:23], s[22:23]
  v_mfma_f32_32x32x16_bf16 v[32:47], a[48:51], v[160:163], 0
  ds_read_b128 v[192:195], v1 offset:20480
  ds_read_b128 v[196:199], v1 offset:21504
  v_rcp_f32 v48, v48
  v_rcp_f32 v49, v49
  v_mfma_f32_32x32x16_bf16 v[32:47], a[52:55], v[164:167], v[32:47]
  ds_read_b128 v[200:203], v1 offset:22528
  ds_read_b128 v[204:207], v1 offset:23552
  v_rcp_f32 v50, v50
  v_rcp_f32 v51, v51
  v_mfma_f32_32x32x16_bf16 v[32:47], a[56:59], v[168:171], v[32:47]
  ds_read_b128 v[208:211], v1 offset:24576
  ds_read_b128 v[212:215], v1 offset:25600
  v_rcp_f32 v52, v52
  v_rcp_f32 v53, v53
  v_mfma_f32_32x32x16_bf16 v[32:47], a[60:63], v[172:175], v[32:47]
  buffer_store_dwordx4 v[116:119], v10, s[8:11], s28 offen offset:32
  v_rcp_f32 v54, v54
  v_rcp_f32 v55, v55
  v_mfma_f32_32x32x16_bf16 v[32:47], a[64:67], v[176:179], v[32:47]
  v_rcp_f32 v56, v56
  v_rcp_f32 v57, v57
  v_rcp_f32_e64 v58, v58
  v_mfma_f32_32x32x16_bf16 v[32:47], a[68:71], v[180:183], v[32:47]
  s_waitcnt lgkmcnt(0)
  v_rcp_f32 v59, v59
  v_rcp_f32 v60, v60
  v_rcp_f32 v61, v61
  v_rcp_f32 v62, v62
  v_rcp_f32 v63, v63
  v_pk_mul_f32 v[16:17], v[16:17], v[48:49]
  v_pk_mul_f32 v[18:19], v[18:19], v[50:51]
  v_pk_mul_f32 v[20:21], v[20:21], v[52:53]
  v_pk_mul_f32 v[22:23], v[22:23], v[54:55]
  v_pk_mul_f32 v[24:25], v[24:25], v[56:57]
  v_pk_mul_f32 v[26:27], v[26:27], v[58:59]
  v_pk_mul_f32 v[28:29], v[28:29], v[60:61]
  v_pk_mul_f32 v[30:31], v[30:31], v[62:63]
  v_pk_fma_f32 v[48:49], v[32:33], v[32:33], s[20:21] neg_lo:[1,0,1] neg_hi:[1,0,1]
  v_pk_fma_f32 v[50:51], v[34:35], v[34:35], s[20:21] neg_lo:[1,0,1] neg_hi:[1,0,1]
  v_pk_fma_f32 v[52:53], v[36:37], v[36:37], s[20:21] neg_lo:[1,0,1] neg_hi:[1,0,1]
  v_pk_fma_f32 v[54:55], v[38:39], v[38:39], s[20:21] neg_lo:[1,0,1] neg_hi:[1,0,1]
  v_pk_fma_f32 v[56:57], v[40:41], v[40:41], s[20:21] neg_lo:[1,0,1] neg_hi:[1,0,1]
  v_pk_fma_f32 v[58:59], v[42:43], v[42:43], s[20:21] neg_lo:[1,0,1] neg_hi:[1,0,1]
  v_pk_fma_f32 v[60:61], v[44:45], v[44:45], s[20:21] neg_lo:[1,0,1] neg_hi:[1,0,1]
  v_pk_fma_f32 v[62:63], v[46:47], v[46:47], s[20:21] neg_lo:[1,0,1] neg_hi:[1,0,1]
  v_pk_mul_f32 v[48:49], v[32:33], v[48:49]
  v_pk_mul_f32 v[50:51], v[34:35], v[50:51]
  v_pk_mul_f32 v[52:53], v[36:37], v[52:53]
  v_pk_mul_f32 v[54:55], v[38:39], v[54:55]
  v_pk_mul_f32 v[56:57], v[40:41], v[56:57]
  v_cvt_pk_bf16_f32 v184, v16, v17
  v_cvt_pk_bf16_f32 v185, v18, v19
  v_cvt_pk_bf16_f32 v186, v20, v21
  v_cvt_pk_bf16_f32 v187, v22, v23
  v_pk_mul_f32 v[58:59], v[42:43], v[58:59]
  v_pk_mul_f32 v[60:61], v[44:45], v[60:61]
  v_pk_mul_f32 v[62:63], v[46:47], v[62:63]
  v_mfma_f32_32x32x16_bf16 v[64:79], v[192:195], v[184:187], v[64:79]
  s_add_u32 s29, s29, 0x60000
  v_cvt_pk_bf16_f32 v188, v24, v25
  v_cvt_pk_bf16_f32 v189, v26, v27
  v_cvt_pk_bf16_f32 v190, v28, v29
  v_cvt_pk_bf16_f32 v191, v30, v31
  v_exp_f32_e64 v48, v48
  v_mfma_f32_32x32x16_bf16 v[80:95], v[196:199], v[184:187], v[80:95]
  s_add_u32 s52, s52, 0x60000
  v_exp_f32 v49, v49
  v_exp_f32 v50, v50
  v_exp_f32_e64 v51, v51
  v_mfma_f32_32x32x16_bf16 v[96:111], v[200:203], v[184:187], v[96:111]
  s_mov_b32 s32, s30
  v_exp_f32 v52, v52
  v_exp_f32_e64 v53, v53
  v_subrev_u32 v11, 0x4100, v4
  v_mfma_f32_32x32x16_bf16 v[64:79], v[204:207], v[188:191], v[64:79]
  s_add_u32 s30, s33, 32
  v_exp_f32 v54, v54
  v_exp_f32 v55, v55
  v_exp_f32 v56, v56
  v_mfma_f32_32x32x16_bf16 v[80:95], v[208:211], v[188:191], v[80:95]
  s_sub_u32 s33, s31, 0
  v_exp_f32 v57, v57
  v_exp_f32_e64 v58, v58
  v_add_u32 v4, 0x8200, v4
  v_exp_f32_e64 v59, v59
  v_mfma_f32_32x32x16_bf16 v[96:111], v[212:215], v[188:191], v[96:111]
  v_exp_f32 v60, v60
  v_exp_f32 v61, v61
  v_exp_f32 v62, v62
  v_exp_f32 v63, v63
  v_min_u32_e64 v4, v11, v4
  v_pk_fma_f32 v[48:49], v[48:49], s[22:23], s[22:23]
  v_pk_fma_f32 v[50:51], v[50:51], s[22:23], s[22:23]
  v_pk_fma_f32 v[52:53], v[52:53], s[22:23], s[22:23]
  v_pk_fma_f32 v[54:55], v[54:55], s[22:23], s[22:23]
  v_pk_fma_f32 v[56:57], v[56:57], s[22:23], s[22:23]
  v_pk_fma_f32 v[58:59], v[58:59], s[22:23], s[22:23]
  v_pk_fma_f32 v[60:61], v[60:61], s[22:23], s[22:23]
  v_pk_fma_f32 v[62:63], v[62:63], s[22:23], s[22:23]
  v_mfma_f32_32x32x16_bf16 v[16:31], a[72:75], v[160:163], 0
  ds_read_b128 v[192:195], v1 offset:26624
  ds_read_b128 v[196:199], v1 offset:27648
  v_rcp_f32 v48, v48
  v_rcp_f32 v49, v49
  v_mfma_f32_32x32x16_bf16 v[16:31], a[76:79], v[164:167], v[16:31]
  ds_read_b128 v[200:203], v1 offset:28672
  ds_read_b128 v[204:207], v1 offset:29696
  v_rcp_f32 v50, v50
  v_rcp_f32 v51, v51
  v_mfma_f32_32x32x16_bf16 v[16:31], a[80:83], v[168:171], v[16:31]
  ds_read_b128 v[208:211], v1 offset:30720
  ds_read_b128 v[212:215], v1 offset:31744
  v_rcp_f32 v52, v52
  v_rcp_f32 v53, v53
  v_mfma_f32_32x32x16_bf16 v[16:31], a[84:87], v[172:175], v[16:31]
  buffer_load_dword v249, v248, s[4:7], s29 offen
  v_rcp_f32 v54, v54
  v_rcp_f32 v55, v55
  v_mfma_f32_32x32x16_bf16 v[16:31], a[88:91], v[176:179], v[16:31]
  v_rcp_f32 v56, v56
  v_rcp_f32 v57, v57
  v_rcp_f32_e64 v58, v58
  v_mfma_f32_32x32x16_bf16 v[16:31], a[92:95], v[180:183], v[16:31]
  s_waitcnt lgkmcnt(0)
  v_rcp_f32 v59, v59
  v_rcp_f32 v60, v60
  v_rcp_f32 v61, v61
  v_rcp_f32 v62, v62
  v_rcp_f32 v63, v63
  v_pk_mul_f32 v[32:33], v[32:33], v[48:49]
  v_pk_mul_f32 v[34:35], v[34:35], v[50:51]
  v_pk_mul_f32 v[36:37], v[36:37], v[52:53]
  v_pk_mul_f32 v[38:39], v[38:39], v[54:55]
  v_pk_mul_f32 v[40:41], v[40:41], v[56:57]
  v_pk_mul_f32 v[42:43], v[42:43], v[58:59]
  v_pk_mul_f32 v[44:45], v[44:45], v[60:61]
  v_pk_mul_f32 v[46:47], v[46:47], v[62:63]
  v_pk_fma_f32 v[48:49], v[16:17], v[16:17], s[20:21] neg_lo:[1,0,1] neg_hi:[1,0,1]
  v_pk_fma_f32 v[50:51], v[18:19], v[18:19], s[20:21] neg_lo:[1,0,1] neg_hi:[1,0,1]
  v_pk_fma_f32 v[52:53], v[20:21], v[20:21], s[20:21] neg_lo:[1,0,1] neg_hi:[1,0,1]
  v_pk_fma_f32 v[54:55], v[22:23], v[22:23], s[20:21] neg_lo:[1,0,1] neg_hi:[1,0,1]
  v_pk_fma_f32 v[56:57], v[24:25], v[24:25], s[20:21] neg_lo:[1,0,1] neg_hi:[1,0,1]
  v_pk_fma_f32 v[58:59], v[26:27], v[26:27], s[20:21] neg_lo:[1,0,1] neg_hi:[1,0,1]
  v_pk_fma_f32 v[60:61], v[28:29], v[28:29], s[20:21] neg_lo:[1,0,1] neg_hi:[1,0,1]
  v_pk_fma_f32 v[62:63], v[30:31], v[30:31], s[20:21] neg_lo:[1,0,1] neg_hi:[1,0,1]
  v_pk_mul_f32 v[48:49], v[16:17], v[48:49]
  v_pk_mul_f32 v[50:51], v[18:19], v[50:51]
  v_pk_mul_f32 v[52:53], v[20:21], v[52:53]
  v_pk_mul_f32 v[54:55], v[22:23], v[54:55]
  v_pk_mul_f32 v[56:57], v[24:25], v[56:57]
  v_cvt_pk_bf16_f32 v184, v32, v33
  v_cvt_pk_bf16_f32 v185, v34, v35
  v_cvt_pk_bf16_f32 v186, v36, v37
  v_cvt_pk_bf16_f32 v187, v38, v39
  v_pk_mul_f32 v[58:59], v[26:27], v[58:59]
  v_pk_mul_f32 v[60:61], v[28:29], v[60:61]
  v_pk_mul_f32 v[62:63], v[30:31], v[62:63]
  v_mfma_f32_32x32x16_bf16 v[64:79], v[192:195], v[184:187], v[64:79]
  s_nop 0
  s_waitcnt vmcnt(3)
  ds_read_b128 v[220:223], v4 offset:96
  v_cvt_pk_bf16_f32 v188, v40, v41
  v_cvt_pk_bf16_f32 v189, v42, v43
  v_cvt_pk_bf16_f32 v190, v44, v45
  v_cvt_pk_bf16_f32 v191, v46, v47
  v_mfma_f32_32x32x16_bf16 v[80:95], v[196:199], v[184:187], v[80:95]
  ds_read_b128 v[228:231], v4 offset:288
  v_exp_f32 v48, v48
  v_exp_f32 v49, v49
  v_exp_f32_e64 v50, v50
  v_mfma_f32_32x32x16_bf16 v[96:111], v[200:203], v[184:187], v[96:111]
  ds_read_b128 v[236:239], v4 offset:480
  v_exp_f32 v51, v51
  v_exp_f32 v52, v52
  v_mfma_f32_32x32x16_bf16 v[64:79], v[204:207], v[188:191], v[64:79]
  v_exp_f32 v53, v53
  v_exp_f32 v54, v54
  v_exp_f32_e64 v55, v55
  v_mfma_f32_32x32x16_bf16 v[80:95], v[208:211], v[188:191], v[80:95]
  v_exp_f32 v56, v56
  v_exp_f32 v57, v57
  v_exp_f32_e64 v58, v58
  v_mfma_f32_32x32x16_bf16 v[96:111], v[212:215], v[188:191], v[96:111]
  s_waitcnt lgkmcnt(0)
  v_exp_f32 v59, v59
  v_exp_f32 v60, v60
  v_exp_f32 v61, v61
  v_exp_f32 v62, v62
  v_exp_f32 v63, v63
  v_pk_fma_f32 v[48:49], v[48:49], s[22:23], s[22:23]
  v_pk_fma_f32 v[50:51], v[50:51], s[22:23], s[22:23]
  v_pk_fma_f32 v[52:53], v[52:53], s[22:23], s[22:23]
  v_pk_fma_f32 v[54:55], v[54:55], s[22:23], s[22:23]
  v_pk_fma_f32 v[56:57], v[56:57], s[22:23], s[22:23]
  v_pk_fma_f32 v[58:59], v[58:59], s[22:23], s[22:23]
  v_pk_fma_f32 v[60:61], v[60:61], s[22:23], s[22:23]
  v_pk_fma_f32 v[62:63], v[62:63], s[22:23], s[22:23]
  v_mfma_f32_32x32x16_bf16 v[32:47], a[96:99], v[160:163], 0
  ds_read_b128 v[192:195], v0 offset:24576
  ds_read_b128 v[196:199], v0 offset:25600
  v_rcp_f32 v48, v48
  v_rcp_f32 v49, v49
  v_mfma_f32_16x16x32_bf16 v[136:139], a[240:243], v[220:223], 0
  ds_read_b128 v[216:219], v3 offset:2800
  ds_read_b128 v[220:223], v4 offset:112
  v_mfma_f32_32x32x16_bf16 v[32:47], a[100:103], v[164:167], v[32:47]
  ds_read_b128 v[200:203], v0 offset:26624
  ds_read_b128 v[204:207], v0 offset:27648
  v_rcp_f32 v50, v50
  v_rcp_f32 v51, v51
  v_mfma_f32_16x16x32_bf16 v[136:139], a[244:247], v[228:231], v[136:139]
  ds_read_b128 v[224:227], v3 offset:7600
  ds_read_b128 v[228:231], v4 offset:304
  v_mfma_f32_32x32x16_bf16 v[32:47], a[104:107], v[168:171], v[32:47]
  ds_read_b128 v[208:211], v0 offset:28672
  ds_read_b128 v[212:215], v0 offset:29696
  v_rcp_f32 v52, v52
  v_rcp_f32 v53, v53
  v_mfma_f32_16x16x32_bf16 v[136:139], a[248:251], v[236:239], v[136:139]
  ds_read_b128 v[232:235], v3 offset:12400
  ds_read_b128 v[236:239], v4 offset:496
  v_mfma_f32_32x32x16_bf16 v[32:47], a[108:111], v[172:175], v[32:47]
  buffer_store_dwordx4 v[120:123], v10, s[8:11], s28 offen offset:64
  v_rcp_f32 v54, v54
  v_rcp_f32 v55, v55
  v_mfma_f32_32x32x16_bf16 v[32:47], a[112:115], v[176:179], v[32:47]
  v_rcp_f32 v56, v56
  v_rcp_f32 v57, v57
  v_rcp_f32_e64 v58, v58
  v_mfma_f32_32x32x16_bf16 v[32:47], a[116:119], v[180:183], v[32:47]
  s_waitcnt lgkmcnt(0)
  v_rcp_f32 v59, v59
  v_rcp_f32 v60, v60
  v_rcp_f32 v61, v61
  v_rcp_f32 v62, v62
  v_rcp_f32 v63, v63
  v_pk_mul_f32 v[16:17], v[16:17], v[48:49]
  v_pk_mul_f32 v[18:19], v[18:19], v[50:51]
  v_pk_mul_f32 v[20:21], v[20:21], v[52:53]
  v_pk_mul_f32 v[22:23], v[22:23], v[54:55]
  v_pk_mul_f32 v[24:25], v[24:25], v[56:57]
  v_pk_mul_f32 v[26:27], v[26:27], v[58:59]
  v_pk_mul_f32 v[28:29], v[28:29], v[60:61]
  v_pk_mul_f32 v[30:31], v[30:31], v[62:63]
  v_pk_add_f32 v[12:13], v[136:137], v[138:139]
  v_pk_mul_f32 v[14:15], v[136:137], v[136:137]
  v_pk_fma_f32 v[14:15], v[138:139], v[138:139], v[14:15]
  v_pk_fma_f32 v[48:49], v[32:33], v[32:33], s[20:21] neg_lo:[1,0,1] neg_hi:[1,0,1]
  v_pk_fma_f32 v[50:51], v[34:35], v[34:35], s[20:21] neg_lo:[1,0,1] neg_hi:[1,0,1]
  v_pk_fma_f32 v[52:53], v[36:37], v[36:37], s[20:21] neg_lo:[1,0,1] neg_hi:[1,0,1]
  v_pk_fma_f32 v[54:55], v[38:39], v[38:39], s[20:21] neg_lo:[1,0,1] neg_hi:[1,0,1]
  v_pk_fma_f32 v[56:57], v[40:41], v[40:41], s[20:21] neg_lo:[1,0,1] neg_hi:[1,0,1]
  v_pk_fma_f32 v[58:59], v[42:43], v[42:43], s[20:21] neg_lo:[1,0,1] neg_hi:[1,0,1]
  v_pk_fma_f32 v[60:61], v[44:45], v[44:45], s[20:21] neg_lo:[1,0,1] neg_hi:[1,0,1]
  v_pk_fma_f32 v[62:63], v[46:47], v[46:47], s[20:21] neg_lo:[1,0,1] neg_hi:[1,0,1]
  v_pk_mul_f32 v[48:49], v[32:33], v[48:49]
  v_pk_mul_f32 v[50:51], v[34:35], v[50:51]
  v_pk_mul_f32 v[52:53], v[36:37], v[52:53]
  v_pk_mul_f32 v[54:55], v[38:39], v[54:55]
  v_pk_mul_f32 v[56:57], v[40:41], v[56:57]
  v_pk_mul_f32 v[58:59], v[42:43], v[58:59]
  v_pk_mul_f32 v[60:61], v[44:45], v[60:61]
  v_pk_mul_f32 v[62:63], v[46:47], v[62:63]
  v_mfma_f32_16x16x32_bf16 v[140:143], v[216:219], v[220:223], 0
  v_cvt_pk_bf16_f32 v184, v16, v17
  v_cvt_pk_bf16_f32 v185, v18, v19
  v_mfma_f32_16x16x32_bf16 v[140:143], v[224:227], v[228:231], v[140:143]
  v_cvt_pk_bf16_f32 v186, v20, v21
  v_cvt_pk_bf16_f32 v187, v22, v23
  v_mfma_f32_16x16x32_bf16 v[140:143], v[232:235], v[236:239], v[140:143]
  ds_read_b128 v[220:223], v4 offset:128
  v_mfma_f32_32x32x16_bf16 v[64:79], v[192:195], v[184:187], v[64:79]
  ds_read_b128 v[224:227], v3 offset:8000
  ds_read_b128 v[228:231], v4 offset:320
  v_cvt_pk_bf16_f32 v188, v24, v25
  v_cvt_pk_bf16_f32 v189, v26, v27
  v_cvt_pk_bf16_f32 v190, v28, v29
  v_cvt_pk_bf16_f32 v191, v30, v31
  v_mfma_f32_32x32x16_bf16 v[80:95], v[196:199], v[184:187], v[80:95]
  ds_read_b128 v[232:235], v3 offset:12800
  ds_read_b128 v[236:239], v4 offset:512
  v_exp_f32 v48, v48
  v_exp_f32 v49, v49
  v_mfma_f32_32x32x16_bf16 v[96:111], v[200:203], v[184:187], v[96:111]
  s_sub_u32 s31, s32, 32
  v_exp_f32 v50, v50
  v_exp_f32 v51, v51
  v_exp_f32 v52, v52
  v_mfma_f32_32x32x16_bf16 v[64:79], v[204:207], v[188:191], v[64:79]
  v_exp_f32 v53, v53
  v_exp_f32 v54, v54
  v_exp_f32_e64 v55, v55
  v_mfma_f32_32x32x16_bf16 v[80:95], v[208:211], v[188:191], v[80:95]
  v_exp_f32 v56, v56
  v_exp_f32 v57, v57
  v_exp_f32_e64 v58, v58
  v_mfma_f32_32x32x16_bf16 v[96:111], v[212:215], v[188:191], v[96:111]
  s_waitcnt lgkmcnt(0)
  v_exp_f32 v59, v59
  v_exp_f32 v60, v60
  v_exp_f32 v61, v61
  v_exp_f32 v62, v62
  v_exp_f32 v63, v63
  v_pk_add_f32 v[12:13], v[12:13], v[140:141]
  v_pk_fma_f32 v[14:15], v[140:141], v[140:141], v[14:15]
  v_pk_add_f32 v[12:13], v[12:13], v[142:143]
  v_pk_fma_f32 v[14:15], v[142:143], v[142:143], v[14:15]
  v_pk_fma_f32 v[48:49], v[48:49], s[22:23], s[22:23]
  v_pk_fma_f32 v[50:51], v[50:51], s[22:23], s[22:23]
  v_pk_fma_f32 v[52:53], v[52:53], s[22:23], s[22:23]
  v_pk_fma_f32 v[54:55], v[54:55], s[22:23], s[22:23]
  v_pk_fma_f32 v[56:57], v[56:57], s[22:23], s[22:23]
  v_pk_fma_f32 v[58:59], v[58:59], s[22:23], s[22:23]
  v_pk_fma_f32 v[60:61], v[60:61], s[22:23], s[22:23]
  v_pk_fma_f32 v[62:63], v[62:63], s[22:23], s[22:23]
  v_mfma_f32_32x32x16_bf16 v[16:31], a[120:123], v[160:163], 0
  ds_read_b128 v[192:195], v0 offset:30720
  ds_read_b128 v[196:199], v0 offset:31744
  v_rcp_f32 v48, v48
  v_rcp_f32 v49, v49
  v_mfma_f32_16x16x32_bf16 v[144:147], a[252:255], v[220:223], 0
  ds_read_b128 v[216:219], v3 offset:3600
  ds_read_b128 v[220:223], v4 offset:144
  v_mfma_f32_32x32x16_bf16 v[16:31], a[124:127], v[164:167], v[16:31]
  ds_read_b128 v[200:203], v0 offset:32768
  ds_read_b128 v[204:207], v0 offset:33792
  v_rcp_f32 v50, v50
  v_rcp_f32 v51, v51
  v_mfma_f32_16x16x32_bf16 v[144:147], v[224:227], v[228:231], v[144:147]
  ds_read_b128 v[224:227], v3 offset:8400
  ds_read_b128 v[228:231], v4 offset:336
  v_mfma_f32_32x32x16_bf16 v[16:31], a[128:131], v[168:171], v[16:31]
  ds_read_b128 v[208:211], v0 offset:34816
  ds_read_b128 v[212:215], v0 offset:35840
  v_rcp_f32 v52, v52
  v_rcp_f32 v53, v53
  v_mfma_f32_16x16x32_bf16 v[144:147], v[232:235], v[236:239], v[144:147]
  ds_read_b128 v[232:235], v3 offset:13200
  ds_read_b128 v[236:239], v4 offset:528
  v_mfma_f32_32x32x16_bf16 v[16:31], a[132:135], v[172:175], v[16:31]
  buffer_store_dwordx4 v[124:127], v10, s[8:11], s28 offen offset:96
  v_rcp_f32 v54, v54
  v_rcp_f32 v55, v55
  v_mfma_f32_32x32x16_bf16 v[16:31], a[136:139], v[176:179], v[16:31]
  v_rcp_f32 v56, v56
  v_rcp_f32 v57, v57
  v_rcp_f32_e64 v58, v58
  v_mfma_f32_32x32x16_bf16 v[16:31], a[140:143], v[180:183], v[16:31]
  s_waitcnt lgkmcnt(0)
  v_rcp_f32 v59, v59
  v_rcp_f32 v60, v60
  v_rcp_f32 v61, v61
  v_rcp_f32 v62, v62
  v_rcp_f32 v63, v63
  v_pk_mul_f32 v[32:33], v[32:33], v[48:49]
  v_pk_mul_f32 v[34:35], v[34:35], v[50:51]
  v_pk_mul_f32 v[36:37], v[36:37], v[52:53]
  v_pk_mul_f32 v[38:39], v[38:39], v[54:55]
  v_pk_mul_f32 v[40:41], v[40:41], v[56:57]
  v_pk_mul_f32 v[42:43], v[42:43], v[58:59]
  v_pk_mul_f32 v[44:45], v[44:45], v[60:61]
  v_pk_mul_f32 v[46:47], v[46:47], v[62:63]
  v_pk_add_f32 v[12:13], v[12:13], v[144:145]
  v_pk_fma_f32 v[14:15], v[144:145], v[144:145], v[14:15]
  v_pk_add_f32 v[12:13], v[12:13], v[146:147]
  v_pk_fma_f32 v[14:15], v[146:147], v[146:147], v[14:15]
  v_pk_fma_f32 v[48:49], v[16:17], v[16:17], s[20:21] neg_lo:[1,0,1] neg_hi:[1,0,1]
  v_pk_fma_f32 v[50:51], v[18:19], v[18:19], s[20:21] neg_lo:[1,0,1] neg_hi:[1,0,1]
  v_pk_fma_f32 v[52:53], v[20:21], v[20:21], s[20:21] neg_lo:[1,0,1] neg_hi:[1,0,1]
  v_pk_fma_f32 v[54:55], v[22:23], v[22:23], s[20:21] neg_lo:[1,0,1] neg_hi:[1,0,1]
  v_pk_fma_f32 v[56:57], v[24:25], v[24:25], s[20:21] neg_lo:[1,0,1] neg_hi:[1,0,1]
  v_pk_fma_f32 v[58:59], v[26:27], v[26:27], s[20:21] neg_lo:[1,0,1] neg_hi:[1,0,1]
  v_pk_fma_f32 v[60:61], v[28:29], v[28:29], s[20:21] neg_lo:[1,0,1] neg_hi:[1,0,1]
  v_pk_fma_f32 v[62:63], v[30:31], v[30:31], s[20:21] neg_lo:[1,0,1] neg_hi:[1,0,1]
  v_pk_mul_f32 v[48:49], v[16:17], v[48:49]
  v_pk_mul_f32 v[50:51], v[18:19], v[50:51]
  v_pk_mul_f32 v[52:53], v[20:21], v[52:53]
  v_pk_mul_f32 v[54:55], v[22:23], v[54:55]
  v_pk_mul_f32 v[56:57], v[24:25], v[56:57]
  v_pk_mul_f32 v[58:59], v[26:27], v[58:59]
  v_pk_mul_f32 v[60:61], v[28:29], v[60:61]
  v_pk_mul_f32 v[62:63], v[30:31], v[62:63]
  v_mfma_f32_16x16x32_bf16 v[148:151], v[216:219], v[220:223], 0
  v_cvt_pk_bf16_f32 v184, v32, v33
  v_cvt_pk_bf16_f32 v185, v34, v35
  v_mfma_f32_16x16x32_bf16 v[148:151], v[224:227], v[228:231], v[148:151]
  v_cvt_pk_bf16_f32 v186, v36, v37
  v_cvt_pk_bf16_f32 v187, v38, v39
  v_mfma_f32_16x16x32_bf16 v[148:151], v[232:235], v[236:239], v[148:151]
  ds_read_b128 v[216:219], v3 offset:4000
  ds_read_b128 v[220:223], v4 offset:160
  v_mfma_f32_32x32x16_bf16 v[64:79], v[192:195], v[184:187], v[64:79]
  ds_read_b128 v[224:227], v3 offset:8800
  ds_read_b128 v[228:231], v4 offset:352
  v_cvt_pk_bf16_f32 v188, v40, v41
  v_cvt_pk_bf16_f32 v189, v42, v43
  v_cvt_pk_bf16_f32 v190, v44, v45
  v_cvt_pk_bf16_f32 v191, v46, v47
  v_mfma_f32_32x32x16_bf16 v[80:95], v[196:199], v[184:187], v[80:95]
  ds_read_b128 v[232:235], v3 offset:13600
  ds_read_b128 v[236:239], v4 offset:544
  v_exp_f32 v48, v48
  v_exp_f32 v49, v49
  v_mfma_f32_32x32x16_bf16 v[96:111], v[200:203], v[184:187], v[96:111]
  v_exp_f32 v50, v50
  v_exp_f32 v51, v51
  v_exp_f32_e64 v52, v52
  v_mfma_f32_32x32x16_bf16 v[64:79], v[204:207], v[188:191], v[64:79]
  v_exp_f32 v53, v53
  v_exp_f32 v54, v54
  v_exp_f32_e64 v55, v55
  v_mfma_f32_32x32x16_bf16 v[80:95], v[208:211], v[188:191], v[80:95]
  v_exp_f32 v56, v56
  v_exp_f32 v57, v57
  v_exp_f32_e64 v58, v58
  v_mfma_f32_32x32x16_bf16 v[96:111], v[212:215], v[188:191], v[96:111]
  s_waitcnt lgkmcnt(0)
  v_exp_f32 v59, v59
  v_exp_f32 v60, v60
  v_exp_f32 v61, v61
  v_exp_f32 v62, v62
  v_exp_f32 v63, v63
  v_pk_add_f32 v[12:13], v[12:13], v[148:149]
  v_pk_fma_f32 v[14:15], v[148:149], v[148:149], v[14:15]
  v_pk_add_f32 v[12:13], v[12:13], v[150:151]
  v_pk_fma_f32 v[14:15], v[150:151], v[150:151], v[14:15]
  v_pk_fma_f32 v[48:49], v[48:49], s[22:23], s[22:23]
  v_pk_fma_f32 v[50:51], v[50:51], s[22:23], s[22:23]
  v_pk_fma_f32 v[52:53], v[52:53], s[22:23], s[22:23]
  v_pk_fma_f32 v[54:55], v[54:55], s[22:23], s[22:23]
  v_pk_fma_f32 v[56:57], v[56:57], s[22:23], s[22:23]
  v_pk_fma_f32 v[58:59], v[58:59], s[22:23], s[22:23]
  v_pk_fma_f32 v[60:61], v[60:61], s[22:23], s[22:23]
  v_pk_fma_f32 v[62:63], v[62:63], s[22:23], s[22:23]
  v_mfma_f32_32x32x16_bf16 v[32:47], a[144:147], v[160:163], 0
  ds_read_b128 v[192:195], v0 offset:36864
  ds_read_b128 v[196:199], v0 offset:37888
  v_rcp_f32 v48, v48
  v_rcp_f32 v49, v49
  v_mfma_f32_16x16x32_bf16 v[152:155], v[216:219], v[220:223], 0
  ds_read_b128 v[216:219], v3 offset:4400
  ds_read_b128 v[220:223], v4 offset:176
  v_mfma_f32_32x32x16_bf16 v[32:47], a[148:151], v[164:167], v[32:47]
  ds_read_b128 v[200:203], v0 offset:38912
  ds_read_b128 v[204:207], v0 offset:39936
  v_rcp_f32 v50, v50
  v_rcp_f32 v51, v51
  v_mfma_f32_16x16x32_bf16 v[152:155], v[224:227], v[228:231], v[152:155]
  ds_read_b128 v[224:227], v3 offset:9200
  ds_read_b128 v[228:231], v4 offset:368
  v_mfma_f32_32x32x16_bf16 v[32:47], a[152:155], v[168:171], v[32:47]
  ds_read_b128 v[208:211], v0 offset:40960
  ds_read_b128 v[212:215], v0 offset:41984
  v_rcp_f32 v52, v52
  v_rcp_f32 v53, v53
  v_mfma_f32_16x16x32_bf16 v[152:155], v[232:235], v[236:239], v[152:155]
  ds_read_b128 v[232:235], v3 offset:14000
  ds_read_b128 v[236:239], v4 offset:560
  v_mfma_f32_32x32x16_bf16 v[32:47], a[156:159], v[172:175], v[32:47]
  v_rcp_f32 v54, v54
  v_rcp_f32 v55, v55
  v_rcp_f32_e64 v56, v56
  v_mfma_f32_32x32x16_bf16 v[32:47], a[160:163], v[176:179], v[32:47]
  v_rcp_f32 v57, v57
  v_rcp_f32 v58, v58
  v_rcp_f32_e64 v59, v59
  v_mfma_f32_32x32x16_bf16 v[32:47], a[164:167], v[180:183], v[32:47]
  s_waitcnt lgkmcnt(0)
  v_rcp_f32 v60, v60
  v_rcp_f32 v61, v61
  v_rcp_f32 v62, v62
  v_rcp_f32_e64 v63, v63
  v_pk_mul_f32 v[16:17], v[16:17], v[48:49]
  v_pk_mul_f32 v[18:19], v[18:19], v[50:51]
  v_pk_mul_f32 v[20:21], v[20:21], v[52:53]
  v_pk_mul_f32 v[22:23], v[22:23], v[54:55]
  v_pk_mul_f32 v[24:25], v[24:25], v[56:57]
  v_pk_mul_f32 v[26:27], v[26:27], v[58:59]
  v_pk_mul_f32 v[28:29], v[28:29], v[60:61]
  v_pk_mul_f32 v[30:31], v[30:31], v[62:63]
  v_pk_add_f32 v[12:13], v[12:13], v[152:153]
  v_pk_fma_f32 v[14:15], v[152:153], v[152:153], v[14:15]
  v_pk_add_f32 v[12:13], v[12:13], v[154:155]
  v_pk_fma_f32 v[14:15], v[154:155], v[154:155], v[14:15]
  v_pk_fma_f32 v[48:49], v[32:33], v[32:33], s[20:21] neg_lo:[1,0,1] neg_hi:[1,0,1]
  v_pk_fma_f32 v[50:51], v[34:35], v[34:35], s[20:21] neg_lo:[1,0,1] neg_hi:[1,0,1]
  v_pk_fma_f32 v[52:53], v[36:37], v[36:37], s[20:21] neg_lo:[1,0,1] neg_hi:[1,0,1]
  v_pk_fma_f32 v[54:55], v[38:39], v[38:39], s[20:21] neg_lo:[1,0,1] neg_hi:[1,0,1]
  v_pk_fma_f32 v[56:57], v[40:41], v[40:41], s[20:21] neg_lo:[1,0,1] neg_hi:[1,0,1]
  v_pk_fma_f32 v[58:59], v[42:43], v[42:43], s[20:21] neg_lo:[1,0,1] neg_hi:[1,0,1]
  v_pk_fma_f32 v[60:61], v[44:45], v[44:45], s[20:21] neg_lo:[1,0,1] neg_hi:[1,0,1]
  v_pk_fma_f32 v[62:63], v[46:47], v[46:47], s[20:21] neg_lo:[1,0,1] neg_hi:[1,0,1]
  v_pk_mul_f32 v[48:49], v[32:33], v[48:49]
  v_pk_mul_f32 v[50:51], v[34:35], v[50:51]
  v_pk_mul_f32 v[52:53], v[36:37], v[52:53]
  v_pk_mul_f32 v[54:55], v[38:39], v[54:55]
  v_pk_mul_f32 v[56:57], v[40:41], v[56:57]
  v_pk_mul_f32 v[58:59], v[42:43], v[58:59]
  v_pk_mul_f32 v[60:61], v[44:45], v[60:61]
  v_pk_mul_f32 v[62:63], v[46:47], v[62:63]
  v_mfma_f32_16x16x32_bf16 v[156:159], v[216:219], v[220:223], 0
  v_cvt_pk_bf16_f32 v184, v16, v17
  v_cvt_pk_bf16_f32 v185, v18, v19
  v_mfma_f32_16x16x32_bf16 v[156:159], v[224:227], v[228:231], v[156:159]
  v_cvt_pk_bf16_f32 v186, v20, v21
  v_cvt_pk_bf16_f32 v187, v22, v23
  v_mfma_f32_16x16x32_bf16 v[156:159], v[232:235], v[236:239], v[156:159]
  ds_read_b128 v[216:219], v3
  ds_read_b128 v[220:223], v4
  v_mfma_f32_32x32x16_bf16 v[64:79], v[192:195], v[184:187], v[64:79]
  ds_read_b128 v[224:227], v3 offset:4800
  ds_read_b128 v[228:231], v4 offset:192
  v_cvt_pk_bf16_f32 v188, v24, v25
  v_cvt_pk_bf16_f32 v189, v26, v27
  v_cvt_pk_bf16_f32 v190, v28, v29
  v_cvt_pk_bf16_f32 v191, v30, v31
  v_mfma_f32_32x32x16_bf16 v[80:95], v[196:199], v[184:187], v[80:95]
  ds_read_b128 v[232:235], v3 offset:9600
  ds_read_b128 v[236:239], v4 offset:384
  v_exp_f32 v48, v48
  v_exp_f32 v49, v49
  v_mfma_f32_32x32x16_bf16 v[96:111], v[200:203], v[184:187], v[96:111]
  v_exp_f32 v50, v50
  v_exp_f32 v51, v51
  v_exp_f32_e64 v52, v52
  v_mfma_f32_32x32x16_bf16 v[64:79], v[204:207], v[188:191], v[64:79]
  v_exp_f32 v53, v53
  v_exp_f32 v54, v54
  v_exp_f32_e64 v55, v55
  v_mfma_f32_32x32x16_bf16 v[80:95], v[208:211], v[188:191], v[80:95]
  v_exp_f32 v56, v56
  v_exp_f32 v57, v57
  v_exp_f32_e64 v58, v58
  v_mfma_f32_32x32x16_bf16 v[96:111], v[212:215], v[188:191], v[96:111]
  s_waitcnt lgkmcnt(0)
  v_exp_f32 v59, v59
  v_exp_f32 v60, v60
  v_exp_f32 v61, v61
  v_exp_f32 v62, v62
  v_exp_f32 v63, v63
  v_pk_add_f32 v[12:13], v[12:13], v[156:157]
  v_pk_fma_f32 v[14:15], v[156:157], v[156:157], v[14:15]
  v_pk_add_f32 v[12:13], v[12:13], v[158:159]
  v_pk_fma_f32 v[14:15], v[158:159], v[158:159], v[14:15]
  v_pk_fma_f32 v[48:49], v[48:49], s[22:23], s[22:23]
  v_pk_fma_f32 v[50:51], v[50:51], s[22:23], s[22:23]
  v_pk_fma_f32 v[52:53], v[52:53], s[22:23], s[22:23]
  v_pk_fma_f32 v[54:55], v[54:55], s[22:23], s[22:23]
  v_pk_fma_f32 v[56:57], v[56:57], s[22:23], s[22:23]
  v_pk_fma_f32 v[58:59], v[58:59], s[22:23], s[22:23]
  v_pk_fma_f32 v[60:61], v[60:61], s[22:23], s[22:23]
  v_pk_fma_f32 v[62:63], v[62:63], s[22:23], s[22:23]
  v_mfma_f32_32x32x16_bf16 v[16:31], a[168:171], v[160:163], 0
  ds_read_b128 v[192:195], v0 offset:43008
  ds_read_b128 v[196:199], v0 offset:44032
  v_rcp_f32 v48, v48
  v_rcp_f32 v49, v49
  v_mfma_f32_16x16x32_bf16 v[112:115], v[216:219], v[220:223], 0
  ds_read_b128 v[216:219], v3 offset:400
  ds_read_b128 v[220:223], v4 offset:16
  v_mfma_f32_32x32x16_bf16 v[16:31], a[172:175], v[164:167], v[16:31]
  ds_read_b128 v[200:203], v0 offset:45056
  ds_read_b128 v[204:207], v0 offset:46080
  v_rcp_f32 v50, v50
  v_rcp_f32 v51, v51
  v_mfma_f32_16x16x32_bf16 v[112:115], v[224:227], v[228:231], v[112:115]
  ds_read_b128 v[224:227], v3 offset:5200
  ds_read_b128 v[228:231], v4 offset:208
  v_mfma_f32_32x32x16_bf16 v[16:31], a[176:179], v[168:171], v[16:31]
  ds_read_b128 v[208:211], v0 offset:47104
  ds_read_b128 v[212:215], v0 offset:48128
  v_rcp_f32 v52, v52
  v_rcp_f32 v53, v53
  v_mfma_f32_16x16x32_bf16 v[112:115], v[232:235], v[236:239], v[112:115]
  ds_read_b128 v[232:235], v3 offset:10000
  ds_read_b128 v[236:239], v4 offset:400
  v_mfma_f32_32x32x16_bf16 v[16:31], a[180:183], v[172:175], v[16:31]
  buffer_store_dwordx4 v[128:131], v10, s[8:11], s28 offen offset:128
  v_rcp_f32 v54, v54
  v_rcp_f32 v55, v55
  v_mfma_f32_32x32x16_bf16 v[16:31], a[184:187], v[176:179], v[16:31]
  v_rcp_f32 v56, v56
  v_rcp_f32 v57, v57
  v_rcp_f32_e64 v58, v58
  v_mfma_f32_32x32x16_bf16 v[16:31], a[188:191], v[180:183], v[16:31]
  s_waitcnt lgkmcnt(0)
  v_rcp_f32 v59, v59
  v_rcp_f32 v60, v60
  v_rcp_f32 v61, v61
  v_rcp_f32 v62, v62
  v_rcp_f32 v63, v63
  v_pk_mul_f32 v[32:33], v[32:33], v[48:49]
  v_pk_mul_f32 v[34:35], v[34:35], v[50:51]
  v_pk_mul_f32 v[36:37], v[36:37], v[52:53]
  v_pk_mul_f32 v[38:39], v[38:39], v[54:55]
  v_pk_mul_f32 v[40:41], v[40:41], v[56:57]
  v_pk_mul_f32 v[42:43], v[42:43], v[58:59]
  v_pk_mul_f32 v[44:45], v[44:45], v[60:61]
  v_pk_mul_f32 v[46:47], v[46:47], v[62:63]
  v_pk_add_f32 v[12:13], v[12:13], v[112:113]
  v_pk_fma_f32 v[14:15], v[112:113], v[112:113], v[14:15]
  v_pk_add_f32 v[12:13], v[12:13], v[114:115]
  v_pk_fma_f32 v[14:15], v[114:115], v[114:115], v[14:15]
  v_pk_fma_f32 v[48:49], v[16:17], v[16:17], s[20:21] neg_lo:[1,0,1] neg_hi:[1,0,1]
  v_pk_fma_f32 v[50:51], v[18:19], v[18:19], s[20:21] neg_lo:[1,0,1] neg_hi:[1,0,1]
  v_pk_fma_f32 v[52:53], v[20:21], v[20:21], s[20:21] neg_lo:[1,0,1] neg_hi:[1,0,1]
  v_pk_fma_f32 v[54:55], v[22:23], v[22:23], s[20:21] neg_lo:[1,0,1] neg_hi:[1,0,1]
  v_pk_fma_f32 v[56:57], v[24:25], v[24:25], s[20:21] neg_lo:[1,0,1] neg_hi:[1,0,1]
  v_pk_fma_f32 v[58:59], v[26:27], v[26:27], s[20:21] neg_lo:[1,0,1] neg_hi:[1,0,1]
  v_pk_fma_f32 v[60:61], v[28:29], v[28:29], s[20:21] neg_lo:[1,0,1] neg_hi:[1,0,1]
  v_pk_fma_f32 v[62:63], v[30:31], v[30:31], s[20:21] neg_lo:[1,0,1] neg_hi:[1,0,1]
  v_pk_mul_f32 v[48:49], v[16:17], v[48:49]
  v_pk_mul_f32 v[50:51], v[18:19], v[50:51]
  v_pk_mul_f32 v[52:53], v[20:21], v[52:53]
  v_pk_mul_f32 v[54:55], v[22:23], v[54:55]
  v_pk_mul_f32 v[56:57], v[24:25], v[56:57]
  v_pk_mul_f32 v[58:59], v[26:27], v[58:59]
  v_pk_mul_f32 v[60:61], v[28:29], v[60:61]
  v_pk_mul_f32 v[62:63], v[30:31], v[62:63]
  v_mfma_f32_16x16x32_bf16 v[116:119], v[216:219], v[220:223], 0
  v_cvt_pk_bf16_f32 v184, v32, v33
  v_cvt_pk_bf16_f32 v185, v34, v35
  v_mfma_f32_16x16x32_bf16 v[116:119], v[224:227], v[228:231], v[116:119]
  v_cvt_pk_bf16_f32 v186, v36, v37
  v_cvt_pk_bf16_f32 v187, v38, v39
  v_mfma_f32_16x16x32_bf16 v[116:119], v[232:235], v[236:239], v[116:119]
  ds_read_b128 v[216:219], v3 offset:800
  ds_read_b128 v[220:223], v4 offset:32
  v_mfma_f32_32x32x16_bf16 v[64:79], v[192:195], v[184:187], v[64:79]
  ds_read_b128 v[224:227], v3 offset:5600
  ds_read_b128 v[228:231], v4 offset:224
  v_cvt_pk_bf16_f32 v188, v40, v41
  v_cvt_pk_bf16_f32 v189, v42, v43
  v_cvt_pk_bf16_f32 v190, v44, v45
  v_cvt_pk_bf16_f32 v191, v46, v47
  v_mfma_f32_32x32x16_bf16 v[80:95], v[196:199], v[184:187], v[80:95]
  ds_read_b128 v[232:235], v3 offset:10400
  ds_read_b128 v[236:239], v4 offset:416
  v_exp_f32 v48, v48
  v_exp_f32 v49, v49
  v_mfma_f32_32x32x16_bf16 v[96:111], v[200:203], v[184:187], v[96:111]
  v_exp_f32 v50, v50
  v_exp_f32 v51, v51
  v_exp_f32_e64 v52, v52
  v_mfma_f32_32x32x16_bf16 v[64:79], v[204:207], v[188:191], v[64:79]
  v_exp_f32 v53, v53
  v_exp_f32 v54, v54
  v_exp_f32_e64 v55, v55
  v_mfma_f32_32x32x16_bf16 v[80:95], v[208:211], v[188:191], v[80:95]
  v_exp_f32 v56, v56
  v_exp_f32 v57, v57
  v_exp_f32_e64 v58, v58
  v_mfma_f32_32x32x16_bf16 v[96:111], v[212:215], v[188:191], v[96:111]
  s_waitcnt lgkmcnt(0)
  v_exp_f32 v59, v59
  v_exp_f32 v60, v60
  v_exp_f32 v61, v61
  v_exp_f32 v62, v62
  v_exp_f32 v63, v63
  v_pk_add_f32 v[12:13], v[12:13], v[116:117]
  v_pk_fma_f32 v[14:15], v[116:117], v[116:117], v[14:15]
  v_pk_add_f32 v[12:13], v[12:13], v[118:119]
  v_pk_fma_f32 v[14:15], v[118:119], v[118:119], v[14:15]
  v_pk_fma_f32 v[48:49], v[48:49], s[22:23], s[22:23]
  v_pk_fma_f32 v[50:51], v[50:51], s[22:23], s[22:23]
  v_pk_fma_f32 v[52:53], v[52:53], s[22:23], s[22:23]
  v_pk_fma_f32 v[54:55], v[54:55], s[22:23], s[22:23]
  v_pk_fma_f32 v[56:57], v[56:57], s[22:23], s[22:23]
  v_pk_fma_f32 v[58:59], v[58:59], s[22:23], s[22:23]
  v_pk_fma_f32 v[60:61], v[60:61], s[22:23], s[22:23]
  v_pk_fma_f32 v[62:63], v[62:63], s[22:23], s[22:23]
  v_mfma_f32_32x32x16_bf16 v[32:47], a[192:195], v[160:163], 0
  ds_read_b128 v[192:195], v0 offset:49152
  ds_read_b128 v[196:199], v0 offset:50176
  v_rcp_f32 v48, v48
  v_rcp_f32 v49, v49
  v_mfma_f32_16x16x32_bf16 v[120:123], v[216:219], v[220:223], 0
  ds_read_b128 v[216:219], v3 offset:1200
  ds_read_b128 v[220:223], v4 offset:48
  v_mfma_f32_32x32x16_bf16 v[32:47], a[196:199], v[164:167], v[32:47]
  ds_read_b128 v[200:203], v0 offset:51200
  ds_read_b128 v[204:207], v0 offset:52224
  v_rcp_f32 v50, v50
  v_rcp_f32 v51, v51
  v_mfma_f32_16x16x32_bf16 v[120:123], v[224:227], v[228:231], v[120:123]
  ds_read_b128 v[224:227], v3 offset:6000
  ds_read_b128 v[228:231], v4 offset:240
  v_mfma_f32_32x32x16_bf16 v[32:47], a[200:203], v[168:171], v[32:47]
  ds_read_b128 v[208:211], v0 offset:53248
  ds_read_b128 v[212:215], v0 offset:54272
  v_rcp_f32 v52, v52
  v_rcp_f32 v53, v53
  v_mfma_f32_16x16x32_bf16 v[120:123], v[232:235], v[236:239], v[120:123]
  ds_read_b128 v[232:235], v3 offset:10800
  ds_read_b128 v[236:239], v4 offset:432
  v_mfma_f32_32x32x16_bf16 v[32:47], a[204:207], v[172:175], v[32:47]
  buffer_store_dwordx4 v[132:135], v10, s[8:11], s28 offen offset:160
  v_rcp_f32 v54, v54
  v_rcp_f32 v55, v55
  v_mfma_f32_32x32x16_bf16 v[32:47], a[208:211], v[176:179], v[32:47]
  v_rcp_f32 v56, v56
  v_rcp_f32 v57, v57
  v_rcp_f32_e64 v58, v58
  v_mfma_f32_32x32x16_bf16 v[32:47], a[212:215], v[180:183], v[32:47]
  s_waitcnt lgkmcnt(0)
  v_rcp_f32 v59, v59
  v_rcp_f32 v60, v60
  v_rcp_f32 v61, v61
  v_rcp_f32 v62, v62
  v_rcp_f32 v63, v63
  v_pk_mul_f32 v[16:17], v[16:17], v[48:49]
  v_pk_mul_f32 v[18:19], v[18:19], v[50:51]
  v_pk_mul_f32 v[20:21], v[20:21], v[52:53]
  v_pk_mul_f32 v[22:23], v[22:23], v[54:55]
  v_pk_mul_f32 v[24:25], v[24:25], v[56:57]
  v_pk_mul_f32 v[26:27], v[26:27], v[58:59]
  v_pk_mul_f32 v[28:29], v[28:29], v[60:61]
  v_pk_mul_f32 v[30:31], v[30:31], v[62:63]
  v_pk_add_f32 v[12:13], v[12:13], v[120:121]
  v_pk_fma_f32 v[14:15], v[120:121], v[120:121], v[14:15]
  v_pk_add_f32 v[12:13], v[12:13], v[122:123]
  v_pk_fma_f32 v[14:15], v[122:123], v[122:123], v[14:15]
  v_pk_fma_f32 v[48:49], v[32:33], v[32:33], s[20:21] neg_lo:[1,0,1] neg_hi:[1,0,1]
  v_pk_fma_f32 v[50:51], v[34:35], v[34:35], s[20:21] neg_lo:[1,0,1] neg_hi:[1,0,1]
  v_pk_fma_f32 v[52:53], v[36:37], v[36:37], s[20:21] neg_lo:[1,0,1] neg_hi:[1,0,1]
  v_pk_fma_f32 v[54:55], v[38:39], v[38:39], s[20:21] neg_lo:[1,0,1] neg_hi:[1,0,1]
  v_pk_fma_f32 v[56:57], v[40:41], v[40:41], s[20:21] neg_lo:[1,0,1] neg_hi:[1,0,1]
  v_pk_fma_f32 v[58:59], v[42:43], v[42:43], s[20:21] neg_lo:[1,0,1] neg_hi:[1,0,1]
  v_pk_fma_f32 v[60:61], v[44:45], v[44:45], s[20:21] neg_lo:[1,0,1] neg_hi:[1,0,1]
  v_pk_fma_f32 v[62:63], v[46:47], v[46:47], s[20:21] neg_lo:[1,0,1] neg_hi:[1,0,1]
  v_pk_mul_f32 v[48:49], v[32:33], v[48:49]
  v_pk_mul_f32 v[50:51], v[34:35], v[50:51]
  v_pk_mul_f32 v[52:53], v[36:37], v[52:53]
  v_pk_mul_f32 v[54:55], v[38:39], v[54:55]
  v_pk_mul_f32 v[56:57], v[40:41], v[56:57]
  v_pk_mul_f32 v[58:59], v[42:43], v[58:59]
  v_pk_mul_f32 v[60:61], v[44:45], v[60:61]
  v_pk_mul_f32 v[62:63], v[46:47], v[62:63]
  v_mfma_f32_16x16x32_bf16 v[124:127], v[216:219], v[220:223], 0
  v_cvt_pk_bf16_f32 v184, v16, v17
  v_cvt_pk_bf16_f32 v185, v18, v19
  v_mfma_f32_16x16x32_bf16 v[124:127], v[224:227], v[228:231], v[124:127]
  v_cvt_pk_bf16_f32 v186, v20, v21
  v_cvt_pk_bf16_f32 v187, v22, v23
  v_mfma_f32_16x16x32_bf16 v[124:127], v[232:235], v[236:239], v[124:127]
  ds_read_b128 v[216:219], v3 offset:1600
  ds_read_b128 v[220:223], v4 offset:64
  v_mfma_f32_32x32x16_bf16 v[64:79], v[192:195], v[184:187], v[64:79]
  ds_read_b128 v[224:227], v3 offset:6400
  ds_read_b128 v[228:231], v4 offset:256
  v_cvt_pk_bf16_f32 v188, v24, v25
  v_cvt_pk_bf16_f32 v189, v26, v27
  v_cvt_pk_bf16_f32 v190, v28, v29
  v_cvt_pk_bf16_f32 v191, v30, v31
  v_mfma_f32_32x32x16_bf16 v[80:95], v[196:199], v[184:187], v[80:95]
  ds_read_b128 v[232:235], v3 offset:11200
  ds_read_b128 v[236:239], v4 offset:448
  v_exp_f32 v48, v48
  v_exp_f32 v49, v49
  v_mfma_f32_32x32x16_bf16 v[96:111], v[200:203], v[184:187], v[96:111]
  v_exp_f32 v50, v50
  v_exp_f32 v51, v51
  v_exp_f32_e64 v52, v52
  v_mfma_f32_32x32x16_bf16 v[64:79], v[204:207], v[188:191], v[64:79]
  v_exp_f32 v53, v53
  v_exp_f32 v54, v54
  v_exp_f32_e64 v55, v55
  v_mfma_f32_32x32x16_bf16 v[80:95], v[208:211], v[188:191], v[80:95]
  v_exp_f32 v56, v56
  v_exp_f32 v57, v57
  v_exp_f32_e64 v58, v58
  v_mfma_f32_32x32x16_bf16 v[96:111], v[212:215], v[188:191], v[96:111]
  s_waitcnt lgkmcnt(0)
  v_exp_f32 v59, v59
  v_exp_f32 v60, v60
  v_exp_f32 v61, v61
  v_exp_f32 v62, v62
  v_exp_f32 v63, v63
  v_pk_add_f32 v[12:13], v[12:13], v[124:125]
  v_pk_fma_f32 v[14:15], v[124:125], v[124:125], v[14:15]
  v_pk_add_f32 v[12:13], v[12:13], v[126:127]
  v_pk_fma_f32 v[14:15], v[126:127], v[126:127], v[14:15]
  v_pk_fma_f32 v[48:49], v[48:49], s[22:23], s[22:23]
  v_pk_fma_f32 v[50:51], v[50:51], s[22:23], s[22:23]
  v_pk_fma_f32 v[52:53], v[52:53], s[22:23], s[22:23]
  v_pk_fma_f32 v[54:55], v[54:55], s[22:23], s[22:23]
  v_pk_fma_f32 v[56:57], v[56:57], s[22:23], s[22:23]
  v_pk_fma_f32 v[58:59], v[58:59], s[22:23], s[22:23]
  v_pk_fma_f32 v[60:61], v[60:61], s[22:23], s[22:23]
  v_pk_fma_f32 v[62:63], v[62:63], s[22:23], s[22:23]
  v_mfma_f32_32x32x16_bf16 v[16:31], a[216:219], v[160:163], 0
  ds_read_b128 v[192:195], v0 offset:55296
  ds_read_b128 v[196:199], v0 offset:56320
  v_rcp_f32 v48, v48
  v_rcp_f32 v49, v49
  v_mfma_f32_16x16x32_bf16 v[128:131], v[216:219], v[220:223], 0
  ds_read_b128 v[216:219], v3 offset:2000
  ds_read_b128 v[220:223], v4 offset:80
  v_mfma_f32_32x32x16_bf16 v[16:31], a[220:223], v[164:167], v[16:31]
  ds_read_b128 v[200:203], v0 offset:57344
  ds_read_b128 v[204:207], v0 offset:58368
  v_rcp_f32 v50, v50
  v_rcp_f32 v51, v51
  v_mfma_f32_16x16x32_bf16 v[128:131], v[224:227], v[228:231], v[128:131]
  ds_read_b128 v[224:227], v3 offset:6800
  ds_read_b128 v[228:231], v4 offset:272
  v_mfma_f32_32x32x16_bf16 v[16:31], a[224:227], v[168:171], v[16:31]
  ds_read_b128 v[208:211], v0 offset:59392
  ds_read_b128 v[212:215], v0 offset:60416
  v_rcp_f32 v52, v52
  v_rcp_f32 v53, v53
  v_mfma_f32_16x16x32_bf16 v[128:131], v[232:235], v[236:239], v[128:131]
  ds_read_b128 v[232:235], v3 offset:11600
  ds_read_b128 v[236:239], v4 offset:464
  v_mfma_f32_32x32x16_bf16 v[16:31], a[228:231], v[172:175], v[16:31]
  v_rcp_f32 v54, v54
  v_rcp_f32 v55, v55
  v_rcp_f32_e64 v56, v56
  v_mfma_f32_32x32x16_bf16 v[16:31], a[232:235], v[176:179], v[16:31]
  v_rcp_f32 v57, v57
  v_rcp_f32 v58, v58
  v_rcp_f32_e64 v59, v59
  v_mfma_f32_32x32x16_bf16 v[16:31], a[236:239], v[180:183], v[16:31]
  s_waitcnt lgkmcnt(0)
  v_rcp_f32 v60, v60
  v_rcp_f32 v61, v61
  v_rcp_f32 v62, v62
  v_rcp_f32_e64 v63, v63
  v_pk_mul_f32 v[32:33], v[32:33], v[48:49]
  v_pk_mul_f32 v[34:35], v[34:35], v[50:51]
  v_pk_mul_f32 v[36:37], v[36:37], v[52:53]
  v_pk_mul_f32 v[38:39], v[38:39], v[54:55]
  v_pk_mul_f32 v[40:41], v[40:41], v[56:57]
  v_pk_mul_f32 v[42:43], v[42:43], v[58:59]
  v_pk_mul_f32 v[44:45], v[44:45], v[60:61]
  v_pk_mul_f32 v[46:47], v[46:47], v[62:63]
  v_pk_add_f32 v[12:13], v[12:13], v[128:129]
  v_pk_fma_f32 v[14:15], v[128:129], v[128:129], v[14:15]
  v_pk_add_f32 v[12:13], v[12:13], v[130:131]
  v_pk_fma_f32 v[14:15], v[130:131], v[130:131], v[14:15]
  v_pk_fma_f32 v[48:49], v[16:17], v[16:17], s[20:21] neg_lo:[1,0,1] neg_hi:[1,0,1]
  v_pk_fma_f32 v[50:51], v[18:19], v[18:19], s[20:21] neg_lo:[1,0,1] neg_hi:[1,0,1]
  v_pk_fma_f32 v[52:53], v[20:21], v[20:21], s[20:21] neg_lo:[1,0,1] neg_hi:[1,0,1]
  v_pk_fma_f32 v[54:55], v[22:23], v[22:23], s[20:21] neg_lo:[1,0,1] neg_hi:[1,0,1]
  v_pk_fma_f32 v[56:57], v[24:25], v[24:25], s[20:21] neg_lo:[1,0,1] neg_hi:[1,0,1]
  v_pk_fma_f32 v[58:59], v[26:27], v[26:27], s[20:21] neg_lo:[1,0,1] neg_hi:[1,0,1]
  v_pk_fma_f32 v[60:61], v[28:29], v[28:29], s[20:21] neg_lo:[1,0,1] neg_hi:[1,0,1]
  v_pk_fma_f32 v[62:63], v[30:31], v[30:31], s[20:21] neg_lo:[1,0,1] neg_hi:[1,0,1]
  v_pk_mul_f32 v[48:49], v[16:17], v[48:49]
  v_pk_mul_f32 v[50:51], v[18:19], v[50:51]
  v_pk_mul_f32 v[52:53], v[20:21], v[52:53]
  v_pk_mul_f32 v[54:55], v[22:23], v[54:55]
  v_pk_mul_f32 v[56:57], v[24:25], v[56:57]
  v_pk_mul_f32 v[58:59], v[26:27], v[58:59]
  v_pk_mul_f32 v[60:61], v[28:29], v[60:61]
  v_pk_mul_f32 v[62:63], v[30:31], v[62:63]
  v_mfma_f32_16x16x32_bf16 v[132:135], v[216:219], v[220:223], 0
  v_cvt_pk_bf16_f32 v184, v32, v33
  v_cvt_pk_bf16_f32 v185, v34, v35
  v_mfma_f32_16x16x32_bf16 v[132:135], v[224:227], v[228:231], v[132:135]
  v_cvt_pk_bf16_f32 v186, v36, v37
  v_cvt_pk_bf16_f32 v187, v38, v39
  v_mfma_f32_16x16x32_bf16 v[132:135], v[232:235], v[236:239], v[132:135]
  ds_read_b128 v[216:219], v0 offset:12288
  ds_read_b128 v[220:223], v0 offset:13312
  v_mfma_f32_32x32x16_bf16 v[64:79], v[192:195], v[184:187], v[64:79]
  ds_read_b128 v[224:227], v0 offset:14336
  ds_read_b128 v[228:231], v0 offset:15360
  v_cvt_pk_bf16_f32 v188, v40, v41
  v_cvt_pk_bf16_f32 v189, v42, v43
  v_cvt_pk_bf16_f32 v190, v44, v45
  v_cvt_pk_bf16_f32 v191, v46, v47
  v_mfma_f32_32x32x16_bf16 v[80:95], v[196:199], v[184:187], v[80:95]
  ds_read_b128 v[232:235], v0 offset:16384
  ds_read_b128 v[236:239], v0 offset:17408
  v_exp_f32 v48, v48
  v_exp_f32 v49, v49
  v_mfma_f32_32x32x16_bf16 v[96:111], v[200:203], v[184:187], v[96:111]
  v_exp_f32 v50, v50
  v_exp_f32 v51, v51
  v_exp_f32_e64 v52, v52
  v_mfma_f32_32x32x16_bf16 v[64:79], v[204:207], v[188:191], v[64:79]
  s_mov_b32 s28, s34
  v_exp_f32 v53, v53
  v_exp_f32 v54, v54
  v_exp_f32 v55, v55
  v_mfma_f32_32x32x16_bf16 v[80:95], v[208:211], v[188:191], v[80:95]
  s_add_u32 s34, s34, 0x60000
  v_exp_f32 v56, v56
  v_exp_f32 v57, v57
  v_exp_f32_e64 v58, v58
  v_mfma_f32_32x32x16_bf16 v[96:111], v[212:215], v[188:191], v[96:111]
  s_waitcnt lgkmcnt(0)
  v_exp_f32 v59, v59
  v_exp_f32 v60, v60
  v_exp_f32 v61, v61
  v_exp_f32 v62, v62
  v_exp_f32 v63, v63
  v_pk_add_f32 v[12:13], v[12:13], v[132:133]
  v_pk_fma_f32 v[14:15], v[132:133], v[132:133], v[14:15]
  v_pk_add_f32 v[12:13], v[12:13], v[134:135]
  v_pk_fma_f32 v[14:15], v[134:135], v[134:135], v[14:15]
  v_pk_fma_f32 v[48:49], v[48:49], s[22:23], s[22:23]
  v_pk_fma_f32 v[50:51], v[50:51], s[22:23], s[22:23]
  v_pk_fma_f32 v[52:53], v[52:53], s[22:23], s[22:23]
  v_pk_fma_f32 v[54:55], v[54:55], s[22:23], s[22:23]
  v_pk_fma_f32 v[56:57], v[56:57], s[22:23], s[22:23]
  v_pk_fma_f32 v[58:59], v[58:59], s[22:23], s[22:23]
  v_pk_fma_f32 v[60:61], v[60:61], s[22:23], s[22:23]
  v_pk_fma_f32 v[62:63], v[62:63], s[22:23], s[22:23]
  v_mfma_f32_32x32x16_bf16 v[32:47], v[216:219], v[160:163], 0
  ds_read_b128 v[192:195], v0 offset:61440
  ds_read_b128 v[196:199], v0 offset:62464
  v_rcp_f32 v48, v48
  v_rcp_f32 v49, v49
  v_add_f32_e64 v12, v12, v13
  v_mfma_f32_32x32x16_bf16 v[32:47], v[220:223], v[164:167], v[32:47]
  ds_read_b128 v[200:203], v0 offset:63488
  ds_read_b128 v[204:207], v0 offset:64512
  v_rcp_f32 v50, v50
  v_add_f32 v14, v14, v15
  v_rcp_f32_e64 v51, v51
  v_mfma_f32_32x32x16_bf16 v[32:47], v[224:227], v[168:171], v[32:47]
  ds_read_b128 v[208:211], v1
  ds_read_b128 v[212:215], v1 offset:1024
  v_permlane32_swap_b32 v12, v14
  v_rcp_f32 v52, v52
  v_add_f32 v12, v12, v14
  v_rcp_f32 v53, v53
  v_mfma_f32_32x32x16_bf16 v[32:47], v[228:231], v[172:175], v[32:47]
  v_mov_b32 v14, v12
  v_rcp_f32 v54, v54
  s_nop 0
  v_permlane32_swap_b32 v12, v14
  v_rcp_f32 v55, v55
  v_mul_f32 v12, s24, v12
  v_mfma_f32_32x32x16_bf16 v[32:47], v[232:235], v[176:179], v[32:47]
  v_rcp_f32 v56, v56
  v_rcp_f32 v57, v57
  v_mul_f32 v13, s24, v14
  v_rcp_f32 v58, v58
  v_fma_f32 v13, -v12, v12, v13
  v_mfma_f32_32x32x16_bf16 v[32:47], v[236:239], v[180:183], v[32:47]
  s_waitcnt lgkmcnt(0)
  v_rcp_f32 v59, v59
  v_max_f32 v13, 0, v13
  v_rcp_f32 v60, v60
  v_add_f32 v13, s25, v13
  v_rcp_f32 v61, v61
  v_rsq_f32 v13, v13
  v_rcp_f32 v62, v62
  v_mul_f32 v14, s22, v13
  v_rcp_f32 v63, v63
  v_mul_f32_e64 v12, -v12, v14
  v_pk_mul_f32 v[16:17], v[16:17], v[48:49]
  v_pk_mul_f32 v[18:19], v[18:19], v[50:51]
  v_pk_mul_f32 v[20:21], v[20:21], v[52:53]
  v_pk_mul_f32 v[22:23], v[22:23], v[54:55]
  v_pk_mul_f32 v[24:25], v[24:25], v[56:57]
  v_pk_mul_f32 v[26:27], v[26:27], v[58:59]
  v_pk_mul_f32 v[28:29], v[28:29], v[60:61]
  v_pk_mul_f32 v[30:31], v[30:31], v[62:63]
  v_pk_fma_f32 v[112:113], v[112:113], v[14:15], v[12:13] op_sel_hi:[1,0,0]
  v_pk_fma_f32 v[114:115], v[114:115], v[14:15], v[12:13] op_sel_hi:[1,0,0]
  v_pk_fma_f32 v[116:117], v[116:117], v[14:15], v[12:13] op_sel_hi:[1,0,0]
  v_pk_fma_f32 v[118:119], v[118:119], v[14:15], v[12:13] op_sel_hi:[1,0,0]
  v_pk_fma_f32 v[120:121], v[120:121], v[14:15], v[12:13] op_sel_hi:[1,0,0]
  v_pk_fma_f32 v[122:123], v[122:123], v[14:15], v[12:13] op_sel_hi:[1,0,0]
  v_pk_fma_f32 v[124:125], v[124:125], v[14:15], v[12:13] op_sel_hi:[1,0,0]
  v_pk_fma_f32 v[126:127], v[126:127], v[14:15], v[12:13] op_sel_hi:[1,0,0]
  v_pk_fma_f32 v[128:129], v[128:129], v[14:15], v[12:13] op_sel_hi:[1,0,0]
  v_pk_fma_f32 v[130:131], v[130:131], v[14:15], v[12:13] op_sel_hi:[1,0,0]
  v_pk_fma_f32 v[132:133], v[132:133], v[14:15], v[12:13] op_sel_hi:[1,0,0]
  v_pk_fma_f32 v[134:135], v[134:135], v[14:15], v[12:13] op_sel_hi:[1,0,0]
  v_pk_fma_f32 v[136:137], v[136:137], v[14:15], v[12:13] op_sel_hi:[1,0,0]
  v_pk_fma_f32 v[138:139], v[138:139], v[14:15], v[12:13] op_sel_hi:[1,0,0]
  v_pk_fma_f32 v[140:141], v[140:141], v[14:15], v[12:13] op_sel_hi:[1,0,0]
  v_pk_fma_f32 v[142:143], v[142:143], v[14:15], v[12:13] op_sel_hi:[1,0,0]
  v_pk_fma_f32 v[144:145], v[144:145], v[14:15], v[12:13] op_sel_hi:[1,0,0]
  v_pk_fma_f32 v[146:147], v[146:147], v[14:15], v[12:13] op_sel_hi:[1,0,0]
  v_pk_fma_f32 v[148:149], v[148:149], v[14:15], v[12:13] op_sel_hi:[1,0,0]
  v_pk_fma_f32 v[150:151], v[150:151], v[14:15], v[12:13] op_sel_hi:[1,0,0]
  v_pk_fma_f32 v[152:153], v[152:153], v[14:15], v[12:13] op_sel_hi:[1,0,0]
  v_pk_fma_f32 v[154:155], v[154:155], v[14:15], v[12:13] op_sel_hi:[1,0,0]
  v_pk_fma_f32 v[156:157], v[156:157], v[14:15], v[12:13] op_sel_hi:[1,0,0]
  v_pk_fma_f32 v[158:159], v[158:159], v[14:15], v[12:13] op_sel_hi:[1,0,0]
  v_pk_fma_f32 v[48:49], v[32:33], v[32:33], s[20:21] neg_lo:[1,0,1] neg_hi:[1,0,1]
  v_pk_fma_f32 v[50:51], v[34:35], v[34:35], s[20:21] neg_lo:[1,0,1] neg_hi:[1,0,1]
  v_pk_fma_f32 v[52:53], v[36:37], v[36:37], s[20:21] neg_lo:[1,0,1] neg_hi:[1,0,1]
  v_pk_fma_f32 v[54:55], v[38:39], v[38:39], s[20:21] neg_lo:[1,0,1] neg_hi:[1,0,1]
  v_pk_fma_f32 v[56:57], v[40:41], v[40:41], s[20:21] neg_lo:[1,0,1] neg_hi:[1,0,1]
  v_pk_fma_f32 v[58:59], v[42:43], v[42:43], s[20:21] neg_lo:[1,0,1] neg_hi:[1,0,1]
  v_pk_fma_f32 v[60:61], v[44:45], v[44:45], s[20:21] neg_lo:[1,0,1] neg_hi:[1,0,1]
  v_pk_fma_f32 v[62:63], v[46:47], v[46:47], s[20:21] neg_lo:[1,0,1] neg_hi:[1,0,1]
  v_pk_mul_f32 v[48:49], v[32:33], v[48:49]
  v_pk_mul_f32 v[50:51], v[34:35], v[50:51]
  v_pk_mul_f32 v[52:53], v[36:37], v[52:53]
  v_pk_mul_f32 v[54:55], v[38:39], v[54:55]
  v_pk_mul_f32 v[56:57], v[40:41], v[56:57]
  v_cvt_pk_bf16_f32 v184, v16, v17
  v_cvt_pk_bf16_f32 v185, v18, v19
  v_cvt_pk_bf16_f32 v186, v20, v21
  v_cvt_pk_bf16_f32 v187, v22, v23
  v_pk_mul_f32 v[58:59], v[42:43], v[58:59]
  v_pk_mul_f32 v[60:61], v[44:45], v[60:61]
  v_pk_mul_f32 v[62:63], v[46:47], v[62:63]
  v_mfma_f32_32x32x16_bf16 v[64:79], v[192:195], v[184:187], v[64:79]
  ds_read_b128 v[216:219], v0 offset:18432
  ds_read_b128 v[220:223], v0 offset:19456
  v_cvt_pk_bf16_f32 v188, v24, v25
  v_cvt_pk_bf16_f32 v189, v26, v27
  v_cvt_pk_bf16_f32 v190, v28, v29
  v_cvt_pk_bf16_f32 v191, v30, v31
  v_exp_f32_e64 v48, v48
  v_cndmask_b32 v159, v159, v250, s[12:13]
  v_mfma_f32_32x32x16_bf16 v[80:95], v[196:199], v[184:187], v[80:95]
  ds_read_b128 v[224:227], v0 offset:20480
  ds_read_b128 v[228:231], v0 offset:21504
  v_exp_f32_e64 v49, v49
  v_cvt_pk_bf16_f32 v160, v112, v113
  v_cvt_pk_bf16_f32 v161, v114, v115
  v_exp_f32_e64 v50, v50
  v_cvt_pk_bf16_f32 v162, v116, v117
  v_mfma_f32_32x32x16_bf16 v[96:111], v[200:203], v[184:187], v[96:111]
  ds_read_b128 v[232:235], v0 offset:22528
  ds_read_b128 v[236:239], v0 offset:23552
  v_exp_f32_e64 v51, v51
  v_cvt_pk_bf16_f32 v163, v118, v119
  v_cvt_pk_bf16_f32 v164, v120, v121
  v_exp_f32_e64 v52, v52
  v_cvt_pk_bf16_f32 v165, v122, v123
  v_mfma_f32_32x32x16_bf16 v[64:79], v[204:207], v[188:191], v[64:79]
  v_exp_f32_e64 v53, v53
  v_cvt_pk_bf16_f32 v166, v124, v125
  v_cvt_pk_bf16_f32 v167, v126, v127
  v_exp_f32_e64 v54, v54
  v_cvt_pk_bf16_f32 v168, v128, v129
  v_exp_f32_e64 v55, v55
  v_cvt_pk_bf16_f32 v169, v130, v131
  v_cvt_pk_bf16_f32 v170, v132, v133
  v_mfma_f32_32x32x16_bf16 v[80:95], v[208:211], v[188:191], v[80:95]
  v_exp_f32_e64 v56, v56
  v_cvt_pk_bf16_f32 v171, v134, v135
  v_cvt_pk_bf16_f32 v172, v136, v137
  v_exp_f32_e64 v57, v57
  v_cvt_pk_bf16_f32 v173, v138, v139
  v_exp_f32_e64 v58, v58
  v_cvt_pk_bf16_f32 v174, v140, v141
  v_cvt_pk_bf16_f32 v175, v142, v143
  v_mfma_f32_32x32x16_bf16 v[96:111], v[212:215], v[188:191], v[96:111]
  s_waitcnt lgkmcnt(0)
  v_exp_f32 v59, v59
  v_cvt_pk_bf16_f32 v176, v144, v145
  v_exp_f32_e64 v60, v60
  v_cvt_pk_bf16_f32 v177, v146, v147
  v_cvt_pk_bf16_f32 v178, v148, v149
  v_exp_f32_e64 v61, v61
  v_cvt_pk_bf16_f32 v179, v150, v151
  v_exp_f32_e64 v62, v62
  v_cvt_pk_bf16_f32 v180, v152, v153
  v_cvt_pk_bf16_f32 v181, v154, v155
  v_exp_f32_e64 v63, v63
  v_cvt_pk_bf16_f32 v182, v156, v157
  v_cvt_pk_bf16_f32 v183, v158, v159
  v_pk_fma_f32 v[48:49], v[48:49], s[22:23], s[22:23]
  v_pk_fma_f32 v[50:51], v[50:51], s[22:23], s[22:23]
  v_pk_fma_f32 v[52:53], v[52:53], s[22:23], s[22:23]
  v_pk_fma_f32 v[54:55], v[54:55], s[22:23], s[22:23]
  v_pk_fma_f32 v[56:57], v[56:57], s[22:23], s[22:23]
  v_pk_fma_f32 v[58:59], v[58:59], s[22:23], s[22:23]
  v_pk_fma_f32 v[60:61], v[60:61], s[22:23], s[22:23]
  v_pk_fma_f32 v[62:63], v[62:63], s[22:23], s[22:23]
  s_sub_u32 s26, s26, 1
  s_cmp_lg_u32 s26, 0
  s_waitcnt vmcnt(4)
  s_cbranch_scc1 S_loop
  v_mfma_f32_32x32x16_bf16 v[16:31], v[216:219], v[160:163], 0
  ds_read_b128 v[192:195], v1 offset:2048
  ds_read_b128 v[196:199], v1 offset:3072
  ds_read_b128 v[200:203], v1 offset:4096
  v_rcp_f32 v48, v48
  v_rcp_f32 v49, v49
  v_mfma_f32_32x32x16_bf16 v[16:31], v[220:223], v[164:167], v[16:31]
  ds_read_b128 v[204:207], v1 offset:5120
  ds_read_b128 v[208:211], v1 offset:6144
  ds_read_b128 v[212:215], v1 offset:7168
  v_rcp_f32 v50, v50
  v_rcp_f32 v51, v51
  v_mfma_f32_32x32x16_bf16 v[16:31], v[224:227], v[168:171], v[16:31]
  ds_read_b128 v[136:139], v5
  ds_read_b128 v[140:143], v5 offset:32
  ds_read_b128 v[144:147], v5 offset:64
  v_rcp_f32 v52, v52
  v_rcp_f32 v53, v53
  v_mfma_f32_32x32x16_bf16 v[16:31], v[228:231], v[172:175], v[16:31]
  ds_read_b128 v[148:151], v5 offset:96
  ds_read_b128 v[152:155], v5 offset:128
  ds_read_b128 v[156:159], v5 offset:160
  v_rcp_f32 v54, v54
  v_rcp_f32 v55, v55
  v_mfma_f32_32x32x16_bf16 v[16:31], v[232:235], v[176:179], v[16:31]
  v_rcp_f32 v56, v56
  v_rcp_f32 v57, v57
  v_rcp_f32_e64 v58, v58
  v_mfma_f32_32x32x16_bf16 v[16:31], v[236:239], v[180:183], v[16:31]
  s_waitcnt lgkmcnt(0)
  v_rcp_f32 v59, v59
  v_rcp_f32 v60, v60
  v_rcp_f32 v61, v61
  v_rcp_f32 v62, v62
  v_rcp_f32 v63, v63
  v_pk_mul_f32 v[32:33], v[32:33], v[48:49]
  v_pk_mul_f32 v[34:35], v[34:35], v[50:51]
  v_pk_mul_f32 v[36:37], v[36:37], v[52:53]
  v_pk_mul_f32 v[38:39], v[38:39], v[54:55]
  v_pk_mul_f32 v[40:41], v[40:41], v[56:57]
  v_pk_mul_f32 v[42:43], v[42:43], v[58:59]
  v_pk_mul_f32 v[44:45], v[44:45], v[60:61]
  v_pk_mul_f32 v[46:47], v[46:47], v[62:63]
  v_pk_fma_f32 v[48:49], v[16:17], v[16:17], s[20:21] neg_lo:[1,0,1] neg_hi:[1,0,1]
  v_pk_fma_f32 v[50:51], v[18:19], v[18:19], s[20:21] neg_lo:[1,0,1] neg_hi:[1,0,1]
  v_pk_fma_f32 v[52:53], v[20:21], v[20:21], s[20:21] neg_lo:[1,0,1] neg_hi:[1,0,1]
  v_pk_fma_f32 v[54:55], v[22:23], v[22:23], s[20:21] neg_lo:[1,0,1] neg_hi:[1,0,1]
  v_pk_fma_f32 v[56:57], v[24:25], v[24:25], s[20:21] neg_lo:[1,0,1] neg_hi:[1,0,1]
  v_pk_fma_f32 v[58:59], v[26:27], v[26:27], s[20:21] neg_lo:[1,0,1] neg_hi:[1,0,1]
  v_pk_fma_f32 v[60:61], v[28:29], v[28:29], s[20:21] neg_lo:[1,0,1] neg_hi:[1,0,1]
  v_pk_fma_f32 v[62:63], v[30:31], v[30:31], s[20:21] neg_lo:[1,0,1] neg_hi:[1,0,1]
  v_pk_mul_f32 v[48:49], v[16:17], v[48:49]
  v_pk_mul_f32 v[50:51], v[18:19], v[50:51]
  v_pk_mul_f32 v[52:53], v[20:21], v[52:53]
  v_pk_mul_f32 v[54:55], v[22:23], v[54:55]
  v_pk_mul_f32 v[56:57], v[24:25], v[56:57]
  v_cvt_pk_bf16_f32 v184, v32, v33
  v_cvt_pk_bf16_f32 v185, v34, v35
  v_cvt_pk_bf16_f32 v186, v36, v37
  v_cvt_pk_bf16_f32 v187, v38, v39
  v_pk_mul_f32 v[58:59], v[26:27], v[58:59]
  v_pk_mul_f32 v[60:61], v[28:29], v[60:61]
  v_pk_mul_f32 v[62:63], v[30:31], v[62:63]
  v_mfma_f32_32x32x16_bf16 v[64:79], v[192:195], v[184:187], v[64:79]
  v_cvt_pk_bf16_f32 v188, v40, v41
  v_cvt_pk_bf16_f32 v189, v42, v43
  v_cvt_pk_bf16_f32 v190, v44, v45
  v_cvt_pk_bf16_f32 v191, v46, v47
  v_exp_f32_e64 v48, v48
  v_mfma_f32_32x32x16_bf16 v[80:95], v[196:199], v[184:187], v[80:95]
  v_exp_f32 v49, v49
  v_exp_f32 v50, v50
  v_exp_f32_e64 v51, v51
  v_mfma_f32_32x32x16_bf16 v[96:111], v[200:203], v[184:187], v[96:111]
  v_exp_f32 v52, v52
  v_exp_f32 v53, v53
  v_exp_f32_e64 v54, v54
  v_mfma_f32_32x32x16_bf16 v[64:79], v[204:207], v[188:191], v[64:79]
  v_exp_f32 v55, v55
  v_exp_f32 v56, v56
  v_exp_f32_e64 v57, v57
  v_mfma_f32_32x32x16_bf16 v[80:95], v[208:211], v[188:191], v[80:95]
  v_exp_f32 v58, v58
  v_exp_f32 v59, v59
  v_exp_f32_e64 v60, v60
  v_mfma_f32_32x32x16_bf16 v[96:111], v[212:215], v[188:191], v[96:111]
  v_exp_f32 v61, v61
  v_exp_f32 v62, v62
  v_exp_f32_e64 v63, v63
  v_pk_fma_f32 v[48:49], v[48:49], s[22:23], s[22:23]
  v_pk_fma_f32 v[50:51], v[50:51], s[22:23], s[22:23]
  v_pk_fma_f32 v[52:53], v[52:53], s[22:23], s[22:23]
  v_pk_fma_f32 v[54:55], v[54:55], s[22:23], s[22:23]
  v_pk_fma_f32 v[56:57], v[56:57], s[22:23], s[22:23]
  v_pk_fma_f32 v[58:59], v[58:59], s[22:23], s[22:23]
  v_pk_fma_f32 v[60:61], v[60:61], s[22:23], s[22:23]
  v_pk_fma_f32 v[62:63], v[62:63], s[22:23], s[22:23]
  v_mfma_f32_32x32x16_bf16 v[32:47], a[0:3], v[160:163], 0
  v_cvt_pk_bf16_f32 v112, v64, v65
  v_cvt_pk_bf16_f32 v113, v66, v67
  v_cvt_pk_bf16_f32 v114, v68, v69
  v_cvt_pk_bf16_f32 v115, v70, v71
  v_cvt_pk_bf16_f32 v116, v72, v73
  v_cvt_pk_bf16_f32 v117, v74, v75
  v_mfma_f32_32x32x16_bf16 v[32:47], a[4:7], v[164:167], v[32:47]
  v_cvt_pk_bf16_f32 v118, v76, v77
  v_cvt_pk_bf16_f32 v119, v78, v79
  v_cvt_pk_bf16_f32 v120, v80, v81
  v_cvt_pk_bf16_f32 v121, v82, v83
  v_cvt_pk_bf16_f32 v122, v84, v85
  v_cvt_pk_bf16_f32 v123, v86, v87
  v_mfma_f32_32x32x16_bf16 v[32:47], a[8:11], v[168:171], v[32:47]
  ds_read_b128 v[64:67], v2
  ds_read_b128 v[68:71], v2 offset:32
  ds_read_b128 v[72:75], v2 offset:64
  ds_read_b128 v[76:79], v2 offset:96
  v_cvt_pk_bf16_f32 v124, v88, v89
  v_cvt_pk_bf16_f32 v125, v90, v91
  v_mfma_f32_32x32x16_bf16 v[32:47], a[12:15], v[172:175], v[32:47]
  ds_read_b128 v[192:195], v1 offset:8192
  ds_read_b128 v[196:199], v1 offset:9216
  v_cvt_pk_bf16_f32 v126, v92, v93
  v_cvt_pk_bf16_f32 v127, v94, v95
  v_cvt_pk_bf16_f32 v128, v96, v97
  v_cvt_pk_bf16_f32 v129, v98, v99
  v_mfma_f32_32x32x16_bf16 v[32:47], a[16:19], v[176:179], v[32:47]
  ds_read_b128 v[80:83], v2 offset:128
  ds_read_b128 v[84:87], v2 offset:160
  ds_read_b128 v[88:91], v2 offset:192
  ds_read_b128 v[92:95], v2 offset:224
  v_cvt_pk_bf16_f32 v130, v100, v101
  v_cvt_pk_bf16_f32 v131, v102, v103
  v_mfma_f32_32x32x16_bf16 v[32:47], a[20:23], v[180:183], v[32:47]
  s_nop 0
  s_waitcnt lgkmcnt(6)
  ds_read_b128 v[200:203], v1 offset:10240
  ds_read_b128 v[204:207], v1 offset:11264
  v_cvt_pk_bf16_f32 v132, v104, v105
  v_cvt_pk_bf16_f32 v133, v106, v107
  v_cvt_pk_bf16_f32 v134, v108, v109
  v_cvt_pk_bf16_f32 v135, v110, v111
  v_mfma_f32_32x32x16_bf16 v[64:79], v[240:243], v[136:139], v[64:79]
  ds_read_b128 v[96:99], v2 offset:256
  ds_read_b128 v[100:103], v2 offset:288
  ds_read_b128 v[104:107], v2 offset:320
  ds_read_b128 v[108:111], v2 offset:352
  v_rcp_f32 v48, v48
  v_mfma_f32_32x32x16_bf16 v[64:79], v[244:247], v[140:143], v[64:79]
  s_waitcnt lgkmcnt(6)
  ds_read_b128 v[208:211], v1 offset:12288
  ds_read_b128 v[212:215], v1 offset:13312
  v_rcp_f32 v49, v49
  v_rcp_f32 v50, v50
  v_mfma_f32_32x32x16_bf16 v[80:95], v[240:243], v[144:147], v[80:95]
  v_rcp_f32 v51, v51
  v_rcp_f32 v52, v52
  v_rcp_f32_e64 v53, v53
  v_mfma_f32_32x32x16_bf16 v[80:95], v[244:247], v[148:151], v[80:95]
  s_waitcnt lgkmcnt(2)
  v_rcp_f32 v54, v54
  v_rcp_f32 v55, v55
  v_rcp_f32 v56, v56
  v_mfma_f32_32x32x16_bf16 v[96:111], v[240:243], v[152:155], v[96:111]
  v_rcp_f32 v57, v57
  v_rcp_f32 v58, v58
  v_rcp_f32_e64 v59, v59
  v_mfma_f32_32x32x16_bf16 v[96:111], v[244:247], v[156:159], v[96:111]
  s_waitcnt lgkmcnt(0)
  v_rcp_f32 v60, v60
  v_rcp_f32 v61, v61
  v_rcp_f32 v62, v62
  v_rcp_f32_e64 v63, v63
  v_pk_mul_f32 v[16:17], v[16:17], v[48:49]
  v_pk_mul_f32 v[18:19], v[18:19], v[50:51]
  v_pk_mul_f32 v[20:21], v[20:21], v[52:53]
  v_pk_mul_f32 v[22:23], v[22:23], v[54:55]
  v_pk_mul_f32 v[24:25], v[24:25], v[56:57]
  v_pk_mul_f32 v[26:27], v[26:27], v[58:59]
  v_pk_mul_f32 v[28:29], v[28:29], v[60:61]
  v_pk_mul_f32 v[30:31], v[30:31], v[62:63]
  v_pk_fma_f32 v[48:49], v[32:33], v[32:33], s[20:21] neg_lo:[1,0,1] neg_hi:[1,0,1]
  v_pk_fma_f32 v[50:51], v[34:35], v[34:35], s[20:21] neg_lo:[1,0,1] neg_hi:[1,0,1]
  v_pk_fma_f32 v[52:53], v[36:37], v[36:37], s[20:21] neg_lo:[1,0,1] neg_hi:[1,0,1]
  v_pk_fma_f32 v[54:55], v[38:39], v[38:39], s[20:21] neg_lo:[1,0,1] neg_hi:[1,0,1]
  v_pk_fma_f32 v[56:57], v[40:41], v[40:41], s[20:21] neg_lo:[1,0,1] neg_hi:[1,0,1]
  v_pk_fma_f32 v[58:59], v[42:43], v[42:43], s[20:21] neg_lo:[1,0,1] neg_hi:[1,0,1]
  v_pk_fma_f32 v[60:61], v[44:45], v[44:45], s[20:21] neg_lo:[1,0,1] neg_hi:[1,0,1]
  v_pk_fma_f32 v[62:63], v[46:47], v[46:47], s[20:21] neg_lo:[1,0,1] neg_hi:[1,0,1]
  v_pk_mul_f32 v[48:49], v[32:33], v[48:49]
  v_pk_mul_f32 v[50:51], v[34:35], v[50:51]
  v_pk_mul_f32 v[52:53], v[36:37], v[52:53]
  v_pk_mul_f32 v[54:55], v[38:39], v[54:55]
  v_pk_mul_f32 v[56:57], v[40:41], v[56:57]
  v_cvt_pk_bf16_f32 v184, v16, v17
  v_cvt_pk_bf16_f32 v185, v18, v19
  v_cvt_pk_bf16_f32 v186, v20, v21
  v_cvt_pk_bf16_f32 v187, v22, v23
  v_pk_mul_f32 v[58:59], v[42:43], v[58:59]
  v_pk_mul_f32 v[60:61], v[44:45], v[60:61]
  v_pk_mul_f32 v[62:63], v[46:47], v[62:63]
  v_mfma_f32_32x32x16_bf16 v[64:79], v[192:195], v[184:187], v[64:79]
  v_cvt_pk_bf16_f32 v188, v24, v25
  v_cvt_pk_bf16_f32 v189, v26, v27
  v_cvt_pk_bf16_f32 v190, v28, v29
  v_cvt_pk_bf16_f32 v191, v30, v31
  v_exp_f32_e64 v48, v48
  v_mfma_f32_32x32x16_bf16 v[80:95], v[196:199], v[184:187], v[80:95]
  v_exp_f32 v49, v49
  v_exp_f32 v50, v50
  v_exp_f32_e64 v51, v51
  v_mfma_f32_32x32x16_bf16 v[96:111], v[200:203], v[184:187], v[96:111]
  v_exp_f32 v52, v52
  v_exp_f32 v53, v53
  v_exp_f32_e64 v54, v54
  v_mfma_f32_32x32x16_bf16 v[64:79], v[204:207], v[188:191], v[64:79]
  v_exp_f32 v55, v55
  v_exp_f32 v56, v56
  v_exp_f32_e64 v57, v57
  v_mfma_f32_32x32x16_bf16 v[80:95], v[208:211], v[188:191], v[80:95]
  v_exp_f32 v58, v58
  v_exp_f32 v59, v59
  v_exp_f32_e64 v60, v60
  v_mfma_f32_32x32x16_bf16 v[96:111], v[212:215], v[188:191], v[96:111]
  v_exp_f32 v61, v61
  v_exp_f32 v62, v62
  v_exp_f32_e64 v63, v63
  v_pk_fma_f32 v[48:49], v[48:49], s[22:23], s[22:23]
  v_pk_fma_f32 v[50:51], v[50:51], s[22:23], s[22:23]
  v_pk_fma_f32 v[52:53], v[52:53], s[22:23], s[22:23]
  v_pk_fma_f32 v[54:55], v[54:55], s[22:23], s[22:23]
  v_pk_fma_f32 v[56:57], v[56:57], s[22:23], s[22:23]
  v_pk_fma_f32 v[58:59], v[58:59], s[22:23], s[22:23]
  v_pk_fma_f32 v[60:61], v[60:61], s[22:23], s[22:23]
  v_pk_fma_f32 v[62:63], v[62:63], s[22:23], s[22:23]
  v_mfma_f32_32x32x16_bf16 v[16:31], a[24:27], v[160:163], 0
  ds_read_b128 v[192:195], v1 offset:14336
  ds_read_b128 v[196:199], v1 offset:15360
  v_rcp_f32 v48, v48
  v_rcp_f32 v49, v49
  v_mfma_f32_32x32x16_bf16 v[16:31], a[28:31], v[164:167], v[16:31]
  ds_read_b128 v[200:203], v1 offset:16384
  ds_read_b128 v[204:207], v1 offset:17408
  v_rcp_f32 v50, v50
  v_rcp_f32 v51, v51
  v_mfma_f32_32x32x16_bf16 v[16:31], a[32:35], v[168:171], v[16:31]
  ds_read_b128 v[208:211], v1 offset:18432
  ds_read_b128 v[212:215], v1 offset:19456
  v_rcp_f32 v52, v52
  v_rcp_f32 v53, v53
  v_mfma_f32_32x32x16_bf16 v[16:31], a[36:39], v[172:175], v[16:31]
  buffer_store_dwordx4 v[112:115], v10, s[8:11], s28 offen
  v_rcp_f32 v54, v54
  v_rcp_f32 v55, v55
  v_mfma_f32_32x32x16_bf16 v[16:31], a[40:43], v[176:179], v[16:31]
  v_rcp_f32 v56, v56
  v_rcp_f32 v57, v57
  v_rcp_f32_e64 v58, v58
  v_mfma_f32_32x32x16_bf16 v[16:31], a[44:47], v[180:183], v[16:31]
  s_waitcnt lgkmcnt(0)
  v_rcp_f32 v59, v59
  v_rcp_f32 v60, v60
  v_rcp_f32 v61, v61
  v_rcp_f32 v62, v62
  v_rcp_f32 v63, v63
  v_pk_mul_f32 v[32:33], v[32:33], v[48:49]
  v_pk_mul_f32 v[34:35], v[34:35], v[50:51]
  v_pk_mul_f32 v[36:37], v[36:37], v[52:53]
  v_pk_mul_f32 v[38:39], v[38:39], v[54:55]
  v_pk_mul_f32 v[40:41], v[40:41], v[56:57]
  v_pk_mul_f32 v[42:43], v[42:43], v[58:59]
  v_pk_mul_f32 v[44:45], v[44:45], v[60:61]
  v_pk_mul_f32 v[46:47], v[46:47], v[62:63]
  v_pk_fma_f32 v[48:49], v[16:17], v[16:17], s[20:21] neg_lo:[1,0,1] neg_hi:[1,0,1]
  v_pk_fma_f32 v[50:51], v[18:19], v[18:19], s[20:21] neg_lo:[1,0,1] neg_hi:[1,0,1]
  v_pk_fma_f32 v[52:53], v[20:21], v[20:21], s[20:21] neg_lo:[1,0,1] neg_hi:[1,0,1]
  v_pk_fma_f32 v[54:55], v[22:23], v[22:23], s[20:21] neg_lo:[1,0,1] neg_hi:[1,0,1]
  v_pk_fma_f32 v[56:57], v[24:25], v[24:25], s[20:21] neg_lo:[1,0,1] neg_hi:[1,0,1]
  v_pk_fma_f32 v[58:59], v[26:27], v[26:27], s[20:21] neg_lo:[1,0,1] neg_hi:[1,0,1]
  v_pk_fma_f32 v[60:61], v[28:29], v[28:29], s[20:21] neg_lo:[1,0,1] neg_hi:[1,0,1]
  v_pk_fma_f32 v[62:63], v[30:31], v[30:31], s[20:21] neg_lo:[1,0,1] neg_hi:[1,0,1]
  v_pk_mul_f32 v[48:49], v[16:17], v[48:49]
  v_pk_mul_f32 v[50:51], v[18:19], v[50:51]
  v_pk_mul_f32 v[52:53], v[20:21], v[52:53]
  v_pk_mul_f32 v[54:55], v[22:23], v[54:55]
  v_pk_mul_f32 v[56:57], v[24:25], v[56:57]
  v_cvt_pk_bf16_f32 v184, v32, v33
  v_cvt_pk_bf16_f32 v185, v34, v35
  v_cvt_pk_bf16_f32 v186, v36, v37
  v_cvt_pk_bf16_f32 v187, v38, v39
  v_pk_mul_f32 v[58:59], v[26:27], v[58:59]
  v_pk_mul_f32 v[60:61], v[28:29], v[60:61]
  v_pk_mul_f32 v[62:63], v[30:31], v[62:63]
  v_mfma_f32_32x32x16_bf16 v[64:79], v[192:195], v[184:187], v[64:79]
  v_cvt_pk_bf16_f32 v188, v40, v41
  v_cvt_pk_bf16_f32 v189, v42, v43
  v_cvt_pk_bf16_f32 v190, v44, v45
  v_cvt_pk_bf16_f32 v191, v46, v47
  v_exp_f32_e64 v48, v48
  v_mfma_f32_32x32x16_bf16 v[80:95], v[196:199], v[184:187], v[80:95]
  v_exp_f32 v49, v49
  v_exp_f32 v50, v50
  v_exp_f32_e64 v51, v51
  v_mfma_f32_32x32x16_bf16 v[96:111], v[200:203], v[184:187], v[96:111]
  v_exp_f32 v52, v52
  v_exp_f32 v53, v53
  v_exp_f32_e64 v54, v54
  v_mfma_f32_32x32x16_bf16 v[64:79], v[204:207], v[188:191], v[64:79]
  v_exp_f32 v55, v55
  v_exp_f32 v56, v56
  v_exp_f32_e64 v57, v57
  v_mfma_f32_32x32x16_bf16 v[80:95], v[208:211], v[188:191], v[80:95]
  v_exp_f32 v58, v58
  v_exp_f32 v59, v59
  v_exp_f32_e64 v60, v60
  v_mfma_f32_32x32x16_bf16 v[96:111], v[212:215], v[188:191], v[96:111]
  v_exp_f32 v61, v61
  v_exp_f32 v62, v62
  v_exp_f32_e64 v63, v63
  v_pk_fma_f32 v[48:49], v[48:49], s[22:23], s[22:23]
  v_pk_fma_f32 v[50:51], v[50:51], s[22:23], s[22:23]
  v_pk_fma_f32 v[52:53], v[52:53], s[22:23], s[22:23]
  v_pk_fma_f32 v[54:55], v[54:55], s[22:23], s[22:23]
  v_pk_fma_f32 v[56:57], v[56:57], s[22:23], s[22:23]
  v_pk_fma_f32 v[58:59], v[58:59], s[22:23], s[22:23]
  v_pk_fma_f32 v[60:61], v[60:61], s[22:23], s[22:23]
  v_pk_fma_f32 v[62:63], v[62:63], s[22:23], s[22:23]
  v_mfma_f32_32x32x16_bf16 v[32:47], a[48:51], v[160:163], 0
  ds_read_b128 v[192:195], v1 offset:20480
  ds_read_b128 v[196:199], v1 offset:21504
  v_rcp_f32 v48, v48
  v_rcp_f32 v49, v49
  v_mfma_f32_32x32x16_bf16 v[32:47], a[52:55], v[164:167], v[32:47]
  ds_read_b128 v[200:203], v1 offset:22528
  ds_read_b128 v[204:207], v1 offset:23552
  v_rcp_f32 v50, v50
  v_rcp_f32 v51, v51
  v_mfma_f32_32x32x16_bf16 v[32:47], a[56:59], v[168:171], v[32:47]
  ds_read_b128 v[208:211], v1 offset:24576
  ds_read_b128 v[212:215], v1 offset:25600
  v_rcp_f32 v52, v52
  v_rcp_f32 v53, v53
  v_mfma_f32_32x32x16_bf16 v[32:47], a[60:63], v[172:175], v[32:47]
  buffer_store_dwordx4 v[116:119], v10, s[8:11], s28 offen offset:32
  v_rcp_f32 v54, v54
  v_rcp_f32 v55, v55
  v_mfma_f32_32x32x16_bf16 v[32:47], a[64:67], v[176:179], v[32:47]
  v_rcp_f32 v56, v56
  v_rcp_f32 v57, v57
  v_rcp_f32_e64 v58, v58
  v_mfma_f32_32x32x16_bf16 v[32:47], a[68:71], v[180:183], v[32:47]
  s_waitcnt lgkmcnt(0)
  v_rcp_f32 v59, v59
  v_rcp_f32 v60, v60
  v_rcp_f32 v61, v61
  v_rcp_f32 v62, v62
  v_rcp_f32 v63, v63
  v_pk_mul_f32 v[16:17], v[16:17], v[48:49]
  v_pk_mul_f32 v[18:19], v[18:19], v[50:51]
  v_pk_mul_f32 v[20:21], v[20:21], v[52:53]
  v_pk_mul_f32 v[22:23], v[22:23], v[54:55]
  v_pk_mul_f32 v[24:25], v[24:25], v[56:57]
  v_pk_mul_f32 v[26:27], v[26:27], v[58:59]
  v_pk_mul_f32 v[28:29], v[28:29], v[60:61]
  v_pk_mul_f32 v[30:31], v[30:31], v[62:63]
  v_pk_fma_f32 v[48:49], v[32:33], v[32:33], s[20:21] neg_lo:[1,0,1] neg_hi:[1,0,1]
  v_pk_fma_f32 v[50:51], v[34:35], v[34:35], s[20:21] neg_lo:[1,0,1] neg_hi:[1,0,1]
  v_pk_fma_f32 v[52:53], v[36:37], v[36:37], s[20:21] neg_lo:[1,0,1] neg_hi:[1,0,1]
  v_pk_fma_f32 v[54:55], v[38:39], v[38:39], s[20:21] neg_lo:[1,0,1] neg_hi:[1,0,1]
  v_pk_fma_f32 v[56:57], v[40:41], v[40:41], s[20:21] neg_lo:[1,0,1] neg_hi:[1,0,1]
  v_pk_fma_f32 v[58:59], v[42:43], v[42:43], s[20:21] neg_lo:[1,0,1] neg_hi:[1,0,1]
  v_pk_fma_f32 v[60:61], v[44:45], v[44:45], s[20:21] neg_lo:[1,0,1] neg_hi:[1,0,1]
  v_pk_fma_f32 v[62:63], v[46:47], v[46:47], s[20:21] neg_lo:[1,0,1] neg_hi:[1,0,1]
  v_pk_mul_f32 v[48:49], v[32:33], v[48:49]
  v_pk_mul_f32 v[50:51], v[34:35], v[50:51]
  v_pk_mul_f32 v[52:53], v[36:37], v[52:53]
  v_pk_mul_f32 v[54:55], v[38:39], v[54:55]
  v_pk_mul_f32 v[56:57], v[40:41], v[56:57]
  v_cvt_pk_bf16_f32 v184, v16, v17
  v_cvt_pk_bf16_f32 v185, v18, v19
  v_cvt_pk_bf16_f32 v186, v20, v21
  v_cvt_pk_bf16_f32 v187, v22, v23
  v_pk_mul_f32 v[58:59], v[42:43], v[58:59]
  v_pk_mul_f32 v[60:61], v[44:45], v[60:61]
  v_pk_mul_f32 v[62:63], v[46:47], v[62:63]
  v_mfma_f32_32x32x16_bf16 v[64:79], v[192:195], v[184:187], v[64:79]
  v_cvt_pk_bf16_f32 v188, v24, v25
  v_cvt_pk_bf16_f32 v189, v26, v27
  v_cvt_pk_bf16_f32 v190, v28, v29
  v_cvt_pk_bf16_f32 v191, v30, v31
  v_exp_f32_e64 v48, v48
  v_mfma_f32_32x32x16_bf16 v[80:95], v[196:199], v[184:187], v[80:95]
  v_exp_f32 v49, v49
  v_exp_f32 v50, v50
  v_exp_f32_e64 v51, v51
  v_mfma_f32_32x32x16_bf16 v[96:111], v[200:203], v[184:187], v[96:111]
  v_exp_f32 v52, v52
  v_exp_f32 v53, v53
  v_exp_f32_e64 v54, v54
  v_mfma_f32_32x32x16_bf16 v[64:79], v[204:207], v[188:191], v[64:79]
  v_exp_f32 v55, v55
  v_exp_f32 v56, v56
  v_exp_f32_e64 v57, v57
  v_mfma_f32_32x32x16_bf16 v[80:95], v[208:211], v[188:191], v[80:95]
  v_exp_f32 v58, v58
  v_exp_f32 v59, v59
  v_exp_f32_e64 v60, v60
  v_mfma_f32_32x32x16_bf16 v[96:111], v[212:215], v[188:191], v[96:111]
  v_exp_f32 v61, v61
  v_exp_f32 v62, v62
  v_exp_f32_e64 v63, v63
  v_pk_fma_f32 v[48:49], v[48:49], s[22:23], s[22:23]
  v_pk_fma_f32 v[50:51], v[50:51], s[22:23], s[22:23]
  v_pk_fma_f32 v[52:53], v[52:53], s[22:23], s[22:23]
  v_pk_fma_f32 v[54:55], v[54:55], s[22:23], s[22:23]
  v_pk_fma_f32 v[56:57], v[56:57], s[22:23], s[22:23]
  v_pk_fma_f32 v[58:59], v[58:59], s[22:23], s[22:23]
  v_pk_fma_f32 v[60:61], v[60:61], s[22:23], s[22:23]
  v_pk_fma_f32 v[62:63], v[62:63], s[22:23], s[22:23]
  v_mfma_f32_32x32x16_bf16 v[16:31], a[72:75], v[160:163], 0
  ds_read_b128 v[192:195], v1 offset:26624
  ds_read_b128 v[196:199], v1 offset:27648
  v_rcp_f32 v48, v48
  v_rcp_f32 v49, v49
  v_mfma_f32_32x32x16_bf16 v[16:31], a[76:79], v[164:167], v[16:31]
  ds_read_b128 v[200:203], v1 offset:28672
  ds_read_b128 v[204:207], v1 offset:29696
  v_rcp_f32 v50, v50
  v_rcp_f32 v51, v51
  v_mfma_f32_32x32x16_bf16 v[16:31], a[80:83], v[168:171], v[16:31]
  ds_read_b128 v[208:211], v1 offset:30720
  ds_read_b128 v[212:215], v1 offset:31744
  v_rcp_f32 v52, v52
  v_rcp_f32 v53, v53
  v_mfma_f32_32x32x16_bf16 v[16:31], a[84:87], v[172:175], v[16:31]
  v_rcp_f32 v54, v54
  v_rcp_f32 v55, v55
  v_rcp_f32_e64 v56, v56
  v_mfma_f32_32x32x16_bf16 v[16:31], a[88:91], v[176:179], v[16:31]
  v_rcp_f32 v57, v57
  v_rcp_f32 v58, v58
  v_rcp_f32_e64 v59, v59
  v_mfma_f32_32x32x16_bf16 v[16:31], a[92:95], v[180:183], v[16:31]
  s_waitcnt lgkmcnt(0)
  v_rcp_f32 v60, v60
  v_rcp_f32 v61, v61
  v_rcp_f32 v62, v62
  v_rcp_f32_e64 v63, v63
  v_pk_mul_f32 v[32:33], v[32:33], v[48:49]
  v_pk_mul_f32 v[34:35], v[34:35], v[50:51]
  v_pk_mul_f32 v[36:37], v[36:37], v[52:53]
  v_pk_mul_f32 v[38:39], v[38:39], v[54:55]
  v_pk_mul_f32 v[40:41], v[40:41], v[56:57]
  v_pk_mul_f32 v[42:43], v[42:43], v[58:59]
  v_pk_mul_f32 v[44:45], v[44:45], v[60:61]
  v_pk_mul_f32 v[46:47], v[46:47], v[62:63]
  v_pk_fma_f32 v[48:49], v[16:17], v[16:17], s[20:21] neg_lo:[1,0,1] neg_hi:[1,0,1]
  v_pk_fma_f32 v[50:51], v[18:19], v[18:19], s[20:21] neg_lo:[1,0,1] neg_hi:[1,0,1]
  v_pk_fma_f32 v[52:53], v[20:21], v[20:21], s[20:21] neg_lo:[1,0,1] neg_hi:[1,0,1]
  v_pk_fma_f32 v[54:55], v[22:23], v[22:23], s[20:21] neg_lo:[1,0,1] neg_hi:[1,0,1]
  v_pk_fma_f32 v[56:57], v[24:25], v[24:25], s[20:21] neg_lo:[1,0,1] neg_hi:[1,0,1]
  v_pk_fma_f32 v[58:59], v[26:27], v[26:27], s[20:21] neg_lo:[1,0,1] neg_hi:[1,0,1]
  v_pk_fma_f32 v[60:61], v[28:29], v[28:29], s[20:21] neg_lo:[1,0,1] neg_hi:[1,0,1]
  v_pk_fma_f32 v[62:63], v[30:31], v[30:31], s[20:21] neg_lo:[1,0,1] neg_hi:[1,0,1]
  v_pk_mul_f32 v[48:49], v[16:17], v[48:49]
  v_pk_mul_f32 v[50:51], v[18:19], v[50:51]
  v_pk_mul_f32 v[52:53], v[20:21], v[52:53]
  v_pk_mul_f32 v[54:55], v[22:23], v[54:55]
  v_pk_mul_f32 v[56:57], v[24:25], v[56:57]
  v_cvt_pk_bf16_f32 v184, v32, v33
  v_cvt_pk_bf16_f32 v185, v34, v35
  v_cvt_pk_bf16_f32 v186, v36, v37
  v_cvt_pk_bf16_f32 v187, v38, v39
  v_pk_mul_f32 v[58:59], v[26:27], v[58:59]
  v_pk_mul_f32 v[60:61], v[28:29], v[60:61]
  v_pk_mul_f32 v[62:63], v[30:31], v[62:63]
  v_mfma_f32_32x32x16_bf16 v[64:79], v[192:195], v[184:187], v[64:79]
  v_cvt_pk_bf16_f32 v188, v40, v41
  v_cvt_pk_bf16_f32 v189, v42, v43
  v_cvt_pk_bf16_f32 v190, v44, v45
  v_cvt_pk_bf16_f32 v191, v46, v47
  v_exp_f32_e64 v48, v48
  v_mfma_f32_32x32x16_bf16 v[80:95], v[196:199], v[184:187], v[80:95]
  v_exp_f32 v49, v49
  v_exp_f32 v50, v50
  v_exp_f32_e64 v51, v51
  v_mfma_f32_32x32x16_bf16 v[96:111], v[200:203], v[184:187], v[96:111]
  v_exp_f32 v52, v52
  v_exp_f32 v53, v53
  v_exp_f32_e64 v54, v54
  v_mfma_f32_32x32x16_bf16 v[64:79], v[204:207], v[188:191], v[64:79]
  v_exp_f32 v55, v55
  v_exp_f32 v56, v56
  v_exp_f32_e64 v57, v57
  v_mfma_f32_32x32x16_bf16 v[80:95], v[208:211], v[188:191], v[80:95]
  v_exp_f32 v58, v58
  v_exp_f32 v59, v59
  v_exp_f32_e64 v60, v60
  v_mfma_f32_32x32x16_bf16 v[96:111], v[212:215], v[188:191], v[96:111]
  v_exp_f32 v61, v61
  v_exp_f32 v62, v62
  v_exp_f32_e64 v63, v63
  v_pk_fma_f32 v[48:49], v[48:49], s[22:23], s[22:23]
  v_pk_fma_f32 v[50:51], v[50:51], s[22:23], s[22:23]
  v_pk_fma_f32 v[52:53], v[52:53], s[22:23], s[22:23]
  v_pk_fma_f32 v[54:55], v[54:55], s[22:23], s[22:23]
  v_pk_fma_f32 v[56:57], v[56:57], s[22:23], s[22:23]
  v_pk_fma_f32 v[58:59], v[58:59], s[22:23], s[22:23]
  v_pk_fma_f32 v[60:61], v[60:61], s[22:23], s[22:23]
  v_pk_fma_f32 v[62:63], v[62:63], s[22:23], s[22:23]
  v_mfma_f32_32x32x16_bf16 v[32:47], a[96:99], v[160:163], 0
  ds_read_b128 v[192:195], v0 offset:24576
  ds_read_b128 v[196:199], v0 offset:25600
  v_rcp_f32 v48, v48
  v_rcp_f32 v49, v49
  v_mfma_f32_32x32x16_bf16 v[32:47], a[100:103], v[164:167], v[32:47]
  ds_read_b128 v[200:203], v0 offset:26624
  ds_read_b128 v[204:207], v0 offset:27648
  v_rcp_f32 v50, v50
  v_rcp_f32 v51, v51
  v_mfma_f32_32x32x16_bf16 v[32:47], a[104:107], v[168:171], v[32:47]
  ds_read_b128 v[208:211], v0 offset:28672
  ds_read_b128 v[212:215], v0 offset:29696
  v_rcp_f32 v52, v52
  v_rcp_f32 v53, v53
  v_mfma_f32_32x32x16_bf16 v[32:47], a[108:111], v[172:175], v[32:47]
  buffer_store_dwordx4 v[120:123], v10, s[8:11], s28 offen offset:64
  v_rcp_f32 v54, v54
  v_rcp_f32 v55, v55
  v_mfma_f32_32x32x16_bf16 v[32:47], a[112:115], v[176:179], v[32:47]
  v_rcp_f32 v56, v56
  v_rcp_f32 v57, v57
  v_rcp_f32_e64 v58, v58
  v_mfma_f32_32x32x16_bf16 v[32:47], a[116:119], v[180:183], v[32:47]
  s_waitcnt lgkmcnt(0)
  v_rcp_f32 v59, v59
  v_rcp_f32 v60, v60
  v_rcp_f32 v61, v61
  v_rcp_f32 v62, v62
  v_rcp_f32 v63, v63
  v_pk_mul_f32 v[16:17], v[16:17], v[48:49]
  v_pk_mul_f32 v[18:19], v[18:19], v[50:51]
  v_pk_mul_f32 v[20:21], v[20:21], v[52:53]
  v_pk_mul_f32 v[22:23], v[22:23], v[54:55]
  v_pk_mul_f32 v[24:25], v[24:25], v[56:57]
  v_pk_mul_f32 v[26:27], v[26:27], v[58:59]
  v_pk_mul_f32 v[28:29], v[28:29], v[60:61]
  v_pk_mul_f32 v[30:31], v[30:31], v[62:63]
  v_pk_fma_f32 v[48:49], v[32:33], v[32:33], s[20:21] neg_lo:[1,0,1] neg_hi:[1,0,1]
  v_pk_fma_f32 v[50:51], v[34:35], v[34:35], s[20:21] neg_lo:[1,0,1] neg_hi:[1,0,1]
  v_pk_fma_f32 v[52:53], v[36:37], v[36:37], s[20:21] neg_lo:[1,0,1] neg_hi:[1,0,1]
  v_pk_fma_f32 v[54:55], v[38:39], v[38:39], s[20:21] neg_lo:[1,0,1] neg_hi:[1,0,1]
  v_pk_fma_f32 v[56:57], v[40:41], v[40:41], s[20:21] neg_lo:[1,0,1] neg_hi:[1,0,1]
  v_pk_fma_f32 v[58:59], v[42:43], v[42:43], s[20:21] neg_lo:[1,0,1] neg_hi:[1,0,1]
  v_pk_fma_f32 v[60:61], v[44:45], v[44:45], s[20:21] neg_lo:[1,0,1] neg_hi:[1,0,1]
  v_pk_fma_f32 v[62:63], v[46:47], v[46:47], s[20:21] neg_lo:[1,0,1] neg_hi:[1,0,1]
  v_pk_mul_f32 v[48:49], v[32:33], v[48:49]
  v_pk_mul_f32 v[50:51], v[34:35], v[50:51]
  v_pk_mul_f32 v[52:53], v[36:37], v[52:53]
  v_pk_mul_f32 v[54:55], v[38:39], v[54:55]
  v_pk_mul_f32 v[56:57], v[40:41], v[56:57]
  v_cvt_pk_bf16_f32 v184, v16, v17
  v_cvt_pk_bf16_f32 v185, v18, v19
  v_cvt_pk_bf16_f32 v186, v20, v21
  v_cvt_pk_bf16_f32 v187, v22, v23
  v_pk_mul_f32 v[58:59], v[42:43], v[58:59]
  v_pk_mul_f32 v[60:61], v[44:45], v[60:61]
  v_pk_mul_f32 v[62:63], v[46:47], v[62:63]
  v_mfma_f32_32x32x16_bf16 v[64:79], v[192:195], v[184:187], v[64:79]
  v_cvt_pk_bf16_f32 v188, v24, v25
  v_cvt_pk_bf16_f32 v189, v26, v27
  v_cvt_pk_bf16_f32 v190, v28, v29
  v_cvt_pk_bf16_f32 v191, v30, v31
  v_exp_f32_e64 v48, v48
  v_mfma_f32_32x32x16_bf16 v[80:95], v[196:199], v[184:187], v[80:95]
  v_exp_f32 v49, v49
  v_exp_f32 v50, v50
  v_exp_f32_e64 v51, v51
  v_mfma_f32_32x32x16_bf16 v[96:111], v[200:203], v[184:187], v[96:111]
  v_exp_f32 v52, v52
  v_exp_f32 v53, v53
  v_exp_f32_e64 v54, v54
  v_mfma_f32_32x32x16_bf16 v[64:79], v[204:207], v[188:191], v[64:79]
  v_exp_f32 v55, v55
  v_exp_f32 v56, v56
  v_exp_f32_e64 v57, v57
  v_mfma_f32_32x32x16_bf16 v[80:95], v[208:211], v[188:191], v[80:95]
  v_exp_f32 v58, v58
  v_exp_f32 v59, v59
  v_exp_f32_e64 v60, v60
  v_mfma_f32_32x32x16_bf16 v[96:111], v[212:215], v[188:191], v[96:111]
  v_exp_f32 v61, v61
  v_exp_f32 v62, v62
  v_exp_f32_e64 v63, v63
  v_pk_fma_f32 v[48:49], v[48:49], s[22:23], s[22:23]
  v_pk_fma_f32 v[50:51], v[50:51], s[22:23], s[22:23]
  v_pk_fma_f32 v[52:53], v[52:53], s[22:23], s[22:23]
  v_pk_fma_f32 v[54:55], v[54:55], s[22:23], s[22:23]
  v_pk_fma_f32 v[56:57], v[56:57], s[22:23], s[22:23]
  v_pk_fma_f32 v[58:59], v[58:59], s[22:23], s[22:23]
  v_pk_fma_f32 v[60:61], v[60:61], s[22:23], s[22:23]
  v_pk_fma_f32 v[62:63], v[62:63], s[22:23], s[22:23]
  v_mfma_f32_32x32x16_bf16 v[16:31], a[120:123], v[160:163], 0
  ds_read_b128 v[192:195], v0 offset:30720
  ds_read_b128 v[196:199], v0 offset:31744
  v_rcp_f32 v48, v48
  v_rcp_f32 v49, v49
  v_mfma_f32_32x32x16_bf16 v[16:31], a[124:127], v[164:167], v[16:31]
  ds_read_b128 v[200:203], v0 offset:32768
  ds_read_b128 v[204:207], v0 offset:33792
  v_rcp_f32 v50, v50
  v_rcp_f32 v51, v51
  v_mfma_f32_32x32x16_bf16 v[16:31], a[128:131], v[168:171], v[16:31]
  ds_read_b128 v[208:211], v0 offset:34816
  ds_read_b128 v[212:215], v0 offset:35840
  v_rcp_f32 v52, v52
  v_rcp_f32 v53, v53
  v_mfma_f32_32x32x16_bf16 v[16:31], a[132:135], v[172:175], v[16:31]
  buffer_store_dwordx4 v[124:127], v10, s[8:11], s28 offen offset:96
  v_rcp_f32 v54, v54
  v_rcp_f32 v55, v55
  v_mfma_f32_32x32x16_bf16 v[16:31], a[136:139], v[176:179], v[16:31]
  v_rcp_f32 v56, v56
  v_rcp_f32 v57, v57
  v_rcp_f32_e64 v58, v58
  v_mfma_f32_32x32x16_bf16 v[16:31], a[140:143], v[180:183], v[16:31]
  s_waitcnt lgkmcnt(0)
  v_rcp_f32 v59, v59
  v_rcp_f32 v60, v60
  v_rcp_f32 v61, v61
  v_rcp_f32 v62, v62
  v_rcp_f32 v63, v63
  v_pk_mul_f32 v[32:33], v[32:33], v[48:49]
  v_pk_mul_f32 v[34:35], v[34:35], v[50:51]
  v_pk_mul_f32 v[36:37], v[36:37], v[52:53]
  v_pk_mul_f32 v[38:39], v[38:39], v[54:55]
  v_pk_mul_f32 v[40:41], v[40:41], v[56:57]
  v_pk_mul_f32 v[42:43], v[42:43], v[58:59]
  v_pk_mul_f32 v[44:45], v[44:45], v[60:61]
  v_pk_mul_f32 v[46:47], v[46:47], v[62:63]
  v_pk_fma_f32 v[48:49], v[16:17], v[16:17], s[20:21] neg_lo:[1,0,1] neg_hi:[1,0,1]
  v_pk_fma_f32 v[50:51], v[18:19], v[18:19], s[20:21] neg_lo:[1,0,1] neg_hi:[1,0,1]
  v_pk_fma_f32 v[52:53], v[20:21], v[20:21], s[20:21] neg_lo:[1,0,1] neg_hi:[1,0,1]
  v_pk_fma_f32 v[54:55], v[22:23], v[22:23], s[20:21] neg_lo:[1,0,1] neg_hi:[1,0,1]
  v_pk_fma_f32 v[56:57], v[24:25], v[24:25], s[20:21] neg_lo:[1,0,1] neg_hi:[1,0,1]
  v_pk_fma_f32 v[58:59], v[26:27], v[26:27], s[20:21] neg_lo:[1,0,1] neg_hi:[1,0,1]
  v_pk_fma_f32 v[60:61], v[28:29], v[28:29], s[20:21] neg_lo:[1,0,1] neg_hi:[1,0,1]
  v_pk_fma_f32 v[62:63], v[30:31], v[30:31], s[20:21] neg_lo:[1,0,1] neg_hi:[1,0,1]
  v_pk_mul_f32 v[48:49], v[16:17], v[48:49]
  v_pk_mul_f32 v[50:51], v[18:19], v[50:51]
  v_pk_mul_f32 v[52:53], v[20:21], v[52:53]
  v_pk_mul_f32 v[54:55], v[22:23], v[54:55]
  v_pk_mul_f32 v[56:57], v[24:25], v[56:57]
  v_cvt_pk_bf16_f32 v184, v32, v33
  v_cvt_pk_bf16_f32 v185, v34, v35
  v_cvt_pk_bf16_f32 v186, v36, v37
  v_cvt_pk_bf16_f32 v187, v38, v39
  v_pk_mul_f32 v[58:59], v[26:27], v[58:59]
  v_pk_mul_f32 v[60:61], v[28:29], v[60:61]
  v_pk_mul_f32 v[62:63], v[30:31], v[62:63]
  v_mfma_f32_32x32x16_bf16 v[64:79], v[192:195], v[184:187], v[64:79]
  v_cvt_pk_bf16_f32 v188, v40, v41
  v_cvt_pk_bf16_f32 v189, v42, v43
  v_cvt_pk_bf16_f32 v190, v44, v45
  v_cvt_pk_bf16_f32 v191, v46, v47
  v_exp_f32_e64 v48, v48
  v_mfma_f32_32x32x16_bf16 v[80:95], v[196:199], v[184:187], v[80:95]
  v_exp_f32 v49, v49
  v_exp_f32 v50, v50
  v_exp_f32_e64 v51, v51
  v_mfma_f32_32x32x16_bf16 v[96:111], v[200:203], v[184:187], v[96:111]
  v_exp_f32 v52, v52
  v_exp_f32 v53, v53
  v_exp_f32_e64 v54, v54
  v_mfma_f32_32x32x16_bf16 v[64:79], v[204:207], v[188:191], v[64:79]
  v_exp_f32 v55, v55
  v_exp_f32 v56, v56
  v_exp_f32_e64 v57, v57
  v_mfma_f32_32x32x16_bf16 v[80:95], v[208:211], v[188:191], v[80:95]
  v_exp_f32 v58, v58
  v_exp_f32 v59, v59
  v_exp_f32_e64 v60, v60
  v_mfma_f32_32x32x16_bf16 v[96:111], v[212:215], v[188:191], v[96:111]
  v_exp_f32 v61, v61
  v_exp_f32 v62, v62
  v_exp_f32_e64 v63, v63
  v_pk_fma_f32 v[48:49], v[48:49], s[22:23], s[22:23]
  v_pk_fma_f32 v[50:51], v[50:51], s[22:23], s[22:23]
  v_pk_fma_f32 v[52:53], v[52:53], s[22:23], s[22:23]
  v_pk_fma_f32 v[54:55], v[54:55], s[22:23], s[22:23]
  v_pk_fma_f32 v[56:57], v[56:57], s[22:23], s[22:23]
  v_pk_fma_f32 v[58:59], v[58:59], s[22:23], s[22:23]
  v_pk_fma_f32 v[60:61], v[60:61], s[22:23], s[22:23]
  v_pk_fma_f32 v[62:63], v[62:63], s[22:23], s[22:23]
  v_mfma_f32_32x32x16_bf16 v[32:47], a[144:147], v[160:163], 0
  ds_read_b128 v[192:195], v0 offset:36864
  ds_read_b128 v[196:199], v0 offset:37888
  v_rcp_f32 v48, v48
  v_rcp_f32 v49, v49
  v_mfma_f32_32x32x16_bf16 v[32:47], a[148:151], v[164:167], v[32:47]
  ds_read_b128 v[200:203], v0 offset:38912
  ds_read_b128 v[204:207], v0 offset:39936
  v_rcp_f32 v50, v50
  v_rcp_f32 v51, v51
  v_mfma_f32_32x32x16_bf16 v[32:47], a[152:155], v[168:171], v[32:47]
  ds_read_b128 v[208:211], v0 offset:40960
  ds_read_b128 v[212:215], v0 offset:41984
  v_rcp_f32 v52, v52
  v_rcp_f32 v53, v53
  v_mfma_f32_32x32x16_bf16 v[32:47], a[156:159], v[172:175], v[32:47]
  v_rcp_f32 v54, v54
  v_rcp_f32 v55, v55
  v_rcp_f32_e64 v56, v56
  v_mfma_f32_32x32x16_bf16 v[32:47], a[160:163], v[176:179], v[32:47]
  v_rcp_f32 v57, v57
  v_rcp_f32 v58, v58
  v_rcp_f32_e64 v59, v59
  v_mfma_f32_32x32x16_bf16 v[32:47], a[164:167], v[180:183], v[32:47]
  s_waitcnt lgkmcnt(0)
  v_rcp_f32 v60, v60
  v_rcp_f32 v61, v61
  v_rcp_f32 v62, v62
  v_rcp_f32_e64 v63, v63
  v_pk_mul_f32 v[16:17], v[16:17], v[48:49]
  v_pk_mul_f32 v[18:19], v[18:19], v[50:51]
  v_pk_mul_f32 v[20:21], v[20:21], v[52:53]
  v_pk_mul_f32 v[22:23], v[22:23], v[54:55]
  v_pk_mul_f32 v[24:25], v[24:25], v[56:57]
  v_pk_mul_f32 v[26:27], v[26:27], v[58:59]
  v_pk_mul_f32 v[28:29], v[28:29], v[60:61]
  v_pk_mul_f32 v[30:31], v[30:31], v[62:63]
  v_pk_fma_f32 v[48:49], v[32:33], v[32:33], s[20:21] neg_lo:[1,0,1] neg_hi:[1,0,1]
  v_pk_fma_f32 v[50:51], v[34:35], v[34:35], s[20:21] neg_lo:[1,0,1] neg_hi:[1,0,1]
  v_pk_fma_f32 v[52:53], v[36:37], v[36:37], s[20:21] neg_lo:[1,0,1] neg_hi:[1,0,1]
  v_pk_fma_f32 v[54:55], v[38:39], v[38:39], s[20:21] neg_lo:[1,0,1] neg_hi:[1,0,1]
  v_pk_fma_f32 v[56:57], v[40:41], v[40:41], s[20:21] neg_lo:[1,0,1] neg_hi:[1,0,1]
  v_pk_fma_f32 v[58:59], v[42:43], v[42:43], s[20:21] neg_lo:[1,0,1] neg_hi:[1,0,1]
  v_pk_fma_f32 v[60:61], v[44:45], v[44:45], s[20:21] neg_lo:[1,0,1] neg_hi:[1,0,1]
  v_pk_fma_f32 v[62:63], v[46:47], v[46:47], s[20:21] neg_lo:[1,0,1] neg_hi:[1,0,1]
  v_pk_mul_f32 v[48:49], v[32:33], v[48:49]
  v_pk_mul_f32 v[50:51], v[34:35], v[50:51]
  v_pk_mul_f32 v[52:53], v[36:37], v[52:53]
  v_pk_mul_f32 v[54:55], v[38:39], v[54:55]
  v_pk_mul_f32 v[56:57], v[40:41], v[56:57]
  v_cvt_pk_bf16_f32 v184, v16, v17
  v_cvt_pk_bf16_f32 v185, v18, v19
  v_cvt_pk_bf16_f32 v186, v20, v21
  v_cvt_pk_bf16_f32 v187, v22, v23
  v_pk_mul_f32 v[58:59], v[42:43], v[58:59]
  v_pk_mul_f32 v[60:61], v[44:45], v[60:61]
  v_pk_mul_f32 v[62:63], v[46:47], v[62:63]
  v_mfma_f32_32x32x16_bf16 v[64:79], v[192:195], v[184:187], v[64:79]
  v_cvt_pk_bf16_f32 v188, v24, v25
  v_cvt_pk_bf16_f32 v189, v26, v27
  v_cvt_pk_bf16_f32 v190, v28, v29
  v_cvt_pk_bf16_f32 v191, v30, v31
  v_exp_f32_e64 v48, v48
  v_mfma_f32_32x32x16_bf16 v[80:95], v[196:199], v[184:187], v[80:95]
  v_exp_f32 v49, v49
  v_exp_f32 v50, v50
  v_exp_f32_e64 v51, v51
  v_mfma_f32_32x32x16_bf16 v[96:111], v[200:203], v[184:187], v[96:111]
  v_exp_f32 v52, v52
  v_exp_f32 v53, v53
  v_exp_f32_e64 v54, v54
  v_mfma_f32_32x32x16_bf16 v[64:79], v[204:207], v[188:191], v[64:79]
  v_exp_f32 v55, v55
  v_exp_f32 v56, v56
  v_exp_f32_e64 v57, v57
  v_mfma_f32_32x32x16_bf16 v[80:95], v[208:211], v[188:191], v[80:95]
  v_exp_f32 v58, v58
  v_exp_f32 v59, v59
  v_exp_f32_e64 v60, v60
  v_mfma_f32_32x32x16_bf16 v[96:111], v[212:215], v[188:191], v[96:111]
  v_exp_f32 v61, v61
  v_exp_f32 v62, v62
  v_exp_f32_e64 v63, v63
  v_pk_fma_f32 v[48:49], v[48:49], s[22:23], s[22:23]
  v_pk_fma_f32 v[50:51], v[50:51], s[22:23], s[22:23]
  v_pk_fma_f32 v[52:53], v[52:53], s[22:23], s[22:23]
  v_pk_fma_f32 v[54:55], v[54:55], s[22:23], s[22:23]
  v_pk_fma_f32 v[56:57], v[56:57], s[22:23], s[22:23]
  v_pk_fma_f32 v[58:59], v[58:59], s[22:23], s[22:23]
  v_pk_fma_f32 v[60:61], v[60:61], s[22:23], s[22:23]
  v_pk_fma_f32 v[62:63], v[62:63], s[22:23], s[22:23]
  v_mfma_f32_32x32x16_bf16 v[16:31], a[168:171], v[160:163], 0
  ds_read_b128 v[192:195], v0 offset:43008
  ds_read_b128 v[196:199], v0 offset:44032
  v_rcp_f32 v48, v48
  v_rcp_f32 v49, v49
  v_mfma_f32_32x32x16_bf16 v[16:31], a[172:175], v[164:167], v[16:31]
  ds_read_b128 v[200:203], v0 offset:45056
  ds_read_b128 v[204:207], v0 offset:46080
  v_rcp_f32 v50, v50
  v_rcp_f32 v51, v51
  v_mfma_f32_32x32x16_bf16 v[16:31], a[176:179], v[168:171], v[16:31]
  ds_read_b128 v[208:211], v0 offset:47104
  ds_read_b128 v[212:215], v0 offset:48128
  v_rcp_f32 v52, v52
  v_rcp_f32 v53, v53
  v_mfma_f32_32x32x16_bf16 v[16:31], a[180:183], v[172:175], v[16:31]
  buffer_store_dwordx4 v[128:131], v10, s[8:11], s28 offen offset:128
  v_rcp_f32 v54, v54
  v_rcp_f32 v55, v55
  v_mfma_f32_32x32x16_bf16 v[16:31], a[184:187], v[176:179], v[16:31]
  v_rcp_f32 v56, v56
  v_rcp_f32 v57, v57
  v_rcp_f32_e64 v58, v58
  v_mfma_f32_32x32x16_bf16 v[16:31], a[188:191], v[180:183], v[16:31]
  s_waitcnt lgkmcnt(0)
  v_rcp_f32 v59, v59
  v_rcp_f32 v60, v60
  v_rcp_f32 v61, v61
  v_rcp_f32 v62, v62
  v_rcp_f32 v63, v63
  v_pk_mul_f32 v[32:33], v[32:33], v[48:49]
  v_pk_mul_f32 v[34:35], v[34:35], v[50:51]
  v_pk_mul_f32 v[36:37], v[36:37], v[52:53]
  v_pk_mul_f32 v[38:39], v[38:39], v[54:55]
  v_pk_mul_f32 v[40:41], v[40:41], v[56:57]
  v_pk_mul_f32 v[42:43], v[42:43], v[58:59]
  v_pk_mul_f32 v[44:45], v[44:45], v[60:61]
  v_pk_mul_f32 v[46:47], v[46:47], v[62:63]
  v_pk_fma_f32 v[48:49], v[16:17], v[16:17], s[20:21] neg_lo:[1,0,1] neg_hi:[1,0,1]
  v_pk_fma_f32 v[50:51], v[18:19], v[18:19], s[20:21] neg_lo:[1,0,1] neg_hi:[1,0,1]
  v_pk_fma_f32 v[52:53], v[20:21], v[20:21], s[20:21] neg_lo:[1,0,1] neg_hi:[1,0,1]
  v_pk_fma_f32 v[54:55], v[22:23], v[22:23], s[20:21] neg_lo:[1,0,1] neg_hi:[1,0,1]
  v_pk_fma_f32 v[56:57], v[24:25], v[24:25], s[20:21] neg_lo:[1,0,1] neg_hi:[1,0,1]
  v_pk_fma_f32 v[58:59], v[26:27], v[26:27], s[20:21] neg_lo:[1,0,1] neg_hi:[1,0,1]
  v_pk_fma_f32 v[60:61], v[28:29], v[28:29], s[20:21] neg_lo:[1,0,1] neg_hi:[1,0,1]
  v_pk_fma_f32 v[62:63], v[30:31], v[30:31], s[20:21] neg_lo:[1,0,1] neg_hi:[1,0,1]
  v_pk_mul_f32 v[48:49], v[16:17], v[48:49]
  v_pk_mul_f32 v[50:51], v[18:19], v[50:51]
  v_pk_mul_f32 v[52:53], v[20:21], v[52:53]
  v_pk_mul_f32 v[54:55], v[22:23], v[54:55]
  v_pk_mul_f32 v[56:57], v[24:25], v[56:57]
  v_cvt_pk_bf16_f32 v184, v32, v33
  v_cvt_pk_bf16_f32 v185, v34, v35
  v_cvt_pk_bf16_f32 v186, v36, v37
  v_cvt_pk_bf16_f32 v187, v38, v39
  v_pk_mul_f32 v[58:59], v[26:27], v[58:59]
  v_pk_mul_f32 v[60:61], v[28:29], v[60:61]
  v_pk_mul_f32 v[62:63], v[30:31], v[62:63]
  v_mfma_f32_32x32x16_bf16 v[64:79], v[192:195], v[184:187], v[64:79]
  v_cvt_pk_bf16_f32 v188, v40, v41
  v_cvt_pk_bf16_f32 v189, v42, v43
  v_cvt_pk_bf16_f32 v190, v44, v45
  v_cvt_pk_bf16_f32 v191, v46, v47
  v_exp_f32_e64 v48, v48
  v_mfma_f32_32x32x16_bf16 v[80:95], v[196:199], v[184:187], v[80:95]
  v_exp_f32 v49, v49
  v_exp_f32 v50, v50
  v_exp_f32_e64 v51, v51
  v_mfma_f32_32x32x16_bf16 v[96:111], v[200:203], v[184:187], v[96:111]
  v_exp_f32 v52, v52
  v_exp_f32 v53, v53
  v_exp_f32_e64 v54, v54
  v_mfma_f32_32x32x16_bf16 v[64:79], v[204:207], v[188:191], v[64:79]
  v_exp_f32 v55, v55
  v_exp_f32 v56, v56
  v_exp_f32_e64 v57, v57
  v_mfma_f32_32x32x16_bf16 v[80:95], v[208:211], v[188:191], v[80:95]
  v_exp_f32 v58, v58
  v_exp_f32 v59, v59
  v_exp_f32_e64 v60, v60
  v_mfma_f32_32x32x16_bf16 v[96:111], v[212:215], v[188:191], v[96:111]
  v_exp_f32 v61, v61
  v_exp_f32 v62, v62
  v_exp_f32_e64 v63, v63
  v_pk_fma_f32 v[48:49], v[48:49], s[22:23], s[22:23]
  v_pk_fma_f32 v[50:51], v[50:51], s[22:23], s[22:23]
  v_pk_fma_f32 v[52:53], v[52:53], s[22:23], s[22:23]
  v_pk_fma_f32 v[54:55], v[54:55], s[22:23], s[22:23]
  v_pk_fma_f32 v[56:57], v[56:57], s[22:23], s[22:23]
  v_pk_fma_f32 v[58:59], v[58:59], s[22:23], s[22:23]
  v_pk_fma_f32 v[60:61], v[60:61], s[22:23], s[22:23]
  v_pk_fma_f32 v[62:63], v[62:63], s[22:23], s[22:23]
  v_mfma_f32_32x32x16_bf16 v[32:47], a[192:195], v[160:163], 0
  ds_read_b128 v[192:195], v0 offset:49152
  ds_read_b128 v[196:199], v0 offset:50176
  v_rcp_f32 v48, v48
  v_rcp_f32 v49, v49
  v_mfma_f32_32x32x16_bf16 v[32:47], a[196:199], v[164:167], v[32:47]
  ds_read_b128 v[200:203], v0 offset:51200
  ds_read_b128 v[204:207], v0 offset:52224
  v_rcp_f32 v50, v50
  v_rcp_f32 v51, v51
  v_mfma_f32_32x32x16_bf16 v[32:47], a[200:203], v[168:171], v[32:47]
  ds_read_b128 v[208:211], v0 offset:53248
  ds_read_b128 v[212:215], v0 offset:54272
  v_rcp_f32 v52, v52
  v_rcp_f32 v53, v53
  v_mfma_f32_32x32x16_bf16 v[32:47], a[204:207], v[172:175], v[32:47]
  buffer_store_dwordx4 v[132:135], v10, s[8:11], s28 offen offset:160
  v_rcp_f32 v54, v54
  v_rcp_f32 v55, v55
  v_mfma_f32_32x32x16_bf16 v[32:47], a[208:211], v[176:179], v[32:47]
  v_rcp_f32 v56, v56
  v_rcp_f32 v57, v57
  v_rcp_f32_e64 v58, v58
  v_mfma_f32_32x32x16_bf16 v[32:47], a[212:215], v[180:183], v[32:47]
  s_waitcnt lgkmcnt(0)
  v_rcp_f32 v59, v59
  v_rcp_f32 v60, v60
  v_rcp_f32 v61, v61
  v_rcp_f32 v62, v62
  v_rcp_f32 v63, v63
  v_pk_mul_f32 v[16:17], v[16:17], v[48:49]
  v_pk_mul_f32 v[18:19], v[18:19], v[50:51]
  v_pk_mul_f32 v[20:21], v[20:21], v[52:53]
  v_pk_mul_f32 v[22:23], v[22:23], v[54:55]
  v_pk_mul_f32 v[24:25], v[24:25], v[56:57]
  v_pk_mul_f32 v[26:27], v[26:27], v[58:59]
  v_pk_mul_f32 v[28:29], v[28:29], v[60:61]
  v_pk_mul_f32 v[30:31], v[30:31], v[62:63]
  v_pk_fma_f32 v[48:49], v[32:33], v[32:33], s[20:21] neg_lo:[1,0,1] neg_hi:[1,0,1]
  v_pk_fma_f32 v[50:51], v[34:35], v[34:35], s[20:21] neg_lo:[1,0,1] neg_hi:[1,0,1]
  v_pk_fma_f32 v[52:53], v[36:37], v[36:37], s[20:21] neg_lo:[1,0,1] neg_hi:[1,0,1]
  v_pk_fma_f32 v[54:55], v[38:39], v[38:39], s[20:21] neg_lo:[1,0,1] neg_hi:[1,0,1]
  v_pk_fma_f32 v[56:57], v[40:41], v[40:41], s[20:21] neg_lo:[1,0,1] neg_hi:[1,0,1]
  v_pk_fma_f32 v[58:59], v[42:43], v[42:43], s[20:21] neg_lo:[1,0,1] neg_hi:[1,0,1]
  v_pk_fma_f32 v[60:61], v[44:45], v[44:45], s[20:21] neg_lo:[1,0,1] neg_hi:[1,0,1]
  v_pk_fma_f32 v[62:63], v[46:47], v[46:47], s[20:21] neg_lo:[1,0,1] neg_hi:[1,0,1]
  v_pk_mul_f32 v[48:49], v[32:33], v[48:49]
  v_pk_mul_f32 v[50:51], v[34:35], v[50:51]
  v_pk_mul_f32 v[52:53], v[36:37], v[52:53]
  v_pk_mul_f32 v[54:55], v[38:39], v[54:55]
  v_pk_mul_f32 v[56:57], v[40:41], v[56:57]
  v_cvt_pk_bf16_f32 v184, v16, v17
  v_cvt_pk_bf16_f32 v185, v18, v19
  v_cvt_pk_bf16_f32 v186, v20, v21
  v_cvt_pk_bf16_f32 v187, v22, v23
  v_pk_mul_f32 v[58:59], v[42:43], v[58:59]
  v_pk_mul_f32 v[60:61], v[44:45], v[60:61]
  v_pk_mul_f32 v[62:63], v[46:47], v[62:63]
  v_mfma_f32_32x32x16_bf16 v[64:79], v[192:195], v[184:187], v[64:79]
  v_cvt_pk_bf16_f32 v188, v24, v25
  v_cvt_pk_bf16_f32 v189, v26, v27
  v_cvt_pk_bf16_f32 v190, v28, v29
  v_cvt_pk_bf16_f32 v191, v30, v31
  v_exp_f32_e64 v48, v48
  v_mfma_f32_32x32x16_bf16 v[80:95], v[196:199], v[184:187], v[80:95]
  v_exp_f32 v49, v49
  v_exp_f32 v50, v50
  v_exp_f32_e64 v51, v51
  v_mfma_f32_32x32x16_bf16 v[96:111], v[200:203], v[184:187], v[96:111]
  v_exp_f32 v52, v52
  v_exp_f32 v53, v53
  v_exp_f32_e64 v54, v54
  v_mfma_f32_32x32x16_bf16 v[64:79], v[204:207], v[188:191], v[64:79]
  v_exp_f32 v55, v55
  v_exp_f32 v56, v56
  v_exp_f32_e64 v57, v57
  v_mfma_f32_32x32x16_bf16 v[80:95], v[208:211], v[188:191], v[80:95]
  v_exp_f32 v58, v58
  v_exp_f32 v59, v59
  v_exp_f32_e64 v60, v60
  v_mfma_f32_32x32x16_bf16 v[96:111], v[212:215], v[188:191], v[96:111]
  v_exp_f32 v61, v61
  v_exp_f32 v62, v62
  v_exp_f32_e64 v63, v63
  v_pk_fma_f32 v[48:49], v[48:49], s[22:23], s[22:23]
  v_pk_fma_f32 v[50:51], v[50:51], s[22:23], s[22:23]
  v_pk_fma_f32 v[52:53], v[52:53], s[22:23], s[22:23]
  v_pk_fma_f32 v[54:55], v[54:55], s[22:23], s[22:23]
  v_pk_fma_f32 v[56:57], v[56:57], s[22:23], s[22:23]
  v_pk_fma_f32 v[58:59], v[58:59], s[22:23], s[22:23]
  v_pk_fma_f32 v[60:61], v[60:61], s[22:23], s[22:23]
  v_pk_fma_f32 v[62:63], v[62:63], s[22:23], s[22:23]
  v_mfma_f32_32x32x16_bf16 v[16:31], a[216:219], v[160:163], 0
  ds_read_b128 v[192:195], v0 offset:55296
  ds_read_b128 v[196:199], v0 offset:56320
  v_rcp_f32 v48, v48
  v_rcp_f32 v49, v49
  v_mfma_f32_32x32x16_bf16 v[16:31], a[220:223], v[164:167], v[16:31]
  ds_read_b128 v[200:203], v0 offset:57344
  ds_read_b128 v[204:207], v0 offset:58368
  v_rcp_f32 v50, v50
  v_rcp_f32 v51, v51
  v_mfma_f32_32x32x16_bf16 v[16:31], a[224:227], v[168:171], v[16:31]
  ds_read_b128 v[208:211], v0 offset:59392
  ds_read_b128 v[212:215], v0 offset:60416
  v_rcp_f32 v52, v52
  v_rcp_f32 v53, v53
  v_mfma_f32_32x32x16_bf16 v[16:31], a[228:231], v[172:175], v[16:31]
  v_rcp_f32 v54, v54
  v_rcp_f32 v55, v55
  v_rcp_f32_e64 v56, v56
  v_mfma_f32_32x32x16_bf16 v[16:31], a[232:235], v[176:179], v[16:31]
  v_rcp_f32 v57, v57
  v_rcp_f32 v58, v58
  v_rcp_f32_e64 v59, v59
  v_mfma_f32_32x32x16_bf16 v[16:31], a[236:239], v[180:183], v[16:31]
  s_waitcnt lgkmcnt(0)
  v_rcp_f32 v60, v60
  v_rcp_f32 v61, v61
  v_rcp_f32 v62, v62
  v_rcp_f32_e64 v63, v63
  v_pk_mul_f32 v[32:33], v[32:33], v[48:49]
  v_pk_mul_f32 v[34:35], v[34:35], v[50:51]
  v_pk_mul_f32 v[36:37], v[36:37], v[52:53]
  v_pk_mul_f32 v[38:39], v[38:39], v[54:55]
  v_pk_mul_f32 v[40:41], v[40:41], v[56:57]
  v_pk_mul_f32 v[42:43], v[42:43], v[58:59]
  v_pk_mul_f32 v[44:45], v[44:45], v[60:61]
  v_pk_mul_f32 v[46:47], v[46:47], v[62:63]
  v_pk_fma_f32 v[48:49], v[16:17], v[16:17], s[20:21] neg_lo:[1,0,1] neg_hi:[1,0,1]
  v_pk_fma_f32 v[50:51], v[18:19], v[18:19], s[20:21] neg_lo:[1,0,1] neg_hi:[1,0,1]
  v_pk_fma_f32 v[52:53], v[20:21], v[20:21], s[20:21] neg_lo:[1,0,1] neg_hi:[1,0,1]
  v_pk_fma_f32 v[54:55], v[22:23], v[22:23], s[20:21] neg_lo:[1,0,1] neg_hi:[1,0,1]
  v_pk_fma_f32 v[56:57], v[24:25], v[24:25], s[20:21] neg_lo:[1,0,1] neg_hi:[1,0,1]
  v_pk_fma_f32 v[58:59], v[26:27], v[26:27], s[20:21] neg_lo:[1,0,1] neg_hi:[1,0,1]
  v_pk_fma_f32 v[60:61], v[28:29], v[28:29], s[20:21] neg_lo:[1,0,1] neg_hi:[1,0,1]
  v_pk_fma_f32 v[62:63], v[30:31], v[30:31], s[20:21] neg_lo:[1,0,1] neg_hi:[1,0,1]
  v_pk_mul_f32 v[48:49], v[16:17], v[48:49]
  v_pk_mul_f32 v[50:51], v[18:19], v[50:51]
  v_pk_mul_f32 v[52:53], v[20:21], v[52:53]
  v_pk_mul_f32 v[54:55], v[22:23], v[54:55]
  v_pk_mul_f32 v[56:57], v[24:25], v[56:57]
  v_cvt_pk_bf16_f32 v184, v32, v33
  v_cvt_pk_bf16_f32 v185, v34, v35
  v_cvt_pk_bf16_f32 v186, v36, v37
  v_cvt_pk_bf16_f32 v187, v38, v39
  v_pk_mul_f32 v[58:59], v[26:27], v[58:59]
  v_pk_mul_f32 v[60:61], v[28:29], v[60:61]
  v_pk_mul_f32 v[62:63], v[30:31], v[62:63]
  v_mfma_f32_32x32x16_bf16 v[64:79], v[192:195], v[184:187], v[64:79]
  ds_read_b128 v[216:219], v0 offset:12288
  ds_read_b128 v[220:223], v0 offset:13312
  v_cvt_pk_bf16_f32 v188, v40, v41
  v_cvt_pk_bf16_f32 v189, v42, v43
  v_cvt_pk_bf16_f32 v190, v44, v45
  v_cvt_pk_bf16_f32 v191, v46, v47
  v_mfma_f32_32x32x16_bf16 v[80:95], v[196:199], v[184:187], v[80:95]
  ds_read_b128 v[224:227], v0 offset:14336
  ds_read_b128 v[228:231], v0 offset:15360
  v_exp_f32 v48, v48
  v_exp_f32 v49, v49
  v_mfma_f32_32x32x16_bf16 v[96:111], v[200:203], v[184:187], v[96:111]
  ds_read_b128 v[232:235], v0 offset:16384
  ds_read_b128 v[236:239], v0 offset:17408
  v_exp_f32 v50, v50
  v_exp_f32 v51, v51
  v_mfma_f32_32x32x16_bf16 v[64:79], v[204:207], v[188:191], v[64:79]
  s_mov_b32 s28, s34
  v_exp_f32 v52, v52
  v_exp_f32 v53, v53
  v_exp_f32 v54, v54
  v_mfma_f32_32x32x16_bf16 v[80:95], v[208:211], v[188:191], v[80:95]
  s_add_u32 s34, s34, 0x60000
  v_exp_f32 v55, v55
  v_exp_f32 v56, v56
  v_exp_f32_e64 v57, v57
  v_mfma_f32_32x32x16_bf16 v[96:111], v[212:215], v[188:191], v[96:111]
  s_waitcnt lgkmcnt(0)
  v_exp_f32 v58, v58
  v_exp_f32 v59, v59
  v_exp_f32 v60, v60
  v_exp_f32 v61, v61
  v_exp_f32 v62, v62
  v_exp_f32_e64 v63, v63
  v_pk_fma_f32 v[48:49], v[48:49], s[22:23], s[22:23]
  v_pk_fma_f32 v[50:51], v[50:51], s[22:23], s[22:23]
  v_pk_fma_f32 v[52:53], v[52:53], s[22:23], s[22:23]
  v_pk_fma_f32 v[54:55], v[54:55], s[22:23], s[22:23]
  v_pk_fma_f32 v[56:57], v[56:57], s[22:23], s[22:23]
  v_pk_fma_f32 v[58:59], v[58:59], s[22:23], s[22:23]
  v_pk_fma_f32 v[60:61], v[60:61], s[22:23], s[22:23]
  v_pk_fma_f32 v[62:63], v[62:63], s[22:23], s[22:23]
  v_mfma_f32_32x32x16_bf16 v[32:47], v[216:219], v[160:163], 0
  ds_read_b128 v[192:195], v0 offset:61440
  ds_read_b128 v[196:199], v0 offset:62464
  v_rcp_f32 v48, v48
  v_rcp_f32 v49, v49
  v_mfma_f32_32x32x16_bf16 v[32:47], v[220:223], v[164:167], v[32:47]
  ds_read_b128 v[200:203], v0 offset:63488
  ds_read_b128 v[204:207], v0 offset:64512
  v_rcp_f32 v50, v50
  v_rcp_f32 v51, v51
  v_mfma_f32_32x32x16_bf16 v[32:47], v[224:227], v[168:171], v[32:47]
  ds_read_b128 v[208:211], v1
  ds_read_b128 v[212:215], v1 offset:1024
  v_rcp_f32 v52, v52
  v_rcp_f32 v53, v53
  v_mfma_f32_32x32x16_bf16 v[32:47], v[228:231], v[172:175], v[32:47]
  v_rcp_f32 v54, v54
  v_rcp_f32 v55, v55
  v_rcp_f32_e64 v56, v56
  v_mfma_f32_32x32x16_bf16 v[32:47], v[232:235], v[176:179], v[32:47]
  v_rcp_f32 v57, v57
  v_rcp_f32 v58, v58
  v_rcp_f32_e64 v59, v59
  v_mfma_f32_32x32x16_bf16 v[32:47], v[236:239], v[180:183], v[32:47]
  s_waitcnt lgkmcnt(0)
  v_rcp_f32 v60, v60
  v_rcp_f32 v61, v61
  v_rcp_f32 v62, v62
  v_rcp_f32_e64 v63, v63
  v_pk_mul_f32 v[16:17], v[16:17], v[48:49]
  v_pk_mul_f32 v[18:19], v[18:19], v[50:51]
  v_pk_mul_f32 v[20:21], v[20:21], v[52:53]
  v_pk_mul_f32 v[22:23], v[22:23], v[54:55]
  v_pk_mul_f32 v[24:25], v[24:25], v[56:57]
  v_pk_mul_f32 v[26:27], v[26:27], v[58:59]
  v_pk_mul_f32 v[28:29], v[28:29], v[60:61]
  v_pk_mul_f32 v[30:31], v[30:31], v[62:63]
  v_pk_fma_f32 v[48:49], v[32:33], v[32:33], s[20:21] neg_lo:[1,0,1] neg_hi:[1,0,1]
  v_pk_fma_f32 v[50:51], v[34:35], v[34:35], s[20:21] neg_lo:[1,0,1] neg_hi:[1,0,1]
  v_pk_fma_f32 v[52:53], v[36:37], v[36:37], s[20:21] neg_lo:[1,0,1] neg_hi:[1,0,1]
  v_pk_fma_f32 v[54:55], v[38:39], v[38:39], s[20:21] neg_lo:[1,0,1] neg_hi:[1,0,1]
  v_pk_fma_f32 v[56:57], v[40:41], v[40:41], s[20:21] neg_lo:[1,0,1] neg_hi:[1,0,1]
  v_pk_fma_f32 v[58:59], v[42:43], v[42:43], s[20:21] neg_lo:[1,0,1] neg_hi:[1,0,1]
  v_pk_fma_f32 v[60:61], v[44:45], v[44:45], s[20:21] neg_lo:[1,0,1] neg_hi:[1,0,1]
  v_pk_fma_f32 v[62:63], v[46:47], v[46:47], s[20:21] neg_lo:[1,0,1] neg_hi:[1,0,1]
  v_pk_mul_f32 v[48:49], v[32:33], v[48:49]
  v_pk_mul_f32 v[50:51], v[34:35], v[50:51]
  v_pk_mul_f32 v[52:53], v[36:37], v[52:53]
  v_pk_mul_f32 v[54:55], v[38:39], v[54:55]
  v_pk_mul_f32 v[56:57], v[40:41], v[56:57]
  v_cvt_pk_bf16_f32 v184, v16, v17
  v_cvt_pk_bf16_f32 v185, v18, v19
  v_cvt_pk_bf16_f32 v186, v20, v21
  v_cvt_pk_bf16_f32 v187, v22, v23
  v_pk_mul_f32 v[58:59], v[42:43], v[58:59]
  v_pk_mul_f32 v[60:61], v[44:45], v[60:61]
  v_pk_mul_f32 v[62:63], v[46:47], v[62:63]
  v_mfma_f32_32x32x16_bf16 v[64:79], v[192:195], v[184:187], v[64:79]
  v_cvt_pk_bf16_f32 v188, v24, v25
  v_cvt_pk_bf16_f32 v189, v26, v27
  v_cvt_pk_bf16_f32 v190, v28, v29
  v_cvt_pk_bf16_f32 v191, v30, v31
  v_exp_f32_e64 v48, v48
  v_mfma_f32_32x32x16_bf16 v[80:95], v[196:199], v[184:187], v[80:95]
  v_exp_f32 v49, v49
  v_exp_f32 v50, v50
  v_exp_f32_e64 v51, v51
  v_mfma_f32_32x32x16_bf16 v[96:111], v[200:203], v[184:187], v[96:111]
  v_exp_f32 v52, v52
  v_exp_f32 v53, v53
  v_exp_f32_e64 v54, v54
  v_mfma_f32_32x32x16_bf16 v[64:79], v[204:207], v[188:191], v[64:79]
  v_exp_f32 v55, v55
  v_exp_f32 v56, v56
  v_exp_f32_e64 v57, v57
  v_mfma_f32_32x32x16_bf16 v[80:95], v[208:211], v[188:191], v[80:95]
  v_exp_f32 v58, v58
  v_exp_f32 v59, v59
  v_exp_f32_e64 v60, v60
  v_mfma_f32_32x32x16_bf16 v[96:111], v[212:215], v[188:191], v[96:111]
  v_exp_f32 v61, v61
  v_exp_f32 v62, v62
  v_exp_f32_e64 v63, v63
  v_pk_fma_f32 v[48:49], v[48:49], s[22:23], s[22:23]
  v_pk_fma_f32 v[50:51], v[50:51], s[22:23], s[22:23]
  v_pk_fma_f32 v[52:53], v[52:53], s[22:23], s[22:23]
  v_pk_fma_f32 v[54:55], v[54:55], s[22:23], s[22:23]
  v_pk_fma_f32 v[56:57], v[56:57], s[22:23], s[22:23]
  v_pk_fma_f32 v[58:59], v[58:59], s[22:23], s[22:23]
  v_pk_fma_f32 v[60:61], v[60:61], s[22:23], s[22:23]
  v_pk_fma_f32 v[62:63], v[62:63], s[22:23], s[22:23]
  ds_read_b128 v[192:195], v1 offset:2048
  ds_read_b128 v[196:199], v1 offset:3072
  ds_read_b128 v[200:203], v1 offset:4096
  ds_read_b128 v[204:207], v1 offset:5120
  ds_read_b128 v[208:211], v1 offset:6144
  ds_read_b128 v[212:215], v1 offset:7168
  v_rcp_f32 v48, v48
  v_rcp_f32 v49, v49
  v_rcp_f32 v50, v50
  v_rcp_f32 v51, v51
  v_rcp_f32 v52, v52
  v_rcp_f32 v53, v53
  v_rcp_f32 v54, v54
  v_rcp_f32 v55, v55
  v_rcp_f32 v56, v56
  v_rcp_f32 v57, v57
  v_rcp_f32 v58, v58
  v_rcp_f32 v59, v59
  v_rcp_f32 v60, v60
  v_rcp_f32 v61, v61
  v_rcp_f32 v62, v62
  v_rcp_f32 v63, v63
  v_pk_mul_f32 v[32:33], v[32:33], v[48:49]
  v_pk_mul_f32 v[34:35], v[34:35], v[50:51]
  v_pk_mul_f32 v[36:37], v[36:37], v[52:53]
  v_pk_mul_f32 v[38:39], v[38:39], v[54:55]
  v_pk_mul_f32 v[40:41], v[40:41], v[56:57]
  v_pk_mul_f32 v[42:43], v[42:43], v[58:59]
  v_pk_mul_f32 v[44:45], v[44:45], v[60:61]
  v_pk_mul_f32 v[46:47], v[46:47], v[62:63]
  v_cvt_pk_bf16_f32 v184, v32, v33
  v_cvt_pk_bf16_f32 v185, v34, v35
  v_cvt_pk_bf16_f32 v186, v36, v37
  v_cvt_pk_bf16_f32 v187, v38, v39
  v_cvt_pk_bf16_f32 v188, v40, v41
  v_cvt_pk_bf16_f32 v189, v42, v43
  v_cvt_pk_bf16_f32 v190, v44, v45
  v_cvt_pk_bf16_f32 v191, v46, v47
  s_waitcnt lgkmcnt(5)
  v_mfma_f32_32x32x16_bf16 v[64:79], v[192:195], v[184:187], v[64:79]
  s_waitcnt lgkmcnt(2)
  v_mfma_f32_32x32x16_bf16 v[64:79], v[204:207], v[188:191], v[64:79]
  v_mfma_f32_32x32x16_bf16 v[80:95], v[196:199], v[184:187], v[80:95]
  s_nop 0
  s_waitcnt lgkmcnt(1)
  v_mfma_f32_32x32x16_bf16 v[80:95], v[208:211], v[188:191], v[80:95]
  v_mfma_f32_32x32x16_bf16 v[96:111], v[200:203], v[184:187], v[96:111]
  s_waitcnt lgkmcnt(0)
  v_mfma_f32_32x32x16_bf16 v[96:111], v[212:215], v[188:191], v[96:111]
  s_nop 5
  v_cvt_pk_bf16_f32 v112, v64, v65
  v_cvt_pk_bf16_f32 v113, v66, v67
  v_cvt_pk_bf16_f32 v114, v68, v69
  v_cvt_pk_bf16_f32 v115, v70, v71
  buffer_store_dwordx4 v[112:115], v10, s[8:11], s28 offen
  v_cvt_pk_bf16_f32 v116, v72, v73
  v_cvt_pk_bf16_f32 v117, v74, v75
  v_cvt_pk_bf16_f32 v118, v76, v77
  v_cvt_pk_bf16_f32 v119, v78, v79
  buffer_store_dwordx4 v[116:119], v10, s[8:11], s28 offen offset:32
  v_cvt_pk_bf16_f32 v120, v80, v81
  v_cvt_pk_bf16_f32 v121, v82, v83
  v_cvt_pk_bf16_f32 v122, v84, v85
  v_cvt_pk_bf16_f32 v123, v86, v87
  buffer_store_dwordx4 v[120:123], v10, s[8:11], s28 offen offset:64
  v_cvt_pk_bf16_f32 v124, v88, v89
  v_cvt_pk_bf16_f32 v125, v90, v91
  v_cvt_pk_bf16_f32 v126, v92, v93
  v_cvt_pk_bf16_f32 v127, v94, v95
  buffer_store_dwordx4 v[124:127], v10, s[8:11], s28 offen offset:96
  v_cvt_pk_bf16_f32 v128, v96, v97
  v_cvt_pk_bf16_f32 v129, v98, v99
  v_cvt_pk_bf16_f32 v130, v100, v101
  v_cvt_pk_bf16_f32 v131, v102, v103
  buffer_store_dwordx4 v[128:131], v10, s[8:11], s28 offen offset:128
  v_cvt_pk_bf16_f32 v132, v104, v105
  v_cvt_pk_bf16_f32 v133, v106, v107
  v_cvt_pk_bf16_f32 v134, v108, v109
  v_cvt_pk_bf16_f32 v135, v110, v111
  buffer_store_dwordx4 v[132:135], v10, s[8:11], s28 offen offset:160
S_end:
  s_endpgm
.section .rodata,"a"
.p2align 6
.amdhsa_kernel standalone__modern_conv_block_convnext__vision_kernel
  .amdhsa_next_free_vgpr 512
  .amdhsa_next_free_sgpr 102
  .amdhsa_accum_offset 256
  .amdhsa_group_segment_fixed_size 0
  .amdhsa_kernarg_size 80
  .amdhsa_user_sgpr_count 2
  .amdhsa_user_sgpr_kernarg_segment_ptr 1
  .amdhsa_system_sgpr_workgroup_id_x 1
.end_amdhsa_kernel
```

```asm
; @launch grid=(256,1,1) block=(256,1,1) lds=163840
.amdgcn_target "amdgcn-amd-amdhsa--gfx950"
.text
.globl standalone__modern_conv_block_convnext__vision_kernel
.p2align 8
.type standalone__modern_conv_block_convnext__vision_kernel,@function
standalone__modern_conv_block_convnext__vision_kernel:
  s_cmp_ge_u32 s2, 0x100
  s_cbranch_scc1 L_end
  s_nop 0
  s_load_dwordx2 s[4:5], s[0:1], 0
  s_load_dwordx2 s[60:61], s[0:1], 8
  s_load_dwordx2 s[64:65], s[0:1], 16
  s_load_dwordx2 s[68:69], s[0:1], 24
  s_load_dwordx2 s[72:73], s[0:1], 32
  s_load_dwordx2 s[76:77], s[0:1], 40
  s_load_dwordx2 s[80:81], s[0:1], 48
  s_load_dwordx2 s[8:9], s[0:1], 56
  s_getpc_b64 s[40:41]
L_pc:
  s_lshl_b32 s32, s2, 9
  s_and_b32 s32, s32, 0xf000
  v_lshl_add_u32 v249, v0, 4, s32
  v_lshrrev_b32_e64 v112, 6, v0
  v_min_u32 v249, L_end-L_pc-12, v249
  v_and_b32 v113, 63, v0
  global_load_dwordx4 v[108:111], v249, s[40:41]
  v_readfirstlane_b32 s27, v112
  s_mov_b32 s62, 0x6c0
  s_mov_b32 s63, 0x20000
  s_mov_b32 s82, 0xc0
  s_mov_b32 s83, 0x20000
  s_mov_b32 s78, 0xc0
  s_mov_b32 s79, 0x20000
  s_mov_b32 s66, 0x12000
  s_mov_b32 s67, 0x20000
  s_mov_b32 s74, 0x12000
  s_mov_b32 s75, 0x20000
  v_bfe_u32 v114, v113, 3, 1
  v_bfe_u32 v115, v113, 4, 1
  v_bfe_u32 v116, v113, 2, 1
  v_and_b32 v117, 3, v113
  v_lshlrev_b32 v118, 4, v113
  s_min_u32 s44, s27, 2
  s_lshl_b32 s45, s44, 6
  s_mul_i32 s46, s44, 0x240
  v_lshlrev_b32 v119, 1, v113
  v_and_b32 v120, 31, v113
  v_lshlrev_b32_e64 v121, 1, v120
  v_lshlrev_b32_e64 v122, 4, v115
  v_lshl_add_u32 v122, v116, 3, v122
  v_lshl_add_u32 v122, v114, 2, v122
  v_add_u32_e64 v122, v122, v117
  v_lshlrev_b32_e64 v123, 1, v122
  s_lshr_b32 s35, s2, 3
  s_lshl_b32 s35, s35, 2
  s_add_u32 s35, s35, s27
  s_sub_u32 s55, s35, 0x48
  s_min_u32 s35, s35, s55
  s_lshl_b32 s47, s35, 10
  s_and_b32 s54, s2, 6
  s_lshl_b32 s54, s54, 1
  s_lshr_b32 s32, s2, 6
  s_add_u32 s54, s54, s32
  s_mul_i32 s59, s54, 0x300000
  s_and_b32 s53, s2, 1
  s_lshl_b32 s53, s53, 8
  s_and_b32 s32, s2, 56
  s_lshl_b32 s32, s32, 2
  s_add_u32 s53, s53, s32
  s_lshl_b32 s32, s27, 3
  s_add_u32 s53, s53, s32
  s_mul_i32 s3, s53, 0xc0
  s_add_u32 s3, s3, 0xf40
  s_mov_b32 s6, 0x3000000
  s_mov_b32 s7, 0x20000
  s_cmp_eq_u32 s53, 0
  s_cselect_b32 s35, 12, 0
  s_sub_u32 s55, 0x78, s35
  s_cmp_eq_u32 s53, 0x1f8
  s_cselect_b32 s55, 0x6c, s55
  s_mul_i32 s15, s27, 0x1040
  s_add_u32 s48, s59, 0x17000
  s_add_u32 s49, s59, 0x47000
  s_waitcnt lgkmcnt(0)
  v_add_u32 v124, 64, v113
  buffer_load_dwordx4 v[108:111], v118, s[64:67], s47 offen
  v_subrev_u32 v127, 57, v113
  v_cmp_le_u32 vcc, 57, v113
  buffer_load_dwordx4 v[108:111], v118, s[72:75], s47 offen
  v_add_u32_e64 v125, 7, v113
  v_add_u32 v126, 0x47, v113
  buffer_load_ushort v129, v119, s[60:63], s46 offen
  v_mov_b32 v199, 0x17c00
  v_cndmask_b32_e64 v124, v124, v127, vcc
  buffer_load_ushort v130, v121, s[60:63], s46 offen offset:128
  v_mov_b32 v127, 0xfffffc00
  v_cndmask_b32_e64 v199, v127, v199, vcc
  v_add_u32_e64 v198, s3, v118
  buffer_load_ushort v131, v119, s[60:63], s46 offen offset:192
  v_lshl_add_u32 v199, v124, 4, v199
  v_add_u32_e64 v199, s3, v199
  buffer_load_ushort v132, v119, s[60:63], s46 offen offset:320
  v_add_u32 v200, 0x17870, v198
  v_add_u32 v201, 0x17870, v198
  buffer_load_ushort v133, v119, s[60:63], s46 offen offset:448
  v_mov_b32 v128, 0x80000000
  v_subrev_u32_e64 v6, s35, v113
  buffer_load_ushort v137, v123, s[80:83], s45 offen
  v_cmp_gt_u32 s[36:37], s55, v6
  v_subrev_u32_e64 v7, s35, v124
  v_cmp_gt_u32 s[38:39], s55, v7
  buffer_load_ushort v138, v123, s[76:79], s45 offen
  v_subrev_u32_e64 v8, s35, v125
  v_cmp_gt_u32 s[40:41], s55, v8
  buffer_load_ushort v134, v123, s[80:83], 0 offen
  v_subrev_u32_e64 v9, s35, v126
  v_cmp_gt_u32 s[42:43], s55, v9
  buffer_load_ushort v135, v123, s[80:83], 0 offen offset:64
  v_cndmask_b32 v6, v128, v198, s[36:37]
  v_cndmask_b32 v7, v128, v199, s[38:39]
  buffer_load_ushort v136, v123, s[80:83], 0 offen offset:128
  v_cndmask_b32 v8, v128, v200, s[40:41]
  v_cndmask_b32 v9, v128, v201, s[42:43]
  s_add_u32 m0, s15, 0x4120
  s_nop 0
  buffer_load_dwordx4 v6, s[4:7], s48 offen lds
  buffer_load_dwordx4 v7, s[4:7], s48 offen offset:1024 lds
  buffer_load_dwordx4 v8, s[4:7], s48 offen offset:2048 lds
  buffer_load_dwordx4 v9, s[4:7], s48 offen offset:3072 lds
  s_sub_u32 s56, s59, 0x19000
  v_add_u32 v198, s56, v6
  s_add_u32 s56, s56, 0x400
  v_add_u32_e64 v199, s56, v7
  s_add_u32 s56, s56, 0x400
  v_add_u32_e64 v200, s56, v8
  s_add_u32 s56, s56, 0x400
  v_add_u32 v201, s56, v9
  v_lshrrev_b32 v139, 5, v113
  v_lshlrev_b32_e64 v202, 4, v117
  v_lshl_add_u32 v202, v139, 6, v202
  v_bfe_u32 v124, v113, 3, 2
  v_lshl_add_u32 v124, v116, 2, v124
  v_cmp_eq_u32 vcc, 7, v124
  v_mul_u32_u24 v203, 0x300, v124
  v_add_u32 v203, v203, v202
  v_cndmask_b32_e64 v204, v128, v202, vcc
  s_mov_b32 s70, 0x300
  s_mov_b32 s71, 0x20000
  s_mov_b32 s10, 0x3000000
  s_mov_b32 s11, 0x20000
  s_and_b32 s36, s27, 2
  s_add_u32 s37, s27, 1
  s_lshr_b32 s37, s37, 1
  s_and_b32 s38, s37, 1
  s_cmp_eq_u32 s27, 1
  s_cselect_b32 s39, 0, 3
  s_cselect_b32 s51, 0x1000, 0
  s_lshl_b32 s32, s36, 8
  s_lshl_b32 s33, s37, 8
  s_add_u32 s43, s32, 0x11d00
  s_add_u32 s50, s33, 0x11d00
  s_add_u32 s51, s51, s33
  s_mul_i32 s40, s38, 0x6000
  s_add_u32 s40, s40, s32
  s_mul_i32 s41, s38, 0x1800
  s_add_u32 s41, s41, s32
  s_add_u32 s41, s41, 0x3000
  s_mul_i32 s42, s39, 0x3000
  s_add_u32 s42, s42, s33
  s_mul_i32 s32, s36, 0x6000
  s_lshl_b32 s33, s38, 11
  s_add_u32 s33, s33, s32
  s_add_u32 s33, s33, 0x10000
  v_add_u32_e64 v195, s33, v118
  s_lshl_b32 s33, s38, 3
  s_add_u32 s33, s33, s32
  s_add_u32 s33, s33, 0x10400
  v_add_u32_e64 v196, s33, v118
  s_mul_i32 s32, s37, 0x6000
  s_lshl_b32 s33, s39, 10
  s_add_u32 s33, s33, s32
  s_add_u32 s33, s33, 0x10000
  v_add_u32 v197, s33, v118
  v_add_u32 v125, 16, v113
  v_lshrrev_b32 v125, 6, v125
  v_lshlrev_b32 v125, 4, v125
  v_xor_b32_e64 v254, v125, v118
  v_lshl_add_u32 v125, v139, 4, 16
  buffer_load_dwordx4 a[72:75], v202, s[64:67], s43 offen
  v_xor_b32_e64 v255, v125, v118
  v_mul_u32_u24 v125, 0x1200, v139
  v_add_u32_e64 v255, v125, v255
  v_add_u32 v125, 0xb0, v113
  v_lshrrev_b32 v125, 6, v125
  v_lshlrev_b32 v125, 4, v125
  v_xor_b32_e64 v244, v125, v118
  v_add_u32 v244, 0x1200, v244
  s_mul_i32 s14, s27, 0x1800
  s_add_u32 s32, s27, 3
  s_and_b32 s32, s32, 3
  s_mul_i32 s32, s32, 0x600
  s_cmp_eq_u32 s27, 0
  s_cselect_b32 s57, 0, 3
  s_cselect_b32 s53, 3, 6
  s_cselect_b32 s55, 6, 0
  s_lshl_b32 s57, s57, 13
  s_add_u32 s57, s57, s32
  s_add_u32 s58, s57, 0x3000
  s_lshl_b32 s53, s53, 13
  s_add_u32 s53, s53, s32
  s_add_u32 s54, s53, 0x3000
  s_lshl_b32 s55, s55, 13
  s_add_u32 s55, s55, s32
  s_add_u32 s56, s55, 0x3000
  v_and_b32_e64 v148, 7, v113
  buffer_load_dwordx4 a[76:79], v202, s[64:67], s43 offen offset:128
  v_lshrrev_b32 v149, 4, v113
  v_lshlrev_b32 v150, 4, v139
  v_and_b32 v141, 1, v113
  v_lshlrev_b32 v141, 4, v141
  v_mov_b32 v127, 0xffff
  v_lshlrev_b32_e64 v127, v141, v127
  v_bfe_u32 v125, v113, 1, 2
  v_lshlrev_b32 v125, v125, 1
  v_bfe_i32 v56, v125, 0, 1
  v_mov_b32 v60, 0
  v_and_b32 v56, v56, v127
  v_bfe_i32 v57, v125, 1, 1
  v_mov_b32 v61, 0
  v_and_b32 v57, v57, v127
  v_bfe_i32 v58, v125, 2, 1
  v_mov_b32_e64 v62, 0
  buffer_load_dwordx4 a[80:83], v202, s[64:67], s50 offen
  v_and_b32_e64 v58, v58, v127
  v_bfe_i32 v59, v125, 3, 1
  v_mov_b32 v63, 0
  v_and_b32 v59, v59, v127
  v_min_u32_e64 v125, 11, v113
  v_mul_u32_u24 v125, 0x190, v125
  ds_write_b128 v125, v[60:63] offset:50304
  v_lshrrev_b32 v125, 2, v0
  v_min_u32 v125, 24, v125
  v_lshlrev_b32 v125, 4, v125
  v_or_b32 v125, v125, v117
  v_lshlrev_b32_e64 v125, 4, v125
  ds_write_b128 v125, v[60:63] offset:54720
  v_bfe_i32 v147, v113, 2, 1
  v_xor_b32 v146, -1, v147
  s_lshl_b32 s32, s44, 7
  v_lshrrev_b32_e64 v142, 3, v113
  v_lshl_add_u32 v145, v142, 8, s45
  v_lshl_add_u32 v145, v148, 3, v145
  v_mul_u32_u24 v142, 0x190, v142
  v_lshl_add_u32 v142, v148, 4, v142
  buffer_load_dwordx4 a[84:87], v202, s[64:67], s50 offen offset:128
  v_add_u32 v142, s32, v142
  v_lshrrev_b32 v143, 3, v120
  v_mul_u32_u24 v143, 0x190, v143
  v_lshl_add_u32 v143, v148, 4, v143
  v_add_u32_e64 v143, s32, v143
  v_lshl_add_u32 v144, v120, 2, s32
  v_sub_u32_e64 v125, v149, v116
  v_lshl_add_u32 v126, v114, 2, v117
  v_mul_u32_u24_e64 v140, 48, v139
  v_lshl_add_u32 v140, v115, 1, v140
  v_sub_u32_e64 v140, v140, v116
  v_lshl_add_u32 v140, v140, 3, v126
  v_lshlrev_b32_e64 v140, 3, v140
  v_add_u32 v11, 0xd600, v140
  v_add_u32 v205, 0xde00, v140
  v_lshl_add_u32 v126, v125, 3, v126
  v_min_u32 v126, 24, v126
  v_lshlrev_b32 v126, 4, v126
  v_add_u32 v3, 0xc300, v126
  v_lshlrev_b32_e64 v151, 2, v115
  v_lshl_add_u32 v151, v114, 1, v151
  buffer_load_dwordx4 a[88:91], v204, s[68:71], s51 offen
  v_bfe_u32 v126, v113, 1, 1
  v_add_u32 v151, v151, v126
  v_xor_b32 v126, v116, v139
  v_lshl_add_u32 v151, v126, 3, v151
  v_lshlrev_b32 v151, v151, 1
  v_mov_b32 v126, 0x3f80
  v_lshlrev_b32_e64 v126, v141, v126
  v_mov_b32 v125, 0xbf80
  v_lshlrev_b32_e64 v125, v141, v125
  v_bfe_i32 v216, v151, 0, 1
  v_and_b32 v224, v216, v126
  v_and_b32 v184, v216, v125
  v_bfe_i32 v217, v151, 1, 1
  v_and_b32 v225, v217, v126
  v_and_b32 v185, v217, v125
  v_bfe_i32 v218, v151, 2, 1
  v_and_b32 v226, v218, v126
  v_and_b32 v186, v218, v125
  v_bfe_i32 v219, v151, 3, 1
  v_and_b32 v227, v219, v126
  v_and_b32 v187, v219, v125
  buffer_load_dwordx4 a[92:95], v204, s[68:71], s51 offen offset:128
  v_bfe_i32 v220, v151, 4, 1
  v_and_b32 v228, v220, v126
  v_and_b32 v188, v220, v125
  v_bfe_i32 v221, v151, 5, 1
  v_and_b32 v229, v221, v126
  v_and_b32 v189, v221, v125
  v_bfe_i32 v222, v151, 6, 1
  v_and_b32 v230, v222, v126
  v_and_b32 v190, v222, v125
  v_bfe_i32 v223, v151, 7, 1
  v_and_b32 v231, v223, v126
  v_and_b32 v191, v223, v125
  v_lshl_add_u32 v151, v116, 1, v114
  v_xor_b32_e64 v126, v115, v139
  v_lshl_add_u32 v151, v126, 2, v151
  v_lshlrev_b32 v151, v151, 1
  v_bfe_u32 v240, v151, 0, 1
  v_mul_u32_u24 v240, 0x3f80, v240
  v_bfe_u32 v241, v151, 1, 1
  v_mul_u32_u24 v241, 0x3f80, v241
  v_bfe_u32 v242, v151, 2, 1
  buffer_load_dwordx4 a[0:3], v203, s[64:67], s40 offen
  v_mul_u32_u24 v242, 0x3f80, v242
  v_bfe_u32 v243, v151, 3, 1
  v_mul_u32_u24 v243, 0x3f80, v243
  s_mov_b32 s22, 0x3e9a0000
  s_mov_b32 s24, 0x3c2aaaab
  s_mov_b32 s25, 0x3727c5ac
  s_mov_b32 s20, 0x36553a11
  s_mov_b32 s21, 0x3aa63895
  s_mov_b32 s12, 0
  s_mov_b32 s13, -1
  s_add_u32 s29, s59, 0x77000
  s_add_u32 s52, s59, 0xa7000
  v_mul_u32_u24 v152, 0xc0, v148
  v_add_u32_e64 v127, s15, v152
  v_lshl_add_u32 v153, v114, 1, v149
  v_lshrrev_b32_e64 v125, 1, v153
  v_mul_u32_u24 v140, 0x4100, v125
  v_and_b32_e64 v125, 1, v125
  v_lshl_add_u32 v140, v125, 5, v140
  v_and_b32_e64 v125, 1, v153
  v_mul_u32_u24 v125, 0x790, v125
  buffer_load_dwordx4 a[4:7], v203, s[64:67], s40 offen offset:128
  s_add_u32 s40, s40, 0x1800
  v_add3_u32 v4, v140, v125, v127
  v_lshl_add_u32 v154, v114, 1, v115
  v_add_u32_e64 v153, 1, v154
  v_add_u32 v127, 0xc0, v127
  v_add_u32 v127, v127, v150
  v_lshrrev_b32 v125, 1, v153
  v_mul_u32_u24 v140, 0x4100, v125
  v_and_b32_e64 v125, 1, v125
  v_lshl_add_u32 v140, v125, 5, v140
  v_and_b32_e64 v125, 1, v153
  v_mul_u32_u24 v125, 0x790, v125
  v_add3_u32 v5, v140, v125, v127
  v_mul_u32_u24 v125, 0x18000, v154
  v_add3_u32 v10, v125, v150, v152
  s_sub_u32 s32, s3, 0xf40
  v_add_u32_e64 v10, s32, v10
  v_add_u32 v2, 0xfb40, v150
  v_add_u32 v0, 0x10000, v118
  v_add_u32 v1, 0x20000, v118
  v_and_b32 v125, 15, v113
  v_lshlrev_b32 v125, 7, v125
  buffer_load_dwordx4 a[8:11], v203, s[64:67], s40 offen
  v_mul_u32_u24 v126, 0x18000, v149
  s_sub_u32 s32, s3, 64
  v_add3_u32 v248, v125, v126, s32
  v_mul_u32_u24 v125, 0x5555, v117
  v_and_b32 v126, 2, v113
  v_lshlrev_b32 v126, 15, v126
  v_sub_u32 v125, v125, v126
  v_add_u32 v250, 0x3e9a0000, v125
  s_add_u32 s32, s14, 0x16000
  v_add_u32 v253, s32, v118
  v_bfe_u32 v125, v122, 2, 2
  v_xor_b32 v125, v125, v139
  v_lshl_add_u32 v125, v125, 4, s32
  v_mul_u32_u24 v126, 0xc0, v122
  v_add_u32_e64 v251, v125, v126
  v_xor_b32 v252, 32, v251
  s_add_u32 s30, s15, 32
  s_add_u32 s31, s15, 0x4100
  s_sub_u32 s28, s59, 0x60000
  s_add_u32 s33, s15, 0x8200
  s_mov_b32 s23, 0x60000
  s_mov_b32 s26, 6
  buffer_load_dwordx4 a[12:15], v203, s[64:67], s40 offen offset:128
  buffer_load_dwordx4 a[16:19], v203, s[64:67], s41 offen
  buffer_load_dwordx4 a[20:23], v203, s[64:67], s41 offen offset:128
  s_waitcnt vmcnt(25)
  v_lshl_or_b32 v129, v129, 16, v129
  v_and_b32 v16, v56, v129
  v_and_b32 v17, v57, v129
  v_and_b32 v18, v58, v129
  v_and_b32 v19, v59, v129
  ds_write_b128 v142, v[16:19] offset:49920
  s_waitcnt vmcnt(24)
  v_lshl_or_b32 v130, v130, 16, v130
  v_and_b32 v20, v56, v130
  v_and_b32 v21, v57, v130
  v_and_b32 v22, v58, v130
  v_and_b32_e64 v23, v59, v130
  ds_write_b128 v143, v[20:23] offset:53120
  s_waitcnt vmcnt(23)
  v_and_b32 v24, v146, v131
  v_and_b32_e64 v25, v147, v131
  ds_write_b64 v145, v[24:25] offset:54784
  s_waitcnt vmcnt(22)
  v_and_b32 v26, v146, v132
  v_and_b32_e64 v27, v147, v132
  ds_write_b64 v145, v[26:27] offset:56832
  s_waitcnt vmcnt(21)
  v_and_b32 v28, v146, v133
  v_and_b32_e64 v29, v147, v133
  ds_write_b64 v145, v[28:29] offset:58880
  s_waitcnt vmcnt(20)
  v_lshlrev_b32 v137, 16, v137
  s_waitcnt vmcnt(19)
  v_lshlrev_b32 v138, 16, v138
  v_mul_f32 v138, v137, v138
  s_waitcnt vmcnt(18)
  v_lshlrev_b32 v134, 16, v134
  s_waitcnt vmcnt(17)
  v_lshlrev_b32 v135, 16, v135
  s_waitcnt vmcnt(16)
  v_lshlrev_b32 v136, 16, v136
  v_xor_b32 v141, 16, v141
  v_mul_f32 v134, 4.0, v134
  v_mul_f32 v135, 4.0, v135
  v_mul_f32 v136, 4.0, v136
  v_lshrrev_b32 v134, v141, v134
  v_lshrrev_b32 v135, v141, v135
  v_lshrrev_b32 v136, v141, v136
  ds_write_b32 v144, v138 offset:64320
  s_waitcnt lgkmcnt(0)
  s_barrier
  ds_read_b128 a[96:99], v3
  ds_read2_b64 a[100:103], v11 offset0:0 offset1:8
  ds_read_b128 a[104:107], v3 offset:400
  ds_read2_b64 a[108:111], v11 offset0:32 offset1:40
  ds_read_b128 a[112:115], v3 offset:800
  ds_read2_b64 a[116:119], v11 offset0:64 offset1:72
  v_and_b32 v125, v216, v134
  v_and_b32 v126, v217, v134
  buffer_load_dwordx4 a[24:27], v203, s[64:67], s42 offen
  v_and_b32 v127, v218, v134
  v_and_b32 v140, v219, v134
  v_accvgpr_write_b32 a192, v125
  v_accvgpr_write_b32 a193, v126
  v_accvgpr_write_b32 a194, v127
  v_accvgpr_write_b32 a195, v140
  v_and_b32 v125, v220, v134
  v_and_b32 v126, v221, v134
  v_and_b32_e64 v127, v222, v134
  buffer_load_dwordx4 a[28:31], v203, s[64:67], s42 offen offset:128
  s_add_u32 s42, s42, 0x1800
  v_and_b32_e64 v140, v223, v134
  ds_read_b128 a[120:123], v3 offset:1200
  ds_read2_b64 a[124:127], v11 offset0:96 offset1:104
  ds_read_b128 a[128:131], v3 offset:1600
  ds_read2_b64 a[132:135], v11 offset0:128 offset1:136
  ds_read_b128 a[136:139], v3 offset:2000
  ds_read2_b64 a[140:143], v11 offset0:160 offset1:168
  v_accvgpr_write_b32 a196, v125
  v_accvgpr_write_b32 a197, v126
  buffer_load_dwordx4 a[32:35], v203, s[64:67], s42 offen
  v_accvgpr_write_b32 a198, v127
  v_accvgpr_write_b32 a199, v140
  v_and_b32 v125, v216, v135
  v_and_b32 v126, v217, v135
  v_and_b32 v127, v218, v135
  v_and_b32 v140, v219, v135
  v_accvgpr_write_b32 a200, v125
  v_accvgpr_write_b32 a201, v126
  v_accvgpr_write_b32 a202, v127
  buffer_load_dwordx4 a[36:39], v203, s[64:67], s42 offen offset:128
  s_add_u32 s42, s42, 0x1800
  v_accvgpr_write_b32 a203, v140
  ds_read_b128 a[144:147], v3 offset:2400
  ds_read2_b64 a[148:151], v11 offset0:192 offset1:200
  ds_read_b128 a[152:155], v3 offset:2800
  ds_read2_b64 a[156:159], v11 offset0:224 offset1:232
  ds_read_b128 a[160:163], v3 offset:3200
  ds_read2_b64 a[240:243], v205 offset0:0 offset1:8
  v_and_b32 v125, v220, v135
  v_and_b32 v126, v221, v135
  buffer_load_dwordx4 a[40:43], v203, s[64:67], s42 offen
  v_and_b32 v127, v222, v135
  v_and_b32 v140, v223, v135
  v_accvgpr_write_b32 a204, v125
  v_accvgpr_write_b32 a205, v126
  v_accvgpr_write_b32 a206, v127
  v_accvgpr_write_b32 a207, v140
  v_and_b32 v125, v216, v136
  v_and_b32 v126, v217, v136
  v_and_b32_e64 v127, v218, v136
  buffer_load_dwordx4 a[44:47], v203, s[64:67], s42 offen offset:128
  s_add_u32 s42, s42, 0x1800
  v_and_b32_e64 v140, v219, v136
  ds_read_b128 a[164:167], v3 offset:3600
  ds_read2_b64 a[244:247], v205 offset0:32 offset1:40
  ds_read_b128 a[168:171], v3 offset:4000
  ds_read2_b64 a[248:251], v205 offset0:64 offset1:72
  ds_read_b128 a[172:175], v3 offset:4400
  ds_read2_b64 a[252:255], v205 offset0:96 offset1:104
  v_accvgpr_write_b32 a208, v125
  v_accvgpr_write_b32 a209, v126
  buffer_load_dwordx4 a[48:51], v203, s[64:67], s42 offen
  v_accvgpr_write_b32 a210, v127
  v_accvgpr_write_b32 a211, v140
  v_and_b32 v125, v220, v136
  v_and_b32 v126, v221, v136
  v_and_b32_e64 v127, v222, v136
  v_and_b32_e64 v140, v223, v136
  v_accvgpr_write_b32 a212, v125
  v_accvgpr_write_b32 a213, v126
  v_accvgpr_write_b32 a214, v127
  buffer_load_dwordx4 a[52:55], v203, s[64:67], s42 offen offset:128
  s_add_u32 s42, s42, 0x1800
  v_accvgpr_write_b32 a215, v140
  s_waitcnt vmcnt(19)
  v_mfma_f32_32x32x16_bf16 v[16:31], a[72:75], v[184:187], 0
  buffer_load_dwordx4 a[56:59], v203, s[64:67], s42 offen
  s_waitcnt vmcnt(19)
  v_mfma_f32_32x32x16_bf16 v[16:31], a[76:79], v[188:191], v[16:31]
  s_waitcnt vmcnt(18)
  v_mfma_f32_32x32x16_bf16 v[32:47], a[80:83], v[184:187], 0
  s_nop 0
  buffer_load_dwordx4 a[60:63], v203, s[64:67], s42 offen offset:128
  s_add_u32 s42, s42, 0x1800
  s_waitcnt vmcnt(15)
  v_mfma_f32_32x32x16_bf16 v[48:63], a[0:3], v[224:227], v[16:31]
  s_nop 0
  buffer_load_dwordx4 a[64:67], v203, s[64:67], s42 offen
  v_mfma_f32_32x32x16_bf16 v[32:47], a[84:87], v[188:191], v[32:47]
  s_waitcnt vmcnt(15)
  v_mfma_f32_32x32x16_bf16 v[48:63], a[4:7], v[228:231], v[48:63]
  buffer_load_dwordx4 a[68:71], v203, s[64:67], s42 offen offset:128
  s_waitcnt vmcnt(15)
  v_mfma_f32_32x32x16_bf16 v[160:175], a[8:11], v[224:227], v[16:31]
  s_add_u32 m0, s15, 0x8200
  s_nop 0
  buffer_load_dwordx4 v6, s[4:7], s49 offen lds
  s_waitcnt vmcnt(15)
  v_mfma_f32_32x32x16_bf16 v[160:175], a[12:15], v[228:231], v[160:175]
  s_nop 0
  buffer_load_dwordx4 v7, s[4:7], s49 offen offset:1024 lds
  s_nop 2
  v_cvt_pk_bf16_f32 v64, v48, v52
  v_cvt_pk_bf16_f32 v65, v56, v60
  v_cvt_pk_bf16_f32 v68, v49, v53
  v_cvt_pk_bf16_f32 v69, v57, v61
  v_max3_f32 v180, |v48|, |v52|, |v56|
  v_max_f32_e64 v180, |v60|, v180
  v_max3_f32 v180, |v49|, |v53|, v180
  v_max3_f32 v180, |v57|, |v61|, v180
  s_waitcnt vmcnt(15)
  v_mfma_f32_32x32x16_bf16 v[96:111], a[16:19], v[224:227], v[16:31]
  s_nop 0
  buffer_load_dwordx4 v8, s[4:7], s49 offen offset:2048 lds
  v_cvt_pk_bf16_f32 v72, v50, v54
  v_cvt_pk_bf16_f32 v73, v58, v62
  v_cvt_pk_bf16_f32 v76, v51, v55
  v_cvt_pk_bf16_f32 v77, v59, v63
  v_max3_f32 v180, |v50|, |v54|, v180
  v_max3_f32 v180, |v58|, |v62|, v180
  v_max3_f32 v180, |v51|, |v55|, v180
  v_max3_f32 v180, |v59|, |v63|, v180
  s_waitcnt vmcnt(15)
  v_mfma_f32_32x32x16_bf16 v[96:111], a[20:23], v[228:231], v[96:111]
  s_nop 0
  buffer_load_dwordx4 v9, s[4:7], s49 offen offset:3072 lds
  v_cvt_pk_bf16_f32 v66, v160, v164
  v_cvt_pk_bf16_f32 v67, v168, v172
  v_cvt_pk_bf16_f32 v70, v161, v165
  v_cvt_pk_bf16_f32 v71, v169, v173
  v_max3_f32 v180, |v160|, |v164|, v180
  v_max3_f32 v180, |v168|, |v172|, v180
  v_max3_f32 v180, |v161|, |v165|, v180
  v_max3_f32 v180, |v169|, |v173|, v180
  ds_write_b128 v195, v[64:67]
  s_waitcnt vmcnt(15)
  s_nop 0
  v_mfma_f32_32x32x16_bf16 v[48:63], a[24:27], v[224:227], v[32:47]
  s_add_u32 m0, s15, 0
  s_nop 0
  buffer_load_dwordx4 v198, s[4:7], 0 offen lds
  ds_write_b128 v195, v[68:71] offset:6144
  v_cvt_pk_bf16_f32 v74, v162, v166
  v_cvt_pk_bf16_f32 v75, v170, v174
  v_cvt_pk_bf16_f32 v78, v163, v167
  v_cvt_pk_bf16_f32 v79, v171, v175
  v_max3_f32 v180, |v162|, |v166|, v180
  v_max3_f32 v180, |v170|, |v174|, v180
  v_max3_f32 v180, |v163|, |v167|, v180
  v_max3_f32 v180, |v171|, |v175|, v180
  s_waitcnt vmcnt(15)
  v_mfma_f32_32x32x16_bf16 v[48:63], a[28:31], v[228:231], v[48:63]
  s_add_u32 m0, s15, 0x400
  s_nop 0
  buffer_load_dwordx4 v199, s[4:7], 0 offen lds
  ds_write_b128 v195, v[72:75] offset:12288
  v_cvt_pk_bf16_f32 v80, v96, v100
  v_cvt_pk_bf16_f32 v81, v104, v108
  v_cvt_pk_bf16_f32 v84, v97, v101
  v_cvt_pk_bf16_f32 v85, v105, v109
  v_max3_f32 v180, |v96|, |v100|, v180
  v_max3_f32 v180, |v104|, |v108|, v180
  v_max3_f32 v180, |v97|, |v101|, v180
  v_max3_f32 v180, |v105|, |v109|, v180
  s_waitcnt vmcnt(15)
  v_mfma_f32_32x32x16_bf16 v[160:175], a[32:35], v[224:227], v[32:47]
  s_add_u32 m0, s15, 0x800
  s_nop 0
  buffer_load_dwordx4 v200, s[4:7], 0 offen lds
  ds_write_b128 v195, v[76:79] offset:18432
  v_cvt_pk_bf16_f32 v88, v98, v102
  v_cvt_pk_bf16_f32 v89, v106, v110
  v_cvt_pk_bf16_f32 v92, v99, v103
  v_cvt_pk_bf16_f32 v93, v107, v111
  v_max3_f32 v180, |v98|, |v102|, v180
  v_max3_f32 v180, |v106|, |v110|, v180
  v_max3_f32 v180, |v99|, |v103|, v180
  v_max3_f32 v180, |v107|, |v111|, v180
  s_waitcnt vmcnt(15)
  v_mfma_f32_32x32x16_bf16 v[160:175], a[36:39], v[228:231], v[160:175]
  s_add_u32 m0, s15, 0xc00
  s_nop 0
  buffer_load_dwordx4 v201, s[4:7], 0 offen lds
  ds_write_b64 v196, v[80:81]
  ds_write_b64 v196, v[84:85] offset:6144
  v_cvt_pk_bf16_f32 v64, v48, v52
  v_cvt_pk_bf16_f32 v65, v56, v60
  v_cvt_pk_bf16_f32 v68, v49, v53
  v_cvt_pk_bf16_f32 v69, v57, v61
  v_max3_f32 v176, |v48|, |v52|, |v56|
  v_max_f32_e64 v176, |v60|, v176
  v_max3_f32 v177, |v49|, |v53|, |v57|
  v_max_f32_e64 v177, |v61|, v177
  s_waitcnt vmcnt(15)
  v_mfma_f32_32x32x16_bf16 v[96:111], a[40:43], v[224:227], v[32:47]
  s_add_u32 m0, s14, 0x22000
  s_nop 0
  buffer_load_dwordx4 v254, s[72:75], s57 offen lds
  ds_write_b64 v196, v[88:89] offset:12288
  ds_write_b64 v196, v[92:93] offset:18432
  v_cvt_pk_bf16_f32 v72, v50, v54
  v_cvt_pk_bf16_f32 v73, v58, v62
  v_cvt_pk_bf16_f32 v76, v51, v55
  v_cvt_pk_bf16_f32 v77, v59, v63
  v_max3_f32 v178, |v50|, |v54|, |v58|
  v_max_f32_e64 v178, |v62|, v178
  v_max3_f32 v179, |v51|, |v55|, |v59|
  v_max_f32_e64 v179, |v63|, v179
  s_waitcnt vmcnt(15)
  v_mfma_f32_32x32x16_bf16 v[96:111], a[44:47], v[228:231], v[96:111]
  s_nop 0
  buffer_load_dwordx4 v255, s[72:75], s57 offen offset:1024 lds
  v_cvt_pk_bf16_f32 v66, v160, v164
  v_cvt_pk_bf16_f32 v67, v168, v172
  v_cvt_pk_bf16_f32 v70, v161, v165
  v_cvt_pk_bf16_f32 v71, v169, v173
  v_max3_f32 v176, |v160|, |v164|, v176
  v_max3_f32 v176, |v168|, |v172|, v176
  v_max3_f32 v177, |v161|, |v165|, v177
  v_max3_f32 v177, |v169|, |v173|, v177
  ds_write_b128 v197, v[64:67]
  s_waitcnt vmcnt(15)
  v_mfma_f32_32x32x16_bf16 v[48:63], a[48:51], v[224:227], v[32:47]
  s_nop 0
  buffer_load_dwordx4 v244, s[72:75], s57 offen offset:2048 lds
  ds_write_b128 v197, v[68:71] offset:6144
  v_cvt_pk_bf16_f32 v74, v162, v166
  v_cvt_pk_bf16_f32 v75, v170, v174
  v_cvt_pk_bf16_f32 v78, v163, v167
  v_cvt_pk_bf16_f32 v79, v171, v175
  v_max3_f32 v178, |v162|, |v166|, v178
  v_max3_f32 v178, |v170|, |v174|, v178
  v_max3_f32 v179, |v163|, |v167|, v179
  v_max3_f32 v179, |v171|, |v175|, v179
  s_waitcnt vmcnt(15)
  v_mfma_f32_32x32x16_bf16 v[48:63], a[52:55], v[228:231], v[48:63]
  s_add_u32 m0, s14, 0x22c00
  s_nop 0
  buffer_load_dwordx4 v254, s[72:75], s58 offen lds
  ds_write_b128 v197, v[72:75] offset:12288
  v_cvt_pk_bf16_f32 v80, v96, v100
  v_cvt_pk_bf16_f32 v81, v104, v108
  v_cvt_pk_bf16_f32 v84, v97, v101
  v_cvt_pk_bf16_f32 v85, v105, v109
  v_max3_f32 v176, |v96|, |v100|, v176
  v_max3_f32 v176, |v104|, |v108|, v176
  v_max3_f32 v177, |v97|, |v101|, v177
  v_max3_f32 v177, |v105|, |v109|, v177
  s_waitcnt vmcnt(15)
  v_mfma_f32_32x32x16_bf16 v[160:175], a[56:59], v[224:227], v[32:47]
  s_nop 0
  buffer_load_dwordx4 v255, s[72:75], s58 offen offset:1024 lds
  ds_write_b128 v197, v[76:79] offset:18432
  v_cvt_pk_bf16_f32 v88, v98, v102
  v_cvt_pk_bf16_f32 v89, v106, v110
  v_cvt_pk_bf16_f32 v92, v99, v103
  v_cvt_pk_bf16_f32 v93, v107, v111
  v_max3_f32 v178, |v98|, |v102|, v178
  v_max3_f32 v178, |v106|, |v110|, v178
  v_max3_f32 v179, |v99|, |v103|, v179
  v_max3_f32 v179, |v107|, |v111|, v179
  v_mfma_f32_32x32x16_bf16 v[96:111], a[88:91], v[224:227], v[32:47]
  s_waitcnt vmcnt(15)
  v_mfma_f32_32x32x16_bf16 v[160:175], a[60:63], v[228:231], v[160:175]
  s_nop 0
  buffer_load_dwordx4 v244, s[72:75], s58 offen offset:2048 lds
  v_cvt_pk_bf16_f32 v82, v48, v52
  v_cvt_pk_bf16_f32 v83, v56, v60
  v_cvt_pk_bf16_f32 v86, v49, v53
  v_cvt_pk_bf16_f32 v87, v57, v61
  v_max3_f32 v176, |v48|, |v52|, v176
  v_max3_f32 v176, |v56|, |v60|, v176
  v_max3_f32 v177, |v49|, |v53|, v177
  v_max3_f32 v177, |v57|, |v61|, v177
  ds_write_b128 v197, v[80:83] offset:1024
  v_mfma_f32_32x32x16_bf16 v[96:111], a[92:95], v[228:231], v[96:111]
  s_waitcnt vmcnt(15)
  v_mfma_f32_32x32x16_bf16 v[96:111], a[64:67], v[224:227], v[96:111]
  s_nop 0
  ds_write_b128 v197, v[84:87] offset:7168
  v_cvt_pk_bf16_f32 v90, v50, v54
  v_cvt_pk_bf16_f32 v91, v58, v62
  v_cvt_pk_bf16_f32 v94, v51, v55
  v_cvt_pk_bf16_f32 v95, v59, v63
  v_max3_f32 v178, |v50|, |v54|, v178
  v_max3_f32 v178, |v58|, |v62|, v178
  v_max3_f32 v179, |v51|, |v55|, v179
  v_max3_f32 v179, |v59|, |v63|, v179
  s_waitcnt vmcnt(14)
  v_mfma_f32_32x32x16_bf16 v[96:111], a[68:71], v[228:231], v[96:111]
  s_nop 0
  ds_write_b128 v197, v[88:91] offset:13312
  v_cvt_pk_bf16_f32 v64, v160, v164
  v_cvt_pk_bf16_f32 v65, v168, v172
  v_cvt_pk_bf16_f32 v68, v161, v165
  v_cvt_pk_bf16_f32 v69, v169, v173
  v_max3_f32 v176, |v160|, |v164|, v176
  v_max3_f32 v176, |v168|, |v172|, v176
  v_max3_f32 v177, |v161|, |v165|, v177
  v_max3_f32 v177, |v169|, |v173|, v177
  ds_write_b128 v197, v[92:95] offset:19456
  v_cvt_pk_bf16_f32 v72, v162, v166
  v_cvt_pk_bf16_f32 v73, v170, v174
  v_cvt_pk_bf16_f32 v76, v163, v167
  v_cvt_pk_bf16_f32 v77, v171, v175
  v_max3_f32 v178, |v162|, |v166|, v178
  v_max3_f32 v178, |v170|, |v174|, v178
  v_max3_f32 v179, |v163|, |v167|, v179
  v_max3_f32 v179, |v171|, |v175|, v179
  v_cvt_pk_bf16_f32 v66, v96, v100
  v_cvt_pk_bf16_f32 v67, v104, v108
  v_cvt_pk_bf16_f32 v70, v97, v101
  v_cvt_pk_bf16_f32 v71, v105, v109
  v_max3_f32 v176, |v96|, |v100|, v176
  v_max3_f32 v176, |v104|, |v108|, v176
  v_max3_f32 v177, |v97|, |v101|, v177
  v_max3_f32 v177, |v105|, |v109|, v177
  ds_write_b128 v197, v[64:67] offset:2048
  ds_write_b128 v197, v[68:71] offset:8192
  v_cvt_pk_bf16_f32 v74, v98, v102
  v_cvt_pk_bf16_f32 v75, v106, v110
  v_cvt_pk_bf16_f32 v78, v99, v103
  v_cvt_pk_bf16_f32 v79, v107, v111
  v_max3_f32 v178, |v98|, |v102|, v178
  v_max3_f32 v178, |v106|, |v110|, v178
  v_max3_f32 v179, |v99|, |v103|, v179
  v_max3_f32 v179, |v107|, |v111|, v179
  ds_write_b128 v197, v[72:75] offset:14336
  ds_write_b128 v197, v[76:79] offset:20480
  s_waitcnt lgkmcnt(0)
  s_barrier
  v_max3_f32 v180, v180, v176, v177
  v_min3_f32 v176, v176, v177, v178
  v_max3_f32 v180, v180, v178, v179
  v_min_f32_e64 v176, v176, v179
  v_cmp_le_u32 vcc, 0x43800000, v180
  s_nop 0
  s_cmp_lg_u64 vcc, 0
  s_cselect_b32 s3, 1, 0
  v_cmp_gt_u32 vcc, 0x3a000000, v176
  s_nop 0
  s_cmp_lg_u64 vcc, 0
  s_cselect_b32 s3, 1, s3
  ds_read_b128 a[0:3], v0 offset:24576
  ds_read_b128 a[4:7], v0 offset:25600
  ds_read_b128 a[8:11], v0 offset:26624
  ds_read_b128 a[12:15], v0 offset:27648
  ds_read_b128 a[16:19], v0 offset:28672
  ds_read_b128 a[20:23], v0 offset:29696
  ds_read_b128 a[24:27], v0 offset:30720
  ds_read_b128 a[28:31], v0 offset:31744
  ds_read_b128 a[32:35], v0 offset:32768
  ds_read_b128 a[36:39], v0 offset:33792
  ds_read_b128 a[40:43], v0 offset:34816
  ds_read_b128 a[44:47], v0 offset:35840
  ds_read_b128 a[48:51], v0 offset:36864
  ds_read_b128 a[52:55], v0 offset:37888
  ds_read_b128 a[56:59], v0 offset:38912
  ds_read_b128 a[60:63], v0 offset:39936
  ds_read_b128 a[64:67], v0 offset:40960
  ds_read_b128 a[68:71], v0 offset:41984
  ds_read_b128 a[72:75], v0 offset:43008
  ds_read_b128 a[76:79], v0 offset:44032
  ds_read_b128 a[80:83], v0 offset:45056
  ds_read_b128 a[84:87], v0 offset:46080
  ds_read_b128 a[88:91], v0 offset:47104
  ds_read_b128 a[92:95], v0 offset:48128
  s_waitcnt vmcnt(6)
  s_nop 0
  ds_read_b128 v[160:163], v4
  ds_read_b128 v[164:167], v4 offset:192
  ds_read_b128 v[168:171], v4 offset:384
  ds_read_b128 v[172:175], v4 offset:16
  ds_read_b128 v[176:179], v4 offset:208
  ds_read_b128 v[180:183], v4 offset:400
  ds_read_b128 v[216:219], v4 offset:32
  ds_read_b128 v[220:223], v4 offset:224
  ds_read_b128 v[224:227], v4 offset:416
  ds_read_b128 v[228:231], v4 offset:48
  ds_read_b128 v[232:235], v4 offset:240
  ds_read_b128 v[236:239], v4 offset:432
  s_waitcnt lgkmcnt(11)
  v_mfma_f32_16x16x32_bf16 v[112:115], a[96:99], v[160:163], 0
  ds_read_b128 v[160:163], v4 offset:64
  s_waitcnt lgkmcnt(9)
  v_mfma_f32_16x16x32_bf16 v[116:119], a[104:107], v[172:175], 0
  s_waitcnt lgkmcnt(0)
  ds_read_b128 v[172:175], v4 offset:80
  s_nop 0
  v_smfmac_f32_16x16x64_bf16 v[112:115], a[100:103], v[164:171], v250
  s_nop 0
  ds_read_b128 v[164:167], v4 offset:256
  ds_read_b128 v[168:171], v4 offset:448
  v_mfma_f32_16x16x32_bf16 v[120:123], a[112:115], v[216:219], 0
  s_waitcnt lgkmcnt(2)
  ds_read_b128 v[216:219], v4 offset:96
  v_smfmac_f32_16x16x64_bf16 v[116:119], a[108:111], v[176:183], v250
  ds_read_b128 v[176:179], v4 offset:272
  ds_read_b128 v[180:183], v4 offset:464
  v_mfma_f32_16x16x32_bf16 v[124:127], a[120:123], v[228:231], 0
  s_waitcnt lgkmcnt(2)
  ds_read_b128 v[228:231], v4 offset:112
  v_smfmac_f32_16x16x64_bf16 v[120:123], a[116:119], v[220:227], v250
  ds_read_b128 v[220:223], v4 offset:288
  ds_read_b128 v[224:227], v4 offset:480
  v_mfma_f32_16x16x32_bf16 v[128:131], a[128:131], v[160:163], 0
  s_waitcnt lgkmcnt(2)
  ds_read_b128 v[160:163], v4 offset:128
  v_smfmac_f32_16x16x64_bf16 v[124:127], a[124:127], v[232:239], v250
  ds_read_b128 v[232:235], v4 offset:304
  ds_read_b128 v[236:239], v4 offset:496
  v_mfma_f32_16x16x32_bf16 v[132:135], a[136:139], v[172:175], 0
  s_waitcnt lgkmcnt(2)
  ds_read_b128 v[172:175], v4 offset:144
  v_smfmac_f32_16x16x64_bf16 v[128:131], a[132:135], v[164:171], v250
  s_nop 0
  ds_read_b128 v[164:167], v4 offset:320
  ds_read_b128 v[168:171], v4 offset:512
  v_mfma_f32_16x16x32_bf16 v[136:139], a[144:147], v[216:219], 0
  s_waitcnt lgkmcnt(2)
  ds_read_b128 v[216:219], v4 offset:160
  v_smfmac_f32_16x16x64_bf16 v[132:135], a[140:143], v[176:183], v250
  ds_read_b128 v[176:179], v4 offset:336
  ds_read_b128 v[180:183], v4 offset:528
  v_mfma_f32_16x16x32_bf16 v[140:143], a[152:155], v[228:231], 0
  s_waitcnt lgkmcnt(2)
  ds_read_b128 v[228:231], v4 offset:176
  v_smfmac_f32_16x16x64_bf16 v[136:139], a[148:151], v[220:227], v250
  ds_read_b128 v[220:223], v4 offset:352
  ds_read_b128 v[224:227], v4 offset:544
  v_mfma_f32_16x16x32_bf16 v[144:147], a[160:163], v[160:163], 0
  s_waitcnt lgkmcnt(2)
  v_smfmac_f32_16x16x64_bf16 v[140:143], a[156:159], v[232:239], v250
  s_nop 0
  ds_read_b128 v[232:235], v4 offset:368
  ds_read_b128 v[236:239], v4 offset:560
  v_mfma_f32_16x16x32_bf16 v[148:151], a[164:167], v[172:175], 0
  s_nop 0
  v_smfmac_f32_16x16x64_bf16 v[144:147], a[240:243], v[164:171], v250
  s_nop 0
  v_mfma_f32_16x16x32_bf16 v[152:155], a[168:171], v[216:219], 0
  s_nop 2
  v_smfmac_f32_16x16x64_bf16 v[148:151], a[244:247], v[176:183], v250
  v_mfma_f32_16x16x32_bf16 v[156:159], a[172:175], v[228:231], 0
  s_waitcnt lgkmcnt(2)
  v_smfmac_f32_16x16x64_bf16 v[152:155], a[248:251], v[220:227], v250
  s_waitcnt lgkmcnt(0)
  s_nop 2
  v_smfmac_f32_16x16x64_bf16 v[156:159], a[252:255], v[232:239], v250
  buffer_load_dword v249, v248, s[4:7], s29 offen
  v_pk_add_f32 v[12:13], v[112:113], v[114:115]
  v_pk_mul_f32 v[14:15], v[112:113], v[112:113]
  v_pk_fma_f32 v[14:15], v[114:115], v[114:115], v[14:15]
  v_pk_add_f32 v[12:13], v[12:13], v[116:117]
  v_pk_fma_f32 v[14:15], v[116:117], v[116:117], v[14:15]
  v_pk_add_f32 v[12:13], v[12:13], v[118:119]
  v_pk_fma_f32 v[14:15], v[118:119], v[118:119], v[14:15]
  v_pk_add_f32 v[12:13], v[12:13], v[120:121]
  v_pk_fma_f32 v[14:15], v[120:121], v[120:121], v[14:15]
  v_pk_add_f32 v[12:13], v[12:13], v[122:123]
  v_pk_fma_f32 v[14:15], v[122:123], v[122:123], v[14:15]
  v_pk_add_f32 v[12:13], v[12:13], v[124:125]
  ds_read_b128 v[160:163], v0 offset:18432
  ds_read_b128 v[164:167], v0 offset:19456
  ds_read_b128 v[168:171], v0 offset:20480
  ds_read_b128 v[172:175], v0 offset:21504
  v_pk_fma_f32 v[14:15], v[124:125], v[124:125], v[14:15]
  v_pk_add_f32 v[12:13], v[12:13], v[126:127]
  v_pk_fma_f32 v[14:15], v[126:127], v[126:127], v[14:15]
  v_pk_add_f32 v[12:13], v[12:13], v[128:129]
  v_pk_fma_f32 v[14:15], v[128:129], v[128:129], v[14:15]
  v_pk_add_f32 v[12:13], v[12:13], v[130:131]
  v_pk_fma_f32 v[14:15], v[130:131], v[130:131], v[14:15]
  v_pk_add_f32 v[12:13], v[12:13], v[132:133]
  v_pk_fma_f32 v[14:15], v[132:133], v[132:133], v[14:15]
  v_pk_add_f32 v[12:13], v[12:13], v[134:135]
  v_pk_fma_f32 v[14:15], v[134:135], v[134:135], v[14:15]
  v_pk_add_f32 v[12:13], v[12:13], v[136:137]
  ds_read_b128 v[176:179], v0 offset:22528
  ds_read_b128 v[180:183], v0 offset:23552
  ds_read_b128 a[96:99], v0 offset:49152
  ds_read_b128 a[100:103], v0 offset:50176
  v_pk_fma_f32 v[14:15], v[136:137], v[136:137], v[14:15]
  v_pk_add_f32 v[12:13], v[12:13], v[138:139]
  v_pk_fma_f32 v[14:15], v[138:139], v[138:139], v[14:15]
  v_pk_add_f32 v[12:13], v[12:13], v[140:141]
  v_pk_fma_f32 v[14:15], v[140:141], v[140:141], v[14:15]
  v_pk_add_f32 v[12:13], v[12:13], v[142:143]
  v_pk_fma_f32 v[14:15], v[142:143], v[142:143], v[14:15]
  v_pk_add_f32 v[12:13], v[12:13], v[144:145]
  v_pk_fma_f32 v[14:15], v[144:145], v[144:145], v[14:15]
  v_pk_add_f32 v[12:13], v[12:13], v[146:147]
  v_pk_fma_f32 v[14:15], v[146:147], v[146:147], v[14:15]
  v_pk_add_f32 v[12:13], v[12:13], v[148:149]
  ds_read_b128 a[104:107], v0 offset:51200
  ds_read_b128 a[108:111], v0 offset:52224
  ds_read_b128 a[112:115], v0 offset:53248
  ds_read_b128 a[116:119], v0 offset:54272
  v_pk_fma_f32 v[14:15], v[148:149], v[148:149], v[14:15]
  v_pk_add_f32 v[12:13], v[12:13], v[150:151]
  v_pk_fma_f32 v[14:15], v[150:151], v[150:151], v[14:15]
  v_pk_add_f32 v[12:13], v[12:13], v[152:153]
  v_pk_fma_f32 v[14:15], v[152:153], v[152:153], v[14:15]
  v_pk_add_f32 v[12:13], v[12:13], v[154:155]
  v_pk_fma_f32 v[14:15], v[154:155], v[154:155], v[14:15]
  v_pk_add_f32 v[12:13], v[12:13], v[156:157]
  v_pk_fma_f32 v[14:15], v[156:157], v[156:157], v[14:15]
  v_pk_add_f32 v[12:13], v[12:13], v[158:159]
  v_pk_fma_f32 v[14:15], v[158:159], v[158:159], v[14:15]
  v_add_f32_e64 v12, v12, v13
  ds_read_b128 a[120:123], v0 offset:55296
  ds_read_b128 a[124:127], v0 offset:56320
  ds_read_b128 a[128:131], v0 offset:57344
  ds_read_b128 a[132:135], v0 offset:58368
  v_add_f32 v14, v14, v15
  s_nop 1
  v_permlane32_swap_b32 v12, v14
  v_add_f32 v12, v12, v14
  v_mov_b32 v14, v12
  s_nop 1
  v_permlane32_swap_b32 v12, v14
  v_mul_f32 v12, s24, v12
  v_mul_f32_e64 v13, s24, v14
  v_fma_f32 v13, -v12, v12, v13
  v_max_f32_e64 v13, 0, v13
  v_add_f32_e64 v13, s25, v13
  v_rsq_f32 v13, v13
  s_nop 0
  v_mul_f32_e64 v14, s22, v13
  ds_read_b128 a[136:139], v0 offset:59392
  ds_read_b128 a[140:143], v0 offset:60416
  ds_read_b128 a[144:147], v0 offset:61440
  ds_read_b128 a[148:151], v0 offset:62464
  v_mul_f32_e64 v12, -v12, v14
  v_pk_fma_f32 v[112:113], v[112:113], v[14:15], v[12:13] op_sel_hi:[1,0,0]
  v_pk_fma_f32 v[114:115], v[114:115], v[14:15], v[12:13] op_sel_hi:[1,0,0]
  v_pk_fma_f32 v[116:117], v[116:117], v[14:15], v[12:13] op_sel_hi:[1,0,0]
  v_pk_fma_f32 v[118:119], v[118:119], v[14:15], v[12:13] op_sel_hi:[1,0,0]
  v_pk_fma_f32 v[120:121], v[120:121], v[14:15], v[12:13] op_sel_hi:[1,0,0]
  v_pk_fma_f32 v[122:123], v[122:123], v[14:15], v[12:13] op_sel_hi:[1,0,0]
  v_pk_fma_f32 v[124:125], v[124:125], v[14:15], v[12:13] op_sel_hi:[1,0,0]
  v_pk_fma_f32 v[126:127], v[126:127], v[14:15], v[12:13] op_sel_hi:[1,0,0]
  v_pk_fma_f32 v[128:129], v[128:129], v[14:15], v[12:13] op_sel_hi:[1,0,0]
  v_pk_fma_f32 v[130:131], v[130:131], v[14:15], v[12:13] op_sel_hi:[1,0,0]
  v_pk_fma_f32 v[132:133], v[132:133], v[14:15], v[12:13] op_sel_hi:[1,0,0]
  ds_read_b128 a[152:155], v0 offset:63488
  ds_read_b128 a[156:159], v0 offset:64512
  ds_read_b128 a[160:163], v1
  ds_read_b128 a[164:167], v1 offset:1024
  v_pk_fma_f32 v[134:135], v[134:135], v[14:15], v[12:13] op_sel_hi:[1,0,0]
  v_pk_fma_f32 v[136:137], v[136:137], v[14:15], v[12:13] op_sel_hi:[1,0,0]
  v_pk_fma_f32 v[138:139], v[138:139], v[14:15], v[12:13] op_sel_hi:[1,0,0]
  v_pk_fma_f32 v[140:141], v[140:141], v[14:15], v[12:13] op_sel_hi:[1,0,0]
  v_pk_fma_f32 v[142:143], v[142:143], v[14:15], v[12:13] op_sel_hi:[1,0,0]
  v_pk_fma_f32 v[144:145], v[144:145], v[14:15], v[12:13] op_sel_hi:[1,0,0]
  v_pk_fma_f32 v[146:147], v[146:147], v[14:15], v[12:13] op_sel_hi:[1,0,0]
  v_pk_fma_f32 v[148:149], v[148:149], v[14:15], v[12:13] op_sel_hi:[1,0,0]
  v_pk_fma_f32 v[150:151], v[150:151], v[14:15], v[12:13] op_sel_hi:[1,0,0]
  v_pk_fma_f32 v[152:153], v[152:153], v[14:15], v[12:13] op_sel_hi:[1,0,0]
  v_pk_fma_f32 v[154:155], v[154:155], v[14:15], v[12:13] op_sel_hi:[1,0,0]
  v_pk_fma_f32 v[156:157], v[156:157], v[14:15], v[12:13] op_sel_hi:[1,0,0]
  ds_read_b128 a[168:171], v1 offset:2048
  ds_read_b128 a[172:175], v1 offset:3072
  ds_read_b128 a[176:179], v1 offset:4096
  ds_read_b128 a[180:183], v1 offset:5120
  v_pk_fma_f32 v[158:159], v[158:159], v[14:15], v[12:13] op_sel_hi:[1,0,0]
  v_cndmask_b32 v159, v159, v250, s[12:13]
  v_cvt_pk_bf16_f32 v216, v112, v113
  v_cvt_pk_bf16_f32 v217, v114, v115
  v_cvt_pk_bf16_f32 v218, v116, v117
  v_cvt_pk_bf16_f32 v219, v118, v119
  v_cvt_pk_bf16_f32 v220, v120, v121
  v_cvt_pk_bf16_f32 v221, v122, v123
  v_cvt_pk_bf16_f32 v222, v124, v125
  v_cvt_pk_bf16_f32 v223, v126, v127
  v_cvt_pk_bf16_f32 v224, v128, v129
  v_cvt_pk_bf16_f32 v225, v130, v131
  ds_read_b128 a[184:187], v1 offset:6144
  ds_read_b128 a[188:191], v1 offset:7168
  v_cvt_pk_bf16_f32 v226, v132, v133
  v_cvt_pk_bf16_f32 v227, v134, v135
  v_cvt_pk_bf16_f32 v228, v136, v137
  v_cvt_pk_bf16_f32 v229, v138, v139
  v_cvt_pk_bf16_f32 v230, v140, v141
  v_cvt_pk_bf16_f32 v231, v142, v143
  v_cvt_pk_bf16_f32 v232, v144, v145
  v_cvt_pk_bf16_f32 v233, v146, v147
  v_cvt_pk_bf16_f32 v234, v148, v149
  v_cvt_pk_bf16_f32 v235, v150, v151
  v_cvt_pk_bf16_f32 v236, v152, v153
  v_cvt_pk_bf16_f32 v237, v154, v155
  v_cvt_pk_bf16_f32 v238, v156, v157
  v_cvt_pk_bf16_f32 v239, v158, v159
  s_waitcnt lgkmcnt(15)
  v_mfma_f32_32x32x16_bf16 v[16:31], v[160:163], v[216:219], 0
  s_waitcnt vmcnt(1)
  ds_read_b128 a[216:219], v251 offset:49152
  ds_read_b128 v[112:115], v5
  ds_read_b128 v[116:119], v5 offset:32
  v_mfma_f32_32x32x16_bf16 v[16:31], v[164:167], v[220:223], v[16:31]
  s_add_u32 m0, s14, 0x16000
  ds_read_b128 v[136:139], v2
  ds_read_b128 v[140:143], v2 offset:32
  ds_read_b128 v[144:147], v2 offset:64
  v_mfma_f32_32x32x16_bf16 v[16:31], v[168:171], v[224:227], v[16:31]
  ds_read_b128 v[148:151], v2 offset:96
  ds_read_b128 a[220:223], v252 offset:49152
  ds_read_b128 v[120:123], v5 offset:64
  v_mfma_f32_32x32x16_bf16 v[16:31], v[172:175], v[228:231], v[16:31]
  ds_read_b128 v[124:127], v5 offset:96
  ds_read_b128 v[152:155], v2 offset:128
  ds_read_b128 v[156:159], v2 offset:160
  s_nop 0
  v_mfma_f32_32x32x16_bf16 v[16:31], v[176:179], v[232:235], v[16:31]
  s_nop 0
  ds_read_b128 v[160:163], v2 offset:192
  ds_read_b128 v[164:167], v2 offset:224
  ds_read_b128 a[224:227], v251 offset:49216
  s_nop 0
  v_mfma_f32_32x32x16_bf16 v[16:31], v[180:183], v[236:239], v[16:31]
  s_waitcnt lgkmcnt(12)
  ds_read_b128 a[228:231], v252 offset:49216
  ds_read_b128 a[232:235], v251 offset:49280
  ds_read_b128 a[236:239], v252 offset:49280
  s_nop 2
  v_mfma_f32_32x32x16_bf16 v[64:79], a[216:219], a[192:195], 0
  s_waitcnt lgkmcnt(11)
  ds_read_b128 v[128:131], v5 offset:128
  ds_read_b128 v[132:135], v5 offset:160
  ds_read_b128 v[168:171], v2 offset:256
  v_subrev_u32 v14, 0x4100, v5
  v_add_u32 v5, 0x8200, v5
  v_cvt_pk_f16_f32 v48, v16, v17
  v_smfmac_f32_32x32x32_bf16 v[136:151], v[240:243], v[112:119], v250
  s_waitcnt lgkmcnt(12)
  v_cvt_pk_f16_f32 v49, v18, v19
  v_cvt_pk_f16_f32 v50, v20, v21
  v_cvt_pk_f16_f32 v51, v22, v23
  v_cvt_pk_f16_f32 v52, v24, v25
  v_cvt_pk_f16_f32 v53, v26, v27
  v_mfma_f32_32x32x16_bf16 v[64:79], a[220:223], a[196:199], v[64:79]
  s_waitcnt lgkmcnt(7)
  ds_read_b128 v[172:175], v2 offset:288
  ds_read_b128 v[176:179], v2 offset:320
  ds_read_b128 v[180:183], v2 offset:352
  v_cvt_pk_f16_f32 v54, v28, v29
  v_cvt_pk_f16_f32 v55, v30, v31
  v_pk_fma_f16 v56, v48, v48, s20 op_sel_hi:[1,1,0] neg_lo:[1,0,0] neg_hi:[1,0,0] clamp
  v_smfmac_f32_32x32x32_bf16 v[152:167], v[240:243], v[120:127], v250
  s_waitcnt lgkmcnt(9)
  v_pk_fma_f16 v57, v49, v49, s20 op_sel_hi:[1,1,0] neg_lo:[1,0,0] neg_hi:[1,0,0] clamp
  v_pk_fma_f16 v58, v50, v50, s20 op_sel_hi:[1,1,0] neg_lo:[1,0,0] neg_hi:[1,0,0] clamp
  v_pk_fma_f16 v59, v51, v51, s20 op_sel_hi:[1,1,0] neg_lo:[1,0,0] neg_hi:[1,0,0] clamp
  v_pk_fma_f16 v184, v56, v56, s20 op_sel:[0,0,1]
  v_pk_fma_f16 v185, v57, v57, s20 op_sel:[0,0,1]
  v_mfma_f32_32x32x16_bf16 v[80:95], a[224:227], a[200:203], 0
  s_waitcnt lgkmcnt(6)
  v_cvt_pk_f16_f32 v64, v64, v65
  v_cvt_pk_f16_f32 v65, v66, v67
  v_cvt_pk_f16_f32 v66, v68, v69
  v_cvt_pk_f16_f32 v67, v70, v71
  v_pk_mul_f16 v64, v64, s21 op_sel:[0,1]
  v_pk_mul_f16 v65, v65, s21 op_sel:[0,1]
  v_mfma_f32_32x32x16_bf16 v[80:95], a[228:231], a[204:207], v[80:95]
  v_pk_mul_f16 v66, v66, s21 op_sel:[0,1]
  v_pk_mul_f16 v67, v67, s21 op_sel:[0,1]
  v_cvt_pk_f16_f32 v68, v72, v73
  v_cvt_pk_f16_f32 v69, v74, v75
  v_cvt_pk_f16_f32 v70, v76, v77
  v_cvt_pk_f16_f32 v71, v78, v79
  v_mfma_f32_32x32x16_bf16 v[96:111], a[232:235], a[208:211], 0
  v_pk_mul_f16 v68, v68, s21 op_sel:[0,1]
  v_pk_mul_f16 v69, v69, s21 op_sel:[0,1]
  v_pk_mul_f16 v70, v70, s21 op_sel:[0,1]
  v_pk_mul_f16 v71, v71, s21 op_sel:[0,1]
  v_pk_fma_f16 v186, v58, v58, s20 op_sel:[0,0,1]
  v_cvt_pk_f16_f32 v80, v80, v81
  v_mfma_f32_32x32x16_bf16 v[96:111], a[236:239], a[212:215], v[96:111]
  s_waitcnt lgkmcnt(0)
  s_nop 0
  v_cvt_pk_f16_f32 v81, v82, v83
  v_cvt_pk_f16_f32 v82, v84, v85
  v_cvt_pk_f16_f32 v83, v86, v87
  v_pk_mul_f16 v80, v80, s21 op_sel:[0,1]
  v_pk_mul_f16 v81, v81, s21 op_sel:[0,1]
  v_pk_mul_f16 v82, v82, s21 op_sel:[0,1]
  v_smfmac_f32_32x32x32_bf16 v[168:183], v[240:243], v[128:135], v250
  v_pk_mul_f16 v83, v83, s21 op_sel:[0,1]
  v_cvt_pk_f16_f32 v84, v88, v89
  v_cvt_pk_f16_f32 v85, v90, v91
  v_cvt_pk_f16_f32 v86, v92, v93
  v_cvt_pk_f16_f32 v87, v94, v95
  v_mfma_f32_32x32x16_bf16 v[16:31], a[0:3], v[216:219], 0
  v_pk_mul_f16 v84, v84, s21 op_sel:[0,1]
  v_pk_mul_f16 v85, v85, s21 op_sel:[0,1]
  v_pk_mul_f16 v86, v86, s21 op_sel:[0,1]
  v_pk_mul_f16 v87, v87, s21 op_sel:[0,1]
  v_cvt_pk_f16_f32 v96, v96, v97
  v_cvt_pk_f16_f32 v97, v98, v99
  v_cvt_pk_f16_f32 v98, v100, v101
  v_cvt_pk_f16_f32 v99, v102, v103
  v_pk_mul_f16 v96, v96, s21 op_sel:[0,1]
  v_pk_mul_f16 v97, v97, s21 op_sel:[0,1]
  v_pk_mul_f16 v98, v98, s21 op_sel:[0,1]
  v_pk_mul_f16 v99, v99, s21 op_sel:[0,1]
  v_cvt_pk_f16_f32 v100, v104, v105
  v_cvt_pk_f16_f32 v101, v106, v107
  v_cvt_pk_f16_f32 v102, v108, v109
  v_cvt_pk_f16_f32 v103, v110, v111
  v_pk_mul_f16 v100, v100, s21 op_sel:[0,1]
  v_pk_mul_f16 v101, v101, s21 op_sel:[0,1]
  v_pk_mul_f16 v102, v102, s21 op_sel:[0,1]
  v_pk_mul_f16 v103, v103, s21 op_sel:[0,1]
  v_mfma_f32_32x32x16_bf16 v[16:31], a[4:7], v[220:223], v[16:31]
  ds_write_b128 v253, v[64:67] offset:49152
  ds_write_b128 v253, v[68:71] offset:52224
  ds_write_b128 v253, v[80:83] offset:50176
  ds_write_b128 v253, v[84:87] offset:53248
  ds_write_b128 v253, v[96:99] offset:51200
  ds_write_b128 v253, v[100:103] offset:54272
  s_waitcnt lgkmcnt(0)
  s_barrier
  v_mfma_f32_32x32x16_bf16 v[16:31], a[8:11], v[224:227], v[16:31]
  ds_read_b128 v[192:195], v1 offset:8192
  buffer_load_dwordx4 v254, s[72:75], s53 offen lds
  buffer_load_dwordx4 v255, s[72:75], s53 offen offset:1024 lds
  buffer_load_dwordx4 v244, s[72:75], s53 offen offset:2048 lds
  v_mfma_f32_32x32x16_bf16 v[16:31], a[12:15], v[228:231], v[16:31]
  s_add_u32 m0, s14, 0x16c00
  ds_read_b128 v[196:199], v1 offset:9216
  v_pk_fma_f16 v187, v59, v59, s20 op_sel:[0,0,1]
  v_pk_fma_f16 v184, v184, v56, s21 op_sel_hi:[1,1,0]
  v_pk_fma_f16 v185, v185, v57, s21 op_sel_hi:[1,1,0]
  v_pk_fma_f16 v186, v186, v58, s21 op_sel_hi:[1,1,0]
  v_pk_fma_f16 v187, v187, v59, s21 op_sel_hi:[1,1,0]
  v_mfma_f32_32x32x16_bf16 v[16:31], a[16:19], v[232:235], v[16:31]
  ds_read_b128 v[200:203], v1 offset:10240
  buffer_load_dwordx4 v254, s[72:75], s54 offen lds
  buffer_load_dwordx4 v255, s[72:75], s54 offen offset:1024 lds
  buffer_load_dwordx4 v244, s[72:75], s54 offen offset:2048 lds
  v_pk_fma_f16 v184, v184, v48, 0.5 op_sel_hi:[1,1,0] clamp
  v_pk_fma_f16 v185, v185, v49, 0.5 op_sel_hi:[1,1,0] clamp
  v_pk_fma_f16 v186, v186, v50, 0.5 op_sel_hi:[1,1,0] clamp
  v_pk_fma_f16 v187, v187, v51, 0.5 op_sel_hi:[1,1,0] clamp
  v_pk_mul_f16 v184, v184, v48
  v_pk_mul_f16 v185, v185, v49
  v_pk_mul_f16 v186, v186, v50
  v_pk_mul_f16 v187, v187, v51
  v_mfma_f32_32x32x16_bf16 v[16:31], a[20:23], v[236:239], v[16:31]
  s_waitcnt lgkmcnt(2)
  s_mov_b32 m0, s30
  ds_read_b128 v[204:207], v1 offset:11264
  ds_read_b128 v[208:211], v1 offset:12288
  v_or_b32_e64 v12, v64, v65
  v_or3_b32 v12, v66, v67, v12
  v_or3_b32 v12, v68, v69, v12
  v_or3_b32 v12, v70, v71, v12
  v_mfma_f32_32x32x16_f16 v[64:79], v[192:195], v[184:187], v[136:151]
  s_waitcnt lgkmcnt(3)
  buffer_load_dwordx4 v6, s[4:7], s29 offen lds
  buffer_load_dwordx4 v7, s[4:7], s29 offen offset:1024 lds
  buffer_load_dwordx4 v8, s[4:7], s29 offen offset:2048 lds
  buffer_load_dwordx4 v9, s[4:7], s29 offen offset:3072 lds
  v_or3_b32 v12, v80, v81, v12
  v_or3_b32 v12, v82, v83, v12
  v_or3_b32 v12, v84, v85, v12
  v_or3_b32 v12, v86, v87, v12
  v_mfma_f32_32x32x16_f16 v[80:95], v[196:199], v[184:187], v[152:167]
  s_waitcnt lgkmcnt(2)
  ds_read_b128 v[212:215], v1 offset:13312
  v_pk_fma_f16 v56, v52, v52, s20 op_sel_hi:[1,1,0] neg_lo:[1,0,0] neg_hi:[1,0,0] clamp
  v_pk_fma_f16 v57, v53, v53, s20 op_sel_hi:[1,1,0] neg_lo:[1,0,0] neg_hi:[1,0,0] clamp
  v_pk_fma_f16 v58, v54, v54, s20 op_sel_hi:[1,1,0] neg_lo:[1,0,0] neg_hi:[1,0,0] clamp
  v_pk_fma_f16 v59, v55, v55, s20 op_sel_hi:[1,1,0] neg_lo:[1,0,0] neg_hi:[1,0,0] clamp
  v_pk_fma_f16 v188, v56, v56, s20 op_sel:[0,0,1]
  v_pk_fma_f16 v189, v57, v57, s20 op_sel:[0,0,1]
  v_pk_fma_f16 v190, v58, v58, s20 op_sel:[0,0,1]
  v_pk_fma_f16 v191, v59, v59, s20 op_sel:[0,0,1]
  v_pk_fma_f16 v188, v188, v56, s21 op_sel_hi:[1,1,0]
  v_pk_fma_f16 v189, v189, v57, s21 op_sel_hi:[1,1,0]
  v_pk_fma_f16 v190, v190, v58, s21 op_sel_hi:[1,1,0]
  v_pk_fma_f16 v191, v191, v59, s21 op_sel_hi:[1,1,0]
  v_pk_fma_f16 v188, v188, v52, 0.5 op_sel_hi:[1,1,0] clamp
  v_pk_fma_f16 v189, v189, v53, 0.5 op_sel_hi:[1,1,0] clamp
  v_pk_fma_f16 v190, v190, v54, 0.5 op_sel_hi:[1,1,0] clamp
  v_pk_fma_f16 v191, v191, v55, 0.5 op_sel_hi:[1,1,0] clamp
  v_pk_mul_f16 v188, v188, v52
  v_pk_mul_f16 v189, v189, v53
  v_pk_mul_f16 v190, v190, v54
  v_pk_mul_f16 v191, v191, v55
  v_or3_b32 v12, v96, v97, v12
  v_or3_b32 v12, v98, v99, v12
  v_or3_b32 v12, v100, v101, v12
  v_or3_b32 v12, v102, v103, v12
  v_mfma_f32_32x32x16_f16 v[96:111], v[200:203], v[184:187], v[168:183]
  s_waitcnt lgkmcnt(2)
  s_mov_b32 m0, s31
  v_cvt_pk_f16_f32 v48, v16, v17
  v_cvt_pk_f16_f32 v49, v18, v19
  v_cvt_pk_f16_f32 v50, v20, v21
  v_cvt_pk_f16_f32 v51, v22, v23
  v_cvt_pk_f16_f32 v52, v24, v25
  v_cvt_pk_f16_f32 v53, v26, v27
  v_mfma_f32_32x32x16_f16 v[64:79], v[204:207], v[188:191], v[64:79]
  s_waitcnt lgkmcnt(1)
  s_nop 0
  ds_read_b128 v[192:195], v1 offset:14336
  ds_read_b128 v[196:199], v1 offset:15360
  v_cvt_pk_f16_f32 v54, v28, v29
  v_cvt_pk_f16_f32 v55, v30, v31
  v_pk_fma_f16 v56, v48, v48, s20 op_sel_hi:[1,1,0] neg_lo:[1,0,0] neg_hi:[1,0,0] clamp
  v_pk_fma_f16 v57, v49, v49, s20 op_sel_hi:[1,1,0] neg_lo:[1,0,0] neg_hi:[1,0,0] clamp
  v_mfma_f32_32x32x16_f16 v[80:95], v[208:211], v[188:191], v[80:95]
  s_waitcnt lgkmcnt(2)
  buffer_load_dwordx4 v6, s[4:7], s52 offen lds
  buffer_load_dwordx4 v7, s[4:7], s52 offen offset:1024 lds
  buffer_load_dwordx4 v8, s[4:7], s52 offen offset:2048 lds
  buffer_load_dwordx4 v9, s[4:7], s52 offen offset:3072 lds
  v_mfma_f32_32x32x16_f16 v[96:111], v[212:215], v[188:191], v[96:111]
  s_cmp_eq_u32 s26, 1
  v_pk_fma_f16 v58, v50, v50, s20 op_sel_hi:[1,1,0] neg_lo:[1,0,0] neg_hi:[1,0,0] clamp
  v_pk_fma_f16 v59, v51, v51, s20 op_sel_hi:[1,1,0] neg_lo:[1,0,0] neg_hi:[1,0,0] clamp
  v_pk_fma_f16 v184, v56, v56, s20 op_sel:[0,0,1]
  v_pk_fma_f16 v185, v57, v57, s20 op_sel:[0,0,1]
  v_pk_fma_f16 v186, v58, v58, s20 op_sel:[0,0,1]
  v_pk_fma_f16 v187, v59, v59, s20 op_sel:[0,0,1]
  v_mfma_f32_32x32x16_bf16 v[16:31], a[24:27], v[216:219], 0
  s_cselect_b32 s35, 0x40000000, s23
  s_add_u32 s29, s29, s35
  s_add_u32 m0, s14, 0x1c000
  v_pk_fma_f16 v184, v184, v56, s21 op_sel_hi:[1,1,0]
  v_pk_fma_f16 v185, v185, v57, s21 op_sel_hi:[1,1,0]
  v_pk_fma_f16 v186, v186, v58, s21 op_sel_hi:[1,1,0]
  v_pk_fma_f16 v187, v187, v59, s21 op_sel_hi:[1,1,0]
  v_pk_fma_f16 v184, v184, v48, 0.5 op_sel_hi:[1,1,0] clamp
  v_pk_fma_f16 v185, v185, v49, 0.5 op_sel_hi:[1,1,0] clamp
  v_mfma_f32_32x32x16_bf16 v[16:31], a[28:31], v[220:223], v[16:31]
  buffer_load_dwordx4 v254, s[72:75], s55 offen lds
  buffer_load_dwordx4 v255, s[72:75], s55 offen offset:1024 lds
  buffer_load_dwordx4 v244, s[72:75], s55 offen offset:2048 lds
  v_pk_fma_f16 v186, v186, v50, 0.5 op_sel_hi:[1,1,0] clamp
  v_mfma_f32_32x32x16_bf16 v[16:31], a[32:35], v[224:227], v[16:31]
  s_add_u32 m0, s14, 0x1cc00
  ds_read_b128 v[200:203], v1 offset:16384
  v_pk_fma_f16 v187, v187, v51, 0.5 op_sel_hi:[1,1,0] clamp
  v_pk_mul_f16 v184, v184, v48
  v_pk_mul_f16 v185, v185, v49
  v_pk_mul_f16 v186, v186, v50
  v_pk_mul_f16 v187, v187, v51
  v_mfma_f32_32x32x16_bf16 v[16:31], a[36:39], v[228:231], v[16:31]
  s_nop 0
  ds_read_b128 v[204:207], v1 offset:17408
  buffer_load_dwordx4 v254, s[72:75], s56 offen lds
  buffer_load_dwordx4 v255, s[72:75], s56 offen offset:1024 lds
  buffer_load_dwordx4 v244, s[72:75], s56 offen offset:2048 lds
  v_mfma_f32_32x32x16_bf16 v[16:31], a[40:43], v[232:235], v[16:31]
  s_add_u32 s52, s52, s35
  ds_read_b128 v[208:211], v1 offset:18432
  v_pk_fma_f16 v56, v52, v52, s20 op_sel_hi:[1,1,0] neg_lo:[1,0,0] neg_hi:[1,0,0] clamp
  v_pk_fma_f16 v57, v53, v53, s20 op_sel_hi:[1,1,0] neg_lo:[1,0,0] neg_hi:[1,0,0] clamp
  v_pk_fma_f16 v58, v54, v54, s20 op_sel_hi:[1,1,0] neg_lo:[1,0,0] neg_hi:[1,0,0] clamp
  v_pk_fma_f16 v59, v55, v55, s20 op_sel_hi:[1,1,0] neg_lo:[1,0,0] neg_hi:[1,0,0] clamp
  v_pk_fma_f16 v188, v56, v56, s20 op_sel:[0,0,1]
  v_mfma_f32_32x32x16_bf16 v[16:31], a[44:47], v[236:239], v[16:31]
  s_waitcnt vmcnt(14) lgkmcnt(3)
  v_pk_fma_f16 v189, v57, v57, s20 op_sel:[0,0,1]
  v_pk_fma_f16 v190, v58, v58, s20 op_sel:[0,0,1]
  v_pk_fma_f16 v191, v59, v59, s20 op_sel:[0,0,1]
  v_pk_fma_f16 v188, v188, v56, s21 op_sel_hi:[1,1,0]
  v_pk_fma_f16 v189, v189, v57, s21 op_sel_hi:[1,1,0]
  v_pk_fma_f16 v190, v190, v58, s21 op_sel_hi:[1,1,0]
  v_mfma_f32_32x32x16_f16 v[64:79], v[192:195], v[184:187], v[64:79]
  s_mov_b32 s32, s30
  v_pk_fma_f16 v191, v191, v59, s21 op_sel_hi:[1,1,0]
  v_pk_fma_f16 v188, v188, v52, 0.5 op_sel_hi:[1,1,0] clamp
  v_pk_fma_f16 v189, v189, v53, 0.5 op_sel_hi:[1,1,0] clamp
  v_pk_fma_f16 v190, v190, v54, 0.5 op_sel_hi:[1,1,0] clamp
  v_pk_fma_f16 v191, v191, v55, 0.5 op_sel_hi:[1,1,0] clamp
  v_pk_mul_f16 v188, v188, v52
  v_mfma_f32_32x32x16_f16 v[80:95], v[196:199], v[184:187], v[80:95]
  s_waitcnt lgkmcnt(2)
  ds_read_b128 v[212:215], v1 offset:19456
  ds_read_b128 a[216:219], v251
  ds_read_b128 a[220:223], v252
  v_pk_mul_f16 v189, v189, v53
  v_pk_mul_f16 v190, v190, v54
  v_pk_mul_f16 v191, v191, v55
  v_mfma_f32_32x32x16_f16 v[96:111], v[200:203], v[184:187], v[96:111]
  s_waitcnt lgkmcnt(4)
  ds_read_b128 a[224:227], v251 offset:64
  ds_read_b128 a[228:231], v252 offset:64
  ds_read_b128 a[232:235], v251 offset:128
  v_cvt_pk_f16_f32 v48, v16, v17
  v_cvt_pk_f16_f32 v49, v18, v19
  v_cvt_pk_f16_f32 v50, v20, v21
  v_mfma_f32_32x32x16_f16 v[64:79], v[204:207], v[188:191], v[64:79]
  s_waitcnt lgkmcnt(6)
  ds_read_b128 a[236:239], v252 offset:128
  v_cvt_pk_f16_f32 v51, v22, v23
  v_cvt_pk_f16_f32 v52, v24, v25
  v_cvt_pk_f16_f32 v53, v26, v27
  v_cvt_pk_f16_f32 v54, v28, v29
  v_cvt_pk_f16_f32 v55, v30, v31
  v_mfma_f32_32x32x16_f16 v[80:95], v[208:211], v[188:191], v[80:95]
  s_waitcnt lgkmcnt(6)
  ds_read_b128 v[192:195], v1 offset:20480
  ds_read_b128 v[196:199], v1 offset:21504
  v_pk_fma_f16 v56, v48, v48, s20 op_sel_hi:[1,1,0] neg_lo:[1,0,0] neg_hi:[1,0,0] clamp
  v_pk_fma_f16 v57, v49, v49, s20 op_sel_hi:[1,1,0] neg_lo:[1,0,0] neg_hi:[1,0,0] clamp
  v_pk_fma_f16 v58, v50, v50, s20 op_sel_hi:[1,1,0] neg_lo:[1,0,0] neg_hi:[1,0,0] clamp
  v_pk_fma_f16 v59, v51, v51, s20 op_sel_hi:[1,1,0] neg_lo:[1,0,0] neg_hi:[1,0,0] clamp
  v_mfma_f32_32x32x16_f16 v[96:111], v[212:215], v[188:191], v[96:111]
  s_waitcnt lgkmcnt(7)
  v_pk_fma_f16 v184, v56, v56, s20 op_sel:[0,0,1]
  v_pk_fma_f16 v185, v57, v57, s20 op_sel:[0,0,1]
  v_pk_fma_f16 v186, v58, v58, s20 op_sel:[0,0,1]
  v_pk_fma_f16 v187, v59, v59, s20 op_sel:[0,0,1]
  v_pk_fma_f16 v184, v184, v56, s21 op_sel_hi:[1,1,0]
  v_pk_fma_f16 v185, v185, v57, s21 op_sel_hi:[1,1,0]
  v_mfma_f32_32x32x16_bf16 v[112:127], a[216:219], a[192:195], 0
  s_waitcnt lgkmcnt(6)
  v_pk_fma_f16 v186, v186, v58, s21 op_sel_hi:[1,1,0]
  v_pk_fma_f16 v187, v187, v59, s21 op_sel_hi:[1,1,0]
  v_pk_fma_f16 v184, v184, v48, 0.5 op_sel_hi:[1,1,0] clamp
  v_pk_fma_f16 v185, v185, v49, 0.5 op_sel_hi:[1,1,0] clamp
  v_pk_fma_f16 v186, v186, v50, 0.5 op_sel_hi:[1,1,0] clamp
  v_pk_fma_f16 v187, v187, v51, 0.5 op_sel_hi:[1,1,0] clamp
  v_mfma_f32_32x32x16_bf16 v[112:127], a[220:223], a[196:199], v[112:127]
  s_waitcnt lgkmcnt(3)
  ds_read_b128 v[200:203], v1 offset:22528
  ds_read_b128 v[204:207], v1 offset:23552
  v_pk_mul_f16 v184, v184, v48
  v_pk_mul_f16 v185, v185, v49
  v_pk_mul_f16 v186, v186, v50
  v_pk_mul_f16 v187, v187, v51
  v_mfma_f32_32x32x16_bf16 v[128:143], a[224:227], a[200:203], 0
  s_add_u32 s30, s33, 32
  ds_read_b128 v[208:211], v1 offset:24576
  v_pk_fma_f16 v56, v52, v52, s20 op_sel_hi:[1,1,0] neg_lo:[1,0,0] neg_hi:[1,0,0] clamp
  v_pk_fma_f16 v57, v53, v53, s20 op_sel_hi:[1,1,0] neg_lo:[1,0,0] neg_hi:[1,0,0] clamp
  v_pk_fma_f16 v58, v54, v54, s20 op_sel_hi:[1,1,0] neg_lo:[1,0,0] neg_hi:[1,0,0] clamp
  v_pk_fma_f16 v59, v55, v55, s20 op_sel_hi:[1,1,0] neg_lo:[1,0,0] neg_hi:[1,0,0] clamp
  v_pk_fma_f16 v188, v56, v56, s20 op_sel:[0,0,1]
  v_mfma_f32_32x32x16_bf16 v[128:143], a[228:231], a[204:207], v[128:143]
  s_mov_b32 s33, s31
  v_pk_fma_f16 v189, v57, v57, s20 op_sel:[0,0,1]
  v_pk_fma_f16 v190, v58, v58, s20 op_sel:[0,0,1]
  v_pk_fma_f16 v191, v59, v59, s20 op_sel:[0,0,1]
  v_pk_fma_f16 v188, v188, v56, s21 op_sel_hi:[1,1,0]
  v_pk_fma_f16 v189, v189, v57, s21 op_sel_hi:[1,1,0]
  v_pk_fma_f16 v190, v190, v58, s21 op_sel_hi:[1,1,0]
  v_mfma_f32_32x32x16_bf16 v[144:159], a[232:235], a[208:211], 0
  s_waitcnt lgkmcnt(3)
  v_pk_fma_f16 v191, v191, v59, s21 op_sel_hi:[1,1,0]
  v_pk_fma_f16 v188, v188, v52, 0.5 op_sel_hi:[1,1,0] clamp
  v_pk_fma_f16 v189, v189, v53, 0.5 op_sel_hi:[1,1,0] clamp
  v_pk_fma_f16 v190, v190, v54, 0.5 op_sel_hi:[1,1,0] clamp
  v_pk_fma_f16 v191, v191, v55, 0.5 op_sel_hi:[1,1,0] clamp
  v_pk_mul_f16 v188, v188, v52
  v_mfma_f32_32x32x16_bf16 v[144:159], a[236:239], a[212:215], v[144:159]
  s_sub_u32 s31, s32, 32
  ds_read_b128 v[212:215], v1 offset:25600
  v_pk_mul_f16 v189, v189, v53
  v_pk_mul_f16 v190, v190, v54
  v_pk_mul_f16 v191, v191, v55
  v_cvt_pk_f16_f32 v112, v112, v113
  v_cvt_pk_f16_f32 v113, v114, v115
  v_mfma_f32_32x32x16_bf16 v[16:31], a[48:51], v[216:219], 0
  s_nop 0
  v_cvt_pk_f16_f32 v114, v116, v117
  v_cvt_pk_f16_f32 v115, v118, v119
  v_pk_mul_f16 v112, v112, s21 op_sel:[0,1]
  v_pk_mul_f16 v113, v113, s21 op_sel:[0,1]
  v_pk_mul_f16 v114, v114, s21 op_sel:[0,1]
  v_pk_mul_f16 v115, v115, s21 op_sel:[0,1]
  v_mfma_f32_32x32x16_bf16 v[16:31], a[52:55], v[220:223], v[16:31]
  v_cvt_pk_f16_f32 v116, v120, v121
  v_cvt_pk_f16_f32 v117, v122, v123
  v_cvt_pk_f16_f32 v118, v124, v125
  v_cvt_pk_f16_f32 v119, v126, v127
  v_pk_mul_f16 v116, v116, s21 op_sel:[0,1]
  v_pk_mul_f16 v117, v117, s21 op_sel:[0,1]
  v_mfma_f32_32x32x16_bf16 v[16:31], a[56:59], v[224:227], v[16:31]
  v_pk_mul_f16 v118, v118, s21 op_sel:[0,1]
  v_pk_mul_f16 v119, v119, s21 op_sel:[0,1]
  v_or3_b32 v12, v112, v113, v12
  v_or3_b32 v12, v114, v115, v12
  v_or3_b32 v12, v116, v117, v12
  v_or3_b32 v12, v118, v119, v12
  v_mfma_f32_32x32x16_bf16 v[16:31], a[60:63], v[228:231], v[16:31]
  ds_write_b128 v253, v[112:115]
  v_cvt_pk_f16_f32 v128, v128, v129
  v_mfma_f32_32x32x16_bf16 v[16:31], a[64:67], v[232:235], v[16:31]
  s_nop 0
  ds_write_b128 v253, v[116:119] offset:3072
  v_cvt_pk_f16_f32 v129, v130, v131
  v_mfma_f32_32x32x16_bf16 v[16:31], a[68:71], v[236:239], v[16:31]
  s_waitcnt vmcnt(0)
  ds_read_b128 a[216:219], v251 offset:24576
  ds_read_b128 a[220:223], v252 offset:24576
  ds_read_b128 a[224:227], v251 offset:24640
  v_cvt_pk_f16_f32 v130, v132, v133
  v_cvt_pk_f16_f32 v131, v134, v135
  v_pk_mul_f16 v128, v128, s21 op_sel:[0,1]
  v_mfma_f32_32x32x16_f16 v[64:79], v[192:195], v[184:187], v[64:79]
  ds_read_b128 a[228:231], v252 offset:24640
  v_pk_mul_f16 v129, v129, s21 op_sel:[0,1]
  v_pk_mul_f16 v130, v130, s21 op_sel:[0,1]
  v_pk_mul_f16 v131, v131, s21 op_sel:[0,1]
  v_cvt_pk_f16_f32 v132, v136, v137
  v_cvt_pk_f16_f32 v133, v138, v139
  v_mfma_f32_32x32x16_f16 v[80:95], v[196:199], v[184:187], v[80:95]
  s_waitcnt lgkmcnt(6)
  s_nop 0
  v_cvt_pk_f16_f32 v134, v140, v141
  v_cvt_pk_f16_f32 v135, v142, v143
  v_pk_mul_f16 v132, v132, s21 op_sel:[0,1]
  v_pk_mul_f16 v133, v133, s21 op_sel:[0,1]
  v_pk_mul_f16 v134, v134, s21 op_sel:[0,1]
  v_pk_mul_f16 v135, v135, s21 op_sel:[0,1]
  v_mfma_f32_32x32x16_f16 v[96:111], v[200:203], v[184:187], v[96:111]
  ds_read_b128 a[232:235], v251 offset:24704
  ds_write_b128 v253, v[128:131] offset:1024
  v_mfma_f32_32x32x16_f16 v[64:79], v[204:207], v[188:191], v[64:79]
  ds_write_b128 v253, v[132:135] offset:4096
  v_or3_b32 v12, v128, v129, v12
  v_mfma_f32_32x32x16_f16 v[80:95], v[208:211], v[188:191], v[80:95]
  s_nop 0
  ds_read_b128 a[236:239], v252 offset:24704
  v_or3_b32 v12, v130, v131, v12
  v_or3_b32 v12, v132, v133, v12
  v_or3_b32 v12, v134, v135, v12
  v_cvt_pk_f16_f32 v144, v144, v145
  v_cvt_pk_f16_f32 v145, v146, v147
  v_mfma_f32_32x32x16_f16 v[96:111], v[212:215], v[188:191], v[96:111]
  s_waitcnt lgkmcnt(4)
  v_cvt_pk_f16_f32 v146, v148, v149
  v_cvt_pk_f16_f32 v147, v150, v151
  v_pk_mul_f16 v144, v144, s21 op_sel:[0,1]
  v_pk_mul_f16 v145, v145, s21 op_sel:[0,1]
  v_pk_mul_f16 v146, v146, s21 op_sel:[0,1]
  v_pk_mul_f16 v147, v147, s21 op_sel:[0,1]
  v_mfma_f32_32x32x16_bf16 v[112:127], a[216:219], a[192:195], 0
  v_cvt_pk_f16_f32 v148, v152, v153
  v_cvt_pk_f16_f32 v149, v154, v155
  v_cvt_pk_f16_f32 v150, v156, v157
  v_cvt_pk_f16_f32 v151, v158, v159
  v_pk_mul_f16 v148, v148, s21 op_sel:[0,1]
  v_pk_mul_f16 v149, v149, s21 op_sel:[0,1]
  v_mfma_f32_32x32x16_bf16 v[112:127], a[220:223], a[196:199], v[112:127]
  v_pk_mul_f16 v150, v150, s21 op_sel:[0,1]
  v_pk_mul_f16 v151, v151, s21 op_sel:[0,1]
  v_or3_b32 v12, v144, v145, v12
  v_or3_b32 v12, v146, v147, v12
  v_or3_b32 v12, v148, v149, v12
  v_or3_b32 v12, v150, v151, v12
  v_mfma_f32_32x32x16_bf16 v[128:143], a[224:227], a[200:203], 0
  ds_write_b128 v253, v[144:147] offset:2048
  v_cvt_pk_f16_f32 v48, v16, v17
  v_mfma_f32_32x32x16_bf16 v[128:143], a[228:231], a[204:207], v[128:143]
  s_waitcnt lgkmcnt(1)
  ds_write_b128 v253, v[148:151] offset:5120
  v_cvt_pk_f16_f32 v49, v18, v19
  v_mfma_f32_32x32x16_bf16 v[144:159], a[232:235], a[208:211], 0
  s_nop 0
  v_cvt_pk_f16_f32 v50, v20, v21
  v_cvt_pk_f16_f32 v51, v22, v23
  v_cvt_pk_f16_f32 v52, v24, v25
  v_cvt_pk_f16_f32 v53, v26, v27
  v_cvt_pk_f16_f32 v54, v28, v29
  v_cvt_pk_f16_f32 v55, v30, v31
  v_mfma_f32_32x32x16_bf16 v[144:159], a[236:239], a[212:215], v[144:159]
  ds_read_b128 v[192:195], v1 offset:26624
  ds_read_b128 v[196:199], v1 offset:27648
  v_pk_fma_f16 v56, v48, v48, s20 op_sel_hi:[1,1,0] neg_lo:[1,0,0] neg_hi:[1,0,0] clamp
  v_pk_fma_f16 v57, v49, v49, s20 op_sel_hi:[1,1,0] neg_lo:[1,0,0] neg_hi:[1,0,0] clamp
  v_pk_fma_f16 v58, v50, v50, s20 op_sel_hi:[1,1,0] neg_lo:[1,0,0] neg_hi:[1,0,0] clamp
  v_pk_fma_f16 v59, v51, v51, s20 op_sel_hi:[1,1,0] neg_lo:[1,0,0] neg_hi:[1,0,0] clamp
  v_mfma_f32_32x32x16_bf16 v[16:31], a[72:75], v[216:219], 0
  v_pk_fma_f16 v184, v56, v56, s20 op_sel:[0,0,1]
  v_pk_fma_f16 v185, v57, v57, s20 op_sel:[0,0,1]
  v_pk_fma_f16 v186, v58, v58, s20 op_sel:[0,0,1]
  v_pk_fma_f16 v187, v59, v59, s20 op_sel:[0,0,1]
  v_pk_fma_f16 v184, v184, v56, s21 op_sel_hi:[1,1,0]
  v_pk_fma_f16 v185, v185, v57, s21 op_sel_hi:[1,1,0]
  v_mfma_f32_32x32x16_bf16 v[16:31], a[76:79], v[220:223], v[16:31]
  v_pk_fma_f16 v186, v186, v58, s21 op_sel_hi:[1,1,0]
  v_pk_fma_f16 v187, v187, v59, s21 op_sel_hi:[1,1,0]
  v_pk_fma_f16 v184, v184, v48, 0.5 op_sel_hi:[1,1,0] clamp
  v_pk_fma_f16 v185, v185, v49, 0.5 op_sel_hi:[1,1,0] clamp
  v_pk_fma_f16 v186, v186, v50, 0.5 op_sel_hi:[1,1,0] clamp
  v_pk_fma_f16 v187, v187, v51, 0.5 op_sel_hi:[1,1,0] clamp
  v_mfma_f32_32x32x16_bf16 v[16:31], a[80:83], v[224:227], v[16:31]
  ds_read_b128 v[200:203], v1 offset:28672
  ds_read_b128 v[204:207], v1 offset:29696
  v_pk_mul_f16 v184, v184, v48
  v_pk_mul_f16 v185, v185, v49
  v_pk_mul_f16 v186, v186, v50
  v_pk_mul_f16 v187, v187, v51
  v_mfma_f32_32x32x16_bf16 v[16:31], a[84:87], v[228:231], v[16:31]
  ds_read_b128 v[208:211], v1 offset:30720
  v_pk_fma_f16 v56, v52, v52, s20 op_sel_hi:[1,1,0] neg_lo:[1,0,0] neg_hi:[1,0,0] clamp
  v_pk_fma_f16 v57, v53, v53, s20 op_sel_hi:[1,1,0] neg_lo:[1,0,0] neg_hi:[1,0,0] clamp
  v_pk_fma_f16 v58, v54, v54, s20 op_sel_hi:[1,1,0] neg_lo:[1,0,0] neg_hi:[1,0,0] clamp
  v_pk_fma_f16 v59, v55, v55, s20 op_sel_hi:[1,1,0] neg_lo:[1,0,0] neg_hi:[1,0,0] clamp
  v_pk_fma_f16 v188, v56, v56, s20 op_sel:[0,0,1]
  v_mfma_f32_32x32x16_bf16 v[16:31], a[88:91], v[232:235], v[16:31]
  v_pk_fma_f16 v189, v57, v57, s20 op_sel:[0,0,1]
  v_pk_fma_f16 v190, v58, v58, s20 op_sel:[0,0,1]
  v_pk_fma_f16 v191, v59, v59, s20 op_sel:[0,0,1]
  v_pk_fma_f16 v188, v188, v56, s21 op_sel_hi:[1,1,0]
  v_pk_fma_f16 v189, v189, v57, s21 op_sel_hi:[1,1,0]
  v_pk_fma_f16 v190, v190, v58, s21 op_sel_hi:[1,1,0]
  v_mfma_f32_32x32x16_bf16 v[16:31], a[92:95], v[236:239], v[16:31]
  s_waitcnt lgkmcnt(3)
  s_nop 0
  v_pk_fma_f16 v191, v191, v59, s21 op_sel_hi:[1,1,0]
  v_pk_fma_f16 v188, v188, v52, 0.5 op_sel_hi:[1,1,0] clamp
  v_pk_fma_f16 v189, v189, v53, 0.5 op_sel_hi:[1,1,0] clamp
  v_pk_fma_f16 v190, v190, v54, 0.5 op_sel_hi:[1,1,0] clamp
  v_pk_fma_f16 v191, v191, v55, 0.5 op_sel_hi:[1,1,0] clamp
  v_pk_mul_f16 v188, v188, v52
  v_mfma_f32_32x32x16_f16 v[64:79], v[192:195], v[184:187], v[64:79]
  buffer_load_dword v249, v248, s[4:7], s29 offen
  v_pk_mul_f16 v189, v189, v53
  v_pk_mul_f16 v190, v190, v54
  v_mfma_f32_32x32x16_f16 v[80:95], v[196:199], v[184:187], v[80:95]
  s_waitcnt lgkmcnt(1)
  ds_read_b128 v[212:215], v1 offset:31744
  v_pk_mul_f16 v191, v191, v55
  v_min_u32 v5, v14, v5
  v_subrev_u32 v14, 0x4100, v4
  v_add_u32 v4, 0x8200, v4
  v_min_u32_e64 v4, v14, v4
  v_cvt_pk_f16_f32 v112, v112, v113
  v_cvt_pk_f16_f32 v113, v114, v115
  v_cvt_pk_f16_f32 v114, v116, v117
  v_cvt_pk_f16_f32 v115, v118, v119
  v_pk_mul_f16 v112, v112, s21 op_sel:[0,1]
  v_pk_mul_f16 v113, v113, s21 op_sel:[0,1]
  v_pk_mul_f16 v114, v114, s21 op_sel:[0,1]
  v_pk_mul_f16 v115, v115, s21 op_sel:[0,1]
  v_cvt_pk_f16_f32 v116, v120, v121
  v_cvt_pk_f16_f32 v117, v122, v123
  v_cvt_pk_f16_f32 v118, v124, v125
  v_cvt_pk_f16_f32 v119, v126, v127
  v_pk_mul_f16 v116, v116, s21 op_sel:[0,1]
  v_pk_mul_f16 v117, v117, s21 op_sel:[0,1]
  v_pk_mul_f16 v118, v118, s21 op_sel:[0,1]
  v_pk_mul_f16 v119, v119, s21 op_sel:[0,1]
  v_or3_b32 v12, v112, v113, v12
  v_or3_b32 v12, v114, v115, v12
  v_or3_b32 v12, v116, v117, v12
  v_or3_b32 v12, v118, v119, v12
  v_cvt_pk_f16_f32 v128, v128, v129
  v_cvt_pk_f16_f32 v129, v130, v131
  v_cvt_pk_f16_f32 v130, v132, v133
  v_cvt_pk_f16_f32 v131, v134, v135
  v_pk_mul_f16 v128, v128, s21 op_sel:[0,1]
  v_pk_mul_f16 v129, v129, s21 op_sel:[0,1]
  v_pk_mul_f16 v130, v130, s21 op_sel:[0,1]
  v_pk_mul_f16 v131, v131, s21 op_sel:[0,1]
  v_cvt_pk_f16_f32 v132, v136, v137
  v_cvt_pk_f16_f32 v133, v138, v139
  v_cvt_pk_f16_f32 v134, v140, v141
  v_cvt_pk_f16_f32 v135, v142, v143
  v_pk_mul_f16 v132, v132, s21 op_sel:[0,1]
  v_pk_mul_f16 v133, v133, s21 op_sel:[0,1]
  v_pk_mul_f16 v134, v134, s21 op_sel:[0,1]
  v_pk_mul_f16 v135, v135, s21 op_sel:[0,1]
  v_or3_b32 v12, v128, v129, v12
  v_or3_b32 v12, v130, v131, v12
  v_or3_b32 v12, v132, v133, v12
  v_or3_b32 v12, v134, v135, v12
  v_cvt_pk_f16_f32 v144, v144, v145
  v_cvt_pk_f16_f32 v145, v146, v147
  v_cvt_pk_f16_f32 v146, v148, v149
  v_cvt_pk_f16_f32 v147, v150, v151
  v_pk_mul_f16 v144, v144, s21 op_sel:[0,1]
  v_pk_mul_f16 v145, v145, s21 op_sel:[0,1]
  v_pk_mul_f16 v146, v146, s21 op_sel:[0,1]
  v_pk_mul_f16 v147, v147, s21 op_sel:[0,1]
  v_cvt_pk_f16_f32 v148, v152, v153
  v_cvt_pk_f16_f32 v149, v154, v155
  v_cvt_pk_f16_f32 v150, v156, v157
  v_cvt_pk_f16_f32 v151, v158, v159
  v_pk_mul_f16 v148, v148, s21 op_sel:[0,1]
  v_pk_mul_f16 v149, v149, s21 op_sel:[0,1]
  v_pk_mul_f16 v150, v150, s21 op_sel:[0,1]
  v_pk_mul_f16 v151, v151, s21 op_sel:[0,1]
  v_or3_b32 v12, v144, v145, v12
  v_or3_b32 v12, v146, v147, v12
  v_or3_b32 v12, v148, v149, v12
  v_or3_b32 v12, v150, v151, v12
  v_mfma_f32_32x32x16_f16 v[96:111], v[200:203], v[184:187], v[96:111]
  ds_read_b128 v[160:163], v3 offset:2400
  ds_read_b128 v[164:167], v4 offset:96
  ds_read_b128 v[168:171], v4 offset:288
  v_and_b32 v13, 0x40004000, v12
  v_and_b32 v12, 0x30003000, v12
  v_cmp_ne_u32 vcc, 0, v13
  v_mfma_f32_32x32x16_f16 v[64:79], v[204:207], v[188:191], v[64:79]
  s_waitcnt lgkmcnt(4)
  s_cmp_lg_u64 vcc, 0
  s_cselect_b32 s3, 1, s3
  ds_read_b128 v[172:175], v4 offset:480
  ds_read2_b64 v[176:179], v11 offset0:192 offset1:200
  ds_read_b128 v[32:35], v0 offset:12288
  ds_read_b128 v[36:39], v0 offset:13312
  ds_read_b128 v[40:43], v0 offset:14336
  ds_read_b128 v[44:47], v0 offset:15360
  ds_read_b128 v[60:63], v0 offset:16384
  ds_read_b128 v[244:247], v0 offset:17408
  ds_read_b128 a[192:195], v0
  ds_read_b128 a[196:199], v0 offset:1024
  ds_read_b128 a[200:203], v0 offset:2048
  ds_read_b128 a[204:207], v0 offset:3072
  ds_read_b128 a[208:211], v0 offset:4096
  ds_read_b128 a[212:215], v0 offset:5120
  ds_read_b128 a[216:219], v0 offset:6144
  ds_read_b128 a[220:223], v0 offset:7168
  ds_read_b128 a[224:227], v0 offset:8192
  ds_read_b128 a[228:231], v0 offset:9216
  ds_read_b128 a[232:235], v0 offset:10240
  ds_read_b128 a[236:239], v0 offset:11264
  v_cmp_ne_u32 vcc, 0, v12
  v_lshl_add_u32 v13, s27, 2, v2
  v_mfma_f32_32x32x16_f16 v[80:95], v[208:211], v[188:191], v[80:95]
  s_waitcnt lgkmcnt(15)
  s_cmp_eq_u64 vcc, 0
  s_cselect_b32 s3, 1, s3
  v_mov_b32 v12, s3
  v_cvt_pk_f16_f32 v48, v16, v17
  v_cvt_pk_f16_f32 v49, v18, v19
  v_cvt_pk_f16_f32 v50, v20, v21
  v_cvt_pk_f16_f32 v51, v22, v23
  v_mfma_f32_32x32x16_f16 v[96:111], v[212:215], v[188:191], v[96:111]
  s_waitcnt lgkmcnt(0)
  ds_write_b32 v13, v12 offset:384
  ds_write_b128 v253, v[112:115] offset:24576
  ds_write_b128 v253, v[116:119] offset:27648
  ds_write_b128 v253, v[128:131] offset:25600
  ds_write_b128 v253, v[132:135] offset:28672
  ds_write_b128 v253, v[144:147] offset:26624
  ds_write_b128 v253, v[148:151] offset:29696
  v_cvt_pk_f16_f32 v52, v24, v25
  v_cvt_pk_f16_f32 v53, v26, v27
  v_cvt_pk_f16_f32 v54, v28, v29
  v_cvt_pk_f16_f32 v55, v30, v31
  v_pk_fma_f16 v56, v48, v48, s20 op_sel_hi:[1,1,0] neg_lo:[1,0,0] neg_hi:[1,0,0] clamp
  v_pk_fma_f16 v57, v49, v49, s20 op_sel_hi:[1,1,0] neg_lo:[1,0,0] neg_hi:[1,0,0] clamp
  v_pk_fma_f16 v58, v50, v50, s20 op_sel_hi:[1,1,0] neg_lo:[1,0,0] neg_hi:[1,0,0] clamp
  v_pk_fma_f16 v59, v51, v51, s20 op_sel_hi:[1,1,0] neg_lo:[1,0,0] neg_hi:[1,0,0] clamp
  v_pk_fma_f16 v184, v56, v56, s20 op_sel:[0,0,1]
  v_pk_fma_f16 v185, v57, v57, s20 op_sel:[0,0,1]
  v_pk_fma_f16 v186, v58, v58, s20 op_sel:[0,0,1]
  v_pk_fma_f16 v187, v59, v59, s20 op_sel:[0,0,1]
  s_waitcnt lgkmcnt(0)
  s_barrier
  .p2align 6
L_loop:
  v_mfma_f32_32x32x16_bf16 v[16:31], a[96:99], v[216:219], 0
  s_add_u32 s28, s28, 0x60000
  ds_read_b128 v[192:195], v0 offset:24576
  v_pk_fma_f16 v184, v184, v56, s21 op_sel_hi:[1,1,0]
  v_pk_fma_f16 v185, v185, v57, s21 op_sel_hi:[1,1,0]
  v_pk_fma_f16 v186, v186, v58, s21 op_sel_hi:[1,1,0]
  v_pk_fma_f16 v187, v187, v59, s21 op_sel_hi:[1,1,0]
  v_pk_fma_f16 v184, v184, v48, 0.5 op_sel_hi:[1,1,0] clamp
  v_mfma_f32_32x32x16_bf16 v[16:31], a[100:103], v[220:223], v[16:31]
  s_mov_b32 m0, s30
  s_nop 0
  v_pk_fma_f16 v185, v185, v49, 0.5 op_sel_hi:[1,1,0] clamp
  v_pk_fma_f16 v186, v186, v50, 0.5 op_sel_hi:[1,1,0] clamp
  v_pk_fma_f16 v187, v187, v51, 0.5 op_sel_hi:[1,1,0] clamp
  v_pk_mul_f16 v184, v184, v48
  v_pk_mul_f16 v185, v185, v49
  v_pk_mul_f16 v186, v186, v50
  v_mfma_f32_16x16x32_bf16 v[136:139], v[160:163], v[164:167], 0
  ds_read_b128 v[160:163], v3 offset:2800
  ds_read_b128 v[164:167], v4 offset:112
  v_mfma_f32_32x32x16_bf16 v[16:31], a[104:107], v[224:227], v[16:31]
  ds_read_b128 v[196:199], v0 offset:25600
  ds_read_b128 v[200:203], v0 offset:26624
  ds_read_b128 v[204:207], v0 offset:27648
  v_pk_mul_f16 v187, v187, v51
  v_pk_fma_f16 v56, v52, v52, s20 op_sel_hi:[1,1,0] neg_lo:[1,0,0] neg_hi:[1,0,0] clamp
  v_pk_fma_f16 v57, v53, v53, s20 op_sel_hi:[1,1,0] neg_lo:[1,0,0] neg_hi:[1,0,0] clamp
  v_smfmac_f32_16x16x64_bf16 v[136:139], v[176:179], v[168:175], v250
  ds_read_b128 v[168:171], v4 offset:304
  ds_read_b128 v[172:175], v4 offset:496
  v_mfma_f32_32x32x16_bf16 v[16:31], a[108:111], v[228:231], v[16:31]
  ds_read2_b64 v[176:179], v11 offset0:224 offset1:232
  ds_read_b128 v[208:211], v0 offset:28672
  v_pk_fma_f16 v58, v54, v54, s20 op_sel_hi:[1,1,0] neg_lo:[1,0,0] neg_hi:[1,0,0] clamp
  v_pk_fma_f16 v59, v55, v55, s20 op_sel_hi:[1,1,0] neg_lo:[1,0,0] neg_hi:[1,0,0] clamp
  v_pk_fma_f16 v188, v56, v56, s20 op_sel:[0,0,1]
  v_pk_fma_f16 v189, v57, v57, s20 op_sel:[0,0,1]
  v_mfma_f32_32x32x16_bf16 v[16:31], a[112:115], v[232:235], v[16:31]
  v_pk_fma_f16 v190, v58, v58, s20 op_sel:[0,0,1]
  v_pk_fma_f16 v191, v59, v59, s20 op_sel:[0,0,1]
  v_pk_fma_f16 v188, v188, v56, s21 op_sel_hi:[1,1,0]
  v_pk_fma_f16 v189, v189, v57, s21 op_sel_hi:[1,1,0]
  v_pk_fma_f16 v190, v190, v58, s21 op_sel_hi:[1,1,0]
  v_pk_fma_f16 v191, v191, v59, s21 op_sel_hi:[1,1,0]
  v_mfma_f32_32x32x16_bf16 v[16:31], a[116:119], v[236:239], v[16:31]
  s_waitcnt lgkmcnt(9)
  v_pk_fma_f16 v188, v188, v52, 0.5 op_sel_hi:[1,1,0] clamp
  v_pk_fma_f16 v189, v189, v53, 0.5 op_sel_hi:[1,1,0] clamp
  v_pk_fma_f16 v190, v190, v54, 0.5 op_sel_hi:[1,1,0] clamp
  v_pk_fma_f16 v191, v191, v55, 0.5 op_sel_hi:[1,1,0] clamp
  v_pk_mul_f16 v188, v188, v52
  v_pk_mul_f16 v189, v189, v53
  v_mfma_f32_32x32x16_f16 v[64:79], v[192:195], v[184:187], v[64:79]
  s_waitcnt lgkmcnt(7)
  ds_read_b128 v[212:215], v0 offset:29696
  ds_read_b128 v[192:195], v0 offset:30720
  v_pk_mul_f16 v190, v190, v54
  v_pk_mul_f16 v191, v191, v55
  v_add_f32_e64 v12, v136, v138
  v_cvt_pk_f16_f32 v48, v16, v17
  v_mfma_f32_16x16x32_bf16 v[140:143], v[160:163], v[164:167], 0
  s_waitcnt lgkmcnt(6)
  ds_read_b128 v[160:163], v3 offset:3200
  ds_read_b128 v[164:167], v4 offset:128
  v_mfma_f32_32x32x16_f16 v[80:95], v[196:199], v[184:187], v[80:95]
  s_waitcnt lgkmcnt(5)
  v_cvt_pk_f16_f32 v49, v18, v19
  v_cvt_pk_f16_f32 v50, v20, v21
  v_cvt_pk_f16_f32 v51, v22, v23
  v_cvt_pk_f16_f32 v52, v24, v25
  v_cvt_pk_f16_f32 v53, v26, v27
  v_cvt_pk_f16_f32 v54, v28, v29
  v_smfmac_f32_16x16x64_bf16 v[140:143], v[176:179], v[168:175], v250
  ds_read_b128 v[168:171], v4 offset:320
  ds_read_b128 v[172:175], v4 offset:512
  v_mfma_f32_32x32x16_f16 v[96:111], v[200:203], v[184:187], v[96:111]
  ds_read_b128 v[196:199], v0 offset:31744
  v_cvt_pk_f16_f32 v55, v30, v31
  v_pk_fma_f16 v56, v48, v48, s20 op_sel_hi:[1,1,0] neg_lo:[1,0,0] neg_hi:[1,0,0] clamp
  v_pk_fma_f16 v57, v49, v49, s20 op_sel_hi:[1,1,0] neg_lo:[1,0,0] neg_hi:[1,0,0] clamp
  v_pk_fma_f16 v58, v50, v50, s20 op_sel_hi:[1,1,0] neg_lo:[1,0,0] neg_hi:[1,0,0] clamp
  v_pk_fma_f16 v59, v51, v51, s20 op_sel_hi:[1,1,0] neg_lo:[1,0,0] neg_hi:[1,0,0] clamp
  v_mfma_f32_32x32x16_f16 v[64:79], v[204:207], v[188:191], v[64:79]
  s_waitcnt lgkmcnt(7)
  v_pk_fma_f16 v184, v56, v56, s20 op_sel:[0,0,1]
  v_pk_fma_f16 v185, v57, v57, s20 op_sel:[0,0,1]
  v_pk_fma_f16 v186, v58, v58, s20 op_sel:[0,0,1]
  v_pk_fma_f16 v187, v59, v59, s20 op_sel:[0,0,1]
  v_pk_fma_f16 v184, v184, v56, s21 op_sel_hi:[1,1,0]
  v_pk_fma_f16 v185, v185, v57, s21 op_sel_hi:[1,1,0]
  v_mfma_f32_32x32x16_f16 v[80:95], v[208:211], v[188:191], v[80:95]
  s_waitcnt lgkmcnt(5)
  v_pk_fma_f16 v186, v186, v58, s21 op_sel_hi:[1,1,0]
  v_pk_fma_f16 v187, v187, v59, s21 op_sel_hi:[1,1,0]
  v_pk_fma_f16 v184, v184, v48, 0.5 op_sel_hi:[1,1,0] clamp
  v_pk_fma_f16 v185, v185, v49, 0.5 op_sel_hi:[1,1,0] clamp
  v_pk_fma_f16 v186, v186, v50, 0.5 op_sel_hi:[1,1,0] clamp
  v_pk_fma_f16 v187, v187, v51, 0.5 op_sel_hi:[1,1,0] clamp
  v_mfma_f32_32x32x16_f16 v[96:111], v[212:215], v[188:191], v[96:111]
  s_nop 0
  s_waitcnt lgkmcnt(3)
  ds_read_b128 v[200:203], v0 offset:32768
  ds_read_b128 v[204:207], v0 offset:33792
  v_pk_mul_f16 v184, v184, v48
  v_pk_mul_f16 v185, v185, v49
  v_pk_mul_f16 v186, v186, v50
  v_pk_mul_f16 v187, v187, v51
  v_mfma_f32_16x16x32_bf16 v[144:147], v[160:163], v[164:167], 0
  s_nop 0
  ds_read_b128 v[160:163], v3 offset:3600
  ds_read_b128 v[164:167], v4 offset:144
  v_mfma_f32_32x32x16_bf16 v[16:31], a[120:123], v[216:219], 0
  s_waitcnt lgkmcnt(5)
  v_pk_fma_f16 v56, v52, v52, s20 op_sel_hi:[1,1,0] neg_lo:[1,0,0] neg_hi:[1,0,0] clamp
  v_pk_fma_f16 v57, v53, v53, s20 op_sel_hi:[1,1,0] neg_lo:[1,0,0] neg_hi:[1,0,0] clamp
  v_pk_fma_f16 v58, v54, v54, s20 op_sel_hi:[1,1,0] neg_lo:[1,0,0] neg_hi:[1,0,0] clamp
  v_pk_fma_f16 v59, v55, v55, s20 op_sel_hi:[1,1,0] neg_lo:[1,0,0] neg_hi:[1,0,0] clamp
  v_pk_fma_f16 v188, v56, v56, s20 op_sel:[0,0,1]
  v_pk_fma_f16 v189, v57, v57, s20 op_sel:[0,0,1]
  v_smfmac_f32_16x16x64_bf16 v[144:147], a[240:243], v[168:175], v250
  ds_read_b128 v[168:171], v4 offset:336
  ds_read_b128 v[172:175], v4 offset:528
  v_mfma_f32_32x32x16_bf16 v[16:31], a[124:127], v[220:223], v[16:31]
  v_pk_fma_f16 v190, v58, v58, s20 op_sel:[0,0,1]
  v_pk_fma_f16 v191, v59, v59, s20 op_sel:[0,0,1]
  v_pk_fma_f16 v188, v188, v56, s21 op_sel_hi:[1,1,0]
  v_pk_fma_f16 v189, v189, v57, s21 op_sel_hi:[1,1,0]
  v_pk_fma_f16 v190, v190, v58, s21 op_sel_hi:[1,1,0]
  v_pk_fma_f16 v191, v191, v59, s21 op_sel_hi:[1,1,0]
  v_mfma_f32_32x32x16_bf16 v[16:31], a[128:131], v[224:227], v[16:31]
  v_pk_fma_f16 v188, v188, v52, 0.5 op_sel_hi:[1,1,0] clamp
  v_pk_fma_f16 v189, v189, v53, 0.5 op_sel_hi:[1,1,0] clamp
  v_pk_fma_f16 v190, v190, v54, 0.5 op_sel_hi:[1,1,0] clamp
  v_pk_fma_f16 v191, v191, v55, 0.5 op_sel_hi:[1,1,0] clamp
  v_pk_mul_f16 v188, v188, v52
  v_pk_mul_f16 v189, v189, v53
  v_mfma_f32_32x32x16_bf16 v[16:31], a[132:135], v[228:231], v[16:31]
  ds_read_b128 v[208:211], v0 offset:34816
  ds_read_b128 v[212:215], v0 offset:35840
  v_pk_mul_f16 v190, v190, v54
  v_pk_mul_f16 v191, v191, v55
  v_add_f32 v13, v137, v139
  v_mul_f32 v14, v136, v136
  v_mfma_f32_32x32x16_bf16 v[16:31], a[136:139], v[232:235], v[16:31]
  s_waitcnt lgkmcnt(4)
  v_mul_f32 v15, v137, v137
  v_fmac_f32 v14, v138, v138
  v_fmac_f32 v15, v139, v139
  v_add_f32 v12, v12, v140
  v_add_f32 v13, v13, v141
  v_fmac_f32_e64 v14, v140, v140
  v_mfma_f32_16x16x32_bf16 v[148:151], v[160:163], v[164:167], 0
  ds_read_b128 v[160:163], v3 offset:4000
  ds_read_b128 v[164:167], v4 offset:160
  v_mfma_f32_32x32x16_bf16 v[16:31], a[140:143], v[236:239], v[16:31]
  s_waitcnt lgkmcnt(4)
  v_fmac_f32 v15, v141, v141
  v_add_f32_e64 v12, v12, v142
  v_add_f32_e64 v13, v13, v143
  v_fmac_f32_e64 v14, v142, v142
  v_fmac_f32_e64 v15, v143, v143
  v_add_f32_e64 v12, v12, v144
  v_smfmac_f32_16x16x64_bf16 v[148:151], a[244:247], v[168:175], v250
  ds_read_b128 v[168:171], v4 offset:352
  ds_read_b128 v[172:175], v4 offset:544
  v_mfma_f32_32x32x16_f16 v[64:79], v[192:195], v[184:187], v[64:79]
  ds_read_b128 v[192:195], v0 offset:36864
  v_add_f32_e64 v13, v13, v145
  v_cvt_pk_f16_f32 v48, v16, v17
  v_cvt_pk_f16_f32 v49, v18, v19
  v_cvt_pk_f16_f32 v50, v20, v21
  v_cvt_pk_f16_f32 v51, v22, v23
  v_mfma_f32_32x32x16_f16 v[80:95], v[196:199], v[184:187], v[80:95]
  ds_read_b128 v[196:199], v0 offset:37888
  v_cvt_pk_f16_f32 v52, v24, v25
  v_cvt_pk_f16_f32 v53, v26, v27
  v_cvt_pk_f16_f32 v54, v28, v29
  v_cvt_pk_f16_f32 v55, v30, v31
  v_pk_fma_f16 v56, v48, v48, s20 op_sel_hi:[1,1,0] neg_lo:[1,0,0] neg_hi:[1,0,0] clamp
  v_mfma_f32_32x32x16_f16 v[96:111], v[200:203], v[184:187], v[96:111]
  v_pk_fma_f16 v57, v49, v49, s20 op_sel_hi:[1,1,0] neg_lo:[1,0,0] neg_hi:[1,0,0] clamp
  v_pk_fma_f16 v58, v50, v50, s20 op_sel_hi:[1,1,0] neg_lo:[1,0,0] neg_hi:[1,0,0] clamp
  v_pk_fma_f16 v59, v51, v51, s20 op_sel_hi:[1,1,0] neg_lo:[1,0,0] neg_hi:[1,0,0] clamp
  v_pk_fma_f16 v184, v56, v56, s20 op_sel:[0,0,1]
  v_pk_fma_f16 v185, v57, v57, s20 op_sel:[0,0,1]
  v_pk_fma_f16 v186, v58, v58, s20 op_sel:[0,0,1]
  v_mfma_f32_32x32x16_f16 v[64:79], v[204:207], v[188:191], v[64:79]
  s_waitcnt lgkmcnt(4)
  s_nop 0
  v_pk_fma_f16 v187, v59, v59, s20 op_sel:[0,0,1]
  v_pk_fma_f16 v184, v184, v56, s21 op_sel_hi:[1,1,0]
  v_pk_fma_f16 v185, v185, v57, s21 op_sel_hi:[1,1,0]
  v_pk_fma_f16 v186, v186, v58, s21 op_sel_hi:[1,1,0]
  v_pk_fma_f16 v187, v187, v59, s21 op_sel_hi:[1,1,0]
  v_pk_fma_f16 v184, v184, v48, 0.5 op_sel_hi:[1,1,0] clamp
  v_mfma_f32_16x16x32_bf16 v[152:155], v[160:163], v[164:167], 0
  s_nop 0
  ds_read_b128 v[160:163], v3 offset:4400
  ds_read_b128 v[164:167], v4 offset:176
  v_mfma_f32_32x32x16_f16 v[80:95], v[208:211], v[188:191], v[80:95]
  s_waitcnt lgkmcnt(4)
  v_pk_fma_f16 v185, v185, v49, 0.5 op_sel_hi:[1,1,0] clamp
  v_pk_fma_f16 v186, v186, v50, 0.5 op_sel_hi:[1,1,0] clamp
  v_pk_fma_f16 v187, v187, v51, 0.5 op_sel_hi:[1,1,0] clamp
  v_pk_mul_f16 v184, v184, v48
  v_pk_mul_f16 v185, v185, v49
  v_pk_mul_f16 v186, v186, v50
  v_smfmac_f32_16x16x64_bf16 v[152:155], a[248:251], v[168:175], v250
  ds_read_b128 v[168:171], v4 offset:368
  ds_read_b128 v[172:175], v4 offset:560
  v_mfma_f32_32x32x16_f16 v[96:111], v[212:215], v[188:191], v[96:111]
  ds_read_b128 v[200:203], v0 offset:38912
  ds_read_b128 v[204:207], v0 offset:39936
  ds_read_b128 v[208:211], v0 offset:40960
  v_pk_mul_f16 v187, v187, v51
  v_pk_fma_f16 v56, v52, v52, s20 op_sel_hi:[1,1,0] neg_lo:[1,0,0] neg_hi:[1,0,0] clamp
  v_pk_fma_f16 v57, v53, v53, s20 op_sel_hi:[1,1,0] neg_lo:[1,0,0] neg_hi:[1,0,0] clamp
  v_mfma_f32_32x32x16_bf16 v[16:31], a[144:147], v[216:219], 0
  v_pk_fma_f16 v58, v54, v54, s20 op_sel_hi:[1,1,0] neg_lo:[1,0,0] neg_hi:[1,0,0] clamp
  v_pk_fma_f16 v59, v55, v55, s20 op_sel_hi:[1,1,0] neg_lo:[1,0,0] neg_hi:[1,0,0] clamp
  v_pk_fma_f16 v188, v56, v56, s20 op_sel:[0,0,1]
  v_pk_fma_f16 v189, v57, v57, s20 op_sel:[0,0,1]
  v_pk_fma_f16 v190, v58, v58, s20 op_sel:[0,0,1]
  v_pk_fma_f16 v191, v59, v59, s20 op_sel:[0,0,1]
  v_mfma_f32_32x32x16_bf16 v[16:31], a[148:151], v[220:223], v[16:31]
  s_nop 0
  v_pk_fma_f16 v188, v188, v56, s21 op_sel_hi:[1,1,0]
  v_pk_fma_f16 v189, v189, v57, s21 op_sel_hi:[1,1,0]
  v_pk_fma_f16 v190, v190, v58, s21 op_sel_hi:[1,1,0]
  v_pk_fma_f16 v191, v191, v59, s21 op_sel_hi:[1,1,0]
  v_pk_fma_f16 v188, v188, v52, 0.5 op_sel_hi:[1,1,0] clamp
  v_pk_fma_f16 v189, v189, v53, 0.5 op_sel_hi:[1,1,0] clamp
  v_mfma_f32_32x32x16_bf16 v[16:31], a[152:155], v[224:227], v[16:31]
  s_waitcnt lgkmcnt(5)
  v_pk_fma_f16 v190, v190, v54, 0.5 op_sel_hi:[1,1,0] clamp
  v_pk_fma_f16 v191, v191, v55, 0.5 op_sel_hi:[1,1,0] clamp
  v_pk_mul_f16 v188, v188, v52
  v_pk_mul_f16 v189, v189, v53
  v_pk_mul_f16 v190, v190, v54
  v_pk_mul_f16 v191, v191, v55
  v_mfma_f32_16x16x32_bf16 v[156:159], v[160:163], v[164:167], 0
  ds_read_b128 v[160:163], v3
  ds_read_b128 v[164:167], v4
  v_mfma_f32_32x32x16_bf16 v[16:31], a[156:159], v[228:231], v[16:31]
  s_waitcnt lgkmcnt(5)
  ds_read_b128 v[212:215], v0 offset:41984
  v_fmac_f32 v14, v144, v144
  v_fmac_f32 v15, v145, v145
  v_add_f32 v12, v12, v146
  v_add_f32 v13, v13, v147
  v_fmac_f32 v14, v146, v146
  v_smfmac_f32_16x16x64_bf16 v[156:159], a[252:255], v[168:175], v250
  ds_read_b128 v[168:171], v4 offset:192
  ds_read_b128 v[172:175], v4 offset:384
  v_mfma_f32_32x32x16_bf16 v[16:31], a[160:163], v[232:235], v[16:31]
  ds_read2_b64 v[176:179], v11 offset0:0 offset1:8
  v_fmac_f32 v15, v147, v147
  v_add_f32 v12, v12, v148
  v_add_f32 v13, v13, v149
  v_fmac_f32 v14, v148, v148
  v_fmac_f32_e64 v15, v149, v149
  v_mfma_f32_32x32x16_bf16 v[16:31], a[164:167], v[236:239], v[16:31]
  v_add_f32 v12, v12, v150
  v_add_f32 v13, v13, v151
  v_fmac_f32 v14, v150, v150
  v_fmac_f32 v15, v151, v151
  v_add_f32_e64 v12, v12, v152
  v_add_f32_e64 v13, v13, v153
  v_mfma_f32_32x32x16_f16 v[64:79], v[192:195], v[184:187], v[64:79]
  ds_read_b128 v[192:195], v0 offset:43008
  v_fmac_f32_e64 v14, v152, v152
  v_fmac_f32_e64 v15, v153, v153
  v_add_f32_e64 v12, v12, v154
  v_add_f32 v13, v13, v155
  v_cvt_pk_f16_f32 v48, v16, v17
  v_mfma_f32_32x32x16_f16 v[80:95], v[196:199], v[184:187], v[80:95]
  s_waitcnt lgkmcnt(5)
  v_cvt_pk_f16_f32 v49, v18, v19
  v_cvt_pk_f16_f32 v50, v20, v21
  v_cvt_pk_f16_f32 v51, v22, v23
  v_cvt_pk_f16_f32 v52, v24, v25
  v_cvt_pk_f16_f32 v53, v26, v27
  v_cvt_pk_f16_f32 v54, v28, v29
  v_mfma_f32_16x16x32_bf16 v[112:115], v[160:163], v[164:167], 0
  s_nop 0
  ds_read_b128 v[160:163], v3 offset:400
  ds_read_b128 v[164:167], v4 offset:16
  v_mfma_f32_32x32x16_f16 v[96:111], v[200:203], v[184:187], v[96:111]
  s_waitcnt lgkmcnt(3)
  ds_read_b128 v[196:199], v0 offset:44032
  v_cvt_pk_f16_f32 v55, v30, v31
  v_pk_fma_f16 v56, v48, v48, s20 op_sel_hi:[1,1,0] neg_lo:[1,0,0] neg_hi:[1,0,0] clamp
  v_pk_fma_f16 v57, v49, v49, s20 op_sel_hi:[1,1,0] neg_lo:[1,0,0] neg_hi:[1,0,0] clamp
  v_pk_fma_f16 v58, v50, v50, s20 op_sel_hi:[1,1,0] neg_lo:[1,0,0] neg_hi:[1,0,0] clamp
  v_pk_fma_f16 v59, v51, v51, s20 op_sel_hi:[1,1,0] neg_lo:[1,0,0] neg_hi:[1,0,0] clamp
  v_smfmac_f32_16x16x64_bf16 v[112:115], v[176:179], v[168:175], v250
  ds_read_b128 v[168:171], v4 offset:208
  ds_read_b128 v[172:175], v4 offset:400
  v_mfma_f32_32x32x16_f16 v[64:79], v[204:207], v[188:191], v[64:79]
  ds_read2_b64 v[176:179], v11 offset0:32 offset1:40
  v_pk_fma_f16 v184, v56, v56, s20 op_sel:[0,0,1]
  v_pk_fma_f16 v185, v57, v57, s20 op_sel:[0,0,1]
  v_pk_fma_f16 v186, v58, v58, s20 op_sel:[0,0,1]
  v_pk_fma_f16 v187, v59, v59, s20 op_sel:[0,0,1]
  v_pk_fma_f16 v184, v184, v56, s21 op_sel_hi:[1,1,0]
  v_mfma_f32_32x32x16_f16 v[80:95], v[208:211], v[188:191], v[80:95]
  v_pk_fma_f16 v185, v185, v57, s21 op_sel_hi:[1,1,0]
  v_pk_fma_f16 v186, v186, v58, s21 op_sel_hi:[1,1,0]
  v_pk_fma_f16 v187, v187, v59, s21 op_sel_hi:[1,1,0]
  v_pk_fma_f16 v184, v184, v48, 0.5 op_sel_hi:[1,1,0] clamp
  v_pk_fma_f16 v185, v185, v49, 0.5 op_sel_hi:[1,1,0] clamp
  v_pk_fma_f16 v186, v186, v50, 0.5 op_sel_hi:[1,1,0] clamp
  v_mfma_f32_32x32x16_f16 v[96:111], v[212:215], v[188:191], v[96:111]
  ds_read_b128 v[200:203], v0 offset:45056
  v_pk_fma_f16 v187, v187, v51, 0.5 op_sel_hi:[1,1,0] clamp
  v_pk_mul_f16 v184, v184, v48
  v_pk_mul_f16 v185, v185, v49
  v_pk_mul_f16 v186, v186, v50
  v_pk_mul_f16 v187, v187, v51
  v_mfma_f32_32x32x16_bf16 v[16:31], a[168:171], v[216:219], 0
  s_waitcnt lgkmcnt(5)
  ds_read_b128 v[204:207], v0 offset:46080
  ds_read_b128 v[208:211], v0 offset:47104
  v_pk_fma_f16 v56, v52, v52, s20 op_sel_hi:[1,1,0] neg_lo:[1,0,0] neg_hi:[1,0,0] clamp
  v_pk_fma_f16 v57, v53, v53, s20 op_sel_hi:[1,1,0] neg_lo:[1,0,0] neg_hi:[1,0,0] clamp
  v_pk_fma_f16 v58, v54, v54, s20 op_sel_hi:[1,1,0] neg_lo:[1,0,0] neg_hi:[1,0,0] clamp
  v_pk_fma_f16 v59, v55, v55, s20 op_sel_hi:[1,1,0] neg_lo:[1,0,0] neg_hi:[1,0,0] clamp
  v_mfma_f32_16x16x32_bf16 v[116:119], v[160:163], v[164:167], 0
  ds_read_b128 v[160:163], v3 offset:800
  ds_read_b128 v[164:167], v4 offset:32
  v_mfma_f32_32x32x16_bf16 v[16:31], a[172:175], v[220:223], v[16:31]
  s_waitcnt lgkmcnt(5)
  v_pk_fma_f16 v188, v56, v56, s20 op_sel:[0,0,1]
  v_pk_fma_f16 v189, v57, v57, s20 op_sel:[0,0,1]
  v_pk_fma_f16 v190, v58, v58, s20 op_sel:[0,0,1]
  v_pk_fma_f16 v191, v59, v59, s20 op_sel:[0,0,1]
  v_pk_fma_f16 v188, v188, v56, s21 op_sel_hi:[1,1,0]
  v_pk_fma_f16 v189, v189, v57, s21 op_sel_hi:[1,1,0]
  v_smfmac_f32_16x16x64_bf16 v[116:119], v[176:179], v[168:175], v250
  ds_read_b128 v[168:171], v4 offset:224
  ds_read_b128 v[172:175], v4 offset:416
  v_mfma_f32_32x32x16_bf16 v[16:31], a[176:179], v[224:227], v[16:31]
  ds_read2_b64 v[176:179], v11 offset0:64 offset1:72
  v_pk_fma_f16 v190, v190, v58, s21 op_sel_hi:[1,1,0]
  v_pk_fma_f16 v191, v191, v59, s21 op_sel_hi:[1,1,0]
  v_pk_fma_f16 v188, v188, v52, 0.5 op_sel_hi:[1,1,0] clamp
  v_pk_fma_f16 v189, v189, v53, 0.5 op_sel_hi:[1,1,0] clamp
  v_pk_fma_f16 v190, v190, v54, 0.5 op_sel_hi:[1,1,0] clamp
  v_mfma_f32_32x32x16_bf16 v[16:31], a[180:183], v[228:231], v[16:31]
  ds_read_b128 v[212:215], v0 offset:48128
  v_pk_fma_f16 v191, v191, v55, 0.5 op_sel_hi:[1,1,0] clamp
  v_pk_mul_f16 v188, v188, v52
  v_pk_mul_f16 v189, v189, v53
  v_pk_mul_f16 v190, v190, v54
  v_pk_mul_f16 v191, v191, v55
  v_mfma_f32_32x32x16_bf16 v[16:31], a[184:187], v[232:235], v[16:31]
  v_fmac_f32 v14, v154, v154
  v_fmac_f32 v15, v155, v155
  v_add_f32 v12, v12, v156
  v_add_f32 v13, v13, v157
  v_fmac_f32 v14, v156, v156
  v_fmac_f32 v15, v157, v157
  v_mfma_f32_32x32x16_bf16 v[16:31], a[188:191], v[236:239], v[16:31]
  s_waitcnt lgkmcnt(4)
  v_add_f32 v12, v12, v158
  v_add_f32 v13, v13, v159
  v_fmac_f32 v14, v158, v158
  v_fmac_f32_e64 v15, v159, v159
  v_add_f32_e64 v12, v12, v112
  v_add_f32_e64 v13, v13, v113
  v_mfma_f32_16x16x32_bf16 v[120:123], v[160:163], v[164:167], 0
  ds_read_b128 v[160:163], v3 offset:1200
  ds_read_b128 v[164:167], v4 offset:48
  v_mfma_f32_32x32x16_f16 v[64:79], v[192:195], v[184:187], v[64:79]
  s_waitcnt lgkmcnt(3)
  ds_read_b128 v[192:195], v0 offset:49152
  v_fmac_f32 v14, v112, v112
  v_cvt_pk_f16_f32 v48, v16, v17
  v_cvt_pk_f16_f32 v49, v18, v19
  v_cvt_pk_f16_f32 v50, v20, v21
  v_cvt_pk_f16_f32 v51, v22, v23
  v_smfmac_f32_16x16x64_bf16 v[120:123], v[176:179], v[168:175], v250
  ds_read_b128 v[168:171], v4 offset:240
  ds_read_b128 v[172:175], v4 offset:432
  v_mfma_f32_32x32x16_f16 v[80:95], v[196:199], v[184:187], v[80:95]
  ds_read2_b64 v[176:179], v11 offset0:96 offset1:104
  ds_read_b128 v[196:199], v0 offset:50176
  v_cvt_pk_f16_f32 v52, v24, v25
  v_cvt_pk_f16_f32 v53, v26, v27
  v_cvt_pk_f16_f32 v54, v28, v29
  v_cvt_pk_f16_f32 v55, v30, v31
  v_mfma_f32_32x32x16_f16 v[96:111], v[200:203], v[184:187], v[96:111]
  v_pk_fma_f16 v56, v48, v48, s20 op_sel_hi:[1,1,0] neg_lo:[1,0,0] neg_hi:[1,0,0] clamp
  v_pk_fma_f16 v57, v49, v49, s20 op_sel_hi:[1,1,0] neg_lo:[1,0,0] neg_hi:[1,0,0] clamp
  v_pk_fma_f16 v58, v50, v50, s20 op_sel_hi:[1,1,0] neg_lo:[1,0,0] neg_hi:[1,0,0] clamp
  v_pk_fma_f16 v59, v51, v51, s20 op_sel_hi:[1,1,0] neg_lo:[1,0,0] neg_hi:[1,0,0] clamp
  v_pk_fma_f16 v184, v56, v56, s20 op_sel:[0,0,1]
  v_pk_fma_f16 v185, v57, v57, s20 op_sel:[0,0,1]
  v_mfma_f32_32x32x16_f16 v[64:79], v[204:207], v[188:191], v[64:79]
  v_pk_fma_f16 v186, v58, v58, s20 op_sel:[0,0,1]
  v_pk_fma_f16 v187, v59, v59, s20 op_sel:[0,0,1]
  v_pk_fma_f16 v184, v184, v56, s21 op_sel_hi:[1,1,0]
  v_pk_fma_f16 v185, v185, v57, s21 op_sel_hi:[1,1,0]
  v_pk_fma_f16 v186, v186, v58, s21 op_sel_hi:[1,1,0]
  v_pk_fma_f16 v187, v187, v59, s21 op_sel_hi:[1,1,0]
  v_mfma_f32_32x32x16_f16 v[80:95], v[208:211], v[188:191], v[80:95]
  s_waitcnt lgkmcnt(5)
  s_nop 0
  v_pk_fma_f16 v184, v184, v48, 0.5 op_sel_hi:[1,1,0] clamp
  v_pk_fma_f16 v185, v185, v49, 0.5 op_sel_hi:[1,1,0] clamp
  v_pk_fma_f16 v186, v186, v50, 0.5 op_sel_hi:[1,1,0] clamp
  v_pk_fma_f16 v187, v187, v51, 0.5 op_sel_hi:[1,1,0] clamp
  v_pk_mul_f16 v184, v184, v48
  v_pk_mul_f16 v185, v185, v49
  v_mfma_f32_16x16x32_bf16 v[124:127], v[160:163], v[164:167], 0
  s_nop 0
  ds_read_b128 v[160:163], v3 offset:1600
  ds_read_b128 v[164:167], v4 offset:64
  v_mfma_f32_32x32x16_f16 v[96:111], v[212:215], v[188:191], v[96:111]
  s_waitcnt lgkmcnt(3)
  ds_read_b128 v[200:203], v0 offset:51200
  ds_read_b128 v[204:207], v0 offset:52224
  ds_read_b128 v[208:211], v0 offset:53248
  v_pk_mul_f16 v186, v186, v50
  v_pk_mul_f16 v187, v187, v51
  v_pk_fma_f16 v56, v52, v52, s20 op_sel_hi:[1,1,0] neg_lo:[1,0,0] neg_hi:[1,0,0] clamp
  v_smfmac_f32_16x16x64_bf16 v[124:127], v[176:179], v[168:175], v250
  ds_read_b128 v[168:171], v4 offset:256
  ds_read_b128 v[172:175], v4 offset:448
  v_mfma_f32_32x32x16_bf16 v[16:31], a[192:195], v[216:219], 0
  ds_read2_b64 v[176:179], v11 offset0:128 offset1:136
  v_pk_fma_f16 v57, v53, v53, s20 op_sel_hi:[1,1,0] neg_lo:[1,0,0] neg_hi:[1,0,0] clamp
  v_pk_fma_f16 v58, v54, v54, s20 op_sel_hi:[1,1,0] neg_lo:[1,0,0] neg_hi:[1,0,0] clamp
  v_pk_fma_f16 v59, v55, v55, s20 op_sel_hi:[1,1,0] neg_lo:[1,0,0] neg_hi:[1,0,0] clamp
  v_pk_fma_f16 v188, v56, v56, s20 op_sel:[0,0,1]
  v_pk_fma_f16 v189, v57, v57, s20 op_sel:[0,0,1]
  v_mfma_f32_32x32x16_bf16 v[16:31], a[196:199], v[220:223], v[16:31]
  v_pk_fma_f16 v190, v58, v58, s20 op_sel:[0,0,1]
  v_pk_fma_f16 v191, v59, v59, s20 op_sel:[0,0,1]
  v_pk_fma_f16 v188, v188, v56, s21 op_sel_hi:[1,1,0]
  v_pk_fma_f16 v189, v189, v57, s21 op_sel_hi:[1,1,0]
  v_pk_fma_f16 v190, v190, v58, s21 op_sel_hi:[1,1,0]
  v_pk_fma_f16 v191, v191, v59, s21 op_sel_hi:[1,1,0]
  v_mfma_f32_32x32x16_bf16 v[16:31], a[200:203], v[224:227], v[16:31]
  v_pk_fma_f16 v188, v188, v52, 0.5 op_sel_hi:[1,1,0] clamp
  v_pk_fma_f16 v189, v189, v53, 0.5 op_sel_hi:[1,1,0] clamp
  v_pk_fma_f16 v190, v190, v54, 0.5 op_sel_hi:[1,1,0] clamp
  v_pk_fma_f16 v191, v191, v55, 0.5 op_sel_hi:[1,1,0] clamp
  v_pk_mul_f16 v188, v188, v52
  v_pk_mul_f16 v189, v189, v53
  v_mfma_f32_32x32x16_bf16 v[16:31], a[204:207], v[228:231], v[16:31]
  s_waitcnt lgkmcnt(6)
  ds_read_b128 v[212:215], v0 offset:54272
  v_pk_mul_f16 v190, v190, v54
  v_pk_mul_f16 v191, v191, v55
  v_fmac_f32 v15, v113, v113
  v_add_f32 v12, v12, v114
  v_add_f32 v13, v13, v115
  v_mfma_f32_16x16x32_bf16 v[128:131], v[160:163], v[164:167], 0
  ds_read_b128 v[160:163], v3 offset:2000
  ds_read_b128 v[164:167], v4 offset:80
  v_mfma_f32_32x32x16_bf16 v[16:31], a[208:211], v[232:235], v[16:31]
  s_waitcnt lgkmcnt(3)
  v_fmac_f32 v14, v114, v114
  v_fmac_f32 v15, v115, v115
  v_add_f32 v12, v12, v116
  v_add_f32 v13, v13, v117
  v_fmac_f32 v14, v116, v116
  v_fmac_f32_e64 v15, v117, v117
  v_smfmac_f32_16x16x64_bf16 v[128:131], v[176:179], v[168:175], v250
  ds_read_b128 v[168:171], v4 offset:272
  ds_read_b128 v[172:175], v4 offset:464
  v_mfma_f32_32x32x16_bf16 v[16:31], a[212:215], v[236:239], v[16:31]
  ds_read2_b64 v[176:179], v11 offset0:160 offset1:168
  v_add_f32 v12, v12, v118
  v_add_f32 v13, v13, v119
  v_fmac_f32_e64 v14, v118, v118
  v_fmac_f32_e64 v15, v119, v119
  v_add_f32_e64 v12, v12, v120
  v_mfma_f32_32x32x16_f16 v[64:79], v[192:195], v[184:187], v[64:79]
  ds_read_b128 v[192:195], v0 offset:55296
  v_add_f32_e64 v13, v13, v121
  v_fmac_f32_e64 v14, v120, v120
  v_fmac_f32_e64 v15, v121, v121
  v_add_f32_e64 v12, v12, v122
  v_cvt_pk_f16_f32 v48, v16, v17
  v_mfma_f32_32x32x16_f16 v[80:95], v[196:199], v[184:187], v[80:95]
  v_cvt_pk_f16_f32 v49, v18, v19
  v_cvt_pk_f16_f32 v50, v20, v21
  v_cvt_pk_f16_f32 v51, v22, v23
  v_cvt_pk_f16_f32 v52, v24, v25
  v_cvt_pk_f16_f32 v53, v26, v27
  v_cvt_pk_f16_f32 v54, v28, v29
  v_mfma_f32_32x32x16_f16 v[96:111], v[200:203], v[184:187], v[96:111]
  s_waitcnt lgkmcnt(4)
  s_nop 0
  ds_read_b128 v[196:199], v0 offset:56320
  v_cvt_pk_f16_f32 v55, v30, v31
  v_pk_fma_f16 v56, v48, v48, s20 op_sel_hi:[1,1,0] neg_lo:[1,0,0] neg_hi:[1,0,0] clamp
  v_pk_fma_f16 v57, v49, v49, s20 op_sel_hi:[1,1,0] neg_lo:[1,0,0] neg_hi:[1,0,0] clamp
  v_pk_fma_f16 v58, v50, v50, s20 op_sel_hi:[1,1,0] neg_lo:[1,0,0] neg_hi:[1,0,0] clamp
  v_pk_fma_f16 v59, v51, v51, s20 op_sel_hi:[1,1,0] neg_lo:[1,0,0] neg_hi:[1,0,0] clamp
  v_mfma_f32_16x16x32_bf16 v[132:135], v[160:163], v[164:167], 0
  s_nop 0
  v_pk_fma_f16 v184, v56, v56, s20 op_sel:[0,0,1]
  v_pk_fma_f16 v185, v57, v57, s20 op_sel:[0,0,1]
  v_mfma_f32_32x32x16_f16 v[64:79], v[204:207], v[188:191], v[64:79]
  s_waitcnt lgkmcnt(2)
  v_pk_fma_f16 v186, v58, v58, s20 op_sel:[0,0,1]
  v_pk_fma_f16 v187, v59, v59, s20 op_sel:[0,0,1]
  v_pk_fma_f16 v184, v184, v56, s21 op_sel_hi:[1,1,0]
  v_pk_fma_f16 v185, v185, v57, s21 op_sel_hi:[1,1,0]
  v_pk_fma_f16 v186, v186, v58, s21 op_sel_hi:[1,1,0]
  v_pk_fma_f16 v187, v187, v59, s21 op_sel_hi:[1,1,0]
  v_smfmac_f32_16x16x64_bf16 v[132:135], v[176:179], v[168:175], v250
  ds_read_b128 v[200:203], v0 offset:57344
  v_pk_fma_f16 v184, v184, v48, 0.5 op_sel_hi:[1,1,0] clamp
  v_mfma_f32_32x32x16_f16 v[80:95], v[208:211], v[188:191], v[80:95]
  v_pk_fma_f16 v185, v185, v49, 0.5 op_sel_hi:[1,1,0] clamp
  v_pk_fma_f16 v186, v186, v50, 0.5 op_sel_hi:[1,1,0] clamp
  v_pk_fma_f16 v187, v187, v51, 0.5 op_sel_hi:[1,1,0] clamp
  v_pk_mul_f16 v184, v184, v48
  v_pk_mul_f16 v185, v185, v49
  v_pk_mul_f16 v186, v186, v50
  v_mfma_f32_32x32x16_f16 v[96:111], v[212:215], v[188:191], v[96:111]
  ds_read_b128 v[204:207], v0 offset:58368
  ds_read_b128 v[208:211], v0 offset:59392
  v_pk_mul_f16 v187, v187, v51
  v_pk_fma_f16 v56, v52, v52, s20 op_sel_hi:[1,1,0] neg_lo:[1,0,0] neg_hi:[1,0,0] clamp
  v_pk_fma_f16 v57, v53, v53, s20 op_sel_hi:[1,1,0] neg_lo:[1,0,0] neg_hi:[1,0,0] clamp
  v_pk_fma_f16 v58, v54, v54, s20 op_sel_hi:[1,1,0] neg_lo:[1,0,0] neg_hi:[1,0,0] clamp
  v_mfma_f32_32x32x16_bf16 v[16:31], a[216:219], v[216:219], 0
  v_add_f32 v13, v13, v123
  v_fmac_f32 v14, v122, v122
  v_fmac_f32 v15, v123, v123
  v_add_f32 v12, v12, v124
  v_add_f32 v13, v13, v125
  v_fmac_f32 v14, v124, v124
  v_fmac_f32 v15, v125, v125
  v_add_f32 v12, v12, v126
  v_add_f32_e64 v13, v13, v127
  v_pk_fma_f32 v[14:15], v[126:127], v[126:127], v[14:15]
  v_pk_add_f32 v[12:13], v[12:13], v[128:129]
  v_pk_fma_f32 v[14:15], v[128:129], v[128:129], v[14:15]
  v_pk_add_f32 v[12:13], v[12:13], v[130:131]
  v_pk_fma_f32 v[14:15], v[130:131], v[130:131], v[14:15]
  v_pk_add_f32 v[12:13], v[12:13], v[132:133]
  v_pk_fma_f32 v[14:15], v[132:133], v[132:133], v[14:15]
  v_pk_add_f32 v[12:13], v[12:13], v[134:135]
  v_pk_fma_f32 v[14:15], v[134:135], v[134:135], v[14:15]
  v_mfma_f32_32x32x16_bf16 v[16:31], a[220:223], v[220:223], v[16:31]
  v_pk_fma_f16 v59, v55, v55, s20 op_sel_hi:[1,1,0] neg_lo:[1,0,0] neg_hi:[1,0,0] clamp
  v_pk_fma_f16 v188, v56, v56, s20 op_sel:[0,0,1]
  v_pk_fma_f16 v189, v57, v57, s20 op_sel:[0,0,1]
  v_pk_fma_f16 v190, v58, v58, s20 op_sel:[0,0,1]
  v_pk_fma_f16 v191, v59, v59, s20 op_sel:[0,0,1]
  v_pk_fma_f16 v188, v188, v56, s21 op_sel_hi:[1,1,0]
  v_mfma_f32_32x32x16_bf16 v[16:31], a[224:227], v[224:227], v[16:31]
  v_pk_fma_f16 v189, v189, v57, s21 op_sel_hi:[1,1,0]
  v_pk_fma_f16 v190, v190, v58, s21 op_sel_hi:[1,1,0]
  v_pk_fma_f16 v191, v191, v59, s21 op_sel_hi:[1,1,0]
  v_pk_fma_f16 v188, v188, v52, 0.5 op_sel_hi:[1,1,0] clamp
  v_pk_fma_f16 v189, v189, v53, 0.5 op_sel_hi:[1,1,0] clamp
  v_pk_fma_f16 v190, v190, v54, 0.5 op_sel_hi:[1,1,0] clamp
  v_mfma_f32_32x32x16_bf16 v[16:31], a[228:231], v[228:231], v[16:31]
  ds_read_b128 v[212:215], v0 offset:60416
  v_pk_fma_f16 v191, v191, v55, 0.5 op_sel_hi:[1,1,0] clamp
  v_pk_mul_f16 v188, v188, v52
  v_pk_mul_f16 v189, v189, v53
  v_pk_mul_f16 v190, v190, v54
  v_pk_mul_f16 v191, v191, v55
  v_mfma_f32_32x32x16_bf16 v[16:31], a[232:235], v[232:235], v[16:31]
  ds_read_b128 v[160:163], v0 offset:18432
  ds_read_b128 v[164:167], v0 offset:19456
  ds_read_b128 v[168:171], v0 offset:20480
  v_add_f32_e64 v12, v12, v13
  v_add_f32 v14, v14, v15
  v_mfma_f32_32x32x16_bf16 v[16:31], a[236:239], v[236:239], v[16:31]
  s_waitcnt lgkmcnt(4)
  ds_read_b128 v[172:175], v0 offset:21504
  ds_read_b128 v[176:179], v0 offset:22528
  v_permlane32_swap_b32 v12, v14
  v_add_f32 v12, v12, v14
  v_mov_b32_e64 v14, v12
  v_mfma_f32_32x32x16_f16 v[64:79], v[192:195], v[184:187], v[64:79]
  ds_read_b128 v[192:195], v0 offset:61440
  v_permlane32_swap_b32 v12, v14
  v_mul_f32 v12, s24, v12
  v_mul_f32_e64 v13, s24, v14
  v_fma_f32 v13, -v12, v12, v13
  v_mfma_f32_32x32x16_f16 v[80:95], v[196:199], v[184:187], v[80:95]
  v_cvt_pk_f16_f32 v48, v16, v17
  v_cvt_pk_f16_f32 v49, v18, v19
  v_cvt_pk_f16_f32 v50, v20, v21
  v_cvt_pk_f16_f32 v51, v22, v23
  v_cvt_pk_f16_f32 v52, v24, v25
  v_cvt_pk_f16_f32 v53, v26, v27
  v_mfma_f32_32x32x16_f16 v[96:111], v[200:203], v[184:187], v[96:111]
  v_cvt_pk_f16_f32 v54, v28, v29
  v_cvt_pk_f16_f32 v55, v30, v31
  v_max_f32 v13, 0, v13
  v_add_f32 v13, s25, v13
  v_rsq_f32_e64 v13, v13
  v_mfma_f32_32x32x16_f16 v[64:79], v[204:207], v[188:191], v[64:79]
  ds_read_b128 v[196:199], v0 offset:62464
  v_mul_f32 v14, s22, v13
  v_mul_f32_e64 v12, -v12, v14
  v_pk_fma_f16 v56, v48, v48, s20 op_sel_hi:[1,1,0] neg_lo:[1,0,0] neg_hi:[1,0,0] clamp
  v_pk_fma_f16 v57, v49, v49, s20 op_sel_hi:[1,1,0] neg_lo:[1,0,0] neg_hi:[1,0,0] clamp
  v_pk_fma_f16 v58, v50, v50, s20 op_sel_hi:[1,1,0] neg_lo:[1,0,0] neg_hi:[1,0,0] clamp
  v_mfma_f32_32x32x16_f16 v[80:95], v[208:211], v[188:191], v[80:95]
  s_waitcnt lgkmcnt(2)
  v_pk_fma_f16 v59, v51, v51, s20 op_sel_hi:[1,1,0] neg_lo:[1,0,0] neg_hi:[1,0,0] clamp
  v_pk_fma_f16 v184, v56, v56, s20 op_sel:[0,0,1]
  v_pk_fma_f16 v185, v57, v57, s20 op_sel:[0,0,1]
  v_pk_fma_f16 v186, v58, v58, s20 op_sel:[0,0,1]
  v_pk_fma_f16 v187, v59, v59, s20 op_sel:[0,0,1]
  v_pk_fma_f16 v184, v184, v56, s21 op_sel_hi:[1,1,0]
  v_mfma_f32_32x32x16_f16 v[96:111], v[212:215], v[188:191], v[96:111]
  v_fma_f32 v112, v112, v14, v12
  v_fma_f32 v113, v113, v14, v12
  v_fma_f32 v114, v114, v14, v12
  v_fma_f32 v115, v115, v14, v12
  v_fma_f32 v116, v116, v14, v12
  v_fma_f32 v117, v117, v14, v12
  v_fma_f32 v118, v118, v14, v12
  v_fma_f32 v119, v119, v14, v12
  v_fma_f32 v120, v120, v14, v12
  v_fma_f32 v121, v121, v14, v12
  v_pk_fma_f32 v[122:123], v[122:123], v[14:15], v[12:13] op_sel_hi:[1,0,0]
  v_pk_fma_f32 v[124:125], v[124:125], v[14:15], v[12:13] op_sel_hi:[1,0,0]
  v_pk_fma_f32 v[126:127], v[126:127], v[14:15], v[12:13] op_sel_hi:[1,0,0]
  v_pk_fma_f32 v[128:129], v[128:129], v[14:15], v[12:13] op_sel_hi:[1,0,0]
  v_pk_fma_f32 v[130:131], v[130:131], v[14:15], v[12:13] op_sel_hi:[1,0,0]
  v_pk_fma_f32 v[132:133], v[132:133], v[14:15], v[12:13] op_sel_hi:[1,0,0]
  v_pk_fma_f32 v[134:135], v[134:135], v[14:15], v[12:13] op_sel_hi:[1,0,0]
  v_pk_fma_f32 v[136:137], v[136:137], v[14:15], v[12:13] op_sel_hi:[1,0,0]
  v_pk_fma_f32 v[138:139], v[138:139], v[14:15], v[12:13] op_sel_hi:[1,0,0]
  v_pk_fma_f32 v[140:141], v[140:141], v[14:15], v[12:13] op_sel_hi:[1,0,0]
  v_pk_fma_f32 v[142:143], v[142:143], v[14:15], v[12:13] op_sel_hi:[1,0,0]
  v_pk_fma_f32 v[144:145], v[144:145], v[14:15], v[12:13] op_sel_hi:[1,0,0]
  v_pk_fma_f32 v[146:147], v[146:147], v[14:15], v[12:13] op_sel_hi:[1,0,0]
  v_pk_fma_f32 v[148:149], v[148:149], v[14:15], v[12:13] op_sel_hi:[1,0,0]
  v_pk_fma_f32 v[150:151], v[150:151], v[14:15], v[12:13] op_sel_hi:[1,0,0]
  v_pk_fma_f32 v[152:153], v[152:153], v[14:15], v[12:13] op_sel_hi:[1,0,0]
  v_pk_fma_f32 v[154:155], v[154:155], v[14:15], v[12:13] op_sel_hi:[1,0,0]
  v_pk_fma_f32 v[156:157], v[156:157], v[14:15], v[12:13] op_sel_hi:[1,0,0]
  v_pk_fma_f32 v[158:159], v[158:159], v[14:15], v[12:13] op_sel_hi:[1,0,0]
  v_mfma_f32_32x32x16_bf16 v[16:31], v[32:35], v[216:219], 0
  v_pk_fma_f16 v185, v185, v57, s21 op_sel_hi:[1,1,0]
  v_pk_fma_f16 v186, v186, v58, s21 op_sel_hi:[1,1,0]
  v_pk_fma_f16 v187, v187, v59, s21 op_sel_hi:[1,1,0]
  v_pk_fma_f16 v184, v184, v48, 0.5 op_sel_hi:[1,1,0] clamp
  v_pk_fma_f16 v185, v185, v49, 0.5 op_sel_hi:[1,1,0] clamp
  v_pk_fma_f16 v186, v186, v50, 0.5 op_sel_hi:[1,1,0] clamp
  v_mfma_f32_32x32x16_bf16 v[16:31], v[36:39], v[220:223], v[16:31]
  ds_read_b128 v[200:203], v0 offset:63488
  v_pk_fma_f16 v187, v187, v51, 0.5 op_sel_hi:[1,1,0] clamp
  v_pk_mul_f16 v184, v184, v48
  v_pk_mul_f16 v185, v185, v49
  v_pk_mul_f16 v186, v186, v50
  v_pk_mul_f16 v187, v187, v51
  v_mfma_f32_32x32x16_bf16 v[16:31], v[40:43], v[224:227], v[16:31]
  ds_read_b128 v[204:207], v0 offset:64512
  ds_read_b128 v[208:211], v1
  v_pk_fma_f16 v56, v52, v52, s20 op_sel_hi:[1,1,0] neg_lo:[1,0,0] neg_hi:[1,0,0] clamp
  v_pk_fma_f16 v57, v53, v53, s20 op_sel_hi:[1,1,0] neg_lo:[1,0,0] neg_hi:[1,0,0] clamp
  v_pk_fma_f16 v58, v54, v54, s20 op_sel_hi:[1,1,0] neg_lo:[1,0,0] neg_hi:[1,0,0] clamp
  v_pk_fma_f16 v59, v55, v55, s20 op_sel_hi:[1,1,0] neg_lo:[1,0,0] neg_hi:[1,0,0] clamp
  v_mfma_f32_32x32x16_bf16 v[16:31], v[44:47], v[228:231], v[16:31]
  v_pk_fma_f16 v188, v56, v56, s20 op_sel:[0,0,1]
  v_pk_fma_f16 v189, v57, v57, s20 op_sel:[0,0,1]
  v_pk_fma_f16 v190, v58, v58, s20 op_sel:[0,0,1]
  v_pk_fma_f16 v191, v59, v59, s20 op_sel:[0,0,1]
  v_pk_fma_f16 v188, v188, v56, s21 op_sel_hi:[1,1,0]
  v_pk_fma_f16 v189, v189, v57, s21 op_sel_hi:[1,1,0]
  v_mfma_f32_32x32x16_bf16 v[16:31], v[60:63], v[232:235], v[16:31]
  s_nop 0
  v_pk_fma_f16 v190, v190, v58, s21 op_sel_hi:[1,1,0]
  v_pk_fma_f16 v191, v191, v59, s21 op_sel_hi:[1,1,0]
  v_pk_fma_f16 v188, v188, v52, 0.5 op_sel_hi:[1,1,0] clamp
  v_pk_fma_f16 v189, v189, v53, 0.5 op_sel_hi:[1,1,0] clamp
  v_pk_fma_f16 v190, v190, v54, 0.5 op_sel_hi:[1,1,0] clamp
  v_pk_fma_f16 v191, v191, v55, 0.5 op_sel_hi:[1,1,0] clamp
  v_mfma_f32_32x32x16_bf16 v[16:31], v[244:247], v[236:239], v[16:31]
  s_waitcnt lgkmcnt(3)
  ds_read_b128 v[212:215], v1 offset:1024
  v_pk_mul_f16 v188, v188, v52
  v_pk_mul_f16 v189, v189, v53
  v_pk_mul_f16 v190, v190, v54
  v_pk_mul_f16 v191, v191, v55
  v_cndmask_b32 v159, v159, v250, s[12:13]
  v_mfma_f32_32x32x16_f16 v[64:79], v[192:195], v[184:187], v[64:79]
  v_cvt_pk_bf16_f32 v216, v112, v113
  v_cvt_pk_bf16_f32 v217, v114, v115
  v_cvt_pk_bf16_f32 v218, v116, v117
  v_cvt_pk_bf16_f32 v219, v118, v119
  v_cvt_pk_bf16_f32 v220, v120, v121
  v_cvt_pk_f16_f32 v48, v16, v17
  v_mfma_f32_32x32x16_f16 v[80:95], v[196:199], v[184:187], v[80:95]
  s_waitcnt lgkmcnt(1)
  s_nop 0
  v_cvt_pk_f16_f32 v49, v18, v19
  v_cvt_pk_f16_f32 v50, v20, v21
  v_cvt_pk_f16_f32 v51, v22, v23
  v_cvt_pk_f16_f32 v52, v24, v25
  v_cvt_pk_f16_f32 v53, v26, v27
  v_cvt_pk_f16_f32 v54, v28, v29
  v_mfma_f32_32x32x16_f16 v[96:111], v[200:203], v[184:187], v[96:111]
  v_cvt_pk_f16_f32 v55, v30, v31
  v_cvt_pk_bf16_f32 v221, v122, v123
  v_cvt_pk_bf16_f32 v222, v124, v125
  v_cvt_pk_bf16_f32 v223, v126, v127
  v_cvt_pk_bf16_f32 v224, v128, v129
  v_cvt_pk_bf16_f32 v225, v130, v131
  v_mfma_f32_32x32x16_f16 v[64:79], v[204:207], v[188:191], v[64:79]
  ds_read_b128 v[180:183], v0 offset:23552
  v_cvt_pk_bf16_f32 v226, v132, v133
  v_cvt_pk_bf16_f32 v227, v134, v135
  v_cvt_pk_bf16_f32 v228, v136, v137
  v_cvt_pk_bf16_f32 v229, v138, v139
  v_cvt_pk_bf16_f32 v230, v140, v141
  v_mfma_f32_32x32x16_f16 v[80:95], v[208:211], v[188:191], v[80:95]
  s_waitcnt lgkmcnt(1)
  ds_read_b128 v[192:195], v1 offset:2048
  v_cvt_pk_bf16_f32 v231, v142, v143
  v_cvt_pk_bf16_f32 v232, v144, v145
  v_cvt_pk_bf16_f32 v233, v146, v147
  v_cvt_pk_bf16_f32 v234, v148, v149
  v_cvt_pk_bf16_f32 v235, v150, v151
  v_mfma_f32_32x32x16_f16 v[96:111], v[212:215], v[188:191], v[96:111]
  s_nop 0
  ds_read_b128 v[112:115], v5
  ds_read_b128 v[116:119], v5 offset:32
  v_cvt_pk_bf16_f32 v236, v152, v153
  v_cvt_pk_bf16_f32 v237, v154, v155
  v_cvt_pk_bf16_f32 v238, v156, v157
  v_cvt_pk_bf16_f32 v239, v158, v159
  v_mfma_f32_32x32x16_bf16 v[16:31], v[160:163], v[216:219], 0
  ds_read_b128 v[136:139], v2
  ds_read_b128 v[140:143], v2 offset:32
  ds_read_b128 v[144:147], v2 offset:64
  v_pk_fma_f16 v56, v48, v48, s20 op_sel_hi:[1,1,0] neg_lo:[1,0,0] neg_hi:[1,0,0] clamp
  v_pk_fma_f16 v57, v49, v49, s20 op_sel_hi:[1,1,0] neg_lo:[1,0,0] neg_hi:[1,0,0] clamp
  v_pk_fma_f16 v58, v50, v50, s20 op_sel_hi:[1,1,0] neg_lo:[1,0,0] neg_hi:[1,0,0] clamp
  v_mfma_f32_32x32x16_bf16 v[16:31], v[164:167], v[220:223], v[16:31]
  ds_read_b128 v[148:151], v2 offset:96
  v_pk_fma_f16 v59, v51, v51, s20 op_sel_hi:[1,1,0] neg_lo:[1,0,0] neg_hi:[1,0,0] clamp
  v_pk_fma_f16 v184, v56, v56, s20 op_sel:[0,0,1]
  v_pk_fma_f16 v185, v57, v57, s20 op_sel:[0,0,1]
  v_pk_fma_f16 v186, v58, v58, s20 op_sel:[0,0,1]
  v_pk_fma_f16 v187, v59, v59, s20 op_sel:[0,0,1]
  v_mfma_f32_32x32x16_bf16 v[16:31], v[168:171], v[224:227], v[16:31]
  v_pk_fma_f16 v184, v184, v56, s21 op_sel_hi:[1,1,0]
  v_pk_fma_f16 v185, v185, v57, s21 op_sel_hi:[1,1,0]
  v_pk_fma_f16 v186, v186, v58, s21 op_sel_hi:[1,1,0]
  v_pk_fma_f16 v187, v187, v59, s21 op_sel_hi:[1,1,0]
  v_pk_fma_f16 v184, v184, v48, 0.5 op_sel_hi:[1,1,0] clamp
  v_pk_fma_f16 v185, v185, v49, 0.5 op_sel_hi:[1,1,0] clamp
  v_mfma_f32_32x32x16_bf16 v[16:31], v[172:175], v[228:231], v[16:31]
  s_nop 0
  v_pk_fma_f16 v186, v186, v50, 0.5 op_sel_hi:[1,1,0] clamp
  v_pk_fma_f16 v187, v187, v51, 0.5 op_sel_hi:[1,1,0] clamp
  v_pk_mul_f16 v184, v184, v48
  v_pk_mul_f16 v185, v185, v49
  v_pk_mul_f16 v186, v186, v50
  v_pk_mul_f16 v187, v187, v51
  v_mfma_f32_32x32x16_bf16 v[16:31], v[176:179], v[232:235], v[16:31]
  s_waitcnt lgkmcnt(4)
  ds_read_b128 v[196:199], v1 offset:3072
  ds_read_b128 v[120:123], v5 offset:64
  ds_read_b128 v[124:127], v5 offset:96
  v_pk_fma_f16 v56, v52, v52, s20 op_sel_hi:[1,1,0] neg_lo:[1,0,0] neg_hi:[1,0,0] clamp
  v_pk_fma_f16 v57, v53, v53, s20 op_sel_hi:[1,1,0] neg_lo:[1,0,0] neg_hi:[1,0,0] clamp
  v_pk_fma_f16 v58, v54, v54, s20 op_sel_hi:[1,1,0] neg_lo:[1,0,0] neg_hi:[1,0,0] clamp
  v_mfma_f32_32x32x16_bf16 v[16:31], v[180:183], v[236:239], v[16:31]
  ds_read_b128 v[152:155], v2 offset:128
  ds_read_b128 v[156:159], v2 offset:160
  ds_read_b128 v[160:163], v2 offset:192
  ds_read_b128 v[164:167], v2 offset:224
  v_mfma_f32_32x32x16_f16 v[64:79], v[192:195], v[184:187], v[64:79]
  s_waitcnt lgkmcnt(7)
  ds_read_b128 v[200:203], v1 offset:4096
  ds_read_b128 v[204:207], v1 offset:5120
  ds_read_b128 v[208:211], v1 offset:6144
  v_pk_fma_f16 v59, v55, v55, s20 op_sel_hi:[1,1,0] neg_lo:[1,0,0] neg_hi:[1,0,0] clamp
  v_pk_fma_f16 v188, v56, v56, s20 op_sel:[0,0,1]
  v_pk_fma_f16 v189, v57, v57, s20 op_sel:[0,0,1]
  v_smfmac_f32_32x32x32_bf16 v[136:151], v[240:243], v[112:119], v250
  s_waitcnt lgkmcnt(9)
  v_pk_fma_f16 v190, v58, v58, s20 op_sel:[0,0,1]
  v_pk_fma_f16 v191, v59, v59, s20 op_sel:[0,0,1]
  v_pk_fma_f16 v188, v188, v56, s21 op_sel_hi:[1,1,0]
  v_pk_fma_f16 v189, v189, v57, s21 op_sel_hi:[1,1,0]
  v_pk_fma_f16 v190, v190, v58, s21 op_sel_hi:[1,1,0]
  v_mfma_f32_32x32x16_f16 v[80:95], v[196:199], v[184:187], v[80:95]
  s_waitcnt lgkmcnt(3)
  v_pk_fma_f16 v191, v191, v59, s21 op_sel_hi:[1,1,0]
  v_pk_fma_f16 v188, v188, v52, 0.5 op_sel_hi:[1,1,0] clamp
  v_pk_fma_f16 v189, v189, v53, 0.5 op_sel_hi:[1,1,0] clamp
  v_pk_fma_f16 v190, v190, v54, 0.5 op_sel_hi:[1,1,0] clamp
  v_pk_fma_f16 v191, v191, v55, 0.5 op_sel_hi:[1,1,0] clamp
  v_pk_mul_f16 v188, v188, v52
  v_smfmac_f32_32x32x32_bf16 v[152:167], v[240:243], v[120:127], v250
  s_waitcnt lgkmcnt(2)
  ds_read_b128 v[212:215], v1 offset:7168
  v_pk_mul_f16 v189, v189, v53
  v_pk_mul_f16 v190, v190, v54
  v_pk_mul_f16 v191, v191, v55
  v_cvt_pk_f16_f32 v48, v16, v17
  v_mfma_f32_32x32x16_f16 v[96:111], v[200:203], v[184:187], v[96:111]
  s_waitcnt lgkmcnt(2)
  ds_read_b128 v[128:131], v5 offset:128
  ds_read_b128 v[132:135], v5 offset:160
  ds_read_b128 v[168:171], v2 offset:256
  ds_read_b128 v[172:175], v2 offset:288
  ds_read_b128 v[176:179], v2 offset:320
  ds_read_b128 v[180:183], v2 offset:352
  v_mfma_f32_32x32x16_f16 v[64:79], v[204:207], v[188:191], v[64:79]
  s_waitcnt lgkmcnt(7)
  v_cvt_pk_f16_f32 v49, v18, v19
  v_cvt_pk_f16_f32 v50, v20, v21
  v_cvt_pk_f16_f32 v51, v22, v23
  v_cvt_pk_f16_f32 v52, v24, v25
  v_cvt_pk_f16_f32 v53, v26, v27
  v_cvt_pk_f16_f32 v54, v28, v29
  v_mfma_f32_32x32x16_f16 v[80:95], v[208:211], v[188:191], v[80:95]
  s_waitcnt lgkmcnt(6)
  ds_read_b128 v[192:195], v1 offset:8192
  ds_read_b128 v[196:199], v1 offset:9216
  v_cvt_pk_f16_f32 v55, v30, v31
  v_pk_fma_f16 v56, v48, v48, s20 op_sel_hi:[1,1,0] neg_lo:[1,0,0] neg_hi:[1,0,0] clamp
  v_pk_fma_f16 v57, v49, v49, s20 op_sel_hi:[1,1,0] neg_lo:[1,0,0] neg_hi:[1,0,0] clamp
  v_pk_fma_f16 v58, v50, v50, s20 op_sel_hi:[1,1,0] neg_lo:[1,0,0] neg_hi:[1,0,0] clamp
  v_mfma_f32_32x32x16_f16 v[96:111], v[212:215], v[188:191], v[96:111]
  s_waitcnt lgkmcnt(2)
  v_pk_fma_f16 v59, v51, v51, s20 op_sel_hi:[1,1,0] neg_lo:[1,0,0] neg_hi:[1,0,0] clamp
  v_pk_fma_f16 v184, v56, v56, s20 op_sel:[0,0,1]
  v_pk_fma_f16 v185, v57, v57, s20 op_sel:[0,0,1]
  v_pk_fma_f16 v186, v58, v58, s20 op_sel:[0,0,1]
  v_pk_fma_f16 v187, v59, v59, s20 op_sel:[0,0,1]
  v_pk_fma_f16 v184, v184, v56, s21 op_sel_hi:[1,1,0]
  v_smfmac_f32_32x32x32_bf16 v[168:183], v[240:243], v[128:135], v250
  v_pk_fma_f16 v185, v185, v57, s21 op_sel_hi:[1,1,0]
  v_pk_fma_f16 v186, v186, v58, s21 op_sel_hi:[1,1,0]
  v_pk_fma_f16 v187, v187, v59, s21 op_sel_hi:[1,1,0]
  v_pk_fma_f16 v184, v184, v48, 0.5 op_sel_hi:[1,1,0] clamp
  v_pk_fma_f16 v185, v185, v49, 0.5 op_sel_hi:[1,1,0] clamp
  v_mfma_f32_32x32x16_bf16 v[16:31], a[0:3], v[216:219], 0
  v_pk_fma_f16 v186, v186, v50, 0.5 op_sel_hi:[1,1,0] clamp
  v_pk_fma_f16 v187, v187, v51, 0.5 op_sel_hi:[1,1,0] clamp
  v_pk_mul_f16 v184, v184, v48
  v_pk_mul_f16 v185, v185, v49
  v_pk_mul_f16 v186, v186, v50
  v_pk_mul_f16 v187, v187, v51
  v_mfma_f32_32x32x16_bf16 v[16:31], a[4:7], v[220:223], v[16:31]
  ds_read_b128 v[200:203], v1 offset:10240
  ds_read_b128 v[204:207], v1 offset:11264
  v_cvt_pk_bf16_f32 v112, v64, v65
  v_cvt_pk_bf16_f32 v113, v66, v67
  v_cvt_pk_bf16_f32 v114, v68, v69
  v_cvt_pk_bf16_f32 v115, v70, v71
  v_mfma_f32_32x32x16_bf16 v[16:31], a[8:11], v[224:227], v[16:31]
  ds_read_b128 v[208:211], v1 offset:12288
  v_cvt_pk_bf16_f32 v116, v72, v73
  v_cvt_pk_bf16_f32 v117, v74, v75
  v_cvt_pk_bf16_f32 v118, v76, v77
  v_cvt_pk_bf16_f32 v119, v78, v79
  v_cvt_pk_bf16_f32 v120, v80, v81
  v_mfma_f32_32x32x16_bf16 v[16:31], a[12:15], v[228:231], v[16:31]
  v_cvt_pk_bf16_f32 v121, v82, v83
  v_cvt_pk_bf16_f32 v122, v84, v85
  v_cvt_pk_bf16_f32 v123, v86, v87
  v_cvt_pk_bf16_f32 v124, v88, v89
  v_cvt_pk_bf16_f32 v125, v90, v91
  v_cvt_pk_bf16_f32 v126, v92, v93
  v_mfma_f32_32x32x16_bf16 v[16:31], a[16:19], v[232:235], v[16:31]
  v_cvt_pk_bf16_f32 v127, v94, v95
  v_pk_fma_f16 v56, v52, v52, s20 op_sel_hi:[1,1,0] neg_lo:[1,0,0] neg_hi:[1,0,0] clamp
  v_pk_fma_f16 v57, v53, v53, s20 op_sel_hi:[1,1,0] neg_lo:[1,0,0] neg_hi:[1,0,0] clamp
  v_pk_fma_f16 v58, v54, v54, s20 op_sel_hi:[1,1,0] neg_lo:[1,0,0] neg_hi:[1,0,0] clamp
  v_pk_fma_f16 v59, v55, v55, s20 op_sel_hi:[1,1,0] neg_lo:[1,0,0] neg_hi:[1,0,0] clamp
  v_pk_fma_f16 v188, v56, v56, s20 op_sel:[0,0,1]
  v_mfma_f32_32x32x16_bf16 v[16:31], a[20:23], v[236:239], v[16:31]
  s_waitcnt lgkmcnt(3)
  v_pk_fma_f16 v189, v57, v57, s20 op_sel:[0,0,1]
  v_pk_fma_f16 v190, v58, v58, s20 op_sel:[0,0,1]
  v_pk_fma_f16 v191, v59, v59, s20 op_sel:[0,0,1]
  v_pk_fma_f16 v188, v188, v56, s21 op_sel_hi:[1,1,0]
  v_pk_fma_f16 v189, v189, v57, s21 op_sel_hi:[1,1,0]
  v_pk_fma_f16 v190, v190, v58, s21 op_sel_hi:[1,1,0]
  v_mfma_f32_32x32x16_f16 v[64:79], v[192:195], v[184:187], v[136:151]
  buffer_load_dwordx4 v6, s[4:7], s29 offen lds
  buffer_load_dwordx4 v7, s[4:7], s29 offen offset:1024 lds
  buffer_load_dwordx4 v8, s[4:7], s29 offen offset:2048 lds
  buffer_load_dwordx4 v9, s[4:7], s29 offen offset:3072 lds
  v_mfma_f32_32x32x16_f16 v[80:95], v[196:199], v[184:187], v[152:167]
  s_waitcnt lgkmcnt(0)
  ds_read_b128 v[212:215], v1 offset:13312
  v_pk_fma_f16 v191, v191, v59, s21 op_sel_hi:[1,1,0]
  v_pk_fma_f16 v188, v188, v52, 0.5 op_sel_hi:[1,1,0] clamp
  v_pk_fma_f16 v189, v189, v53, 0.5 op_sel_hi:[1,1,0] clamp
  v_pk_fma_f16 v190, v190, v54, 0.5 op_sel_hi:[1,1,0] clamp
  v_pk_fma_f16 v191, v191, v55, 0.5 op_sel_hi:[1,1,0] clamp
  v_pk_mul_f16 v188, v188, v52
  v_pk_mul_f16 v189, v189, v53
  v_pk_mul_f16 v190, v190, v54
  v_pk_mul_f16 v191, v191, v55
  v_cvt_pk_bf16_f32 v128, v96, v97
  v_cvt_pk_bf16_f32 v129, v98, v99
  v_cvt_pk_bf16_f32 v130, v100, v101
  v_cvt_pk_bf16_f32 v131, v102, v103
  v_cvt_pk_bf16_f32 v132, v104, v105
  v_cvt_pk_bf16_f32 v133, v106, v107
  v_cvt_pk_bf16_f32 v134, v108, v109
  v_cvt_pk_bf16_f32 v135, v110, v111
  v_mfma_f32_32x32x16_f16 v[96:111], v[200:203], v[184:187], v[168:183]
  s_mov_b32 m0, s31
  v_cvt_pk_f16_f32 v48, v16, v17
  v_cvt_pk_f16_f32 v49, v18, v19
  v_cvt_pk_f16_f32 v50, v20, v21
  v_cvt_pk_f16_f32 v51, v22, v23
  v_cvt_pk_f16_f32 v52, v24, v25
  v_cvt_pk_f16_f32 v53, v26, v27
  v_mfma_f32_32x32x16_f16 v[64:79], v[204:207], v[188:191], v[64:79]
  s_cmp_eq_u32 s26, 1
  ds_read_b128 v[192:195], v1 offset:14336
  ds_read_b128 v[196:199], v1 offset:15360
  v_cvt_pk_f16_f32 v54, v28, v29
  v_cvt_pk_f16_f32 v55, v30, v31
  v_pk_fma_f16 v56, v48, v48, s20 op_sel_hi:[1,1,0] neg_lo:[1,0,0] neg_hi:[1,0,0] clamp
  v_pk_fma_f16 v57, v49, v49, s20 op_sel_hi:[1,1,0] neg_lo:[1,0,0] neg_hi:[1,0,0] clamp
  v_mfma_f32_32x32x16_f16 v[80:95], v[208:211], v[188:191], v[80:95]
  s_waitcnt lgkmcnt(2)
  buffer_load_dwordx4 v6, s[4:7], s52 offen lds
  buffer_load_dwordx4 v7, s[4:7], s52 offen offset:1024 lds
  buffer_load_dwordx4 v8, s[4:7], s52 offen offset:2048 lds
  buffer_load_dwordx4 v9, s[4:7], s52 offen offset:3072 lds
  v_mfma_f32_32x32x16_f16 v[96:111], v[212:215], v[188:191], v[96:111]
  s_cselect_b32 s35, 0x40000000, s23
  v_pk_fma_f16 v58, v50, v50, s20 op_sel_hi:[1,1,0] neg_lo:[1,0,0] neg_hi:[1,0,0] clamp
  v_pk_fma_f16 v59, v51, v51, s20 op_sel_hi:[1,1,0] neg_lo:[1,0,0] neg_hi:[1,0,0] clamp
  v_pk_fma_f16 v184, v56, v56, s20 op_sel:[0,0,1]
  v_pk_fma_f16 v185, v57, v57, s20 op_sel:[0,0,1]
  v_pk_fma_f16 v186, v58, v58, s20 op_sel:[0,0,1]
  v_pk_fma_f16 v187, v59, v59, s20 op_sel:[0,0,1]
  v_mfma_f32_32x32x16_bf16 v[16:31], a[24:27], v[216:219], 0
  s_add_u32 s29, s29, s35
  v_pk_fma_f16 v184, v184, v56, s21 op_sel_hi:[1,1,0]
  v_pk_fma_f16 v185, v185, v57, s21 op_sel_hi:[1,1,0]
  v_pk_fma_f16 v186, v186, v58, s21 op_sel_hi:[1,1,0]
  v_pk_fma_f16 v187, v187, v59, s21 op_sel_hi:[1,1,0]
  v_pk_fma_f16 v184, v184, v48, 0.5 op_sel_hi:[1,1,0] clamp
  v_pk_fma_f16 v185, v185, v49, 0.5 op_sel_hi:[1,1,0] clamp
  v_mfma_f32_32x32x16_bf16 v[16:31], a[28:31], v[220:223], v[16:31]
  s_add_u32 s52, s52, s35
  v_pk_fma_f16 v186, v186, v50, 0.5 op_sel_hi:[1,1,0] clamp
  v_pk_fma_f16 v187, v187, v51, 0.5 op_sel_hi:[1,1,0] clamp
  v_pk_mul_f16 v184, v184, v48
  v_pk_mul_f16 v185, v185, v49
  v_pk_mul_f16 v186, v186, v50
  v_pk_mul_f16 v187, v187, v51
  v_mfma_f32_32x32x16_bf16 v[16:31], a[32:35], v[224:227], v[16:31]
  s_mov_b32 s32, s30
  ds_read_b128 v[200:203], v1 offset:16384
  buffer_store_dwordx4 v[112:115], v10, s[8:11], s28 offen
  v_mfma_f32_32x32x16_bf16 v[16:31], a[36:39], v[228:231], v[16:31]
  s_add_u32 s30, s33, 32
  ds_read_b128 v[204:207], v1 offset:17408
  ds_read_b128 v[208:211], v1 offset:18432
  v_pk_fma_f16 v56, v52, v52, s20 op_sel_hi:[1,1,0] neg_lo:[1,0,0] neg_hi:[1,0,0] clamp
  v_pk_fma_f16 v57, v53, v53, s20 op_sel_hi:[1,1,0] neg_lo:[1,0,0] neg_hi:[1,0,0] clamp
  v_pk_fma_f16 v58, v54, v54, s20 op_sel_hi:[1,1,0] neg_lo:[1,0,0] neg_hi:[1,0,0] clamp
  v_pk_fma_f16 v59, v55, v55, s20 op_sel_hi:[1,1,0] neg_lo:[1,0,0] neg_hi:[1,0,0] clamp
  v_mfma_f32_32x32x16_bf16 v[16:31], a[40:43], v[232:235], v[16:31]
  s_mov_b32 s33, s31
  v_pk_fma_f16 v188, v56, v56, s20 op_sel:[0,0,1]
  v_pk_fma_f16 v189, v57, v57, s20 op_sel:[0,0,1]
  v_pk_fma_f16 v190, v58, v58, s20 op_sel:[0,0,1]
  v_pk_fma_f16 v191, v59, v59, s20 op_sel:[0,0,1]
  v_pk_fma_f16 v188, v188, v56, s21 op_sel_hi:[1,1,0]
  v_pk_fma_f16 v189, v189, v57, s21 op_sel_hi:[1,1,0]
  v_mfma_f32_32x32x16_bf16 v[16:31], a[44:47], v[236:239], v[16:31]
  s_waitcnt lgkmcnt(3)
  v_pk_fma_f16 v190, v190, v58, s21 op_sel_hi:[1,1,0]
  v_pk_fma_f16 v191, v191, v59, s21 op_sel_hi:[1,1,0]
  v_pk_fma_f16 v188, v188, v52, 0.5 op_sel_hi:[1,1,0] clamp
  v_pk_fma_f16 v189, v189, v53, 0.5 op_sel_hi:[1,1,0] clamp
  v_pk_fma_f16 v190, v190, v54, 0.5 op_sel_hi:[1,1,0] clamp
  v_pk_fma_f16 v191, v191, v55, 0.5 op_sel_hi:[1,1,0] clamp
  v_mfma_f32_32x32x16_f16 v[64:79], v[192:195], v[184:187], v[64:79]
  s_sub_u32 s31, s32, 32
  s_nop 0
  ds_read_b128 v[212:215], v1 offset:19456
  v_pk_mul_f16 v188, v188, v52
  v_pk_mul_f16 v189, v189, v53
  v_pk_mul_f16 v190, v190, v54
  v_pk_mul_f16 v191, v191, v55
  v_cvt_pk_f16_f32 v48, v16, v17
  v_mfma_f32_32x32x16_f16 v[80:95], v[196:199], v[184:187], v[80:95]
  s_waitcnt lgkmcnt(3)
  buffer_store_dwordx4 v[116:119], v10, s[8:11], s28 offen offset:32
  v_cvt_pk_f16_f32 v49, v18, v19
  v_mfma_f32_32x32x16_f16 v[96:111], v[200:203], v[184:187], v[96:111]
  s_waitcnt lgkmcnt(1)
  v_cvt_pk_f16_f32 v50, v20, v21
  v_cvt_pk_f16_f32 v51, v22, v23
  v_cvt_pk_f16_f32 v52, v24, v25
  v_cvt_pk_f16_f32 v53, v26, v27
  v_cvt_pk_f16_f32 v54, v28, v29
  v_cvt_pk_f16_f32 v55, v30, v31
  v_mfma_f32_32x32x16_f16 v[64:79], v[204:207], v[188:191], v[64:79]
  ds_read_b128 v[192:195], v1 offset:20480
  ds_read_b128 v[196:199], v1 offset:21504
  v_pk_fma_f16 v56, v48, v48, s20 op_sel_hi:[1,1,0] neg_lo:[1,0,0] neg_hi:[1,0,0] clamp
  v_pk_fma_f16 v57, v49, v49, s20 op_sel_hi:[1,1,0] neg_lo:[1,0,0] neg_hi:[1,0,0] clamp
  v_pk_fma_f16 v58, v50, v50, s20 op_sel_hi:[1,1,0] neg_lo:[1,0,0] neg_hi:[1,0,0] clamp
  v_pk_fma_f16 v59, v51, v51, s20 op_sel_hi:[1,1,0] neg_lo:[1,0,0] neg_hi:[1,0,0] clamp
  v_mfma_f32_32x32x16_f16 v[80:95], v[208:211], v[188:191], v[80:95]
  s_waitcnt lgkmcnt(2)
  s_nop 0
  v_pk_fma_f16 v184, v56, v56, s20 op_sel:[0,0,1]
  v_pk_fma_f16 v185, v57, v57, s20 op_sel:[0,0,1]
  v_pk_fma_f16 v186, v58, v58, s20 op_sel:[0,0,1]
  v_pk_fma_f16 v187, v59, v59, s20 op_sel:[0,0,1]
  v_pk_fma_f16 v184, v184, v56, s21 op_sel_hi:[1,1,0]
  v_pk_fma_f16 v185, v185, v57, s21 op_sel_hi:[1,1,0]
  v_mfma_f32_32x32x16_f16 v[96:111], v[212:215], v[188:191], v[96:111]
  v_pk_fma_f16 v186, v186, v58, s21 op_sel_hi:[1,1,0]
  v_pk_fma_f16 v187, v187, v59, s21 op_sel_hi:[1,1,0]
  v_pk_fma_f16 v184, v184, v48, 0.5 op_sel_hi:[1,1,0] clamp
  v_pk_fma_f16 v185, v185, v49, 0.5 op_sel_hi:[1,1,0] clamp
  v_pk_fma_f16 v186, v186, v50, 0.5 op_sel_hi:[1,1,0] clamp
  v_pk_fma_f16 v187, v187, v51, 0.5 op_sel_hi:[1,1,0] clamp
  v_mfma_f32_32x32x16_bf16 v[16:31], a[48:51], v[216:219], 0
  buffer_store_dwordx4 v[120:123], v10, s[8:11], s28 offen offset:64
  v_pk_mul_f16 v184, v184, v48
  v_mfma_f32_32x32x16_bf16 v[16:31], a[52:55], v[220:223], v[16:31]
  ds_read_b128 v[200:203], v1 offset:22528
  ds_read_b128 v[204:207], v1 offset:23552
  ds_read_b128 v[208:211], v1 offset:24576
  v_pk_mul_f16 v185, v185, v49
  v_pk_mul_f16 v186, v186, v50
  v_pk_mul_f16 v187, v187, v51
  v_mfma_f32_32x32x16_bf16 v[16:31], a[56:59], v[224:227], v[16:31]
  v_pk_fma_f16 v56, v52, v52, s20 op_sel_hi:[1,1,0] neg_lo:[1,0,0] neg_hi:[1,0,0] clamp
  v_pk_fma_f16 v57, v53, v53, s20 op_sel_hi:[1,1,0] neg_lo:[1,0,0] neg_hi:[1,0,0] clamp
  v_pk_fma_f16 v58, v54, v54, s20 op_sel_hi:[1,1,0] neg_lo:[1,0,0] neg_hi:[1,0,0] clamp
  v_pk_fma_f16 v59, v55, v55, s20 op_sel_hi:[1,1,0] neg_lo:[1,0,0] neg_hi:[1,0,0] clamp
  v_pk_fma_f16 v188, v56, v56, s20 op_sel:[0,0,1]
  v_pk_fma_f16 v189, v57, v57, s20 op_sel:[0,0,1]
  v_mfma_f32_32x32x16_bf16 v[16:31], a[60:63], v[228:231], v[16:31]
  v_pk_fma_f16 v190, v58, v58, s20 op_sel:[0,0,1]
  v_pk_fma_f16 v191, v59, v59, s20 op_sel:[0,0,1]
  v_pk_fma_f16 v188, v188, v56, s21 op_sel_hi:[1,1,0]
  v_pk_fma_f16 v189, v189, v57, s21 op_sel_hi:[1,1,0]
  v_pk_fma_f16 v190, v190, v58, s21 op_sel_hi:[1,1,0]
  v_pk_fma_f16 v191, v191, v59, s21 op_sel_hi:[1,1,0]
  v_mfma_f32_32x32x16_bf16 v[16:31], a[64:67], v[232:235], v[16:31]
  v_pk_fma_f16 v188, v188, v52, 0.5 op_sel_hi:[1,1,0] clamp
  v_pk_fma_f16 v189, v189, v53, 0.5 op_sel_hi:[1,1,0] clamp
  v_pk_fma_f16 v190, v190, v54, 0.5 op_sel_hi:[1,1,0] clamp
  v_pk_fma_f16 v191, v191, v55, 0.5 op_sel_hi:[1,1,0] clamp
  v_pk_mul_f16 v188, v188, v52
  v_pk_mul_f16 v189, v189, v53
  v_mfma_f32_32x32x16_bf16 v[16:31], a[68:71], v[236:239], v[16:31]
  s_waitcnt lgkmcnt(3)
  buffer_store_dwordx4 v[124:127], v10, s[8:11], s28 offen offset:96
  v_pk_mul_f16 v190, v190, v54
  v_mfma_f32_32x32x16_f16 v[64:79], v[192:195], v[184:187], v[64:79]
  s_nop 0
  ds_read_b128 v[212:215], v1 offset:25600
  ds_read_b128 v[192:195], v1 offset:26624
  v_pk_mul_f16 v191, v191, v55
  v_subrev_u32 v14, 0x4100, v5
  v_add_u32 v5, 0x8200, v5
  v_min_u32 v5, v14, v5
  v_mfma_f32_32x32x16_f16 v[80:95], v[196:199], v[184:187], v[80:95]
  s_waitcnt lgkmcnt(2)
  ds_read_b128 v[196:199], v1 offset:27648
  v_subrev_u32 v14, 0x4100, v4
  v_cvt_pk_f16_f32 v48, v16, v17
  v_cvt_pk_f16_f32 v49, v18, v19
  v_cvt_pk_f16_f32 v50, v20, v21
  v_cvt_pk_f16_f32 v51, v22, v23
  v_mfma_f32_32x32x16_f16 v[96:111], v[200:203], v[184:187], v[96:111]
  v_cvt_pk_f16_f32 v52, v24, v25
  v_cvt_pk_f16_f32 v53, v26, v27
  v_cvt_pk_f16_f32 v54, v28, v29
  v_cvt_pk_f16_f32 v55, v30, v31
  v_pk_fma_f16 v56, v48, v48, s20 op_sel_hi:[1,1,0] neg_lo:[1,0,0] neg_hi:[1,0,0] clamp
  v_pk_fma_f16 v57, v49, v49, s20 op_sel_hi:[1,1,0] neg_lo:[1,0,0] neg_hi:[1,0,0] clamp
  v_mfma_f32_32x32x16_f16 v[64:79], v[204:207], v[188:191], v[64:79]
  v_pk_fma_f16 v58, v50, v50, s20 op_sel_hi:[1,1,0] neg_lo:[1,0,0] neg_hi:[1,0,0] clamp
  v_pk_fma_f16 v59, v51, v51, s20 op_sel_hi:[1,1,0] neg_lo:[1,0,0] neg_hi:[1,0,0] clamp
  v_pk_fma_f16 v184, v56, v56, s20 op_sel:[0,0,1]
  v_pk_fma_f16 v185, v57, v57, s20 op_sel:[0,0,1]
  v_pk_fma_f16 v186, v58, v58, s20 op_sel:[0,0,1]
  v_pk_fma_f16 v187, v59, v59, s20 op_sel:[0,0,1]
  v_mfma_f32_32x32x16_f16 v[80:95], v[208:211], v[188:191], v[80:95]
  s_waitcnt lgkmcnt(2)
  buffer_store_dwordx4 v[128:131], v10, s[8:11], s28 offen offset:128
  v_pk_fma_f16 v184, v184, v56, s21 op_sel_hi:[1,1,0]
  v_mfma_f32_32x32x16_f16 v[96:111], v[212:215], v[188:191], v[96:111]
  s_nop 0
  v_pk_fma_f16 v185, v185, v57, s21 op_sel_hi:[1,1,0]
  v_pk_fma_f16 v186, v186, v58, s21 op_sel_hi:[1,1,0]
  v_pk_fma_f16 v187, v187, v59, s21 op_sel_hi:[1,1,0]
  v_pk_fma_f16 v184, v184, v48, 0.5 op_sel_hi:[1,1,0] clamp
  v_pk_fma_f16 v185, v185, v49, 0.5 op_sel_hi:[1,1,0] clamp
  v_pk_fma_f16 v186, v186, v50, 0.5 op_sel_hi:[1,1,0] clamp
  v_mfma_f32_32x32x16_bf16 v[16:31], a[72:75], v[216:219], 0
  ds_read_b128 v[200:203], v1 offset:28672
  v_pk_fma_f16 v187, v187, v51, 0.5 op_sel_hi:[1,1,0] clamp
  v_pk_mul_f16 v184, v184, v48
  v_pk_mul_f16 v185, v185, v49
  v_pk_mul_f16 v186, v186, v50
  v_pk_mul_f16 v187, v187, v51
  v_mfma_f32_32x32x16_bf16 v[16:31], a[76:79], v[220:223], v[16:31]
  ds_read_b128 v[204:207], v1 offset:29696
  ds_read_b128 v[208:211], v1 offset:30720
  v_pk_fma_f16 v56, v52, v52, s20 op_sel_hi:[1,1,0] neg_lo:[1,0,0] neg_hi:[1,0,0] clamp
  v_pk_fma_f16 v57, v53, v53, s20 op_sel_hi:[1,1,0] neg_lo:[1,0,0] neg_hi:[1,0,0] clamp
  v_pk_fma_f16 v58, v54, v54, s20 op_sel_hi:[1,1,0] neg_lo:[1,0,0] neg_hi:[1,0,0] clamp
  v_pk_fma_f16 v59, v55, v55, s20 op_sel_hi:[1,1,0] neg_lo:[1,0,0] neg_hi:[1,0,0] clamp
  v_mfma_f32_32x32x16_bf16 v[16:31], a[80:83], v[224:227], v[16:31]
  v_pk_fma_f16 v188, v56, v56, s20 op_sel:[0,0,1]
  v_pk_fma_f16 v189, v57, v57, s20 op_sel:[0,0,1]
  v_pk_fma_f16 v190, v58, v58, s20 op_sel:[0,0,1]
  v_pk_fma_f16 v191, v59, v59, s20 op_sel:[0,0,1]
  v_pk_fma_f16 v188, v188, v56, s21 op_sel_hi:[1,1,0]
  v_pk_fma_f16 v189, v189, v57, s21 op_sel_hi:[1,1,0]
  v_mfma_f32_32x32x16_bf16 v[16:31], a[84:87], v[228:231], v[16:31]
  buffer_store_dwordx4 v[132:135], v10, s[8:11], s28 offen offset:160
  v_pk_fma_f16 v190, v190, v58, s21 op_sel_hi:[1,1,0]
  v_mfma_f32_32x32x16_bf16 v[16:31], a[88:91], v[232:235], v[16:31]
  v_pk_fma_f16 v191, v191, v59, s21 op_sel_hi:[1,1,0]
  v_pk_fma_f16 v188, v188, v52, 0.5 op_sel_hi:[1,1,0] clamp
  v_pk_fma_f16 v189, v189, v53, 0.5 op_sel_hi:[1,1,0] clamp
  v_pk_fma_f16 v190, v190, v54, 0.5 op_sel_hi:[1,1,0] clamp
  v_pk_fma_f16 v191, v191, v55, 0.5 op_sel_hi:[1,1,0] clamp
  v_pk_mul_f16 v188, v188, v52
  v_mfma_f32_32x32x16_bf16 v[16:31], a[92:95], v[236:239], v[16:31]
  s_waitcnt lgkmcnt(2)
  ds_read_b128 v[212:215], v1 offset:31744
  v_pk_mul_f16 v189, v189, v53
  v_pk_mul_f16 v190, v190, v54
  v_pk_mul_f16 v191, v191, v55
  v_add_u32 v4, 0x8200, v4
  v_min_u32 v4, v14, v4
  v_mfma_f32_32x32x16_f16 v[64:79], v[192:195], v[184:187], v[64:79]
  s_nop 0
  ds_read_b128 v[160:163], v3 offset:2400
  ds_read2_b64 v[176:179], v11 offset0:192 offset1:200
  buffer_load_dword v249, v248, s[4:7], s29 offen
  v_mfma_f32_32x32x16_f16 v[80:95], v[196:199], v[184:187], v[80:95]
  s_nop 0
  v_cvt_pk_f16_f32 v48, v16, v17
  v_cvt_pk_f16_f32 v49, v18, v19
  v_cvt_pk_f16_f32 v50, v20, v21
  v_cvt_pk_f16_f32 v51, v22, v23
  v_cvt_pk_f16_f32 v52, v24, v25
  v_cvt_pk_f16_f32 v53, v26, v27
  v_mfma_f32_32x32x16_f16 v[96:111], v[200:203], v[184:187], v[96:111]
  s_waitcnt vmcnt(7) lgkmcnt(3)
  ds_read_b128 v[164:167], v4 offset:96
  ds_read_b128 v[168:171], v4 offset:288
  ds_read_b128 v[172:175], v4 offset:480
  v_cvt_pk_f16_f32 v54, v28, v29
  v_cvt_pk_f16_f32 v55, v30, v31
  v_pk_fma_f16 v56, v48, v48, s20 op_sel_hi:[1,1,0] neg_lo:[1,0,0] neg_hi:[1,0,0] clamp
  v_mfma_f32_32x32x16_f16 v[64:79], v[204:207], v[188:191], v[64:79]
  s_sub_u32 s26, s26, 1
  v_pk_fma_f16 v57, v49, v49, s20 op_sel_hi:[1,1,0] neg_lo:[1,0,0] neg_hi:[1,0,0] clamp
  v_pk_fma_f16 v58, v50, v50, s20 op_sel_hi:[1,1,0] neg_lo:[1,0,0] neg_hi:[1,0,0] clamp
  v_pk_fma_f16 v59, v51, v51, s20 op_sel_hi:[1,1,0] neg_lo:[1,0,0] neg_hi:[1,0,0] clamp
  v_pk_fma_f16 v184, v56, v56, s20 op_sel:[0,0,1]
  v_pk_fma_f16 v185, v57, v57, s20 op_sel:[0,0,1]
  v_pk_fma_f16 v186, v58, v58, s20 op_sel:[0,0,1]
  v_mfma_f32_32x32x16_f16 v[80:95], v[208:211], v[188:191], v[80:95]
  s_waitcnt lgkmcnt(5)
  v_pk_fma_f16 v187, v59, v59, s20 op_sel:[0,0,1]
  s_nop 0
  v_mfma_f32_32x32x16_f16 v[96:111], v[212:215], v[188:191], v[96:111]
  s_waitcnt lgkmcnt(0)
  s_cbranch_scc0 L_loop
  v_mfma_f32_32x32x16_bf16 v[16:31], a[96:99], v[216:219], 0
  s_add_u32 s28, s28, 0x60000
  ds_read_b128 v[192:195], v0 offset:24576
  ds_read_b128 v[196:199], v0 offset:25600
  v_pk_fma_f16 v184, v184, v56, s21 op_sel_hi:[1,1,0]
  v_pk_fma_f16 v185, v185, v57, s21 op_sel_hi:[1,1,0]
  v_pk_fma_f16 v186, v186, v58, s21 op_sel_hi:[1,1,0]
  v_pk_fma_f16 v187, v187, v59, s21 op_sel_hi:[1,1,0]
  v_mfma_f32_32x32x16_bf16 v[16:31], a[100:103], v[220:223], v[16:31]
  v_pk_fma_f16 v184, v184, v48, 0.5 op_sel_hi:[1,1,0] clamp
  v_pk_fma_f16 v185, v185, v49, 0.5 op_sel_hi:[1,1,0] clamp
  v_pk_fma_f16 v186, v186, v50, 0.5 op_sel_hi:[1,1,0] clamp
  v_pk_fma_f16 v187, v187, v51, 0.5 op_sel_hi:[1,1,0] clamp
  v_pk_mul_f16 v184, v184, v48
  v_pk_mul_f16 v185, v185, v49
  v_mfma_f32_32x32x16_bf16 v[16:31], a[104:107], v[224:227], v[16:31]
  ds_read_b128 v[200:203], v0 offset:26624
  ds_read_b128 v[204:207], v0 offset:27648
  ds_read_b128 v[208:211], v0 offset:28672
  v_pk_mul_f16 v186, v186, v50
  v_pk_mul_f16 v187, v187, v51
  v_pk_fma_f16 v56, v52, v52, s20 op_sel_hi:[1,1,0] neg_lo:[1,0,0] neg_hi:[1,0,0] clamp
  v_mfma_f32_32x32x16_bf16 v[16:31], a[108:111], v[228:231], v[16:31]
  v_pk_fma_f16 v57, v53, v53, s20 op_sel_hi:[1,1,0] neg_lo:[1,0,0] neg_hi:[1,0,0] clamp
  v_pk_fma_f16 v58, v54, v54, s20 op_sel_hi:[1,1,0] neg_lo:[1,0,0] neg_hi:[1,0,0] clamp
  v_pk_fma_f16 v59, v55, v55, s20 op_sel_hi:[1,1,0] neg_lo:[1,0,0] neg_hi:[1,0,0] clamp
  v_pk_fma_f16 v188, v56, v56, s20 op_sel:[0,0,1]
  v_pk_fma_f16 v189, v57, v57, s20 op_sel:[0,0,1]
  v_pk_fma_f16 v190, v58, v58, s20 op_sel:[0,0,1]
  v_mfma_f32_32x32x16_bf16 v[16:31], a[112:115], v[232:235], v[16:31]
  v_pk_fma_f16 v191, v59, v59, s20 op_sel:[0,0,1]
  v_pk_fma_f16 v188, v188, v56, s21 op_sel_hi:[1,1,0]
  v_pk_fma_f16 v189, v189, v57, s21 op_sel_hi:[1,1,0]
  v_pk_fma_f16 v190, v190, v58, s21 op_sel_hi:[1,1,0]
  v_pk_fma_f16 v191, v191, v59, s21 op_sel_hi:[1,1,0]
  v_pk_fma_f16 v188, v188, v52, 0.5 op_sel_hi:[1,1,0] clamp
  v_mfma_f32_32x32x16_bf16 v[16:31], a[116:119], v[236:239], v[16:31]
  s_waitcnt lgkmcnt(3)
  s_nop 0
  v_pk_fma_f16 v189, v189, v53, 0.5 op_sel_hi:[1,1,0] clamp
  v_pk_fma_f16 v190, v190, v54, 0.5 op_sel_hi:[1,1,0] clamp
  v_pk_fma_f16 v191, v191, v55, 0.5 op_sel_hi:[1,1,0] clamp
  v_pk_mul_f16 v188, v188, v52
  v_pk_mul_f16 v189, v189, v53
  v_pk_mul_f16 v190, v190, v54
  v_mfma_f32_32x32x16_f16 v[64:79], v[192:195], v[184:187], v[64:79]
  ds_read_b128 v[212:215], v0 offset:29696
  ds_read_b128 v[192:195], v0 offset:30720
  v_pk_mul_f16 v191, v191, v55
  s_nop 1
  v_cvt_pk_f16_f32 v48, v16, v17
  v_mfma_f32_32x32x16_f16 v[80:95], v[196:199], v[184:187], v[80:95]
  s_waitcnt lgkmcnt(2)
  v_cvt_pk_f16_f32 v49, v18, v19
  v_cvt_pk_f16_f32 v50, v20, v21
  v_cvt_pk_f16_f32 v51, v22, v23
  v_cvt_pk_f16_f32 v52, v24, v25
  v_cvt_pk_f16_f32 v53, v26, v27
  v_cvt_pk_f16_f32 v54, v28, v29
  v_mfma_f32_32x32x16_f16 v[96:111], v[200:203], v[184:187], v[96:111]
  ds_read_b128 v[196:199], v0 offset:31744
  v_cvt_pk_f16_f32 v55, v30, v31
  v_pk_fma_f16 v56, v48, v48, s20 op_sel_hi:[1,1,0] neg_lo:[1,0,0] neg_hi:[1,0,0] clamp
  v_pk_fma_f16 v57, v49, v49, s20 op_sel_hi:[1,1,0] neg_lo:[1,0,0] neg_hi:[1,0,0] clamp
  v_pk_fma_f16 v58, v50, v50, s20 op_sel_hi:[1,1,0] neg_lo:[1,0,0] neg_hi:[1,0,0] clamp
  v_pk_fma_f16 v59, v51, v51, s20 op_sel_hi:[1,1,0] neg_lo:[1,0,0] neg_hi:[1,0,0] clamp
  v_mfma_f32_32x32x16_f16 v[64:79], v[204:207], v[188:191], v[64:79]
  v_pk_fma_f16 v184, v56, v56, s20 op_sel:[0,0,1]
  v_pk_fma_f16 v185, v57, v57, s20 op_sel:[0,0,1]
  v_pk_fma_f16 v186, v58, v58, s20 op_sel:[0,0,1]
  v_pk_fma_f16 v187, v59, v59, s20 op_sel:[0,0,1]
  v_pk_fma_f16 v184, v184, v56, s21 op_sel_hi:[1,1,0]
  v_pk_fma_f16 v185, v185, v57, s21 op_sel_hi:[1,1,0]
  v_mfma_f32_32x32x16_f16 v[80:95], v[208:211], v[188:191], v[80:95]
  s_waitcnt lgkmcnt(2)
  v_pk_fma_f16 v186, v186, v58, s21 op_sel_hi:[1,1,0]
  v_pk_fma_f16 v187, v187, v59, s21 op_sel_hi:[1,1,0]
  v_pk_fma_f16 v184, v184, v48, 0.5 op_sel_hi:[1,1,0] clamp
  v_pk_fma_f16 v185, v185, v49, 0.5 op_sel_hi:[1,1,0] clamp
  v_pk_fma_f16 v186, v186, v50, 0.5 op_sel_hi:[1,1,0] clamp
  v_pk_fma_f16 v187, v187, v51, 0.5 op_sel_hi:[1,1,0] clamp
  v_mfma_f32_32x32x16_f16 v[96:111], v[212:215], v[188:191], v[96:111]
  s_nop 0
  ds_read_b128 v[200:203], v0 offset:32768
  ds_read_b128 v[204:207], v0 offset:33792
  v_pk_mul_f16 v184, v184, v48
  v_pk_mul_f16 v185, v185, v49
  v_pk_mul_f16 v186, v186, v50
  v_pk_mul_f16 v187, v187, v51
  v_mfma_f32_32x32x16_bf16 v[16:31], a[120:123], v[216:219], 0
  ds_read_b128 v[12:15], v2 offset:384
  ds_read_b128 v[208:211], v0 offset:34816
  v_pk_fma_f16 v56, v52, v52, s20 op_sel_hi:[1,1,0] neg_lo:[1,0,0] neg_hi:[1,0,0] clamp
  v_pk_fma_f16 v57, v53, v53, s20 op_sel_hi:[1,1,0] neg_lo:[1,0,0] neg_hi:[1,0,0] clamp
  v_pk_fma_f16 v58, v54, v54, s20 op_sel_hi:[1,1,0] neg_lo:[1,0,0] neg_hi:[1,0,0] clamp
  v_pk_fma_f16 v59, v55, v55, s20 op_sel_hi:[1,1,0] neg_lo:[1,0,0] neg_hi:[1,0,0] clamp
  v_mfma_f32_32x32x16_bf16 v[16:31], a[124:127], v[220:223], v[16:31]
  v_pk_fma_f16 v188, v56, v56, s20 op_sel:[0,0,1]
  v_pk_fma_f16 v189, v57, v57, s20 op_sel:[0,0,1]
  v_pk_fma_f16 v190, v58, v58, s20 op_sel:[0,0,1]
  v_pk_fma_f16 v191, v59, v59, s20 op_sel:[0,0,1]
  v_pk_fma_f16 v188, v188, v56, s21 op_sel_hi:[1,1,0]
  v_pk_fma_f16 v189, v189, v57, s21 op_sel_hi:[1,1,0]
  v_mfma_f32_32x32x16_bf16 v[16:31], a[128:131], v[224:227], v[16:31]
  v_pk_fma_f16 v190, v190, v58, s21 op_sel_hi:[1,1,0]
  v_pk_fma_f16 v191, v191, v59, s21 op_sel_hi:[1,1,0]
  v_pk_fma_f16 v188, v188, v52, 0.5 op_sel_hi:[1,1,0] clamp
  v_pk_fma_f16 v189, v189, v53, 0.5 op_sel_hi:[1,1,0] clamp
  v_pk_fma_f16 v190, v190, v54, 0.5 op_sel_hi:[1,1,0] clamp
  v_pk_fma_f16 v191, v191, v55, 0.5 op_sel_hi:[1,1,0] clamp
  v_mfma_f32_32x32x16_bf16 v[16:31], a[132:135], v[228:231], v[16:31]
  ds_read_b128 v[212:215], v0 offset:35840
  v_pk_mul_f16 v188, v188, v52
  v_pk_mul_f16 v189, v189, v53
  v_pk_mul_f16 v190, v190, v54
  v_pk_mul_f16 v191, v191, v55
  v_mfma_f32_32x32x16_bf16 v[16:31], a[136:139], v[232:235], v[16:31]
  s_waitcnt lgkmcnt(2)
  v_or3_b32 v12, v12, v13, v14
  v_or_b32 v12, v12, v15
  v_cmp_ne_u32 vcc, 0, v12
  s_nop 0
  v_mfma_f32_32x32x16_bf16 v[16:31], a[140:143], v[236:239], v[16:31]
  s_cbranch_vccnz L_slow
  s_nop 4
  v_mfma_f32_32x32x16_f16 v[64:79], v[192:195], v[184:187], v[64:79]
  s_nop 0
  ds_read_b128 v[192:195], v0 offset:36864
  s_nop 3
  v_cvt_pk_f16_f32 v48, v16, v17
  v_mfma_f32_32x32x16_f16 v[80:95], v[196:199], v[184:187], v[80:95]
  v_cvt_pk_f16_f32 v49, v18, v19
  v_cvt_pk_f16_f32 v50, v20, v21
  v_cvt_pk_f16_f32 v51, v22, v23
  v_cvt_pk_f16_f32 v52, v24, v25
  v_cvt_pk_f16_f32 v53, v26, v27
  v_cvt_pk_f16_f32 v54, v28, v29
  v_mfma_f32_32x32x16_f16 v[96:111], v[200:203], v[184:187], v[96:111]
  ds_read_b128 v[196:199], v0 offset:37888
  v_cvt_pk_f16_f32 v55, v30, v31
  v_pk_fma_f16 v56, v48, v48, s20 op_sel_hi:[1,1,0] neg_lo:[1,0,0] neg_hi:[1,0,0] clamp
  v_pk_fma_f16 v57, v49, v49, s20 op_sel_hi:[1,1,0] neg_lo:[1,0,0] neg_hi:[1,0,0] clamp
  v_pk_fma_f16 v58, v50, v50, s20 op_sel_hi:[1,1,0] neg_lo:[1,0,0] neg_hi:[1,0,0] clamp
  v_pk_fma_f16 v59, v51, v51, s20 op_sel_hi:[1,1,0] neg_lo:[1,0,0] neg_hi:[1,0,0] clamp
  v_mfma_f32_32x32x16_f16 v[64:79], v[204:207], v[188:191], v[64:79]
  s_waitcnt lgkmcnt(2)
  s_nop 0
  v_pk_fma_f16 v184, v56, v56, s20 op_sel:[0,0,1]
  v_pk_fma_f16 v185, v57, v57, s20 op_sel:[0,0,1]
  v_pk_fma_f16 v186, v58, v58, s20 op_sel:[0,0,1]
  v_pk_fma_f16 v187, v59, v59, s20 op_sel:[0,0,1]
  v_pk_fma_f16 v184, v184, v56, s21 op_sel_hi:[1,1,0]
  v_pk_fma_f16 v185, v185, v57, s21 op_sel_hi:[1,1,0]
  v_mfma_f32_32x32x16_f16 v[80:95], v[208:211], v[188:191], v[80:95]
  v_pk_fma_f16 v186, v186, v58, s21 op_sel_hi:[1,1,0]
  v_pk_fma_f16 v187, v187, v59, s21 op_sel_hi:[1,1,0]
  v_pk_fma_f16 v184, v184, v48, 0.5 op_sel_hi:[1,1,0] clamp
  v_pk_fma_f16 v185, v185, v49, 0.5 op_sel_hi:[1,1,0] clamp
  v_pk_fma_f16 v186, v186, v50, 0.5 op_sel_hi:[1,1,0] clamp
  v_pk_fma_f16 v187, v187, v51, 0.5 op_sel_hi:[1,1,0] clamp
  v_mfma_f32_32x32x16_f16 v[96:111], v[212:215], v[188:191], v[96:111]
  ds_read_b128 v[200:203], v0 offset:38912
  ds_read_b128 v[204:207], v0 offset:39936
  v_pk_mul_f16 v184, v184, v48
  v_pk_mul_f16 v185, v185, v49
  v_pk_mul_f16 v186, v186, v50
  v_pk_mul_f16 v187, v187, v51
  v_mfma_f32_32x32x16_bf16 v[16:31], a[144:147], v[216:219], 0
  ds_read_b128 v[208:211], v0 offset:40960
  v_pk_fma_f16 v56, v52, v52, s20 op_sel_hi:[1,1,0] neg_lo:[1,0,0] neg_hi:[1,0,0] clamp
  v_pk_fma_f16 v57, v53, v53, s20 op_sel_hi:[1,1,0] neg_lo:[1,0,0] neg_hi:[1,0,0] clamp
  v_pk_fma_f16 v58, v54, v54, s20 op_sel_hi:[1,1,0] neg_lo:[1,0,0] neg_hi:[1,0,0] clamp
  v_pk_fma_f16 v59, v55, v55, s20 op_sel_hi:[1,1,0] neg_lo:[1,0,0] neg_hi:[1,0,0] clamp
  v_pk_fma_f16 v188, v56, v56, s20 op_sel:[0,0,1]
  v_mfma_f32_32x32x16_bf16 v[16:31], a[148:151], v[220:223], v[16:31]
  v_pk_fma_f16 v189, v57, v57, s20 op_sel:[0,0,1]
  v_pk_fma_f16 v190, v58, v58, s20 op_sel:[0,0,1]
  v_pk_fma_f16 v191, v59, v59, s20 op_sel:[0,0,1]
  v_pk_fma_f16 v188, v188, v56, s21 op_sel_hi:[1,1,0]
  v_pk_fma_f16 v189, v189, v57, s21 op_sel_hi:[1,1,0]
  v_pk_fma_f16 v190, v190, v58, s21 op_sel_hi:[1,1,0]
  v_mfma_f32_32x32x16_bf16 v[16:31], a[152:155], v[224:227], v[16:31]
  v_pk_fma_f16 v191, v191, v59, s21 op_sel_hi:[1,1,0]
  v_pk_fma_f16 v188, v188, v52, 0.5 op_sel_hi:[1,1,0] clamp
  v_pk_fma_f16 v189, v189, v53, 0.5 op_sel_hi:[1,1,0] clamp
  v_pk_fma_f16 v190, v190, v54, 0.5 op_sel_hi:[1,1,0] clamp
  v_pk_fma_f16 v191, v191, v55, 0.5 op_sel_hi:[1,1,0] clamp
  v_pk_mul_f16 v188, v188, v52
  v_mfma_f32_32x32x16_bf16 v[16:31], a[156:159], v[228:231], v[16:31]
  ds_read_b128 v[212:215], v0 offset:41984
  v_pk_mul_f16 v189, v189, v53
  v_pk_mul_f16 v190, v190, v54
  v_pk_mul_f16 v191, v191, v55
  v_mfma_f32_32x32x16_bf16 v[16:31], a[160:163], v[232:235], v[16:31]
  v_mfma_f32_32x32x16_bf16 v[16:31], a[164:167], v[236:239], v[16:31]
  s_waitcnt lgkmcnt(1)
  s_nop 5
  s_nop 0
  v_mfma_f32_32x32x16_f16 v[64:79], v[192:195], v[184:187], v[64:79]
  ds_read_b128 v[192:195], v0 offset:43008
  s_nop 2
  v_cvt_pk_f16_f32 v48, v16, v17
  v_cvt_pk_f16_f32 v49, v18, v19
  v_mfma_f32_32x32x16_f16 v[80:95], v[196:199], v[184:187], v[80:95]
  v_cvt_pk_f16_f32 v50, v20, v21
  v_cvt_pk_f16_f32 v51, v22, v23
  v_cvt_pk_f16_f32 v52, v24, v25
  v_cvt_pk_f16_f32 v53, v26, v27
  v_cvt_pk_f16_f32 v54, v28, v29
  v_cvt_pk_f16_f32 v55, v30, v31
  v_mfma_f32_32x32x16_f16 v[96:111], v[200:203], v[184:187], v[96:111]
  ds_read_b128 v[196:199], v0 offset:44032
  v_pk_fma_f16 v56, v48, v48, s20 op_sel_hi:[1,1,0] neg_lo:[1,0,0] neg_hi:[1,0,0] clamp
  v_pk_fma_f16 v57, v49, v49, s20 op_sel_hi:[1,1,0] neg_lo:[1,0,0] neg_hi:[1,0,0] clamp
  v_pk_fma_f16 v58, v50, v50, s20 op_sel_hi:[1,1,0] neg_lo:[1,0,0] neg_hi:[1,0,0] clamp
  v_pk_fma_f16 v59, v51, v51, s20 op_sel_hi:[1,1,0] neg_lo:[1,0,0] neg_hi:[1,0,0] clamp
  v_pk_fma_f16 v184, v56, v56, s20 op_sel:[0,0,1]
  v_mfma_f32_32x32x16_f16 v[64:79], v[204:207], v[188:191], v[64:79]
  s_nop 0
  v_pk_fma_f16 v185, v57, v57, s20 op_sel:[0,0,1]
  v_pk_fma_f16 v186, v58, v58, s20 op_sel:[0,0,1]
  v_pk_fma_f16 v187, v59, v59, s20 op_sel:[0,0,1]
  v_pk_fma_f16 v184, v184, v56, s21 op_sel_hi:[1,1,0]
  v_pk_fma_f16 v185, v185, v57, s21 op_sel_hi:[1,1,0]
  v_pk_fma_f16 v186, v186, v58, s21 op_sel_hi:[1,1,0]
  v_mfma_f32_32x32x16_f16 v[80:95], v[208:211], v[188:191], v[80:95]
  s_waitcnt lgkmcnt(2)
  v_pk_fma_f16 v187, v187, v59, s21 op_sel_hi:[1,1,0]
  v_pk_fma_f16 v184, v184, v48, 0.5 op_sel_hi:[1,1,0] clamp
  v_pk_fma_f16 v185, v185, v49, 0.5 op_sel_hi:[1,1,0] clamp
  v_pk_fma_f16 v186, v186, v50, 0.5 op_sel_hi:[1,1,0] clamp
  v_pk_fma_f16 v187, v187, v51, 0.5 op_sel_hi:[1,1,0] clamp
  v_pk_mul_f16 v184, v184, v48
  v_mfma_f32_32x32x16_f16 v[96:111], v[212:215], v[188:191], v[96:111]
  ds_read_b128 v[200:203], v0 offset:45056
  ds_read_b128 v[204:207], v0 offset:46080
  ds_read_b128 v[208:211], v0 offset:47104
  v_pk_mul_f16 v185, v185, v49
  v_pk_mul_f16 v186, v186, v50
  v_pk_mul_f16 v187, v187, v51
  v_mfma_f32_32x32x16_bf16 v[16:31], a[168:171], v[216:219], 0
  v_pk_fma_f16 v56, v52, v52, s20 op_sel_hi:[1,1,0] neg_lo:[1,0,0] neg_hi:[1,0,0] clamp
  v_pk_fma_f16 v57, v53, v53, s20 op_sel_hi:[1,1,0] neg_lo:[1,0,0] neg_hi:[1,0,0] clamp
  v_pk_fma_f16 v58, v54, v54, s20 op_sel_hi:[1,1,0] neg_lo:[1,0,0] neg_hi:[1,0,0] clamp
  v_pk_fma_f16 v59, v55, v55, s20 op_sel_hi:[1,1,0] neg_lo:[1,0,0] neg_hi:[1,0,0] clamp
  v_pk_fma_f16 v188, v56, v56, s20 op_sel:[0,0,1]
  v_pk_fma_f16 v189, v57, v57, s20 op_sel:[0,0,1]
  v_mfma_f32_32x32x16_bf16 v[16:31], a[172:175], v[220:223], v[16:31]
  v_pk_fma_f16 v190, v58, v58, s20 op_sel:[0,0,1]
  v_pk_fma_f16 v191, v59, v59, s20 op_sel:[0,0,1]
  v_pk_fma_f16 v188, v188, v56, s21 op_sel_hi:[1,1,0]
  v_pk_fma_f16 v189, v189, v57, s21 op_sel_hi:[1,1,0]
  v_pk_fma_f16 v190, v190, v58, s21 op_sel_hi:[1,1,0]
  v_pk_fma_f16 v191, v191, v59, s21 op_sel_hi:[1,1,0]
  v_mfma_f32_32x32x16_bf16 v[16:31], a[176:179], v[224:227], v[16:31]
  v_pk_fma_f16 v188, v188, v52, 0.5 op_sel_hi:[1,1,0] clamp
  v_pk_fma_f16 v189, v189, v53, 0.5 op_sel_hi:[1,1,0] clamp
  v_pk_fma_f16 v190, v190, v54, 0.5 op_sel_hi:[1,1,0] clamp
  v_pk_fma_f16 v191, v191, v55, 0.5 op_sel_hi:[1,1,0] clamp
  v_pk_mul_f16 v188, v188, v52
  v_pk_mul_f16 v189, v189, v53
  v_mfma_f32_32x32x16_bf16 v[16:31], a[180:183], v[228:231], v[16:31]
  ds_read_b128 v[212:215], v0 offset:48128
  v_pk_mul_f16 v190, v190, v54
  v_pk_mul_f16 v191, v191, v55
  v_mfma_f32_32x32x16_bf16 v[16:31], a[184:187], v[232:235], v[16:31]
  v_mfma_f32_32x32x16_bf16 v[16:31], a[188:191], v[236:239], v[16:31]
  s_waitcnt lgkmcnt(1)
  s_nop 5
  s_nop 0
  v_mfma_f32_32x32x16_f16 v[64:79], v[192:195], v[184:187], v[64:79]
  ds_read_b128 v[192:195], v0 offset:49152
  s_nop 2
  v_cvt_pk_f16_f32 v48, v16, v17
  v_cvt_pk_f16_f32 v49, v18, v19
  v_mfma_f32_32x32x16_f16 v[80:95], v[196:199], v[184:187], v[80:95]
  v_cvt_pk_f16_f32 v50, v20, v21
  v_cvt_pk_f16_f32 v51, v22, v23
  v_cvt_pk_f16_f32 v52, v24, v25
  v_cvt_pk_f16_f32 v53, v26, v27
  v_cvt_pk_f16_f32 v54, v28, v29
  v_cvt_pk_f16_f32 v55, v30, v31
  v_mfma_f32_32x32x16_f16 v[96:111], v[200:203], v[184:187], v[96:111]
  ds_read_b128 v[196:199], v0 offset:50176
  v_pk_fma_f16 v56, v48, v48, s20 op_sel_hi:[1,1,0] neg_lo:[1,0,0] neg_hi:[1,0,0] clamp
  v_pk_fma_f16 v57, v49, v49, s20 op_sel_hi:[1,1,0] neg_lo:[1,0,0] neg_hi:[1,0,0] clamp
  v_pk_fma_f16 v58, v50, v50, s20 op_sel_hi:[1,1,0] neg_lo:[1,0,0] neg_hi:[1,0,0] clamp
  v_pk_fma_f16 v59, v51, v51, s20 op_sel_hi:[1,1,0] neg_lo:[1,0,0] neg_hi:[1,0,0] clamp
  v_pk_fma_f16 v184, v56, v56, s20 op_sel:[0,0,1]
  v_mfma_f32_32x32x16_f16 v[64:79], v[204:207], v[188:191], v[64:79]
  v_pk_fma_f16 v185, v57, v57, s20 op_sel:[0,0,1]
  v_pk_fma_f16 v186, v58, v58, s20 op_sel:[0,0,1]
  v_pk_fma_f16 v187, v59, v59, s20 op_sel:[0,0,1]
  v_pk_fma_f16 v184, v184, v56, s21 op_sel_hi:[1,1,0]
  v_pk_fma_f16 v185, v185, v57, s21 op_sel_hi:[1,1,0]
  v_pk_fma_f16 v186, v186, v58, s21 op_sel_hi:[1,1,0]
  v_mfma_f32_32x32x16_f16 v[80:95], v[208:211], v[188:191], v[80:95]
  s_waitcnt lgkmcnt(2)
  v_pk_fma_f16 v187, v187, v59, s21 op_sel_hi:[1,1,0]
  v_pk_fma_f16 v184, v184, v48, 0.5 op_sel_hi:[1,1,0] clamp
  v_pk_fma_f16 v185, v185, v49, 0.5 op_sel_hi:[1,1,0] clamp
  v_pk_fma_f16 v186, v186, v50, 0.5 op_sel_hi:[1,1,0] clamp
  v_pk_fma_f16 v187, v187, v51, 0.5 op_sel_hi:[1,1,0] clamp
  v_pk_mul_f16 v184, v184, v48
  v_mfma_f32_32x32x16_f16 v[96:111], v[212:215], v[188:191], v[96:111]
  s_nop 0
  ds_read_b128 v[200:203], v0 offset:51200
  ds_read_b128 v[204:207], v0 offset:52224
  ds_read_b128 v[208:211], v0 offset:53248
  v_pk_mul_f16 v185, v185, v49
  v_pk_mul_f16 v186, v186, v50
  v_pk_mul_f16 v187, v187, v51
  v_mfma_f32_32x32x16_bf16 v[16:31], a[192:195], v[216:219], 0
  v_pk_fma_f16 v56, v52, v52, s20 op_sel_hi:[1,1,0] neg_lo:[1,0,0] neg_hi:[1,0,0] clamp
  v_pk_fma_f16 v57, v53, v53, s20 op_sel_hi:[1,1,0] neg_lo:[1,0,0] neg_hi:[1,0,0] clamp
  v_pk_fma_f16 v58, v54, v54, s20 op_sel_hi:[1,1,0] neg_lo:[1,0,0] neg_hi:[1,0,0] clamp
  v_pk_fma_f16 v59, v55, v55, s20 op_sel_hi:[1,1,0] neg_lo:[1,0,0] neg_hi:[1,0,0] clamp
  v_pk_fma_f16 v188, v56, v56, s20 op_sel:[0,0,1]
  v_pk_fma_f16 v189, v57, v57, s20 op_sel:[0,0,1]
  v_mfma_f32_32x32x16_bf16 v[16:31], a[196:199], v[220:223], v[16:31]
  v_pk_fma_f16 v190, v58, v58, s20 op_sel:[0,0,1]
  v_pk_fma_f16 v191, v59, v59, s20 op_sel:[0,0,1]
  v_pk_fma_f16 v188, v188, v56, s21 op_sel_hi:[1,1,0]
  v_pk_fma_f16 v189, v189, v57, s21 op_sel_hi:[1,1,0]
  v_pk_fma_f16 v190, v190, v58, s21 op_sel_hi:[1,1,0]
  v_pk_fma_f16 v191, v191, v59, s21 op_sel_hi:[1,1,0]
  v_mfma_f32_32x32x16_bf16 v[16:31], a[200:203], v[224:227], v[16:31]
  v_pk_fma_f16 v188, v188, v52, 0.5 op_sel_hi:[1,1,0] clamp
  v_pk_fma_f16 v189, v189, v53, 0.5 op_sel_hi:[1,1,0] clamp
  v_pk_fma_f16 v190, v190, v54, 0.5 op_sel_hi:[1,1,0] clamp
  v_pk_fma_f16 v191, v191, v55, 0.5 op_sel_hi:[1,1,0] clamp
  v_pk_mul_f16 v188, v188, v52
  v_pk_mul_f16 v189, v189, v53
  v_mfma_f32_32x32x16_bf16 v[16:31], a[204:207], v[228:231], v[16:31]
  ds_read_b128 v[212:215], v0 offset:54272
  v_pk_mul_f16 v190, v190, v54
  v_pk_mul_f16 v191, v191, v55
  v_mfma_f32_32x32x16_bf16 v[16:31], a[208:211], v[232:235], v[16:31]
  s_nop 0
  v_mfma_f32_32x32x16_bf16 v[16:31], a[212:215], v[236:239], v[16:31]
  s_waitcnt lgkmcnt(1)
  s_nop 5
  s_nop 0
  v_mfma_f32_32x32x16_f16 v[64:79], v[192:195], v[184:187], v[64:79]
  s_nop 0
  ds_read_b128 v[192:195], v0 offset:55296
  s_nop 2
  v_cvt_pk_f16_f32 v48, v16, v17
  v_cvt_pk_f16_f32 v49, v18, v19
  v_mfma_f32_32x32x16_f16 v[80:95], v[196:199], v[184:187], v[80:95]
  v_cvt_pk_f16_f32 v50, v20, v21
  v_cvt_pk_f16_f32 v51, v22, v23
  v_cvt_pk_f16_f32 v52, v24, v25
  v_cvt_pk_f16_f32 v53, v26, v27
  v_cvt_pk_f16_f32 v54, v28, v29
  v_cvt_pk_f16_f32 v55, v30, v31
  v_mfma_f32_32x32x16_f16 v[96:111], v[200:203], v[184:187], v[96:111]
  ds_read_b128 v[196:199], v0 offset:56320
  v_pk_fma_f16 v56, v48, v48, s20 op_sel_hi:[1,1,0] neg_lo:[1,0,0] neg_hi:[1,0,0] clamp
  v_pk_fma_f16 v57, v49, v49, s20 op_sel_hi:[1,1,0] neg_lo:[1,0,0] neg_hi:[1,0,0] clamp
  v_pk_fma_f16 v58, v50, v50, s20 op_sel_hi:[1,1,0] neg_lo:[1,0,0] neg_hi:[1,0,0] clamp
  v_pk_fma_f16 v59, v51, v51, s20 op_sel_hi:[1,1,0] neg_lo:[1,0,0] neg_hi:[1,0,0] clamp
  v_pk_fma_f16 v184, v56, v56, s20 op_sel:[0,0,1]
  v_mfma_f32_32x32x16_f16 v[64:79], v[204:207], v[188:191], v[64:79]
  v_pk_fma_f16 v185, v57, v57, s20 op_sel:[0,0,1]
  v_pk_fma_f16 v186, v58, v58, s20 op_sel:[0,0,1]
  v_pk_fma_f16 v187, v59, v59, s20 op_sel:[0,0,1]
  v_pk_fma_f16 v184, v184, v56, s21 op_sel_hi:[1,1,0]
  v_pk_fma_f16 v185, v185, v57, s21 op_sel_hi:[1,1,0]
  v_pk_fma_f16 v186, v186, v58, s21 op_sel_hi:[1,1,0]
  v_mfma_f32_32x32x16_f16 v[80:95], v[208:211], v[188:191], v[80:95]
  s_waitcnt lgkmcnt(2)
  s_nop 0
  v_pk_fma_f16 v187, v187, v59, s21 op_sel_hi:[1,1,0]
  v_pk_fma_f16 v184, v184, v48, 0.5 op_sel_hi:[1,1,0] clamp
  v_pk_fma_f16 v185, v185, v49, 0.5 op_sel_hi:[1,1,0] clamp
  v_pk_fma_f16 v186, v186, v50, 0.5 op_sel_hi:[1,1,0] clamp
  v_pk_fma_f16 v187, v187, v51, 0.5 op_sel_hi:[1,1,0] clamp
  v_pk_mul_f16 v184, v184, v48
  v_mfma_f32_32x32x16_f16 v[96:111], v[212:215], v[188:191], v[96:111]
  ds_read_b128 v[200:203], v0 offset:57344
  ds_read_b128 v[204:207], v0 offset:58368
  ds_read_b128 v[208:211], v0 offset:59392
  v_pk_mul_f16 v185, v185, v49
  v_pk_mul_f16 v186, v186, v50
  v_pk_mul_f16 v187, v187, v51
  v_mfma_f32_32x32x16_bf16 v[16:31], a[216:219], v[216:219], 0
  v_pk_fma_f16 v56, v52, v52, s20 op_sel_hi:[1,1,0] neg_lo:[1,0,0] neg_hi:[1,0,0] clamp
  v_pk_fma_f16 v57, v53, v53, s20 op_sel_hi:[1,1,0] neg_lo:[1,0,0] neg_hi:[1,0,0] clamp
  v_pk_fma_f16 v58, v54, v54, s20 op_sel_hi:[1,1,0] neg_lo:[1,0,0] neg_hi:[1,0,0] clamp
  v_pk_fma_f16 v59, v55, v55, s20 op_sel_hi:[1,1,0] neg_lo:[1,0,0] neg_hi:[1,0,0] clamp
  v_pk_fma_f16 v188, v56, v56, s20 op_sel:[0,0,1]
  v_pk_fma_f16 v189, v57, v57, s20 op_sel:[0,0,1]
  v_mfma_f32_32x32x16_bf16 v[16:31], a[220:223], v[220:223], v[16:31]
  v_pk_fma_f16 v190, v58, v58, s20 op_sel:[0,0,1]
  v_pk_fma_f16 v191, v59, v59, s20 op_sel:[0,0,1]
  v_pk_fma_f16 v188, v188, v56, s21 op_sel_hi:[1,1,0]
  v_pk_fma_f16 v189, v189, v57, s21 op_sel_hi:[1,1,0]
  v_pk_fma_f16 v190, v190, v58, s21 op_sel_hi:[1,1,0]
  v_pk_fma_f16 v191, v191, v59, s21 op_sel_hi:[1,1,0]
  v_mfma_f32_32x32x16_bf16 v[16:31], a[224:227], v[224:227], v[16:31]
  v_pk_fma_f16 v188, v188, v52, 0.5 op_sel_hi:[1,1,0] clamp
  v_pk_fma_f16 v189, v189, v53, 0.5 op_sel_hi:[1,1,0] clamp
  v_pk_fma_f16 v190, v190, v54, 0.5 op_sel_hi:[1,1,0] clamp
  v_pk_fma_f16 v191, v191, v55, 0.5 op_sel_hi:[1,1,0] clamp
  v_pk_mul_f16 v188, v188, v52
  v_pk_mul_f16 v189, v189, v53
  v_mfma_f32_32x32x16_bf16 v[16:31], a[228:231], v[228:231], v[16:31]
  ds_read_b128 v[212:215], v0 offset:60416
  v_pk_mul_f16 v190, v190, v54
  v_pk_mul_f16 v191, v191, v55
  v_mfma_f32_32x32x16_bf16 v[16:31], a[232:235], v[232:235], v[16:31]
  v_mfma_f32_32x32x16_bf16 v[16:31], a[236:239], v[236:239], v[16:31]
  s_waitcnt lgkmcnt(1)
  s_nop 5
  s_nop 0
  v_mfma_f32_32x32x16_f16 v[64:79], v[192:195], v[184:187], v[64:79]
  ds_read_b128 v[192:195], v0 offset:61440
  s_nop 2
  v_cvt_pk_f16_f32 v48, v16, v17
  v_cvt_pk_f16_f32 v49, v18, v19
  v_mfma_f32_32x32x16_f16 v[80:95], v[196:199], v[184:187], v[80:95]
  v_cvt_pk_f16_f32 v50, v20, v21
  v_cvt_pk_f16_f32 v51, v22, v23
  v_cvt_pk_f16_f32 v52, v24, v25
  v_cvt_pk_f16_f32 v53, v26, v27
  v_cvt_pk_f16_f32 v54, v28, v29
  v_cvt_pk_f16_f32 v55, v30, v31
  v_mfma_f32_32x32x16_f16 v[96:111], v[200:203], v[184:187], v[96:111]
  ds_read_b128 v[196:199], v0 offset:62464
  v_pk_fma_f16 v56, v48, v48, s20 op_sel_hi:[1,1,0] neg_lo:[1,0,0] neg_hi:[1,0,0] clamp
  v_pk_fma_f16 v57, v49, v49, s20 op_sel_hi:[1,1,0] neg_lo:[1,0,0] neg_hi:[1,0,0] clamp
  v_pk_fma_f16 v58, v50, v50, s20 op_sel_hi:[1,1,0] neg_lo:[1,0,0] neg_hi:[1,0,0] clamp
  v_pk_fma_f16 v59, v51, v51, s20 op_sel_hi:[1,1,0] neg_lo:[1,0,0] neg_hi:[1,0,0] clamp
  v_pk_fma_f16 v184, v56, v56, s20 op_sel:[0,0,1]
  v_mfma_f32_32x32x16_f16 v[64:79], v[204:207], v[188:191], v[64:79]
  s_nop 0
  v_pk_fma_f16 v185, v57, v57, s20 op_sel:[0,0,1]
  v_pk_fma_f16 v186, v58, v58, s20 op_sel:[0,0,1]
  v_pk_fma_f16 v187, v59, v59, s20 op_sel:[0,0,1]
  v_pk_fma_f16 v184, v184, v56, s21 op_sel_hi:[1,1,0]
  v_pk_fma_f16 v185, v185, v57, s21 op_sel_hi:[1,1,0]
  v_pk_fma_f16 v186, v186, v58, s21 op_sel_hi:[1,1,0]
  v_mfma_f32_32x32x16_f16 v[80:95], v[208:211], v[188:191], v[80:95]
  s_waitcnt lgkmcnt(2)
  v_pk_fma_f16 v187, v187, v59, s21 op_sel_hi:[1,1,0]
  v_pk_fma_f16 v184, v184, v48, 0.5 op_sel_hi:[1,1,0] clamp
  v_pk_fma_f16 v185, v185, v49, 0.5 op_sel_hi:[1,1,0] clamp
  v_pk_fma_f16 v186, v186, v50, 0.5 op_sel_hi:[1,1,0] clamp
  v_pk_fma_f16 v187, v187, v51, 0.5 op_sel_hi:[1,1,0] clamp
  v_pk_mul_f16 v184, v184, v48
  v_mfma_f32_32x32x16_f16 v[96:111], v[212:215], v[188:191], v[96:111]
  ds_read_b128 v[200:203], v0 offset:63488
  ds_read_b128 v[204:207], v0 offset:64512
  ds_read_b128 v[208:211], v1
  v_pk_mul_f16 v185, v185, v49
  v_pk_mul_f16 v186, v186, v50
  v_pk_mul_f16 v187, v187, v51
  v_mfma_f32_32x32x16_bf16 v[16:31], v[32:35], v[216:219], 0
  v_pk_fma_f16 v56, v52, v52, s20 op_sel_hi:[1,1,0] neg_lo:[1,0,0] neg_hi:[1,0,0] clamp
  v_pk_fma_f16 v57, v53, v53, s20 op_sel_hi:[1,1,0] neg_lo:[1,0,0] neg_hi:[1,0,0] clamp
  v_pk_fma_f16 v58, v54, v54, s20 op_sel_hi:[1,1,0] neg_lo:[1,0,0] neg_hi:[1,0,0] clamp
  v_pk_fma_f16 v59, v55, v55, s20 op_sel_hi:[1,1,0] neg_lo:[1,0,0] neg_hi:[1,0,0] clamp
  v_pk_fma_f16 v188, v56, v56, s20 op_sel:[0,0,1]
  v_pk_fma_f16 v189, v57, v57, s20 op_sel:[0,0,1]
  v_mfma_f32_32x32x16_bf16 v[16:31], v[36:39], v[220:223], v[16:31]
  v_pk_fma_f16 v190, v58, v58, s20 op_sel:[0,0,1]
  v_pk_fma_f16 v191, v59, v59, s20 op_sel:[0,0,1]
  v_pk_fma_f16 v188, v188, v56, s21 op_sel_hi:[1,1,0]
  v_pk_fma_f16 v189, v189, v57, s21 op_sel_hi:[1,1,0]
  v_pk_fma_f16 v190, v190, v58, s21 op_sel_hi:[1,1,0]
  v_pk_fma_f16 v191, v191, v59, s21 op_sel_hi:[1,1,0]
  v_mfma_f32_32x32x16_bf16 v[16:31], v[40:43], v[224:227], v[16:31]
  v_pk_fma_f16 v188, v188, v52, 0.5 op_sel_hi:[1,1,0] clamp
  v_pk_fma_f16 v189, v189, v53, 0.5 op_sel_hi:[1,1,0] clamp
  v_pk_fma_f16 v190, v190, v54, 0.5 op_sel_hi:[1,1,0] clamp
  v_pk_fma_f16 v191, v191, v55, 0.5 op_sel_hi:[1,1,0] clamp
  v_pk_mul_f16 v188, v188, v52
  v_pk_mul_f16 v189, v189, v53
  v_mfma_f32_32x32x16_bf16 v[16:31], v[44:47], v[228:231], v[16:31]
  ds_read_b128 v[212:215], v1 offset:1024
  v_pk_mul_f16 v190, v190, v54
  v_pk_mul_f16 v191, v191, v55
  v_mfma_f32_32x32x16_bf16 v[16:31], v[60:63], v[232:235], v[16:31]
  v_mfma_f32_32x32x16_bf16 v[16:31], v[244:247], v[236:239], v[16:31]
  s_waitcnt lgkmcnt(1)
  s_nop 5
  s_nop 0
  v_mfma_f32_32x32x16_f16 v[64:79], v[192:195], v[184:187], v[64:79]
  ds_read_b128 v[192:195], v1 offset:2048
  s_nop 2
  v_cvt_pk_f16_f32 v48, v16, v17
  v_cvt_pk_f16_f32 v49, v18, v19
  v_mfma_f32_32x32x16_f16 v[80:95], v[196:199], v[184:187], v[80:95]
  ds_read_b128 v[196:199], v1 offset:3072
  v_cvt_pk_f16_f32 v50, v20, v21
  v_cvt_pk_f16_f32 v51, v22, v23
  v_cvt_pk_f16_f32 v52, v24, v25
  v_cvt_pk_f16_f32 v53, v26, v27
  v_cvt_pk_f16_f32 v54, v28, v29
  v_mfma_f32_32x32x16_f16 v[96:111], v[200:203], v[184:187], v[96:111]
  v_cvt_pk_f16_f32 v55, v30, v31
  v_pk_fma_f16 v56, v48, v48, s20 op_sel_hi:[1,1,0] neg_lo:[1,0,0] neg_hi:[1,0,0] clamp
  v_pk_fma_f16 v57, v49, v49, s20 op_sel_hi:[1,1,0] neg_lo:[1,0,0] neg_hi:[1,0,0] clamp
  v_pk_fma_f16 v58, v50, v50, s20 op_sel_hi:[1,1,0] neg_lo:[1,0,0] neg_hi:[1,0,0] clamp
  v_pk_fma_f16 v59, v51, v51, s20 op_sel_hi:[1,1,0] neg_lo:[1,0,0] neg_hi:[1,0,0] clamp
  v_pk_fma_f16 v184, v56, v56, s20 op_sel:[0,0,1]
  v_mfma_f32_32x32x16_f16 v[64:79], v[204:207], v[188:191], v[64:79]
  v_pk_fma_f16 v185, v57, v57, s20 op_sel:[0,0,1]
  v_pk_fma_f16 v186, v58, v58, s20 op_sel:[0,0,1]
  v_pk_fma_f16 v187, v59, v59, s20 op_sel:[0,0,1]
  v_pk_fma_f16 v184, v184, v56, s21 op_sel_hi:[1,1,0]
  v_pk_fma_f16 v185, v185, v57, s21 op_sel_hi:[1,1,0]
  v_pk_fma_f16 v186, v186, v58, s21 op_sel_hi:[1,1,0]
  v_mfma_f32_32x32x16_f16 v[80:95], v[208:211], v[188:191], v[80:95]
  s_waitcnt lgkmcnt(2)
  s_nop 0
  ds_read_b128 v[200:203], v1 offset:4096
  v_pk_fma_f16 v187, v187, v59, s21 op_sel_hi:[1,1,0]
  v_pk_fma_f16 v184, v184, v48, 0.5 op_sel_hi:[1,1,0] clamp
  v_pk_fma_f16 v185, v185, v49, 0.5 op_sel_hi:[1,1,0] clamp
  v_pk_fma_f16 v186, v186, v50, 0.5 op_sel_hi:[1,1,0] clamp
  v_pk_fma_f16 v187, v187, v51, 0.5 op_sel_hi:[1,1,0] clamp
  v_pk_mul_f16 v184, v184, v48
  v_pk_mul_f16 v185, v185, v49
  v_pk_mul_f16 v186, v186, v50
  v_pk_mul_f16 v187, v187, v51
  v_mfma_f32_32x32x16_f16 v[96:111], v[212:215], v[188:191], v[96:111]
  s_waitcnt lgkmcnt(2)
  ds_read_b128 v[204:207], v1 offset:5120
  ds_read_b128 v[208:211], v1 offset:6144
  v_pk_fma_f16 v56, v52, v52, s20 op_sel_hi:[1,1,0] neg_lo:[1,0,0] neg_hi:[1,0,0] clamp
  v_pk_fma_f16 v57, v53, v53, s20 op_sel_hi:[1,1,0] neg_lo:[1,0,0] neg_hi:[1,0,0] clamp
  v_pk_fma_f16 v58, v54, v54, s20 op_sel_hi:[1,1,0] neg_lo:[1,0,0] neg_hi:[1,0,0] clamp
  v_pk_fma_f16 v59, v55, v55, s20 op_sel_hi:[1,1,0] neg_lo:[1,0,0] neg_hi:[1,0,0] clamp
  v_mfma_f32_32x32x16_f16 v[64:79], v[192:195], v[184:187], v[64:79]
  s_waitcnt lgkmcnt(3)
  v_pk_fma_f16 v188, v56, v56, s20 op_sel:[0,0,1]
  v_pk_fma_f16 v189, v57, v57, s20 op_sel:[0,0,1]
  v_pk_fma_f16 v190, v58, v58, s20 op_sel:[0,0,1]
  v_pk_fma_f16 v191, v59, v59, s20 op_sel:[0,0,1]
  v_pk_fma_f16 v188, v188, v56, s21 op_sel_hi:[1,1,0]
  v_pk_fma_f16 v189, v189, v57, s21 op_sel_hi:[1,1,0]
  v_mfma_f32_32x32x16_f16 v[80:95], v[196:199], v[184:187], v[80:95]
  s_nop 0
  s_waitcnt lgkmcnt(2)
  ds_read_b128 v[212:215], v1 offset:7168
  v_pk_fma_f16 v190, v190, v58, s21 op_sel_hi:[1,1,0]
  v_pk_fma_f16 v191, v191, v59, s21 op_sel_hi:[1,1,0]
  v_pk_fma_f16 v188, v188, v52, 0.5 op_sel_hi:[1,1,0] clamp
  v_pk_fma_f16 v189, v189, v53, 0.5 op_sel_hi:[1,1,0] clamp
  v_pk_fma_f16 v190, v190, v54, 0.5 op_sel_hi:[1,1,0] clamp
  v_pk_fma_f16 v191, v191, v55, 0.5 op_sel_hi:[1,1,0] clamp
  v_pk_mul_f16 v188, v188, v52
  v_pk_mul_f16 v189, v189, v53
  v_pk_mul_f16 v190, v190, v54
  v_pk_mul_f16 v191, v191, v55
  v_mfma_f32_32x32x16_f16 v[96:111], v[200:203], v[184:187], v[96:111]
  s_waitcnt lgkmcnt(2)
  v_mfma_f32_32x32x16_f16 v[64:79], v[204:207], v[188:191], v[64:79]
  s_waitcnt lgkmcnt(1)
  s_nop 0
  v_mfma_f32_32x32x16_f16 v[80:95], v[208:211], v[188:191], v[80:95]
  s_waitcnt lgkmcnt(0)
  s_nop 5
  s_nop 0
  v_mfma_f32_32x32x16_f16 v[96:111], v[212:215], v[188:191], v[96:111]
  v_cvt_pk_bf16_f32 v112, v64, v65
  v_cvt_pk_bf16_f32 v113, v66, v67
  v_cvt_pk_bf16_f32 v114, v68, v69
  v_cvt_pk_bf16_f32 v115, v70, v71
  v_cvt_pk_bf16_f32 v116, v72, v73
  v_cvt_pk_bf16_f32 v117, v74, v75
  v_cvt_pk_bf16_f32 v118, v76, v77
  v_cvt_pk_bf16_f32 v119, v78, v79
  v_cvt_pk_bf16_f32 v120, v80, v81
  v_cvt_pk_bf16_f32 v121, v82, v83
  v_cvt_pk_bf16_f32 v122, v84, v85
  v_cvt_pk_bf16_f32 v123, v86, v87
  buffer_store_dwordx4 v[112:115], v10, s[8:11], s28 offen
  v_cvt_pk_bf16_f32 v124, v88, v89
  v_cvt_pk_bf16_f32 v125, v90, v91
  v_cvt_pk_bf16_f32 v126, v92, v93
  v_cvt_pk_bf16_f32 v127, v94, v95
  buffer_store_dwordx4 v[116:119], v10, s[8:11], s28 offen offset:32
  v_cvt_pk_bf16_f32 v128, v96, v97
  v_cvt_pk_bf16_f32 v129, v98, v99
  v_cvt_pk_bf16_f32 v130, v100, v101
  v_cvt_pk_bf16_f32 v131, v102, v103
  buffer_store_dwordx4 v[120:123], v10, s[8:11], s28 offen offset:64
  v_cvt_pk_bf16_f32 v132, v104, v105
  v_cvt_pk_bf16_f32 v133, v106, v107
  v_cvt_pk_bf16_f32 v134, v108, v109
  v_cvt_pk_bf16_f32 v135, v110, v111
  buffer_store_dwordx4 v[124:127], v10, s[8:11], s28 offen offset:96
  buffer_store_dwordx4 v[128:131], v10, s[8:11], s28 offen offset:128
  buffer_store_dwordx4 v[132:135], v10, s[8:11], s28 offen offset:160
L_end:
  s_endpgm
L_slow:
  s_waitcnt vmcnt(0) lgkmcnt(0)
  s_nop 15
  s_nop 15
  s_barrier
  v_mbcnt_lo_u32_b32 v0, -1, 0
  v_mbcnt_hi_u32_b32 v0, -1, v0
  v_lshl_add_u32 v0, s27, 6, v0
  s_nop 4
  .p2align 7
  s_cmp_ge_u32 s2, 0x100
  s_cbranch_scc1 S_end
  s_nop 0
  s_load_dwordx2 s[4:5], s[0:1], 0
  s_load_dwordx2 s[60:61], s[0:1], 8
  s_load_dwordx2 s[64:65], s[0:1], 16
  s_load_dwordx2 s[68:69], s[0:1], 24
  s_load_dwordx2 s[72:73], s[0:1], 32
  s_load_dwordx2 s[76:77], s[0:1], 40
  s_load_dwordx2 s[80:81], s[0:1], 48
  s_load_dwordx2 s[8:9], s[0:1], 56
  s_getpc_b64 s[40:41]
S_pc:
  s_lshl_b32 s32, s2, 9
  s_and_b32 s32, s32, 0xf000
  v_lshl_add_u32 v249, v0, 4, s32
  v_lshrrev_b32_e64 v112, 6, v0
  v_min_u32 v249, S_end-S_pc-12, v249
  v_and_b32 v113, 63, v0
  global_load_dwordx4 v[108:111], v249, s[40:41]
  v_readfirstlane_b32 s27, v112
  s_mov_b32 s62, 0x6c0
  s_mov_b32 s63, 0x20000
  s_mov_b32 s82, 0xc0
  s_mov_b32 s83, 0x20000
  s_mov_b32 s78, 0xc0
  s_mov_b32 s79, 0x20000
  s_mov_b32 s66, 0x12000
  s_mov_b32 s67, 0x20000
  s_mov_b32 s74, 0x12000
  s_mov_b32 s75, 0x20000
  v_bfe_u32 v114, v113, 3, 1
  v_bfe_u32 v115, v113, 4, 1
  v_bfe_u32 v116, v113, 2, 1
  v_and_b32 v117, 3, v113
  v_lshlrev_b32 v118, 4, v113
  s_min_u32 s44, s27, 2
  s_lshl_b32 s45, s44, 6
  s_mul_i32 s46, s44, 0x240
  v_lshlrev_b32 v119, 1, v113
  v_and_b32 v120, 31, v113
  v_lshlrev_b32_e64 v121, 1, v120
  v_lshlrev_b32_e64 v122, 4, v115
  v_lshl_add_u32 v122, v116, 3, v122
  v_lshl_add_u32 v122, v114, 2, v122
  v_add_u32_e64 v122, v122, v117
  v_lshlrev_b32_e64 v123, 1, v122
  s_lshr_b32 s35, s2, 3
  s_lshl_b32 s35, s35, 2
  s_add_u32 s35, s35, s27
  s_sub_u32 s55, s35, 0x48
  s_min_u32 s35, s35, s55
  s_lshl_b32 s47, s35, 10
  s_and_b32 s54, s2, 6
  s_lshl_b32 s54, s54, 1
  s_lshr_b32 s32, s2, 6
  s_add_u32 s54, s54, s32
  s_mul_i32 s59, s54, 0x300000
  s_and_b32 s53, s2, 1
  s_lshl_b32 s53, s53, 8
  s_and_b32 s32, s2, 56
  s_lshl_b32 s32, s32, 2
  s_add_u32 s53, s53, s32
  s_lshl_b32 s32, s27, 3
  s_add_u32 s53, s53, s32
  s_mul_i32 s3, s53, 0xc0
  s_add_u32 s3, s3, 0xf40
  s_mov_b32 s6, 0x3000000
  s_mov_b32 s7, 0x20000
  s_cmp_eq_u32 s53, 0
  s_cselect_b32 s35, 12, 0
  s_sub_u32 s55, 0x78, s35
  s_cmp_eq_u32 s53, 0x1f8
  s_cselect_b32 s55, 0x6c, s55
  s_mul_i32 s15, s27, 0x1040
  s_add_u32 s48, s59, 0x17000
  s_add_u32 s49, s59, 0x47000
  s_waitcnt lgkmcnt(0)
  v_add_u32 v124, 64, v113
  buffer_load_dwordx4 v[108:111], v118, s[64:67], s47 offen
  v_subrev_u32 v127, 57, v113
  v_cmp_le_u32 vcc, 57, v113
  buffer_load_dwordx4 v[108:111], v118, s[72:75], s47 offen
  v_add_u32_e64 v125, 7, v113
  v_add_u32 v126, 0x47, v113
  buffer_load_ushort v129, v119, s[60:63], s46 offen
  v_mov_b32 v199, 0x17c00
  v_cndmask_b32_e64 v124, v124, v127, vcc
  buffer_load_ushort v130, v119, s[60:63], s46 offen offset:128
  v_mov_b32 v127, 0xfffffc00
  v_cndmask_b32_e64 v199, v127, v199, vcc
  v_add_u32_e64 v198, s3, v118
  buffer_load_ushort v131, v119, s[60:63], s46 offen offset:256
  v_lshl_add_u32 v199, v124, 4, v199
  v_add_u32_e64 v199, s3, v199
  buffer_load_ushort v132, v119, s[60:63], s46 offen offset:384
  v_add_u32 v200, 0x17870, v198
  v_add_u32 v201, 0x17870, v198
  buffer_load_ushort v133, v121, s[60:63], s46 offen offset:512
  v_mov_b32 v128, 0x80000000
  v_subrev_u32_e64 v6, s35, v113
  buffer_load_ushort v137, v123, s[80:83], s45 offen
  v_cmp_gt_u32 s[36:37], s55, v6
  v_subrev_u32_e64 v7, s35, v124
  v_cmp_gt_u32 s[38:39], s55, v7
  buffer_load_ushort v138, v123, s[76:79], s45 offen
  v_subrev_u32_e64 v8, s35, v125
  v_cmp_gt_u32 s[40:41], s55, v8
  buffer_load_ushort v134, v123, s[80:83], 0 offen
  v_subrev_u32_e64 v9, s35, v126
  v_cmp_gt_u32 s[42:43], s55, v9
  buffer_load_ushort v135, v123, s[80:83], 0 offen offset:64
  v_cndmask_b32 v6, v128, v198, s[36:37]
  v_cndmask_b32 v7, v128, v199, s[38:39]
  buffer_load_ushort v136, v123, s[80:83], 0 offen offset:128
  v_cndmask_b32 v8, v128, v200, s[40:41]
  v_cndmask_b32 v9, v128, v201, s[42:43]
  s_add_u32 m0, s15, 0x4120
  s_nop 0
  buffer_load_dwordx4 v6, s[4:7], s48 offen lds
  buffer_load_dwordx4 v7, s[4:7], s48 offen offset:1024 lds
  buffer_load_dwordx4 v8, s[4:7], s48 offen offset:2048 lds
  buffer_load_dwordx4 v9, s[4:7], s48 offen offset:3072 lds
  s_sub_u32 s56, s59, 0x19000
  v_add_u32 v198, s56, v6
  s_add_u32 s56, s56, 0x400
  v_add_u32_e64 v199, s56, v7
  s_add_u32 s56, s56, 0x400
  v_add_u32_e64 v200, s56, v8
  s_add_u32 s56, s56, 0x400
  v_add_u32 v201, s56, v9
  v_lshrrev_b32 v139, 5, v113
  v_lshlrev_b32_e64 v202, 4, v117
  v_lshl_add_u32 v202, v139, 6, v202
  v_bfe_u32 v124, v113, 3, 2
  v_lshl_add_u32 v124, v116, 2, v124
  v_cmp_eq_u32 vcc, 7, v124
  v_mul_u32_u24 v203, 0x300, v124
  v_add_u32 v203, v203, v202
  v_cndmask_b32_e64 v204, v128, v202, vcc
  s_mov_b32 s70, 0x300
  s_mov_b32 s71, 0x20000
  s_mov_b32 s10, 0x3000000
  s_mov_b32 s11, 0x20000
  s_and_b32 s36, s27, 2
  s_add_u32 s37, s27, 1
  s_lshr_b32 s37, s37, 1
  s_and_b32 s38, s37, 1
  s_cmp_eq_u32 s27, 1
  s_cselect_b32 s39, 0, 3
  s_cselect_b32 s51, 0x1000, 0
  s_lshl_b32 s32, s36, 8
  s_lshl_b32 s33, s37, 8
  s_add_u32 s43, s32, 0x11d00
  s_add_u32 s50, s33, 0x11d00
  s_add_u32 s51, s51, s33
  s_mul_i32 s40, s38, 0x6000
  s_add_u32 s40, s40, s32
  s_mul_i32 s41, s38, 0x1800
  s_add_u32 s41, s41, s32
  s_add_u32 s41, s41, 0x3000
  s_mul_i32 s42, s39, 0x3000
  s_add_u32 s42, s42, s33
  s_mul_i32 s32, s36, 0x6000
  s_lshl_b32 s33, s38, 11
  s_add_u32 s33, s33, s32
  s_add_u32 s33, s33, 0x10000
  v_add_u32_e64 v195, s33, v118
  s_lshl_b32 s33, s38, 3
  s_add_u32 s33, s33, s32
  s_add_u32 s33, s33, 0x10400
  v_add_u32_e64 v196, s33, v118
  s_mul_i32 s32, s37, 0x6000
  s_lshl_b32 s33, s39, 10
  s_add_u32 s33, s33, s32
  s_add_u32 s33, s33, 0x10000
  v_add_u32 v197, s33, v118
  v_add_u32 v125, 16, v113
  v_lshrrev_b32_e64 v125, 6, v125
  buffer_load_dwordx4 a[72:75], v202, s[64:67], s43 offen
  v_lshlrev_b32 v125, 4, v125
  v_xor_b32 v254, v125, v118
  v_lshl_add_u32 v125, v139, 4, 16
  v_xor_b32_e64 v255, v125, v118
  v_mul_u32_u24 v125, 0x1200, v139
  v_add_u32_e64 v255, v125, v255
  v_add_u32 v125, 0xb0, v113
  v_lshrrev_b32 v125, 6, v125
  v_lshlrev_b32 v125, 4, v125
  v_xor_b32_e64 v194, v125, v118
  v_add_u32 v194, 0x1200, v194
  s_mul_i32 s14, s27, 0x1800
  s_add_u32 s32, s27, 3
  s_and_b32 s32, s32, 3
  s_mul_i32 s32, s32, 0x600
  s_cmp_eq_u32 s27, 0
  s_cselect_b32 s57, 0, 3
  s_cselect_b32 s53, 3, 6
  s_cselect_b32 s55, 6, 0
  s_lshl_b32 s57, s57, 13
  s_add_u32 s57, s57, s32
  s_add_u32 s58, s57, 0x3000
  s_lshl_b32 s53, s53, 13
  s_add_u32 s53, s53, s32
  s_add_u32 s54, s53, 0x3000
  s_lshl_b32 s55, s55, 13
  s_add_u32 s55, s55, s32
  s_add_u32 s56, s55, 0x3000
  v_and_b32_e64 v145, 7, v113
  buffer_load_dwordx4 a[76:79], v202, s[64:67], s43 offen offset:128
  v_lshrrev_b32 v146, 4, v113
  v_lshlrev_b32 v147, 4, v139
  v_and_b32 v141, 1, v113
  v_lshlrev_b32 v141, 4, v141
  v_mov_b32 v127, 0xffff
  v_lshlrev_b32_e64 v127, v141, v127
  v_bfe_u32 v125, v113, 1, 2
  buffer_load_dwordx4 a[80:83], v202, s[64:67], s50 offen
  v_lshlrev_b32 v125, v125, 1
  v_bfe_i32 v56, v125, 0, 1
  v_mov_b32 v60, 0
  v_and_b32 v56, v56, v127
  v_bfe_i32 v57, v125, 1, 1
  v_mov_b32 v61, 0
  v_and_b32 v57, v57, v127
  v_bfe_i32 v58, v125, 2, 1
  v_mov_b32 v62, 0
  v_and_b32 v58, v58, v127
  v_bfe_i32 v59, v125, 3, 1
  v_mov_b32 v63, 0
  v_and_b32 v59, v59, v127
  v_min_u32_e64 v125, 35, v113
  v_mul_u32_u24 v125, 0x190, v125
  ds_write_b128 v125, v[60:63] offset:50304
  s_lshl_b32 s32, s44, 7
  v_lshrrev_b32 v142, 3, v113
  buffer_load_dwordx4 a[84:87], v202, s[64:67], s50 offen offset:128
  v_mul_u32_u24 v142, 0x190, v142
  v_lshl_add_u32 v142, v145, 4, v142
  v_add_u32 v142, s32, v142
  v_lshrrev_b32 v143, 3, v120
  v_mul_u32_u24 v143, 0x190, v143
  v_lshl_add_u32 v143, v145, 4, v143
  v_add_u32_e64 v143, s32, v143
  v_lshl_add_u32 v144, v120, 2, s32
  v_sub_u32_e64 v125, v146, v116
  v_lshl_add_u32 v126, v114, 2, v117
  v_lshl_add_u32 v126, v125, 3, v126
  v_min_u32 v126, 24, v126
  v_lshlrev_b32 v126, 4, v126
  v_add_u32 v3, 0xc300, v126
  v_lshlrev_b32_e64 v148, 2, v115
  v_lshl_add_u32 v148, v114, 1, v148
  v_bfe_u32 v126, v113, 1, 1
  buffer_load_dwordx4 a[88:91], v204, s[68:71], s51 offen
  v_add_u32 v148, v148, v126
  v_xor_b32 v126, v116, v139
  v_lshl_add_u32 v148, v126, 3, v148
  v_lshlrev_b32 v148, v148, 1
  v_mov_b32 v126, 0x3f80
  v_lshlrev_b32_e64 v126, v141, v126
  v_mov_b32 v125, 0xbf80
  v_lshlrev_b32_e64 v125, v141, v125
  v_bfe_i32 v160, v148, 0, 1
  v_and_b32 v240, v160, v126
  v_and_b32 v184, v160, v125
  v_bfe_i32 v161, v148, 1, 1
  v_and_b32 v241, v161, v126
  v_and_b32 v185, v161, v125
  v_bfe_i32 v162, v148, 2, 1
  v_and_b32 v242, v162, v126
  v_and_b32 v186, v162, v125
  v_bfe_i32 v163, v148, 3, 1
  buffer_load_dwordx4 a[92:95], v204, s[68:71], s51 offen offset:128
  v_and_b32 v243, v163, v126
  v_and_b32 v187, v163, v125
  v_bfe_i32 v164, v148, 4, 1
  v_and_b32 v244, v164, v126
  v_and_b32 v188, v164, v125
  v_bfe_i32 v165, v148, 5, 1
  v_and_b32 v245, v165, v126
  v_and_b32 v189, v165, v125
  v_bfe_i32 v166, v148, 6, 1
  v_and_b32 v246, v166, v126
  v_and_b32 v190, v166, v125
  v_bfe_i32 v167, v148, 7, 1
  v_and_b32 v247, v167, v126
  v_and_b32 v191, v167, v125
  s_mov_b32 s22, 0x3eeff558
  s_mov_b32 s24, 0x3c2aaaab
  s_mov_b32 s25, 0x3727c5ac
  s_mov_b32 s20, 0x409d30fc
  s_mov_b32 s21, 0x409d30fc
  s_mov_b32 s23, 0x3eeff558
  s_mov_b32 s12, 0
  s_mov_b32 s13, -1
  s_add_u32 s29, s59, 0x77000
  s_add_u32 s52, s59, 0xa7000
  v_mul_u32_u24 v149, 0xc0, v145
  buffer_load_dwordx4 a[0:3], v203, s[64:67], s40 offen
  v_add_u32_e64 v127, s15, v149
  v_lshl_add_u32 v150, v114, 1, v146
  v_lshrrev_b32_e64 v125, 1, v150
  v_mul_u32_u24 v140, 0x4100, v125
  v_and_b32_e64 v125, 1, v125
  v_lshl_add_u32 v140, v125, 5, v140
  v_and_b32_e64 v125, 1, v150
  v_mul_u32_u24 v125, 0x790, v125
  v_add3_u32 v4, v140, v125, v127
  v_lshl_add_u32 v151, v114, 1, v115
  buffer_load_dwordx4 a[4:7], v203, s[64:67], s40 offen offset:128
  s_add_u32 s40, s40, 0x1800
  v_add_u32_e64 v150, 1, v151
  v_add_u32 v127, 0xc0, v127
  v_add_u32_e64 v127, v127, v147
  v_lshrrev_b32_e64 v125, 1, v150
  v_mul_u32_u24 v140, 0x4100, v125
  v_and_b32_e64 v125, 1, v125
  v_lshl_add_u32 v140, v125, 5, v140
  v_and_b32_e64 v125, 1, v150
  v_mul_u32_u24 v125, 0x790, v125
  v_add3_u32 v5, v140, v125, v127
  v_mul_u32_u24 v125, 0x18000, v151
  v_add3_u32 v10, v125, v147, v149
  s_sub_u32 s32, s3, 0xf40
  v_add_u32_e64 v10, s32, v10
  v_add_u32 v2, 0xfb40, v147
  v_add_u32 v0, 0x10000, v118
  v_add_u32 v1, 0x20000, v118
  v_and_b32_e64 v125, 15, v113
  buffer_load_dwordx4 a[8:11], v203, s[64:67], s40 offen
  v_lshlrev_b32 v125, 7, v125
  v_mul_u32_u24 v126, 0x18000, v146
  s_sub_u32 s32, s3, 64
  v_add3_u32 v248, v125, v126, s32
  v_mov_b32 v250, 0x3ef00000
  s_add_u32 s32, s14, 0x16000
  v_add_u32_e64 v253, s32, v118
  v_bfe_u32 v125, v122, 2, 2
  v_xor_b32_e64 v125, v125, v139
  v_lshl_add_u32 v125, v125, 4, s32
  v_mul_u32_u24 v126, 0xc0, v122
  v_add_u32_e64 v251, v125, v126
  v_xor_b32_e64 v252, 32, v251
  s_add_u32 s30, s15, 32
  s_add_u32 s31, s15, 0x4100
  s_mov_b32 s34, s59
  s_mov_b32 s28, 0x80000000
  s_add_u32 s33, s15, 0x8200
  buffer_load_dwordx4 a[12:15], v203, s[64:67], s40 offen offset:128
  buffer_load_dwordx4 a[16:19], v203, s[64:67], s41 offen
  buffer_load_dwordx4 a[20:23], v203, s[64:67], s41 offen offset:128
  s_waitcnt vmcnt(25)
  v_lshl_or_b32 v129, v129, 16, v129
  v_and_b32 v16, v56, v129
  v_and_b32 v17, v57, v129
  v_and_b32 v18, v58, v129
  v_and_b32_e64 v19, v59, v129
  ds_write_b128 v142, v[16:19] offset:49920
  s_waitcnt vmcnt(24)
  v_lshl_or_b32 v130, v130, 16, v130
  v_and_b32 v20, v56, v130
  v_and_b32 v21, v57, v130
  v_and_b32 v22, v58, v130
  v_and_b32 v23, v59, v130
  ds_write_b128 v142, v[20:23] offset:53120
  s_waitcnt vmcnt(23)
  v_lshl_or_b32 v131, v131, 16, v131
  v_and_b32 v24, v56, v131
  v_and_b32 v25, v57, v131
  v_and_b32 v26, v58, v131
  v_and_b32 v27, v59, v131
  ds_write_b128 v142, v[24:27] offset:56320
  s_waitcnt vmcnt(22)
  v_lshl_or_b32 v132, v132, 16, v132
  v_and_b32 v28, v56, v132
  v_and_b32 v29, v57, v132
  v_and_b32 v30, v58, v132
  v_and_b32 v31, v59, v132
  ds_write_b128 v142, v[28:31] offset:59520
  s_waitcnt vmcnt(21)
  v_lshl_or_b32 v133, v133, 16, v133
  v_and_b32 v16, v56, v133
  v_and_b32 v17, v57, v133
  v_and_b32 v18, v58, v133
  v_and_b32 v19, v59, v133
  ds_write_b128 v143, v[16:19] offset:62720
  s_waitcnt vmcnt(20)
  v_lshlrev_b32 v137, 16, v137
  s_waitcnt vmcnt(19)
  v_lshlrev_b32 v138, 16, v138
  v_mul_f32 v138, v137, v138
  s_waitcnt vmcnt(18)
  v_lshlrev_b32 v134, v141, v134
  s_waitcnt vmcnt(17)
  v_lshlrev_b32 v135, v141, v135
  s_waitcnt vmcnt(16)
  v_lshlrev_b32_e64 v136, v141, v136
  ds_write_b32 v144, v138 offset:64320
  s_waitcnt lgkmcnt(0)
  s_barrier
  ds_read_b128 a[96:99], v3
  ds_read_b128 a[100:103], v3 offset:4800
  ds_read_b128 a[104:107], v3 offset:9600
  ds_read_b128 a[108:111], v3 offset:400
  ds_read_b128 a[112:115], v3 offset:5200
  ds_read_b128 a[116:119], v3 offset:10000
  v_and_b32 v125, v160, v134
  v_and_b32 v126, v161, v134
  v_and_b32_e64 v127, v162, v134
  buffer_load_dwordx4 a[24:27], v203, s[64:67], s42 offen
  v_and_b32_e64 v140, v163, v134
  v_accvgpr_write_b32 a192, v125
  v_accvgpr_write_b32 a193, v126
  v_accvgpr_write_b32 a194, v127
  v_accvgpr_write_b32 a195, v140
  ds_read_b128 a[120:123], v3 offset:800
  ds_read_b128 a[124:127], v3 offset:5600
  ds_read_b128 a[128:131], v3 offset:10400
  ds_read_b128 a[132:135], v3 offset:1200
  ds_read_b128 a[136:139], v3 offset:6000
  ds_read_b128 a[140:143], v3 offset:10800
  buffer_load_dwordx4 a[28:31], v203, s[64:67], s42 offen offset:128
  s_add_u32 s42, s42, 0x1800
  v_and_b32 v125, v164, v134
  v_and_b32 v126, v165, v134
  v_and_b32 v127, v166, v134
  v_and_b32 v140, v167, v134
  v_accvgpr_write_b32 a196, v125
  v_accvgpr_write_b32 a197, v126
  v_accvgpr_write_b32 a198, v127
  v_accvgpr_write_b32 a199, v140
  ds_read_b128 a[144:147], v3 offset:1600
  ds_read_b128 a[148:151], v3 offset:6400
  buffer_load_dwordx4 a[32:35], v203, s[64:67], s42 offen
  ds_read_b128 a[152:155], v3 offset:11200
  ds_read_b128 a[156:159], v3 offset:2000
  ds_read_b128 a[160:163], v3 offset:6800
  ds_read_b128 a[164:167], v3 offset:11600
  v_and_b32 v125, v160, v135
  v_and_b32 v126, v161, v135
  v_and_b32 v127, v162, v135
  v_and_b32 v140, v163, v135
  v_accvgpr_write_b32 a200, v125
  v_accvgpr_write_b32 a201, v126
  v_accvgpr_write_b32 a202, v127
  buffer_load_dwordx4 a[36:39], v203, s[64:67], s42 offen offset:128
  s_add_u32 s42, s42, 0x1800
  v_accvgpr_write_b32 a203, v140
  ds_read_b128 a[240:243], v3 offset:2400
  ds_read_b128 a[244:247], v3 offset:7200
  ds_read_b128 a[248:251], v3 offset:12000
  ds_read_b128 a[168:171], v3 offset:2800
  ds_read_b128 a[172:175], v3 offset:7600
  ds_read_b128 a[176:179], v3 offset:12400
  v_and_b32 v125, v164, v135
  v_and_b32 v126, v165, v135
  v_and_b32 v127, v166, v135
  v_and_b32 v140, v167, v135
  buffer_load_dwordx4 a[40:43], v203, s[64:67], s42 offen
  v_accvgpr_write_b32 a204, v125
  v_accvgpr_write_b32 a205, v126
  v_accvgpr_write_b32 a206, v127
  v_accvgpr_write_b32 a207, v140
  ds_read_b128 a[252:255], v3 offset:3200
  ds_read_b128 a[180:183], v3 offset:8000
  ds_read_b128 a[184:187], v3 offset:12800
  ds_read_b128 a[188:191], v3 offset:3600
  ds_read_b128 a[216:219], v3 offset:8400
  ds_read_b128 a[220:223], v3 offset:13200
  buffer_load_dwordx4 a[44:47], v203, s[64:67], s42 offen offset:128
  s_add_u32 s42, s42, 0x1800
  v_and_b32 v125, v160, v136
  v_and_b32 v126, v161, v136
  v_and_b32 v127, v162, v136
  v_and_b32 v140, v163, v136
  v_accvgpr_write_b32 a208, v125
  v_accvgpr_write_b32 a209, v126
  v_accvgpr_write_b32 a210, v127
  v_accvgpr_write_b32 a211, v140
  ds_read_b128 a[224:227], v3 offset:4000
  ds_read_b128 a[228:231], v3 offset:8800
  ds_read_b128 a[232:235], v3 offset:13600
  buffer_load_dwordx4 a[48:51], v203, s[64:67], s42 offen
  ds_read_b128 a[236:239], v3 offset:4400
  ds_read_b128 v[208:211], v3 offset:9200
  ds_read_b128 v[212:215], v3 offset:14000
  v_and_b32 v125, v164, v136
  v_and_b32 v126, v165, v136
  v_and_b32 v127, v166, v136
  v_and_b32 v140, v167, v136
  v_accvgpr_write_b32 a212, v125
  v_accvgpr_write_b32 a213, v126
  v_accvgpr_write_b32 a214, v127
  buffer_load_dwordx4 a[52:55], v203, s[64:67], s42 offen offset:128
  s_add_u32 s42, s42, 0x1800
  v_accvgpr_write_b32 a215, v140
  s_waitcnt vmcnt(19)
  v_mfma_f32_32x32x16_bf16 v[16:31], a[72:75], v[184:187], 0
  buffer_load_dwordx4 a[56:59], v203, s[64:67], s42 offen
  s_waitcnt vmcnt(19)
  v_mfma_f32_32x32x16_bf16 v[16:31], a[76:79], v[188:191], v[16:31]
  s_waitcnt vmcnt(18)
  v_mfma_f32_32x32x16_bf16 v[32:47], a[80:83], v[184:187], 0
  s_nop 0
  buffer_load_dwordx4 a[60:63], v203, s[64:67], s42 offen offset:128
  s_add_u32 s42, s42, 0x1800
  s_waitcnt vmcnt(15)
  v_mfma_f32_32x32x16_bf16 v[48:63], a[0:3], v[240:243], v[16:31]
  s_nop 0
  buffer_load_dwordx4 a[64:67], v203, s[64:67], s42 offen
  v_mfma_f32_32x32x16_bf16 v[32:47], a[84:87], v[188:191], v[32:47]
  s_waitcnt vmcnt(15)
  v_mfma_f32_32x32x16_bf16 v[48:63], a[4:7], v[244:247], v[48:63]
  buffer_load_dwordx4 a[68:71], v203, s[64:67], s42 offen offset:128
  s_waitcnt vmcnt(15)
  v_mfma_f32_32x32x16_bf16 v[216:231], a[8:11], v[240:243], v[16:31]
  s_add_u32 m0, s15, 0x8200
  s_nop 0
  buffer_load_dwordx4 v6, s[4:7], s49 offen lds
  s_waitcnt vmcnt(15)
  v_mfma_f32_32x32x16_bf16 v[216:231], a[12:15], v[244:247], v[216:231]
  buffer_load_dwordx4 v7, s[4:7], s49 offen offset:1024 lds
  s_nop 2
  v_cvt_pk_bf16_f32 v64, v48, v52
  v_cvt_pk_bf16_f32 v65, v56, v60
  v_cvt_pk_bf16_f32 v68, v49, v53
  v_cvt_pk_bf16_f32 v69, v57, v61
  s_waitcnt vmcnt(15)
  v_mfma_f32_32x32x16_bf16 v[96:111], a[16:19], v[240:243], v[16:31]
  buffer_load_dwordx4 v8, s[4:7], s49 offen offset:2048 lds
  v_cvt_pk_bf16_f32 v72, v50, v54
  v_cvt_pk_bf16_f32 v73, v58, v62
  v_cvt_pk_bf16_f32 v76, v51, v55
  v_cvt_pk_bf16_f32 v77, v59, v63
  s_waitcnt vmcnt(15)
  v_mfma_f32_32x32x16_bf16 v[96:111], a[20:23], v[244:247], v[96:111]
  buffer_load_dwordx4 v9, s[4:7], s49 offen offset:3072 lds
  v_cvt_pk_bf16_f32 v66, v216, v220
  v_cvt_pk_bf16_f32 v67, v224, v228
  v_cvt_pk_bf16_f32 v70, v217, v221
  v_cvt_pk_bf16_f32 v71, v225, v229
  ds_write_b128 v195, v[64:67]
  s_waitcnt vmcnt(15)
  v_mfma_f32_32x32x16_bf16 v[48:63], a[24:27], v[240:243], v[32:47]
  s_add_u32 m0, s15, 0
  s_nop 0
  buffer_load_dwordx4 v198, s[4:7], 0 offen lds
  ds_write_b128 v195, v[68:71] offset:6144
  v_cvt_pk_bf16_f32 v74, v218, v222
  v_cvt_pk_bf16_f32 v75, v226, v230
  v_cvt_pk_bf16_f32 v78, v219, v223
  v_cvt_pk_bf16_f32 v79, v227, v231
  s_waitcnt vmcnt(15)
  v_mfma_f32_32x32x16_bf16 v[48:63], a[28:31], v[244:247], v[48:63]
  s_add_u32 m0, s15, 0x400
  s_nop 0
  buffer_load_dwordx4 v199, s[4:7], 0 offen lds
  ds_write_b128 v195, v[72:75] offset:12288
  v_cvt_pk_bf16_f32 v80, v96, v100
  v_cvt_pk_bf16_f32 v81, v104, v108
  v_cvt_pk_bf16_f32 v84, v97, v101
  v_cvt_pk_bf16_f32 v85, v105, v109
  s_waitcnt vmcnt(15)
  v_mfma_f32_32x32x16_bf16 v[216:231], a[32:35], v[240:243], v[32:47]
  s_add_u32 m0, s15, 0x800
  s_nop 0
  buffer_load_dwordx4 v200, s[4:7], 0 offen lds
  ds_write_b128 v195, v[76:79] offset:18432
  v_cvt_pk_bf16_f32 v88, v98, v102
  v_cvt_pk_bf16_f32 v89, v106, v110
  v_cvt_pk_bf16_f32 v92, v99, v103
  v_cvt_pk_bf16_f32 v93, v107, v111
  s_waitcnt vmcnt(15)
  v_mfma_f32_32x32x16_bf16 v[216:231], a[36:39], v[244:247], v[216:231]
  s_add_u32 m0, s15, 0xc00
  s_nop 0
  buffer_load_dwordx4 v201, s[4:7], 0 offen lds
  ds_write_b64 v196, v[80:81]
  ds_write_b64 v196, v[84:85] offset:6144
  v_cvt_pk_bf16_f32 v64, v48, v52
  v_cvt_pk_bf16_f32 v65, v56, v60
  v_cvt_pk_bf16_f32 v68, v49, v53
  v_cvt_pk_bf16_f32 v69, v57, v61
  s_waitcnt vmcnt(15)
  v_mfma_f32_32x32x16_bf16 v[96:111], a[40:43], v[240:243], v[32:47]
  s_add_u32 m0, s14, 0x22000
  s_nop 0
  buffer_load_dwordx4 v254, s[72:75], s57 offen lds
  ds_write_b64 v196, v[88:89] offset:12288
  ds_write_b64 v196, v[92:93] offset:18432
  v_cvt_pk_bf16_f32 v72, v50, v54
  v_cvt_pk_bf16_f32 v73, v58, v62
  v_cvt_pk_bf16_f32 v76, v51, v55
  v_cvt_pk_bf16_f32 v77, v59, v63
  s_waitcnt vmcnt(15)
  v_mfma_f32_32x32x16_bf16 v[96:111], a[44:47], v[244:247], v[96:111]
  s_nop 0
  buffer_load_dwordx4 v255, s[72:75], s57 offen offset:1024 lds
  v_cvt_pk_bf16_f32 v66, v216, v220
  v_cvt_pk_bf16_f32 v67, v224, v228
  v_cvt_pk_bf16_f32 v70, v217, v221
  v_cvt_pk_bf16_f32 v71, v225, v229
  ds_write_b128 v197, v[64:67]
  s_waitcnt vmcnt(15)
  v_mfma_f32_32x32x16_bf16 v[48:63], a[48:51], v[240:243], v[32:47]
  s_nop 0
  buffer_load_dwordx4 v194, s[72:75], s57 offen offset:2048 lds
  ds_write_b128 v197, v[68:71] offset:6144
  v_cvt_pk_bf16_f32 v74, v218, v222
  v_cvt_pk_bf16_f32 v75, v226, v230
  v_cvt_pk_bf16_f32 v78, v219, v223
  v_cvt_pk_bf16_f32 v79, v227, v231
  s_waitcnt vmcnt(15)
  v_mfma_f32_32x32x16_bf16 v[48:63], a[52:55], v[244:247], v[48:63]
  s_add_u32 m0, s14, 0x22c00
  s_nop 0
  buffer_load_dwordx4 v254, s[72:75], s58 offen lds
  ds_write_b128 v197, v[72:75] offset:12288
  v_cvt_pk_bf16_f32 v80, v96, v100
  v_cvt_pk_bf16_f32 v81, v104, v108
  v_cvt_pk_bf16_f32 v84, v97, v101
  v_cvt_pk_bf16_f32 v85, v105, v109
  s_waitcnt vmcnt(15)
  v_mfma_f32_32x32x16_bf16 v[216:231], a[56:59], v[240:243], v[32:47]
  s_nop 0
  buffer_load_dwordx4 v255, s[72:75], s58 offen offset:1024 lds
  ds_write_b128 v197, v[76:79] offset:18432
  v_cvt_pk_bf16_f32 v88, v98, v102
  v_cvt_pk_bf16_f32 v89, v106, v110
  v_cvt_pk_bf16_f32 v92, v99, v103
  v_cvt_pk_bf16_f32 v93, v107, v111
  v_mfma_f32_32x32x16_bf16 v[96:111], a[88:91], v[240:243], v[32:47]
  s_waitcnt vmcnt(15)
  v_mfma_f32_32x32x16_bf16 v[216:231], a[60:63], v[244:247], v[216:231]
  s_nop 0
  buffer_load_dwordx4 v194, s[72:75], s58 offen offset:2048 lds
  v_cvt_pk_bf16_f32 v82, v48, v52
  v_cvt_pk_bf16_f32 v83, v56, v60
  v_cvt_pk_bf16_f32 v86, v49, v53
  v_cvt_pk_bf16_f32 v87, v57, v61
  ds_write_b128 v197, v[80:83] offset:1024
  v_mfma_f32_32x32x16_bf16 v[96:111], a[92:95], v[244:247], v[96:111]
  s_waitcnt vmcnt(15)
  v_mfma_f32_32x32x16_bf16 v[96:111], a[64:67], v[240:243], v[96:111]
  s_nop 0
  ds_write_b128 v197, v[84:87] offset:7168
  v_cvt_pk_bf16_f32 v90, v50, v54
  v_cvt_pk_bf16_f32 v91, v58, v62
  v_cvt_pk_bf16_f32 v94, v51, v55
  v_cvt_pk_bf16_f32 v95, v59, v63
  s_waitcnt vmcnt(14)
  v_mfma_f32_32x32x16_bf16 v[96:111], a[68:71], v[244:247], v[96:111]
  s_nop 0
  ds_write_b128 v197, v[88:91] offset:13312
  v_cvt_pk_bf16_f32 v64, v216, v220
  v_cvt_pk_bf16_f32 v65, v224, v228
  v_cvt_pk_bf16_f32 v68, v217, v221
  v_cvt_pk_bf16_f32 v69, v225, v229
  ds_write_b128 v197, v[92:95] offset:19456
  v_cvt_pk_bf16_f32 v72, v218, v222
  v_cvt_pk_bf16_f32 v73, v226, v230
  v_cvt_pk_bf16_f32 v76, v219, v223
  v_cvt_pk_bf16_f32 v77, v227, v231
  s_nop 1
  s_nop 0
  v_cvt_pk_bf16_f32 v66, v96, v100
  v_cvt_pk_bf16_f32 v67, v104, v108
  v_cvt_pk_bf16_f32 v70, v97, v101
  v_cvt_pk_bf16_f32 v71, v105, v109
  ds_write_b128 v197, v[64:67] offset:2048
  ds_write_b128 v197, v[68:71] offset:8192
  v_cvt_pk_bf16_f32 v74, v98, v102
  v_cvt_pk_bf16_f32 v75, v106, v110
  v_cvt_pk_bf16_f32 v78, v99, v103
  v_cvt_pk_bf16_f32 v79, v107, v111
  ds_write_b128 v197, v[72:75] offset:14336
  ds_write_b128 v197, v[76:79] offset:20480
  s_waitcnt lgkmcnt(0)
  s_barrier
  ds_read_b128 a[0:3], v0 offset:24576
  ds_read_b128 a[4:7], v0 offset:25600
  ds_read_b128 a[8:11], v0 offset:26624
  ds_read_b128 a[12:15], v0 offset:27648
  ds_read_b128 a[16:19], v0 offset:28672
  ds_read_b128 a[20:23], v0 offset:29696
  ds_read_b128 a[24:27], v0 offset:30720
  ds_read_b128 a[28:31], v0 offset:31744
  ds_read_b128 a[32:35], v0 offset:32768
  ds_read_b128 a[36:39], v0 offset:33792
  ds_read_b128 a[40:43], v0 offset:34816
  ds_read_b128 a[44:47], v0 offset:35840
  ds_read_b128 a[48:51], v0 offset:36864
  ds_read_b128 a[52:55], v0 offset:37888
  ds_read_b128 a[56:59], v0 offset:38912
  ds_read_b128 a[60:63], v0 offset:39936
  ds_read_b128 a[64:67], v0 offset:40960
  ds_read_b128 a[68:71], v0 offset:41984
  ds_read_b128 a[72:75], v0 offset:43008
  ds_read_b128 a[76:79], v0 offset:44032
  ds_read_b128 a[80:83], v0 offset:45056
  ds_read_b128 a[84:87], v0 offset:46080
  ds_read_b128 a[88:91], v0 offset:47104
  ds_read_b128 a[92:95], v0 offset:48128
  s_waitcnt vmcnt(6)
  s_nop 0
  ds_read_b128 v[216:219], v4
  ds_read_b128 v[220:223], v4 offset:16
  ds_read_b128 v[224:227], v4 offset:192
  ds_read_b128 v[228:231], v4 offset:208
  ds_read_b128 v[232:235], v4 offset:384
  ds_read_b128 v[236:239], v4 offset:400
  ds_read_b128 v[160:163], v4 offset:32
  ds_read_b128 v[164:167], v4 offset:48
  ds_read_b128 v[168:171], v4 offset:224
  ds_read_b128 v[172:175], v4 offset:240
  ds_read_b128 v[176:179], v4 offset:416
  s_waitcnt lgkmcnt(10)
  v_mfma_f32_16x16x32_bf16 v[112:115], a[96:99], v[216:219], 0
  s_waitcnt lgkmcnt(9)
  ds_read_b128 v[180:183], v4 offset:432
  v_mfma_f32_16x16x32_bf16 v[116:119], a[108:111], v[220:223], 0
  s_waitcnt lgkmcnt(9)
  ds_read_b128 v[216:219], v4 offset:64
  v_mfma_f32_16x16x32_bf16 v[112:115], a[100:103], v[224:227], v[112:115]
  s_waitcnt lgkmcnt(9)
  ds_read_b128 v[220:223], v4 offset:80
  v_mfma_f32_16x16x32_bf16 v[116:119], a[112:115], v[228:231], v[116:119]
  s_waitcnt lgkmcnt(9)
  ds_read_b128 v[224:227], v4 offset:256
  v_mfma_f32_16x16x32_bf16 v[112:115], a[104:107], v[232:235], v[112:115]
  s_waitcnt lgkmcnt(9)
  ds_read_b128 v[228:231], v4 offset:272
  v_mfma_f32_16x16x32_bf16 v[116:119], a[116:119], v[236:239], v[116:119]
  s_waitcnt lgkmcnt(9)
  ds_read_b128 v[232:235], v4 offset:448
  v_mfma_f32_16x16x32_bf16 v[120:123], a[120:123], v[160:163], 0
  s_waitcnt lgkmcnt(9)
  ds_read_b128 v[236:239], v4 offset:464
  v_mfma_f32_16x16x32_bf16 v[124:127], a[132:135], v[164:167], 0
  s_waitcnt lgkmcnt(9)
  ds_read_b128 v[160:163], v4 offset:96
  v_mfma_f32_16x16x32_bf16 v[120:123], a[124:127], v[168:171], v[120:123]
  s_waitcnt lgkmcnt(9)
  ds_read_b128 v[164:167], v4 offset:112
  v_mfma_f32_16x16x32_bf16 v[124:127], a[136:139], v[172:175], v[124:127]
  s_waitcnt lgkmcnt(9)
  ds_read_b128 v[168:171], v4 offset:288
  v_mfma_f32_16x16x32_bf16 v[120:123], a[128:131], v[176:179], v[120:123]
  s_waitcnt lgkmcnt(9)
  ds_read_b128 v[172:175], v4 offset:304
  v_mfma_f32_16x16x32_bf16 v[124:127], a[140:143], v[180:183], v[124:127]
  s_waitcnt lgkmcnt(9)
  ds_read_b128 v[176:179], v4 offset:480
  v_mfma_f32_16x16x32_bf16 v[128:131], a[144:147], v[216:219], 0
  s_waitcnt lgkmcnt(9)
  ds_read_b128 v[180:183], v4 offset:496
  v_mfma_f32_16x16x32_bf16 v[132:135], a[156:159], v[220:223], 0
  s_waitcnt lgkmcnt(9)
  ds_read_b128 v[216:219], v4 offset:128
  v_mfma_f32_16x16x32_bf16 v[128:131], a[148:151], v[224:227], v[128:131]
  s_waitcnt lgkmcnt(9)
  ds_read_b128 v[220:223], v4 offset:144
  v_mfma_f32_16x16x32_bf16 v[132:135], a[160:163], v[228:231], v[132:135]
  s_waitcnt lgkmcnt(9)
  ds_read_b128 v[224:227], v4 offset:320
  v_mfma_f32_16x16x32_bf16 v[128:131], a[152:155], v[232:235], v[128:131]
  s_waitcnt lgkmcnt(9)
  ds_read_b128 v[228:231], v4 offset:336
  v_mfma_f32_16x16x32_bf16 v[132:135], a[164:167], v[236:239], v[132:135]
  s_waitcnt lgkmcnt(9)
  ds_read_b128 v[232:235], v4 offset:512
  v_mfma_f32_16x16x32_bf16 v[136:139], a[240:243], v[160:163], 0
  s_waitcnt lgkmcnt(9)
  ds_read_b128 v[236:239], v4 offset:528
  v_mfma_f32_16x16x32_bf16 v[140:143], a[168:171], v[164:167], 0
  s_waitcnt lgkmcnt(9)
  ds_read_b128 v[160:163], v4 offset:160
  v_mfma_f32_16x16x32_bf16 v[136:139], a[244:247], v[168:171], v[136:139]
  s_waitcnt lgkmcnt(9)
  ds_read_b128 v[164:167], v4 offset:176
  v_mfma_f32_16x16x32_bf16 v[140:143], a[172:175], v[172:175], v[140:143]
  s_waitcnt lgkmcnt(9)
  ds_read_b128 v[168:171], v4 offset:352
  v_mfma_f32_16x16x32_bf16 v[136:139], a[248:251], v[176:179], v[136:139]
  s_waitcnt lgkmcnt(9)
  ds_read_b128 v[172:175], v4 offset:368
  v_mfma_f32_16x16x32_bf16 v[140:143], a[176:179], v[180:183], v[140:143]
  s_waitcnt lgkmcnt(9)
  ds_read_b128 v[176:179], v4 offset:544
  v_mfma_f32_16x16x32_bf16 v[144:147], a[252:255], v[216:219], 0
  s_waitcnt lgkmcnt(9)
  ds_read_b128 v[180:183], v4 offset:560
  v_mfma_f32_16x16x32_bf16 v[148:151], a[188:191], v[220:223], 0
  s_waitcnt lgkmcnt(9)
  v_mfma_f32_16x16x32_bf16 v[144:147], a[180:183], v[224:227], v[144:147]
  s_waitcnt lgkmcnt(8)
  v_mfma_f32_16x16x32_bf16 v[148:151], a[216:219], v[228:231], v[148:151]
  s_waitcnt lgkmcnt(7)
  v_mfma_f32_16x16x32_bf16 v[144:147], a[184:187], v[232:235], v[144:147]
  s_waitcnt lgkmcnt(6)
  v_mfma_f32_16x16x32_bf16 v[148:151], a[220:223], v[236:239], v[148:151]
  s_waitcnt lgkmcnt(5)
  v_mfma_f32_16x16x32_bf16 v[152:155], a[224:227], v[160:163], 0
  s_waitcnt lgkmcnt(4)
  v_mfma_f32_16x16x32_bf16 v[156:159], a[236:239], v[164:167], 0
  s_waitcnt lgkmcnt(3)
  v_mfma_f32_16x16x32_bf16 v[152:155], a[228:231], v[168:171], v[152:155]
  s_waitcnt lgkmcnt(2)
  v_mfma_f32_16x16x32_bf16 v[156:159], v[208:211], v[172:175], v[156:159]
  s_waitcnt lgkmcnt(1)
  v_mfma_f32_16x16x32_bf16 v[152:155], a[232:235], v[176:179], v[152:155]
  s_waitcnt lgkmcnt(0)
  v_mfma_f32_16x16x32_bf16 v[156:159], v[212:215], v[180:183], v[156:159]
  buffer_load_dword v249, v248, s[4:7], s29 offen
  v_pk_add_f32 v[12:13], v[112:113], v[114:115]
  v_pk_mul_f32 v[14:15], v[112:113], v[112:113]
  v_pk_fma_f32 v[14:15], v[114:115], v[114:115], v[14:15]
  v_pk_add_f32 v[12:13], v[12:13], v[116:117]
  v_pk_fma_f32 v[14:15], v[116:117], v[116:117], v[14:15]
  v_pk_add_f32 v[12:13], v[12:13], v[118:119]
  v_pk_fma_f32 v[14:15], v[118:119], v[118:119], v[14:15]
  v_pk_add_f32 v[12:13], v[12:13], v[120:121]
  v_pk_fma_f32 v[14:15], v[120:121], v[120:121], v[14:15]
  v_pk_add_f32 v[12:13], v[12:13], v[122:123]
  v_pk_fma_f32 v[14:15], v[122:123], v[122:123], v[14:15]
  v_pk_add_f32 v[12:13], v[12:13], v[124:125]
  ds_read_b128 v[216:219], v0 offset:18432
  ds_read_b128 v[220:223], v0 offset:19456
  ds_read_b128 v[224:227], v0 offset:20480
  ds_read_b128 v[228:231], v0 offset:21504
  v_pk_fma_f32 v[14:15], v[124:125], v[124:125], v[14:15]
  v_pk_add_f32 v[12:13], v[12:13], v[126:127]
  v_pk_fma_f32 v[14:15], v[126:127], v[126:127], v[14:15]
  v_pk_add_f32 v[12:13], v[12:13], v[128:129]
  v_pk_fma_f32 v[14:15], v[128:129], v[128:129], v[14:15]
  v_pk_add_f32 v[12:13], v[12:13], v[130:131]
  v_pk_fma_f32 v[14:15], v[130:131], v[130:131], v[14:15]
  v_pk_add_f32 v[12:13], v[12:13], v[132:133]
  v_pk_fma_f32 v[14:15], v[132:133], v[132:133], v[14:15]
  v_pk_add_f32 v[12:13], v[12:13], v[134:135]
  v_pk_fma_f32 v[14:15], v[134:135], v[134:135], v[14:15]
  v_pk_add_f32 v[12:13], v[12:13], v[136:137]
  ds_read_b128 v[232:235], v0 offset:22528
  ds_read_b128 v[236:239], v0 offset:23552
  ds_read_b128 a[96:99], v0 offset:49152
  ds_read_b128 a[100:103], v0 offset:50176
  v_pk_fma_f32 v[14:15], v[136:137], v[136:137], v[14:15]
  v_pk_add_f32 v[12:13], v[12:13], v[138:139]
  v_pk_fma_f32 v[14:15], v[138:139], v[138:139], v[14:15]
  v_pk_add_f32 v[12:13], v[12:13], v[140:141]
  v_pk_fma_f32 v[14:15], v[140:141], v[140:141], v[14:15]
  v_pk_add_f32 v[12:13], v[12:13], v[142:143]
  v_pk_fma_f32 v[14:15], v[142:143], v[142:143], v[14:15]
  v_pk_add_f32 v[12:13], v[12:13], v[144:145]
  v_pk_fma_f32 v[14:15], v[144:145], v[144:145], v[14:15]
  v_pk_add_f32 v[12:13], v[12:13], v[146:147]
  v_pk_fma_f32 v[14:15], v[146:147], v[146:147], v[14:15]
  v_pk_add_f32 v[12:13], v[12:13], v[148:149]
  ds_read_b128 a[104:107], v0 offset:51200
  ds_read_b128 a[108:111], v0 offset:52224
  ds_read_b128 a[112:115], v0 offset:53248
  ds_read_b128 a[116:119], v0 offset:54272
  v_pk_fma_f32 v[14:15], v[148:149], v[148:149], v[14:15]
  v_pk_add_f32 v[12:13], v[12:13], v[150:151]
  v_pk_fma_f32 v[14:15], v[150:151], v[150:151], v[14:15]
  v_pk_add_f32 v[12:13], v[12:13], v[152:153]
  v_pk_fma_f32 v[14:15], v[152:153], v[152:153], v[14:15]
  v_pk_add_f32 v[12:13], v[12:13], v[154:155]
  v_pk_fma_f32 v[14:15], v[154:155], v[154:155], v[14:15]
  v_pk_add_f32 v[12:13], v[12:13], v[156:157]
  v_pk_fma_f32 v[14:15], v[156:157], v[156:157], v[14:15]
  v_pk_add_f32 v[12:13], v[12:13], v[158:159]
  v_pk_fma_f32 v[14:15], v[158:159], v[158:159], v[14:15]
  v_add_f32_e64 v12, v12, v13
  ds_read_b128 a[120:123], v0 offset:55296
  ds_read_b128 a[124:127], v0 offset:56320
  ds_read_b128 a[128:131], v0 offset:57344
  ds_read_b128 a[132:135], v0 offset:58368
  v_add_f32 v14, v14, v15
  s_nop 1
  v_permlane32_swap_b32 v12, v14
  v_add_f32 v12, v12, v14
  v_mov_b32 v14, v12
  s_nop 1
  v_permlane32_swap_b32 v12, v14
  v_mul_f32 v12, s24, v12
  v_mul_f32 v13, s24, v14
  v_fma_f32 v13, -v12, v12, v13
  v_max_f32 v13, 0, v13
  v_add_f32 v13, s25, v13
  v_rsq_f32 v13, v13
  s_nop 0
  v_mul_f32 v14, s22, v13
  ds_read_b128 a[136:139], v0 offset:59392
  ds_read_b128 a[140:143], v0 offset:60416
  ds_read_b128 a[144:147], v0 offset:61440
  ds_read_b128 a[148:151], v0 offset:62464
  v_mul_f32_e64 v12, -v12, v14
  v_pk_fma_f32 v[112:113], v[112:113], v[14:15], v[12:13] op_sel_hi:[1,0,0]
  v_pk_fma_f32 v[114:115], v[114:115], v[14:15], v[12:13] op_sel_hi:[1,0,0]
  v_pk_fma_f32 v[116:117], v[116:117], v[14:15], v[12:13] op_sel_hi:[1,0,0]
  v_pk_fma_f32 v[118:119], v[118:119], v[14:15], v[12:13] op_sel_hi:[1,0,0]
  v_pk_fma_f32 v[120:121], v[120:121], v[14:15], v[12:13] op_sel_hi:[1,0,0]
  v_pk_fma_f32 v[122:123], v[122:123], v[14:15], v[12:13] op_sel_hi:[1,0,0]
  v_pk_fma_f32 v[124:125], v[124:125], v[14:15], v[12:13] op_sel_hi:[1,0,0]
  v_pk_fma_f32 v[126:127], v[126:127], v[14:15], v[12:13] op_sel_hi:[1,0,0]
  v_pk_fma_f32 v[128:129], v[128:129], v[14:15], v[12:13] op_sel_hi:[1,0,0]
  v_pk_fma_f32 v[130:131], v[130:131], v[14:15], v[12:13] op_sel_hi:[1,0,0]
  v_pk_fma_f32 v[132:133], v[132:133], v[14:15], v[12:13] op_sel_hi:[1,0,0]
  ds_read_b128 a[152:155], v0 offset:63488
  ds_read_b128 a[156:159], v0 offset:64512
  ds_read_b128 a[160:163], v1
  ds_read_b128 a[164:167], v1 offset:1024
  v_pk_fma_f32 v[134:135], v[134:135], v[14:15], v[12:13] op_sel_hi:[1,0,0]
  v_pk_fma_f32 v[136:137], v[136:137], v[14:15], v[12:13] op_sel_hi:[1,0,0]
  v_pk_fma_f32 v[138:139], v[138:139], v[14:15], v[12:13] op_sel_hi:[1,0,0]
  v_pk_fma_f32 v[140:141], v[140:141], v[14:15], v[12:13] op_sel_hi:[1,0,0]
  v_pk_fma_f32 v[142:143], v[142:143], v[14:15], v[12:13] op_sel_hi:[1,0,0]
  v_pk_fma_f32 v[144:145], v[144:145], v[14:15], v[12:13] op_sel_hi:[1,0,0]
  v_pk_fma_f32 v[146:147], v[146:147], v[14:15], v[12:13] op_sel_hi:[1,0,0]
  v_pk_fma_f32 v[148:149], v[148:149], v[14:15], v[12:13] op_sel_hi:[1,0,0]
  v_pk_fma_f32 v[150:151], v[150:151], v[14:15], v[12:13] op_sel_hi:[1,0,0]
  v_pk_fma_f32 v[152:153], v[152:153], v[14:15], v[12:13] op_sel_hi:[1,0,0]
  v_pk_fma_f32 v[154:155], v[154:155], v[14:15], v[12:13] op_sel_hi:[1,0,0]
  v_pk_fma_f32 v[156:157], v[156:157], v[14:15], v[12:13] op_sel_hi:[1,0,0]
  ds_read_b128 a[168:171], v1 offset:2048
  ds_read_b128 a[172:175], v1 offset:3072
  ds_read_b128 a[176:179], v1 offset:4096
  ds_read_b128 a[180:183], v1 offset:5120
  v_pk_fma_f32 v[158:159], v[158:159], v[14:15], v[12:13] op_sel_hi:[1,0,0]
  v_cndmask_b32 v159, v159, v250, s[12:13]
  v_cvt_pk_bf16_f32 v160, v112, v113
  v_cvt_pk_bf16_f32 v161, v114, v115
  v_cvt_pk_bf16_f32 v162, v116, v117
  v_cvt_pk_bf16_f32 v163, v118, v119
  v_cvt_pk_bf16_f32 v164, v120, v121
  v_cvt_pk_bf16_f32 v165, v122, v123
  v_cvt_pk_bf16_f32 v166, v124, v125
  v_cvt_pk_bf16_f32 v167, v126, v127
  v_cvt_pk_bf16_f32 v168, v128, v129
  v_cvt_pk_bf16_f32 v169, v130, v131
  ds_read_b128 a[184:187], v1 offset:6144
  ds_read_b128 a[188:191], v1 offset:7168
  v_cvt_pk_bf16_f32 v170, v132, v133
  v_cvt_pk_bf16_f32 v171, v134, v135
  v_cvt_pk_bf16_f32 v172, v136, v137
  v_cvt_pk_bf16_f32 v173, v138, v139
  v_cvt_pk_bf16_f32 v174, v140, v141
  v_cvt_pk_bf16_f32 v175, v142, v143
  v_cvt_pk_bf16_f32 v176, v144, v145
  v_cvt_pk_bf16_f32 v177, v146, v147
  v_cvt_pk_bf16_f32 v178, v148, v149
  v_cvt_pk_bf16_f32 v179, v150, v151
  v_cvt_pk_bf16_f32 v180, v152, v153
  v_cvt_pk_bf16_f32 v181, v154, v155
  v_cvt_pk_bf16_f32 v182, v156, v157
  v_cvt_pk_bf16_f32 v183, v158, v159
  s_waitcnt lgkmcnt(15)
  v_mfma_f32_32x32x16_bf16 v[16:31], v[216:219], v[160:163], 0
  s_nop 0
  ds_read_b128 v[136:139], v5
  ds_read_b128 v[140:143], v5 offset:32
  ds_read_b128 v[144:147], v5 offset:64
  v_mfma_f32_32x32x16_bf16 v[16:31], v[220:223], v[164:167], v[16:31]
  ds_read_b128 v[148:151], v5 offset:96
  ds_read_b128 v[152:155], v5 offset:128
  ds_read_b128 v[156:159], v5 offset:160
  v_mfma_f32_32x32x16_bf16 v[16:31], v[224:227], v[168:171], v[16:31]
  s_waitcnt vmcnt(1)
  ds_read_b128 a[216:219], v251 offset:49152
  ds_read_b128 a[220:223], v252 offset:49152
  v_mfma_f32_32x32x16_bf16 v[16:31], v[228:231], v[172:175], v[16:31]
  s_nop 0
  ds_read_b128 a[224:227], v251 offset:49216
  ds_read_b128 a[228:231], v252 offset:49216
  ds_read_b128 a[232:235], v251 offset:49280
  v_mfma_f32_32x32x16_bf16 v[16:31], v[232:235], v[176:179], v[16:31]
  s_nop 0
  ds_read_b128 a[236:239], v252 offset:49280
  v_mfma_f32_32x32x16_bf16 v[16:31], v[236:239], v[180:183], v[16:31]
  s_nop 11
  v_pk_fma_f32 v[48:49], v[16:17], v[16:17], s[20:21] neg_lo:[1,0,1] neg_hi:[1,0,1]
  v_pk_fma_f32 v[50:51], v[18:19], v[18:19], s[20:21] neg_lo:[1,0,1] neg_hi:[1,0,1]
  v_pk_fma_f32 v[52:53], v[20:21], v[20:21], s[20:21] neg_lo:[1,0,1] neg_hi:[1,0,1]
  v_pk_fma_f32 v[54:55], v[22:23], v[22:23], s[20:21] neg_lo:[1,0,1] neg_hi:[1,0,1]
  v_pk_fma_f32 v[56:57], v[24:25], v[24:25], s[20:21] neg_lo:[1,0,1] neg_hi:[1,0,1]
  v_pk_fma_f32 v[58:59], v[26:27], v[26:27], s[20:21] neg_lo:[1,0,1] neg_hi:[1,0,1]
  v_pk_fma_f32 v[60:61], v[28:29], v[28:29], s[20:21] neg_lo:[1,0,1] neg_hi:[1,0,1]
  v_pk_fma_f32 v[62:63], v[30:31], v[30:31], s[20:21] neg_lo:[1,0,1] neg_hi:[1,0,1]
  v_pk_mul_f32 v[48:49], v[16:17], v[48:49]
  v_pk_mul_f32 v[50:51], v[18:19], v[50:51]
  v_pk_mul_f32 v[52:53], v[20:21], v[52:53]
  v_pk_mul_f32 v[54:55], v[22:23], v[54:55]
  v_pk_mul_f32 v[56:57], v[24:25], v[56:57]
  v_pk_mul_f32 v[58:59], v[26:27], v[58:59]
  v_pk_mul_f32 v[60:61], v[28:29], v[60:61]
  v_pk_mul_f32 v[62:63], v[30:31], v[62:63]
  s_waitcnt lgkmcnt(5)
  v_mfma_f32_32x32x16_bf16 v[64:79], a[216:219], a[192:195], 0
  s_mov_b32 m0, s30
  v_exp_f32 v48, v48
  v_exp_f32 v49, v49
  v_exp_f32 v50, v50
  v_exp_f32 v51, v51
  v_exp_f32 v52, v52
  s_waitcnt lgkmcnt(4)
  v_mfma_f32_32x32x16_bf16 v[64:79], a[220:223], a[196:199], v[64:79]
  buffer_load_dwordx4 v6, s[4:7], s29 offen lds
  v_exp_f32 v53, v53
  s_waitcnt lgkmcnt(3)
  v_mfma_f32_32x32x16_bf16 v[80:95], a[224:227], a[200:203], 0
  buffer_load_dwordx4 v7, s[4:7], s29 offen offset:1024 lds
  s_waitcnt lgkmcnt(2)
  v_mfma_f32_32x32x16_bf16 v[80:95], a[228:231], a[204:207], v[80:95]
  buffer_load_dwordx4 v8, s[4:7], s29 offen offset:2048 lds
  s_nop 3
  v_cvt_pk_bf16_f32 v64, v64, v65
  v_cvt_pk_bf16_f32 v65, v66, v67
  v_cvt_pk_bf16_f32 v66, v68, v69
  v_cvt_pk_bf16_f32 v67, v70, v71
  ds_write_b128 v253, v[64:67] offset:49152
  v_exp_f32 v54, v54
  v_exp_f32 v55, v55
  v_cvt_pk_bf16_f32 v68, v72, v73
  v_cvt_pk_bf16_f32 v69, v74, v75
  v_cvt_pk_bf16_f32 v70, v76, v77
  s_waitcnt lgkmcnt(2)
  v_mfma_f32_32x32x16_bf16 v[96:111], a[232:235], a[208:211], 0
  s_nop 0
  buffer_load_dwordx4 v9, s[4:7], s29 offen offset:3072 lds
  v_cvt_pk_bf16_f32 v71, v78, v79
  v_exp_f32_e64 v56, v56
  v_exp_f32 v57, v57
  ds_write_b128 v253, v[68:71] offset:52224
  s_waitcnt lgkmcnt(2)
  v_mfma_f32_32x32x16_bf16 v[96:111], a[236:239], a[212:215], v[96:111]
  v_cvt_pk_bf16_f32 v80, v80, v81
  v_cvt_pk_bf16_f32 v81, v82, v83
  v_cvt_pk_bf16_f32 v82, v84, v85
  v_cvt_pk_bf16_f32 v83, v86, v87
  v_exp_f32 v58, v58
  v_exp_f32 v59, v59
  ds_write_b128 v253, v[80:83] offset:50176
  v_cvt_pk_bf16_f32 v84, v88, v89
  v_cvt_pk_bf16_f32 v85, v90, v91
  v_cvt_pk_bf16_f32 v86, v92, v93
  v_cvt_pk_bf16_f32 v87, v94, v95
  v_exp_f32 v60, v60
  v_exp_f32 v61, v61
  ds_write_b128 v253, v[84:87] offset:53248
  v_cvt_pk_bf16_f32 v96, v96, v97
  v_cvt_pk_bf16_f32 v97, v98, v99
  v_cvt_pk_bf16_f32 v98, v100, v101
  v_cvt_pk_bf16_f32 v99, v102, v103
  v_exp_f32 v62, v62
  v_exp_f32 v63, v63
  v_cvt_pk_bf16_f32 v100, v104, v105
  v_cvt_pk_bf16_f32 v101, v106, v107
  v_cvt_pk_bf16_f32 v102, v108, v109
  v_cvt_pk_bf16_f32 v103, v110, v111
  ds_write_b128 v253, v[96:99] offset:51200
  v_pk_fma_f32 v[48:49], v[48:49], s[22:23], s[22:23]
  v_pk_fma_f32 v[50:51], v[50:51], s[22:23], s[22:23]
  v_pk_fma_f32 v[52:53], v[52:53], s[22:23], s[22:23]
  v_pk_fma_f32 v[54:55], v[54:55], s[22:23], s[22:23]
  v_pk_fma_f32 v[56:57], v[56:57], s[22:23], s[22:23]
  v_pk_fma_f32 v[58:59], v[58:59], s[22:23], s[22:23]
  v_pk_fma_f32 v[60:61], v[60:61], s[22:23], s[22:23]
  v_pk_fma_f32 v[62:63], v[62:63], s[22:23], s[22:23]
  ds_write_b128 v253, v[100:103] offset:54272
  s_waitcnt lgkmcnt(0)
  s_barrier
  v_mfma_f32_32x32x16_bf16 v[32:47], a[0:3], v[160:163], 0
  ds_read_b128 v[64:67], v2
  ds_read_b128 v[68:71], v2 offset:32
  ds_read_b128 v[72:75], v2 offset:64
  s_add_u32 m0, s14, 0x16000
  v_rcp_f32_e64 v48, v48
  v_mfma_f32_32x32x16_bf16 v[32:47], a[4:7], v[164:167], v[32:47]
  ds_read_b128 v[76:79], v2 offset:96
  ds_read_b128 v[80:83], v2 offset:128
  ds_read_b128 v[84:87], v2 offset:160
  buffer_load_dwordx4 v254, s[72:75], s53 offen lds
  v_rcp_f32_e64 v49, v49
  v_mfma_f32_32x32x16_bf16 v[32:47], a[8:11], v[168:171], v[32:47]
  ds_read_b128 v[88:91], v2 offset:192
  ds_read_b128 v[92:95], v2 offset:224
  ds_read_b128 v[96:99], v2 offset:256
  buffer_load_dwordx4 v255, s[72:75], s53 offen offset:1024 lds
  v_rcp_f32_e64 v50, v50
  v_mfma_f32_32x32x16_bf16 v[32:47], a[12:15], v[172:175], v[32:47]
  ds_read_b128 v[100:103], v2 offset:288
  ds_read_b128 v[104:107], v2 offset:320
  ds_read_b128 v[108:111], v2 offset:352
  v_rcp_f32_e64 v51, v51
  v_mfma_f32_32x32x16_bf16 v[32:47], a[16:19], v[176:179], v[32:47]
  buffer_load_dwordx4 v194, s[72:75], s53 offen offset:2048 lds
  s_add_u32 m0, s14, 0x16c00
  v_rcp_f32 v52, v52
  v_rcp_f32 v53, v53
  v_mfma_f32_32x32x16_bf16 v[32:47], a[20:23], v[180:183], v[32:47]
  s_waitcnt lgkmcnt(0)
  buffer_load_dwordx4 v254, s[72:75], s54 offen lds
  v_rcp_f32 v54, v54
  v_rcp_f32_e64 v55, v55
  v_mfma_f32_32x32x16_bf16 v[64:79], v[240:243], v[136:139], v[64:79]
  v_mov_b32 v112, v194
  v_rcp_f32 v56, v56
  v_rcp_f32_e64 v57, v57
  v_mfma_f32_32x32x16_bf16 v[64:79], v[244:247], v[140:143], v[64:79]
  buffer_load_dwordx4 v255, s[72:75], s54 offen offset:1024 lds
  v_rcp_f32 v58, v58
  v_rcp_f32 v59, v59
  v_mfma_f32_32x32x16_bf16 v[80:95], v[240:243], v[144:147], v[80:95]
  buffer_load_dwordx4 v194, s[72:75], s54 offen offset:2048 lds
  v_rcp_f32_e64 v60, v60
  v_rcp_f32_e64 v61, v61
  v_mfma_f32_32x32x16_bf16 v[80:95], v[244:247], v[148:151], v[80:95]
  ds_read_b128 v[192:195], v1 offset:8192
  ds_read_b128 v[196:199], v1 offset:9216
  v_rcp_f32_e64 v62, v62
  v_rcp_f32_e64 v63, v63
  v_mfma_f32_32x32x16_bf16 v[96:111], v[240:243], v[152:155], v[96:111]
  s_nop 0
  ds_read_b128 v[200:203], v1 offset:10240
  ds_read_b128 v[204:207], v1 offset:11264
  v_mfma_f32_32x32x16_bf16 v[96:111], v[244:247], v[156:159], v[96:111]
  s_waitcnt lgkmcnt(0)
  ds_read_b128 v[208:211], v1 offset:12288
  ds_read_b128 v[212:215], v1 offset:13312
  v_pk_mul_f32 v[16:17], v[16:17], v[48:49]
  v_pk_mul_f32 v[18:19], v[18:19], v[50:51]
  v_pk_mul_f32 v[20:21], v[20:21], v[52:53]
  v_pk_mul_f32 v[22:23], v[22:23], v[54:55]
  v_pk_mul_f32 v[24:25], v[24:25], v[56:57]
  v_pk_mul_f32 v[26:27], v[26:27], v[58:59]
  v_pk_mul_f32 v[28:29], v[28:29], v[60:61]
  v_pk_mul_f32 v[30:31], v[30:31], v[62:63]
  v_pk_fma_f32 v[48:49], v[32:33], v[32:33], s[20:21] neg_lo:[1,0,1] neg_hi:[1,0,1]
  v_pk_fma_f32 v[50:51], v[34:35], v[34:35], s[20:21] neg_lo:[1,0,1] neg_hi:[1,0,1]
  v_pk_fma_f32 v[52:53], v[36:37], v[36:37], s[20:21] neg_lo:[1,0,1] neg_hi:[1,0,1]
  v_pk_fma_f32 v[54:55], v[38:39], v[38:39], s[20:21] neg_lo:[1,0,1] neg_hi:[1,0,1]
  v_pk_fma_f32 v[56:57], v[40:41], v[40:41], s[20:21] neg_lo:[1,0,1] neg_hi:[1,0,1]
  v_pk_fma_f32 v[58:59], v[42:43], v[42:43], s[20:21] neg_lo:[1,0,1] neg_hi:[1,0,1]
  v_pk_fma_f32 v[60:61], v[44:45], v[44:45], s[20:21] neg_lo:[1,0,1] neg_hi:[1,0,1]
  v_pk_fma_f32 v[62:63], v[46:47], v[46:47], s[20:21] neg_lo:[1,0,1] neg_hi:[1,0,1]
  v_pk_mul_f32 v[48:49], v[32:33], v[48:49]
  v_pk_mul_f32 v[50:51], v[34:35], v[50:51]
  v_pk_mul_f32 v[52:53], v[36:37], v[52:53]
  v_pk_mul_f32 v[54:55], v[38:39], v[54:55]
  v_pk_mul_f32 v[56:57], v[40:41], v[56:57]
  v_cvt_pk_bf16_f32 v184, v16, v17
  v_cvt_pk_bf16_f32 v185, v18, v19
  v_cvt_pk_bf16_f32 v186, v20, v21
  v_cvt_pk_bf16_f32 v187, v22, v23
  v_pk_mul_f32 v[58:59], v[42:43], v[58:59]
  v_pk_mul_f32 v[60:61], v[44:45], v[60:61]
  v_pk_mul_f32 v[62:63], v[46:47], v[62:63]
  v_mfma_f32_32x32x16_bf16 v[64:79], v[192:195], v[184:187], v[64:79]
  s_mov_b32 m0, s31
  v_cvt_pk_bf16_f32 v188, v24, v25
  v_cvt_pk_bf16_f32 v189, v26, v27
  v_cvt_pk_bf16_f32 v190, v28, v29
  v_cvt_pk_bf16_f32 v191, v30, v31
  v_exp_f32 v48, v48
  v_mfma_f32_32x32x16_bf16 v[80:95], v[196:199], v[184:187], v[80:95]
  buffer_load_dwordx4 v6, s[4:7], s52 offen lds
  v_exp_f32 v49, v49
  v_exp_f32 v50, v50
  v_exp_f32_e64 v51, v51
  v_mfma_f32_32x32x16_bf16 v[96:111], v[200:203], v[184:187], v[96:111]
  buffer_load_dwordx4 v7, s[4:7], s52 offen offset:1024 lds
  v_exp_f32 v52, v52
  v_exp_f32 v53, v53
  v_mfma_f32_32x32x16_bf16 v[64:79], v[204:207], v[188:191], v[64:79]
  buffer_load_dwordx4 v8, s[4:7], s52 offen offset:2048 lds
  v_exp_f32 v54, v54
  v_exp_f32 v55, v55
  v_exp_f32 v56, v56
  s_waitcnt lgkmcnt(1)
  v_mfma_f32_32x32x16_bf16 v[80:95], v[208:211], v[188:191], v[80:95]
  buffer_load_dwordx4 v9, s[4:7], s52 offen offset:3072 lds
  v_exp_f32 v57, v57
  v_exp_f32 v58, v58
  s_waitcnt lgkmcnt(0)
  v_mfma_f32_32x32x16_bf16 v[96:111], v[212:215], v[188:191], v[96:111]
  v_exp_f32 v59, v59
  v_exp_f32 v60, v60
  v_exp_f32 v61, v61
  v_exp_f32 v62, v62
  v_exp_f32 v63, v63
  v_pk_fma_f32 v[48:49], v[48:49], s[22:23], s[22:23]
  v_pk_fma_f32 v[50:51], v[50:51], s[22:23], s[22:23]
  v_pk_fma_f32 v[52:53], v[52:53], s[22:23], s[22:23]
  v_pk_fma_f32 v[54:55], v[54:55], s[22:23], s[22:23]
  v_pk_fma_f32 v[56:57], v[56:57], s[22:23], s[22:23]
  v_pk_fma_f32 v[58:59], v[58:59], s[22:23], s[22:23]
  v_pk_fma_f32 v[60:61], v[60:61], s[22:23], s[22:23]
  v_pk_fma_f32 v[62:63], v[62:63], s[22:23], s[22:23]
  v_mfma_f32_32x32x16_bf16 v[16:31], a[24:27], v[160:163], 0
  ds_read_b128 v[192:195], v1 offset:14336
  ds_read_b128 v[196:199], v1 offset:15360
  s_add_u32 m0, s14, 0x1c000
  v_rcp_f32 v48, v48
  v_rcp_f32 v49, v49
  v_mfma_f32_32x32x16_bf16 v[16:31], a[28:31], v[164:167], v[16:31]
  ds_read_b128 v[200:203], v1 offset:16384
  ds_read_b128 v[204:207], v1 offset:17408
  buffer_load_dwordx4 v254, s[72:75], s55 offen lds
  v_rcp_f32 v50, v50
  v_rcp_f32 v51, v51
  v_mfma_f32_32x32x16_bf16 v[16:31], a[32:35], v[168:171], v[16:31]
  ds_read_b128 v[208:211], v1 offset:18432
  ds_read_b128 v[212:215], v1 offset:19456
  v_rcp_f32 v52, v52
  v_rcp_f32 v53, v53
  v_mfma_f32_32x32x16_bf16 v[16:31], a[36:39], v[172:175], v[16:31]
  buffer_load_dwordx4 v255, s[72:75], s55 offen offset:1024 lds
  v_rcp_f32 v54, v54
  v_rcp_f32 v55, v55
  v_rcp_f32_e64 v56, v56
  v_mfma_f32_32x32x16_bf16 v[16:31], a[40:43], v[176:179], v[16:31]
  v_rcp_f32 v57, v57
  v_rcp_f32 v58, v58
  v_rcp_f32 v59, v59
  v_mfma_f32_32x32x16_bf16 v[16:31], a[44:47], v[180:183], v[16:31]
  s_waitcnt lgkmcnt(0)
  buffer_load_dwordx4 v112, s[72:75], s55 offen offset:2048 lds
  v_rcp_f32 v60, v60
  v_rcp_f32 v61, v61
  v_rcp_f32 v62, v62
  v_rcp_f32 v63, v63
  v_pk_mul_f32 v[32:33], v[32:33], v[48:49]
  v_pk_mul_f32 v[34:35], v[34:35], v[50:51]
  v_pk_mul_f32 v[36:37], v[36:37], v[52:53]
  v_pk_mul_f32 v[38:39], v[38:39], v[54:55]
  v_pk_mul_f32 v[40:41], v[40:41], v[56:57]
  v_pk_mul_f32 v[42:43], v[42:43], v[58:59]
  v_pk_mul_f32 v[44:45], v[44:45], v[60:61]
  v_pk_mul_f32 v[46:47], v[46:47], v[62:63]
  v_pk_fma_f32 v[48:49], v[16:17], v[16:17], s[20:21] neg_lo:[1,0,1] neg_hi:[1,0,1]
  v_pk_fma_f32 v[50:51], v[18:19], v[18:19], s[20:21] neg_lo:[1,0,1] neg_hi:[1,0,1]
  v_pk_fma_f32 v[52:53], v[20:21], v[20:21], s[20:21] neg_lo:[1,0,1] neg_hi:[1,0,1]
  v_pk_fma_f32 v[54:55], v[22:23], v[22:23], s[20:21] neg_lo:[1,0,1] neg_hi:[1,0,1]
  v_pk_fma_f32 v[56:57], v[24:25], v[24:25], s[20:21] neg_lo:[1,0,1] neg_hi:[1,0,1]
  v_pk_fma_f32 v[58:59], v[26:27], v[26:27], s[20:21] neg_lo:[1,0,1] neg_hi:[1,0,1]
  v_pk_fma_f32 v[60:61], v[28:29], v[28:29], s[20:21] neg_lo:[1,0,1] neg_hi:[1,0,1]
  v_pk_fma_f32 v[62:63], v[30:31], v[30:31], s[20:21] neg_lo:[1,0,1] neg_hi:[1,0,1]
  v_pk_mul_f32 v[48:49], v[16:17], v[48:49]
  v_pk_mul_f32 v[50:51], v[18:19], v[50:51]
  v_pk_mul_f32 v[52:53], v[20:21], v[52:53]
  v_pk_mul_f32 v[54:55], v[22:23], v[54:55]
  v_pk_mul_f32 v[56:57], v[24:25], v[56:57]
  v_cvt_pk_bf16_f32 v184, v32, v33
  v_cvt_pk_bf16_f32 v185, v34, v35
  v_cvt_pk_bf16_f32 v186, v36, v37
  v_cvt_pk_bf16_f32 v187, v38, v39
  v_pk_mul_f32 v[58:59], v[26:27], v[58:59]
  v_pk_mul_f32 v[60:61], v[28:29], v[60:61]
  v_pk_mul_f32 v[62:63], v[30:31], v[62:63]
  v_mfma_f32_32x32x16_bf16 v[64:79], v[192:195], v[184:187], v[64:79]
  s_add_u32 m0, s14, 0x1cc00
  v_cvt_pk_bf16_f32 v188, v40, v41
  v_cvt_pk_bf16_f32 v189, v42, v43
  v_cvt_pk_bf16_f32 v190, v44, v45
  v_cvt_pk_bf16_f32 v191, v46, v47
  v_exp_f32_e64 v48, v48
  v_mfma_f32_32x32x16_bf16 v[80:95], v[196:199], v[184:187], v[80:95]
  buffer_load_dwordx4 v254, s[72:75], s56 offen lds
  v_exp_f32 v49, v49
  v_exp_f32 v50, v50
  v_exp_f32 v51, v51
  v_mfma_f32_32x32x16_bf16 v[96:111], v[200:203], v[184:187], v[96:111]
  s_waitcnt vmcnt(8)
  ds_read_b128 a[216:219], v251
  ds_read_b128 a[220:223], v252
  ds_read_b128 a[224:227], v251 offset:64
  v_exp_f32 v52, v52
  v_exp_f32 v53, v53
  v_mfma_f32_32x32x16_bf16 v[64:79], v[204:207], v[188:191], v[64:79]
  ds_read_b128 a[228:231], v252 offset:64
  ds_read_b128 a[232:235], v251 offset:128
  ds_read_b128 a[236:239], v252 offset:128
  buffer_load_dwordx4 v255, s[72:75], s56 offen offset:1024 lds
  v_subrev_u32 v11, 0x4100, v5
  v_exp_f32_e64 v54, v54
  v_mfma_f32_32x32x16_bf16 v[80:95], v[208:211], v[188:191], v[80:95]
  v_exp_f32 v55, v55
  v_exp_f32 v56, v56
  v_exp_f32_e64 v57, v57
  v_exp_f32 v58, v58
  v_mfma_f32_32x32x16_bf16 v[96:111], v[212:215], v[188:191], v[96:111]
  s_waitcnt lgkmcnt(0)
  buffer_load_dwordx4 v112, s[72:75], s56 offen offset:2048 lds
  v_add_u32 v5, 0x8200, v5
  v_exp_f32 v59, v59
  v_exp_f32 v60, v60
  v_exp_f32 v61, v61
  v_exp_f32 v62, v62
  v_exp_f32 v63, v63
  v_min_u32 v5, v11, v5
  v_pk_fma_f32 v[48:49], v[48:49], s[22:23], s[22:23]
  v_pk_fma_f32 v[50:51], v[50:51], s[22:23], s[22:23]
  v_pk_fma_f32 v[52:53], v[52:53], s[22:23], s[22:23]
  v_pk_fma_f32 v[54:55], v[54:55], s[22:23], s[22:23]
  v_pk_fma_f32 v[56:57], v[56:57], s[22:23], s[22:23]
  v_pk_fma_f32 v[58:59], v[58:59], s[22:23], s[22:23]
  v_pk_fma_f32 v[60:61], v[60:61], s[22:23], s[22:23]
  v_pk_fma_f32 v[62:63], v[62:63], s[22:23], s[22:23]
  v_mfma_f32_32x32x16_bf16 v[112:127], a[216:219], a[192:195], 0
  ds_read_b128 v[192:195], v1 offset:20480
  ds_read_b128 v[196:199], v1 offset:21504
  v_rcp_f32 v48, v48
  v_rcp_f32 v49, v49
  v_mfma_f32_32x32x16_bf16 v[112:127], a[220:223], a[196:199], v[112:127]
  ds_read_b128 v[200:203], v1 offset:22528
  ds_read_b128 v[204:207], v1 offset:23552
  v_rcp_f32 v50, v50
  v_rcp_f32 v51, v51
  v_mfma_f32_32x32x16_bf16 v[128:143], a[224:227], a[200:203], 0
  ds_read_b128 v[208:211], v1 offset:24576
  ds_read_b128 v[212:215], v1 offset:25600
  v_rcp_f32_e64 v52, v52
  v_rcp_f32 v53, v53
  v_mfma_f32_32x32x16_bf16 v[128:143], a[228:231], a[204:207], v[128:143]
  s_nop 1
  v_cvt_pk_bf16_f32 v112, v112, v113
  v_cvt_pk_bf16_f32 v113, v114, v115
  v_cvt_pk_bf16_f32 v114, v116, v117
  v_cvt_pk_bf16_f32 v115, v118, v119
  v_rcp_f32_e64 v54, v54
  v_mfma_f32_32x32x16_bf16 v[144:159], a[232:235], a[208:211], 0
  ds_write_b128 v253, v[112:115]
  v_cvt_pk_bf16_f32 v116, v120, v121
  v_cvt_pk_bf16_f32 v117, v122, v123
  v_cvt_pk_bf16_f32 v118, v124, v125
  v_cvt_pk_bf16_f32 v119, v126, v127
  v_mfma_f32_32x32x16_bf16 v[144:159], a[236:239], a[212:215], v[144:159]
  ds_write_b128 v253, v[116:119] offset:3072
  v_cvt_pk_bf16_f32 v128, v128, v129
  v_cvt_pk_bf16_f32 v129, v130, v131
  v_cvt_pk_bf16_f32 v130, v132, v133
  v_cvt_pk_bf16_f32 v131, v134, v135
  v_mfma_f32_32x32x16_bf16 v[32:47], a[48:51], v[160:163], 0
  ds_write_b128 v253, v[128:131] offset:1024
  v_cvt_pk_bf16_f32 v132, v136, v137
  v_cvt_pk_bf16_f32 v133, v138, v139
  v_cvt_pk_bf16_f32 v134, v140, v141
  v_cvt_pk_bf16_f32 v135, v142, v143
  v_mfma_f32_32x32x16_bf16 v[32:47], a[52:55], v[164:167], v[32:47]
  ds_write_b128 v253, v[132:135] offset:4096
  v_cvt_pk_bf16_f32 v144, v144, v145
  v_cvt_pk_bf16_f32 v145, v146, v147
  v_cvt_pk_bf16_f32 v146, v148, v149
  v_cvt_pk_bf16_f32 v147, v150, v151
  v_mfma_f32_32x32x16_bf16 v[32:47], a[56:59], v[168:171], v[32:47]
  ds_write_b128 v253, v[144:147] offset:2048
  v_cvt_pk_bf16_f32 v148, v152, v153
  v_cvt_pk_bf16_f32 v149, v154, v155
  v_cvt_pk_bf16_f32 v150, v156, v157
  v_cvt_pk_bf16_f32 v151, v158, v159
  v_mfma_f32_32x32x16_bf16 v[32:47], a[60:63], v[172:175], v[32:47]
  ds_write_b128 v253, v[148:151] offset:5120
  v_rcp_f32 v55, v55
  v_rcp_f32 v56, v56
  v_mfma_f32_32x32x16_bf16 v[32:47], a[64:67], v[176:179], v[32:47]
  v_rcp_f32 v57, v57
  v_rcp_f32 v58, v58
  v_rcp_f32_e64 v59, v59
  v_mfma_f32_32x32x16_bf16 v[32:47], a[68:71], v[180:183], v[32:47]
  s_waitcnt lgkmcnt(6)
  v_rcp_f32 v60, v60
  v_rcp_f32 v61, v61
  v_rcp_f32 v62, v62
  v_rcp_f32_e64 v63, v63
  v_pk_mul_f32 v[16:17], v[16:17], v[48:49]
  v_pk_mul_f32 v[18:19], v[18:19], v[50:51]
  v_pk_mul_f32 v[20:21], v[20:21], v[52:53]
  v_pk_mul_f32 v[22:23], v[22:23], v[54:55]
  v_pk_mul_f32 v[24:25], v[24:25], v[56:57]
  v_pk_mul_f32 v[26:27], v[26:27], v[58:59]
  v_pk_mul_f32 v[28:29], v[28:29], v[60:61]
  v_pk_mul_f32 v[30:31], v[30:31], v[62:63]
  v_pk_fma_f32 v[48:49], v[32:33], v[32:33], s[20:21] neg_lo:[1,0,1] neg_hi:[1,0,1]
  v_pk_fma_f32 v[50:51], v[34:35], v[34:35], s[20:21] neg_lo:[1,0,1] neg_hi:[1,0,1]
  v_pk_fma_f32 v[52:53], v[36:37], v[36:37], s[20:21] neg_lo:[1,0,1] neg_hi:[1,0,1]
  v_pk_fma_f32 v[54:55], v[38:39], v[38:39], s[20:21] neg_lo:[1,0,1] neg_hi:[1,0,1]
  v_pk_fma_f32 v[56:57], v[40:41], v[40:41], s[20:21] neg_lo:[1,0,1] neg_hi:[1,0,1]
  v_pk_fma_f32 v[58:59], v[42:43], v[42:43], s[20:21] neg_lo:[1,0,1] neg_hi:[1,0,1]
  v_pk_fma_f32 v[60:61], v[44:45], v[44:45], s[20:21] neg_lo:[1,0,1] neg_hi:[1,0,1]
  v_pk_fma_f32 v[62:63], v[46:47], v[46:47], s[20:21] neg_lo:[1,0,1] neg_hi:[1,0,1]
  v_pk_mul_f32 v[48:49], v[32:33], v[48:49]
  v_pk_mul_f32 v[50:51], v[34:35], v[50:51]
  v_pk_mul_f32 v[52:53], v[36:37], v[52:53]
  v_pk_mul_f32 v[54:55], v[38:39], v[54:55]
  v_pk_mul_f32 v[56:57], v[40:41], v[56:57]
  v_cvt_pk_bf16_f32 v184, v16, v17
  v_cvt_pk_bf16_f32 v185, v18, v19
  v_cvt_pk_bf16_f32 v186, v20, v21
  v_cvt_pk_bf16_f32 v187, v22, v23
  v_pk_mul_f32 v[58:59], v[42:43], v[58:59]
  v_pk_mul_f32 v[60:61], v[44:45], v[60:61]
  v_pk_mul_f32 v[62:63], v[46:47], v[62:63]
  v_mfma_f32_32x32x16_bf16 v[64:79], v[192:195], v[184:187], v[64:79]
  s_add_u32 s29, s29, 0x60000
  v_cvt_pk_bf16_f32 v188, v24, v25
  v_cvt_pk_bf16_f32 v189, v26, v27
  v_cvt_pk_bf16_f32 v190, v28, v29
  v_cvt_pk_bf16_f32 v191, v30, v31
  v_exp_f32_e64 v48, v48
  v_mfma_f32_32x32x16_bf16 v[80:95], v[196:199], v[184:187], v[80:95]
  s_add_u32 s52, s52, 0x60000
  v_exp_f32 v49, v49
  v_exp_f32 v50, v50
  v_exp_f32_e64 v51, v51
  v_mfma_f32_32x32x16_bf16 v[96:111], v[200:203], v[184:187], v[96:111]
  s_mov_b32 s32, s30
  s_waitcnt vmcnt(0)
  ds_read_b128 a[216:219], v251 offset:24576
  ds_read_b128 a[220:223], v252 offset:24576
  ds_read_b128 a[224:227], v251 offset:24640
  v_exp_f32_e64 v52, v52
  v_exp_f32 v53, v53
  v_mfma_f32_32x32x16_bf16 v[64:79], v[204:207], v[188:191], v[64:79]
  s_add_u32 s30, s33, 32
  ds_read_b128 a[228:231], v252 offset:24640
  ds_read_b128 a[232:235], v251 offset:24704
  ds_read_b128 a[236:239], v252 offset:24704
  v_subrev_u32 v11, 0x4100, v4
  v_exp_f32_e64 v54, v54
  v_mfma_f32_32x32x16_bf16 v[80:95], v[208:211], v[188:191], v[80:95]
  s_sub_u32 s33, s31, 0
  v_exp_f32 v55, v55
  v_exp_f32 v56, v56
  v_exp_f32 v57, v57
  v_exp_f32 v58, v58
  v_mfma_f32_32x32x16_bf16 v[96:111], v[212:215], v[188:191], v[96:111]
  s_waitcnt lgkmcnt(0)
  v_add_u32 v4, 0x8200, v4
  v_exp_f32 v59, v59
  v_exp_f32 v60, v60
  v_exp_f32 v61, v61
  v_exp_f32 v62, v62
  v_exp_f32 v63, v63
  v_min_u32 v4, v11, v4
  v_pk_fma_f32 v[48:49], v[48:49], s[22:23], s[22:23]
  v_pk_fma_f32 v[50:51], v[50:51], s[22:23], s[22:23]
  v_pk_fma_f32 v[52:53], v[52:53], s[22:23], s[22:23]
  v_pk_fma_f32 v[54:55], v[54:55], s[22:23], s[22:23]
  v_pk_fma_f32 v[56:57], v[56:57], s[22:23], s[22:23]
  v_pk_fma_f32 v[58:59], v[58:59], s[22:23], s[22:23]
  v_pk_fma_f32 v[60:61], v[60:61], s[22:23], s[22:23]
  v_pk_fma_f32 v[62:63], v[62:63], s[22:23], s[22:23]
  v_mfma_f32_32x32x16_bf16 v[112:127], a[216:219], a[192:195], 0
  ds_read_b128 v[192:195], v1 offset:26624
  ds_read_b128 v[196:199], v1 offset:27648
  v_rcp_f32 v48, v48
  v_rcp_f32 v49, v49
  v_mfma_f32_32x32x16_bf16 v[112:127], a[220:223], a[196:199], v[112:127]
  ds_read_b128 v[200:203], v1 offset:28672
  ds_read_b128 v[204:207], v1 offset:29696
  v_rcp_f32 v50, v50
  v_rcp_f32 v51, v51
  v_mfma_f32_32x32x16_bf16 v[128:143], a[224:227], a[200:203], 0
  ds_read_b128 v[208:211], v1 offset:30720
  ds_read_b128 v[212:215], v1 offset:31744
  v_rcp_f32_e64 v52, v52
  v_rcp_f32 v53, v53
  v_mfma_f32_32x32x16_bf16 v[128:143], a[228:231], a[204:207], v[128:143]
  s_nop 1
  v_cvt_pk_bf16_f32 v112, v112, v113
  v_cvt_pk_bf16_f32 v113, v114, v115
  v_cvt_pk_bf16_f32 v114, v116, v117
  v_cvt_pk_bf16_f32 v115, v118, v119
  v_rcp_f32_e64 v54, v54
  v_mfma_f32_32x32x16_bf16 v[144:159], a[232:235], a[208:211], 0
  ds_write_b128 v253, v[112:115] offset:24576
  v_cvt_pk_bf16_f32 v116, v120, v121
  v_cvt_pk_bf16_f32 v117, v122, v123
  v_cvt_pk_bf16_f32 v118, v124, v125
  v_cvt_pk_bf16_f32 v119, v126, v127
  v_mfma_f32_32x32x16_bf16 v[144:159], a[236:239], a[212:215], v[144:159]
  ds_write_b128 v253, v[116:119] offset:27648
  v_cvt_pk_bf16_f32 v128, v128, v129
  v_cvt_pk_bf16_f32 v129, v130, v131
  v_cvt_pk_bf16_f32 v130, v132, v133
  v_cvt_pk_bf16_f32 v131, v134, v135
  v_mfma_f32_32x32x16_bf16 v[16:31], a[72:75], v[160:163], 0
  ds_write_b128 v253, v[128:131] offset:25600
  v_cvt_pk_bf16_f32 v132, v136, v137
  v_cvt_pk_bf16_f32 v133, v138, v139
  v_cvt_pk_bf16_f32 v134, v140, v141
  v_cvt_pk_bf16_f32 v135, v142, v143
  v_mfma_f32_32x32x16_bf16 v[16:31], a[76:79], v[164:167], v[16:31]
  ds_write_b128 v253, v[132:135] offset:28672
  v_cvt_pk_bf16_f32 v144, v144, v145
  v_cvt_pk_bf16_f32 v145, v146, v147
  v_cvt_pk_bf16_f32 v146, v148, v149
  v_cvt_pk_bf16_f32 v147, v150, v151
  v_mfma_f32_32x32x16_bf16 v[16:31], a[80:83], v[168:171], v[16:31]
  ds_write_b128 v253, v[144:147] offset:26624
  v_cvt_pk_bf16_f32 v148, v152, v153
  v_cvt_pk_bf16_f32 v149, v154, v155
  v_cvt_pk_bf16_f32 v150, v156, v157
  v_cvt_pk_bf16_f32 v151, v158, v159
  v_mfma_f32_32x32x16_bf16 v[16:31], a[84:87], v[172:175], v[16:31]
  ds_write_b128 v253, v[148:151] offset:29696
  buffer_load_dword v249, v248, s[4:7], s29 offen
  v_rcp_f32_e64 v55, v55
  v_mfma_f32_32x32x16_bf16 v[16:31], a[88:91], v[176:179], v[16:31]
  v_rcp_f32 v56, v56
  v_rcp_f32 v57, v57
  v_rcp_f32_e64 v58, v58
  v_mfma_f32_32x32x16_bf16 v[16:31], a[92:95], v[180:183], v[16:31]
  s_waitcnt lgkmcnt(6)
  v_rcp_f32 v59, v59
  v_rcp_f32 v60, v60
  v_rcp_f32 v61, v61
  v_rcp_f32 v62, v62
  v_rcp_f32 v63, v63
  v_pk_mul_f32 v[32:33], v[32:33], v[48:49]
  v_pk_mul_f32 v[34:35], v[34:35], v[50:51]
  v_pk_mul_f32 v[36:37], v[36:37], v[52:53]
  v_pk_mul_f32 v[38:39], v[38:39], v[54:55]
  v_pk_mul_f32 v[40:41], v[40:41], v[56:57]
  v_pk_mul_f32 v[42:43], v[42:43], v[58:59]
  v_pk_mul_f32 v[44:45], v[44:45], v[60:61]
  v_pk_mul_f32 v[46:47], v[46:47], v[62:63]
  v_pk_fma_f32 v[48:49], v[16:17], v[16:17], s[20:21] neg_lo:[1,0,1] neg_hi:[1,0,1]
  v_pk_fma_f32 v[50:51], v[18:19], v[18:19], s[20:21] neg_lo:[1,0,1] neg_hi:[1,0,1]
  v_pk_fma_f32 v[52:53], v[20:21], v[20:21], s[20:21] neg_lo:[1,0,1] neg_hi:[1,0,1]
  v_pk_fma_f32 v[54:55], v[22:23], v[22:23], s[20:21] neg_lo:[1,0,1] neg_hi:[1,0,1]
  v_pk_fma_f32 v[56:57], v[24:25], v[24:25], s[20:21] neg_lo:[1,0,1] neg_hi:[1,0,1]
  v_pk_fma_f32 v[58:59], v[26:27], v[26:27], s[20:21] neg_lo:[1,0,1] neg_hi:[1,0,1]
  v_pk_fma_f32 v[60:61], v[28:29], v[28:29], s[20:21] neg_lo:[1,0,1] neg_hi:[1,0,1]
  v_pk_fma_f32 v[62:63], v[30:31], v[30:31], s[20:21] neg_lo:[1,0,1] neg_hi:[1,0,1]
  v_pk_mul_f32 v[48:49], v[16:17], v[48:49]
  v_pk_mul_f32 v[50:51], v[18:19], v[50:51]
  v_pk_mul_f32 v[52:53], v[20:21], v[52:53]
  v_pk_mul_f32 v[54:55], v[22:23], v[54:55]
  v_pk_mul_f32 v[56:57], v[24:25], v[56:57]
  v_cvt_pk_bf16_f32 v184, v32, v33
  v_cvt_pk_bf16_f32 v185, v34, v35
  v_cvt_pk_bf16_f32 v186, v36, v37
  v_cvt_pk_bf16_f32 v187, v38, v39
  v_pk_mul_f32 v[58:59], v[26:27], v[58:59]
  v_pk_mul_f32 v[60:61], v[28:29], v[60:61]
  v_pk_mul_f32 v[62:63], v[30:31], v[62:63]
  v_mfma_f32_32x32x16_bf16 v[64:79], v[192:195], v[184:187], v[64:79]
  ds_read_b128 v[220:223], v4 offset:96
  v_cvt_pk_bf16_f32 v188, v40, v41
  v_cvt_pk_bf16_f32 v189, v42, v43
  v_cvt_pk_bf16_f32 v190, v44, v45
  v_cvt_pk_bf16_f32 v191, v46, v47
  v_mfma_f32_32x32x16_bf16 v[80:95], v[196:199], v[184:187], v[80:95]
  ds_read_b128 v[228:231], v4 offset:288
  v_exp_f32 v48, v48
  v_exp_f32 v49, v49
  v_exp_f32_e64 v50, v50
  v_mfma_f32_32x32x16_bf16 v[96:111], v[200:203], v[184:187], v[96:111]
  ds_read_b128 v[236:239], v4 offset:480
  v_exp_f32 v51, v51
  v_exp_f32 v52, v52
  v_mfma_f32_32x32x16_bf16 v[64:79], v[204:207], v[188:191], v[64:79]
  v_exp_f32 v53, v53
  v_exp_f32 v54, v54
  v_exp_f32_e64 v55, v55
  v_mfma_f32_32x32x16_bf16 v[80:95], v[208:211], v[188:191], v[80:95]
  v_exp_f32 v56, v56
  v_exp_f32 v57, v57
  v_exp_f32_e64 v58, v58
  v_mfma_f32_32x32x16_bf16 v[96:111], v[212:215], v[188:191], v[96:111]
  s_waitcnt lgkmcnt(0)
  v_exp_f32 v59, v59
  v_exp_f32 v60, v60
  v_exp_f32 v61, v61
  v_exp_f32_e64 v62, v62
  v_exp_f32_e64 v63, v63
  v_pk_fma_f32 v[48:49], v[48:49], s[22:23], s[22:23]
  v_pk_fma_f32 v[50:51], v[50:51], s[22:23], s[22:23]
  v_pk_fma_f32 v[52:53], v[52:53], s[22:23], s[22:23]
  v_pk_fma_f32 v[54:55], v[54:55], s[22:23], s[22:23]
  v_pk_fma_f32 v[56:57], v[56:57], s[22:23], s[22:23]
  v_pk_fma_f32 v[58:59], v[58:59], s[22:23], s[22:23]
  v_pk_fma_f32 v[60:61], v[60:61], s[22:23], s[22:23]
  v_pk_fma_f32 v[62:63], v[62:63], s[22:23], s[22:23]
  s_barrier
  v_mfma_f32_32x32x16_bf16 v[32:47], a[96:99], v[160:163], 0
  ds_read_b128 v[192:195], v0 offset:24576
  ds_read_b128 v[196:199], v0 offset:25600
  v_rcp_f32 v48, v48
  v_rcp_f32_e64 v49, v49
  v_mfma_f32_16x16x32_bf16 v[136:139], a[240:243], v[220:223], 0
  ds_read_b128 v[216:219], v3 offset:2800
  ds_read_b128 v[220:223], v4 offset:112
  v_mfma_f32_32x32x16_bf16 v[32:47], a[100:103], v[164:167], v[32:47]
  ds_read_b128 v[200:203], v0 offset:26624
  ds_read_b128 v[204:207], v0 offset:27648
  v_rcp_f32 v50, v50
  v_rcp_f32 v51, v51
  v_mfma_f32_16x16x32_bf16 v[136:139], a[244:247], v[228:231], v[136:139]
  ds_read_b128 v[224:227], v3 offset:7600
  ds_read_b128 v[228:231], v4 offset:304
  v_mfma_f32_32x32x16_bf16 v[32:47], a[104:107], v[168:171], v[32:47]
  ds_read_b128 v[208:211], v0 offset:28672
  ds_read_b128 v[212:215], v0 offset:29696
  v_rcp_f32 v52, v52
  v_rcp_f32 v53, v53
  v_mfma_f32_16x16x32_bf16 v[136:139], a[248:251], v[236:239], v[136:139]
  ds_read_b128 v[232:235], v3 offset:12400
  ds_read_b128 v[236:239], v4 offset:496
  v_mfma_f32_32x32x16_bf16 v[32:47], a[108:111], v[172:175], v[32:47]
  v_rcp_f32 v54, v54
  v_rcp_f32 v55, v55
  v_rcp_f32_e64 v56, v56
  v_mfma_f32_32x32x16_bf16 v[32:47], a[112:115], v[176:179], v[32:47]
  v_rcp_f32 v57, v57
  v_rcp_f32 v58, v58
  v_rcp_f32_e64 v59, v59
  v_mfma_f32_32x32x16_bf16 v[32:47], a[116:119], v[180:183], v[32:47]
  s_waitcnt lgkmcnt(0)
  v_rcp_f32 v60, v60
  v_rcp_f32 v61, v61
  v_rcp_f32 v62, v62
  v_rcp_f32_e64 v63, v63
  v_pk_mul_f32 v[16:17], v[16:17], v[48:49]
  v_pk_mul_f32 v[18:19], v[18:19], v[50:51]
  v_pk_mul_f32 v[20:21], v[20:21], v[52:53]
  v_pk_mul_f32 v[22:23], v[22:23], v[54:55]
  v_pk_mul_f32 v[24:25], v[24:25], v[56:57]
  v_pk_mul_f32 v[26:27], v[26:27], v[58:59]
  v_pk_mul_f32 v[28:29], v[28:29], v[60:61]
  v_pk_mul_f32 v[30:31], v[30:31], v[62:63]
  v_pk_add_f32 v[12:13], v[136:137], v[138:139]
  v_pk_mul_f32 v[14:15], v[136:137], v[136:137]
  v_pk_fma_f32 v[14:15], v[138:139], v[138:139], v[14:15]
  v_pk_fma_f32 v[48:49], v[32:33], v[32:33], s[20:21] neg_lo:[1,0,1] neg_hi:[1,0,1]
  v_pk_fma_f32 v[50:51], v[34:35], v[34:35], s[20:21] neg_lo:[1,0,1] neg_hi:[1,0,1]
  v_pk_fma_f32 v[52:53], v[36:37], v[36:37], s[20:21] neg_lo:[1,0,1] neg_hi:[1,0,1]
  v_pk_fma_f32 v[54:55], v[38:39], v[38:39], s[20:21] neg_lo:[1,0,1] neg_hi:[1,0,1]
  v_pk_fma_f32 v[56:57], v[40:41], v[40:41], s[20:21] neg_lo:[1,0,1] neg_hi:[1,0,1]
  v_pk_fma_f32 v[58:59], v[42:43], v[42:43], s[20:21] neg_lo:[1,0,1] neg_hi:[1,0,1]
  v_pk_fma_f32 v[60:61], v[44:45], v[44:45], s[20:21] neg_lo:[1,0,1] neg_hi:[1,0,1]
  v_pk_fma_f32 v[62:63], v[46:47], v[46:47], s[20:21] neg_lo:[1,0,1] neg_hi:[1,0,1]
  v_pk_mul_f32 v[48:49], v[32:33], v[48:49]
  v_pk_mul_f32 v[50:51], v[34:35], v[50:51]
  v_pk_mul_f32 v[52:53], v[36:37], v[52:53]
  v_pk_mul_f32 v[54:55], v[38:39], v[54:55]
  v_pk_mul_f32 v[56:57], v[40:41], v[56:57]
  v_pk_mul_f32 v[58:59], v[42:43], v[58:59]
  v_pk_mul_f32 v[60:61], v[44:45], v[60:61]
  v_pk_mul_f32 v[62:63], v[46:47], v[62:63]
  v_mfma_f32_16x16x32_bf16 v[140:143], v[216:219], v[220:223], 0
  v_cvt_pk_bf16_f32 v184, v16, v17
  v_cvt_pk_bf16_f32 v185, v18, v19
  v_mfma_f32_16x16x32_bf16 v[140:143], v[224:227], v[228:231], v[140:143]
  v_cvt_pk_bf16_f32 v186, v20, v21
  v_cvt_pk_bf16_f32 v187, v22, v23
  v_mfma_f32_16x16x32_bf16 v[140:143], v[232:235], v[236:239], v[140:143]
  ds_read_b128 v[220:223], v4 offset:128
  v_mfma_f32_32x32x16_bf16 v[64:79], v[192:195], v[184:187], v[64:79]
  ds_read_b128 v[224:227], v3 offset:8000
  ds_read_b128 v[228:231], v4 offset:320
  v_cvt_pk_bf16_f32 v188, v24, v25
  v_cvt_pk_bf16_f32 v189, v26, v27
  v_cvt_pk_bf16_f32 v190, v28, v29
  v_cvt_pk_bf16_f32 v191, v30, v31
  v_mfma_f32_32x32x16_bf16 v[80:95], v[196:199], v[184:187], v[80:95]
  ds_read_b128 v[232:235], v3 offset:12800
  ds_read_b128 v[236:239], v4 offset:512
  v_exp_f32 v48, v48
  v_exp_f32 v49, v49
  v_mfma_f32_32x32x16_bf16 v[96:111], v[200:203], v[184:187], v[96:111]
  s_sub_u32 s31, s32, 32
  v_exp_f32 v50, v50
  v_exp_f32 v51, v51
  v_exp_f32 v52, v52
  v_mfma_f32_32x32x16_bf16 v[64:79], v[204:207], v[188:191], v[64:79]
  v_exp_f32 v53, v53
  v_exp_f32 v54, v54
  v_exp_f32_e64 v55, v55
  v_mfma_f32_32x32x16_bf16 v[80:95], v[208:211], v[188:191], v[80:95]
  v_exp_f32 v56, v56
  v_exp_f32 v57, v57
  v_exp_f32_e64 v58, v58
  v_mfma_f32_32x32x16_bf16 v[96:111], v[212:215], v[188:191], v[96:111]
  s_waitcnt lgkmcnt(0)
  v_exp_f32 v59, v59
  v_exp_f32 v60, v60
  v_exp_f32 v61, v61
  v_exp_f32 v62, v62
  v_exp_f32 v63, v63
  v_pk_add_f32 v[12:13], v[12:13], v[140:141]
  v_pk_fma_f32 v[14:15], v[140:141], v[140:141], v[14:15]
  v_pk_add_f32 v[12:13], v[12:13], v[142:143]
  v_pk_fma_f32 v[14:15], v[142:143], v[142:143], v[14:15]
  v_pk_fma_f32 v[48:49], v[48:49], s[22:23], s[22:23]
  v_pk_fma_f32 v[50:51], v[50:51], s[22:23], s[22:23]
  v_pk_fma_f32 v[52:53], v[52:53], s[22:23], s[22:23]
  v_pk_fma_f32 v[54:55], v[54:55], s[22:23], s[22:23]
  v_pk_fma_f32 v[56:57], v[56:57], s[22:23], s[22:23]
  v_pk_fma_f32 v[58:59], v[58:59], s[22:23], s[22:23]
  v_pk_fma_f32 v[60:61], v[60:61], s[22:23], s[22:23]
  v_pk_fma_f32 v[62:63], v[62:63], s[22:23], s[22:23]
  v_mfma_f32_32x32x16_bf16 v[16:31], a[120:123], v[160:163], 0
  ds_read_b128 v[192:195], v0 offset:30720
  ds_read_b128 v[196:199], v0 offset:31744
  v_rcp_f32 v48, v48
  v_rcp_f32 v49, v49
  v_mfma_f32_16x16x32_bf16 v[144:147], a[252:255], v[220:223], 0
  ds_read_b128 v[216:219], v3 offset:3600
  ds_read_b128 v[220:223], v4 offset:144
  v_mfma_f32_32x32x16_bf16 v[16:31], a[124:127], v[164:167], v[16:31]
  ds_read_b128 v[200:203], v0 offset:32768
  ds_read_b128 v[204:207], v0 offset:33792
  v_rcp_f32 v50, v50
  v_rcp_f32 v51, v51
  v_mfma_f32_16x16x32_bf16 v[144:147], v[224:227], v[228:231], v[144:147]
  ds_read_b128 v[224:227], v3 offset:8400
  ds_read_b128 v[228:231], v4 offset:336
  v_mfma_f32_32x32x16_bf16 v[16:31], a[128:131], v[168:171], v[16:31]
  ds_read_b128 v[208:211], v0 offset:34816
  ds_read_b128 v[212:215], v0 offset:35840
  v_rcp_f32 v52, v52
  v_rcp_f32 v53, v53
  v_mfma_f32_16x16x32_bf16 v[144:147], v[232:235], v[236:239], v[144:147]
  ds_read_b128 v[232:235], v3 offset:13200
  ds_read_b128 v[236:239], v4 offset:528
  v_mfma_f32_32x32x16_bf16 v[16:31], a[132:135], v[172:175], v[16:31]
  v_rcp_f32 v54, v54
  v_rcp_f32 v55, v55
  v_rcp_f32_e64 v56, v56
  v_mfma_f32_32x32x16_bf16 v[16:31], a[136:139], v[176:179], v[16:31]
  ds_read_b128 a[192:195], v0
  ds_read_b128 a[196:199], v0 offset:1024
  ds_read_b128 a[200:203], v0 offset:2048
  v_rcp_f32 v57, v57
  v_rcp_f32 v58, v58
  v_mfma_f32_32x32x16_bf16 v[16:31], a[140:143], v[180:183], v[16:31]
  s_waitcnt lgkmcnt(3)
  v_rcp_f32 v59, v59
  v_rcp_f32 v60, v60
  v_rcp_f32 v61, v61
  v_rcp_f32 v62, v62
  v_rcp_f32 v63, v63
  v_pk_mul_f32 v[32:33], v[32:33], v[48:49]
  v_pk_mul_f32 v[34:35], v[34:35], v[50:51]
  v_pk_mul_f32 v[36:37], v[36:37], v[52:53]
  v_pk_mul_f32 v[38:39], v[38:39], v[54:55]
  v_pk_mul_f32 v[40:41], v[40:41], v[56:57]
  v_pk_mul_f32 v[42:43], v[42:43], v[58:59]
  v_pk_mul_f32 v[44:45], v[44:45], v[60:61]
  v_pk_mul_f32 v[46:47], v[46:47], v[62:63]
  v_pk_add_f32 v[12:13], v[12:13], v[144:145]
  v_pk_fma_f32 v[14:15], v[144:145], v[144:145], v[14:15]
  v_pk_add_f32 v[12:13], v[12:13], v[146:147]
  v_pk_fma_f32 v[14:15], v[146:147], v[146:147], v[14:15]
  v_pk_fma_f32 v[48:49], v[16:17], v[16:17], s[20:21] neg_lo:[1,0,1] neg_hi:[1,0,1]
  v_pk_fma_f32 v[50:51], v[18:19], v[18:19], s[20:21] neg_lo:[1,0,1] neg_hi:[1,0,1]
  v_pk_fma_f32 v[52:53], v[20:21], v[20:21], s[20:21] neg_lo:[1,0,1] neg_hi:[1,0,1]
  v_pk_fma_f32 v[54:55], v[22:23], v[22:23], s[20:21] neg_lo:[1,0,1] neg_hi:[1,0,1]
  v_pk_fma_f32 v[56:57], v[24:25], v[24:25], s[20:21] neg_lo:[1,0,1] neg_hi:[1,0,1]
  v_pk_fma_f32 v[58:59], v[26:27], v[26:27], s[20:21] neg_lo:[1,0,1] neg_hi:[1,0,1]
  v_pk_fma_f32 v[60:61], v[28:29], v[28:29], s[20:21] neg_lo:[1,0,1] neg_hi:[1,0,1]
  v_pk_fma_f32 v[62:63], v[30:31], v[30:31], s[20:21] neg_lo:[1,0,1] neg_hi:[1,0,1]
  v_pk_mul_f32 v[48:49], v[16:17], v[48:49]
  v_pk_mul_f32 v[50:51], v[18:19], v[50:51]
  v_pk_mul_f32 v[52:53], v[20:21], v[52:53]
  v_pk_mul_f32 v[54:55], v[22:23], v[54:55]
  v_pk_mul_f32 v[56:57], v[24:25], v[56:57]
  v_pk_mul_f32 v[58:59], v[26:27], v[58:59]
  v_pk_mul_f32 v[60:61], v[28:29], v[60:61]
  v_pk_mul_f32 v[62:63], v[30:31], v[62:63]
  v_mfma_f32_16x16x32_bf16 v[148:151], v[216:219], v[220:223], 0
  v_cvt_pk_bf16_f32 v184, v32, v33
  v_cvt_pk_bf16_f32 v185, v34, v35
  v_mfma_f32_16x16x32_bf16 v[148:151], v[224:227], v[228:231], v[148:151]
  v_cvt_pk_bf16_f32 v186, v36, v37
  v_cvt_pk_bf16_f32 v187, v38, v39
  v_mfma_f32_16x16x32_bf16 v[148:151], v[232:235], v[236:239], v[148:151]
  ds_read_b128 v[216:219], v3 offset:4000
  ds_read_b128 v[220:223], v4 offset:160
  v_mfma_f32_32x32x16_bf16 v[64:79], v[192:195], v[184:187], v[64:79]
  ds_read_b128 v[224:227], v3 offset:8800
  ds_read_b128 v[228:231], v4 offset:352
  v_cvt_pk_bf16_f32 v188, v40, v41
  v_cvt_pk_bf16_f32 v189, v42, v43
  v_cvt_pk_bf16_f32 v190, v44, v45
  v_cvt_pk_bf16_f32 v191, v46, v47
  v_mfma_f32_32x32x16_bf16 v[80:95], v[196:199], v[184:187], v[80:95]
  ds_read_b128 v[232:235], v3 offset:13600
  ds_read_b128 v[236:239], v4 offset:544
  v_exp_f32 v48, v48
  v_exp_f32 v49, v49
  v_mfma_f32_32x32x16_bf16 v[96:111], v[200:203], v[184:187], v[96:111]
  v_exp_f32 v50, v50
  v_exp_f32 v51, v51
  v_exp_f32_e64 v52, v52
  v_mfma_f32_32x32x16_bf16 v[64:79], v[204:207], v[188:191], v[64:79]
  v_exp_f32 v53, v53
  v_exp_f32 v54, v54
  v_exp_f32_e64 v55, v55
  v_mfma_f32_32x32x16_bf16 v[80:95], v[208:211], v[188:191], v[80:95]
  ds_read_b128 a[204:207], v0 offset:3072
  ds_read_b128 a[208:211], v0 offset:4096
  ds_read_b128 a[212:215], v0 offset:5120
  v_exp_f32 v56, v56
  v_exp_f32 v57, v57
  v_mfma_f32_32x32x16_bf16 v[96:111], v[212:215], v[188:191], v[96:111]
  s_waitcnt lgkmcnt(3)
  v_exp_f32 v58, v58
  v_exp_f32 v59, v59
  v_exp_f32 v60, v60
  v_exp_f32 v61, v61
  v_exp_f32 v62, v62
  v_exp_f32_e64 v63, v63
  v_pk_add_f32 v[12:13], v[12:13], v[148:149]
  v_pk_fma_f32 v[14:15], v[148:149], v[148:149], v[14:15]
  v_pk_add_f32 v[12:13], v[12:13], v[150:151]
  v_pk_fma_f32 v[14:15], v[150:151], v[150:151], v[14:15]
  v_pk_fma_f32 v[48:49], v[48:49], s[22:23], s[22:23]
  v_pk_fma_f32 v[50:51], v[50:51], s[22:23], s[22:23]
  v_pk_fma_f32 v[52:53], v[52:53], s[22:23], s[22:23]
  v_pk_fma_f32 v[54:55], v[54:55], s[22:23], s[22:23]
  v_pk_fma_f32 v[56:57], v[56:57], s[22:23], s[22:23]
  v_pk_fma_f32 v[58:59], v[58:59], s[22:23], s[22:23]
  v_pk_fma_f32 v[60:61], v[60:61], s[22:23], s[22:23]
  v_pk_fma_f32 v[62:63], v[62:63], s[22:23], s[22:23]
  v_mfma_f32_32x32x16_bf16 v[32:47], a[144:147], v[160:163], 0
  ds_read_b128 v[192:195], v0 offset:36864
  ds_read_b128 v[196:199], v0 offset:37888
  v_rcp_f32 v48, v48
  v_rcp_f32 v49, v49
  v_mfma_f32_16x16x32_bf16 v[152:155], v[216:219], v[220:223], 0
  ds_read_b128 v[216:219], v3 offset:4400
  ds_read_b128 v[220:223], v4 offset:176
  v_mfma_f32_32x32x16_bf16 v[32:47], a[148:151], v[164:167], v[32:47]
  ds_read_b128 v[200:203], v0 offset:38912
  ds_read_b128 v[204:207], v0 offset:39936
  v_rcp_f32 v50, v50
  v_rcp_f32 v51, v51
  v_mfma_f32_16x16x32_bf16 v[152:155], v[224:227], v[228:231], v[152:155]
  ds_read_b128 v[224:227], v3 offset:9200
  ds_read_b128 v[228:231], v4 offset:368
  v_mfma_f32_32x32x16_bf16 v[32:47], a[152:155], v[168:171], v[32:47]
  ds_read_b128 v[208:211], v0 offset:40960
  ds_read_b128 v[212:215], v0 offset:41984
  v_rcp_f32 v52, v52
  v_rcp_f32 v53, v53
  v_mfma_f32_16x16x32_bf16 v[152:155], v[232:235], v[236:239], v[152:155]
  ds_read_b128 v[232:235], v3 offset:14000
  ds_read_b128 v[236:239], v4 offset:560
  v_mfma_f32_32x32x16_bf16 v[32:47], a[156:159], v[172:175], v[32:47]
  v_rcp_f32 v54, v54
  v_rcp_f32 v55, v55
  v_rcp_f32_e64 v56, v56
  v_mfma_f32_32x32x16_bf16 v[32:47], a[160:163], v[176:179], v[32:47]
  ds_read_b128 a[216:219], v0 offset:6144
  ds_read_b128 a[220:223], v0 offset:7168
  ds_read_b128 a[224:227], v0 offset:8192
  v_rcp_f32 v57, v57
  v_rcp_f32 v58, v58
  v_mfma_f32_32x32x16_bf16 v[32:47], a[164:167], v[180:183], v[32:47]
  s_waitcnt lgkmcnt(3)
  v_rcp_f32 v59, v59
  v_rcp_f32 v60, v60
  v_rcp_f32 v61, v61
  v_rcp_f32 v62, v62
  v_rcp_f32 v63, v63
  v_pk_mul_f32 v[16:17], v[16:17], v[48:49]
  v_pk_mul_f32 v[18:19], v[18:19], v[50:51]
  v_pk_mul_f32 v[20:21], v[20:21], v[52:53]
  v_pk_mul_f32 v[22:23], v[22:23], v[54:55]
  v_pk_mul_f32 v[24:25], v[24:25], v[56:57]
  v_pk_mul_f32 v[26:27], v[26:27], v[58:59]
  v_pk_mul_f32 v[28:29], v[28:29], v[60:61]
  v_pk_mul_f32 v[30:31], v[30:31], v[62:63]
  v_pk_add_f32 v[12:13], v[12:13], v[152:153]
  v_pk_fma_f32 v[14:15], v[152:153], v[152:153], v[14:15]
  v_pk_add_f32 v[12:13], v[12:13], v[154:155]
  v_pk_fma_f32 v[14:15], v[154:155], v[154:155], v[14:15]
  v_pk_fma_f32 v[48:49], v[32:33], v[32:33], s[20:21] neg_lo:[1,0,1] neg_hi:[1,0,1]
  v_pk_fma_f32 v[50:51], v[34:35], v[34:35], s[20:21] neg_lo:[1,0,1] neg_hi:[1,0,1]
  v_pk_fma_f32 v[52:53], v[36:37], v[36:37], s[20:21] neg_lo:[1,0,1] neg_hi:[1,0,1]
  v_pk_fma_f32 v[54:55], v[38:39], v[38:39], s[20:21] neg_lo:[1,0,1] neg_hi:[1,0,1]
  v_pk_fma_f32 v[56:57], v[40:41], v[40:41], s[20:21] neg_lo:[1,0,1] neg_hi:[1,0,1]
  v_pk_fma_f32 v[58:59], v[42:43], v[42:43], s[20:21] neg_lo:[1,0,1] neg_hi:[1,0,1]
  v_pk_fma_f32 v[60:61], v[44:45], v[44:45], s[20:21] neg_lo:[1,0,1] neg_hi:[1,0,1]
  v_pk_fma_f32 v[62:63], v[46:47], v[46:47], s[20:21] neg_lo:[1,0,1] neg_hi:[1,0,1]
  v_pk_mul_f32 v[48:49], v[32:33], v[48:49]
  v_pk_mul_f32 v[50:51], v[34:35], v[50:51]
  v_pk_mul_f32 v[52:53], v[36:37], v[52:53]
  v_pk_mul_f32 v[54:55], v[38:39], v[54:55]
  v_pk_mul_f32 v[56:57], v[40:41], v[56:57]
  v_pk_mul_f32 v[58:59], v[42:43], v[58:59]
  v_pk_mul_f32 v[60:61], v[44:45], v[60:61]
  v_pk_mul_f32 v[62:63], v[46:47], v[62:63]
  v_mfma_f32_16x16x32_bf16 v[156:159], v[216:219], v[220:223], 0
  v_cvt_pk_bf16_f32 v184, v16, v17
  v_cvt_pk_bf16_f32 v185, v18, v19
  v_mfma_f32_16x16x32_bf16 v[156:159], v[224:227], v[228:231], v[156:159]
  v_cvt_pk_bf16_f32 v186, v20, v21
  v_cvt_pk_bf16_f32 v187, v22, v23
  v_mfma_f32_16x16x32_bf16 v[156:159], v[232:235], v[236:239], v[156:159]
  ds_read_b128 v[216:219], v3
  ds_read_b128 v[220:223], v4
  v_mfma_f32_32x32x16_bf16 v[64:79], v[192:195], v[184:187], v[64:79]
  ds_read_b128 v[224:227], v3 offset:4800
  ds_read_b128 v[228:231], v4 offset:192
  v_cvt_pk_bf16_f32 v188, v24, v25
  v_cvt_pk_bf16_f32 v189, v26, v27
  v_cvt_pk_bf16_f32 v190, v28, v29
  v_cvt_pk_bf16_f32 v191, v30, v31
  v_mfma_f32_32x32x16_bf16 v[80:95], v[196:199], v[184:187], v[80:95]
  ds_read_b128 v[232:235], v3 offset:9600
  ds_read_b128 v[236:239], v4 offset:384
  v_exp_f32 v48, v48
  v_exp_f32 v49, v49
  v_mfma_f32_32x32x16_bf16 v[96:111], v[200:203], v[184:187], v[96:111]
  v_exp_f32 v50, v50
  v_exp_f32 v51, v51
  v_exp_f32_e64 v52, v52
  v_mfma_f32_32x32x16_bf16 v[64:79], v[204:207], v[188:191], v[64:79]
  v_exp_f32 v53, v53
  v_exp_f32 v54, v54
  v_exp_f32_e64 v55, v55
  v_mfma_f32_32x32x16_bf16 v[80:95], v[208:211], v[188:191], v[80:95]
  ds_read_b128 a[228:231], v0 offset:9216
  ds_read_b128 a[232:235], v0 offset:10240
  ds_read_b128 a[236:239], v0 offset:11264
  v_exp_f32 v56, v56
  v_exp_f32 v57, v57
  v_mfma_f32_32x32x16_bf16 v[96:111], v[212:215], v[188:191], v[96:111]
  s_waitcnt lgkmcnt(3)
  v_exp_f32 v58, v58
  v_exp_f32 v59, v59
  v_exp_f32 v60, v60
  v_exp_f32 v61, v61
  v_exp_f32 v62, v62
  v_exp_f32_e64 v63, v63
  v_pk_add_f32 v[12:13], v[12:13], v[156:157]
  v_pk_fma_f32 v[14:15], v[156:157], v[156:157], v[14:15]
  v_pk_add_f32 v[12:13], v[12:13], v[158:159]
  v_pk_fma_f32 v[14:15], v[158:159], v[158:159], v[14:15]
  v_pk_fma_f32 v[48:49], v[48:49], s[22:23], s[22:23]
  v_pk_fma_f32 v[50:51], v[50:51], s[22:23], s[22:23]
  v_pk_fma_f32 v[52:53], v[52:53], s[22:23], s[22:23]
  v_pk_fma_f32 v[54:55], v[54:55], s[22:23], s[22:23]
  v_pk_fma_f32 v[56:57], v[56:57], s[22:23], s[22:23]
  v_pk_fma_f32 v[58:59], v[58:59], s[22:23], s[22:23]
  v_pk_fma_f32 v[60:61], v[60:61], s[22:23], s[22:23]
  v_pk_fma_f32 v[62:63], v[62:63], s[22:23], s[22:23]
  v_mfma_f32_32x32x16_bf16 v[16:31], a[168:171], v[160:163], 0
  ds_read_b128 v[192:195], v0 offset:43008
  ds_read_b128 v[196:199], v0 offset:44032
  v_rcp_f32 v48, v48
  v_rcp_f32 v49, v49
  v_mfma_f32_16x16x32_bf16 v[112:115], v[216:219], v[220:223], 0
  ds_read_b128 v[216:219], v3 offset:400
  ds_read_b128 v[220:223], v4 offset:16
  v_mfma_f32_32x32x16_bf16 v[16:31], a[172:175], v[164:167], v[16:31]
  ds_read_b128 v[200:203], v0 offset:45056
  ds_read_b128 v[204:207], v0 offset:46080
  v_rcp_f32 v50, v50
  v_rcp_f32 v51, v51
  v_mfma_f32_16x16x32_bf16 v[112:115], v[224:227], v[228:231], v[112:115]
  ds_read_b128 v[224:227], v3 offset:5200
  ds_read_b128 v[228:231], v4 offset:208
  v_mfma_f32_32x32x16_bf16 v[16:31], a[176:179], v[168:171], v[16:31]
  ds_read_b128 v[208:211], v0 offset:47104
  ds_read_b128 v[212:215], v0 offset:48128
  v_rcp_f32 v52, v52
  v_rcp_f32 v53, v53
  v_mfma_f32_16x16x32_bf16 v[112:115], v[232:235], v[236:239], v[112:115]
  ds_read_b128 v[232:235], v3 offset:10000
  ds_read_b128 v[236:239], v4 offset:400
  v_mfma_f32_32x32x16_bf16 v[16:31], a[180:183], v[172:175], v[16:31]
  v_rcp_f32 v54, v54
  v_rcp_f32 v55, v55
  v_rcp_f32_e64 v56, v56
  v_mfma_f32_32x32x16_bf16 v[16:31], a[184:187], v[176:179], v[16:31]
  v_rcp_f32 v57, v57
  v_rcp_f32 v58, v58
  v_rcp_f32_e64 v59, v59
  v_mfma_f32_32x32x16_bf16 v[16:31], a[188:191], v[180:183], v[16:31]
  s_waitcnt lgkmcnt(0)
  v_rcp_f32 v60, v60
  v_rcp_f32 v61, v61
  v_rcp_f32 v62, v62
  v_rcp_f32_e64 v63, v63
  v_pk_mul_f32 v[32:33], v[32:33], v[48:49]
  v_pk_mul_f32 v[34:35], v[34:35], v[50:51]
  v_pk_mul_f32 v[36:37], v[36:37], v[52:53]
  v_pk_mul_f32 v[38:39], v[38:39], v[54:55]
  v_pk_mul_f32 v[40:41], v[40:41], v[56:57]
  v_pk_mul_f32 v[42:43], v[42:43], v[58:59]
  v_pk_mul_f32 v[44:45], v[44:45], v[60:61]
  v_pk_mul_f32 v[46:47], v[46:47], v[62:63]
  v_pk_add_f32 v[12:13], v[12:13], v[112:113]
  v_pk_fma_f32 v[14:15], v[112:113], v[112:113], v[14:15]
  v_pk_add_f32 v[12:13], v[12:13], v[114:115]
  v_pk_fma_f32 v[14:15], v[114:115], v[114:115], v[14:15]
  v_pk_fma_f32 v[48:49], v[16:17], v[16:17], s[20:21] neg_lo:[1,0,1] neg_hi:[1,0,1]
  v_pk_fma_f32 v[50:51], v[18:19], v[18:19], s[20:21] neg_lo:[1,0,1] neg_hi:[1,0,1]
  v_pk_fma_f32 v[52:53], v[20:21], v[20:21], s[20:21] neg_lo:[1,0,1] neg_hi:[1,0,1]
  v_pk_fma_f32 v[54:55], v[22:23], v[22:23], s[20:21] neg_lo:[1,0,1] neg_hi:[1,0,1]
  v_pk_fma_f32 v[56:57], v[24:25], v[24:25], s[20:21] neg_lo:[1,0,1] neg_hi:[1,0,1]
  v_pk_fma_f32 v[58:59], v[26:27], v[26:27], s[20:21] neg_lo:[1,0,1] neg_hi:[1,0,1]
  v_pk_fma_f32 v[60:61], v[28:29], v[28:29], s[20:21] neg_lo:[1,0,1] neg_hi:[1,0,1]
  v_pk_fma_f32 v[62:63], v[30:31], v[30:31], s[20:21] neg_lo:[1,0,1] neg_hi:[1,0,1]
  v_pk_mul_f32 v[48:49], v[16:17], v[48:49]
  v_pk_mul_f32 v[50:51], v[18:19], v[50:51]
  v_pk_mul_f32 v[52:53], v[20:21], v[52:53]
  v_pk_mul_f32 v[54:55], v[22:23], v[54:55]
  v_pk_mul_f32 v[56:57], v[24:25], v[56:57]
  v_pk_mul_f32 v[58:59], v[26:27], v[58:59]
  v_pk_mul_f32 v[60:61], v[28:29], v[60:61]
  v_pk_mul_f32 v[62:63], v[30:31], v[62:63]
  v_mfma_f32_16x16x32_bf16 v[116:119], v[216:219], v[220:223], 0
  v_cvt_pk_bf16_f32 v184, v32, v33
  v_cvt_pk_bf16_f32 v185, v34, v35
  v_mfma_f32_16x16x32_bf16 v[116:119], v[224:227], v[228:231], v[116:119]
  v_cvt_pk_bf16_f32 v186, v36, v37
  v_cvt_pk_bf16_f32 v187, v38, v39
  v_mfma_f32_16x16x32_bf16 v[116:119], v[232:235], v[236:239], v[116:119]
  ds_read_b128 v[216:219], v3 offset:800
  ds_read_b128 v[220:223], v4 offset:32
  v_mfma_f32_32x32x16_bf16 v[64:79], v[192:195], v[184:187], v[64:79]
  ds_read_b128 v[224:227], v3 offset:5600
  ds_read_b128 v[228:231], v4 offset:224
  v_cvt_pk_bf16_f32 v188, v40, v41
  v_cvt_pk_bf16_f32 v189, v42, v43
  v_cvt_pk_bf16_f32 v190, v44, v45
  v_cvt_pk_bf16_f32 v191, v46, v47
  v_mfma_f32_32x32x16_bf16 v[80:95], v[196:199], v[184:187], v[80:95]
  ds_read_b128 v[232:235], v3 offset:10400
  ds_read_b128 v[236:239], v4 offset:416
  v_exp_f32 v48, v48
  v_exp_f32 v49, v49
  v_mfma_f32_32x32x16_bf16 v[96:111], v[200:203], v[184:187], v[96:111]
  v_exp_f32 v50, v50
  v_exp_f32 v51, v51
  v_exp_f32_e64 v52, v52
  v_mfma_f32_32x32x16_bf16 v[64:79], v[204:207], v[188:191], v[64:79]
  v_exp_f32 v53, v53
  v_exp_f32 v54, v54
  v_exp_f32_e64 v55, v55
  v_mfma_f32_32x32x16_bf16 v[80:95], v[208:211], v[188:191], v[80:95]
  v_exp_f32 v56, v56
  v_exp_f32 v57, v57
  v_exp_f32_e64 v58, v58
  v_mfma_f32_32x32x16_bf16 v[96:111], v[212:215], v[188:191], v[96:111]
  s_waitcnt lgkmcnt(0)
  v_exp_f32 v59, v59
  v_exp_f32 v60, v60
  v_exp_f32 v61, v61
  v_exp_f32 v62, v62
  v_exp_f32 v63, v63
  v_pk_add_f32 v[12:13], v[12:13], v[116:117]
  v_pk_fma_f32 v[14:15], v[116:117], v[116:117], v[14:15]
  v_pk_add_f32 v[12:13], v[12:13], v[118:119]
  v_pk_fma_f32 v[14:15], v[118:119], v[118:119], v[14:15]
  v_pk_fma_f32 v[48:49], v[48:49], s[22:23], s[22:23]
  v_pk_fma_f32 v[50:51], v[50:51], s[22:23], s[22:23]
  v_pk_fma_f32 v[52:53], v[52:53], s[22:23], s[22:23]
  v_pk_fma_f32 v[54:55], v[54:55], s[22:23], s[22:23]
  v_pk_fma_f32 v[56:57], v[56:57], s[22:23], s[22:23]
  v_pk_fma_f32 v[58:59], v[58:59], s[22:23], s[22:23]
  v_pk_fma_f32 v[60:61], v[60:61], s[22:23], s[22:23]
  v_pk_fma_f32 v[62:63], v[62:63], s[22:23], s[22:23]
  v_mfma_f32_32x32x16_bf16 v[32:47], a[192:195], v[160:163], 0
  ds_read_b128 v[192:195], v0 offset:49152
  ds_read_b128 v[196:199], v0 offset:50176
  v_rcp_f32 v48, v48
  v_rcp_f32 v49, v49
  v_mfma_f32_16x16x32_bf16 v[120:123], v[216:219], v[220:223], 0
  ds_read_b128 v[216:219], v3 offset:1200
  ds_read_b128 v[220:223], v4 offset:48
  v_mfma_f32_32x32x16_bf16 v[32:47], a[196:199], v[164:167], v[32:47]
  ds_read_b128 v[200:203], v0 offset:51200
  ds_read_b128 v[204:207], v0 offset:52224
  v_rcp_f32 v50, v50
  v_rcp_f32 v51, v51
  v_mfma_f32_16x16x32_bf16 v[120:123], v[224:227], v[228:231], v[120:123]
  ds_read_b128 v[224:227], v3 offset:6000
  ds_read_b128 v[228:231], v4 offset:240
  v_mfma_f32_32x32x16_bf16 v[32:47], a[200:203], v[168:171], v[32:47]
  ds_read_b128 v[208:211], v0 offset:53248
  ds_read_b128 v[212:215], v0 offset:54272
  v_rcp_f32 v52, v52
  v_rcp_f32 v53, v53
  v_mfma_f32_16x16x32_bf16 v[120:123], v[232:235], v[236:239], v[120:123]
  ds_read_b128 v[232:235], v3 offset:10800
  ds_read_b128 v[236:239], v4 offset:432
  v_mfma_f32_32x32x16_bf16 v[32:47], a[204:207], v[172:175], v[32:47]
  v_rcp_f32 v54, v54
  v_rcp_f32 v55, v55
  v_rcp_f32_e64 v56, v56
  v_mfma_f32_32x32x16_bf16 v[32:47], a[208:211], v[176:179], v[32:47]
  v_rcp_f32 v57, v57
  v_rcp_f32 v58, v58
  v_rcp_f32_e64 v59, v59
  v_mfma_f32_32x32x16_bf16 v[32:47], a[212:215], v[180:183], v[32:47]
  s_waitcnt lgkmcnt(0)
  v_rcp_f32 v60, v60
  v_rcp_f32 v61, v61
  v_rcp_f32 v62, v62
  v_rcp_f32_e64 v63, v63
  v_pk_mul_f32 v[16:17], v[16:17], v[48:49]
  v_pk_mul_f32 v[18:19], v[18:19], v[50:51]
  v_pk_mul_f32 v[20:21], v[20:21], v[52:53]
  v_pk_mul_f32 v[22:23], v[22:23], v[54:55]
  v_pk_mul_f32 v[24:25], v[24:25], v[56:57]
  v_pk_mul_f32 v[26:27], v[26:27], v[58:59]
  v_pk_mul_f32 v[28:29], v[28:29], v[60:61]
  v_pk_mul_f32 v[30:31], v[30:31], v[62:63]
  v_pk_add_f32 v[12:13], v[12:13], v[120:121]
  v_pk_fma_f32 v[14:15], v[120:121], v[120:121], v[14:15]
  v_pk_add_f32 v[12:13], v[12:13], v[122:123]
  v_pk_fma_f32 v[14:15], v[122:123], v[122:123], v[14:15]
  v_pk_fma_f32 v[48:49], v[32:33], v[32:33], s[20:21] neg_lo:[1,0,1] neg_hi:[1,0,1]
  v_pk_fma_f32 v[50:51], v[34:35], v[34:35], s[20:21] neg_lo:[1,0,1] neg_hi:[1,0,1]
  v_pk_fma_f32 v[52:53], v[36:37], v[36:37], s[20:21] neg_lo:[1,0,1] neg_hi:[1,0,1]
  v_pk_fma_f32 v[54:55], v[38:39], v[38:39], s[20:21] neg_lo:[1,0,1] neg_hi:[1,0,1]
  v_pk_fma_f32 v[56:57], v[40:41], v[40:41], s[20:21] neg_lo:[1,0,1] neg_hi:[1,0,1]
  v_pk_fma_f32 v[58:59], v[42:43], v[42:43], s[20:21] neg_lo:[1,0,1] neg_hi:[1,0,1]
  v_pk_fma_f32 v[60:61], v[44:45], v[44:45], s[20:21] neg_lo:[1,0,1] neg_hi:[1,0,1]
  v_pk_fma_f32 v[62:63], v[46:47], v[46:47], s[20:21] neg_lo:[1,0,1] neg_hi:[1,0,1]
  v_pk_mul_f32 v[48:49], v[32:33], v[48:49]
  v_pk_mul_f32 v[50:51], v[34:35], v[50:51]
  v_pk_mul_f32 v[52:53], v[36:37], v[52:53]
  v_pk_mul_f32 v[54:55], v[38:39], v[54:55]
  v_pk_mul_f32 v[56:57], v[40:41], v[56:57]
  v_pk_mul_f32 v[58:59], v[42:43], v[58:59]
  v_pk_mul_f32 v[60:61], v[44:45], v[60:61]
  v_pk_mul_f32 v[62:63], v[46:47], v[62:63]
  v_mfma_f32_16x16x32_bf16 v[124:127], v[216:219], v[220:223], 0
  v_cvt_pk_bf16_f32 v184, v16, v17
  v_cvt_pk_bf16_f32 v185, v18, v19
  v_mfma_f32_16x16x32_bf16 v[124:127], v[224:227], v[228:231], v[124:127]
  v_cvt_pk_bf16_f32 v186, v20, v21
  v_cvt_pk_bf16_f32 v187, v22, v23
  v_mfma_f32_16x16x32_bf16 v[124:127], v[232:235], v[236:239], v[124:127]
  ds_read_b128 v[216:219], v3 offset:1600
  ds_read_b128 v[220:223], v4 offset:64
  v_mfma_f32_32x32x16_bf16 v[64:79], v[192:195], v[184:187], v[64:79]
  ds_read_b128 v[224:227], v3 offset:6400
  ds_read_b128 v[228:231], v4 offset:256
  v_cvt_pk_bf16_f32 v188, v24, v25
  v_cvt_pk_bf16_f32 v189, v26, v27
  v_cvt_pk_bf16_f32 v190, v28, v29
  v_cvt_pk_bf16_f32 v191, v30, v31
  v_mfma_f32_32x32x16_bf16 v[80:95], v[196:199], v[184:187], v[80:95]
  ds_read_b128 v[232:235], v3 offset:11200
  ds_read_b128 v[236:239], v4 offset:448
  v_exp_f32 v48, v48
  v_exp_f32 v49, v49
  v_mfma_f32_32x32x16_bf16 v[96:111], v[200:203], v[184:187], v[96:111]
  v_exp_f32 v50, v50
  v_exp_f32 v51, v51
  v_exp_f32_e64 v52, v52
  v_mfma_f32_32x32x16_bf16 v[64:79], v[204:207], v[188:191], v[64:79]
  v_exp_f32 v53, v53
  v_exp_f32 v54, v54
  v_exp_f32_e64 v55, v55
  v_mfma_f32_32x32x16_bf16 v[80:95], v[208:211], v[188:191], v[80:95]
  v_exp_f32 v56, v56
  v_exp_f32 v57, v57
  v_exp_f32_e64 v58, v58
  v_mfma_f32_32x32x16_bf16 v[96:111], v[212:215], v[188:191], v[96:111]
  s_waitcnt lgkmcnt(0)
  v_exp_f32 v59, v59
  v_exp_f32 v60, v60
  v_exp_f32 v61, v61
  v_exp_f32 v62, v62
  v_exp_f32 v63, v63
  v_pk_add_f32 v[12:13], v[12:13], v[124:125]
  v_pk_fma_f32 v[14:15], v[124:125], v[124:125], v[14:15]
  v_pk_add_f32 v[12:13], v[12:13], v[126:127]
  v_pk_fma_f32 v[14:15], v[126:127], v[126:127], v[14:15]
  v_pk_fma_f32 v[48:49], v[48:49], s[22:23], s[22:23]
  v_pk_fma_f32 v[50:51], v[50:51], s[22:23], s[22:23]
  v_pk_fma_f32 v[52:53], v[52:53], s[22:23], s[22:23]
  v_pk_fma_f32 v[54:55], v[54:55], s[22:23], s[22:23]
  v_pk_fma_f32 v[56:57], v[56:57], s[22:23], s[22:23]
  v_pk_fma_f32 v[58:59], v[58:59], s[22:23], s[22:23]
  v_pk_fma_f32 v[60:61], v[60:61], s[22:23], s[22:23]
  v_pk_fma_f32 v[62:63], v[62:63], s[22:23], s[22:23]
  v_mfma_f32_32x32x16_bf16 v[16:31], a[216:219], v[160:163], 0
  ds_read_b128 v[192:195], v0 offset:55296
  ds_read_b128 v[196:199], v0 offset:56320
  v_rcp_f32 v48, v48
  v_rcp_f32 v49, v49
  v_mfma_f32_16x16x32_bf16 v[128:131], v[216:219], v[220:223], 0
  ds_read_b128 v[216:219], v3 offset:2000
  ds_read_b128 v[220:223], v4 offset:80
  v_mfma_f32_32x32x16_bf16 v[16:31], a[220:223], v[164:167], v[16:31]
  ds_read_b128 v[200:203], v0 offset:57344
  ds_read_b128 v[204:207], v0 offset:58368
  v_rcp_f32 v50, v50
  v_rcp_f32 v51, v51
  v_mfma_f32_16x16x32_bf16 v[128:131], v[224:227], v[228:231], v[128:131]
  ds_read_b128 v[224:227], v3 offset:6800
  ds_read_b128 v[228:231], v4 offset:272
  v_mfma_f32_32x32x16_bf16 v[16:31], a[224:227], v[168:171], v[16:31]
  ds_read_b128 v[208:211], v0 offset:59392
  ds_read_b128 v[212:215], v0 offset:60416
  v_rcp_f32 v52, v52
  v_rcp_f32 v53, v53
  v_mfma_f32_16x16x32_bf16 v[128:131], v[232:235], v[236:239], v[128:131]
  ds_read_b128 v[232:235], v3 offset:11600
  ds_read_b128 v[236:239], v4 offset:464
  v_mfma_f32_32x32x16_bf16 v[16:31], a[228:231], v[172:175], v[16:31]
  v_rcp_f32 v54, v54
  v_rcp_f32 v55, v55
  v_rcp_f32_e64 v56, v56
  v_mfma_f32_32x32x16_bf16 v[16:31], a[232:235], v[176:179], v[16:31]
  v_rcp_f32 v57, v57
  v_rcp_f32 v58, v58
  v_rcp_f32_e64 v59, v59
  v_mfma_f32_32x32x16_bf16 v[16:31], a[236:239], v[180:183], v[16:31]
  s_waitcnt lgkmcnt(0)
  v_rcp_f32 v60, v60
  v_rcp_f32 v61, v61
  v_rcp_f32 v62, v62
  v_rcp_f32_e64 v63, v63
  v_pk_mul_f32 v[32:33], v[32:33], v[48:49]
  v_pk_mul_f32 v[34:35], v[34:35], v[50:51]
  v_pk_mul_f32 v[36:37], v[36:37], v[52:53]
  v_pk_mul_f32 v[38:39], v[38:39], v[54:55]
  v_pk_mul_f32 v[40:41], v[40:41], v[56:57]
  v_pk_mul_f32 v[42:43], v[42:43], v[58:59]
  v_pk_mul_f32 v[44:45], v[44:45], v[60:61]
  v_pk_mul_f32 v[46:47], v[46:47], v[62:63]
  v_pk_add_f32 v[12:13], v[12:13], v[128:129]
  v_pk_fma_f32 v[14:15], v[128:129], v[128:129], v[14:15]
  v_pk_add_f32 v[12:13], v[12:13], v[130:131]
  v_pk_fma_f32 v[14:15], v[130:131], v[130:131], v[14:15]
  v_pk_fma_f32 v[48:49], v[16:17], v[16:17], s[20:21] neg_lo:[1,0,1] neg_hi:[1,0,1]
  v_pk_fma_f32 v[50:51], v[18:19], v[18:19], s[20:21] neg_lo:[1,0,1] neg_hi:[1,0,1]
  v_pk_fma_f32 v[52:53], v[20:21], v[20:21], s[20:21] neg_lo:[1,0,1] neg_hi:[1,0,1]
  v_pk_fma_f32 v[54:55], v[22:23], v[22:23], s[20:21] neg_lo:[1,0,1] neg_hi:[1,0,1]
  v_pk_fma_f32 v[56:57], v[24:25], v[24:25], s[20:21] neg_lo:[1,0,1] neg_hi:[1,0,1]
  v_pk_fma_f32 v[58:59], v[26:27], v[26:27], s[20:21] neg_lo:[1,0,1] neg_hi:[1,0,1]
  v_pk_fma_f32 v[60:61], v[28:29], v[28:29], s[20:21] neg_lo:[1,0,1] neg_hi:[1,0,1]
  v_pk_fma_f32 v[62:63], v[30:31], v[30:31], s[20:21] neg_lo:[1,0,1] neg_hi:[1,0,1]
  v_pk_mul_f32 v[48:49], v[16:17], v[48:49]
  v_pk_mul_f32 v[50:51], v[18:19], v[50:51]
  v_pk_mul_f32 v[52:53], v[20:21], v[52:53]
  v_pk_mul_f32 v[54:55], v[22:23], v[54:55]
  v_pk_mul_f32 v[56:57], v[24:25], v[56:57]
  v_pk_mul_f32 v[58:59], v[26:27], v[58:59]
  v_pk_mul_f32 v[60:61], v[28:29], v[60:61]
  v_pk_mul_f32 v[62:63], v[30:31], v[62:63]
  v_mfma_f32_16x16x32_bf16 v[132:135], v[216:219], v[220:223], 0
  v_cvt_pk_bf16_f32 v184, v32, v33
  v_cvt_pk_bf16_f32 v185, v34, v35
  v_mfma_f32_16x16x32_bf16 v[132:135], v[224:227], v[228:231], v[132:135]
  v_cvt_pk_bf16_f32 v186, v36, v37
  v_cvt_pk_bf16_f32 v187, v38, v39
  v_mfma_f32_16x16x32_bf16 v[132:135], v[232:235], v[236:239], v[132:135]
  ds_read_b128 v[216:219], v0 offset:12288
  ds_read_b128 v[220:223], v0 offset:13312
  v_mfma_f32_32x32x16_bf16 v[64:79], v[192:195], v[184:187], v[64:79]
  ds_read_b128 v[224:227], v0 offset:14336
  ds_read_b128 v[228:231], v0 offset:15360
  v_cvt_pk_bf16_f32 v188, v40, v41
  v_cvt_pk_bf16_f32 v189, v42, v43
  v_cvt_pk_bf16_f32 v190, v44, v45
  v_cvt_pk_bf16_f32 v191, v46, v47
  v_mfma_f32_32x32x16_bf16 v[80:95], v[196:199], v[184:187], v[80:95]
  ds_read_b128 v[232:235], v0 offset:16384
  ds_read_b128 v[236:239], v0 offset:17408
  v_exp_f32 v48, v48
  v_exp_f32 v49, v49
  v_mfma_f32_32x32x16_bf16 v[96:111], v[200:203], v[184:187], v[96:111]
  v_exp_f32 v50, v50
  v_exp_f32 v51, v51
  v_exp_f32_e64 v52, v52
  v_mfma_f32_32x32x16_bf16 v[64:79], v[204:207], v[188:191], v[64:79]
  s_mov_b32 s28, s34
  v_exp_f32 v53, v53
  v_exp_f32 v54, v54
  v_exp_f32 v55, v55
  v_mfma_f32_32x32x16_bf16 v[80:95], v[208:211], v[188:191], v[80:95]
  s_add_u32 s34, s34, 0x60000
  v_exp_f32 v56, v56
  v_exp_f32 v57, v57
  v_exp_f32_e64 v58, v58
  v_mfma_f32_32x32x16_bf16 v[96:111], v[212:215], v[188:191], v[96:111]
  s_waitcnt lgkmcnt(0)
  v_exp_f32 v59, v59
  v_exp_f32 v60, v60
  v_exp_f32 v61, v61
  v_exp_f32 v62, v62
  v_exp_f32 v63, v63
  v_pk_add_f32 v[12:13], v[12:13], v[132:133]
  v_pk_fma_f32 v[14:15], v[132:133], v[132:133], v[14:15]
  v_pk_add_f32 v[12:13], v[12:13], v[134:135]
  v_pk_fma_f32 v[14:15], v[134:135], v[134:135], v[14:15]
  v_pk_fma_f32 v[48:49], v[48:49], s[22:23], s[22:23]
  v_pk_fma_f32 v[50:51], v[50:51], s[22:23], s[22:23]
  v_pk_fma_f32 v[52:53], v[52:53], s[22:23], s[22:23]
  v_pk_fma_f32 v[54:55], v[54:55], s[22:23], s[22:23]
  v_pk_fma_f32 v[56:57], v[56:57], s[22:23], s[22:23]
  v_pk_fma_f32 v[58:59], v[58:59], s[22:23], s[22:23]
  v_pk_fma_f32 v[60:61], v[60:61], s[22:23], s[22:23]
  v_pk_fma_f32 v[62:63], v[62:63], s[22:23], s[22:23]
  v_mfma_f32_32x32x16_bf16 v[32:47], v[216:219], v[160:163], 0
  ds_read_b128 v[192:195], v0 offset:61440
  ds_read_b128 v[196:199], v0 offset:62464
  v_rcp_f32 v48, v48
  v_rcp_f32 v49, v49
  v_add_f32_e64 v12, v12, v13
  v_mfma_f32_32x32x16_bf16 v[32:47], v[220:223], v[164:167], v[32:47]
  ds_read_b128 v[200:203], v0 offset:63488
  ds_read_b128 v[204:207], v0 offset:64512
  v_rcp_f32 v50, v50
  v_add_f32 v14, v14, v15
  v_rcp_f32_e64 v51, v51
  v_mfma_f32_32x32x16_bf16 v[32:47], v[224:227], v[168:171], v[32:47]
  ds_read_b128 v[208:211], v1
  ds_read_b128 v[212:215], v1 offset:1024
  v_permlane32_swap_b32 v12, v14
  v_rcp_f32 v52, v52
  v_add_f32 v12, v12, v14
  v_rcp_f32 v53, v53
  v_mfma_f32_32x32x16_bf16 v[32:47], v[228:231], v[172:175], v[32:47]
  v_mov_b32 v14, v12
  v_rcp_f32 v54, v54
  s_nop 0
  v_permlane32_swap_b32 v12, v14
  v_rcp_f32 v55, v55
  v_mul_f32 v12, s24, v12
  v_mfma_f32_32x32x16_bf16 v[32:47], v[232:235], v[176:179], v[32:47]
  v_rcp_f32 v56, v56
  v_rcp_f32 v57, v57
  v_mul_f32 v13, s24, v14
  v_rcp_f32 v58, v58
  v_fma_f32 v13, -v12, v12, v13
  v_mfma_f32_32x32x16_bf16 v[32:47], v[236:239], v[180:183], v[32:47]
  s_waitcnt lgkmcnt(0)
  v_rcp_f32 v59, v59
  v_max_f32 v13, 0, v13
  v_rcp_f32 v60, v60
  v_add_f32 v13, s25, v13
  v_rcp_f32 v61, v61
  v_rsq_f32 v13, v13
  v_rcp_f32 v62, v62
  v_mul_f32 v14, s22, v13
  v_rcp_f32 v63, v63
  v_mul_f32_e64 v12, -v12, v14
  v_pk_mul_f32 v[16:17], v[16:17], v[48:49]
  v_pk_mul_f32 v[18:19], v[18:19], v[50:51]
  v_pk_mul_f32 v[20:21], v[20:21], v[52:53]
  v_pk_mul_f32 v[22:23], v[22:23], v[54:55]
  v_pk_mul_f32 v[24:25], v[24:25], v[56:57]
  v_pk_mul_f32 v[26:27], v[26:27], v[58:59]
  v_pk_mul_f32 v[28:29], v[28:29], v[60:61]
  v_pk_mul_f32 v[30:31], v[30:31], v[62:63]
  v_pk_fma_f32 v[112:113], v[112:113], v[14:15], v[12:13] op_sel_hi:[1,0,0]
  v_pk_fma_f32 v[114:115], v[114:115], v[14:15], v[12:13] op_sel_hi:[1,0,0]
  v_pk_fma_f32 v[116:117], v[116:117], v[14:15], v[12:13] op_sel_hi:[1,0,0]
  v_pk_fma_f32 v[118:119], v[118:119], v[14:15], v[12:13] op_sel_hi:[1,0,0]
  v_pk_fma_f32 v[120:121], v[120:121], v[14:15], v[12:13] op_sel_hi:[1,0,0]
  v_pk_fma_f32 v[122:123], v[122:123], v[14:15], v[12:13] op_sel_hi:[1,0,0]
  v_pk_fma_f32 v[124:125], v[124:125], v[14:15], v[12:13] op_sel_hi:[1,0,0]
  v_pk_fma_f32 v[126:127], v[126:127], v[14:15], v[12:13] op_sel_hi:[1,0,0]
  v_pk_fma_f32 v[128:129], v[128:129], v[14:15], v[12:13] op_sel_hi:[1,0,0]
  v_pk_fma_f32 v[130:131], v[130:131], v[14:15], v[12:13] op_sel_hi:[1,0,0]
  v_pk_fma_f32 v[132:133], v[132:133], v[14:15], v[12:13] op_sel_hi:[1,0,0]
  v_pk_fma_f32 v[134:135], v[134:135], v[14:15], v[12:13] op_sel_hi:[1,0,0]
  v_pk_fma_f32 v[136:137], v[136:137], v[14:15], v[12:13] op_sel_hi:[1,0,0]
  v_pk_fma_f32 v[138:139], v[138:139], v[14:15], v[12:13] op_sel_hi:[1,0,0]
  v_pk_fma_f32 v[140:141], v[140:141], v[14:15], v[12:13] op_sel_hi:[1,0,0]
  v_pk_fma_f32 v[142:143], v[142:143], v[14:15], v[12:13] op_sel_hi:[1,0,0]
  v_pk_fma_f32 v[144:145], v[144:145], v[14:15], v[12:13] op_sel_hi:[1,0,0]
  v_pk_fma_f32 v[146:147], v[146:147], v[14:15], v[12:13] op_sel_hi:[1,0,0]
  v_pk_fma_f32 v[148:149], v[148:149], v[14:15], v[12:13] op_sel_hi:[1,0,0]
  v_pk_fma_f32 v[150:151], v[150:151], v[14:15], v[12:13] op_sel_hi:[1,0,0]
  v_pk_fma_f32 v[152:153], v[152:153], v[14:15], v[12:13] op_sel_hi:[1,0,0]
  v_pk_fma_f32 v[154:155], v[154:155], v[14:15], v[12:13] op_sel_hi:[1,0,0]
  v_pk_fma_f32 v[156:157], v[156:157], v[14:15], v[12:13] op_sel_hi:[1,0,0]
  v_pk_fma_f32 v[158:159], v[158:159], v[14:15], v[12:13] op_sel_hi:[1,0,0]
  v_pk_fma_f32 v[48:49], v[32:33], v[32:33], s[20:21] neg_lo:[1,0,1] neg_hi:[1,0,1]
  v_pk_fma_f32 v[50:51], v[34:35], v[34:35], s[20:21] neg_lo:[1,0,1] neg_hi:[1,0,1]
  v_pk_fma_f32 v[52:53], v[36:37], v[36:37], s[20:21] neg_lo:[1,0,1] neg_hi:[1,0,1]
  v_pk_fma_f32 v[54:55], v[38:39], v[38:39], s[20:21] neg_lo:[1,0,1] neg_hi:[1,0,1]
  v_pk_fma_f32 v[56:57], v[40:41], v[40:41], s[20:21] neg_lo:[1,0,1] neg_hi:[1,0,1]
  v_pk_fma_f32 v[58:59], v[42:43], v[42:43], s[20:21] neg_lo:[1,0,1] neg_hi:[1,0,1]
  v_pk_fma_f32 v[60:61], v[44:45], v[44:45], s[20:21] neg_lo:[1,0,1] neg_hi:[1,0,1]
  v_pk_fma_f32 v[62:63], v[46:47], v[46:47], s[20:21] neg_lo:[1,0,1] neg_hi:[1,0,1]
  v_pk_mul_f32 v[48:49], v[32:33], v[48:49]
  v_pk_mul_f32 v[50:51], v[34:35], v[50:51]
  v_pk_mul_f32 v[52:53], v[36:37], v[52:53]
  v_pk_mul_f32 v[54:55], v[38:39], v[54:55]
  v_pk_mul_f32 v[56:57], v[40:41], v[56:57]
  v_cvt_pk_bf16_f32 v184, v16, v17
  v_cvt_pk_bf16_f32 v185, v18, v19
  v_cvt_pk_bf16_f32 v186, v20, v21
  v_cvt_pk_bf16_f32 v187, v22, v23
  v_pk_mul_f32 v[58:59], v[42:43], v[58:59]
  v_pk_mul_f32 v[60:61], v[44:45], v[60:61]
  v_pk_mul_f32 v[62:63], v[46:47], v[62:63]
  v_mfma_f32_32x32x16_bf16 v[64:79], v[192:195], v[184:187], v[64:79]
  ds_read_b128 v[216:219], v0 offset:18432
  ds_read_b128 v[220:223], v0 offset:19456
  v_cvt_pk_bf16_f32 v188, v24, v25
  v_cvt_pk_bf16_f32 v189, v26, v27
  v_cvt_pk_bf16_f32 v190, v28, v29
  v_cvt_pk_bf16_f32 v191, v30, v31
  v_exp_f32_e64 v48, v48
  v_cndmask_b32 v159, v159, v250, s[12:13]
  v_mfma_f32_32x32x16_bf16 v[80:95], v[196:199], v[184:187], v[80:95]
  ds_read_b128 v[224:227], v0 offset:20480
  ds_read_b128 v[228:231], v0 offset:21504
  v_exp_f32_e64 v49, v49
  v_cvt_pk_bf16_f32 v160, v112, v113
  v_cvt_pk_bf16_f32 v161, v114, v115
  v_exp_f32_e64 v50, v50
  v_cvt_pk_bf16_f32 v162, v116, v117
  v_mfma_f32_32x32x16_bf16 v[96:111], v[200:203], v[184:187], v[96:111]
  ds_read_b128 v[232:235], v0 offset:22528
  ds_read_b128 v[236:239], v0 offset:23552
  v_exp_f32_e64 v51, v51
  v_cvt_pk_bf16_f32 v163, v118, v119
  v_cvt_pk_bf16_f32 v164, v120, v121
  v_exp_f32_e64 v52, v52
  v_cvt_pk_bf16_f32 v165, v122, v123
  v_mfma_f32_32x32x16_bf16 v[64:79], v[204:207], v[188:191], v[64:79]
  v_exp_f32_e64 v53, v53
  v_cvt_pk_bf16_f32 v166, v124, v125
  v_cvt_pk_bf16_f32 v167, v126, v127
  v_exp_f32_e64 v54, v54
  v_cvt_pk_bf16_f32 v168, v128, v129
  v_exp_f32_e64 v55, v55
  v_cvt_pk_bf16_f32 v169, v130, v131
  v_cvt_pk_bf16_f32 v170, v132, v133
  v_mfma_f32_32x32x16_bf16 v[80:95], v[208:211], v[188:191], v[80:95]
  v_exp_f32_e64 v56, v56
  v_cvt_pk_bf16_f32 v171, v134, v135
  v_cvt_pk_bf16_f32 v172, v136, v137
  v_exp_f32_e64 v57, v57
  v_cvt_pk_bf16_f32 v173, v138, v139
  v_exp_f32_e64 v58, v58
  v_cvt_pk_bf16_f32 v174, v140, v141
  v_cvt_pk_bf16_f32 v175, v142, v143
  v_mfma_f32_32x32x16_bf16 v[96:111], v[212:215], v[188:191], v[96:111]
  s_waitcnt lgkmcnt(0)
  v_exp_f32 v59, v59
  v_cvt_pk_bf16_f32 v176, v144, v145
  v_exp_f32_e64 v60, v60
  v_cvt_pk_bf16_f32 v177, v146, v147
  v_cvt_pk_bf16_f32 v178, v148, v149
  v_exp_f32_e64 v61, v61
  v_cvt_pk_bf16_f32 v179, v150, v151
  v_exp_f32_e64 v62, v62
  v_cvt_pk_bf16_f32 v180, v152, v153
  v_cvt_pk_bf16_f32 v181, v154, v155
  v_exp_f32_e64 v63, v63
  v_cvt_pk_bf16_f32 v182, v156, v157
  v_cvt_pk_bf16_f32 v183, v158, v159
  v_pk_fma_f32 v[48:49], v[48:49], s[22:23], s[22:23]
  v_pk_fma_f32 v[50:51], v[50:51], s[22:23], s[22:23]
  v_pk_fma_f32 v[52:53], v[52:53], s[22:23], s[22:23]
  v_pk_fma_f32 v[54:55], v[54:55], s[22:23], s[22:23]
  v_pk_fma_f32 v[56:57], v[56:57], s[22:23], s[22:23]
  v_pk_fma_f32 v[58:59], v[58:59], s[22:23], s[22:23]
  v_pk_fma_f32 v[60:61], v[60:61], s[22:23], s[22:23]
  v_pk_fma_f32 v[62:63], v[62:63], s[22:23], s[22:23]
  s_mov_b32 s26, 6
  .p2align 6
  s_waitcnt vmcnt(0)
S_loop:
  v_mfma_f32_32x32x16_bf16 v[16:31], v[216:219], v[160:163], 0
  s_nop 0
  ds_read_b128 v[192:195], v1 offset:2048
  ds_read_b128 v[196:199], v1 offset:3072
  ds_read_b128 v[200:203], v1 offset:4096
  v_rcp_f32 v48, v48
  v_rcp_f32 v49, v49
  v_mfma_f32_32x32x16_bf16 v[16:31], v[220:223], v[164:167], v[16:31]
  ds_read_b128 v[204:207], v1 offset:5120
  ds_read_b128 v[208:211], v1 offset:6144
  ds_read_b128 v[212:215], v1 offset:7168
  v_rcp_f32 v50, v50
  v_rcp_f32 v51, v51
  v_mfma_f32_32x32x16_bf16 v[16:31], v[224:227], v[168:171], v[16:31]
  ds_read_b128 v[136:139], v5
  ds_read_b128 v[140:143], v5 offset:32
  ds_read_b128 v[144:147], v5 offset:64
  v_rcp_f32 v52, v52
  v_rcp_f32 v53, v53
  v_mfma_f32_32x32x16_bf16 v[16:31], v[228:231], v[172:175], v[16:31]
  ds_read_b128 v[148:151], v5 offset:96
  ds_read_b128 v[152:155], v5 offset:128
  ds_read_b128 v[156:159], v5 offset:160
  v_rcp_f32 v54, v54
  v_rcp_f32 v55, v55
  v_mfma_f32_32x32x16_bf16 v[16:31], v[232:235], v[176:179], v[16:31]
  v_rcp_f32 v56, v56
  v_rcp_f32 v57, v57
  v_rcp_f32_e64 v58, v58
  v_mfma_f32_32x32x16_bf16 v[16:31], v[236:239], v[180:183], v[16:31]
  s_waitcnt lgkmcnt(0)
  v_rcp_f32 v59, v59
  v_rcp_f32 v60, v60
  v_rcp_f32 v61, v61
  v_rcp_f32 v62, v62
  v_rcp_f32 v63, v63
  v_pk_mul_f32 v[32:33], v[32:33], v[48:49]
  v_pk_mul_f32 v[34:35], v[34:35], v[50:51]
  v_pk_mul_f32 v[36:37], v[36:37], v[52:53]
  v_pk_mul_f32 v[38:39], v[38:39], v[54:55]
  v_pk_mul_f32 v[40:41], v[40:41], v[56:57]
  v_pk_mul_f32 v[42:43], v[42:43], v[58:59]
  v_pk_mul_f32 v[44:45], v[44:45], v[60:61]
  v_pk_mul_f32 v[46:47], v[46:47], v[62:63]
  v_pk_fma_f32 v[48:49], v[16:17], v[16:17], s[20:21] neg_lo:[1,0,1] neg_hi:[1,0,1]
  v_pk_fma_f32 v[50:51], v[18:19], v[18:19], s[20:21] neg_lo:[1,0,1] neg_hi:[1,0,1]
  v_pk_fma_f32 v[52:53], v[20:21], v[20:21], s[20:21] neg_lo:[1,0,1] neg_hi:[1,0,1]
  v_pk_fma_f32 v[54:55], v[22:23], v[22:23], s[20:21] neg_lo:[1,0,1] neg_hi:[1,0,1]
  v_pk_fma_f32 v[56:57], v[24:25], v[24:25], s[20:21] neg_lo:[1,0,1] neg_hi:[1,0,1]
  v_pk_fma_f32 v[58:59], v[26:27], v[26:27], s[20:21] neg_lo:[1,0,1] neg_hi:[1,0,1]
  v_pk_fma_f32 v[60:61], v[28:29], v[28:29], s[20:21] neg_lo:[1,0,1] neg_hi:[1,0,1]
  v_pk_fma_f32 v[62:63], v[30:31], v[30:31], s[20:21] neg_lo:[1,0,1] neg_hi:[1,0,1]
  v_pk_mul_f32 v[48:49], v[16:17], v[48:49]
  v_pk_mul_f32 v[50:51], v[18:19], v[50:51]
  v_pk_mul_f32 v[52:53], v[20:21], v[52:53]
  v_pk_mul_f32 v[54:55], v[22:23], v[54:55]
  v_pk_mul_f32 v[56:57], v[24:25], v[56:57]
  v_cvt_pk_bf16_f32 v184, v32, v33
  v_cvt_pk_bf16_f32 v185, v34, v35
  v_cvt_pk_bf16_f32 v186, v36, v37
  v_cvt_pk_bf16_f32 v187, v38, v39
  v_pk_mul_f32 v[58:59], v[26:27], v[58:59]
  v_pk_mul_f32 v[60:61], v[28:29], v[60:61]
  v_pk_mul_f32 v[62:63], v[30:31], v[62:63]
  v_mfma_f32_32x32x16_bf16 v[64:79], v[192:195], v[184:187], v[64:79]
  s_mov_b32 m0, s30
  v_cvt_pk_bf16_f32 v188, v40, v41
  v_cvt_pk_bf16_f32 v189, v42, v43
  v_cvt_pk_bf16_f32 v190, v44, v45
  v_cvt_pk_bf16_f32 v191, v46, v47
  v_exp_f32 v48, v48
  v_mfma_f32_32x32x16_bf16 v[80:95], v[196:199], v[184:187], v[80:95]
  buffer_load_dwordx4 v6, s[4:7], s29 offen lds
  v_exp_f32 v49, v49
  v_exp_f32 v50, v50
  v_exp_f32_e64 v51, v51
  v_mfma_f32_32x32x16_bf16 v[96:111], v[200:203], v[184:187], v[96:111]
  buffer_load_dwordx4 v7, s[4:7], s29 offen offset:1024 lds
  v_exp_f32 v52, v52
  v_exp_f32 v53, v53
  v_mfma_f32_32x32x16_bf16 v[64:79], v[204:207], v[188:191], v[64:79]
  buffer_load_dwordx4 v8, s[4:7], s29 offen offset:2048 lds
  v_exp_f32 v54, v54
  v_exp_f32 v55, v55
  v_exp_f32_e64 v56, v56
  v_mfma_f32_32x32x16_bf16 v[80:95], v[208:211], v[188:191], v[80:95]
  buffer_load_dwordx4 v9, s[4:7], s29 offen offset:3072 lds
  v_exp_f32 v57, v57
  v_exp_f32 v58, v58
  v_mfma_f32_32x32x16_bf16 v[96:111], v[212:215], v[188:191], v[96:111]
  v_exp_f32 v59, v59
  v_exp_f32 v60, v60
  v_exp_f32 v61, v61
  v_exp_f32 v62, v62
  v_exp_f32_e64 v63, v63
  v_pk_fma_f32 v[48:49], v[48:49], s[22:23], s[22:23]
  v_pk_fma_f32 v[50:51], v[50:51], s[22:23], s[22:23]
  v_pk_fma_f32 v[52:53], v[52:53], s[22:23], s[22:23]
  v_pk_fma_f32 v[54:55], v[54:55], s[22:23], s[22:23]
  v_pk_fma_f32 v[56:57], v[56:57], s[22:23], s[22:23]
  v_pk_fma_f32 v[58:59], v[58:59], s[22:23], s[22:23]
  v_pk_fma_f32 v[60:61], v[60:61], s[22:23], s[22:23]
  v_pk_fma_f32 v[62:63], v[62:63], s[22:23], s[22:23]
  v_mfma_f32_32x32x16_bf16 v[32:47], a[0:3], v[160:163], 0
  v_cvt_pk_bf16_f32 v112, v64, v65
  v_cvt_pk_bf16_f32 v113, v66, v67
  v_cvt_pk_bf16_f32 v114, v68, v69
  v_cvt_pk_bf16_f32 v115, v70, v71
  v_cvt_pk_bf16_f32 v116, v72, v73
  v_cvt_pk_bf16_f32 v117, v74, v75
  v_mfma_f32_32x32x16_bf16 v[32:47], a[4:7], v[164:167], v[32:47]
  v_cvt_pk_bf16_f32 v118, v76, v77
  v_cvt_pk_bf16_f32 v119, v78, v79
  v_cvt_pk_bf16_f32 v120, v80, v81
  v_cvt_pk_bf16_f32 v121, v82, v83
  v_cvt_pk_bf16_f32 v122, v84, v85
  v_cvt_pk_bf16_f32 v123, v86, v87
  v_mfma_f32_32x32x16_bf16 v[32:47], a[8:11], v[168:171], v[32:47]
  ds_read_b128 v[64:67], v2
  ds_read_b128 v[68:71], v2 offset:32
  ds_read_b128 v[72:75], v2 offset:64
  ds_read_b128 v[76:79], v2 offset:96
  v_cvt_pk_bf16_f32 v124, v88, v89
  v_cvt_pk_bf16_f32 v125, v90, v91
  v_mfma_f32_32x32x16_bf16 v[32:47], a[12:15], v[172:175], v[32:47]
  ds_read_b128 v[192:195], v1 offset:8192
  ds_read_b128 v[196:199], v1 offset:9216
  v_cvt_pk_bf16_f32 v126, v92, v93
  v_cvt_pk_bf16_f32 v127, v94, v95
  v_cvt_pk_bf16_f32 v128, v96, v97
  v_cvt_pk_bf16_f32 v129, v98, v99
  v_mfma_f32_32x32x16_bf16 v[32:47], a[16:19], v[176:179], v[32:47]
  ds_read_b128 v[80:83], v2 offset:128
  ds_read_b128 v[84:87], v2 offset:160
  ds_read_b128 v[88:91], v2 offset:192
  ds_read_b128 v[92:95], v2 offset:224
  v_cvt_pk_bf16_f32 v130, v100, v101
  v_cvt_pk_bf16_f32 v131, v102, v103
  v_mfma_f32_32x32x16_bf16 v[32:47], a[20:23], v[180:183], v[32:47]
  s_waitcnt lgkmcnt(6)
  ds_read_b128 v[200:203], v1 offset:10240
  ds_read_b128 v[204:207], v1 offset:11264
  v_cvt_pk_bf16_f32 v132, v104, v105
  v_cvt_pk_bf16_f32 v133, v106, v107
  v_cvt_pk_bf16_f32 v134, v108, v109
  v_cvt_pk_bf16_f32 v135, v110, v111
  v_mfma_f32_32x32x16_bf16 v[64:79], v[240:243], v[136:139], v[64:79]
  s_nop 0
  ds_read_b128 v[96:99], v2 offset:256
  ds_read_b128 v[100:103], v2 offset:288
  ds_read_b128 v[104:107], v2 offset:320
  ds_read_b128 v[108:111], v2 offset:352
  v_rcp_f32 v48, v48
  v_mfma_f32_32x32x16_bf16 v[64:79], v[244:247], v[140:143], v[64:79]
  s_waitcnt lgkmcnt(6)
  ds_read_b128 v[208:211], v1 offset:12288
  ds_read_b128 v[212:215], v1 offset:13312
  v_rcp_f32 v49, v49
  v_rcp_f32 v50, v50
  v_mfma_f32_32x32x16_bf16 v[80:95], v[240:243], v[144:147], v[80:95]
  v_rcp_f32 v51, v51
  v_rcp_f32 v52, v52
  v_rcp_f32_e64 v53, v53
  v_mfma_f32_32x32x16_bf16 v[80:95], v[244:247], v[148:151], v[80:95]
  s_waitcnt lgkmcnt(2)
  v_rcp_f32 v54, v54
  v_rcp_f32 v55, v55
  v_rcp_f32 v56, v56
  v_mfma_f32_32x32x16_bf16 v[96:111], v[240:243], v[152:155], v[96:111]
  v_rcp_f32 v57, v57
  v_rcp_f32 v58, v58
  v_rcp_f32_e64 v59, v59
  v_mfma_f32_32x32x16_bf16 v[96:111], v[244:247], v[156:159], v[96:111]
  s_waitcnt lgkmcnt(0)
  v_rcp_f32 v60, v60
  v_rcp_f32 v61, v61
  v_rcp_f32 v62, v62
  v_rcp_f32_e64 v63, v63
  v_pk_mul_f32 v[16:17], v[16:17], v[48:49]
  v_pk_mul_f32 v[18:19], v[18:19], v[50:51]
  v_pk_mul_f32 v[20:21], v[20:21], v[52:53]
  v_pk_mul_f32 v[22:23], v[22:23], v[54:55]
  v_pk_mul_f32 v[24:25], v[24:25], v[56:57]
  v_pk_mul_f32 v[26:27], v[26:27], v[58:59]
  v_pk_mul_f32 v[28:29], v[28:29], v[60:61]
  v_pk_mul_f32 v[30:31], v[30:31], v[62:63]
  v_pk_fma_f32 v[48:49], v[32:33], v[32:33], s[20:21] neg_lo:[1,0,1] neg_hi:[1,0,1]
  v_pk_fma_f32 v[50:51], v[34:35], v[34:35], s[20:21] neg_lo:[1,0,1] neg_hi:[1,0,1]
  v_pk_fma_f32 v[52:53], v[36:37], v[36:37], s[20:21] neg_lo:[1,0,1] neg_hi:[1,0,1]
  v_pk_fma_f32 v[54:55], v[38:39], v[38:39], s[20:21] neg_lo:[1,0,1] neg_hi:[1,0,1]
  v_pk_fma_f32 v[56:57], v[40:41], v[40:41], s[20:21] neg_lo:[1,0,1] neg_hi:[1,0,1]
  v_pk_fma_f32 v[58:59], v[42:43], v[42:43], s[20:21] neg_lo:[1,0,1] neg_hi:[1,0,1]
  v_pk_fma_f32 v[60:61], v[44:45], v[44:45], s[20:21] neg_lo:[1,0,1] neg_hi:[1,0,1]
  v_pk_fma_f32 v[62:63], v[46:47], v[46:47], s[20:21] neg_lo:[1,0,1] neg_hi:[1,0,1]
  v_pk_mul_f32 v[48:49], v[32:33], v[48:49]
  v_pk_mul_f32 v[50:51], v[34:35], v[50:51]
  v_pk_mul_f32 v[52:53], v[36:37], v[52:53]
  v_pk_mul_f32 v[54:55], v[38:39], v[54:55]
  v_pk_mul_f32 v[56:57], v[40:41], v[56:57]
  v_cvt_pk_bf16_f32 v184, v16, v17
  v_cvt_pk_bf16_f32 v185, v18, v19
  v_cvt_pk_bf16_f32 v186, v20, v21
  v_cvt_pk_bf16_f32 v187, v22, v23
  v_pk_mul_f32 v[58:59], v[42:43], v[58:59]
  v_pk_mul_f32 v[60:61], v[44:45], v[60:61]
  v_pk_mul_f32 v[62:63], v[46:47], v[62:63]
  v_mfma_f32_32x32x16_bf16 v[64:79], v[192:195], v[184:187], v[64:79]
  s_mov_b32 m0, s31
  v_cvt_pk_bf16_f32 v188, v24, v25
  v_cvt_pk_bf16_f32 v189, v26, v27
  v_cvt_pk_bf16_f32 v190, v28, v29
  v_cvt_pk_bf16_f32 v191, v30, v31
  v_exp_f32 v48, v48
  v_mfma_f32_32x32x16_bf16 v[80:95], v[196:199], v[184:187], v[80:95]
  buffer_load_dwordx4 v6, s[4:7], s52 offen lds
  v_exp_f32 v49, v49
  v_exp_f32 v50, v50
  v_exp_f32_e64 v51, v51
  v_mfma_f32_32x32x16_bf16 v[96:111], v[200:203], v[184:187], v[96:111]
  buffer_load_dwordx4 v7, s[4:7], s52 offen offset:1024 lds
  v_exp_f32 v52, v52
  v_exp_f32 v53, v53
  v_mfma_f32_32x32x16_bf16 v[64:79], v[204:207], v[188:191], v[64:79]
  buffer_load_dwordx4 v8, s[4:7], s52 offen offset:2048 lds
  v_exp_f32 v54, v54
  v_exp_f32 v55, v55
  v_exp_f32_e64 v56, v56
  v_mfma_f32_32x32x16_bf16 v[80:95], v[208:211], v[188:191], v[80:95]
  buffer_load_dwordx4 v9, s[4:7], s52 offen offset:3072 lds
  v_exp_f32 v57, v57
  v_exp_f32 v58, v58
  v_mfma_f32_32x32x16_bf16 v[96:111], v[212:215], v[188:191], v[96:111]
  v_exp_f32 v59, v59
  v_exp_f32 v60, v60
  v_exp_f32 v61, v61
  v_exp_f32 v62, v62
  v_exp_f32_e64 v63, v63
  v_pk_fma_f32 v[48:49], v[48:49], s[22:23], s[22:23]
  v_pk_fma_f32 v[50:51], v[50:51], s[22:23], s[22:23]
  v_pk_fma_f32 v[52:53], v[52:53], s[22:23], s[22:23]
  v_pk_fma_f32 v[54:55], v[54:55], s[22:23], s[22:23]
  v_pk_fma_f32 v[56:57], v[56:57], s[22:23], s[22:23]
  v_pk_fma_f32 v[58:59], v[58:59], s[22:23], s[22:23]
  v_pk_fma_f32 v[60:61], v[60:61], s[22:23], s[22:23]
  v_pk_fma_f32 v[62:63], v[62:63], s[22:23], s[22:23]
  v_mfma_f32_32x32x16_bf16 v[16:31], a[24:27], v[160:163], 0
  ds_read_b128 v[192:195], v1 offset:14336
  ds_read_b128 v[196:199], v1 offset:15360
  v_rcp_f32 v48, v48
  v_rcp_f32 v49, v49
  v_mfma_f32_32x32x16_bf16 v[16:31], a[28:31], v[164:167], v[16:31]
  ds_read_b128 v[200:203], v1 offset:16384
  ds_read_b128 v[204:207], v1 offset:17408
  v_rcp_f32 v50, v50
  v_rcp_f32 v51, v51
  v_mfma_f32_32x32x16_bf16 v[16:31], a[32:35], v[168:171], v[16:31]
  ds_read_b128 v[208:211], v1 offset:18432
  ds_read_b128 v[212:215], v1 offset:19456
  v_rcp_f32 v52, v52
  v_rcp_f32 v53, v53
  v_mfma_f32_32x32x16_bf16 v[16:31], a[36:39], v[172:175], v[16:31]
  buffer_store_dwordx4 v[112:115], v10, s[8:11], s28 offen
  v_rcp_f32 v54, v54
  v_rcp_f32 v55, v55
  v_mfma_f32_32x32x16_bf16 v[16:31], a[40:43], v[176:179], v[16:31]
  v_rcp_f32 v56, v56
  v_rcp_f32 v57, v57
  v_rcp_f32_e64 v58, v58
  v_mfma_f32_32x32x16_bf16 v[16:31], a[44:47], v[180:183], v[16:31]
  s_waitcnt lgkmcnt(0)
  v_rcp_f32 v59, v59
  v_rcp_f32 v60, v60
  v_rcp_f32 v61, v61
  v_rcp_f32 v62, v62
  v_rcp_f32 v63, v63
  v_pk_mul_f32 v[32:33], v[32:33], v[48:49]
  v_pk_mul_f32 v[34:35], v[34:35], v[50:51]
  v_pk_mul_f32 v[36:37], v[36:37], v[52:53]
  v_pk_mul_f32 v[38:39], v[38:39], v[54:55]
  v_pk_mul_f32 v[40:41], v[40:41], v[56:57]
  v_pk_mul_f32 v[42:43], v[42:43], v[58:59]
  v_pk_mul_f32 v[44:45], v[44:45], v[60:61]
  v_pk_mul_f32 v[46:47], v[46:47], v[62:63]
  v_pk_fma_f32 v[48:49], v[16:17], v[16:17], s[20:21] neg_lo:[1,0,1] neg_hi:[1,0,1]
  v_pk_fma_f32 v[50:51], v[18:19], v[18:19], s[20:21] neg_lo:[1,0,1] neg_hi:[1,0,1]
  v_pk_fma_f32 v[52:53], v[20:21], v[20:21], s[20:21] neg_lo:[1,0,1] neg_hi:[1,0,1]
  v_pk_fma_f32 v[54:55], v[22:23], v[22:23], s[20:21] neg_lo:[1,0,1] neg_hi:[1,0,1]
  v_pk_fma_f32 v[56:57], v[24:25], v[24:25], s[20:21] neg_lo:[1,0,1] neg_hi:[1,0,1]
  v_pk_fma_f32 v[58:59], v[26:27], v[26:27], s[20:21] neg_lo:[1,0,1] neg_hi:[1,0,1]
  v_pk_fma_f32 v[60:61], v[28:29], v[28:29], s[20:21] neg_lo:[1,0,1] neg_hi:[1,0,1]
  v_pk_fma_f32 v[62:63], v[30:31], v[30:31], s[20:21] neg_lo:[1,0,1] neg_hi:[1,0,1]
  v_pk_mul_f32 v[48:49], v[16:17], v[48:49]
  v_pk_mul_f32 v[50:51], v[18:19], v[50:51]
  v_pk_mul_f32 v[52:53], v[20:21], v[52:53]
  v_pk_mul_f32 v[54:55], v[22:23], v[54:55]
  v_pk_mul_f32 v[56:57], v[24:25], v[56:57]
  v_cvt_pk_bf16_f32 v184, v32, v33
  v_cvt_pk_bf16_f32 v185, v34, v35
  v_cvt_pk_bf16_f32 v186, v36, v37
  v_cvt_pk_bf16_f32 v187, v38, v39
  v_pk_mul_f32 v[58:59], v[26:27], v[58:59]
  v_pk_mul_f32 v[60:61], v[28:29], v[60:61]
  v_pk_mul_f32 v[62:63], v[30:31], v[62:63]
  v_mfma_f32_32x32x16_bf16 v[64:79], v[192:195], v[184:187], v[64:79]
  v_cvt_pk_bf16_f32 v188, v40, v41
  v_cvt_pk_bf16_f32 v189, v42, v43
  v_cvt_pk_bf16_f32 v190, v44, v45
  v_cvt_pk_bf16_f32 v191, v46, v47
  v_exp_f32_e64 v48, v48
  v_mfma_f32_32x32x16_bf16 v[80:95], v[196:199], v[184:187], v[80:95]
  v_exp_f32 v49, v49
  v_exp_f32 v50, v50
  v_exp_f32_e64 v51, v51
  v_mfma_f32_32x32x16_bf16 v[96:111], v[200:203], v[184:187], v[96:111]
  v_exp_f32 v52, v52
  v_exp_f32 v53, v53
  v_subrev_u32 v11, 0x4100, v5
  v_mfma_f32_32x32x16_bf16 v[64:79], v[204:207], v[188:191], v[64:79]
  v_exp_f32 v54, v54
  v_exp_f32 v55, v55
  v_exp_f32_e64 v56, v56
  v_mfma_f32_32x32x16_bf16 v[80:95], v[208:211], v[188:191], v[80:95]
  v_exp_f32 v57, v57
  v_exp_f32 v58, v58
  v_add_u32 v5, 0x8200, v5
  v_exp_f32_e64 v59, v59
  v_mfma_f32_32x32x16_bf16 v[96:111], v[212:215], v[188:191], v[96:111]
  v_exp_f32 v60, v60
  v_exp_f32 v61, v61
  v_exp_f32 v62, v62
  v_exp_f32 v63, v63
  v_min_u32_e64 v5, v11, v5
  v_pk_fma_f32 v[48:49], v[48:49], s[22:23], s[22:23]
  v_pk_fma_f32 v[50:51], v[50:51], s[22:23], s[22:23]
  v_pk_fma_f32 v[52:53], v[52:53], s[22:23], s[22:23]
  v_pk_fma_f32 v[54:55], v[54:55], s[22:23], s[22:23]
  v_pk_fma_f32 v[56:57], v[56:57], s[22:23], s[22:23]
  v_pk_fma_f32 v[58:59], v[58:59], s[22:23], s[22:23]
  v_pk_fma_f32 v[60:61], v[60:61], s[22:23], s[22:23]
  v_pk_fma_f32 v[62:63], v[62:63], s[22:23], s[22:23]
  v_mfma_f32_32x32x16_bf16 v[32:47], a[48:51], v[160:163], 0
  ds_read_b128 v[192:195], v1 offset:20480
  ds_read_b128 v[196:199], v1 offset:21504
  v_rcp_f32 v48, v48
  v_rcp_f32 v49, v49
  v_mfma_f32_32x32x16_bf16 v[32:47], a[52:55], v[164:167], v[32:47]
  ds_read_b128 v[200:203], v1 offset:22528
  ds_read_b128 v[204:207], v1 offset:23552
  v_rcp_f32 v50, v50
  v_rcp_f32 v51, v51
  v_mfma_f32_32x32x16_bf16 v[32:47], a[56:59], v[168:171], v[32:47]
  ds_read_b128 v[208:211], v1 offset:24576
  ds_read_b128 v[212:215], v1 offset:25600
  v_rcp_f32 v52, v52
  v_rcp_f32 v53, v53
  v_mfma_f32_32x32x16_bf16 v[32:47], a[60:63], v[172:175], v[32:47]
  buffer_store_dwordx4 v[116:119], v10, s[8:11], s28 offen offset:32
  v_rcp_f32 v54, v54
  v_rcp_f32 v55, v55
  v_mfma_f32_32x32x16_bf16 v[32:47], a[64:67], v[176:179], v[32:47]
  v_rcp_f32 v56, v56
  v_rcp_f32 v57, v57
  v_rcp_f32_e64 v58, v58
  v_mfma_f32_32x32x16_bf16 v[32:47], a[68:71], v[180:183], v[32:47]
  s_waitcnt lgkmcnt(0)
  v_rcp_f32 v59, v59
  v_rcp_f32 v60, v60
  v_rcp_f32 v61, v61
  v_rcp_f32 v62, v62
  v_rcp_f32 v63, v63
  v_pk_mul_f32 v[16:17], v[16:17], v[48:49]
  v_pk_mul_f32 v[18:19], v[18:19], v[50:51]
  v_pk_mul_f32 v[20:21], v[20:21], v[52:53]
  v_pk_mul_f32 v[22:23], v[22:23], v[54:55]
  v_pk_mul_f32 v[24:25], v[24:25], v[56:57]
  v_pk_mul_f32 v[26:27], v[26:27], v[58:59]
  v_pk_mul_f32 v[28:29], v[28:29], v[60:61]
  v_pk_mul_f32 v[30:31], v[30:31], v[62:63]
  v_pk_fma_f32 v[48:49], v[32:33], v[32:33], s[20:21] neg_lo:[1,0,1] neg_hi:[1,0,1]
  v_pk_fma_f32 v[50:51], v[34:35], v[34:35], s[20:21] neg_lo:[1,0,1] neg_hi:[1,0,1]
  v_pk_fma_f32 v[52:53], v[36:37], v[36:37], s[20:21] neg_lo:[1,0,1] neg_hi:[1,0,1]
  v_pk_fma_f32 v[54:55], v[38:39], v[38:39], s[20:21] neg_lo:[1,0,1] neg_hi:[1,0,1]
  v_pk_fma_f32 v[56:57], v[40:41], v[40:41], s[20:21] neg_lo:[1,0,1] neg_hi:[1,0,1]
  v_pk_fma_f32 v[58:59], v[42:43], v[42:43], s[20:21] neg_lo:[1,0,1] neg_hi:[1,0,1]
  v_pk_fma_f32 v[60:61], v[44:45], v[44:45], s[20:21] neg_lo:[1,0,1] neg_hi:[1,0,1]
  v_pk_fma_f32 v[62:63], v[46:47], v[46:47], s[20:21] neg_lo:[1,0,1] neg_hi:[1,0,1]
  v_pk_mul_f32 v[48:49], v[32:33], v[48:49]
  v_pk_mul_f32 v[50:51], v[34:35], v[50:51]
  v_pk_mul_f32 v[52:53], v[36:37], v[52:53]
  v_pk_mul_f32 v[54:55], v[38:39], v[54:55]
  v_pk_mul_f32 v[56:57], v[40:41], v[56:57]
  v_cvt_pk_bf16_f32 v184, v16, v17
  v_cvt_pk_bf16_f32 v185, v18, v19
  v_cvt_pk_bf16_f32 v186, v20, v21
  v_cvt_pk_bf16_f32 v187, v22, v23
  v_pk_mul_f32 v[58:59], v[42:43], v[58:59]
  v_pk_mul_f32 v[60:61], v[44:45], v[60:61]
  v_pk_mul_f32 v[62:63], v[46:47], v[62:63]
  v_mfma_f32_32x32x16_bf16 v[64:79], v[192:195], v[184:187], v[64:79]
  s_add_u32 s29, s29, 0x60000
  v_cvt_pk_bf16_f32 v188, v24, v25
  v_cvt_pk_bf16_f32 v189, v26, v27
  v_cvt_pk_bf16_f32 v190, v28, v29
  v_cvt_pk_bf16_f32 v191, v30, v31
  v_exp_f32_e64 v48, v48
  v_mfma_f32_32x32x16_bf16 v[80:95], v[196:199], v[184:187], v[80:95]
  s_add_u32 s52, s52, 0x60000
  v_exp_f32 v49, v49
  v_exp_f32 v50, v50
  v_exp_f32_e64 v51, v51
  v_mfma_f32_32x32x16_bf16 v[96:111], v[200:203], v[184:187], v[96:111]
  s_mov_b32 s32, s30
  v_exp_f32 v52, v52
  v_exp_f32_e64 v53, v53
  v_subrev_u32 v11, 0x4100, v4
  v_mfma_f32_32x32x16_bf16 v[64:79], v[204:207], v[188:191], v[64:79]
  s_add_u32 s30, s33, 32
  v_exp_f32 v54, v54
  v_exp_f32 v55, v55
  v_exp_f32 v56, v56
  v_mfma_f32_32x32x16_bf16 v[80:95], v[208:211], v[188:191], v[80:95]
  s_sub_u32 s33, s31, 0
  v_exp_f32 v57, v57
  v_exp_f32_e64 v58, v58
  v_add_u32 v4, 0x8200, v4
  v_exp_f32_e64 v59, v59
  v_mfma_f32_32x32x16_bf16 v[96:111], v[212:215], v[188:191], v[96:111]
  v_exp_f32 v60, v60
  v_exp_f32 v61, v61
  v_exp_f32 v62, v62
  v_exp_f32 v63, v63
  v_min_u32_e64 v4, v11, v4
  v_pk_fma_f32 v[48:49], v[48:49], s[22:23], s[22:23]
  v_pk_fma_f32 v[50:51], v[50:51], s[22:23], s[22:23]
  v_pk_fma_f32 v[52:53], v[52:53], s[22:23], s[22:23]
  v_pk_fma_f32 v[54:55], v[54:55], s[22:23], s[22:23]
  v_pk_fma_f32 v[56:57], v[56:57], s[22:23], s[22:23]
  v_pk_fma_f32 v[58:59], v[58:59], s[22:23], s[22:23]
  v_pk_fma_f32 v[60:61], v[60:61], s[22:23], s[22:23]
  v_pk_fma_f32 v[62:63], v[62:63], s[22:23], s[22:23]
  v_mfma_f32_32x32x16_bf16 v[16:31], a[72:75], v[160:163], 0
  ds_read_b128 v[192:195], v1 offset:26624
  ds_read_b128 v[196:199], v1 offset:27648
  v_rcp_f32 v48, v48
  v_rcp_f32 v49, v49
  v_mfma_f32_32x32x16_bf16 v[16:31], a[76:79], v[164:167], v[16:31]
  ds_read_b128 v[200:203], v1 offset:28672
  ds_read_b128 v[204:207], v1 offset:29696
  v_rcp_f32 v50, v50
  v_rcp_f32 v51, v51
  v_mfma_f32_32x32x16_bf16 v[16:31], a[80:83], v[168:171], v[16:31]
  ds_read_b128 v[208:211], v1 offset:30720
  ds_read_b128 v[212:215], v1 offset:31744
  v_rcp_f32 v52, v52
  v_rcp_f32 v53, v53
  v_mfma_f32_32x32x16_bf16 v[16:31], a[84:87], v[172:175], v[16:31]
  buffer_load_dword v249, v248, s[4:7], s29 offen
  v_rcp_f32 v54, v54
  v_rcp_f32 v55, v55
  v_mfma_f32_32x32x16_bf16 v[16:31], a[88:91], v[176:179], v[16:31]
  v_rcp_f32 v56, v56
  v_rcp_f32 v57, v57
  v_rcp_f32_e64 v58, v58
  v_mfma_f32_32x32x16_bf16 v[16:31], a[92:95], v[180:183], v[16:31]
  s_waitcnt lgkmcnt(0)
  v_rcp_f32 v59, v59
  v_rcp_f32 v60, v60
  v_rcp_f32 v61, v61
  v_rcp_f32_e64 v62, v62
  v_rcp_f32_e64 v63, v63
  v_pk_mul_f32 v[32:33], v[32:33], v[48:49]
  v_pk_mul_f32 v[34:35], v[34:35], v[50:51]
  v_pk_mul_f32 v[36:37], v[36:37], v[52:53]
  v_pk_mul_f32 v[38:39], v[38:39], v[54:55]
  v_pk_mul_f32 v[40:41], v[40:41], v[56:57]
  v_pk_mul_f32 v[42:43], v[42:43], v[58:59]
  v_pk_mul_f32 v[44:45], v[44:45], v[60:61]
  v_pk_mul_f32 v[46:47], v[46:47], v[62:63]
  v_pk_fma_f32 v[48:49], v[16:17], v[16:17], s[20:21] neg_lo:[1,0,1] neg_hi:[1,0,1]
  v_pk_fma_f32 v[50:51], v[18:19], v[18:19], s[20:21] neg_lo:[1,0,1] neg_hi:[1,0,1]
  v_pk_fma_f32 v[52:53], v[20:21], v[20:21], s[20:21] neg_lo:[1,0,1] neg_hi:[1,0,1]
  v_pk_fma_f32 v[54:55], v[22:23], v[22:23], s[20:21] neg_lo:[1,0,1] neg_hi:[1,0,1]
  v_pk_fma_f32 v[56:57], v[24:25], v[24:25], s[20:21] neg_lo:[1,0,1] neg_hi:[1,0,1]
  v_pk_fma_f32 v[58:59], v[26:27], v[26:27], s[20:21] neg_lo:[1,0,1] neg_hi:[1,0,1]
  v_pk_fma_f32 v[60:61], v[28:29], v[28:29], s[20:21] neg_lo:[1,0,1] neg_hi:[1,0,1]
  v_pk_fma_f32 v[62:63], v[30:31], v[30:31], s[20:21] neg_lo:[1,0,1] neg_hi:[1,0,1]
  v_pk_mul_f32 v[48:49], v[16:17], v[48:49]
  v_pk_mul_f32 v[50:51], v[18:19], v[50:51]
  v_pk_mul_f32 v[52:53], v[20:21], v[52:53]
  v_pk_mul_f32 v[54:55], v[22:23], v[54:55]
  v_pk_mul_f32 v[56:57], v[24:25], v[56:57]
  v_cvt_pk_bf16_f32 v184, v32, v33
  v_cvt_pk_bf16_f32 v185, v34, v35
  v_cvt_pk_bf16_f32 v186, v36, v37
  v_cvt_pk_bf16_f32 v187, v38, v39
  v_pk_mul_f32 v[58:59], v[26:27], v[58:59]
  v_pk_mul_f32 v[60:61], v[28:29], v[60:61]
  v_pk_mul_f32 v[62:63], v[30:31], v[62:63]
  v_mfma_f32_32x32x16_bf16 v[64:79], v[192:195], v[184:187], v[64:79]
  s_waitcnt vmcnt(3)
  ds_read_b128 v[220:223], v4 offset:96
  v_cvt_pk_bf16_f32 v188, v40, v41
  v_cvt_pk_bf16_f32 v189, v42, v43
  v_cvt_pk_bf16_f32 v190, v44, v45
  v_cvt_pk_bf16_f32 v191, v46, v47
  v_mfma_f32_32x32x16_bf16 v[80:95], v[196:199], v[184:187], v[80:95]
  ds_read_b128 v[228:231], v4 offset:288
  v_exp_f32 v48, v48
  v_exp_f32 v49, v49
  v_exp_f32 v50, v50
  v_mfma_f32_32x32x16_bf16 v[96:111], v[200:203], v[184:187], v[96:111]
  ds_read_b128 v[236:239], v4 offset:480
  v_exp_f32 v51, v51
  v_exp_f32 v52, v52
  v_mfma_f32_32x32x16_bf16 v[64:79], v[204:207], v[188:191], v[64:79]
  v_exp_f32 v53, v53
  v_exp_f32 v54, v54
  v_exp_f32_e64 v55, v55
  v_mfma_f32_32x32x16_bf16 v[80:95], v[208:211], v[188:191], v[80:95]
  v_exp_f32 v56, v56
  v_exp_f32 v57, v57
  v_exp_f32_e64 v58, v58
  v_mfma_f32_32x32x16_bf16 v[96:111], v[212:215], v[188:191], v[96:111]
  s_waitcnt lgkmcnt(0)
  v_exp_f32 v59, v59
  v_exp_f32 v60, v60
  v_exp_f32 v61, v61
  v_exp_f32 v62, v62
  v_exp_f32 v63, v63
  v_pk_fma_f32 v[48:49], v[48:49], s[22:23], s[22:23]
  v_pk_fma_f32 v[50:51], v[50:51], s[22:23], s[22:23]
  v_pk_fma_f32 v[52:53], v[52:53], s[22:23], s[22:23]
  v_pk_fma_f32 v[54:55], v[54:55], s[22:23], s[22:23]
  v_pk_fma_f32 v[56:57], v[56:57], s[22:23], s[22:23]
  v_pk_fma_f32 v[58:59], v[58:59], s[22:23], s[22:23]
  v_pk_fma_f32 v[60:61], v[60:61], s[22:23], s[22:23]
  v_pk_fma_f32 v[62:63], v[62:63], s[22:23], s[22:23]
  v_mfma_f32_32x32x16_bf16 v[32:47], a[96:99], v[160:163], 0
  ds_read_b128 v[192:195], v0 offset:24576
  ds_read_b128 v[196:199], v0 offset:25600
  v_rcp_f32 v48, v48
  v_rcp_f32 v49, v49
  v_mfma_f32_16x16x32_bf16 v[136:139], a[240:243], v[220:223], 0
  ds_read_b128 v[216:219], v3 offset:2800
  ds_read_b128 v[220:223], v4 offset:112
  v_mfma_f32_32x32x16_bf16 v[32:47], a[100:103], v[164:167], v[32:47]
  ds_read_b128 v[200:203], v0 offset:26624
  ds_read_b128 v[204:207], v0 offset:27648
  v_rcp_f32 v50, v50
  v_rcp_f32 v51, v51
  v_mfma_f32_16x16x32_bf16 v[136:139], a[244:247], v[228:231], v[136:139]
  ds_read_b128 v[224:227], v3 offset:7600
  ds_read_b128 v[228:231], v4 offset:304
  v_mfma_f32_32x32x16_bf16 v[32:47], a[104:107], v[168:171], v[32:47]
  ds_read_b128 v[208:211], v0 offset:28672
  ds_read_b128 v[212:215], v0 offset:29696
  v_rcp_f32 v52, v52
  v_rcp_f32 v53, v53
  v_mfma_f32_16x16x32_bf16 v[136:139], a[248:251], v[236:239], v[136:139]
  ds_read_b128 v[232:235], v3 offset:12400
  ds_read_b128 v[236:239], v4 offset:496
  v_mfma_f32_32x32x16_bf16 v[32:47], a[108:111], v[172:175], v[32:47]
  buffer_store_dwordx4 v[120:123], v10, s[8:11], s28 offen offset:64
  v_rcp_f32 v54, v54
  v_rcp_f32 v55, v55
  v_mfma_f32_32x32x16_bf16 v[32:47], a[112:115], v[176:179], v[32:47]
  v_rcp_f32 v56, v56
  v_rcp_f32 v57, v57
  v_rcp_f32_e64 v58, v58
  v_mfma_f32_32x32x16_bf16 v[32:47], a[116:119], v[180:183], v[32:47]
  s_waitcnt lgkmcnt(0)
  v_rcp_f32 v59, v59
  v_rcp_f32 v60, v60
  v_rcp_f32 v61, v61
  v_rcp_f32 v62, v62
  v_rcp_f32 v63, v63
  v_pk_mul_f32 v[16:17], v[16:17], v[48:49]
  v_pk_mul_f32 v[18:19], v[18:19], v[50:51]
  v_pk_mul_f32 v[20:21], v[20:21], v[52:53]
  v_pk_mul_f32 v[22:23], v[22:23], v[54:55]
  v_pk_mul_f32 v[24:25], v[24:25], v[56:57]
  v_pk_mul_f32 v[26:27], v[26:27], v[58:59]
  v_pk_mul_f32 v[28:29], v[28:29], v[60:61]
  v_pk_mul_f32 v[30:31], v[30:31], v[62:63]
  v_pk_add_f32 v[12:13], v[136:137], v[138:139]
  v_pk_mul_f32 v[14:15], v[136:137], v[136:137]
  v_pk_fma_f32 v[14:15], v[138:139], v[138:139], v[14:15]
  v_pk_fma_f32 v[48:49], v[32:33], v[32:33], s[20:21] neg_lo:[1,0,1] neg_hi:[1,0,1]
  v_pk_fma_f32 v[50:51], v[34:35], v[34:35], s[20:21] neg_lo:[1,0,1] neg_hi:[1,0,1]
  v_pk_fma_f32 v[52:53], v[36:37], v[36:37], s[20:21] neg_lo:[1,0,1] neg_hi:[1,0,1]
  v_pk_fma_f32 v[54:55], v[38:39], v[38:39], s[20:21] neg_lo:[1,0,1] neg_hi:[1,0,1]
  v_pk_fma_f32 v[56:57], v[40:41], v[40:41], s[20:21] neg_lo:[1,0,1] neg_hi:[1,0,1]
  v_pk_fma_f32 v[58:59], v[42:43], v[42:43], s[20:21] neg_lo:[1,0,1] neg_hi:[1,0,1]
  v_pk_fma_f32 v[60:61], v[44:45], v[44:45], s[20:21] neg_lo:[1,0,1] neg_hi:[1,0,1]
  v_pk_fma_f32 v[62:63], v[46:47], v[46:47], s[20:21] neg_lo:[1,0,1] neg_hi:[1,0,1]
  v_pk_mul_f32 v[48:49], v[32:33], v[48:49]
  v_pk_mul_f32 v[50:51], v[34:35], v[50:51]
  v_pk_mul_f32 v[52:53], v[36:37], v[52:53]
  v_pk_mul_f32 v[54:55], v[38:39], v[54:55]
  v_pk_mul_f32 v[56:57], v[40:41], v[56:57]
  v_pk_mul_f32 v[58:59], v[42:43], v[58:59]
  v_pk_mul_f32 v[60:61], v[44:45], v[60:61]
  v_pk_mul_f32 v[62:63], v[46:47], v[62:63]
  v_mfma_f32_16x16x32_bf16 v[140:143], v[216:219], v[220:223], 0
  v_cvt_pk_bf16_f32 v184, v16, v17
  v_cvt_pk_bf16_f32 v185, v18, v19
  v_mfma_f32_16x16x32_bf16 v[140:143], v[224:227], v[228:231], v[140:143]
  v_cvt_pk_bf16_f32 v186, v20, v21
  v_cvt_pk_bf16_f32 v187, v22, v23
  v_mfma_f32_16x16x32_bf16 v[140:143], v[232:235], v[236:239], v[140:143]
  ds_read_b128 v[220:223], v4 offset:128
  v_mfma_f32_32x32x16_bf16 v[64:79], v[192:195], v[184:187], v[64:79]
  ds_read_b128 v[224:227], v3 offset:8000
  ds_read_b128 v[228:231], v4 offset:320
  v_cvt_pk_bf16_f32 v188, v24, v25
  v_cvt_pk_bf16_f32 v189, v26, v27
  v_cvt_pk_bf16_f32 v190, v28, v29
  v_cvt_pk_bf16_f32 v191, v30, v31
  v_mfma_f32_32x32x16_bf16 v[80:95], v[196:199], v[184:187], v[80:95]
  ds_read_b128 v[232:235], v3 offset:12800
  ds_read_b128 v[236:239], v4 offset:512
  v_exp_f32 v48, v48
  v_exp_f32 v49, v49
  v_mfma_f32_32x32x16_bf16 v[96:111], v[200:203], v[184:187], v[96:111]
  s_sub_u32 s31, s32, 32
  v_exp_f32 v50, v50
  v_exp_f32 v51, v51
  v_exp_f32 v52, v52
  v_mfma_f32_32x32x16_bf16 v[64:79], v[204:207], v[188:191], v[64:79]
  v_exp_f32 v53, v53
  v_exp_f32 v54, v54
  v_exp_f32_e64 v55, v55
  v_mfma_f32_32x32x16_bf16 v[80:95], v[208:211], v[188:191], v[80:95]
  v_exp_f32 v56, v56
  v_exp_f32 v57, v57
  v_exp_f32_e64 v58, v58
  v_mfma_f32_32x32x16_bf16 v[96:111], v[212:215], v[188:191], v[96:111]
  s_waitcnt lgkmcnt(0)
  v_exp_f32 v59, v59
  v_exp_f32 v60, v60
  v_exp_f32 v61, v61
  v_exp_f32 v62, v62
  v_exp_f32 v63, v63
  v_pk_add_f32 v[12:13], v[12:13], v[140:141]
  v_pk_fma_f32 v[14:15], v[140:141], v[140:141], v[14:15]
  v_pk_add_f32 v[12:13], v[12:13], v[142:143]
  v_pk_fma_f32 v[14:15], v[142:143], v[142:143], v[14:15]
  v_pk_fma_f32 v[48:49], v[48:49], s[22:23], s[22:23]
  v_pk_fma_f32 v[50:51], v[50:51], s[22:23], s[22:23]
  v_pk_fma_f32 v[52:53], v[52:53], s[22:23], s[22:23]
  v_pk_fma_f32 v[54:55], v[54:55], s[22:23], s[22:23]
  v_pk_fma_f32 v[56:57], v[56:57], s[22:23], s[22:23]
  v_pk_fma_f32 v[58:59], v[58:59], s[22:23], s[22:23]
  v_pk_fma_f32 v[60:61], v[60:61], s[22:23], s[22:23]
  v_pk_fma_f32 v[62:63], v[62:63], s[22:23], s[22:23]
  v_mfma_f32_32x32x16_bf16 v[16:31], a[120:123], v[160:163], 0
  ds_read_b128 v[192:195], v0 offset:30720
  ds_read_b128 v[196:199], v0 offset:31744
  v_rcp_f32 v48, v48
  v_rcp_f32 v49, v49
  v_mfma_f32_16x16x32_bf16 v[144:147], a[252:255], v[220:223], 0
  ds_read_b128 v[216:219], v3 offset:3600
  ds_read_b128 v[220:223], v4 offset:144
  v_mfma_f32_32x32x16_bf16 v[16:31], a[124:127], v[164:167], v[16:31]
  ds_read_b128 v[200:203], v0 offset:32768
  ds_read_b128 v[204:207], v0 offset:33792
  v_rcp_f32 v50, v50
  v_rcp_f32 v51, v51
  v_mfma_f32_16x16x32_bf16 v[144:147], v[224:227], v[228:231], v[144:147]
  ds_read_b128 v[224:227], v3 offset:8400
  ds_read_b128 v[228:231], v4 offset:336
  v_mfma_f32_32x32x16_bf16 v[16:31], a[128:131], v[168:171], v[16:31]
  ds_read_b128 v[208:211], v0 offset:34816
  ds_read_b128 v[212:215], v0 offset:35840
  v_rcp_f32 v52, v52
  v_rcp_f32 v53, v53
  v_mfma_f32_16x16x32_bf16 v[144:147], v[232:235], v[236:239], v[144:147]
  ds_read_b128 v[232:235], v3 offset:13200
  ds_read_b128 v[236:239], v4 offset:528
  v_mfma_f32_32x32x16_bf16 v[16:31], a[132:135], v[172:175], v[16:31]
  buffer_store_dwordx4 v[124:127], v10, s[8:11], s28 offen offset:96
  v_rcp_f32 v54, v54
  v_rcp_f32 v55, v55
  v_mfma_f32_32x32x16_bf16 v[16:31], a[136:139], v[176:179], v[16:31]
  v_rcp_f32 v56, v56
  v_rcp_f32 v57, v57
  v_rcp_f32_e64 v58, v58
  v_mfma_f32_32x32x16_bf16 v[16:31], a[140:143], v[180:183], v[16:31]
  s_waitcnt lgkmcnt(0)
  v_rcp_f32 v59, v59
  v_rcp_f32 v60, v60
  v_rcp_f32 v61, v61
  v_rcp_f32 v62, v62
  v_rcp_f32 v63, v63
  v_pk_mul_f32 v[32:33], v[32:33], v[48:49]
  v_pk_mul_f32 v[34:35], v[34:35], v[50:51]
  v_pk_mul_f32 v[36:37], v[36:37], v[52:53]
  v_pk_mul_f32 v[38:39], v[38:39], v[54:55]
  v_pk_mul_f32 v[40:41], v[40:41], v[56:57]
  v_pk_mul_f32 v[42:43], v[42:43], v[58:59]
  v_pk_mul_f32 v[44:45], v[44:45], v[60:61]
  v_pk_mul_f32 v[46:47], v[46:47], v[62:63]
  v_pk_add_f32 v[12:13], v[12:13], v[144:145]
  v_pk_fma_f32 v[14:15], v[144:145], v[144:145], v[14:15]
  v_pk_add_f32 v[12:13], v[12:13], v[146:147]
  v_pk_fma_f32 v[14:15], v[146:147], v[146:147], v[14:15]
  v_pk_fma_f32 v[48:49], v[16:17], v[16:17], s[20:21] neg_lo:[1,0,1] neg_hi:[1,0,1]
  v_pk_fma_f32 v[50:51], v[18:19], v[18:19], s[20:21] neg_lo:[1,0,1] neg_hi:[1,0,1]
  v_pk_fma_f32 v[52:53], v[20:21], v[20:21], s[20:21] neg_lo:[1,0,1] neg_hi:[1,0,1]
  v_pk_fma_f32 v[54:55], v[22:23], v[22:23], s[20:21] neg_lo:[1,0,1] neg_hi:[1,0,1]
  v_pk_fma_f32 v[56:57], v[24:25], v[24:25], s[20:21] neg_lo:[1,0,1] neg_hi:[1,0,1]
  v_pk_fma_f32 v[58:59], v[26:27], v[26:27], s[20:21] neg_lo:[1,0,1] neg_hi:[1,0,1]
  v_pk_fma_f32 v[60:61], v[28:29], v[28:29], s[20:21] neg_lo:[1,0,1] neg_hi:[1,0,1]
  v_pk_fma_f32 v[62:63], v[30:31], v[30:31], s[20:21] neg_lo:[1,0,1] neg_hi:[1,0,1]
  v_pk_mul_f32 v[48:49], v[16:17], v[48:49]
  v_pk_mul_f32 v[50:51], v[18:19], v[50:51]
  v_pk_mul_f32 v[52:53], v[20:21], v[52:53]
  v_pk_mul_f32 v[54:55], v[22:23], v[54:55]
  v_pk_mul_f32 v[56:57], v[24:25], v[56:57]
  v_pk_mul_f32 v[58:59], v[26:27], v[58:59]
  v_pk_mul_f32 v[60:61], v[28:29], v[60:61]
  v_pk_mul_f32 v[62:63], v[30:31], v[62:63]
  v_mfma_f32_16x16x32_bf16 v[148:151], v[216:219], v[220:223], 0
  v_cvt_pk_bf16_f32 v184, v32, v33
  v_cvt_pk_bf16_f32 v185, v34, v35
  v_mfma_f32_16x16x32_bf16 v[148:151], v[224:227], v[228:231], v[148:151]
  v_cvt_pk_bf16_f32 v186, v36, v37
  v_cvt_pk_bf16_f32 v187, v38, v39
  v_mfma_f32_16x16x32_bf16 v[148:151], v[232:235], v[236:239], v[148:151]
  ds_read_b128 v[216:219], v3 offset:4000
  ds_read_b128 v[220:223], v4 offset:160
  v_mfma_f32_32x32x16_bf16 v[64:79], v[192:195], v[184:187], v[64:79]
  ds_read_b128 v[224:227], v3 offset:8800
  ds_read_b128 v[228:231], v4 offset:352
  v_cvt_pk_bf16_f32 v188, v40, v41
  v_cvt_pk_bf16_f32 v189, v42, v43
  v_cvt_pk_bf16_f32 v190, v44, v45
  v_cvt_pk_bf16_f32 v191, v46, v47
  v_mfma_f32_32x32x16_bf16 v[80:95], v[196:199], v[184:187], v[80:95]
  ds_read_b128 v[232:235], v3 offset:13600
  ds_read_b128 v[236:239], v4 offset:544
  v_exp_f32 v48, v48
  v_exp_f32 v49, v49
  v_mfma_f32_32x32x16_bf16 v[96:111], v[200:203], v[184:187], v[96:111]
  v_exp_f32 v50, v50
  v_exp_f32 v51, v51
  v_exp_f32_e64 v52, v52
  v_mfma_f32_32x32x16_bf16 v[64:79], v[204:207], v[188:191], v[64:79]
  v_exp_f32 v53, v53
  v_exp_f32 v54, v54
  v_exp_f32_e64 v55, v55
  v_mfma_f32_32x32x16_bf16 v[80:95], v[208:211], v[188:191], v[80:95]
  v_exp_f32 v56, v56
  v_exp_f32 v57, v57
  v_exp_f32_e64 v58, v58
  v_mfma_f32_32x32x16_bf16 v[96:111], v[212:215], v[188:191], v[96:111]
  s_waitcnt lgkmcnt(0)
  v_exp_f32 v59, v59
  v_exp_f32 v60, v60
  v_exp_f32 v61, v61
  v_exp_f32 v62, v62
  v_exp_f32 v63, v63
  v_pk_add_f32 v[12:13], v[12:13], v[148:149]
  v_pk_fma_f32 v[14:15], v[148:149], v[148:149], v[14:15]
  v_pk_add_f32 v[12:13], v[12:13], v[150:151]
  v_pk_fma_f32 v[14:15], v[150:151], v[150:151], v[14:15]
  v_pk_fma_f32 v[48:49], v[48:49], s[22:23], s[22:23]
  v_pk_fma_f32 v[50:51], v[50:51], s[22:23], s[22:23]
  v_pk_fma_f32 v[52:53], v[52:53], s[22:23], s[22:23]
  v_pk_fma_f32 v[54:55], v[54:55], s[22:23], s[22:23]
  v_pk_fma_f32 v[56:57], v[56:57], s[22:23], s[22:23]
  v_pk_fma_f32 v[58:59], v[58:59], s[22:23], s[22:23]
  v_pk_fma_f32 v[60:61], v[60:61], s[22:23], s[22:23]
  v_pk_fma_f32 v[62:63], v[62:63], s[22:23], s[22:23]
  v_mfma_f32_32x32x16_bf16 v[32:47], a[144:147], v[160:163], 0
  ds_read_b128 v[192:195], v0 offset:36864
  ds_read_b128 v[196:199], v0 offset:37888
  v_rcp_f32 v48, v48
  v_rcp_f32 v49, v49
  v_mfma_f32_16x16x32_bf16 v[152:155], v[216:219], v[220:223], 0
  ds_read_b128 v[216:219], v3 offset:4400
  ds_read_b128 v[220:223], v4 offset:176
  v_mfma_f32_32x32x16_bf16 v[32:47], a[148:151], v[164:167], v[32:47]
  ds_read_b128 v[200:203], v0 offset:38912
  ds_read_b128 v[204:207], v0 offset:39936
  v_rcp_f32 v50, v50
  v_rcp_f32 v51, v51
  v_mfma_f32_16x16x32_bf16 v[152:155], v[224:227], v[228:231], v[152:155]
  ds_read_b128 v[224:227], v3 offset:9200
  ds_read_b128 v[228:231], v4 offset:368
  v_mfma_f32_32x32x16_bf16 v[32:47], a[152:155], v[168:171], v[32:47]
  ds_read_b128 v[208:211], v0 offset:40960
  ds_read_b128 v[212:215], v0 offset:41984
  v_rcp_f32 v52, v52
  v_rcp_f32 v53, v53
  v_mfma_f32_16x16x32_bf16 v[152:155], v[232:235], v[236:239], v[152:155]
  ds_read_b128 v[232:235], v3 offset:14000
  ds_read_b128 v[236:239], v4 offset:560
  v_mfma_f32_32x32x16_bf16 v[32:47], a[156:159], v[172:175], v[32:47]
  v_rcp_f32 v54, v54
  v_rcp_f32 v55, v55
  v_rcp_f32_e64 v56, v56
  v_mfma_f32_32x32x16_bf16 v[32:47], a[160:163], v[176:179], v[32:47]
  v_rcp_f32 v57, v57
  v_rcp_f32 v58, v58
  v_rcp_f32_e64 v59, v59
  v_mfma_f32_32x32x16_bf16 v[32:47], a[164:167], v[180:183], v[32:47]
  s_waitcnt lgkmcnt(0)
  v_rcp_f32 v60, v60
  v_rcp_f32 v61, v61
  v_rcp_f32 v62, v62
  v_rcp_f32_e64 v63, v63
  v_pk_mul_f32 v[16:17], v[16:17], v[48:49]
  v_pk_mul_f32 v[18:19], v[18:19], v[50:51]
  v_pk_mul_f32 v[20:21], v[20:21], v[52:53]
  v_pk_mul_f32 v[22:23], v[22:23], v[54:55]
  v_pk_mul_f32 v[24:25], v[24:25], v[56:57]
  v_pk_mul_f32 v[26:27], v[26:27], v[58:59]
  v_pk_mul_f32 v[28:29], v[28:29], v[60:61]
  v_pk_mul_f32 v[30:31], v[30:31], v[62:63]
  v_pk_add_f32 v[12:13], v[12:13], v[152:153]
  v_pk_fma_f32 v[14:15], v[152:153], v[152:153], v[14:15]
  v_pk_add_f32 v[12:13], v[12:13], v[154:155]
  v_pk_fma_f32 v[14:15], v[154:155], v[154:155], v[14:15]
  v_pk_fma_f32 v[48:49], v[32:33], v[32:33], s[20:21] neg_lo:[1,0,1] neg_hi:[1,0,1]
  v_pk_fma_f32 v[50:51], v[34:35], v[34:35], s[20:21] neg_lo:[1,0,1] neg_hi:[1,0,1]
  v_pk_fma_f32 v[52:53], v[36:37], v[36:37], s[20:21] neg_lo:[1,0,1] neg_hi:[1,0,1]
  v_pk_fma_f32 v[54:55], v[38:39], v[38:39], s[20:21] neg_lo:[1,0,1] neg_hi:[1,0,1]
  v_pk_fma_f32 v[56:57], v[40:41], v[40:41], s[20:21] neg_lo:[1,0,1] neg_hi:[1,0,1]
  v_pk_fma_f32 v[58:59], v[42:43], v[42:43], s[20:21] neg_lo:[1,0,1] neg_hi:[1,0,1]
  v_pk_fma_f32 v[60:61], v[44:45], v[44:45], s[20:21] neg_lo:[1,0,1] neg_hi:[1,0,1]
  v_pk_fma_f32 v[62:63], v[46:47], v[46:47], s[20:21] neg_lo:[1,0,1] neg_hi:[1,0,1]
  v_pk_mul_f32 v[48:49], v[32:33], v[48:49]
  v_pk_mul_f32 v[50:51], v[34:35], v[50:51]
  v_pk_mul_f32 v[52:53], v[36:37], v[52:53]
  v_pk_mul_f32 v[54:55], v[38:39], v[54:55]
  v_pk_mul_f32 v[56:57], v[40:41], v[56:57]
  v_pk_mul_f32 v[58:59], v[42:43], v[58:59]
  v_pk_mul_f32 v[60:61], v[44:45], v[60:61]
  v_pk_mul_f32 v[62:63], v[46:47], v[62:63]
  v_mfma_f32_16x16x32_bf16 v[156:159], v[216:219], v[220:223], 0
  v_cvt_pk_bf16_f32 v184, v16, v17
  v_cvt_pk_bf16_f32 v185, v18, v19
  v_mfma_f32_16x16x32_bf16 v[156:159], v[224:227], v[228:231], v[156:159]
  v_cvt_pk_bf16_f32 v186, v20, v21
  v_cvt_pk_bf16_f32 v187, v22, v23
  v_mfma_f32_16x16x32_bf16 v[156:159], v[232:235], v[236:239], v[156:159]
  ds_read_b128 v[216:219], v3
  ds_read_b128 v[220:223], v4
  v_mfma_f32_32x32x16_bf16 v[64:79], v[192:195], v[184:187], v[64:79]
  ds_read_b128 v[224:227], v3 offset:4800
  ds_read_b128 v[228:231], v4 offset:192
  v_cvt_pk_bf16_f32 v188, v24, v25
  v_cvt_pk_bf16_f32 v189, v26, v27
  v_cvt_pk_bf16_f32 v190, v28, v29
  v_cvt_pk_bf16_f32 v191, v30, v31
  v_mfma_f32_32x32x16_bf16 v[80:95], v[196:199], v[184:187], v[80:95]
  ds_read_b128 v[232:235], v3 offset:9600
  ds_read_b128 v[236:239], v4 offset:384
  v_exp_f32 v48, v48
  v_exp_f32 v49, v49
  v_mfma_f32_32x32x16_bf16 v[96:111], v[200:203], v[184:187], v[96:111]
  v_exp_f32 v50, v50
  v_exp_f32 v51, v51
  v_exp_f32_e64 v52, v52
  v_mfma_f32_32x32x16_bf16 v[64:79], v[204:207], v[188:191], v[64:79]
  v_exp_f32 v53, v53
  v_exp_f32 v54, v54
  v_exp_f32_e64 v55, v55
  v_mfma_f32_32x32x16_bf16 v[80:95], v[208:211], v[188:191], v[80:95]
  v_exp_f32 v56, v56
  v_exp_f32 v57, v57
  v_exp_f32_e64 v58, v58
  v_mfma_f32_32x32x16_bf16 v[96:111], v[212:215], v[188:191], v[96:111]
  s_waitcnt lgkmcnt(0)
  v_exp_f32 v59, v59
  v_exp_f32 v60, v60
  v_exp_f32 v61, v61
  v_exp_f32 v62, v62
  v_exp_f32 v63, v63
  v_pk_add_f32 v[12:13], v[12:13], v[156:157]
  v_pk_fma_f32 v[14:15], v[156:157], v[156:157], v[14:15]
  v_pk_add_f32 v[12:13], v[12:13], v[158:159]
  v_pk_fma_f32 v[14:15], v[158:159], v[158:159], v[14:15]
  v_pk_fma_f32 v[48:49], v[48:49], s[22:23], s[22:23]
  v_pk_fma_f32 v[50:51], v[50:51], s[22:23], s[22:23]
  v_pk_fma_f32 v[52:53], v[52:53], s[22:23], s[22:23]
  v_pk_fma_f32 v[54:55], v[54:55], s[22:23], s[22:23]
  v_pk_fma_f32 v[56:57], v[56:57], s[22:23], s[22:23]
  v_pk_fma_f32 v[58:59], v[58:59], s[22:23], s[22:23]
  v_pk_fma_f32 v[60:61], v[60:61], s[22:23], s[22:23]
  v_pk_fma_f32 v[62:63], v[62:63], s[22:23], s[22:23]
  v_mfma_f32_32x32x16_bf16 v[16:31], a[168:171], v[160:163], 0
  ds_read_b128 v[192:195], v0 offset:43008
  ds_read_b128 v[196:199], v0 offset:44032
  v_rcp_f32 v48, v48
  v_rcp_f32 v49, v49
  v_mfma_f32_16x16x32_bf16 v[112:115], v[216:219], v[220:223], 0
  ds_read_b128 v[216:219], v3 offset:400
  ds_read_b128 v[220:223], v4 offset:16
  v_mfma_f32_32x32x16_bf16 v[16:31], a[172:175], v[164:167], v[16:31]
  ds_read_b128 v[200:203], v0 offset:45056
  ds_read_b128 v[204:207], v0 offset:46080
  v_rcp_f32 v50, v50
  v_rcp_f32 v51, v51
  v_mfma_f32_16x16x32_bf16 v[112:115], v[224:227], v[228:231], v[112:115]
  ds_read_b128 v[224:227], v3 offset:5200
  ds_read_b128 v[228:231], v4 offset:208
  v_mfma_f32_32x32x16_bf16 v[16:31], a[176:179], v[168:171], v[16:31]
  ds_read_b128 v[208:211], v0 offset:47104
  ds_read_b128 v[212:215], v0 offset:48128
  v_rcp_f32 v52, v52
  v_rcp_f32 v53, v53
  v_mfma_f32_16x16x32_bf16 v[112:115], v[232:235], v[236:239], v[112:115]
  ds_read_b128 v[232:235], v3 offset:10000
  ds_read_b128 v[236:239], v4 offset:400
  v_mfma_f32_32x32x16_bf16 v[16:31], a[180:183], v[172:175], v[16:31]
  buffer_store_dwordx4 v[128:131], v10, s[8:11], s28 offen offset:128
  v_rcp_f32 v54, v54
  v_rcp_f32 v55, v55
  v_mfma_f32_32x32x16_bf16 v[16:31], a[184:187], v[176:179], v[16:31]
  v_rcp_f32 v56, v56
  v_rcp_f32 v57, v57
  v_rcp_f32_e64 v58, v58
  v_mfma_f32_32x32x16_bf16 v[16:31], a[188:191], v[180:183], v[16:31]
  s_waitcnt lgkmcnt(0)
  v_rcp_f32 v59, v59
  v_rcp_f32 v60, v60
  v_rcp_f32 v61, v61
  v_rcp_f32 v62, v62
  v_rcp_f32 v63, v63
  v_pk_mul_f32 v[32:33], v[32:33], v[48:49]
  v_pk_mul_f32 v[34:35], v[34:35], v[50:51]
  v_pk_mul_f32 v[36:37], v[36:37], v[52:53]
  v_pk_mul_f32 v[38:39], v[38:39], v[54:55]
  v_pk_mul_f32 v[40:41], v[40:41], v[56:57]
  v_pk_mul_f32 v[42:43], v[42:43], v[58:59]
  v_pk_mul_f32 v[44:45], v[44:45], v[60:61]
  v_pk_mul_f32 v[46:47], v[46:47], v[62:63]
  v_pk_add_f32 v[12:13], v[12:13], v[112:113]
  v_pk_fma_f32 v[14:15], v[112:113], v[112:113], v[14:15]
  v_pk_add_f32 v[12:13], v[12:13], v[114:115]
  v_pk_fma_f32 v[14:15], v[114:115], v[114:115], v[14:15]
  v_pk_fma_f32 v[48:49], v[16:17], v[16:17], s[20:21] neg_lo:[1,0,1] neg_hi:[1,0,1]
  v_pk_fma_f32 v[50:51], v[18:19], v[18:19], s[20:21] neg_lo:[1,0,1] neg_hi:[1,0,1]
  v_pk_fma_f32 v[52:53], v[20:21], v[20:21], s[20:21] neg_lo:[1,0,1] neg_hi:[1,0,1]
  v_pk_fma_f32 v[54:55], v[22:23], v[22:23], s[20:21] neg_lo:[1,0,1] neg_hi:[1,0,1]
  v_pk_fma_f32 v[56:57], v[24:25], v[24:25], s[20:21] neg_lo:[1,0,1] neg_hi:[1,0,1]
  v_pk_fma_f32 v[58:59], v[26:27], v[26:27], s[20:21] neg_lo:[1,0,1] neg_hi:[1,0,1]
  v_pk_fma_f32 v[60:61], v[28:29], v[28:29], s[20:21] neg_lo:[1,0,1] neg_hi:[1,0,1]
  v_pk_fma_f32 v[62:63], v[30:31], v[30:31], s[20:21] neg_lo:[1,0,1] neg_hi:[1,0,1]
  v_pk_mul_f32 v[48:49], v[16:17], v[48:49]
  v_pk_mul_f32 v[50:51], v[18:19], v[50:51]
  v_pk_mul_f32 v[52:53], v[20:21], v[52:53]
  v_pk_mul_f32 v[54:55], v[22:23], v[54:55]
  v_pk_mul_f32 v[56:57], v[24:25], v[56:57]
  v_pk_mul_f32 v[58:59], v[26:27], v[58:59]
  v_pk_mul_f32 v[60:61], v[28:29], v[60:61]
  v_pk_mul_f32 v[62:63], v[30:31], v[62:63]
  v_mfma_f32_16x16x32_bf16 v[116:119], v[216:219], v[220:223], 0
  v_cvt_pk_bf16_f32 v184, v32, v33
  v_cvt_pk_bf16_f32 v185, v34, v35
  v_mfma_f32_16x16x32_bf16 v[116:119], v[224:227], v[228:231], v[116:119]
  v_cvt_pk_bf16_f32 v186, v36, v37
  v_cvt_pk_bf16_f32 v187, v38, v39
  v_mfma_f32_16x16x32_bf16 v[116:119], v[232:235], v[236:239], v[116:119]
  ds_read_b128 v[216:219], v3 offset:800
  ds_read_b128 v[220:223], v4 offset:32
  v_mfma_f32_32x32x16_bf16 v[64:79], v[192:195], v[184:187], v[64:79]
  ds_read_b128 v[224:227], v3 offset:5600
  ds_read_b128 v[228:231], v4 offset:224
  v_cvt_pk_bf16_f32 v188, v40, v41
  v_cvt_pk_bf16_f32 v189, v42, v43
  v_cvt_pk_bf16_f32 v190, v44, v45
  v_cvt_pk_bf16_f32 v191, v46, v47
  v_mfma_f32_32x32x16_bf16 v[80:95], v[196:199], v[184:187], v[80:95]
  ds_read_b128 v[232:235], v3 offset:10400
  ds_read_b128 v[236:239], v4 offset:416
  v_exp_f32 v48, v48
  v_exp_f32 v49, v49
  v_mfma_f32_32x32x16_bf16 v[96:111], v[200:203], v[184:187], v[96:111]
  v_exp_f32 v50, v50
  v_exp_f32 v51, v51
  v_exp_f32_e64 v52, v52
  v_mfma_f32_32x32x16_bf16 v[64:79], v[204:207], v[188:191], v[64:79]
  v_exp_f32 v53, v53
  v_exp_f32 v54, v54
  v_exp_f32_e64 v55, v55
  v_mfma_f32_32x32x16_bf16 v[80:95], v[208:211], v[188:191], v[80:95]
  v_exp_f32 v56, v56
  v_exp_f32 v57, v57
  v_exp_f32_e64 v58, v58
  v_mfma_f32_32x32x16_bf16 v[96:111], v[212:215], v[188:191], v[96:111]
  s_waitcnt lgkmcnt(0)
  v_exp_f32 v59, v59
  v_exp_f32 v60, v60
  v_exp_f32 v61, v61
  v_exp_f32 v62, v62
  v_exp_f32 v63, v63
  v_pk_add_f32 v[12:13], v[12:13], v[116:117]
  v_pk_fma_f32 v[14:15], v[116:117], v[116:117], v[14:15]
  v_pk_add_f32 v[12:13], v[12:13], v[118:119]
  v_pk_fma_f32 v[14:15], v[118:119], v[118:119], v[14:15]
  v_pk_fma_f32 v[48:49], v[48:49], s[22:23], s[22:23]
  v_pk_fma_f32 v[50:51], v[50:51], s[22:23], s[22:23]
  v_pk_fma_f32 v[52:53], v[52:53], s[22:23], s[22:23]
  v_pk_fma_f32 v[54:55], v[54:55], s[22:23], s[22:23]
  v_pk_fma_f32 v[56:57], v[56:57], s[22:23], s[22:23]
  v_pk_fma_f32 v[58:59], v[58:59], s[22:23], s[22:23]
  v_pk_fma_f32 v[60:61], v[60:61], s[22:23], s[22:23]
  v_pk_fma_f32 v[62:63], v[62:63], s[22:23], s[22:23]
  v_mfma_f32_32x32x16_bf16 v[32:47], a[192:195], v[160:163], 0
  ds_read_b128 v[192:195], v0 offset:49152
  ds_read_b128 v[196:199], v0 offset:50176
  v_rcp_f32 v48, v48
  v_rcp_f32 v49, v49
  v_mfma_f32_16x16x32_bf16 v[120:123], v[216:219], v[220:223], 0
  ds_read_b128 v[216:219], v3 offset:1200
  ds_read_b128 v[220:223], v4 offset:48
  v_mfma_f32_32x32x16_bf16 v[32:47], a[196:199], v[164:167], v[32:47]
  ds_read_b128 v[200:203], v0 offset:51200
  ds_read_b128 v[204:207], v0 offset:52224
  v_rcp_f32 v50, v50
  v_rcp_f32 v51, v51
  v_mfma_f32_16x16x32_bf16 v[120:123], v[224:227], v[228:231], v[120:123]
  ds_read_b128 v[224:227], v3 offset:6000
  ds_read_b128 v[228:231], v4 offset:240
  v_mfma_f32_32x32x16_bf16 v[32:47], a[200:203], v[168:171], v[32:47]
  ds_read_b128 v[208:211], v0 offset:53248
  ds_read_b128 v[212:215], v0 offset:54272
  v_rcp_f32 v52, v52
  v_rcp_f32 v53, v53
  v_mfma_f32_16x16x32_bf16 v[120:123], v[232:235], v[236:239], v[120:123]
  ds_read_b128 v[232:235], v3 offset:10800
  ds_read_b128 v[236:239], v4 offset:432
  v_mfma_f32_32x32x16_bf16 v[32:47], a[204:207], v[172:175], v[32:47]
  buffer_store_dwordx4 v[132:135], v10, s[8:11], s28 offen offset:160
  v_rcp_f32 v54, v54
  v_rcp_f32 v55, v55
  v_mfma_f32_32x32x16_bf16 v[32:47], a[208:211], v[176:179], v[32:47]
  v_rcp_f32 v56, v56
  v_rcp_f32 v57, v57
  v_rcp_f32_e64 v58, v58
  v_mfma_f32_32x32x16_bf16 v[32:47], a[212:215], v[180:183], v[32:47]
  s_waitcnt lgkmcnt(0)
  v_rcp_f32 v59, v59
  v_rcp_f32 v60, v60
  v_rcp_f32 v61, v61
  v_rcp_f32 v62, v62
  v_rcp_f32 v63, v63
  v_pk_mul_f32 v[16:17], v[16:17], v[48:49]
  v_pk_mul_f32 v[18:19], v[18:19], v[50:51]
  v_pk_mul_f32 v[20:21], v[20:21], v[52:53]
  v_pk_mul_f32 v[22:23], v[22:23], v[54:55]
  v_pk_mul_f32 v[24:25], v[24:25], v[56:57]
  v_pk_mul_f32 v[26:27], v[26:27], v[58:59]
  v_pk_mul_f32 v[28:29], v[28:29], v[60:61]
  v_pk_mul_f32 v[30:31], v[30:31], v[62:63]
  v_pk_add_f32 v[12:13], v[12:13], v[120:121]
  v_pk_fma_f32 v[14:15], v[120:121], v[120:121], v[14:15]
  v_pk_add_f32 v[12:13], v[12:13], v[122:123]
  v_pk_fma_f32 v[14:15], v[122:123], v[122:123], v[14:15]
  v_pk_fma_f32 v[48:49], v[32:33], v[32:33], s[20:21] neg_lo:[1,0,1] neg_hi:[1,0,1]
  v_pk_fma_f32 v[50:51], v[34:35], v[34:35], s[20:21] neg_lo:[1,0,1] neg_hi:[1,0,1]
  v_pk_fma_f32 v[52:53], v[36:37], v[36:37], s[20:21] neg_lo:[1,0,1] neg_hi:[1,0,1]
  v_pk_fma_f32 v[54:55], v[38:39], v[38:39], s[20:21] neg_lo:[1,0,1] neg_hi:[1,0,1]
  v_pk_fma_f32 v[56:57], v[40:41], v[40:41], s[20:21] neg_lo:[1,0,1] neg_hi:[1,0,1]
  v_pk_fma_f32 v[58:59], v[42:43], v[42:43], s[20:21] neg_lo:[1,0,1] neg_hi:[1,0,1]
  v_pk_fma_f32 v[60:61], v[44:45], v[44:45], s[20:21] neg_lo:[1,0,1] neg_hi:[1,0,1]
  v_pk_fma_f32 v[62:63], v[46:47], v[46:47], s[20:21] neg_lo:[1,0,1] neg_hi:[1,0,1]
  v_pk_mul_f32 v[48:49], v[32:33], v[48:49]
  v_pk_mul_f32 v[50:51], v[34:35], v[50:51]
  v_pk_mul_f32 v[52:53], v[36:37], v[52:53]
  v_pk_mul_f32 v[54:55], v[38:39], v[54:55]
  v_pk_mul_f32 v[56:57], v[40:41], v[56:57]
  v_pk_mul_f32 v[58:59], v[42:43], v[58:59]
  v_pk_mul_f32 v[60:61], v[44:45], v[60:61]
  v_pk_mul_f32 v[62:63], v[46:47], v[62:63]
  v_mfma_f32_16x16x32_bf16 v[124:127], v[216:219], v[220:223], 0
  v_cvt_pk_bf16_f32 v184, v16, v17
  v_cvt_pk_bf16_f32 v185, v18, v19
  v_mfma_f32_16x16x32_bf16 v[124:127], v[224:227], v[228:231], v[124:127]
  v_cvt_pk_bf16_f32 v186, v20, v21
  v_cvt_pk_bf16_f32 v187, v22, v23
  v_mfma_f32_16x16x32_bf16 v[124:127], v[232:235], v[236:239], v[124:127]
  ds_read_b128 v[216:219], v3 offset:1600
  ds_read_b128 v[220:223], v4 offset:64
  v_mfma_f32_32x32x16_bf16 v[64:79], v[192:195], v[184:187], v[64:79]
  ds_read_b128 v[224:227], v3 offset:6400
  ds_read_b128 v[228:231], v4 offset:256
  v_cvt_pk_bf16_f32 v188, v24, v25
  v_cvt_pk_bf16_f32 v189, v26, v27
  v_cvt_pk_bf16_f32 v190, v28, v29
  v_cvt_pk_bf16_f32 v191, v30, v31
  v_mfma_f32_32x32x16_bf16 v[80:95], v[196:199], v[184:187], v[80:95]
  ds_read_b128 v[232:235], v3 offset:11200
  ds_read_b128 v[236:239], v4 offset:448
  v_exp_f32 v48, v48
  v_exp_f32 v49, v49
  v_mfma_f32_32x32x16_bf16 v[96:111], v[200:203], v[184:187], v[96:111]
  v_exp_f32 v50, v50
  v_exp_f32 v51, v51
  v_exp_f32_e64 v52, v52
  v_mfma_f32_32x32x16_bf16 v[64:79], v[204:207], v[188:191], v[64:79]
  v_exp_f32 v53, v53
  v_exp_f32 v54, v54
  v_exp_f32_e64 v55, v55
  v_mfma_f32_32x32x16_bf16 v[80:95], v[208:211], v[188:191], v[80:95]
  v_exp_f32 v56, v56
  v_exp_f32 v57, v57
  v_exp_f32_e64 v58, v58
  v_mfma_f32_32x32x16_bf16 v[96:111], v[212:215], v[188:191], v[96:111]
  s_waitcnt lgkmcnt(0)
  v_exp_f32 v59, v59
  v_exp_f32 v60, v60
  v_exp_f32 v61, v61
  v_exp_f32 v62, v62
  v_exp_f32 v63, v63
  v_pk_add_f32 v[12:13], v[12:13], v[124:125]
  v_pk_fma_f32 v[14:15], v[124:125], v[124:125], v[14:15]
  v_pk_add_f32 v[12:13], v[12:13], v[126:127]
  v_pk_fma_f32 v[14:15], v[126:127], v[126:127], v[14:15]
  v_pk_fma_f32 v[48:49], v[48:49], s[22:23], s[22:23]
  v_pk_fma_f32 v[50:51], v[50:51], s[22:23], s[22:23]
  v_pk_fma_f32 v[52:53], v[52:53], s[22:23], s[22:23]
  v_pk_fma_f32 v[54:55], v[54:55], s[22:23], s[22:23]
  v_pk_fma_f32 v[56:57], v[56:57], s[22:23], s[22:23]
  v_pk_fma_f32 v[58:59], v[58:59], s[22:23], s[22:23]
  v_pk_fma_f32 v[60:61], v[60:61], s[22:23], s[22:23]
  v_pk_fma_f32 v[62:63], v[62:63], s[22:23], s[22:23]
  v_mfma_f32_32x32x16_bf16 v[16:31], a[216:219], v[160:163], 0
  ds_read_b128 v[192:195], v0 offset:55296
  ds_read_b128 v[196:199], v0 offset:56320
  v_rcp_f32 v48, v48
  v_rcp_f32 v49, v49
  v_mfma_f32_16x16x32_bf16 v[128:131], v[216:219], v[220:223], 0
  ds_read_b128 v[216:219], v3 offset:2000
  ds_read_b128 v[220:223], v4 offset:80
  v_mfma_f32_32x32x16_bf16 v[16:31], a[220:223], v[164:167], v[16:31]
  ds_read_b128 v[200:203], v0 offset:57344
  ds_read_b128 v[204:207], v0 offset:58368
  v_rcp_f32 v50, v50
  v_rcp_f32 v51, v51
  v_mfma_f32_16x16x32_bf16 v[128:131], v[224:227], v[228:231], v[128:131]
  ds_read_b128 v[224:227], v3 offset:6800
  ds_read_b128 v[228:231], v4 offset:272
  v_mfma_f32_32x32x16_bf16 v[16:31], a[224:227], v[168:171], v[16:31]
  ds_read_b128 v[208:211], v0 offset:59392
  ds_read_b128 v[212:215], v0 offset:60416
  v_rcp_f32 v52, v52
  v_rcp_f32 v53, v53
  v_mfma_f32_16x16x32_bf16 v[128:131], v[232:235], v[236:239], v[128:131]
  ds_read_b128 v[232:235], v3 offset:11600
  ds_read_b128 v[236:239], v4 offset:464
  v_mfma_f32_32x32x16_bf16 v[16:31], a[228:231], v[172:175], v[16:31]
  v_rcp_f32 v54, v54
  v_rcp_f32 v55, v55
  v_rcp_f32_e64 v56, v56
  v_mfma_f32_32x32x16_bf16 v[16:31], a[232:235], v[176:179], v[16:31]
  v_rcp_f32 v57, v57
  v_rcp_f32 v58, v58
  v_rcp_f32_e64 v59, v59
  v_mfma_f32_32x32x16_bf16 v[16:31], a[236:239], v[180:183], v[16:31]
  s_waitcnt lgkmcnt(0)
  v_rcp_f32 v60, v60
  v_rcp_f32 v61, v61
  v_rcp_f32 v62, v62
  v_rcp_f32_e64 v63, v63
  v_pk_mul_f32 v[32:33], v[32:33], v[48:49]
  v_pk_mul_f32 v[34:35], v[34:35], v[50:51]
  v_pk_mul_f32 v[36:37], v[36:37], v[52:53]
  v_pk_mul_f32 v[38:39], v[38:39], v[54:55]
  v_pk_mul_f32 v[40:41], v[40:41], v[56:57]
  v_pk_mul_f32 v[42:43], v[42:43], v[58:59]
  v_pk_mul_f32 v[44:45], v[44:45], v[60:61]
  v_pk_mul_f32 v[46:47], v[46:47], v[62:63]
  v_pk_add_f32 v[12:13], v[12:13], v[128:129]
  v_pk_fma_f32 v[14:15], v[128:129], v[128:129], v[14:15]
  v_pk_add_f32 v[12:13], v[12:13], v[130:131]
  v_pk_fma_f32 v[14:15], v[130:131], v[130:131], v[14:15]
  v_pk_fma_f32 v[48:49], v[16:17], v[16:17], s[20:21] neg_lo:[1,0,1] neg_hi:[1,0,1]
  v_pk_fma_f32 v[50:51], v[18:19], v[18:19], s[20:21] neg_lo:[1,0,1] neg_hi:[1,0,1]
  v_pk_fma_f32 v[52:53], v[20:21], v[20:21], s[20:21] neg_lo:[1,0,1] neg_hi:[1,0,1]
  v_pk_fma_f32 v[54:55], v[22:23], v[22:23], s[20:21] neg_lo:[1,0,1] neg_hi:[1,0,1]
  v_pk_fma_f32 v[56:57], v[24:25], v[24:25], s[20:21] neg_lo:[1,0,1] neg_hi:[1,0,1]
  v_pk_fma_f32 v[58:59], v[26:27], v[26:27], s[20:21] neg_lo:[1,0,1] neg_hi:[1,0,1]
  v_pk_fma_f32 v[60:61], v[28:29], v[28:29], s[20:21] neg_lo:[1,0,1] neg_hi:[1,0,1]
  v_pk_fma_f32 v[62:63], v[30:31], v[30:31], s[20:21] neg_lo:[1,0,1] neg_hi:[1,0,1]
  v_pk_mul_f32 v[48:49], v[16:17], v[48:49]
  v_pk_mul_f32 v[50:51], v[18:19], v[50:51]
  v_pk_mul_f32 v[52:53], v[20:21], v[52:53]
  v_pk_mul_f32 v[54:55], v[22:23], v[54:55]
  v_pk_mul_f32 v[56:57], v[24:25], v[56:57]
  v_pk_mul_f32 v[58:59], v[26:27], v[58:59]
  v_pk_mul_f32 v[60:61], v[28:29], v[60:61]
  v_pk_mul_f32 v[62:63], v[30:31], v[62:63]
  v_mfma_f32_16x16x32_bf16 v[132:135], v[216:219], v[220:223], 0
  v_cvt_pk_bf16_f32 v184, v32, v33
  v_cvt_pk_bf16_f32 v185, v34, v35
  v_mfma_f32_16x16x32_bf16 v[132:135], v[224:227], v[228:231], v[132:135]
  v_cvt_pk_bf16_f32 v186, v36, v37
  v_cvt_pk_bf16_f32 v187, v38, v39
  v_mfma_f32_16x16x32_bf16 v[132:135], v[232:235], v[236:239], v[132:135]
  ds_read_b128 v[216:219], v0 offset:12288
  ds_read_b128 v[220:223], v0 offset:13312
  v_mfma_f32_32x32x16_bf16 v[64:79], v[192:195], v[184:187], v[64:79]
  ds_read_b128 v[224:227], v0 offset:14336
  ds_read_b128 v[228:231], v0 offset:15360
  v_cvt_pk_bf16_f32 v188, v40, v41
  v_cvt_pk_bf16_f32 v189, v42, v43
  v_cvt_pk_bf16_f32 v190, v44, v45
  v_cvt_pk_bf16_f32 v191, v46, v47
  v_mfma_f32_32x32x16_bf16 v[80:95], v[196:199], v[184:187], v[80:95]
  ds_read_b128 v[232:235], v0 offset:16384
  ds_read_b128 v[236:239], v0 offset:17408
  v_exp_f32 v48, v48
  v_exp_f32 v49, v49
  v_mfma_f32_32x32x16_bf16 v[96:111], v[200:203], v[184:187], v[96:111]
  v_exp_f32 v50, v50
  v_exp_f32 v51, v51
  v_exp_f32_e64 v52, v52
  v_mfma_f32_32x32x16_bf16 v[64:79], v[204:207], v[188:191], v[64:79]
  s_mov_b32 s28, s34
  v_exp_f32 v53, v53
  v_exp_f32 v54, v54
  v_exp_f32 v55, v55
  v_mfma_f32_32x32x16_bf16 v[80:95], v[208:211], v[188:191], v[80:95]
  s_add_u32 s34, s34, 0x60000
  v_exp_f32 v56, v56
  v_exp_f32 v57, v57
  v_exp_f32_e64 v58, v58
  v_mfma_f32_32x32x16_bf16 v[96:111], v[212:215], v[188:191], v[96:111]
  s_waitcnt lgkmcnt(0)
  v_exp_f32 v59, v59
  v_exp_f32 v60, v60
  v_exp_f32 v61, v61
  v_exp_f32 v62, v62
  v_exp_f32 v63, v63
  v_pk_add_f32 v[12:13], v[12:13], v[132:133]
  v_pk_fma_f32 v[14:15], v[132:133], v[132:133], v[14:15]
  v_pk_add_f32 v[12:13], v[12:13], v[134:135]
  v_pk_fma_f32 v[14:15], v[134:135], v[134:135], v[14:15]
  v_pk_fma_f32 v[48:49], v[48:49], s[22:23], s[22:23]
  v_pk_fma_f32 v[50:51], v[50:51], s[22:23], s[22:23]
  v_pk_fma_f32 v[52:53], v[52:53], s[22:23], s[22:23]
  v_pk_fma_f32 v[54:55], v[54:55], s[22:23], s[22:23]
  v_pk_fma_f32 v[56:57], v[56:57], s[22:23], s[22:23]
  v_pk_fma_f32 v[58:59], v[58:59], s[22:23], s[22:23]
  v_pk_fma_f32 v[60:61], v[60:61], s[22:23], s[22:23]
  v_pk_fma_f32 v[62:63], v[62:63], s[22:23], s[22:23]
  v_mfma_f32_32x32x16_bf16 v[32:47], v[216:219], v[160:163], 0
  ds_read_b128 v[192:195], v0 offset:61440
  ds_read_b128 v[196:199], v0 offset:62464
  v_rcp_f32 v48, v48
  v_rcp_f32 v49, v49
  v_add_f32_e64 v12, v12, v13
  v_mfma_f32_32x32x16_bf16 v[32:47], v[220:223], v[164:167], v[32:47]
  ds_read_b128 v[200:203], v0 offset:63488
  ds_read_b128 v[204:207], v0 offset:64512
  v_rcp_f32 v50, v50
  v_add_f32 v14, v14, v15
  v_rcp_f32_e64 v51, v51
  v_mfma_f32_32x32x16_bf16 v[32:47], v[224:227], v[168:171], v[32:47]
  ds_read_b128 v[208:211], v1
  ds_read_b128 v[212:215], v1 offset:1024
  v_permlane32_swap_b32 v12, v14
  v_rcp_f32 v52, v52
  v_add_f32 v12, v12, v14
  v_rcp_f32 v53, v53
  v_mfma_f32_32x32x16_bf16 v[32:47], v[228:231], v[172:175], v[32:47]
  v_mov_b32 v14, v12
  v_rcp_f32 v54, v54
  s_nop 0
  v_permlane32_swap_b32 v12, v14
  v_rcp_f32 v55, v55
  v_mul_f32 v12, s24, v12
  v_mfma_f32_32x32x16_bf16 v[32:47], v[232:235], v[176:179], v[32:47]
  v_rcp_f32 v56, v56
  v_rcp_f32 v57, v57
  v_mul_f32 v13, s24, v14
  v_rcp_f32 v58, v58
  v_fma_f32 v13, -v12, v12, v13
  v_mfma_f32_32x32x16_bf16 v[32:47], v[236:239], v[180:183], v[32:47]
  s_waitcnt lgkmcnt(0)
  v_rcp_f32 v59, v59
  v_max_f32 v13, 0, v13
  v_rcp_f32 v60, v60
  v_add_f32 v13, s25, v13
  v_rcp_f32 v61, v61
  v_rsq_f32 v13, v13
  v_rcp_f32 v62, v62
  v_mul_f32 v14, s22, v13
  v_rcp_f32 v63, v63
  v_mul_f32_e64 v12, -v12, v14
  v_pk_mul_f32 v[16:17], v[16:17], v[48:49]
  v_pk_mul_f32 v[18:19], v[18:19], v[50:51]
  v_pk_mul_f32 v[20:21], v[20:21], v[52:53]
  v_pk_mul_f32 v[22:23], v[22:23], v[54:55]
  v_pk_mul_f32 v[24:25], v[24:25], v[56:57]
  v_pk_mul_f32 v[26:27], v[26:27], v[58:59]
  v_pk_mul_f32 v[28:29], v[28:29], v[60:61]
  v_pk_mul_f32 v[30:31], v[30:31], v[62:63]
  v_pk_fma_f32 v[112:113], v[112:113], v[14:15], v[12:13] op_sel_hi:[1,0,0]
  v_pk_fma_f32 v[114:115], v[114:115], v[14:15], v[12:13] op_sel_hi:[1,0,0]
  v_pk_fma_f32 v[116:117], v[116:117], v[14:15], v[12:13] op_sel_hi:[1,0,0]
  v_pk_fma_f32 v[118:119], v[118:119], v[14:15], v[12:13] op_sel_hi:[1,0,0]
  v_pk_fma_f32 v[120:121], v[120:121], v[14:15], v[12:13] op_sel_hi:[1,0,0]
  v_pk_fma_f32 v[122:123], v[122:123], v[14:15], v[12:13] op_sel_hi:[1,0,0]
  v_pk_fma_f32 v[124:125], v[124:125], v[14:15], v[12:13] op_sel_hi:[1,0,0]
  v_pk_fma_f32 v[126:127], v[126:127], v[14:15], v[12:13] op_sel_hi:[1,0,0]
  v_pk_fma_f32 v[128:129], v[128:129], v[14:15], v[12:13] op_sel_hi:[1,0,0]
  v_pk_fma_f32 v[130:131], v[130:131], v[14:15], v[12:13] op_sel_hi:[1,0,0]
  v_pk_fma_f32 v[132:133], v[132:133], v[14:15], v[12:13] op_sel_hi:[1,0,0]
  v_pk_fma_f32 v[134:135], v[134:135], v[14:15], v[12:13] op_sel_hi:[1,0,0]
  v_pk_fma_f32 v[136:137], v[136:137], v[14:15], v[12:13] op_sel_hi:[1,0,0]
  v_pk_fma_f32 v[138:139], v[138:139], v[14:15], v[12:13] op_sel_hi:[1,0,0]
  v_pk_fma_f32 v[140:141], v[140:141], v[14:15], v[12:13] op_sel_hi:[1,0,0]
  v_pk_fma_f32 v[142:143], v[142:143], v[14:15], v[12:13] op_sel_hi:[1,0,0]
  v_pk_fma_f32 v[144:145], v[144:145], v[14:15], v[12:13] op_sel_hi:[1,0,0]
  v_pk_fma_f32 v[146:147], v[146:147], v[14:15], v[12:13] op_sel_hi:[1,0,0]
  v_pk_fma_f32 v[148:149], v[148:149], v[14:15], v[12:13] op_sel_hi:[1,0,0]
  v_pk_fma_f32 v[150:151], v[150:151], v[14:15], v[12:13] op_sel_hi:[1,0,0]
  v_pk_fma_f32 v[152:153], v[152:153], v[14:15], v[12:13] op_sel_hi:[1,0,0]
  v_pk_fma_f32 v[154:155], v[154:155], v[14:15], v[12:13] op_sel_hi:[1,0,0]
  v_pk_fma_f32 v[156:157], v[156:157], v[14:15], v[12:13] op_sel_hi:[1,0,0]
  v_pk_fma_f32 v[158:159], v[158:159], v[14:15], v[12:13] op_sel_hi:[1,0,0]
  v_pk_fma_f32 v[48:49], v[32:33], v[32:33], s[20:21] neg_lo:[1,0,1] neg_hi:[1,0,1]
  v_pk_fma_f32 v[50:51], v[34:35], v[34:35], s[20:21] neg_lo:[1,0,1] neg_hi:[1,0,1]
  v_pk_fma_f32 v[52:53], v[36:37], v[36:37], s[20:21] neg_lo:[1,0,1] neg_hi:[1,0,1]
  v_pk_fma_f32 v[54:55], v[38:39], v[38:39], s[20:21] neg_lo:[1,0,1] neg_hi:[1,0,1]
  v_pk_fma_f32 v[56:57], v[40:41], v[40:41], s[20:21] neg_lo:[1,0,1] neg_hi:[1,0,1]
  v_pk_fma_f32 v[58:59], v[42:43], v[42:43], s[20:21] neg_lo:[1,0,1] neg_hi:[1,0,1]
  v_pk_fma_f32 v[60:61], v[44:45], v[44:45], s[20:21] neg_lo:[1,0,1] neg_hi:[1,0,1]
  v_pk_fma_f32 v[62:63], v[46:47], v[46:47], s[20:21] neg_lo:[1,0,1] neg_hi:[1,0,1]
  v_pk_mul_f32 v[48:49], v[32:33], v[48:49]
  v_pk_mul_f32 v[50:51], v[34:35], v[50:51]
  v_pk_mul_f32 v[52:53], v[36:37], v[52:53]
  v_pk_mul_f32 v[54:55], v[38:39], v[54:55]
  v_pk_mul_f32 v[56:57], v[40:41], v[56:57]
  v_cvt_pk_bf16_f32 v184, v16, v17
  v_cvt_pk_bf16_f32 v185, v18, v19
  v_cvt_pk_bf16_f32 v186, v20, v21
  v_cvt_pk_bf16_f32 v187, v22, v23
  v_pk_mul_f32 v[58:59], v[42:43], v[58:59]
  v_pk_mul_f32 v[60:61], v[44:45], v[60:61]
  v_pk_mul_f32 v[62:63], v[46:47], v[62:63]
  v_mfma_f32_32x32x16_bf16 v[64:79], v[192:195], v[184:187], v[64:79]
  ds_read_b128 v[216:219], v0 offset:18432
  ds_read_b128 v[220:223], v0 offset:19456
  v_cvt_pk_bf16_f32 v188, v24, v25
  v_cvt_pk_bf16_f32 v189, v26, v27
  v_cvt_pk_bf16_f32 v190, v28, v29
  v_cvt_pk_bf16_f32 v191, v30, v31
  v_exp_f32_e64 v48, v48
  v_cndmask_b32 v159, v159, v250, s[12:13]
  v_mfma_f32_32x32x16_bf16 v[80:95], v[196:199], v[184:187], v[80:95]
  ds_read_b128 v[224:227], v0 offset:20480
  ds_read_b128 v[228:231], v0 offset:21504
  v_exp_f32_e64 v49, v49
  v_cvt_pk_bf16_f32 v160, v112, v113
  v_cvt_pk_bf16_f32 v161, v114, v115
  v_exp_f32_e64 v50, v50
  v_cvt_pk_bf16_f32 v162, v116, v117
  v_mfma_f32_32x32x16_bf16 v[96:111], v[200:203], v[184:187], v[96:111]
  ds_read_b128 v[232:235], v0 offset:22528
  ds_read_b128 v[236:239], v0 offset:23552
  v_exp_f32_e64 v51, v51
  v_cvt_pk_bf16_f32 v163, v118, v119
  v_cvt_pk_bf16_f32 v164, v120, v121
  v_exp_f32_e64 v52, v52
  v_cvt_pk_bf16_f32 v165, v122, v123
  v_mfma_f32_32x32x16_bf16 v[64:79], v[204:207], v[188:191], v[64:79]
  v_exp_f32_e64 v53, v53
  v_cvt_pk_bf16_f32 v166, v124, v125
  v_cvt_pk_bf16_f32 v167, v126, v127
  v_exp_f32_e64 v54, v54
  v_cvt_pk_bf16_f32 v168, v128, v129
  v_exp_f32_e64 v55, v55
  v_cvt_pk_bf16_f32 v169, v130, v131
  v_cvt_pk_bf16_f32 v170, v132, v133
  v_mfma_f32_32x32x16_bf16 v[80:95], v[208:211], v[188:191], v[80:95]
  v_exp_f32_e64 v56, v56
  v_cvt_pk_bf16_f32 v171, v134, v135
  v_cvt_pk_bf16_f32 v172, v136, v137
  v_exp_f32_e64 v57, v57
  v_cvt_pk_bf16_f32 v173, v138, v139
  v_exp_f32_e64 v58, v58
  v_cvt_pk_bf16_f32 v174, v140, v141
  v_cvt_pk_bf16_f32 v175, v142, v143
  v_mfma_f32_32x32x16_bf16 v[96:111], v[212:215], v[188:191], v[96:111]
  s_waitcnt lgkmcnt(0)
  v_exp_f32 v59, v59
  v_cvt_pk_bf16_f32 v176, v144, v145
  v_exp_f32_e64 v60, v60
  v_cvt_pk_bf16_f32 v177, v146, v147
  v_cvt_pk_bf16_f32 v178, v148, v149
  v_exp_f32_e64 v61, v61
  v_cvt_pk_bf16_f32 v179, v150, v151
  v_exp_f32_e64 v62, v62
  v_cvt_pk_bf16_f32 v180, v152, v153
  v_cvt_pk_bf16_f32 v181, v154, v155
  v_exp_f32_e64 v63, v63
  v_cvt_pk_bf16_f32 v182, v156, v157
  v_cvt_pk_bf16_f32 v183, v158, v159
  v_pk_fma_f32 v[48:49], v[48:49], s[22:23], s[22:23]
  v_pk_fma_f32 v[50:51], v[50:51], s[22:23], s[22:23]
  v_pk_fma_f32 v[52:53], v[52:53], s[22:23], s[22:23]
  v_pk_fma_f32 v[54:55], v[54:55], s[22:23], s[22:23]
  v_pk_fma_f32 v[56:57], v[56:57], s[22:23], s[22:23]
  v_pk_fma_f32 v[58:59], v[58:59], s[22:23], s[22:23]
  v_pk_fma_f32 v[60:61], v[60:61], s[22:23], s[22:23]
  v_pk_fma_f32 v[62:63], v[62:63], s[22:23], s[22:23]
  s_sub_u32 s26, s26, 1
  s_cmp_lg_u32 s26, 0
  s_waitcnt vmcnt(4)
  s_cbranch_scc1 S_loop
  v_mfma_f32_32x32x16_bf16 v[16:31], v[216:219], v[160:163], 0
  ds_read_b128 v[192:195], v1 offset:2048
  ds_read_b128 v[196:199], v1 offset:3072
  ds_read_b128 v[200:203], v1 offset:4096
  v_rcp_f32 v48, v48
  v_rcp_f32 v49, v49
  v_mfma_f32_32x32x16_bf16 v[16:31], v[220:223], v[164:167], v[16:31]
  ds_read_b128 v[204:207], v1 offset:5120
  ds_read_b128 v[208:211], v1 offset:6144
  ds_read_b128 v[212:215], v1 offset:7168
  v_rcp_f32 v50, v50
  v_rcp_f32 v51, v51
  v_mfma_f32_32x32x16_bf16 v[16:31], v[224:227], v[168:171], v[16:31]
  ds_read_b128 v[136:139], v5
  ds_read_b128 v[140:143], v5 offset:32
  ds_read_b128 v[144:147], v5 offset:64
  v_rcp_f32 v52, v52
  v_rcp_f32 v53, v53
  v_mfma_f32_32x32x16_bf16 v[16:31], v[228:231], v[172:175], v[16:31]
  ds_read_b128 v[148:151], v5 offset:96
  ds_read_b128 v[152:155], v5 offset:128
  ds_read_b128 v[156:159], v5 offset:160
  v_rcp_f32 v54, v54
  v_rcp_f32 v55, v55
  v_mfma_f32_32x32x16_bf16 v[16:31], v[232:235], v[176:179], v[16:31]
  v_rcp_f32 v56, v56
  v_rcp_f32 v57, v57
  v_rcp_f32_e64 v58, v58
  v_mfma_f32_32x32x16_bf16 v[16:31], v[236:239], v[180:183], v[16:31]
  s_waitcnt lgkmcnt(0)
  v_rcp_f32 v59, v59
  v_rcp_f32 v60, v60
  v_rcp_f32 v61, v61
  v_rcp_f32 v62, v62
  v_rcp_f32 v63, v63
  v_pk_mul_f32 v[32:33], v[32:33], v[48:49]
  v_pk_mul_f32 v[34:35], v[34:35], v[50:51]
  v_pk_mul_f32 v[36:37], v[36:37], v[52:53]
  v_pk_mul_f32 v[38:39], v[38:39], v[54:55]
  v_pk_mul_f32 v[40:41], v[40:41], v[56:57]
  v_pk_mul_f32 v[42:43], v[42:43], v[58:59]
  v_pk_mul_f32 v[44:45], v[44:45], v[60:61]
  v_pk_mul_f32 v[46:47], v[46:47], v[62:63]
  v_pk_fma_f32 v[48:49], v[16:17], v[16:17], s[20:21] neg_lo:[1,0,1] neg_hi:[1,0,1]
  v_pk_fma_f32 v[50:51], v[18:19], v[18:19], s[20:21] neg_lo:[1,0,1] neg_hi:[1,0,1]
  v_pk_fma_f32 v[52:53], v[20:21], v[20:21], s[20:21] neg_lo:[1,0,1] neg_hi:[1,0,1]
  v_pk_fma_f32 v[54:55], v[22:23], v[22:23], s[20:21] neg_lo:[1,0,1] neg_hi:[1,0,1]
  v_pk_fma_f32 v[56:57], v[24:25], v[24:25], s[20:21] neg_lo:[1,0,1] neg_hi:[1,0,1]
  v_pk_fma_f32 v[58:59], v[26:27], v[26:27], s[20:21] neg_lo:[1,0,1] neg_hi:[1,0,1]
  v_pk_fma_f32 v[60:61], v[28:29], v[28:29], s[20:21] neg_lo:[1,0,1] neg_hi:[1,0,1]
  v_pk_fma_f32 v[62:63], v[30:31], v[30:31], s[20:21] neg_lo:[1,0,1] neg_hi:[1,0,1]
  v_pk_mul_f32 v[48:49], v[16:17], v[48:49]
  v_pk_mul_f32 v[50:51], v[18:19], v[50:51]
  v_pk_mul_f32 v[52:53], v[20:21], v[52:53]
  v_pk_mul_f32 v[54:55], v[22:23], v[54:55]
  v_pk_mul_f32 v[56:57], v[24:25], v[56:57]
  v_cvt_pk_bf16_f32 v184, v32, v33
  v_cvt_pk_bf16_f32 v185, v34, v35
  v_cvt_pk_bf16_f32 v186, v36, v37
  v_cvt_pk_bf16_f32 v187, v38, v39
  v_pk_mul_f32 v[58:59], v[26:27], v[58:59]
  v_pk_mul_f32 v[60:61], v[28:29], v[60:61]
  v_pk_mul_f32 v[62:63], v[30:31], v[62:63]
  v_mfma_f32_32x32x16_bf16 v[64:79], v[192:195], v[184:187], v[64:79]
  v_cvt_pk_bf16_f32 v188, v40, v41
  v_cvt_pk_bf16_f32 v189, v42, v43
  v_cvt_pk_bf16_f32 v190, v44, v45
  v_cvt_pk_bf16_f32 v191, v46, v47
  v_exp_f32_e64 v48, v48
  v_mfma_f32_32x32x16_bf16 v[80:95], v[196:199], v[184:187], v[80:95]
  v_exp_f32 v49, v49
  v_exp_f32 v50, v50
  v_exp_f32_e64 v51, v51
  v_mfma_f32_32x32x16_bf16 v[96:111], v[200:203], v[184:187], v[96:111]
  v_exp_f32 v52, v52
  v_exp_f32 v53, v53
  v_exp_f32_e64 v54, v54
  v_mfma_f32_32x32x16_bf16 v[64:79], v[204:207], v[188:191], v[64:79]
  v_exp_f32 v55, v55
  v_exp_f32 v56, v56
  v_exp_f32_e64 v57, v57
  v_mfma_f32_32x32x16_bf16 v[80:95], v[208:211], v[188:191], v[80:95]
  v_exp_f32_e64 v58, v58
  v_exp_f32_e64 v59, v59
  v_exp_f32_e64 v60, v60
  v_mfma_f32_32x32x16_bf16 v[96:111], v[212:215], v[188:191], v[96:111]
  v_exp_f32_e64 v61, v61
  v_exp_f32_e64 v62, v62
  v_exp_f32_e64 v63, v63
  v_pk_fma_f32 v[48:49], v[48:49], s[22:23], s[22:23]
  v_pk_fma_f32 v[50:51], v[50:51], s[22:23], s[22:23]
  v_pk_fma_f32 v[52:53], v[52:53], s[22:23], s[22:23]
  v_pk_fma_f32 v[54:55], v[54:55], s[22:23], s[22:23]
  v_pk_fma_f32 v[56:57], v[56:57], s[22:23], s[22:23]
  v_pk_fma_f32 v[58:59], v[58:59], s[22:23], s[22:23]
  v_pk_fma_f32 v[60:61], v[60:61], s[22:23], s[22:23]
  v_pk_fma_f32 v[62:63], v[62:63], s[22:23], s[22:23]
  v_mfma_f32_32x32x16_bf16 v[32:47], a[0:3], v[160:163], 0
  v_cvt_pk_bf16_f32 v112, v64, v65
  v_cvt_pk_bf16_f32 v113, v66, v67
  v_cvt_pk_bf16_f32 v114, v68, v69
  v_cvt_pk_bf16_f32 v115, v70, v71
  v_cvt_pk_bf16_f32 v116, v72, v73
  v_cvt_pk_bf16_f32 v117, v74, v75
  v_mfma_f32_32x32x16_bf16 v[32:47], a[4:7], v[164:167], v[32:47]
  v_cvt_pk_bf16_f32 v118, v76, v77
  v_cvt_pk_bf16_f32 v119, v78, v79
  v_cvt_pk_bf16_f32 v120, v80, v81
  v_cvt_pk_bf16_f32 v121, v82, v83
  v_cvt_pk_bf16_f32 v122, v84, v85
  v_cvt_pk_bf16_f32 v123, v86, v87
  v_mfma_f32_32x32x16_bf16 v[32:47], a[8:11], v[168:171], v[32:47]
  ds_read_b128 v[64:67], v2
  ds_read_b128 v[68:71], v2 offset:32
  ds_read_b128 v[72:75], v2 offset:64
  ds_read_b128 v[76:79], v2 offset:96
  v_cvt_pk_bf16_f32 v124, v88, v89
  v_cvt_pk_bf16_f32 v125, v90, v91
  v_mfma_f32_32x32x16_bf16 v[32:47], a[12:15], v[172:175], v[32:47]
  ds_read_b128 v[192:195], v1 offset:8192
  ds_read_b128 v[196:199], v1 offset:9216
  v_cvt_pk_bf16_f32 v126, v92, v93
  v_cvt_pk_bf16_f32 v127, v94, v95
  v_cvt_pk_bf16_f32 v128, v96, v97
  v_cvt_pk_bf16_f32 v129, v98, v99
  v_mfma_f32_32x32x16_bf16 v[32:47], a[16:19], v[176:179], v[32:47]
  ds_read_b128 v[80:83], v2 offset:128
  ds_read_b128 v[84:87], v2 offset:160
  ds_read_b128 v[88:91], v2 offset:192
  ds_read_b128 v[92:95], v2 offset:224
  v_cvt_pk_bf16_f32 v130, v100, v101
  v_cvt_pk_bf16_f32 v131, v102, v103
  v_mfma_f32_32x32x16_bf16 v[32:47], a[20:23], v[180:183], v[32:47]
  s_waitcnt lgkmcnt(6)
  ds_read_b128 v[200:203], v1 offset:10240
  ds_read_b128 v[204:207], v1 offset:11264
  v_cvt_pk_bf16_f32 v132, v104, v105
  v_cvt_pk_bf16_f32 v133, v106, v107
  v_cvt_pk_bf16_f32 v134, v108, v109
  v_cvt_pk_bf16_f32 v135, v110, v111
  v_mfma_f32_32x32x16_bf16 v[64:79], v[240:243], v[136:139], v[64:79]
  s_nop 0
  ds_read_b128 v[96:99], v2 offset:256
  ds_read_b128 v[100:103], v2 offset:288
  ds_read_b128 v[104:107], v2 offset:320
  ds_read_b128 v[108:111], v2 offset:352
  v_rcp_f32 v48, v48
  v_mfma_f32_32x32x16_bf16 v[64:79], v[244:247], v[140:143], v[64:79]
  s_waitcnt lgkmcnt(6)
  ds_read_b128 v[208:211], v1 offset:12288
  ds_read_b128 v[212:215], v1 offset:13312
  v_rcp_f32 v49, v49
  v_rcp_f32 v50, v50
  v_mfma_f32_32x32x16_bf16 v[80:95], v[240:243], v[144:147], v[80:95]
  v_rcp_f32 v51, v51
  v_rcp_f32 v52, v52
  v_rcp_f32_e64 v53, v53
  v_mfma_f32_32x32x16_bf16 v[80:95], v[244:247], v[148:151], v[80:95]
  s_waitcnt lgkmcnt(2)
  v_rcp_f32 v54, v54
  v_rcp_f32 v55, v55
  v_rcp_f32 v56, v56
  v_mfma_f32_32x32x16_bf16 v[96:111], v[240:243], v[152:155], v[96:111]
  v_rcp_f32 v57, v57
  v_rcp_f32 v58, v58
  v_rcp_f32_e64 v59, v59
  v_mfma_f32_32x32x16_bf16 v[96:111], v[244:247], v[156:159], v[96:111]
  s_waitcnt lgkmcnt(0)
  v_rcp_f32 v60, v60
  v_rcp_f32 v61, v61
  v_rcp_f32 v62, v62
  v_rcp_f32_e64 v63, v63
  v_pk_mul_f32 v[16:17], v[16:17], v[48:49]
  v_pk_mul_f32 v[18:19], v[18:19], v[50:51]
  v_pk_mul_f32 v[20:21], v[20:21], v[52:53]
  v_pk_mul_f32 v[22:23], v[22:23], v[54:55]
  v_pk_mul_f32 v[24:25], v[24:25], v[56:57]
  v_pk_mul_f32 v[26:27], v[26:27], v[58:59]
  v_pk_mul_f32 v[28:29], v[28:29], v[60:61]
  v_pk_mul_f32 v[30:31], v[30:31], v[62:63]
  v_pk_fma_f32 v[48:49], v[32:33], v[32:33], s[20:21] neg_lo:[1,0,1] neg_hi:[1,0,1]
  v_pk_fma_f32 v[50:51], v[34:35], v[34:35], s[20:21] neg_lo:[1,0,1] neg_hi:[1,0,1]
  v_pk_fma_f32 v[52:53], v[36:37], v[36:37], s[20:21] neg_lo:[1,0,1] neg_hi:[1,0,1]
  v_pk_fma_f32 v[54:55], v[38:39], v[38:39], s[20:21] neg_lo:[1,0,1] neg_hi:[1,0,1]
  v_pk_fma_f32 v[56:57], v[40:41], v[40:41], s[20:21] neg_lo:[1,0,1] neg_hi:[1,0,1]
  v_pk_fma_f32 v[58:59], v[42:43], v[42:43], s[20:21] neg_lo:[1,0,1] neg_hi:[1,0,1]
  v_pk_fma_f32 v[60:61], v[44:45], v[44:45], s[20:21] neg_lo:[1,0,1] neg_hi:[1,0,1]
  v_pk_fma_f32 v[62:63], v[46:47], v[46:47], s[20:21] neg_lo:[1,0,1] neg_hi:[1,0,1]
  v_pk_mul_f32 v[48:49], v[32:33], v[48:49]
  v_pk_mul_f32 v[50:51], v[34:35], v[50:51]
  v_pk_mul_f32 v[52:53], v[36:37], v[52:53]
  v_pk_mul_f32 v[54:55], v[38:39], v[54:55]
  v_pk_mul_f32 v[56:57], v[40:41], v[56:57]
  v_cvt_pk_bf16_f32 v184, v16, v17
  v_cvt_pk_bf16_f32 v185, v18, v19
  v_cvt_pk_bf16_f32 v186, v20, v21
  v_cvt_pk_bf16_f32 v187, v22, v23
  v_pk_mul_f32 v[58:59], v[42:43], v[58:59]
  v_pk_mul_f32 v[60:61], v[44:45], v[60:61]
  v_pk_mul_f32 v[62:63], v[46:47], v[62:63]
  v_mfma_f32_32x32x16_bf16 v[64:79], v[192:195], v[184:187], v[64:79]
  v_cvt_pk_bf16_f32 v188, v24, v25
  v_cvt_pk_bf16_f32 v189, v26, v27
  v_cvt_pk_bf16_f32 v190, v28, v29
  v_cvt_pk_bf16_f32 v191, v30, v31
  v_exp_f32_e64 v48, v48
  v_mfma_f32_32x32x16_bf16 v[80:95], v[196:199], v[184:187], v[80:95]
  v_exp_f32 v49, v49
  v_exp_f32 v50, v50
  v_exp_f32_e64 v51, v51
  v_mfma_f32_32x32x16_bf16 v[96:111], v[200:203], v[184:187], v[96:111]
  v_exp_f32 v52, v52
  v_exp_f32 v53, v53
  v_exp_f32_e64 v54, v54
  v_mfma_f32_32x32x16_bf16 v[64:79], v[204:207], v[188:191], v[64:79]
  v_exp_f32 v55, v55
  v_exp_f32 v56, v56
  v_exp_f32_e64 v57, v57
  v_mfma_f32_32x32x16_bf16 v[80:95], v[208:211], v[188:191], v[80:95]
  v_exp_f32 v58, v58
  v_exp_f32 v59, v59
  v_exp_f32_e64 v60, v60
  v_mfma_f32_32x32x16_bf16 v[96:111], v[212:215], v[188:191], v[96:111]
  v_exp_f32 v61, v61
  v_exp_f32 v62, v62
  v_exp_f32_e64 v63, v63
  v_pk_fma_f32 v[48:49], v[48:49], s[22:23], s[22:23]
  v_pk_fma_f32 v[50:51], v[50:51], s[22:23], s[22:23]
  v_pk_fma_f32 v[52:53], v[52:53], s[22:23], s[22:23]
  v_pk_fma_f32 v[54:55], v[54:55], s[22:23], s[22:23]
  v_pk_fma_f32 v[56:57], v[56:57], s[22:23], s[22:23]
  v_pk_fma_f32 v[58:59], v[58:59], s[22:23], s[22:23]
  v_pk_fma_f32 v[60:61], v[60:61], s[22:23], s[22:23]
  v_pk_fma_f32 v[62:63], v[62:63], s[22:23], s[22:23]
  v_mfma_f32_32x32x16_bf16 v[16:31], a[24:27], v[160:163], 0
  ds_read_b128 v[192:195], v1 offset:14336
  ds_read_b128 v[196:199], v1 offset:15360
  v_rcp_f32 v48, v48
  v_rcp_f32 v49, v49
  v_mfma_f32_32x32x16_bf16 v[16:31], a[28:31], v[164:167], v[16:31]
  ds_read_b128 v[200:203], v1 offset:16384
  ds_read_b128 v[204:207], v1 offset:17408
  v_rcp_f32 v50, v50
  v_rcp_f32 v51, v51
  v_mfma_f32_32x32x16_bf16 v[16:31], a[32:35], v[168:171], v[16:31]
  ds_read_b128 v[208:211], v1 offset:18432
  ds_read_b128 v[212:215], v1 offset:19456
  v_rcp_f32 v52, v52
  v_rcp_f32 v53, v53
  v_mfma_f32_32x32x16_bf16 v[16:31], a[36:39], v[172:175], v[16:31]
  buffer_store_dwordx4 v[112:115], v10, s[8:11], s28 offen
  v_rcp_f32 v54, v54
  v_rcp_f32 v55, v55
  v_mfma_f32_32x32x16_bf16 v[16:31], a[40:43], v[176:179], v[16:31]
  v_rcp_f32 v56, v56
  v_rcp_f32 v57, v57
  v_rcp_f32_e64 v58, v58
  v_mfma_f32_32x32x16_bf16 v[16:31], a[44:47], v[180:183], v[16:31]
  s_waitcnt lgkmcnt(0)
  v_rcp_f32 v59, v59
  v_rcp_f32 v60, v60
  v_rcp_f32 v61, v61
  v_rcp_f32 v62, v62
  v_rcp_f32 v63, v63
  v_pk_mul_f32 v[32:33], v[32:33], v[48:49]
  v_pk_mul_f32 v[34:35], v[34:35], v[50:51]
  v_pk_mul_f32 v[36:37], v[36:37], v[52:53]
  v_pk_mul_f32 v[38:39], v[38:39], v[54:55]
  v_pk_mul_f32 v[40:41], v[40:41], v[56:57]
  v_pk_mul_f32 v[42:43], v[42:43], v[58:59]
  v_pk_mul_f32 v[44:45], v[44:45], v[60:61]
  v_pk_mul_f32 v[46:47], v[46:47], v[62:63]
  v_pk_fma_f32 v[48:49], v[16:17], v[16:17], s[20:21] neg_lo:[1,0,1] neg_hi:[1,0,1]
  v_pk_fma_f32 v[50:51], v[18:19], v[18:19], s[20:21] neg_lo:[1,0,1] neg_hi:[1,0,1]
  v_pk_fma_f32 v[52:53], v[20:21], v[20:21], s[20:21] neg_lo:[1,0,1] neg_hi:[1,0,1]
  v_pk_fma_f32 v[54:55], v[22:23], v[22:23], s[20:21] neg_lo:[1,0,1] neg_hi:[1,0,1]
  v_pk_fma_f32 v[56:57], v[24:25], v[24:25], s[20:21] neg_lo:[1,0,1] neg_hi:[1,0,1]
  v_pk_fma_f32 v[58:59], v[26:27], v[26:27], s[20:21] neg_lo:[1,0,1] neg_hi:[1,0,1]
  v_pk_fma_f32 v[60:61], v[28:29], v[28:29], s[20:21] neg_lo:[1,0,1] neg_hi:[1,0,1]
  v_pk_fma_f32 v[62:63], v[30:31], v[30:31], s[20:21] neg_lo:[1,0,1] neg_hi:[1,0,1]
  v_pk_mul_f32 v[48:49], v[16:17], v[48:49]
  v_pk_mul_f32 v[50:51], v[18:19], v[50:51]
  v_pk_mul_f32 v[52:53], v[20:21], v[52:53]
  v_pk_mul_f32 v[54:55], v[22:23], v[54:55]
  v_pk_mul_f32 v[56:57], v[24:25], v[56:57]
  v_cvt_pk_bf16_f32 v184, v32, v33
  v_cvt_pk_bf16_f32 v185, v34, v35
  v_cvt_pk_bf16_f32 v186, v36, v37
  v_cvt_pk_bf16_f32 v187, v38, v39
  v_pk_mul_f32 v[58:59], v[26:27], v[58:59]
  v_pk_mul_f32 v[60:61], v[28:29], v[60:61]
  v_pk_mul_f32 v[62:63], v[30:31], v[62:63]
  v_mfma_f32_32x32x16_bf16 v[64:79], v[192:195], v[184:187], v[64:79]
  v_cvt_pk_bf16_f32 v188, v40, v41
  v_cvt_pk_bf16_f32 v189, v42, v43
  v_cvt_pk_bf16_f32 v190, v44, v45
  v_cvt_pk_bf16_f32 v191, v46, v47
  v_exp_f32_e64 v48, v48
  v_mfma_f32_32x32x16_bf16 v[80:95], v[196:199], v[184:187], v[80:95]
  v_exp_f32 v49, v49
  v_exp_f32 v50, v50
  v_exp_f32_e64 v51, v51
  v_mfma_f32_32x32x16_bf16 v[96:111], v[200:203], v[184:187], v[96:111]
  v_exp_f32 v52, v52
  v_exp_f32 v53, v53
  v_exp_f32_e64 v54, v54
  v_mfma_f32_32x32x16_bf16 v[64:79], v[204:207], v[188:191], v[64:79]
  v_exp_f32 v55, v55
  v_exp_f32 v56, v56
  v_exp_f32_e64 v57, v57
  v_mfma_f32_32x32x16_bf16 v[80:95], v[208:211], v[188:191], v[80:95]
  v_exp_f32 v58, v58
  v_exp_f32 v59, v59
  v_exp_f32_e64 v60, v60
  v_mfma_f32_32x32x16_bf16 v[96:111], v[212:215], v[188:191], v[96:111]
  v_exp_f32 v61, v61
  v_exp_f32 v62, v62
  v_exp_f32_e64 v63, v63
  v_pk_fma_f32 v[48:49], v[48:49], s[22:23], s[22:23]
  v_pk_fma_f32 v[50:51], v[50:51], s[22:23], s[22:23]
  v_pk_fma_f32 v[52:53], v[52:53], s[22:23], s[22:23]
  v_pk_fma_f32 v[54:55], v[54:55], s[22:23], s[22:23]
  v_pk_fma_f32 v[56:57], v[56:57], s[22:23], s[22:23]
  v_pk_fma_f32 v[58:59], v[58:59], s[22:23], s[22:23]
  v_pk_fma_f32 v[60:61], v[60:61], s[22:23], s[22:23]
  v_pk_fma_f32 v[62:63], v[62:63], s[22:23], s[22:23]
  v_mfma_f32_32x32x16_bf16 v[32:47], a[48:51], v[160:163], 0
  ds_read_b128 v[192:195], v1 offset:20480
  ds_read_b128 v[196:199], v1 offset:21504
  v_rcp_f32 v48, v48
  v_rcp_f32 v49, v49
  v_mfma_f32_32x32x16_bf16 v[32:47], a[52:55], v[164:167], v[32:47]
  ds_read_b128 v[200:203], v1 offset:22528
  ds_read_b128 v[204:207], v1 offset:23552
  v_rcp_f32 v50, v50
  v_rcp_f32 v51, v51
  v_mfma_f32_32x32x16_bf16 v[32:47], a[56:59], v[168:171], v[32:47]
  ds_read_b128 v[208:211], v1 offset:24576
  ds_read_b128 v[212:215], v1 offset:25600
  v_rcp_f32 v52, v52
  v_rcp_f32 v53, v53
  v_mfma_f32_32x32x16_bf16 v[32:47], a[60:63], v[172:175], v[32:47]
  buffer_store_dwordx4 v[116:119], v10, s[8:11], s28 offen offset:32
  v_rcp_f32 v54, v54
  v_rcp_f32 v55, v55
  v_mfma_f32_32x32x16_bf16 v[32:47], a[64:67], v[176:179], v[32:47]
  v_rcp_f32 v56, v56
  v_rcp_f32 v57, v57
  v_rcp_f32_e64 v58, v58
  v_mfma_f32_32x32x16_bf16 v[32:47], a[68:71], v[180:183], v[32:47]
  s_waitcnt lgkmcnt(0)
  v_rcp_f32 v59, v59
  v_rcp_f32 v60, v60
  v_rcp_f32 v61, v61
  v_rcp_f32 v62, v62
  v_rcp_f32 v63, v63
  v_pk_mul_f32 v[16:17], v[16:17], v[48:49]
  v_pk_mul_f32 v[18:19], v[18:19], v[50:51]
  v_pk_mul_f32 v[20:21], v[20:21], v[52:53]
  v_pk_mul_f32 v[22:23], v[22:23], v[54:55]
  v_pk_mul_f32 v[24:25], v[24:25], v[56:57]
  v_pk_mul_f32 v[26:27], v[26:27], v[58:59]
  v_pk_mul_f32 v[28:29], v[28:29], v[60:61]
  v_pk_mul_f32 v[30:31], v[30:31], v[62:63]
  v_pk_fma_f32 v[48:49], v[32:33], v[32:33], s[20:21] neg_lo:[1,0,1] neg_hi:[1,0,1]
  v_pk_fma_f32 v[50:51], v[34:35], v[34:35], s[20:21] neg_lo:[1,0,1] neg_hi:[1,0,1]
  v_pk_fma_f32 v[52:53], v[36:37], v[36:37], s[20:21] neg_lo:[1,0,1] neg_hi:[1,0,1]
  v_pk_fma_f32 v[54:55], v[38:39], v[38:39], s[20:21] neg_lo:[1,0,1] neg_hi:[1,0,1]
  v_pk_fma_f32 v[56:57], v[40:41], v[40:41], s[20:21] neg_lo:[1,0,1] neg_hi:[1,0,1]
  v_pk_fma_f32 v[58:59], v[42:43], v[42:43], s[20:21] neg_lo:[1,0,1] neg_hi:[1,0,1]
  v_pk_fma_f32 v[60:61], v[44:45], v[44:45], s[20:21] neg_lo:[1,0,1] neg_hi:[1,0,1]
  v_pk_fma_f32 v[62:63], v[46:47], v[46:47], s[20:21] neg_lo:[1,0,1] neg_hi:[1,0,1]
  v_pk_mul_f32 v[48:49], v[32:33], v[48:49]
  v_pk_mul_f32 v[50:51], v[34:35], v[50:51]
  v_pk_mul_f32 v[52:53], v[36:37], v[52:53]
  v_pk_mul_f32 v[54:55], v[38:39], v[54:55]
  v_pk_mul_f32 v[56:57], v[40:41], v[56:57]
  v_cvt_pk_bf16_f32 v184, v16, v17
  v_cvt_pk_bf16_f32 v185, v18, v19
  v_cvt_pk_bf16_f32 v186, v20, v21
  v_cvt_pk_bf16_f32 v187, v22, v23
  v_pk_mul_f32 v[58:59], v[42:43], v[58:59]
  v_pk_mul_f32 v[60:61], v[44:45], v[60:61]
  v_pk_mul_f32 v[62:63], v[46:47], v[62:63]
  v_mfma_f32_32x32x16_bf16 v[64:79], v[192:195], v[184:187], v[64:79]
  v_cvt_pk_bf16_f32 v188, v24, v25
  v_cvt_pk_bf16_f32 v189, v26, v27
  v_cvt_pk_bf16_f32 v190, v28, v29
  v_cvt_pk_bf16_f32 v191, v30, v31
  v_exp_f32_e64 v48, v48
  v_mfma_f32_32x32x16_bf16 v[80:95], v[196:199], v[184:187], v[80:95]
  v_exp_f32 v49, v49
  v_exp_f32 v50, v50
  v_exp_f32_e64 v51, v51
  v_mfma_f32_32x32x16_bf16 v[96:111], v[200:203], v[184:187], v[96:111]
  v_exp_f32 v52, v52
  v_exp_f32 v53, v53
  v_exp_f32_e64 v54, v54
  v_mfma_f32_32x32x16_bf16 v[64:79], v[204:207], v[188:191], v[64:79]
  v_exp_f32 v55, v55
  v_exp_f32 v56, v56
  v_exp_f32_e64 v57, v57
  v_mfma_f32_32x32x16_bf16 v[80:95], v[208:211], v[188:191], v[80:95]
  v_exp_f32 v58, v58
  v_exp_f32 v59, v59
  v_exp_f32_e64 v60, v60
  v_mfma_f32_32x32x16_bf16 v[96:111], v[212:215], v[188:191], v[96:111]
  v_exp_f32 v61, v61
  v_exp_f32 v62, v62
  v_exp_f32_e64 v63, v63
  v_pk_fma_f32 v[48:49], v[48:49], s[22:23], s[22:23]
  v_pk_fma_f32 v[50:51], v[50:51], s[22:23], s[22:23]
  v_pk_fma_f32 v[52:53], v[52:53], s[22:23], s[22:23]
  v_pk_fma_f32 v[54:55], v[54:55], s[22:23], s[22:23]
  v_pk_fma_f32 v[56:57], v[56:57], s[22:23], s[22:23]
  v_pk_fma_f32 v[58:59], v[58:59], s[22:23], s[22:23]
  v_pk_fma_f32 v[60:61], v[60:61], s[22:23], s[22:23]
  v_pk_fma_f32 v[62:63], v[62:63], s[22:23], s[22:23]
  v_mfma_f32_32x32x16_bf16 v[16:31], a[72:75], v[160:163], 0
  ds_read_b128 v[192:195], v1 offset:26624
  ds_read_b128 v[196:199], v1 offset:27648
  v_rcp_f32 v48, v48
  v_rcp_f32 v49, v49
  v_mfma_f32_32x32x16_bf16 v[16:31], a[76:79], v[164:167], v[16:31]
  ds_read_b128 v[200:203], v1 offset:28672
  ds_read_b128 v[204:207], v1 offset:29696
  v_rcp_f32 v50, v50
  v_rcp_f32 v51, v51
  v_mfma_f32_32x32x16_bf16 v[16:31], a[80:83], v[168:171], v[16:31]
  ds_read_b128 v[208:211], v1 offset:30720
  ds_read_b128 v[212:215], v1 offset:31744
  v_rcp_f32 v52, v52
  v_rcp_f32 v53, v53
  v_mfma_f32_32x32x16_bf16 v[16:31], a[84:87], v[172:175], v[16:31]
  v_rcp_f32 v54, v54
  v_rcp_f32 v55, v55
  v_rcp_f32_e64 v56, v56
  v_mfma_f32_32x32x16_bf16 v[16:31], a[88:91], v[176:179], v[16:31]
  v_rcp_f32 v57, v57
  v_rcp_f32 v58, v58
  v_rcp_f32_e64 v59, v59
  v_mfma_f32_32x32x16_bf16 v[16:31], a[92:95], v[180:183], v[16:31]
  s_waitcnt lgkmcnt(0)
  v_rcp_f32 v60, v60
  v_rcp_f32 v61, v61
  v_rcp_f32 v62, v62
  v_rcp_f32_e64 v63, v63
  v_pk_mul_f32 v[32:33], v[32:33], v[48:49]
  v_pk_mul_f32 v[34:35], v[34:35], v[50:51]
  v_pk_mul_f32 v[36:37], v[36:37], v[52:53]
  v_pk_mul_f32 v[38:39], v[38:39], v[54:55]
  v_pk_mul_f32 v[40:41], v[40:41], v[56:57]
  v_pk_mul_f32 v[42:43], v[42:43], v[58:59]
  v_pk_mul_f32 v[44:45], v[44:45], v[60:61]
  v_pk_mul_f32 v[46:47], v[46:47], v[62:63]
  v_pk_fma_f32 v[48:49], v[16:17], v[16:17], s[20:21] neg_lo:[1,0,1] neg_hi:[1,0,1]
  v_pk_fma_f32 v[50:51], v[18:19], v[18:19], s[20:21] neg_lo:[1,0,1] neg_hi:[1,0,1]
  v_pk_fma_f32 v[52:53], v[20:21], v[20:21], s[20:21] neg_lo:[1,0,1] neg_hi:[1,0,1]
  v_pk_fma_f32 v[54:55], v[22:23], v[22:23], s[20:21] neg_lo:[1,0,1] neg_hi:[1,0,1]
  v_pk_fma_f32 v[56:57], v[24:25], v[24:25], s[20:21] neg_lo:[1,0,1] neg_hi:[1,0,1]
  v_pk_fma_f32 v[58:59], v[26:27], v[26:27], s[20:21] neg_lo:[1,0,1] neg_hi:[1,0,1]
  v_pk_fma_f32 v[60:61], v[28:29], v[28:29], s[20:21] neg_lo:[1,0,1] neg_hi:[1,0,1]
  v_pk_fma_f32 v[62:63], v[30:31], v[30:31], s[20:21] neg_lo:[1,0,1] neg_hi:[1,0,1]
  v_pk_mul_f32 v[48:49], v[16:17], v[48:49]
  v_pk_mul_f32 v[50:51], v[18:19], v[50:51]
  v_pk_mul_f32 v[52:53], v[20:21], v[52:53]
  v_pk_mul_f32 v[54:55], v[22:23], v[54:55]
  v_pk_mul_f32 v[56:57], v[24:25], v[56:57]
  v_cvt_pk_bf16_f32 v184, v32, v33
  v_cvt_pk_bf16_f32 v185, v34, v35
  v_cvt_pk_bf16_f32 v186, v36, v37
  v_cvt_pk_bf16_f32 v187, v38, v39
  v_pk_mul_f32 v[58:59], v[26:27], v[58:59]
  v_pk_mul_f32 v[60:61], v[28:29], v[60:61]
  v_pk_mul_f32 v[62:63], v[30:31], v[62:63]
  v_mfma_f32_32x32x16_bf16 v[64:79], v[192:195], v[184:187], v[64:79]
  v_cvt_pk_bf16_f32 v188, v40, v41
  v_cvt_pk_bf16_f32 v189, v42, v43
  v_cvt_pk_bf16_f32 v190, v44, v45
  v_cvt_pk_bf16_f32 v191, v46, v47
  v_exp_f32_e64 v48, v48
  v_mfma_f32_32x32x16_bf16 v[80:95], v[196:199], v[184:187], v[80:95]
  v_exp_f32 v49, v49
  v_exp_f32 v50, v50
  v_exp_f32_e64 v51, v51
  v_mfma_f32_32x32x16_bf16 v[96:111], v[200:203], v[184:187], v[96:111]
  v_exp_f32 v52, v52
  v_exp_f32 v53, v53
  v_exp_f32_e64 v54, v54
  v_mfma_f32_32x32x16_bf16 v[64:79], v[204:207], v[188:191], v[64:79]
  v_exp_f32 v55, v55
  v_exp_f32 v56, v56
  v_exp_f32_e64 v57, v57
  v_mfma_f32_32x32x16_bf16 v[80:95], v[208:211], v[188:191], v[80:95]
  v_exp_f32 v58, v58
  v_exp_f32 v59, v59
  v_exp_f32_e64 v60, v60
  v_mfma_f32_32x32x16_bf16 v[96:111], v[212:215], v[188:191], v[96:111]
  v_exp_f32 v61, v61
  v_exp_f32 v62, v62
  v_exp_f32_e64 v63, v63
  v_pk_fma_f32 v[48:49], v[48:49], s[22:23], s[22:23]
  v_pk_fma_f32 v[50:51], v[50:51], s[22:23], s[22:23]
  v_pk_fma_f32 v[52:53], v[52:53], s[22:23], s[22:23]
  v_pk_fma_f32 v[54:55], v[54:55], s[22:23], s[22:23]
  v_pk_fma_f32 v[56:57], v[56:57], s[22:23], s[22:23]
  v_pk_fma_f32 v[58:59], v[58:59], s[22:23], s[22:23]
  v_pk_fma_f32 v[60:61], v[60:61], s[22:23], s[22:23]
  v_pk_fma_f32 v[62:63], v[62:63], s[22:23], s[22:23]
  v_mfma_f32_32x32x16_bf16 v[32:47], a[96:99], v[160:163], 0
  ds_read_b128 v[192:195], v0 offset:24576
  ds_read_b128 v[196:199], v0 offset:25600
  v_rcp_f32 v48, v48
  v_rcp_f32 v49, v49
  v_mfma_f32_32x32x16_bf16 v[32:47], a[100:103], v[164:167], v[32:47]
  ds_read_b128 v[200:203], v0 offset:26624
  ds_read_b128 v[204:207], v0 offset:27648
  v_rcp_f32 v50, v50
  v_rcp_f32 v51, v51
  v_mfma_f32_32x32x16_bf16 v[32:47], a[104:107], v[168:171], v[32:47]
  ds_read_b128 v[208:211], v0 offset:28672
  ds_read_b128 v[212:215], v0 offset:29696
  v_rcp_f32 v52, v52
  v_rcp_f32 v53, v53
  v_mfma_f32_32x32x16_bf16 v[32:47], a[108:111], v[172:175], v[32:47]
  buffer_store_dwordx4 v[120:123], v10, s[8:11], s28 offen offset:64
  v_rcp_f32 v54, v54
  v_rcp_f32 v55, v55
  v_mfma_f32_32x32x16_bf16 v[32:47], a[112:115], v[176:179], v[32:47]
  v_rcp_f32 v56, v56
  v_rcp_f32 v57, v57
  v_rcp_f32_e64 v58, v58
  v_mfma_f32_32x32x16_bf16 v[32:47], a[116:119], v[180:183], v[32:47]
  s_waitcnt lgkmcnt(0)
  v_rcp_f32 v59, v59
  v_rcp_f32 v60, v60
  v_rcp_f32 v61, v61
  v_rcp_f32 v62, v62
  v_rcp_f32 v63, v63
  v_pk_mul_f32 v[16:17], v[16:17], v[48:49]
  v_pk_mul_f32 v[18:19], v[18:19], v[50:51]
  v_pk_mul_f32 v[20:21], v[20:21], v[52:53]
  v_pk_mul_f32 v[22:23], v[22:23], v[54:55]
  v_pk_mul_f32 v[24:25], v[24:25], v[56:57]
  v_pk_mul_f32 v[26:27], v[26:27], v[58:59]
  v_pk_mul_f32 v[28:29], v[28:29], v[60:61]
  v_pk_mul_f32 v[30:31], v[30:31], v[62:63]
  v_pk_fma_f32 v[48:49], v[32:33], v[32:33], s[20:21] neg_lo:[1,0,1] neg_hi:[1,0,1]
  v_pk_fma_f32 v[50:51], v[34:35], v[34:35], s[20:21] neg_lo:[1,0,1] neg_hi:[1,0,1]
  v_pk_fma_f32 v[52:53], v[36:37], v[36:37], s[20:21] neg_lo:[1,0,1] neg_hi:[1,0,1]
  v_pk_fma_f32 v[54:55], v[38:39], v[38:39], s[20:21] neg_lo:[1,0,1] neg_hi:[1,0,1]
  v_pk_fma_f32 v[56:57], v[40:41], v[40:41], s[20:21] neg_lo:[1,0,1] neg_hi:[1,0,1]
  v_pk_fma_f32 v[58:59], v[42:43], v[42:43], s[20:21] neg_lo:[1,0,1] neg_hi:[1,0,1]
  v_pk_fma_f32 v[60:61], v[44:45], v[44:45], s[20:21] neg_lo:[1,0,1] neg_hi:[1,0,1]
  v_pk_fma_f32 v[62:63], v[46:47], v[46:47], s[20:21] neg_lo:[1,0,1] neg_hi:[1,0,1]
  v_pk_mul_f32 v[48:49], v[32:33], v[48:49]
  v_pk_mul_f32 v[50:51], v[34:35], v[50:51]
  v_pk_mul_f32 v[52:53], v[36:37], v[52:53]
  v_pk_mul_f32 v[54:55], v[38:39], v[54:55]
  v_pk_mul_f32 v[56:57], v[40:41], v[56:57]
  v_cvt_pk_bf16_f32 v184, v16, v17
  v_cvt_pk_bf16_f32 v185, v18, v19
  v_cvt_pk_bf16_f32 v186, v20, v21
  v_cvt_pk_bf16_f32 v187, v22, v23
  v_pk_mul_f32 v[58:59], v[42:43], v[58:59]
  v_pk_mul_f32 v[60:61], v[44:45], v[60:61]
  v_pk_mul_f32 v[62:63], v[46:47], v[62:63]
  v_mfma_f32_32x32x16_bf16 v[64:79], v[192:195], v[184:187], v[64:79]
  v_cvt_pk_bf16_f32 v188, v24, v25
  v_cvt_pk_bf16_f32 v189, v26, v27
  v_cvt_pk_bf16_f32 v190, v28, v29
  v_cvt_pk_bf16_f32 v191, v30, v31
  v_exp_f32_e64 v48, v48
  v_mfma_f32_32x32x16_bf16 v[80:95], v[196:199], v[184:187], v[80:95]
  v_exp_f32 v49, v49
  v_exp_f32 v50, v50
  v_exp_f32_e64 v51, v51
  v_mfma_f32_32x32x16_bf16 v[96:111], v[200:203], v[184:187], v[96:111]
  v_exp_f32 v52, v52
  v_exp_f32 v53, v53
  v_exp_f32_e64 v54, v54
  v_mfma_f32_32x32x16_bf16 v[64:79], v[204:207], v[188:191], v[64:79]
  v_exp_f32 v55, v55
  v_exp_f32 v56, v56
  v_exp_f32_e64 v57, v57
  v_mfma_f32_32x32x16_bf16 v[80:95], v[208:211], v[188:191], v[80:95]
  v_exp_f32 v58, v58
  v_exp_f32 v59, v59
  v_exp_f32_e64 v60, v60
  v_mfma_f32_32x32x16_bf16 v[96:111], v[212:215], v[188:191], v[96:111]
  v_exp_f32 v61, v61
  v_exp_f32 v62, v62
  v_exp_f32_e64 v63, v63
  v_pk_fma_f32 v[48:49], v[48:49], s[22:23], s[22:23]
  v_pk_fma_f32 v[50:51], v[50:51], s[22:23], s[22:23]
  v_pk_fma_f32 v[52:53], v[52:53], s[22:23], s[22:23]
  v_pk_fma_f32 v[54:55], v[54:55], s[22:23], s[22:23]
  v_pk_fma_f32 v[56:57], v[56:57], s[22:23], s[22:23]
  v_pk_fma_f32 v[58:59], v[58:59], s[22:23], s[22:23]
  v_pk_fma_f32 v[60:61], v[60:61], s[22:23], s[22:23]
  v_pk_fma_f32 v[62:63], v[62:63], s[22:23], s[22:23]
  v_mfma_f32_32x32x16_bf16 v[16:31], a[120:123], v[160:163], 0
  ds_read_b128 v[192:195], v0 offset:30720
  ds_read_b128 v[196:199], v0 offset:31744
  v_rcp_f32 v48, v48
  v_rcp_f32 v49, v49
  v_mfma_f32_32x32x16_bf16 v[16:31], a[124:127], v[164:167], v[16:31]
  ds_read_b128 v[200:203], v0 offset:32768
  ds_read_b128 v[204:207], v0 offset:33792
  v_rcp_f32 v50, v50
  v_rcp_f32 v51, v51
  v_mfma_f32_32x32x16_bf16 v[16:31], a[128:131], v[168:171], v[16:31]
  ds_read_b128 v[208:211], v0 offset:34816
  ds_read_b128 v[212:215], v0 offset:35840
  v_rcp_f32 v52, v52
  v_rcp_f32 v53, v53
  v_mfma_f32_32x32x16_bf16 v[16:31], a[132:135], v[172:175], v[16:31]
  buffer_store_dwordx4 v[124:127], v10, s[8:11], s28 offen offset:96
  v_rcp_f32 v54, v54
  v_rcp_f32 v55, v55
  v_mfma_f32_32x32x16_bf16 v[16:31], a[136:139], v[176:179], v[16:31]
  v_rcp_f32 v56, v56
  v_rcp_f32 v57, v57
  v_rcp_f32_e64 v58, v58
  v_mfma_f32_32x32x16_bf16 v[16:31], a[140:143], v[180:183], v[16:31]
  s_waitcnt lgkmcnt(0)
  v_rcp_f32 v59, v59
  v_rcp_f32 v60, v60
  v_rcp_f32 v61, v61
  v_rcp_f32 v62, v62
  v_rcp_f32 v63, v63
  v_pk_mul_f32 v[32:33], v[32:33], v[48:49]
  v_pk_mul_f32 v[34:35], v[34:35], v[50:51]
  v_pk_mul_f32 v[36:37], v[36:37], v[52:53]
  v_pk_mul_f32 v[38:39], v[38:39], v[54:55]
  v_pk_mul_f32 v[40:41], v[40:41], v[56:57]
  v_pk_mul_f32 v[42:43], v[42:43], v[58:59]
  v_pk_mul_f32 v[44:45], v[44:45], v[60:61]
  v_pk_mul_f32 v[46:47], v[46:47], v[62:63]
  v_pk_fma_f32 v[48:49], v[16:17], v[16:17], s[20:21] neg_lo:[1,0,1] neg_hi:[1,0,1]
  v_pk_fma_f32 v[50:51], v[18:19], v[18:19], s[20:21] neg_lo:[1,0,1] neg_hi:[1,0,1]
  v_pk_fma_f32 v[52:53], v[20:21], v[20:21], s[20:21] neg_lo:[1,0,1] neg_hi:[1,0,1]
  v_pk_fma_f32 v[54:55], v[22:23], v[22:23], s[20:21] neg_lo:[1,0,1] neg_hi:[1,0,1]
  v_pk_fma_f32 v[56:57], v[24:25], v[24:25], s[20:21] neg_lo:[1,0,1] neg_hi:[1,0,1]
  v_pk_fma_f32 v[58:59], v[26:27], v[26:27], s[20:21] neg_lo:[1,0,1] neg_hi:[1,0,1]
  v_pk_fma_f32 v[60:61], v[28:29], v[28:29], s[20:21] neg_lo:[1,0,1] neg_hi:[1,0,1]
  v_pk_fma_f32 v[62:63], v[30:31], v[30:31], s[20:21] neg_lo:[1,0,1] neg_hi:[1,0,1]
  v_pk_mul_f32 v[48:49], v[16:17], v[48:49]
  v_pk_mul_f32 v[50:51], v[18:19], v[50:51]
  v_pk_mul_f32 v[52:53], v[20:21], v[52:53]
  v_pk_mul_f32 v[54:55], v[22:23], v[54:55]
  v_pk_mul_f32 v[56:57], v[24:25], v[56:57]
  v_cvt_pk_bf16_f32 v184, v32, v33
  v_cvt_pk_bf16_f32 v185, v34, v35
  v_cvt_pk_bf16_f32 v186, v36, v37
  v_cvt_pk_bf16_f32 v187, v38, v39
  v_pk_mul_f32 v[58:59], v[26:27], v[58:59]
  v_pk_mul_f32 v[60:61], v[28:29], v[60:61]
  v_pk_mul_f32 v[62:63], v[30:31], v[62:63]
  v_mfma_f32_32x32x16_bf16 v[64:79], v[192:195], v[184:187], v[64:79]
  v_cvt_pk_bf16_f32 v188, v40, v41
  v_cvt_pk_bf16_f32 v189, v42, v43
  v_cvt_pk_bf16_f32 v190, v44, v45
  v_cvt_pk_bf16_f32 v191, v46, v47
  v_exp_f32_e64 v48, v48
  v_mfma_f32_32x32x16_bf16 v[80:95], v[196:199], v[184:187], v[80:95]
  v_exp_f32 v49, v49
  v_exp_f32 v50, v50
  v_exp_f32_e64 v51, v51
  v_mfma_f32_32x32x16_bf16 v[96:111], v[200:203], v[184:187], v[96:111]
  v_exp_f32 v52, v52
  v_exp_f32 v53, v53
  v_exp_f32_e64 v54, v54
  v_mfma_f32_32x32x16_bf16 v[64:79], v[204:207], v[188:191], v[64:79]
  v_exp_f32 v55, v55
  v_exp_f32 v56, v56
  v_exp_f32_e64 v57, v57
  v_mfma_f32_32x32x16_bf16 v[80:95], v[208:211], v[188:191], v[80:95]
  v_exp_f32 v58, v58
  v_exp_f32 v59, v59
  v_exp_f32_e64 v60, v60
  v_mfma_f32_32x32x16_bf16 v[96:111], v[212:215], v[188:191], v[96:111]
  v_exp_f32 v61, v61
  v_exp_f32 v62, v62
  v_exp_f32_e64 v63, v63
  v_pk_fma_f32 v[48:49], v[48:49], s[22:23], s[22:23]
  v_pk_fma_f32 v[50:51], v[50:51], s[22:23], s[22:23]
  v_pk_fma_f32 v[52:53], v[52:53], s[22:23], s[22:23]
  v_pk_fma_f32 v[54:55], v[54:55], s[22:23], s[22:23]
  v_pk_fma_f32 v[56:57], v[56:57], s[22:23], s[22:23]
  v_pk_fma_f32 v[58:59], v[58:59], s[22:23], s[22:23]
  v_pk_fma_f32 v[60:61], v[60:61], s[22:23], s[22:23]
  v_pk_fma_f32 v[62:63], v[62:63], s[22:23], s[22:23]
  v_mfma_f32_32x32x16_bf16 v[32:47], a[144:147], v[160:163], 0
  ds_read_b128 v[192:195], v0 offset:36864
  ds_read_b128 v[196:199], v0 offset:37888
  v_rcp_f32 v48, v48
  v_rcp_f32 v49, v49
  v_mfma_f32_32x32x16_bf16 v[32:47], a[148:151], v[164:167], v[32:47]
  ds_read_b128 v[200:203], v0 offset:38912
  ds_read_b128 v[204:207], v0 offset:39936
  v_rcp_f32 v50, v50
  v_rcp_f32 v51, v51
  v_mfma_f32_32x32x16_bf16 v[32:47], a[152:155], v[168:171], v[32:47]
  ds_read_b128 v[208:211], v0 offset:40960
  ds_read_b128 v[212:215], v0 offset:41984
  v_rcp_f32 v52, v52
  v_rcp_f32 v53, v53
  v_mfma_f32_32x32x16_bf16 v[32:47], a[156:159], v[172:175], v[32:47]
  v_rcp_f32 v54, v54
  v_rcp_f32 v55, v55
  v_rcp_f32_e64 v56, v56
  v_mfma_f32_32x32x16_bf16 v[32:47], a[160:163], v[176:179], v[32:47]
  v_rcp_f32 v57, v57
  v_rcp_f32 v58, v58
  v_rcp_f32_e64 v59, v59
  v_mfma_f32_32x32x16_bf16 v[32:47], a[164:167], v[180:183], v[32:47]
  s_waitcnt lgkmcnt(0)
  v_rcp_f32 v60, v60
  v_rcp_f32 v61, v61
  v_rcp_f32 v62, v62
  v_rcp_f32_e64 v63, v63
  v_pk_mul_f32 v[16:17], v[16:17], v[48:49]
  v_pk_mul_f32 v[18:19], v[18:19], v[50:51]
  v_pk_mul_f32 v[20:21], v[20:21], v[52:53]
  v_pk_mul_f32 v[22:23], v[22:23], v[54:55]
  v_pk_mul_f32 v[24:25], v[24:25], v[56:57]
  v_pk_mul_f32 v[26:27], v[26:27], v[58:59]
  v_pk_mul_f32 v[28:29], v[28:29], v[60:61]
  v_pk_mul_f32 v[30:31], v[30:31], v[62:63]
  v_pk_fma_f32 v[48:49], v[32:33], v[32:33], s[20:21] neg_lo:[1,0,1] neg_hi:[1,0,1]
  v_pk_fma_f32 v[50:51], v[34:35], v[34:35], s[20:21] neg_lo:[1,0,1] neg_hi:[1,0,1]
  v_pk_fma_f32 v[52:53], v[36:37], v[36:37], s[20:21] neg_lo:[1,0,1] neg_hi:[1,0,1]
  v_pk_fma_f32 v[54:55], v[38:39], v[38:39], s[20:21] neg_lo:[1,0,1] neg_hi:[1,0,1]
  v_pk_fma_f32 v[56:57], v[40:41], v[40:41], s[20:21] neg_lo:[1,0,1] neg_hi:[1,0,1]
  v_pk_fma_f32 v[58:59], v[42:43], v[42:43], s[20:21] neg_lo:[1,0,1] neg_hi:[1,0,1]
  v_pk_fma_f32 v[60:61], v[44:45], v[44:45], s[20:21] neg_lo:[1,0,1] neg_hi:[1,0,1]
  v_pk_fma_f32 v[62:63], v[46:47], v[46:47], s[20:21] neg_lo:[1,0,1] neg_hi:[1,0,1]
  v_pk_mul_f32 v[48:49], v[32:33], v[48:49]
  v_pk_mul_f32 v[50:51], v[34:35], v[50:51]
  v_pk_mul_f32 v[52:53], v[36:37], v[52:53]
  v_pk_mul_f32 v[54:55], v[38:39], v[54:55]
  v_pk_mul_f32 v[56:57], v[40:41], v[56:57]
  v_cvt_pk_bf16_f32 v184, v16, v17
  v_cvt_pk_bf16_f32 v185, v18, v19
  v_cvt_pk_bf16_f32 v186, v20, v21
  v_cvt_pk_bf16_f32 v187, v22, v23
  v_pk_mul_f32 v[58:59], v[42:43], v[58:59]
  v_pk_mul_f32 v[60:61], v[44:45], v[60:61]
  v_pk_mul_f32 v[62:63], v[46:47], v[62:63]
  v_mfma_f32_32x32x16_bf16 v[64:79], v[192:195], v[184:187], v[64:79]
  v_cvt_pk_bf16_f32 v188, v24, v25
  v_cvt_pk_bf16_f32 v189, v26, v27
  v_cvt_pk_bf16_f32 v190, v28, v29
  v_cvt_pk_bf16_f32 v191, v30, v31
  v_exp_f32_e64 v48, v48
  v_mfma_f32_32x32x16_bf16 v[80:95], v[196:199], v[184:187], v[80:95]
  v_exp_f32 v49, v49
  v_exp_f32 v50, v50
  v_exp_f32_e64 v51, v51
  v_mfma_f32_32x32x16_bf16 v[96:111], v[200:203], v[184:187], v[96:111]
  v_exp_f32 v52, v52
  v_exp_f32 v53, v53
  v_exp_f32_e64 v54, v54
  v_mfma_f32_32x32x16_bf16 v[64:79], v[204:207], v[188:191], v[64:79]
  v_exp_f32 v55, v55
  v_exp_f32 v56, v56
  v_exp_f32_e64 v57, v57
  v_mfma_f32_32x32x16_bf16 v[80:95], v[208:211], v[188:191], v[80:95]
  v_exp_f32 v58, v58
  v_exp_f32 v59, v59
  v_exp_f32_e64 v60, v60
  v_mfma_f32_32x32x16_bf16 v[96:111], v[212:215], v[188:191], v[96:111]
  v_exp_f32 v61, v61
  v_exp_f32 v62, v62
  v_exp_f32_e64 v63, v63
  v_pk_fma_f32 v[48:49], v[48:49], s[22:23], s[22:23]
  v_pk_fma_f32 v[50:51], v[50:51], s[22:23], s[22:23]
  v_pk_fma_f32 v[52:53], v[52:53], s[22:23], s[22:23]
  v_pk_fma_f32 v[54:55], v[54:55], s[22:23], s[22:23]
  v_pk_fma_f32 v[56:57], v[56:57], s[22:23], s[22:23]
  v_pk_fma_f32 v[58:59], v[58:59], s[22:23], s[22:23]
  v_pk_fma_f32 v[60:61], v[60:61], s[22:23], s[22:23]
  v_pk_fma_f32 v[62:63], v[62:63], s[22:23], s[22:23]
  v_mfma_f32_32x32x16_bf16 v[16:31], a[168:171], v[160:163], 0
  ds_read_b128 v[192:195], v0 offset:43008
  ds_read_b128 v[196:199], v0 offset:44032
  v_rcp_f32 v48, v48
  v_rcp_f32 v49, v49
  v_mfma_f32_32x32x16_bf16 v[16:31], a[172:175], v[164:167], v[16:31]
  ds_read_b128 v[200:203], v0 offset:45056
  ds_read_b128 v[204:207], v0 offset:46080
  v_rcp_f32 v50, v50
  v_rcp_f32 v51, v51
  v_mfma_f32_32x32x16_bf16 v[16:31], a[176:179], v[168:171], v[16:31]
  ds_read_b128 v[208:211], v0 offset:47104
  ds_read_b128 v[212:215], v0 offset:48128
  v_rcp_f32 v52, v52
  v_rcp_f32 v53, v53
  v_mfma_f32_32x32x16_bf16 v[16:31], a[180:183], v[172:175], v[16:31]
  buffer_store_dwordx4 v[128:131], v10, s[8:11], s28 offen offset:128
  v_rcp_f32 v54, v54
  v_rcp_f32 v55, v55
  v_mfma_f32_32x32x16_bf16 v[16:31], a[184:187], v[176:179], v[16:31]
  v_rcp_f32 v56, v56
  v_rcp_f32 v57, v57
  v_rcp_f32_e64 v58, v58
  v_mfma_f32_32x32x16_bf16 v[16:31], a[188:191], v[180:183], v[16:31]
  s_waitcnt lgkmcnt(0)
  v_rcp_f32 v59, v59
  v_rcp_f32 v60, v60
  v_rcp_f32 v61, v61
  v_rcp_f32 v62, v62
  v_rcp_f32 v63, v63
  v_pk_mul_f32 v[32:33], v[32:33], v[48:49]
  v_pk_mul_f32 v[34:35], v[34:35], v[50:51]
  v_pk_mul_f32 v[36:37], v[36:37], v[52:53]
  v_pk_mul_f32 v[38:39], v[38:39], v[54:55]
  v_pk_mul_f32 v[40:41], v[40:41], v[56:57]
  v_pk_mul_f32 v[42:43], v[42:43], v[58:59]
  v_pk_mul_f32 v[44:45], v[44:45], v[60:61]
  v_pk_mul_f32 v[46:47], v[46:47], v[62:63]
  v_pk_fma_f32 v[48:49], v[16:17], v[16:17], s[20:21] neg_lo:[1,0,1] neg_hi:[1,0,1]
  v_pk_fma_f32 v[50:51], v[18:19], v[18:19], s[20:21] neg_lo:[1,0,1] neg_hi:[1,0,1]
  v_pk_fma_f32 v[52:53], v[20:21], v[20:21], s[20:21] neg_lo:[1,0,1] neg_hi:[1,0,1]
  v_pk_fma_f32 v[54:55], v[22:23], v[22:23], s[20:21] neg_lo:[1,0,1] neg_hi:[1,0,1]
  v_pk_fma_f32 v[56:57], v[24:25], v[24:25], s[20:21] neg_lo:[1,0,1] neg_hi:[1,0,1]
  v_pk_fma_f32 v[58:59], v[26:27], v[26:27], s[20:21] neg_lo:[1,0,1] neg_hi:[1,0,1]
  v_pk_fma_f32 v[60:61], v[28:29], v[28:29], s[20:21] neg_lo:[1,0,1] neg_hi:[1,0,1]
  v_pk_fma_f32 v[62:63], v[30:31], v[30:31], s[20:21] neg_lo:[1,0,1] neg_hi:[1,0,1]
  v_pk_mul_f32 v[48:49], v[16:17], v[48:49]
  v_pk_mul_f32 v[50:51], v[18:19], v[50:51]
  v_pk_mul_f32 v[52:53], v[20:21], v[52:53]
  v_pk_mul_f32 v[54:55], v[22:23], v[54:55]
  v_pk_mul_f32 v[56:57], v[24:25], v[56:57]
  v_cvt_pk_bf16_f32 v184, v32, v33
  v_cvt_pk_bf16_f32 v185, v34, v35
  v_cvt_pk_bf16_f32 v186, v36, v37
  v_cvt_pk_bf16_f32 v187, v38, v39
  v_pk_mul_f32 v[58:59], v[26:27], v[58:59]
  v_pk_mul_f32 v[60:61], v[28:29], v[60:61]
  v_pk_mul_f32 v[62:63], v[30:31], v[62:63]
  v_mfma_f32_32x32x16_bf16 v[64:79], v[192:195], v[184:187], v[64:79]
  v_cvt_pk_bf16_f32 v188, v40, v41
  v_cvt_pk_bf16_f32 v189, v42, v43
  v_cvt_pk_bf16_f32 v190, v44, v45
  v_cvt_pk_bf16_f32 v191, v46, v47
  v_exp_f32_e64 v48, v48
  v_mfma_f32_32x32x16_bf16 v[80:95], v[196:199], v[184:187], v[80:95]
  v_exp_f32 v49, v49
  v_exp_f32 v50, v50
  v_exp_f32_e64 v51, v51
  v_mfma_f32_32x32x16_bf16 v[96:111], v[200:203], v[184:187], v[96:111]
  v_exp_f32 v52, v52
  v_exp_f32 v53, v53
  v_exp_f32_e64 v54, v54
  v_mfma_f32_32x32x16_bf16 v[64:79], v[204:207], v[188:191], v[64:79]
  v_exp_f32 v55, v55
  v_exp_f32 v56, v56
  v_exp_f32_e64 v57, v57
  v_mfma_f32_32x32x16_bf16 v[80:95], v[208:211], v[188:191], v[80:95]
  v_exp_f32 v58, v58
  v_exp_f32 v59, v59
  v_exp_f32_e64 v60, v60
  v_mfma_f32_32x32x16_bf16 v[96:111], v[212:215], v[188:191], v[96:111]
  v_exp_f32 v61, v61
  v_exp_f32 v62, v62
  v_exp_f32_e64 v63, v63
  v_pk_fma_f32 v[48:49], v[48:49], s[22:23], s[22:23]
  v_pk_fma_f32 v[50:51], v[50:51], s[22:23], s[22:23]
  v_pk_fma_f32 v[52:53], v[52:53], s[22:23], s[22:23]
  v_pk_fma_f32 v[54:55], v[54:55], s[22:23], s[22:23]
  v_pk_fma_f32 v[56:57], v[56:57], s[22:23], s[22:23]
  v_pk_fma_f32 v[58:59], v[58:59], s[22:23], s[22:23]
  v_pk_fma_f32 v[60:61], v[60:61], s[22:23], s[22:23]
  v_pk_fma_f32 v[62:63], v[62:63], s[22:23], s[22:23]
  v_mfma_f32_32x32x16_bf16 v[32:47], a[192:195], v[160:163], 0
  ds_read_b128 v[192:195], v0 offset:49152
  ds_read_b128 v[196:199], v0 offset:50176
  v_rcp_f32 v48, v48
  v_rcp_f32 v49, v49
  v_mfma_f32_32x32x16_bf16 v[32:47], a[196:199], v[164:167], v[32:47]
  ds_read_b128 v[200:203], v0 offset:51200
  ds_read_b128 v[204:207], v0 offset:52224
  v_rcp_f32 v50, v50
  v_rcp_f32 v51, v51
  v_mfma_f32_32x32x16_bf16 v[32:47], a[200:203], v[168:171], v[32:47]
  ds_read_b128 v[208:211], v0 offset:53248
  ds_read_b128 v[212:215], v0 offset:54272
  v_rcp_f32 v52, v52
  v_rcp_f32 v53, v53
  v_mfma_f32_32x32x16_bf16 v[32:47], a[204:207], v[172:175], v[32:47]
  buffer_store_dwordx4 v[132:135], v10, s[8:11], s28 offen offset:160
  v_rcp_f32 v54, v54
  v_rcp_f32 v55, v55
  v_mfma_f32_32x32x16_bf16 v[32:47], a[208:211], v[176:179], v[32:47]
  v_rcp_f32 v56, v56
  v_rcp_f32 v57, v57
  v_rcp_f32_e64 v58, v58
  v_mfma_f32_32x32x16_bf16 v[32:47], a[212:215], v[180:183], v[32:47]
  s_waitcnt lgkmcnt(0)
  v_rcp_f32 v59, v59
  v_rcp_f32 v60, v60
  v_rcp_f32 v61, v61
  v_rcp_f32 v62, v62
  v_rcp_f32 v63, v63
  v_pk_mul_f32 v[16:17], v[16:17], v[48:49]
  v_pk_mul_f32 v[18:19], v[18:19], v[50:51]
  v_pk_mul_f32 v[20:21], v[20:21], v[52:53]
  v_pk_mul_f32 v[22:23], v[22:23], v[54:55]
  v_pk_mul_f32 v[24:25], v[24:25], v[56:57]
  v_pk_mul_f32 v[26:27], v[26:27], v[58:59]
  v_pk_mul_f32 v[28:29], v[28:29], v[60:61]
  v_pk_mul_f32 v[30:31], v[30:31], v[62:63]
  v_pk_fma_f32 v[48:49], v[32:33], v[32:33], s[20:21] neg_lo:[1,0,1] neg_hi:[1,0,1]
  v_pk_fma_f32 v[50:51], v[34:35], v[34:35], s[20:21] neg_lo:[1,0,1] neg_hi:[1,0,1]
  v_pk_fma_f32 v[52:53], v[36:37], v[36:37], s[20:21] neg_lo:[1,0,1] neg_hi:[1,0,1]
  v_pk_fma_f32 v[54:55], v[38:39], v[38:39], s[20:21] neg_lo:[1,0,1] neg_hi:[1,0,1]
  v_pk_fma_f32 v[56:57], v[40:41], v[40:41], s[20:21] neg_lo:[1,0,1] neg_hi:[1,0,1]
  v_pk_fma_f32 v[58:59], v[42:43], v[42:43], s[20:21] neg_lo:[1,0,1] neg_hi:[1,0,1]
  v_pk_fma_f32 v[60:61], v[44:45], v[44:45], s[20:21] neg_lo:[1,0,1] neg_hi:[1,0,1]
  v_pk_fma_f32 v[62:63], v[46:47], v[46:47], s[20:21] neg_lo:[1,0,1] neg_hi:[1,0,1]
  v_pk_mul_f32 v[48:49], v[32:33], v[48:49]
  v_pk_mul_f32 v[50:51], v[34:35], v[50:51]
  v_pk_mul_f32 v[52:53], v[36:37], v[52:53]
  v_pk_mul_f32 v[54:55], v[38:39], v[54:55]
  v_pk_mul_f32 v[56:57], v[40:41], v[56:57]
  v_cvt_pk_bf16_f32 v184, v16, v17
  v_cvt_pk_bf16_f32 v185, v18, v19
  v_cvt_pk_bf16_f32 v186, v20, v21
  v_cvt_pk_bf16_f32 v187, v22, v23
  v_pk_mul_f32 v[58:59], v[42:43], v[58:59]
  v_pk_mul_f32 v[60:61], v[44:45], v[60:61]
  v_pk_mul_f32 v[62:63], v[46:47], v[62:63]
  v_mfma_f32_32x32x16_bf16 v[64:79], v[192:195], v[184:187], v[64:79]
  v_cvt_pk_bf16_f32 v188, v24, v25
  v_cvt_pk_bf16_f32 v189, v26, v27
  v_cvt_pk_bf16_f32 v190, v28, v29
  v_cvt_pk_bf16_f32 v191, v30, v31
  v_exp_f32_e64 v48, v48
  v_mfma_f32_32x32x16_bf16 v[80:95], v[196:199], v[184:187], v[80:95]
  v_exp_f32 v49, v49
  v_exp_f32 v50, v50
  v_exp_f32_e64 v51, v51
  v_mfma_f32_32x32x16_bf16 v[96:111], v[200:203], v[184:187], v[96:111]
  v_exp_f32 v52, v52
  v_exp_f32 v53, v53
  v_exp_f32_e64 v54, v54
  v_mfma_f32_32x32x16_bf16 v[64:79], v[204:207], v[188:191], v[64:79]
  v_exp_f32 v55, v55
  v_exp_f32 v56, v56
  v_exp_f32_e64 v57, v57
  v_mfma_f32_32x32x16_bf16 v[80:95], v[208:211], v[188:191], v[80:95]
  v_exp_f32 v58, v58
  v_exp_f32 v59, v59
  v_exp_f32_e64 v60, v60
  v_mfma_f32_32x32x16_bf16 v[96:111], v[212:215], v[188:191], v[96:111]
  v_exp_f32 v61, v61
  v_exp_f32 v62, v62
  v_exp_f32_e64 v63, v63
  v_pk_fma_f32 v[48:49], v[48:49], s[22:23], s[22:23]
  v_pk_fma_f32 v[50:51], v[50:51], s[22:23], s[22:23]
  v_pk_fma_f32 v[52:53], v[52:53], s[22:23], s[22:23]
  v_pk_fma_f32 v[54:55], v[54:55], s[22:23], s[22:23]
  v_pk_fma_f32 v[56:57], v[56:57], s[22:23], s[22:23]
  v_pk_fma_f32 v[58:59], v[58:59], s[22:23], s[22:23]
  v_pk_fma_f32 v[60:61], v[60:61], s[22:23], s[22:23]
  v_pk_fma_f32 v[62:63], v[62:63], s[22:23], s[22:23]
  v_mfma_f32_32x32x16_bf16 v[16:31], a[216:219], v[160:163], 0
  ds_read_b128 v[192:195], v0 offset:55296
  ds_read_b128 v[196:199], v0 offset:56320
  v_rcp_f32 v48, v48
  v_rcp_f32 v49, v49
  v_mfma_f32_32x32x16_bf16 v[16:31], a[220:223], v[164:167], v[16:31]
  ds_read_b128 v[200:203], v0 offset:57344
  ds_read_b128 v[204:207], v0 offset:58368
  v_rcp_f32 v50, v50
  v_rcp_f32 v51, v51
  v_mfma_f32_32x32x16_bf16 v[16:31], a[224:227], v[168:171], v[16:31]
  ds_read_b128 v[208:211], v0 offset:59392
  ds_read_b128 v[212:215], v0 offset:60416
  v_rcp_f32 v52, v52
  v_rcp_f32 v53, v53
  v_mfma_f32_32x32x16_bf16 v[16:31], a[228:231], v[172:175], v[16:31]
  v_rcp_f32 v54, v54
  v_rcp_f32 v55, v55
  v_rcp_f32_e64 v56, v56
  v_mfma_f32_32x32x16_bf16 v[16:31], a[232:235], v[176:179], v[16:31]
  v_rcp_f32 v57, v57
  v_rcp_f32 v58, v58
  v_rcp_f32_e64 v59, v59
  v_mfma_f32_32x32x16_bf16 v[16:31], a[236:239], v[180:183], v[16:31]
  s_waitcnt lgkmcnt(0)
  v_rcp_f32 v60, v60
  v_rcp_f32 v61, v61
  v_rcp_f32 v62, v62
  v_rcp_f32_e64 v63, v63
  v_pk_mul_f32 v[32:33], v[32:33], v[48:49]
  v_pk_mul_f32 v[34:35], v[34:35], v[50:51]
  v_pk_mul_f32 v[36:37], v[36:37], v[52:53]
  v_pk_mul_f32 v[38:39], v[38:39], v[54:55]
  v_pk_mul_f32 v[40:41], v[40:41], v[56:57]
  v_pk_mul_f32 v[42:43], v[42:43], v[58:59]
  v_pk_mul_f32 v[44:45], v[44:45], v[60:61]
  v_pk_mul_f32 v[46:47], v[46:47], v[62:63]
  v_pk_fma_f32 v[48:49], v[16:17], v[16:17], s[20:21] neg_lo:[1,0,1] neg_hi:[1,0,1]
  v_pk_fma_f32 v[50:51], v[18:19], v[18:19], s[20:21] neg_lo:[1,0,1] neg_hi:[1,0,1]
  v_pk_fma_f32 v[52:53], v[20:21], v[20:21], s[20:21] neg_lo:[1,0,1] neg_hi:[1,0,1]
  v_pk_fma_f32 v[54:55], v[22:23], v[22:23], s[20:21] neg_lo:[1,0,1] neg_hi:[1,0,1]
  v_pk_fma_f32 v[56:57], v[24:25], v[24:25], s[20:21] neg_lo:[1,0,1] neg_hi:[1,0,1]
  v_pk_fma_f32 v[58:59], v[26:27], v[26:27], s[20:21] neg_lo:[1,0,1] neg_hi:[1,0,1]
  v_pk_fma_f32 v[60:61], v[28:29], v[28:29], s[20:21] neg_lo:[1,0,1] neg_hi:[1,0,1]
  v_pk_fma_f32 v[62:63], v[30:31], v[30:31], s[20:21] neg_lo:[1,0,1] neg_hi:[1,0,1]
  v_pk_mul_f32 v[48:49], v[16:17], v[48:49]
  v_pk_mul_f32 v[50:51], v[18:19], v[50:51]
  v_pk_mul_f32 v[52:53], v[20:21], v[52:53]
  v_pk_mul_f32 v[54:55], v[22:23], v[54:55]
  v_pk_mul_f32 v[56:57], v[24:25], v[56:57]
  v_cvt_pk_bf16_f32 v184, v32, v33
  v_cvt_pk_bf16_f32 v185, v34, v35
  v_cvt_pk_bf16_f32 v186, v36, v37
  v_cvt_pk_bf16_f32 v187, v38, v39
  v_pk_mul_f32 v[58:59], v[26:27], v[58:59]
  v_pk_mul_f32 v[60:61], v[28:29], v[60:61]
  v_pk_mul_f32 v[62:63], v[30:31], v[62:63]
  v_mfma_f32_32x32x16_bf16 v[64:79], v[192:195], v[184:187], v[64:79]
  ds_read_b128 v[216:219], v0 offset:12288
  ds_read_b128 v[220:223], v0 offset:13312
  v_cvt_pk_bf16_f32 v188, v40, v41
  v_cvt_pk_bf16_f32 v189, v42, v43
  v_cvt_pk_bf16_f32 v190, v44, v45
  v_cvt_pk_bf16_f32 v191, v46, v47
  v_mfma_f32_32x32x16_bf16 v[80:95], v[196:199], v[184:187], v[80:95]
  ds_read_b128 v[224:227], v0 offset:14336
  ds_read_b128 v[228:231], v0 offset:15360
  v_exp_f32 v48, v48
  v_exp_f32 v49, v49
  v_mfma_f32_32x32x16_bf16 v[96:111], v[200:203], v[184:187], v[96:111]
  ds_read_b128 v[232:235], v0 offset:16384
  ds_read_b128 v[236:239], v0 offset:17408
  v_exp_f32 v50, v50
  v_exp_f32 v51, v51
  v_mfma_f32_32x32x16_bf16 v[64:79], v[204:207], v[188:191], v[64:79]
  s_mov_b32 s28, s34
  v_exp_f32 v52, v52
  v_exp_f32 v53, v53
  v_exp_f32 v54, v54
  v_mfma_f32_32x32x16_bf16 v[80:95], v[208:211], v[188:191], v[80:95]
  s_add_u32 s34, s34, 0x60000
  v_exp_f32 v55, v55
  v_exp_f32 v56, v56
  v_exp_f32_e64 v57, v57
  v_mfma_f32_32x32x16_bf16 v[96:111], v[212:215], v[188:191], v[96:111]
  s_waitcnt lgkmcnt(0)
  v_exp_f32 v58, v58
  v_exp_f32 v59, v59
  v_exp_f32 v60, v60
  v_exp_f32 v61, v61
  v_exp_f32 v62, v62
  v_exp_f32_e64 v63, v63
  v_pk_fma_f32 v[48:49], v[48:49], s[22:23], s[22:23]
  v_pk_fma_f32 v[50:51], v[50:51], s[22:23], s[22:23]
  v_pk_fma_f32 v[52:53], v[52:53], s[22:23], s[22:23]
  v_pk_fma_f32 v[54:55], v[54:55], s[22:23], s[22:23]
  v_pk_fma_f32 v[56:57], v[56:57], s[22:23], s[22:23]
  v_pk_fma_f32 v[58:59], v[58:59], s[22:23], s[22:23]
  v_pk_fma_f32 v[60:61], v[60:61], s[22:23], s[22:23]
  v_pk_fma_f32 v[62:63], v[62:63], s[22:23], s[22:23]
  v_mfma_f32_32x32x16_bf16 v[32:47], v[216:219], v[160:163], 0
  ds_read_b128 v[192:195], v0 offset:61440
  ds_read_b128 v[196:199], v0 offset:62464
  v_rcp_f32 v48, v48
  v_rcp_f32 v49, v49
  v_mfma_f32_32x32x16_bf16 v[32:47], v[220:223], v[164:167], v[32:47]
  ds_read_b128 v[200:203], v0 offset:63488
  ds_read_b128 v[204:207], v0 offset:64512
  v_rcp_f32 v50, v50
  v_rcp_f32 v51, v51
  v_mfma_f32_32x32x16_bf16 v[32:47], v[224:227], v[168:171], v[32:47]
  ds_read_b128 v[208:211], v1
  ds_read_b128 v[212:215], v1 offset:1024
  v_rcp_f32 v52, v52
  v_rcp_f32 v53, v53
  v_mfma_f32_32x32x16_bf16 v[32:47], v[228:231], v[172:175], v[32:47]
  v_rcp_f32 v54, v54
  v_rcp_f32 v55, v55
  v_rcp_f32_e64 v56, v56
  v_mfma_f32_32x32x16_bf16 v[32:47], v[232:235], v[176:179], v[32:47]
  v_rcp_f32 v57, v57
  v_rcp_f32 v58, v58
  v_rcp_f32_e64 v59, v59
  v_mfma_f32_32x32x16_bf16 v[32:47], v[236:239], v[180:183], v[32:47]
  s_waitcnt lgkmcnt(0)
  v_rcp_f32 v60, v60
  v_rcp_f32 v61, v61
  v_rcp_f32 v62, v62
  v_rcp_f32_e64 v63, v63
  v_pk_mul_f32 v[16:17], v[16:17], v[48:49]
  v_pk_mul_f32 v[18:19], v[18:19], v[50:51]
  v_pk_mul_f32 v[20:21], v[20:21], v[52:53]
  v_pk_mul_f32 v[22:23], v[22:23], v[54:55]
  v_pk_mul_f32 v[24:25], v[24:25], v[56:57]
  v_pk_mul_f32 v[26:27], v[26:27], v[58:59]
  v_pk_mul_f32 v[28:29], v[28:29], v[60:61]
  v_pk_mul_f32 v[30:31], v[30:31], v[62:63]
  v_pk_fma_f32 v[48:49], v[32:33], v[32:33], s[20:21] neg_lo:[1,0,1] neg_hi:[1,0,1]
  v_pk_fma_f32 v[50:51], v[34:35], v[34:35], s[20:21] neg_lo:[1,0,1] neg_hi:[1,0,1]
  v_pk_fma_f32 v[52:53], v[36:37], v[36:37], s[20:21] neg_lo:[1,0,1] neg_hi:[1,0,1]
  v_pk_fma_f32 v[54:55], v[38:39], v[38:39], s[20:21] neg_lo:[1,0,1] neg_hi:[1,0,1]
  v_pk_fma_f32 v[56:57], v[40:41], v[40:41], s[20:21] neg_lo:[1,0,1] neg_hi:[1,0,1]
  v_pk_fma_f32 v[58:59], v[42:43], v[42:43], s[20:21] neg_lo:[1,0,1] neg_hi:[1,0,1]
  v_pk_fma_f32 v[60:61], v[44:45], v[44:45], s[20:21] neg_lo:[1,0,1] neg_hi:[1,0,1]
  v_pk_fma_f32 v[62:63], v[46:47], v[46:47], s[20:21] neg_lo:[1,0,1] neg_hi:[1,0,1]
  v_pk_mul_f32 v[48:49], v[32:33], v[48:49]
  v_pk_mul_f32 v[50:51], v[34:35], v[50:51]
  v_pk_mul_f32 v[52:53], v[36:37], v[52:53]
  v_pk_mul_f32 v[54:55], v[38:39], v[54:55]
  v_pk_mul_f32 v[56:57], v[40:41], v[56:57]
  v_cvt_pk_bf16_f32 v184, v16, v17
  v_cvt_pk_bf16_f32 v185, v18, v19
  v_cvt_pk_bf16_f32 v186, v20, v21
  v_cvt_pk_bf16_f32 v187, v22, v23
  v_pk_mul_f32 v[58:59], v[42:43], v[58:59]
  v_pk_mul_f32 v[60:61], v[44:45], v[60:61]
  v_pk_mul_f32 v[62:63], v[46:47], v[62:63]
  v_mfma_f32_32x32x16_bf16 v[64:79], v[192:195], v[184:187], v[64:79]
  v_cvt_pk_bf16_f32 v188, v24, v25
  v_cvt_pk_bf16_f32 v189, v26, v27
  v_cvt_pk_bf16_f32 v190, v28, v29
  v_cvt_pk_bf16_f32 v191, v30, v31
  v_exp_f32_e64 v48, v48
  v_mfma_f32_32x32x16_bf16 v[80:95], v[196:199], v[184:187], v[80:95]
  v_exp_f32 v49, v49
  v_exp_f32 v50, v50
  v_exp_f32_e64 v51, v51
  v_mfma_f32_32x32x16_bf16 v[96:111], v[200:203], v[184:187], v[96:111]
  v_exp_f32 v52, v52
  v_exp_f32 v53, v53
  v_exp_f32_e64 v54, v54
  v_mfma_f32_32x32x16_bf16 v[64:79], v[204:207], v[188:191], v[64:79]
  v_exp_f32 v55, v55
  v_exp_f32 v56, v56
  v_exp_f32_e64 v57, v57
  v_mfma_f32_32x32x16_bf16 v[80:95], v[208:211], v[188:191], v[80:95]
  v_exp_f32 v58, v58
  v_exp_f32 v59, v59
  v_exp_f32_e64 v60, v60
  v_mfma_f32_32x32x16_bf16 v[96:111], v[212:215], v[188:191], v[96:111]
  v_exp_f32 v61, v61
  v_exp_f32 v62, v62
  v_exp_f32_e64 v63, v63
  v_pk_fma_f32 v[48:49], v[48:49], s[22:23], s[22:23]
  v_pk_fma_f32 v[50:51], v[50:51], s[22:23], s[22:23]
  v_pk_fma_f32 v[52:53], v[52:53], s[22:23], s[22:23]
  v_pk_fma_f32 v[54:55], v[54:55], s[22:23], s[22:23]
  v_pk_fma_f32 v[56:57], v[56:57], s[22:23], s[22:23]
  v_pk_fma_f32 v[58:59], v[58:59], s[22:23], s[22:23]
  v_pk_fma_f32 v[60:61], v[60:61], s[22:23], s[22:23]
  v_pk_fma_f32 v[62:63], v[62:63], s[22:23], s[22:23]
  ds_read_b128 v[192:195], v1 offset:2048
  ds_read_b128 v[196:199], v1 offset:3072
  ds_read_b128 v[200:203], v1 offset:4096
  ds_read_b128 v[204:207], v1 offset:5120
  ds_read_b128 v[208:211], v1 offset:6144
  ds_read_b128 v[212:215], v1 offset:7168
  v_rcp_f32 v48, v48
  v_rcp_f32 v49, v49
  v_rcp_f32 v50, v50
  v_rcp_f32 v51, v51
  v_rcp_f32 v52, v52
  v_rcp_f32 v53, v53
  v_rcp_f32 v54, v54
  v_rcp_f32 v55, v55
  v_rcp_f32 v56, v56
  v_rcp_f32 v57, v57
  v_rcp_f32 v58, v58
  v_rcp_f32 v59, v59
  v_rcp_f32 v60, v60
  v_rcp_f32 v61, v61
  v_rcp_f32 v62, v62
  v_rcp_f32 v63, v63
  v_pk_mul_f32 v[32:33], v[32:33], v[48:49]
  v_pk_mul_f32 v[34:35], v[34:35], v[50:51]
  v_pk_mul_f32 v[36:37], v[36:37], v[52:53]
  v_pk_mul_f32 v[38:39], v[38:39], v[54:55]
  v_pk_mul_f32 v[40:41], v[40:41], v[56:57]
  v_pk_mul_f32 v[42:43], v[42:43], v[58:59]
  v_pk_mul_f32 v[44:45], v[44:45], v[60:61]
  v_pk_mul_f32 v[46:47], v[46:47], v[62:63]
  v_cvt_pk_bf16_f32 v184, v32, v33
  v_cvt_pk_bf16_f32 v185, v34, v35
  v_cvt_pk_bf16_f32 v186, v36, v37
  v_cvt_pk_bf16_f32 v187, v38, v39
  v_cvt_pk_bf16_f32 v188, v40, v41
  v_cvt_pk_bf16_f32 v189, v42, v43
  v_cvt_pk_bf16_f32 v190, v44, v45
  v_cvt_pk_bf16_f32 v191, v46, v47
  s_waitcnt lgkmcnt(5)
  v_mfma_f32_32x32x16_bf16 v[64:79], v[192:195], v[184:187], v[64:79]
  s_waitcnt lgkmcnt(2)
  v_mfma_f32_32x32x16_bf16 v[64:79], v[204:207], v[188:191], v[64:79]
  v_mfma_f32_32x32x16_bf16 v[80:95], v[196:199], v[184:187], v[80:95]
  s_waitcnt lgkmcnt(1)
  v_mfma_f32_32x32x16_bf16 v[80:95], v[208:211], v[188:191], v[80:95]
  s_nop 0
  v_mfma_f32_32x32x16_bf16 v[96:111], v[200:203], v[184:187], v[96:111]
  s_waitcnt lgkmcnt(0)
  v_mfma_f32_32x32x16_bf16 v[96:111], v[212:215], v[188:191], v[96:111]
  s_nop 5
  v_cvt_pk_bf16_f32 v112, v64, v65
  v_cvt_pk_bf16_f32 v113, v66, v67
  v_cvt_pk_bf16_f32 v114, v68, v69
  v_cvt_pk_bf16_f32 v115, v70, v71
  buffer_store_dwordx4 v[112:115], v10, s[8:11], s28 offen
  v_cvt_pk_bf16_f32 v116, v72, v73
  v_cvt_pk_bf16_f32 v117, v74, v75
  v_cvt_pk_bf16_f32 v118, v76, v77
  v_cvt_pk_bf16_f32 v119, v78, v79
  buffer_store_dwordx4 v[116:119], v10, s[8:11], s28 offen offset:32
  v_cvt_pk_bf16_f32 v120, v80, v81
  v_cvt_pk_bf16_f32 v121, v82, v83
  v_cvt_pk_bf16_f32 v122, v84, v85
  v_cvt_pk_bf16_f32 v123, v86, v87
  buffer_store_dwordx4 v[120:123], v10, s[8:11], s28 offen offset:64
  v_cvt_pk_bf16_f32 v124, v88, v89
  v_cvt_pk_bf16_f32 v125, v90, v91
  v_cvt_pk_bf16_f32 v126, v92, v93
  v_cvt_pk_bf16_f32 v127, v94, v95
  buffer_store_dwordx4 v[124:127], v10, s[8:11], s28 offen offset:96
  v_cvt_pk_bf16_f32 v128, v96, v97
  v_cvt_pk_bf16_f32 v129, v98, v99
  v_cvt_pk_bf16_f32 v130, v100, v101
  v_cvt_pk_bf16_f32 v131, v102, v103
  buffer_store_dwordx4 v[128:131], v10, s[8:11], s28 offen offset:128
  v_cvt_pk_bf16_f32 v132, v104, v105
  v_cvt_pk_bf16_f32 v133, v106, v107
  v_cvt_pk_bf16_f32 v134, v108, v109
  v_cvt_pk_bf16_f32 v135, v110, v111
  buffer_store_dwordx4 v[132:135], v10, s[8:11], s28 offen offset:160
S_end:
  s_endpgm
.section .rodata,"a"
.p2align 6
.amdhsa_kernel standalone__modern_conv_block_convnext__vision_kernel
  .amdhsa_next_free_vgpr 512
  .amdhsa_next_free_sgpr 102
  .amdhsa_accum_offset 256
  .amdhsa_group_segment_fixed_size 0
  .amdhsa_kernarg_size 80
  .amdhsa_user_sgpr_count 2
  .amdhsa_user_sgpr_kernarg_segment_ptr 1
  .amdhsa_system_sgpr_workgroup_id_x 1
.end_amdhsa_kernel
```

```asm
; @launch grid=(256,1,1) block=(256,1,1) lds=163840
.amdgcn_target "amdgcn-amd-amdhsa--gfx950"
.text
.globl standalone__modern_conv_block_convnext__vision_kernel
.p2align 8
.type standalone__modern_conv_block_convnext__vision_kernel,@function
standalone__modern_conv_block_convnext__vision_kernel:
  s_cmp_ge_u32 s2, 0x100
  s_cbranch_scc1 L_end
  s_nop 0
  s_load_dwordx2 s[4:5], s[0:1], 0
  s_load_dwordx2 s[60:61], s[0:1], 8
  s_load_dwordx2 s[64:65], s[0:1], 16
  s_load_dwordx2 s[68:69], s[0:1], 24
  s_load_dwordx2 s[72:73], s[0:1], 32
  s_load_dwordx2 s[76:77], s[0:1], 40
  s_load_dwordx2 s[80:81], s[0:1], 48
  s_load_dwordx2 s[8:9], s[0:1], 56
  s_getpc_b64 s[40:41]
L_pc:
  s_lshl_b32 s32, s2, 9
  s_and_b32 s32, s32, 0xf000
  v_lshl_add_u32 v249, v0, 4, s32
  v_lshrrev_b32_e64 v112, 6, v0
  v_min_u32 v249, L_cend-L_pc-16, v249
  v_and_b32 v113, 63, v0
  global_load_dwordx4 v[108:111], v249, s[40:41]
  v_readfirstlane_b32 s27, v112
  s_mov_b32 s62, 0x6c0
  s_mov_b32 s63, 0x20000
  s_mov_b32 s82, 0xc0
  s_mov_b32 s83, 0x20000
  s_mov_b32 s78, 0xc0
  s_mov_b32 s79, 0x20000
  s_mov_b32 s66, 0x12000
  s_mov_b32 s67, 0x20000
  s_mov_b32 s74, 0x12000
  s_mov_b32 s75, 0x20000
  v_bfe_u32 v114, v113, 3, 1
  v_bfe_u32 v115, v113, 4, 1
  v_bfe_u32 v116, v113, 2, 1
  v_and_b32 v117, 3, v113
  v_lshlrev_b32 v118, 4, v113
  s_min_u32 s44, s27, 2
  s_lshl_b32 s45, s44, 6
  s_mul_i32 s46, s44, 0x240
  v_lshlrev_b32 v119, 1, v113
  v_and_b32 v120, 31, v113
  v_lshlrev_b32_e64 v121, 1, v120
  v_lshlrev_b32_e64 v122, 4, v115
  v_lshl_add_u32 v122, v116, 3, v122
  v_lshl_add_u32 v122, v114, 2, v122
  v_add_u32_e64 v122, v122, v117
  v_lshlrev_b32_e64 v123, 1, v122
  s_lshr_b32 s35, s2, 3
  s_lshl_b32 s35, s35, 2
  s_add_u32 s35, s35, s27
  s_sub_u32 s55, s35, 0x48
  s_min_u32 s35, s35, s55
  s_lshl_b32 s47, s35, 10
  s_and_b32 s54, s2, 6
  s_lshl_b32 s54, s54, 1
  s_lshr_b32 s32, s2, 6
  s_add_u32 s54, s54, s32
  s_mul_i32 s59, s54, 0x300000
  s_and_b32 s53, s2, 1
  s_lshl_b32 s53, s53, 8
  s_and_b32 s32, s2, 56
  s_lshl_b32 s32, s32, 2
  s_add_u32 s53, s53, s32
  s_lshl_b32 s32, s27, 3
  s_add_u32 s53, s53, s32
  s_mul_i32 s3, s53, 0xc0
  s_add_u32 s3, s3, 0xf40
  s_mov_b32 s6, 0x3000000
  s_mov_b32 s7, 0x20000
  s_cmp_eq_u32 s53, 0
  s_cselect_b32 s35, 12, 0
  s_sub_u32 s55, 0x78, s35
  s_cmp_eq_u32 s53, 0x1f8
  s_cselect_b32 s55, 0x6c, s55
  s_mul_i32 s15, s27, 0x1040
  s_add_u32 s48, s59, 0x17000
  s_add_u32 s49, s59, 0x47000
  s_waitcnt lgkmcnt(0)
  v_add_u32 v124, 64, v113
  buffer_load_dwordx4 v[108:111], v118, s[64:67], s47 offen
  v_subrev_u32 v127, 57, v113
  v_cmp_le_u32 vcc, 57, v113
  buffer_load_dwordx4 v[108:111], v118, s[72:75], s47 offen
  v_add_u32_e64 v125, 7, v113
  v_add_u32 v126, 0x47, v113
  buffer_load_ushort v129, v119, s[60:63], s46 offen
  v_mov_b32 v199, 0x17c00
  v_cndmask_b32_e64 v124, v124, v127, vcc
  buffer_load_ushort v130, v121, s[60:63], s46 offen offset:128
  v_mov_b32 v127, 0xfffffc00
  v_cndmask_b32_e64 v199, v127, v199, vcc
  v_add_u32_e64 v198, s3, v118
  buffer_load_ushort v131, v119, s[60:63], s46 offen offset:192
  v_lshl_add_u32 v199, v124, 4, v199
  v_add_u32_e64 v199, s3, v199
  buffer_load_ushort v132, v119, s[60:63], s46 offen offset:320
  v_add_u32 v200, 0x17870, v198
  v_add_u32 v201, 0x17870, v198
  buffer_load_ushort v133, v119, s[60:63], s46 offen offset:448
  v_mov_b32 v128, 0x80000000
  v_subrev_u32_e64 v6, s35, v113
  buffer_load_ushort v137, v123, s[80:83], s45 offen
  v_cmp_gt_u32 s[36:37], s55, v6
  v_subrev_u32_e64 v7, s35, v124
  v_cmp_gt_u32 s[38:39], s55, v7
  buffer_load_ushort v138, v123, s[76:79], s45 offen
  v_subrev_u32_e64 v8, s35, v125
  v_cmp_gt_u32 s[40:41], s55, v8
  buffer_load_ushort v134, v123, s[80:83], 0 offen
  v_subrev_u32_e64 v9, s35, v126
  v_cmp_gt_u32 s[42:43], s55, v9
  buffer_load_ushort v135, v123, s[80:83], 0 offen offset:64
  v_cndmask_b32 v6, v128, v198, s[36:37]
  v_cndmask_b32 v7, v128, v199, s[38:39]
  buffer_load_ushort v136, v123, s[80:83], 0 offen offset:128
  v_cndmask_b32 v8, v128, v200, s[40:41]
  v_cndmask_b32 v9, v128, v201, s[42:43]
  s_add_u32 m0, s15, 0x4120
  s_nop 0
  buffer_load_dwordx4 v6, s[4:7], s48 offen lds
  buffer_load_dwordx4 v7, s[4:7], s48 offen offset:1024 lds
  buffer_load_dwordx4 v8, s[4:7], s48 offen offset:2048 lds
  buffer_load_dwordx4 v9, s[4:7], s48 offen offset:3072 lds
  s_sub_u32 s56, s59, 0x19000
  v_add_u32 v198, s56, v6
  s_add_u32 s56, s56, 0x400
  v_add_u32_e64 v199, s56, v7
  s_add_u32 s56, s56, 0x400
  v_add_u32_e64 v200, s56, v8
  s_add_u32 s56, s56, 0x400
  v_add_u32 v201, s56, v9
  v_lshrrev_b32 v139, 5, v113
  v_lshlrev_b32_e64 v202, 4, v117
  v_lshl_add_u32 v202, v139, 6, v202
  v_bfe_u32 v124, v113, 3, 2
  v_lshl_add_u32 v124, v116, 2, v124
  v_cmp_eq_u32 vcc, 7, v124
  v_mul_u32_u24 v203, 0x300, v124
  v_add_u32 v203, v203, v202
  v_cndmask_b32_e64 v204, v128, v202, vcc
  s_mov_b32 s70, 0x300
  s_mov_b32 s71, 0x20000
  s_mov_b32 s10, 0x3000000
  s_mov_b32 s11, 0x20000
  s_and_b32 s36, s27, 2
  s_add_u32 s37, s27, 1
  s_lshr_b32 s37, s37, 1
  s_and_b32 s38, s37, 1
  s_cmp_eq_u32 s27, 1
  s_cselect_b32 s39, 0, 3
  s_cselect_b32 s51, 0x1000, 0
  s_lshl_b32 s32, s36, 8
  s_lshl_b32 s33, s37, 8
  s_add_u32 s43, s32, 0x11d00
  s_add_u32 s50, s33, 0x11d00
  s_add_u32 s51, s51, s33
  s_mul_i32 s40, s38, 0x6000
  s_add_u32 s40, s40, s32
  s_mul_i32 s41, s38, 0x1800
  s_add_u32 s41, s41, s32
  s_add_u32 s41, s41, 0x3000
  s_mul_i32 s42, s39, 0x3000
  s_add_u32 s42, s42, s33
  s_mul_i32 s32, s36, 0x6000
  s_lshl_b32 s33, s38, 11
  s_add_u32 s33, s33, s32
  s_add_u32 s33, s33, 0x10000
  v_add_u32_e64 v195, s33, v118
  s_lshl_b32 s33, s38, 3
  s_add_u32 s33, s33, s32
  s_add_u32 s33, s33, 0x10400
  v_add_u32_e64 v196, s33, v118
  s_mul_i32 s32, s37, 0x6000
  s_lshl_b32 s33, s39, 10
  s_add_u32 s33, s33, s32
  s_add_u32 s33, s33, 0x10000
  v_add_u32 v197, s33, v118
  v_add_u32 v125, 16, v113
  v_lshrrev_b32 v125, 6, v125
  v_lshlrev_b32 v125, 4, v125
  v_xor_b32_e64 v254, v125, v118
  v_lshl_add_u32 v125, v139, 4, 16
  v_xor_b32_e64 v255, v125, v118
  buffer_load_dwordx4 a[72:75], v202, s[64:67], s43 offen
  v_mul_u32_u24 v125, 0x1200, v139
  v_add_u32_e64 v255, v125, v255
  v_add_u32 v125, 0xb0, v113
  v_lshrrev_b32 v125, 6, v125
  v_lshlrev_b32 v125, 4, v125
  v_xor_b32_e64 v244, v125, v118
  v_add_u32 v244, 0x1200, v244
  s_mul_i32 s14, s27, 0x1800
  s_add_u32 s32, s27, 3
  s_and_b32 s32, s32, 3
  s_mul_i32 s32, s32, 0x600
  s_cmp_eq_u32 s27, 0
  s_cselect_b32 s57, 0, 3
  s_cselect_b32 s53, 3, 6
  s_cselect_b32 s55, 6, 0
  s_lshl_b32 s57, s57, 13
  s_add_u32 s57, s57, s32
  s_add_u32 s58, s57, 0x3000
  s_lshl_b32 s53, s53, 13
  s_add_u32 s53, s53, s32
  s_add_u32 s54, s53, 0x3000
  s_lshl_b32 s55, s55, 13
  s_add_u32 s55, s55, s32
  s_add_u32 s56, s55, 0x3000
  v_and_b32_e64 v148, 7, v113
  buffer_load_dwordx4 a[76:79], v202, s[64:67], s43 offen offset:128
  v_lshrrev_b32 v149, 4, v113
  v_lshlrev_b32 v150, 4, v139
  v_and_b32 v141, 1, v113
  v_lshlrev_b32 v141, 4, v141
  v_mov_b32 v127, 0xffff
  v_lshlrev_b32_e64 v127, v141, v127
  v_bfe_u32 v125, v113, 1, 2
  v_lshlrev_b32 v125, v125, 1
  v_bfe_i32 v56, v125, 0, 1
  v_mov_b32 v60, 0
  v_and_b32 v56, v56, v127
  v_bfe_i32 v57, v125, 1, 1
  v_mov_b32 v61, 0
  v_and_b32 v57, v57, v127
  v_bfe_i32 v58, v125, 2, 1
  v_mov_b32 v62, 0
  v_and_b32 v58, v58, v127
  buffer_load_dwordx4 a[80:83], v202, s[64:67], s50 offen
  v_bfe_i32 v59, v125, 3, 1
  v_mov_b32 v63, 0
  v_and_b32 v59, v59, v127
  v_min_u32_e64 v125, 11, v113
  v_mul_u32_u24 v125, 0x190, v125
  ds_write_b128 v125, v[60:63] offset:50304
  v_lshrrev_b32 v125, 2, v0
  v_min_u32 v125, 24, v125
  v_lshlrev_b32 v125, 4, v125
  v_or_b32 v125, v125, v117
  v_lshlrev_b32_e64 v125, 4, v125
  ds_write_b128 v125, v[60:63] offset:54720
  v_bfe_i32 v147, v113, 2, 1
  v_xor_b32 v146, -1, v147
  s_lshl_b32 s32, s44, 7
  v_lshrrev_b32_e64 v142, 3, v113
  v_lshl_add_u32 v145, v142, 8, s45
  v_lshl_add_u32 v145, v148, 3, v145
  v_mul_u32_u24 v142, 0x190, v142
  v_lshl_add_u32 v142, v148, 4, v142
  v_add_u32 v142, s32, v142
  v_lshrrev_b32 v143, 3, v120
  buffer_load_dwordx4 a[84:87], v202, s[64:67], s50 offen offset:128
  v_mul_u32_u24 v143, 0x190, v143
  v_lshl_add_u32 v143, v148, 4, v143
  v_add_u32_e64 v143, s32, v143
  v_lshl_add_u32 v144, v120, 2, s32
  v_sub_u32_e64 v125, v149, v116
  v_lshl_add_u32 v126, v114, 2, v117
  v_mul_u32_u24_e64 v140, 48, v139
  v_lshl_add_u32 v140, v115, 1, v140
  v_sub_u32_e64 v140, v140, v116
  v_lshl_add_u32 v140, v140, 3, v126
  v_lshlrev_b32_e64 v140, 3, v140
  v_add_u32 v11, 0xd600, v140
  v_add_u32 v205, 0xde00, v140
  v_lshl_add_u32 v126, v125, 3, v126
  v_min_u32 v126, 24, v126
  v_lshlrev_b32 v126, 4, v126
  v_add_u32 v3, 0xc300, v126
  v_lshlrev_b32_e64 v151, 2, v115
  v_lshl_add_u32 v151, v114, 1, v151
  v_bfe_u32 v126, v113, 1, 1
  v_add_u32_e64 v151, v151, v126
  buffer_load_dwordx4 a[88:91], v204, s[68:71], s51 offen
  v_xor_b32_e64 v126, v116, v139
  v_lshl_add_u32 v151, v126, 3, v151
  v_lshlrev_b32 v151, v151, 1
  v_mov_b32 v126, 0x3f80
  v_lshlrev_b32_e64 v126, v141, v126
  v_mov_b32 v125, 0xbf80
  v_lshlrev_b32_e64 v125, v141, v125
  v_bfe_i32 v216, v151, 0, 1
  v_and_b32 v224, v216, v126
  v_and_b32 v184, v216, v125
  v_bfe_i32 v217, v151, 1, 1
  v_and_b32 v225, v217, v126
  v_and_b32 v185, v217, v125
  v_bfe_i32 v218, v151, 2, 1
  v_and_b32 v226, v218, v126
  v_and_b32 v186, v218, v125
  v_bfe_i32 v219, v151, 3, 1
  v_and_b32 v227, v219, v126
  v_and_b32 v187, v219, v125
  v_bfe_i32 v220, v151, 4, 1
  v_and_b32_e64 v228, v220, v126
  buffer_load_dwordx4 a[92:95], v204, s[68:71], s51 offen offset:128
  v_and_b32_e64 v188, v220, v125
  v_bfe_i32 v221, v151, 5, 1
  v_and_b32 v229, v221, v126
  v_and_b32 v189, v221, v125
  v_bfe_i32 v222, v151, 6, 1
  v_and_b32 v230, v222, v126
  v_and_b32 v190, v222, v125
  v_bfe_i32 v223, v151, 7, 1
  v_and_b32 v231, v223, v126
  v_and_b32 v191, v223, v125
  v_lshl_add_u32 v151, v116, 1, v114
  v_xor_b32_e64 v126, v115, v139
  v_lshl_add_u32 v151, v126, 2, v151
  v_lshlrev_b32 v151, v151, 1
  v_bfe_u32 v240, v151, 0, 1
  v_mul_u32_u24 v240, 0x3f80, v240
  v_bfe_u32 v241, v151, 1, 1
  v_mul_u32_u24 v241, 0x3f80, v241
  v_bfe_u32 v242, v151, 2, 1
  v_mul_u32_u24 v242, 0x3f80, v242
  v_bfe_u32 v243, v151, 3, 1
  v_mul_u32_u24 v243, 0x3f80, v243
  buffer_load_dwordx4 a[0:3], v203, s[64:67], s40 offen
  s_mov_b32 s22, 0x3e9a0000
  s_mov_b32 s24, 0x3c2aaaab
  s_mov_b32 s25, 0x3727c5ac
  s_mov_b32 s20, 0x36553a11
  s_mov_b32 s21, 0x3aa63895
  s_mov_b32 s12, 0
  s_mov_b32 s13, -1
  s_add_u32 s29, s59, 0x77000
  s_add_u32 s52, s59, 0xa7000
  v_mul_u32_u24 v152, 0xc0, v148
  v_add_u32_e64 v127, s15, v152
  v_lshl_add_u32 v153, v114, 1, v149
  v_lshrrev_b32_e64 v125, 1, v153
  v_mul_u32_u24 v140, 0x4100, v125
  v_and_b32_e64 v125, 1, v125
  v_lshl_add_u32 v140, v125, 5, v140
  v_and_b32_e64 v125, 1, v153
  v_mul_u32_u24 v125, 0x790, v125
  v_add3_u32 v4, v140, v125, v127
  v_lshl_add_u32 v154, v114, 1, v115
  v_add_u32_e64 v153, 1, v154
  buffer_load_dwordx4 a[4:7], v203, s[64:67], s40 offen offset:128
  s_add_u32 s40, s40, 0x1800
  v_add_u32 v127, 0xc0, v127
  v_add_u32 v127, v127, v150
  v_lshrrev_b32 v125, 1, v153
  v_mul_u32_u24 v140, 0x4100, v125
  v_and_b32_e64 v125, 1, v125
  v_lshl_add_u32 v140, v125, 5, v140
  v_and_b32_e64 v125, 1, v153
  v_mul_u32_u24 v125, 0x790, v125
  v_add3_u32 v5, v140, v125, v127
  v_mul_u32_u24 v125, 0x30000, v139
  v_bfe_u32 v126, v113, 3, 2
  v_mul_u32_u24 v126, 0x180, v126
  v_lshl_add_u32 v126, v148, 4, v126
  v_add_u32_e64 v10, v125, v126
  s_sub_u32 s32, s3, 0xf40
  v_add_u32_e64 v10, s32, v10
  v_add_u32 v2, 0xf000, v150
  v_add_u32 v0, 0x10000, v118
  v_add_u32 v1, 0x20000, v118
  v_and_b32 v125, 15, v113
  v_lshlrev_b32 v125, 7, v125
  buffer_load_dwordx4 a[8:11], v203, s[64:67], s40 offen
  v_mul_u32_u24 v126, 0x18000, v149
  s_sub_u32 s32, s3, 64
  v_add3_u32 v248, v125, v126, s32
  v_mul_u32_u24 v125, 0x5555, v117
  v_and_b32 v126, 2, v113
  v_lshlrev_b32 v126, 15, v126
  v_sub_u32 v125, v125, v126
  v_add_u32 v250, 0x3e9a0000, v125
  s_add_u32 s32, s14, 0x16000
  v_add_u32 v253, s32, v118
  v_bfe_u32 v125, v122, 2, 2
  v_xor_b32 v125, v125, v139
  v_lshl_add_u32 v125, v125, 4, s32
  v_mul_u32_u24 v126, 0xc0, v122
  v_add_u32_e64 v251, v125, v126
  v_xor_b32 v252, 32, v251
  s_add_u32 s30, s15, 32
  s_add_u32 s31, s15, 0x4100
  s_sub_u32 s28, s59, 0x60000
  s_add_u32 s33, s15, 0x8200
  s_mov_b32 s23, 0x60000
  s_mov_b32 s26, 6
  buffer_load_dwordx4 a[12:15], v203, s[64:67], s40 offen offset:128
  buffer_load_dwordx4 a[16:19], v203, s[64:67], s41 offen
  buffer_load_dwordx4 a[20:23], v203, s[64:67], s41 offen offset:128
  s_waitcnt vmcnt(25)
  v_lshl_or_b32 v129, v129, 16, v129
  v_and_b32 v16, v56, v129
  v_and_b32 v17, v57, v129
  v_and_b32 v18, v58, v129
  v_and_b32 v19, v59, v129
  ds_write_b128 v142, v[16:19] offset:49920
  s_waitcnt vmcnt(24)
  v_lshl_or_b32 v130, v130, 16, v130
  v_and_b32 v20, v56, v130
  v_and_b32 v21, v57, v130
  v_and_b32 v22, v58, v130
  v_and_b32_e64 v23, v59, v130
  ds_write_b128 v143, v[20:23] offset:53120
  s_waitcnt vmcnt(23)
  v_and_b32 v24, v146, v131
  v_and_b32_e64 v25, v147, v131
  ds_write_b64 v145, v[24:25] offset:54784
  s_waitcnt vmcnt(22)
  v_and_b32 v26, v146, v132
  v_and_b32_e64 v27, v147, v132
  ds_write_b64 v145, v[26:27] offset:56832
  s_waitcnt vmcnt(21)
  v_and_b32 v28, v146, v133
  v_and_b32_e64 v29, v147, v133
  ds_write_b64 v145, v[28:29] offset:58880
  s_waitcnt vmcnt(20)
  v_lshlrev_b32 v137, 16, v137
  s_waitcnt vmcnt(19)
  v_lshlrev_b32 v138, 16, v138
  v_mul_f32 v138, v137, v138
  s_waitcnt vmcnt(18)
  v_lshlrev_b32 v134, 16, v134
  s_waitcnt vmcnt(17)
  v_lshlrev_b32 v135, 16, v135
  s_waitcnt vmcnt(16)
  v_lshlrev_b32 v136, 16, v136
  v_xor_b32 v141, 16, v141
  v_mul_f32 v134, 4.0, v134
  v_mul_f32 v135, 4.0, v135
  v_mul_f32 v136, 4.0, v136
  v_lshrrev_b32 v134, v141, v134
  v_lshrrev_b32 v135, v141, v135
  v_lshrrev_b32 v136, v141, v136
  ds_write_b32 v144, v138 offset:61440
  s_waitcnt lgkmcnt(0)
  s_barrier
  ds_read_b128 a[96:99], v3
  ds_read2_b64 a[100:103], v11 offset0:0 offset1:8
  ds_read_b128 a[104:107], v3 offset:400
  ds_read2_b64 a[108:111], v11 offset0:32 offset1:40
  ds_read_b128 a[112:115], v3 offset:800
  ds_read2_b64 a[116:119], v11 offset0:64 offset1:72
  v_and_b32 v125, v216, v134
  v_and_b32 v126, v217, v134
  buffer_load_dwordx4 a[24:27], v203, s[64:67], s42 offen
  v_and_b32 v127, v218, v134
  v_and_b32 v140, v219, v134
  v_accvgpr_write_b32 a192, v125
  v_accvgpr_write_b32 a193, v126
  v_accvgpr_write_b32 a194, v127
  v_accvgpr_write_b32 a195, v140
  v_and_b32 v125, v220, v134
  v_and_b32 v126, v221, v134
  v_and_b32_e64 v127, v222, v134
  buffer_load_dwordx4 a[28:31], v203, s[64:67], s42 offen offset:128
  s_add_u32 s42, s42, 0x1800
  v_and_b32_e64 v140, v223, v134
  ds_read_b128 a[120:123], v3 offset:1200
  ds_read2_b64 a[124:127], v11 offset0:96 offset1:104
  ds_read_b128 a[128:131], v3 offset:1600
  ds_read2_b64 a[132:135], v11 offset0:128 offset1:136
  ds_read_b128 a[136:139], v3 offset:2000
  ds_read2_b64 a[140:143], v11 offset0:160 offset1:168
  v_accvgpr_write_b32 a196, v125
  v_accvgpr_write_b32 a197, v126
  buffer_load_dwordx4 a[32:35], v203, s[64:67], s42 offen
  v_accvgpr_write_b32 a198, v127
  v_accvgpr_write_b32 a199, v140
  v_and_b32 v125, v216, v135
  v_and_b32 v126, v217, v135
  v_and_b32 v127, v218, v135
  v_and_b32 v140, v219, v135
  v_accvgpr_write_b32 a200, v125
  v_accvgpr_write_b32 a201, v126
  v_accvgpr_write_b32 a202, v127
  buffer_load_dwordx4 a[36:39], v203, s[64:67], s42 offen offset:128
  s_add_u32 s42, s42, 0x1800
  v_accvgpr_write_b32 a203, v140
  ds_read_b128 a[144:147], v3 offset:2400
  ds_read2_b64 a[148:151], v11 offset0:192 offset1:200
  ds_read_b128 a[152:155], v3 offset:2800
  ds_read2_b64 a[156:159], v11 offset0:224 offset1:232
  ds_read_b128 a[160:163], v3 offset:3200
  ds_read2_b64 a[240:243], v205 offset0:0 offset1:8
  v_and_b32 v125, v220, v135
  v_and_b32 v126, v221, v135
  buffer_load_dwordx4 a[40:43], v203, s[64:67], s42 offen
  v_and_b32 v127, v222, v135
  v_and_b32 v140, v223, v135
  v_accvgpr_write_b32 a204, v125
  v_accvgpr_write_b32 a205, v126
  v_accvgpr_write_b32 a206, v127
  v_accvgpr_write_b32 a207, v140
  v_and_b32 v125, v216, v136
  v_and_b32 v126, v217, v136
  v_and_b32_e64 v127, v218, v136
  buffer_load_dwordx4 a[44:47], v203, s[64:67], s42 offen offset:128
  s_add_u32 s42, s42, 0x1800
  v_and_b32_e64 v140, v219, v136
  ds_read_b128 a[164:167], v3 offset:3600
  ds_read2_b64 a[244:247], v205 offset0:32 offset1:40
  ds_read_b128 a[168:171], v3 offset:4000
  ds_read2_b64 a[248:251], v205 offset0:64 offset1:72
  ds_read_b128 a[172:175], v3 offset:4400
  ds_read2_b64 a[252:255], v205 offset0:96 offset1:104
  v_accvgpr_write_b32 a208, v125
  v_accvgpr_write_b32 a209, v126
  buffer_load_dwordx4 a[48:51], v203, s[64:67], s42 offen
  v_accvgpr_write_b32 a210, v127
  v_accvgpr_write_b32 a211, v140
  v_and_b32 v125, v220, v136
  v_and_b32 v126, v221, v136
  v_and_b32_e64 v127, v222, v136
  v_and_b32_e64 v140, v223, v136
  v_accvgpr_write_b32 a212, v125
  v_accvgpr_write_b32 a213, v126
  v_accvgpr_write_b32 a214, v127
  buffer_load_dwordx4 a[52:55], v203, s[64:67], s42 offen offset:128
  s_add_u32 s42, s42, 0x1800
  v_accvgpr_write_b32 a215, v140
  s_waitcnt vmcnt(19)
  v_mfma_f32_32x32x16_bf16 v[16:31], a[72:75], v[184:187], 0
  buffer_load_dwordx4 a[56:59], v203, s[64:67], s42 offen
  s_waitcnt vmcnt(19)
  v_mfma_f32_32x32x16_bf16 v[16:31], a[76:79], v[188:191], v[16:31]
  s_waitcnt vmcnt(18)
  v_mfma_f32_32x32x16_bf16 v[32:47], a[80:83], v[184:187], 0
  s_nop 0
  buffer_load_dwordx4 a[60:63], v203, s[64:67], s42 offen offset:128
  s_add_u32 s42, s42, 0x1800
  s_waitcnt vmcnt(15)
  v_mfma_f32_32x32x16_bf16 v[48:63], a[0:3], v[224:227], v[16:31]
  s_nop 0
  buffer_load_dwordx4 a[64:67], v203, s[64:67], s42 offen
  v_mfma_f32_32x32x16_bf16 v[32:47], a[84:87], v[188:191], v[32:47]
  s_waitcnt vmcnt(15)
  v_mfma_f32_32x32x16_bf16 v[48:63], a[4:7], v[228:231], v[48:63]
  buffer_load_dwordx4 a[68:71], v203, s[64:67], s42 offen offset:128
  s_waitcnt vmcnt(15)
  v_mfma_f32_32x32x16_bf16 v[160:175], a[8:11], v[224:227], v[16:31]
  s_add_u32 m0, s15, 0x8200
  s_nop 0
  buffer_load_dwordx4 v6, s[4:7], s49 offen lds
  s_waitcnt vmcnt(15)
  v_mfma_f32_32x32x16_bf16 v[160:175], a[12:15], v[228:231], v[160:175]
  s_nop 0
  buffer_load_dwordx4 v7, s[4:7], s49 offen offset:1024 lds
  s_nop 2
  v_cvt_pk_bf16_f32 v64, v48, v52
  v_cvt_pk_bf16_f32 v65, v56, v60
  v_cvt_pk_bf16_f32 v68, v49, v53
  v_cvt_pk_bf16_f32 v69, v57, v61
  v_max3_f32 v180, |v48|, |v52|, |v56|
  v_max_f32_e64 v180, |v60|, v180
  v_max3_f32 v180, |v49|, |v53|, v180
  v_max3_f32 v180, |v57|, |v61|, v180
  s_waitcnt vmcnt(15)
  v_mfma_f32_32x32x16_bf16 v[96:111], a[16:19], v[224:227], v[16:31]
  s_nop 0
  buffer_load_dwordx4 v8, s[4:7], s49 offen offset:2048 lds
  v_cvt_pk_bf16_f32 v72, v50, v54
  v_cvt_pk_bf16_f32 v73, v58, v62
  v_cvt_pk_bf16_f32 v76, v51, v55
  v_cvt_pk_bf16_f32 v77, v59, v63
  v_max3_f32 v180, |v50|, |v54|, v180
  v_max3_f32 v180, |v58|, |v62|, v180
  v_max3_f32 v180, |v51|, |v55|, v180
  v_max3_f32 v180, |v59|, |v63|, v180
  s_waitcnt vmcnt(15)
  v_mfma_f32_32x32x16_bf16 v[96:111], a[20:23], v[228:231], v[96:111]
  s_nop 0
  buffer_load_dwordx4 v9, s[4:7], s49 offen offset:3072 lds
  v_cvt_pk_bf16_f32 v66, v160, v164
  v_cvt_pk_bf16_f32 v67, v168, v172
  v_cvt_pk_bf16_f32 v70, v161, v165
  v_cvt_pk_bf16_f32 v71, v169, v173
  v_max3_f32 v180, |v160|, |v164|, v180
  v_max3_f32 v180, |v168|, |v172|, v180
  v_max3_f32 v180, |v161|, |v165|, v180
  v_max3_f32 v180, |v169|, |v173|, v180
  ds_write_b128 v195, v[64:67]
  s_waitcnt vmcnt(15)
  s_nop 0
  v_mfma_f32_32x32x16_bf16 v[48:63], a[24:27], v[224:227], v[32:47]
  s_add_u32 m0, s15, 0
  s_nop 0
  buffer_load_dwordx4 v198, s[4:7], 0 offen lds
  ds_write_b128 v195, v[68:71] offset:6144
  v_cvt_pk_bf16_f32 v74, v162, v166
  v_cvt_pk_bf16_f32 v75, v170, v174
  v_cvt_pk_bf16_f32 v78, v163, v167
  v_cvt_pk_bf16_f32 v79, v171, v175
  v_max3_f32 v180, |v162|, |v166|, v180
  v_max3_f32 v180, |v170|, |v174|, v180
  v_max3_f32 v180, |v163|, |v167|, v180
  v_max3_f32 v180, |v171|, |v175|, v180
  s_waitcnt vmcnt(15)
  v_mfma_f32_32x32x16_bf16 v[48:63], a[28:31], v[228:231], v[48:63]
  s_add_u32 m0, s15, 0x400
  s_nop 0
  buffer_load_dwordx4 v199, s[4:7], 0 offen lds
  ds_write_b128 v195, v[72:75] offset:12288
  v_cvt_pk_bf16_f32 v80, v96, v100
  v_cvt_pk_bf16_f32 v81, v104, v108
  v_cvt_pk_bf16_f32 v84, v97, v101
  v_cvt_pk_bf16_f32 v85, v105, v109
  v_max3_f32 v180, |v96|, |v100|, v180
  v_max3_f32 v180, |v104|, |v108|, v180
  v_max3_f32 v180, |v97|, |v101|, v180
  v_max3_f32 v180, |v105|, |v109|, v180
  s_waitcnt vmcnt(15)
  v_mfma_f32_32x32x16_bf16 v[160:175], a[32:35], v[224:227], v[32:47]
  s_add_u32 m0, s15, 0x800
  s_nop 0
  buffer_load_dwordx4 v200, s[4:7], 0 offen lds
  ds_write_b128 v195, v[76:79] offset:18432
  v_cvt_pk_bf16_f32 v88, v98, v102
  v_cvt_pk_bf16_f32 v89, v106, v110
  v_cvt_pk_bf16_f32 v92, v99, v103
  v_cvt_pk_bf16_f32 v93, v107, v111
  v_max3_f32 v180, |v98|, |v102|, v180
  v_max3_f32 v180, |v106|, |v110|, v180
  v_max3_f32 v180, |v99|, |v103|, v180
  v_max3_f32 v180, |v107|, |v111|, v180
  s_waitcnt vmcnt(15)
  v_mfma_f32_32x32x16_bf16 v[160:175], a[36:39], v[228:231], v[160:175]
  s_add_u32 m0, s15, 0xc00
  s_nop 0
  buffer_load_dwordx4 v201, s[4:7], 0 offen lds
  ds_write_b64 v196, v[80:81]
  ds_write_b64 v196, v[84:85] offset:6144
  v_cvt_pk_bf16_f32 v64, v48, v52
  v_cvt_pk_bf16_f32 v65, v56, v60
  v_cvt_pk_bf16_f32 v68, v49, v53
  v_cvt_pk_bf16_f32 v69, v57, v61
  v_max3_f32 v176, |v48|, |v52|, |v56|
  v_max_f32_e64 v176, |v60|, v176
  v_max3_f32 v177, |v49|, |v53|, |v57|
  v_max_f32_e64 v177, |v61|, v177
  s_waitcnt vmcnt(15)
  v_mfma_f32_32x32x16_bf16 v[96:111], a[40:43], v[224:227], v[32:47]
  s_add_u32 m0, s14, 0x22000
  s_nop 0
  buffer_load_dwordx4 v254, s[72:75], s57 offen lds
  ds_write_b64 v196, v[88:89] offset:12288
  ds_write_b64 v196, v[92:93] offset:18432
  v_cvt_pk_bf16_f32 v72, v50, v54
  v_cvt_pk_bf16_f32 v73, v58, v62
  v_cvt_pk_bf16_f32 v76, v51, v55
  v_cvt_pk_bf16_f32 v77, v59, v63
  v_max3_f32 v178, |v50|, |v54|, |v58|
  v_max_f32_e64 v178, |v62|, v178
  v_max3_f32 v179, |v51|, |v55|, |v59|
  v_max_f32_e64 v179, |v63|, v179
  s_waitcnt vmcnt(15)
  v_mfma_f32_32x32x16_bf16 v[96:111], a[44:47], v[228:231], v[96:111]
  s_nop 0
  buffer_load_dwordx4 v255, s[72:75], s57 offen offset:1024 lds
  v_cvt_pk_bf16_f32 v66, v160, v164
  v_cvt_pk_bf16_f32 v67, v168, v172
  v_cvt_pk_bf16_f32 v70, v161, v165
  v_cvt_pk_bf16_f32 v71, v169, v173
  v_max3_f32 v176, |v160|, |v164|, v176
  v_max3_f32 v176, |v168|, |v172|, v176
  v_max3_f32 v177, |v161|, |v165|, v177
  v_max3_f32 v177, |v169|, |v173|, v177
  ds_write_b128 v197, v[64:67]
  s_waitcnt vmcnt(15)
  v_mfma_f32_32x32x16_bf16 v[48:63], a[48:51], v[224:227], v[32:47]
  s_nop 0
  buffer_load_dwordx4 v244, s[72:75], s57 offen offset:2048 lds
  ds_write_b128 v197, v[68:71] offset:6144
  v_cvt_pk_bf16_f32 v74, v162, v166
  v_cvt_pk_bf16_f32 v75, v170, v174
  v_cvt_pk_bf16_f32 v78, v163, v167
  v_cvt_pk_bf16_f32 v79, v171, v175
  v_max3_f32 v178, |v162|, |v166|, v178
  v_max3_f32 v178, |v170|, |v174|, v178
  v_max3_f32 v179, |v163|, |v167|, v179
  v_max3_f32 v179, |v171|, |v175|, v179
  s_waitcnt vmcnt(15)
  v_mfma_f32_32x32x16_bf16 v[48:63], a[52:55], v[228:231], v[48:63]
  s_add_u32 m0, s14, 0x22c00
  s_nop 0
  buffer_load_dwordx4 v254, s[72:75], s58 offen lds
  ds_write_b128 v197, v[72:75] offset:12288
  v_cvt_pk_bf16_f32 v80, v96, v100
  v_cvt_pk_bf16_f32 v81, v104, v108
  v_cvt_pk_bf16_f32 v84, v97, v101
  v_cvt_pk_bf16_f32 v85, v105, v109
  v_max3_f32 v176, |v96|, |v100|, v176
  v_max3_f32 v176, |v104|, |v108|, v176
  v_max3_f32 v177, |v97|, |v101|, v177
  v_max3_f32 v177, |v105|, |v109|, v177
  s_waitcnt vmcnt(15)
  v_mfma_f32_32x32x16_bf16 v[160:175], a[56:59], v[224:227], v[32:47]
  s_nop 0
  buffer_load_dwordx4 v255, s[72:75], s58 offen offset:1024 lds
  ds_write_b128 v197, v[76:79] offset:18432
  v_cvt_pk_bf16_f32 v88, v98, v102
  v_cvt_pk_bf16_f32 v89, v106, v110
  v_cvt_pk_bf16_f32 v92, v99, v103
  v_cvt_pk_bf16_f32 v93, v107, v111
  v_max3_f32 v178, |v98|, |v102|, v178
  v_max3_f32 v178, |v106|, |v110|, v178
  v_max3_f32 v179, |v99|, |v103|, v179
  v_max3_f32 v179, |v107|, |v111|, v179
  v_mfma_f32_32x32x16_bf16 v[96:111], a[88:91], v[224:227], v[32:47]
  s_waitcnt vmcnt(15)
  v_mfma_f32_32x32x16_bf16 v[160:175], a[60:63], v[228:231], v[160:175]
  s_nop 0
  buffer_load_dwordx4 v244, s[72:75], s58 offen offset:2048 lds
  v_cvt_pk_bf16_f32 v82, v48, v52
  v_cvt_pk_bf16_f32 v83, v56, v60
  v_cvt_pk_bf16_f32 v86, v49, v53
  v_cvt_pk_bf16_f32 v87, v57, v61
  v_max3_f32 v176, |v48|, |v52|, v176
  v_max3_f32 v176, |v56|, |v60|, v176
  v_max3_f32 v177, |v49|, |v53|, v177
  v_max3_f32 v177, |v57|, |v61|, v177
  ds_write_b128 v197, v[80:83] offset:1024
  v_mfma_f32_32x32x16_bf16 v[96:111], a[92:95], v[228:231], v[96:111]
  s_waitcnt vmcnt(15)
  v_mfma_f32_32x32x16_bf16 v[96:111], a[64:67], v[224:227], v[96:111]
  s_nop 0
  ds_write_b128 v197, v[84:87] offset:7168
  v_cvt_pk_bf16_f32 v90, v50, v54
  v_cvt_pk_bf16_f32 v91, v58, v62
  v_cvt_pk_bf16_f32 v94, v51, v55
  v_cvt_pk_bf16_f32 v95, v59, v63
  v_max3_f32 v178, |v50|, |v54|, v178
  v_max3_f32 v178, |v58|, |v62|, v178
  v_max3_f32 v179, |v51|, |v55|, v179
  v_max3_f32 v179, |v59|, |v63|, v179
  s_waitcnt vmcnt(14)
  v_mfma_f32_32x32x16_bf16 v[96:111], a[68:71], v[228:231], v[96:111]
  s_nop 0
  ds_write_b128 v197, v[88:91] offset:13312
  v_cvt_pk_bf16_f32 v64, v160, v164
  v_cvt_pk_bf16_f32 v65, v168, v172
  v_cvt_pk_bf16_f32 v68, v161, v165
  v_cvt_pk_bf16_f32 v69, v169, v173
  v_max3_f32 v176, |v160|, |v164|, v176
  v_max3_f32 v176, |v168|, |v172|, v176
  v_max3_f32 v177, |v161|, |v165|, v177
  v_max3_f32 v177, |v169|, |v173|, v177
  ds_write_b128 v197, v[92:95] offset:19456
  v_cvt_pk_bf16_f32 v72, v162, v166
  v_cvt_pk_bf16_f32 v73, v170, v174
  v_cvt_pk_bf16_f32 v76, v163, v167
  v_cvt_pk_bf16_f32 v77, v171, v175
  v_max3_f32 v178, |v162|, |v166|, v178
  v_max3_f32 v178, |v170|, |v174|, v178
  v_max3_f32 v179, |v163|, |v167|, v179
  v_max3_f32 v179, |v171|, |v175|, v179
  v_cvt_pk_bf16_f32 v66, v96, v100
  v_cvt_pk_bf16_f32 v67, v104, v108
  v_cvt_pk_bf16_f32 v70, v97, v101
  v_cvt_pk_bf16_f32 v71, v105, v109
  v_max3_f32 v176, |v96|, |v100|, v176
  v_max3_f32 v176, |v104|, |v108|, v176
  v_max3_f32 v177, |v97|, |v101|, v177
  v_max3_f32 v177, |v105|, |v109|, v177
  ds_write_b128 v197, v[64:67] offset:2048
  ds_write_b128 v197, v[68:71] offset:8192
  v_cvt_pk_bf16_f32 v74, v98, v102
  v_cvt_pk_bf16_f32 v75, v106, v110
  v_cvt_pk_bf16_f32 v78, v99, v103
  v_cvt_pk_bf16_f32 v79, v107, v111
  v_max3_f32 v178, |v98|, |v102|, v178
  v_max3_f32 v178, |v106|, |v110|, v178
  v_max3_f32 v179, |v99|, |v103|, v179
  v_max3_f32 v179, |v107|, |v111|, v179
  ds_write_b128 v197, v[72:75] offset:14336
  ds_write_b128 v197, v[76:79] offset:20480
  s_waitcnt lgkmcnt(0)
  s_barrier
  v_max3_f32 v180, v180, v176, v177
  v_min3_f32 v176, v176, v177, v178
  v_max3_f32 v180, v180, v178, v179
  v_min_f32_e64 v176, v176, v179
  v_cmp_le_u32 vcc, 0x43800000, v180
  s_nop 0
  s_cmp_lg_u64 vcc, 0
  s_cselect_b32 s3, 1, 0
  v_cmp_gt_u32 vcc, 0x3a000000, v176
  s_nop 0
  s_cmp_lg_u64 vcc, 0
  s_cselect_b32 s3, 1, s3
  ds_read_b128 a[0:3], v0 offset:24576
  ds_read_b128 a[4:7], v0 offset:25600
  ds_read_b128 a[8:11], v0 offset:26624
  ds_read_b128 a[12:15], v0 offset:27648
  ds_read_b128 a[16:19], v0 offset:28672
  ds_read_b128 a[20:23], v0 offset:29696
  ds_read_b128 a[24:27], v0 offset:30720
  ds_read_b128 a[28:31], v0 offset:31744
  ds_read_b128 a[32:35], v0 offset:32768
  ds_read_b128 a[36:39], v0 offset:33792
  ds_read_b128 a[40:43], v0 offset:34816
  ds_read_b128 a[44:47], v0 offset:35840
  ds_read_b128 a[48:51], v0 offset:36864
  ds_read_b128 a[52:55], v0 offset:37888
  ds_read_b128 a[56:59], v0 offset:38912
  ds_read_b128 a[60:63], v0 offset:39936
  ds_read_b128 a[64:67], v0 offset:40960
  ds_read_b128 a[68:71], v0 offset:41984
  ds_read_b128 a[72:75], v0 offset:43008
  ds_read_b128 a[76:79], v0 offset:44032
  ds_read_b128 a[80:83], v0 offset:45056
  ds_read_b128 a[84:87], v0 offset:46080
  ds_read_b128 a[88:91], v0 offset:47104
  ds_read_b128 a[92:95], v0 offset:48128
  s_waitcnt vmcnt(6)
  s_nop 0
  ds_read_b128 v[160:163], v4
  ds_read_b128 v[164:167], v4 offset:192
  ds_read_b128 v[168:171], v4 offset:384
  ds_read_b128 v[172:175], v4 offset:16
  ds_read_b128 v[176:179], v4 offset:208
  ds_read_b128 v[180:183], v4 offset:400
  ds_read_b128 v[216:219], v4 offset:32
  ds_read_b128 v[220:223], v4 offset:224
  ds_read_b128 v[224:227], v4 offset:416
  ds_read_b128 v[228:231], v4 offset:48
  ds_read_b128 v[232:235], v4 offset:240
  ds_read_b128 v[236:239], v4 offset:432
  s_waitcnt lgkmcnt(11)
  v_mfma_f32_16x16x32_bf16 v[112:115], a[96:99], v[160:163], 0
  ds_read_b128 v[160:163], v4 offset:64
  s_waitcnt lgkmcnt(9)
  v_mfma_f32_16x16x32_bf16 v[116:119], a[104:107], v[172:175], 0
  s_waitcnt lgkmcnt(0)
  ds_read_b128 v[172:175], v4 offset:80
  s_nop 0
  v_smfmac_f32_16x16x64_bf16 v[112:115], a[100:103], v[164:171], v250
  s_nop 0
  ds_read_b128 v[164:167], v4 offset:256
  ds_read_b128 v[168:171], v4 offset:448
  v_mfma_f32_16x16x32_bf16 v[120:123], a[112:115], v[216:219], 0
  s_waitcnt lgkmcnt(2)
  ds_read_b128 v[216:219], v4 offset:96
  v_smfmac_f32_16x16x64_bf16 v[116:119], a[108:111], v[176:183], v250
  ds_read_b128 v[176:179], v4 offset:272
  ds_read_b128 v[180:183], v4 offset:464
  v_mfma_f32_16x16x32_bf16 v[124:127], a[120:123], v[228:231], 0
  s_waitcnt lgkmcnt(2)
  ds_read_b128 v[228:231], v4 offset:112
  v_smfmac_f32_16x16x64_bf16 v[120:123], a[116:119], v[220:227], v250
  ds_read_b128 v[220:223], v4 offset:288
  ds_read_b128 v[224:227], v4 offset:480
  v_mfma_f32_16x16x32_bf16 v[128:131], a[128:131], v[160:163], 0
  s_waitcnt lgkmcnt(2)
  ds_read_b128 v[160:163], v4 offset:128
  v_smfmac_f32_16x16x64_bf16 v[124:127], a[124:127], v[232:239], v250
  ds_read_b128 v[232:235], v4 offset:304
  ds_read_b128 v[236:239], v4 offset:496
  v_mfma_f32_16x16x32_bf16 v[132:135], a[136:139], v[172:175], 0
  s_waitcnt lgkmcnt(2)
  ds_read_b128 v[172:175], v4 offset:144
  v_smfmac_f32_16x16x64_bf16 v[128:131], a[132:135], v[164:171], v250
  s_nop 0
  ds_read_b128 v[164:167], v4 offset:320
  ds_read_b128 v[168:171], v4 offset:512
  v_mfma_f32_16x16x32_bf16 v[136:139], a[144:147], v[216:219], 0
  s_waitcnt lgkmcnt(2)
  ds_read_b128 v[216:219], v4 offset:160
  v_smfmac_f32_16x16x64_bf16 v[132:135], a[140:143], v[176:183], v250
  ds_read_b128 v[176:179], v4 offset:336
  ds_read_b128 v[180:183], v4 offset:528
  v_mfma_f32_16x16x32_bf16 v[140:143], a[152:155], v[228:231], 0
  s_waitcnt lgkmcnt(2)
  ds_read_b128 v[228:231], v4 offset:176
  v_smfmac_f32_16x16x64_bf16 v[136:139], a[148:151], v[220:227], v250
  ds_read_b128 v[220:223], v4 offset:352
  ds_read_b128 v[224:227], v4 offset:544
  v_mfma_f32_16x16x32_bf16 v[144:147], a[160:163], v[160:163], 0
  s_waitcnt lgkmcnt(2)
  v_smfmac_f32_16x16x64_bf16 v[140:143], a[156:159], v[232:239], v250
  s_nop 0
  ds_read_b128 v[232:235], v4 offset:368
  ds_read_b128 v[236:239], v4 offset:560
  v_mfma_f32_16x16x32_bf16 v[148:151], a[164:167], v[172:175], 0
  s_nop 0
  v_smfmac_f32_16x16x64_bf16 v[144:147], a[240:243], v[164:171], v250
  s_nop 0
  v_mfma_f32_16x16x32_bf16 v[152:155], a[168:171], v[216:219], 0
  s_nop 2
  v_smfmac_f32_16x16x64_bf16 v[148:151], a[244:247], v[176:183], v250
  v_mfma_f32_16x16x32_bf16 v[156:159], a[172:175], v[228:231], 0
  s_waitcnt lgkmcnt(2)
  v_smfmac_f32_16x16x64_bf16 v[152:155], a[248:251], v[220:227], v250
  s_waitcnt lgkmcnt(0)
  s_nop 2
  v_smfmac_f32_16x16x64_bf16 v[156:159], a[252:255], v[232:239], v250
  buffer_load_dword v249, v248, s[4:7], s29 offen
  v_pk_add_f32 v[12:13], v[112:113], v[114:115]
  v_pk_mul_f32 v[14:15], v[112:113], v[112:113]
  v_pk_fma_f32 v[14:15], v[114:115], v[114:115], v[14:15]
  v_pk_add_f32 v[12:13], v[12:13], v[116:117]
  v_pk_fma_f32 v[14:15], v[116:117], v[116:117], v[14:15]
  v_pk_add_f32 v[12:13], v[12:13], v[118:119]
  v_pk_fma_f32 v[14:15], v[118:119], v[118:119], v[14:15]
  v_pk_add_f32 v[12:13], v[12:13], v[120:121]
  v_pk_fma_f32 v[14:15], v[120:121], v[120:121], v[14:15]
  v_pk_add_f32 v[12:13], v[12:13], v[122:123]
  v_pk_fma_f32 v[14:15], v[122:123], v[122:123], v[14:15]
  v_pk_add_f32 v[12:13], v[12:13], v[124:125]
  ds_read_b128 v[160:163], v0 offset:18432
  ds_read_b128 v[164:167], v0 offset:19456
  ds_read_b128 v[168:171], v0 offset:20480
  ds_read_b128 v[172:175], v0 offset:21504
  v_pk_fma_f32 v[14:15], v[124:125], v[124:125], v[14:15]
  v_pk_add_f32 v[12:13], v[12:13], v[126:127]
  v_pk_fma_f32 v[14:15], v[126:127], v[126:127], v[14:15]
  v_pk_add_f32 v[12:13], v[12:13], v[128:129]
  v_pk_fma_f32 v[14:15], v[128:129], v[128:129], v[14:15]
  v_pk_add_f32 v[12:13], v[12:13], v[130:131]
  v_pk_fma_f32 v[14:15], v[130:131], v[130:131], v[14:15]
  v_pk_add_f32 v[12:13], v[12:13], v[132:133]
  v_pk_fma_f32 v[14:15], v[132:133], v[132:133], v[14:15]
  v_pk_add_f32 v[12:13], v[12:13], v[134:135]
  v_pk_fma_f32 v[14:15], v[134:135], v[134:135], v[14:15]
  v_pk_add_f32 v[12:13], v[12:13], v[136:137]
  ds_read_b128 v[176:179], v0 offset:22528
  ds_read_b128 v[180:183], v0 offset:23552
  ds_read_b128 a[96:99], v0 offset:49152
  ds_read_b128 a[100:103], v0 offset:50176
  v_pk_fma_f32 v[14:15], v[136:137], v[136:137], v[14:15]
  v_pk_add_f32 v[12:13], v[12:13], v[138:139]
  v_pk_fma_f32 v[14:15], v[138:139], v[138:139], v[14:15]
  v_pk_add_f32 v[12:13], v[12:13], v[140:141]
  v_pk_fma_f32 v[14:15], v[140:141], v[140:141], v[14:15]
  v_pk_add_f32 v[12:13], v[12:13], v[142:143]
  v_pk_fma_f32 v[14:15], v[142:143], v[142:143], v[14:15]
  v_pk_add_f32 v[12:13], v[12:13], v[144:145]
  v_pk_fma_f32 v[14:15], v[144:145], v[144:145], v[14:15]
  v_pk_add_f32 v[12:13], v[12:13], v[146:147]
  v_pk_fma_f32 v[14:15], v[146:147], v[146:147], v[14:15]
  v_pk_add_f32 v[12:13], v[12:13], v[148:149]
  ds_read_b128 a[104:107], v0 offset:51200
  ds_read_b128 a[108:111], v0 offset:52224
  ds_read_b128 a[112:115], v0 offset:53248
  ds_read_b128 a[116:119], v0 offset:54272
  v_pk_fma_f32 v[14:15], v[148:149], v[148:149], v[14:15]
  v_pk_add_f32 v[12:13], v[12:13], v[150:151]
  v_pk_fma_f32 v[14:15], v[150:151], v[150:151], v[14:15]
  v_pk_add_f32 v[12:13], v[12:13], v[152:153]
  v_pk_fma_f32 v[14:15], v[152:153], v[152:153], v[14:15]
  v_pk_add_f32 v[12:13], v[12:13], v[154:155]
  v_pk_fma_f32 v[14:15], v[154:155], v[154:155], v[14:15]
  v_pk_add_f32 v[12:13], v[12:13], v[156:157]
  v_pk_fma_f32 v[14:15], v[156:157], v[156:157], v[14:15]
  v_pk_add_f32 v[12:13], v[12:13], v[158:159]
  v_pk_fma_f32 v[14:15], v[158:159], v[158:159], v[14:15]
  v_add_f32_e64 v12, v12, v13
  ds_read_b128 a[120:123], v0 offset:55296
  ds_read_b128 a[124:127], v0 offset:56320
  ds_read_b128 a[128:131], v0 offset:57344
  ds_read_b128 a[132:135], v0 offset:58368
  v_add_f32 v14, v14, v15
  s_nop 1
  v_permlane32_swap_b32 v12, v14
  v_add_f32 v12, v12, v14
  v_mov_b32 v14, v12
  s_nop 1
  v_permlane32_swap_b32 v12, v14
  v_mul_f32 v12, s24, v12
  v_mul_f32_e64 v13, s24, v14
  v_fma_f32 v13, -v12, v12, v13
  v_max_f32 v13, 0, v13
  v_add_f32 v13, s25, v13
  v_rsq_f32 v13, v13
  s_nop 0
  v_mul_f32_e64 v14, s22, v13
  ds_read_b128 a[136:139], v0 offset:59392
  ds_read_b128 a[140:143], v0 offset:60416
  ds_read_b128 a[144:147], v0 offset:61440
  ds_read_b128 a[148:151], v0 offset:62464
  v_mul_f32_e64 v12, -v12, v14
  v_pk_fma_f32 v[112:113], v[112:113], v[14:15], v[12:13] op_sel_hi:[1,0,0]
  v_pk_fma_f32 v[114:115], v[114:115], v[14:15], v[12:13] op_sel_hi:[1,0,0]
  v_pk_fma_f32 v[116:117], v[116:117], v[14:15], v[12:13] op_sel_hi:[1,0,0]
  v_pk_fma_f32 v[118:119], v[118:119], v[14:15], v[12:13] op_sel_hi:[1,0,0]
  v_pk_fma_f32 v[120:121], v[120:121], v[14:15], v[12:13] op_sel_hi:[1,0,0]
  v_pk_fma_f32 v[122:123], v[122:123], v[14:15], v[12:13] op_sel_hi:[1,0,0]
  v_pk_fma_f32 v[124:125], v[124:125], v[14:15], v[12:13] op_sel_hi:[1,0,0]
  v_pk_fma_f32 v[126:127], v[126:127], v[14:15], v[12:13] op_sel_hi:[1,0,0]
  v_pk_fma_f32 v[128:129], v[128:129], v[14:15], v[12:13] op_sel_hi:[1,0,0]
  v_pk_fma_f32 v[130:131], v[130:131], v[14:15], v[12:13] op_sel_hi:[1,0,0]
  v_pk_fma_f32 v[132:133], v[132:133], v[14:15], v[12:13] op_sel_hi:[1,0,0]
  ds_read_b128 a[152:155], v0 offset:63488
  ds_read_b128 a[156:159], v0 offset:64512
  ds_read_b128 a[160:163], v1
  ds_read_b128 a[164:167], v1 offset:1024
  v_pk_fma_f32 v[134:135], v[134:135], v[14:15], v[12:13] op_sel_hi:[1,0,0]
  v_pk_fma_f32 v[136:137], v[136:137], v[14:15], v[12:13] op_sel_hi:[1,0,0]
  v_pk_fma_f32 v[138:139], v[138:139], v[14:15], v[12:13] op_sel_hi:[1,0,0]
  v_pk_fma_f32 v[140:141], v[140:141], v[14:15], v[12:13] op_sel_hi:[1,0,0]
  v_pk_fma_f32 v[142:143], v[142:143], v[14:15], v[12:13] op_sel_hi:[1,0,0]
  v_pk_fma_f32 v[144:145], v[144:145], v[14:15], v[12:13] op_sel_hi:[1,0,0]
  v_pk_fma_f32 v[146:147], v[146:147], v[14:15], v[12:13] op_sel_hi:[1,0,0]
  v_pk_fma_f32 v[148:149], v[148:149], v[14:15], v[12:13] op_sel_hi:[1,0,0]
  v_pk_fma_f32 v[150:151], v[150:151], v[14:15], v[12:13] op_sel_hi:[1,0,0]
  v_pk_fma_f32 v[152:153], v[152:153], v[14:15], v[12:13] op_sel_hi:[1,0,0]
  v_pk_fma_f32 v[154:155], v[154:155], v[14:15], v[12:13] op_sel_hi:[1,0,0]
  v_pk_fma_f32 v[156:157], v[156:157], v[14:15], v[12:13] op_sel_hi:[1,0,0]
  ds_read_b128 a[168:171], v1 offset:2048
  ds_read_b128 a[172:175], v1 offset:3072
  ds_read_b128 a[176:179], v1 offset:4096
  ds_read_b128 a[180:183], v1 offset:5120
  v_pk_fma_f32 v[158:159], v[158:159], v[14:15], v[12:13] op_sel_hi:[1,0,0]
  v_cndmask_b32 v159, v159, v250, s[12:13]
  v_cvt_pk_bf16_f32 v216, v112, v113
  v_cvt_pk_bf16_f32 v217, v114, v115
  v_cvt_pk_bf16_f32 v218, v116, v117
  v_cvt_pk_bf16_f32 v219, v118, v119
  v_cvt_pk_bf16_f32 v220, v120, v121
  v_cvt_pk_bf16_f32 v221, v122, v123
  v_cvt_pk_bf16_f32 v222, v124, v125
  v_cvt_pk_bf16_f32 v223, v126, v127
  v_cvt_pk_bf16_f32 v224, v128, v129
  v_cvt_pk_bf16_f32 v225, v130, v131
  ds_read_b128 a[184:187], v1 offset:6144
  ds_read_b128 a[188:191], v1 offset:7168
  v_cvt_pk_bf16_f32 v226, v132, v133
  v_cvt_pk_bf16_f32 v227, v134, v135
  v_cvt_pk_bf16_f32 v228, v136, v137
  v_cvt_pk_bf16_f32 v229, v138, v139
  v_cvt_pk_bf16_f32 v230, v140, v141
  v_cvt_pk_bf16_f32 v231, v142, v143
  v_cvt_pk_bf16_f32 v232, v144, v145
  v_cvt_pk_bf16_f32 v233, v146, v147
  v_cvt_pk_bf16_f32 v234, v148, v149
  v_cvt_pk_bf16_f32 v235, v150, v151
  v_cvt_pk_bf16_f32 v236, v152, v153
  v_cvt_pk_bf16_f32 v237, v154, v155
  v_cvt_pk_bf16_f32 v238, v156, v157
  v_cvt_pk_bf16_f32 v239, v158, v159
  s_waitcnt lgkmcnt(15)
  v_mfma_f32_32x32x16_bf16 v[16:31], v[160:163], v[216:219], 0
  s_waitcnt vmcnt(1)
  ds_read_b128 a[216:219], v251 offset:49152
  ds_read_b128 v[112:115], v5
  ds_read_b128 v[116:119], v5 offset:32
  v_mfma_f32_32x32x16_bf16 v[16:31], v[164:167], v[220:223], v[16:31]
  s_mul_i32 s66, s27, 0x1420
  ds_read_b128 v[136:139], v2
  ds_read_b128 v[140:143], v2 offset:32
  ds_read_b128 v[144:147], v2 offset:64
  v_mfma_f32_32x32x16_bf16 v[16:31], v[168:171], v[224:227], v[16:31]
  s_add_u32 s66, s66, 0xf780
  ds_read_b128 v[148:151], v2 offset:96
  ds_read_b128 a[220:223], v252 offset:49152
  ds_read_b128 v[120:123], v5 offset:64
  v_mfma_f32_32x32x16_bf16 v[16:31], v[172:175], v[228:231], v[16:31]
  s_sub_u32 s15, s66, 0x10000
  ds_read_b128 v[124:127], v5 offset:96
  ds_read_b128 v[152:155], v2 offset:128
  ds_read_b128 v[156:159], v2 offset:160
  v_mfma_f32_32x32x16_bf16 v[16:31], v[176:179], v[232:235], v[16:31]
  s_add_u32 s59, s28, 0x18000
  ds_read_b128 v[160:163], v2 offset:192
  ds_read_b128 v[164:167], v2 offset:224
  ds_read_b128 a[224:227], v251 offset:49216
  s_nop 0
  v_mfma_f32_32x32x16_bf16 v[16:31], v[180:183], v[236:239], v[16:31]
  s_waitcnt lgkmcnt(12)
  ds_read_b128 a[228:231], v252 offset:49216
  ds_read_b128 a[232:235], v251 offset:49280
  ds_read_b128 a[236:239], v252 offset:49280
  s_nop 2
  v_mfma_f32_32x32x16_bf16 v[64:79], a[216:219], a[192:195], 0
  s_waitcnt lgkmcnt(11)
  ds_read_b128 v[128:131], v5 offset:128
  ds_read_b128 v[132:135], v5 offset:160
  ds_read_b128 v[168:171], v2 offset:256
  v_subrev_u32 v14, 0x4100, v5
  v_add_u32 v5, 0x8200, v5
  v_cvt_pk_f16_f32 v48, v16, v17
  v_smfmac_f32_32x32x32_bf16 v[136:151], v[240:243], v[112:119], v250
  s_waitcnt lgkmcnt(12)
  v_cvt_pk_f16_f32 v49, v18, v19
  v_cvt_pk_f16_f32 v50, v20, v21
  v_cvt_pk_f16_f32 v51, v22, v23
  v_cvt_pk_f16_f32 v52, v24, v25
  v_cvt_pk_f16_f32 v53, v26, v27
  v_mfma_f32_32x32x16_bf16 v[64:79], a[220:223], a[196:199], v[64:79]
  s_waitcnt lgkmcnt(7)
  ds_read_b128 v[172:175], v2 offset:288
  ds_read_b128 v[176:179], v2 offset:320
  ds_read_b128 v[180:183], v2 offset:352
  v_cvt_pk_f16_f32 v54, v28, v29
  v_cvt_pk_f16_f32 v55, v30, v31
  v_pk_fma_f16 v56, v48, v48, s20 op_sel_hi:[1,1,0] neg_lo:[1,0,0] neg_hi:[1,0,0] clamp
  v_smfmac_f32_32x32x32_bf16 v[152:167], v[240:243], v[120:127], v250
  s_waitcnt lgkmcnt(9)
  v_pk_fma_f16 v57, v49, v49, s20 op_sel_hi:[1,1,0] neg_lo:[1,0,0] neg_hi:[1,0,0] clamp
  v_pk_fma_f16 v58, v50, v50, s20 op_sel_hi:[1,1,0] neg_lo:[1,0,0] neg_hi:[1,0,0] clamp
  v_pk_fma_f16 v59, v51, v51, s20 op_sel_hi:[1,1,0] neg_lo:[1,0,0] neg_hi:[1,0,0] clamp
  v_pk_fma_f16 v184, v56, v56, s20 op_sel:[0,0,1]
  v_pk_fma_f16 v185, v57, v57, s20 op_sel:[0,0,1]
  v_mfma_f32_32x32x16_bf16 v[80:95], a[224:227], a[200:203], 0
  s_waitcnt lgkmcnt(6)
  v_cvt_pk_f16_f32 v64, v64, v65
  v_cvt_pk_f16_f32 v65, v66, v67
  v_cvt_pk_f16_f32 v66, v68, v69
  v_cvt_pk_f16_f32 v67, v70, v71
  v_pk_mul_f16 v64, v64, s21 op_sel:[0,1]
  v_pk_mul_f16 v65, v65, s21 op_sel:[0,1]
  v_mfma_f32_32x32x16_bf16 v[80:95], a[228:231], a[204:207], v[80:95]
  s_add_u32 m0, s14, 0x16000
  v_pk_mul_f16 v66, v66, s21 op_sel:[0,1]
  v_pk_mul_f16 v67, v67, s21 op_sel:[0,1]
  v_cvt_pk_f16_f32 v68, v72, v73
  v_cvt_pk_f16_f32 v69, v74, v75
  v_cvt_pk_f16_f32 v70, v76, v77
  v_cvt_pk_f16_f32 v71, v78, v79
  v_mfma_f32_32x32x16_bf16 v[96:111], a[232:235], a[208:211], 0
  s_nop 0
  v_pk_mul_f16 v68, v68, s21 op_sel:[0,1]
  v_pk_mul_f16 v69, v69, s21 op_sel:[0,1]
  v_pk_mul_f16 v70, v70, s21 op_sel:[0,1]
  v_pk_mul_f16 v71, v71, s21 op_sel:[0,1]
  v_pk_fma_f16 v186, v58, v58, s20 op_sel:[0,0,1]
  v_cvt_pk_f16_f32 v80, v80, v81
  v_mfma_f32_32x32x16_bf16 v[96:111], a[236:239], a[212:215], v[96:111]
  s_waitcnt lgkmcnt(0)
  v_cvt_pk_f16_f32 v81, v82, v83
  v_cvt_pk_f16_f32 v82, v84, v85
  v_cvt_pk_f16_f32 v83, v86, v87
  v_pk_mul_f16 v80, v80, s21 op_sel:[0,1]
  v_pk_mul_f16 v81, v81, s21 op_sel:[0,1]
  v_pk_mul_f16 v82, v82, s21 op_sel:[0,1]
  v_smfmac_f32_32x32x32_bf16 v[168:183], v[240:243], v[128:135], v250
  v_pk_mul_f16 v83, v83, s21 op_sel:[0,1]
  v_cvt_pk_f16_f32 v84, v88, v89
  v_cvt_pk_f16_f32 v85, v90, v91
  v_cvt_pk_f16_f32 v86, v92, v93
  v_cvt_pk_f16_f32 v87, v94, v95
  v_mfma_f32_32x32x16_bf16 v[16:31], a[0:3], v[216:219], 0
  v_pk_mul_f16 v84, v84, s21 op_sel:[0,1]
  v_pk_mul_f16 v85, v85, s21 op_sel:[0,1]
  v_pk_mul_f16 v86, v86, s21 op_sel:[0,1]
  v_pk_mul_f16 v87, v87, s21 op_sel:[0,1]
  v_cvt_pk_f16_f32 v96, v96, v97
  v_cvt_pk_f16_f32 v97, v98, v99
  v_cvt_pk_f16_f32 v98, v100, v101
  v_cvt_pk_f16_f32 v99, v102, v103
  v_pk_mul_f16 v96, v96, s21 op_sel:[0,1]
  v_pk_mul_f16 v97, v97, s21 op_sel:[0,1]
  v_pk_mul_f16 v98, v98, s21 op_sel:[0,1]
  v_pk_mul_f16 v99, v99, s21 op_sel:[0,1]
  v_cvt_pk_f16_f32 v100, v104, v105
  v_cvt_pk_f16_f32 v101, v106, v107
  v_cvt_pk_f16_f32 v102, v108, v109
  v_cvt_pk_f16_f32 v103, v110, v111
  v_pk_mul_f16 v100, v100, s21 op_sel:[0,1]
  v_pk_mul_f16 v101, v101, s21 op_sel:[0,1]
  v_pk_mul_f16 v102, v102, s21 op_sel:[0,1]
  v_pk_mul_f16 v103, v103, s21 op_sel:[0,1]
  v_mfma_f32_32x32x16_bf16 v[16:31], a[4:7], v[220:223], v[16:31]
  ds_write_b128 v253, v[64:67] offset:49152
  ds_write_b128 v253, v[68:71] offset:52224
  ds_write_b128 v253, v[80:83] offset:50176
  ds_write_b128 v253, v[84:87] offset:53248
  ds_write_b128 v253, v[96:99] offset:51200
  ds_write_b128 v253, v[100:103] offset:54272
  s_waitcnt lgkmcnt(0)
  s_barrier
  v_mfma_f32_32x32x16_bf16 v[16:31], a[8:11], v[224:227], v[16:31]
  ds_read_b128 v[192:195], v1 offset:8192
  buffer_load_dwordx4 v254, s[72:75], s53 offen lds
  buffer_load_dwordx4 v255, s[72:75], s53 offen offset:1024 lds
  buffer_load_dwordx4 v244, s[72:75], s53 offen offset:2048 lds
  v_mfma_f32_32x32x16_bf16 v[16:31], a[12:15], v[228:231], v[16:31]
  s_add_u32 m0, s14, 0x16c00
  ds_read_b128 v[196:199], v1 offset:9216
  v_pk_fma_f16 v187, v59, v59, s20 op_sel:[0,0,1]
  v_pk_fma_f16 v184, v184, v56, s21 op_sel_hi:[1,1,0]
  v_pk_fma_f16 v185, v185, v57, s21 op_sel_hi:[1,1,0]
  v_pk_fma_f16 v186, v186, v58, s21 op_sel_hi:[1,1,0]
  v_pk_fma_f16 v187, v187, v59, s21 op_sel_hi:[1,1,0]
  v_mfma_f32_32x32x16_bf16 v[16:31], a[16:19], v[232:235], v[16:31]
  ds_read_b128 v[200:203], v1 offset:10240
  buffer_load_dwordx4 v254, s[72:75], s54 offen lds
  buffer_load_dwordx4 v255, s[72:75], s54 offen offset:1024 lds
  buffer_load_dwordx4 v244, s[72:75], s54 offen offset:2048 lds
  v_pk_fma_f16 v184, v184, v48, 0.5 op_sel_hi:[1,1,0] clamp
  v_pk_fma_f16 v185, v185, v49, 0.5 op_sel_hi:[1,1,0] clamp
  v_pk_fma_f16 v186, v186, v50, 0.5 op_sel_hi:[1,1,0] clamp
  v_pk_fma_f16 v187, v187, v51, 0.5 op_sel_hi:[1,1,0] clamp
  v_pk_mul_f16 v184, v184, v48
  v_pk_mul_f16 v185, v185, v49
  v_pk_mul_f16 v186, v186, v50
  v_pk_mul_f16 v187, v187, v51
  v_mfma_f32_32x32x16_bf16 v[16:31], a[20:23], v[236:239], v[16:31]
  s_waitcnt lgkmcnt(2)
  s_mov_b32 m0, s30
  ds_read_b128 v[204:207], v1 offset:11264
  ds_read_b128 v[208:211], v1 offset:12288
  v_or_b32_e64 v12, v64, v65
  v_or3_b32 v12, v66, v67, v12
  v_or3_b32 v12, v68, v69, v12
  v_or3_b32 v12, v70, v71, v12
  v_mfma_f32_32x32x16_f16 v[64:79], v[192:195], v[184:187], v[136:151]
  s_waitcnt lgkmcnt(3)
  buffer_load_dwordx4 v6, s[4:7], s29 offen lds
  buffer_load_dwordx4 v7, s[4:7], s29 offen offset:1024 lds
  buffer_load_dwordx4 v8, s[4:7], s29 offen offset:2048 lds
  buffer_load_dwordx4 v9, s[4:7], s29 offen offset:3072 lds
  v_or3_b32 v12, v80, v81, v12
  v_or3_b32 v12, v82, v83, v12
  v_or3_b32 v12, v84, v85, v12
  v_or3_b32 v12, v86, v87, v12
  v_mfma_f32_32x32x16_f16 v[80:95], v[196:199], v[184:187], v[152:167]
  s_waitcnt lgkmcnt(2)
  ds_read_b128 v[212:215], v1 offset:13312
  v_pk_fma_f16 v56, v52, v52, s20 op_sel_hi:[1,1,0] neg_lo:[1,0,0] neg_hi:[1,0,0] clamp
  v_pk_fma_f16 v57, v53, v53, s20 op_sel_hi:[1,1,0] neg_lo:[1,0,0] neg_hi:[1,0,0] clamp
  v_pk_fma_f16 v58, v54, v54, s20 op_sel_hi:[1,1,0] neg_lo:[1,0,0] neg_hi:[1,0,0] clamp
  v_pk_fma_f16 v59, v55, v55, s20 op_sel_hi:[1,1,0] neg_lo:[1,0,0] neg_hi:[1,0,0] clamp
  v_pk_fma_f16 v188, v56, v56, s20 op_sel:[0,0,1]
  v_pk_fma_f16 v189, v57, v57, s20 op_sel:[0,0,1]
  v_pk_fma_f16 v190, v58, v58, s20 op_sel:[0,0,1]
  v_pk_fma_f16 v191, v59, v59, s20 op_sel:[0,0,1]
  v_pk_fma_f16 v188, v188, v56, s21 op_sel_hi:[1,1,0]
  v_pk_fma_f16 v189, v189, v57, s21 op_sel_hi:[1,1,0]
  v_pk_fma_f16 v190, v190, v58, s21 op_sel_hi:[1,1,0]
  v_pk_fma_f16 v191, v191, v59, s21 op_sel_hi:[1,1,0]
  v_pk_fma_f16 v188, v188, v52, 0.5 op_sel_hi:[1,1,0] clamp
  v_pk_fma_f16 v189, v189, v53, 0.5 op_sel_hi:[1,1,0] clamp
  v_pk_fma_f16 v190, v190, v54, 0.5 op_sel_hi:[1,1,0] clamp
  v_pk_fma_f16 v191, v191, v55, 0.5 op_sel_hi:[1,1,0] clamp
  v_pk_mul_f16 v188, v188, v52
  v_pk_mul_f16 v189, v189, v53
  v_pk_mul_f16 v190, v190, v54
  v_pk_mul_f16 v191, v191, v55
  v_or3_b32 v12, v96, v97, v12
  v_or3_b32 v12, v98, v99, v12
  v_or3_b32 v12, v100, v101, v12
  v_or3_b32 v12, v102, v103, v12
  v_mfma_f32_32x32x16_f16 v[96:111], v[200:203], v[184:187], v[168:183]
  s_waitcnt lgkmcnt(2)
  s_mov_b32 m0, s31
  v_cvt_pk_f16_f32 v48, v16, v17
  v_cvt_pk_f16_f32 v49, v18, v19
  v_cvt_pk_f16_f32 v50, v20, v21
  v_cvt_pk_f16_f32 v51, v22, v23
  v_cvt_pk_f16_f32 v52, v24, v25
  v_cvt_pk_f16_f32 v53, v26, v27
  v_mfma_f32_32x32x16_f16 v[64:79], v[204:207], v[188:191], v[64:79]
  s_waitcnt lgkmcnt(1)
  s_nop 0
  ds_read_b128 v[192:195], v1 offset:14336
  ds_read_b128 v[196:199], v1 offset:15360
  v_cvt_pk_f16_f32 v54, v28, v29
  v_cvt_pk_f16_f32 v55, v30, v31
  v_pk_fma_f16 v56, v48, v48, s20 op_sel_hi:[1,1,0] neg_lo:[1,0,0] neg_hi:[1,0,0] clamp
  v_pk_fma_f16 v57, v49, v49, s20 op_sel_hi:[1,1,0] neg_lo:[1,0,0] neg_hi:[1,0,0] clamp
  v_mfma_f32_32x32x16_f16 v[80:95], v[208:211], v[188:191], v[80:95]
  s_waitcnt lgkmcnt(2)
  buffer_load_dwordx4 v6, s[4:7], s52 offen lds
  buffer_load_dwordx4 v7, s[4:7], s52 offen offset:1024 lds
  buffer_load_dwordx4 v8, s[4:7], s52 offen offset:2048 lds
  buffer_load_dwordx4 v9, s[4:7], s52 offen offset:3072 lds
  v_mfma_f32_32x32x16_f16 v[96:111], v[212:215], v[188:191], v[96:111]
  s_cmp_eq_u32 s26, 1
  v_pk_fma_f16 v58, v50, v50, s20 op_sel_hi:[1,1,0] neg_lo:[1,0,0] neg_hi:[1,0,0] clamp
  v_pk_fma_f16 v59, v51, v51, s20 op_sel_hi:[1,1,0] neg_lo:[1,0,0] neg_hi:[1,0,0] clamp
  v_pk_fma_f16 v184, v56, v56, s20 op_sel:[0,0,1]
  v_pk_fma_f16 v185, v57, v57, s20 op_sel:[0,0,1]
  v_pk_fma_f16 v186, v58, v58, s20 op_sel:[0,0,1]
  v_pk_fma_f16 v187, v59, v59, s20 op_sel:[0,0,1]
  v_mfma_f32_32x32x16_bf16 v[16:31], a[24:27], v[216:219], 0
  s_cselect_b32 s35, 0x40000000, s23
  s_add_u32 s29, s29, s35
  s_add_u32 m0, s14, 0x1c000
  v_pk_fma_f16 v184, v184, v56, s21 op_sel_hi:[1,1,0]
  v_pk_fma_f16 v185, v185, v57, s21 op_sel_hi:[1,1,0]
  v_pk_fma_f16 v186, v186, v58, s21 op_sel_hi:[1,1,0]
  v_pk_fma_f16 v187, v187, v59, s21 op_sel_hi:[1,1,0]
  v_pk_fma_f16 v184, v184, v48, 0.5 op_sel_hi:[1,1,0] clamp
  v_pk_fma_f16 v185, v185, v49, 0.5 op_sel_hi:[1,1,0] clamp
  v_mfma_f32_32x32x16_bf16 v[16:31], a[28:31], v[220:223], v[16:31]
  buffer_load_dwordx4 v254, s[72:75], s55 offen lds
  buffer_load_dwordx4 v255, s[72:75], s55 offen offset:1024 lds
  buffer_load_dwordx4 v244, s[72:75], s55 offen offset:2048 lds
  v_pk_fma_f16 v186, v186, v50, 0.5 op_sel_hi:[1,1,0] clamp
  v_mfma_f32_32x32x16_bf16 v[16:31], a[32:35], v[224:227], v[16:31]
  s_add_u32 m0, s14, 0x1cc00
  ds_read_b128 v[200:203], v1 offset:16384
  v_pk_fma_f16 v187, v187, v51, 0.5 op_sel_hi:[1,1,0] clamp
  v_pk_mul_f16 v184, v184, v48
  v_pk_mul_f16 v185, v185, v49
  v_pk_mul_f16 v186, v186, v50
  v_pk_mul_f16 v187, v187, v51
  v_mfma_f32_32x32x16_bf16 v[16:31], a[36:39], v[228:231], v[16:31]
  ds_read_b128 v[204:207], v1 offset:17408
  buffer_load_dwordx4 v254, s[72:75], s56 offen lds
  buffer_load_dwordx4 v255, s[72:75], s56 offen offset:1024 lds
  buffer_load_dwordx4 v244, s[72:75], s56 offen offset:2048 lds
  v_mfma_f32_32x32x16_bf16 v[16:31], a[40:43], v[232:235], v[16:31]
  s_add_u32 s52, s52, s35
  ds_read_b128 v[208:211], v1 offset:18432
  v_pk_fma_f16 v56, v52, v52, s20 op_sel_hi:[1,1,0] neg_lo:[1,0,0] neg_hi:[1,0,0] clamp
  v_pk_fma_f16 v57, v53, v53, s20 op_sel_hi:[1,1,0] neg_lo:[1,0,0] neg_hi:[1,0,0] clamp
  v_pk_fma_f16 v58, v54, v54, s20 op_sel_hi:[1,1,0] neg_lo:[1,0,0] neg_hi:[1,0,0] clamp
  v_pk_fma_f16 v59, v55, v55, s20 op_sel_hi:[1,1,0] neg_lo:[1,0,0] neg_hi:[1,0,0] clamp
  v_pk_fma_f16 v188, v56, v56, s20 op_sel:[0,0,1]
  v_mfma_f32_32x32x16_bf16 v[16:31], a[44:47], v[236:239], v[16:31]
  s_waitcnt vmcnt(14) lgkmcnt(3)
  v_pk_fma_f16 v189, v57, v57, s20 op_sel:[0,0,1]
  v_pk_fma_f16 v190, v58, v58, s20 op_sel:[0,0,1]
  v_pk_fma_f16 v191, v59, v59, s20 op_sel:[0,0,1]
  v_pk_fma_f16 v188, v188, v56, s21 op_sel_hi:[1,1,0]
  v_pk_fma_f16 v189, v189, v57, s21 op_sel_hi:[1,1,0]
  v_pk_fma_f16 v190, v190, v58, s21 op_sel_hi:[1,1,0]
  v_mfma_f32_32x32x16_f16 v[64:79], v[192:195], v[184:187], v[64:79]
  s_mov_b32 s32, s30
  v_pk_fma_f16 v191, v191, v59, s21 op_sel_hi:[1,1,0]
  v_pk_fma_f16 v188, v188, v52, 0.5 op_sel_hi:[1,1,0] clamp
  v_pk_fma_f16 v189, v189, v53, 0.5 op_sel_hi:[1,1,0] clamp
  v_pk_fma_f16 v190, v190, v54, 0.5 op_sel_hi:[1,1,0] clamp
  v_pk_fma_f16 v191, v191, v55, 0.5 op_sel_hi:[1,1,0] clamp
  v_pk_mul_f16 v188, v188, v52
  v_mfma_f32_32x32x16_f16 v[80:95], v[196:199], v[184:187], v[80:95]
  s_waitcnt lgkmcnt(2)
  ds_read_b128 v[212:215], v1 offset:19456
  ds_read_b128 a[216:219], v251
  ds_read_b128 a[220:223], v252
  v_pk_mul_f16 v189, v189, v53
  v_pk_mul_f16 v190, v190, v54
  v_pk_mul_f16 v191, v191, v55
  v_mfma_f32_32x32x16_f16 v[96:111], v[200:203], v[184:187], v[96:111]
  s_waitcnt lgkmcnt(4)
  ds_read_b128 a[224:227], v251 offset:64
  ds_read_b128 a[228:231], v252 offset:64
  ds_read_b128 a[232:235], v251 offset:128
  v_cvt_pk_f16_f32 v48, v16, v17
  v_cvt_pk_f16_f32 v49, v18, v19
  v_cvt_pk_f16_f32 v50, v20, v21
  v_mfma_f32_32x32x16_f16 v[64:79], v[204:207], v[188:191], v[64:79]
  s_waitcnt lgkmcnt(6)
  ds_read_b128 a[236:239], v252 offset:128
  v_cvt_pk_f16_f32 v51, v22, v23
  v_cvt_pk_f16_f32 v52, v24, v25
  v_cvt_pk_f16_f32 v53, v26, v27
  v_cvt_pk_f16_f32 v54, v28, v29
  v_cvt_pk_f16_f32 v55, v30, v31
  v_mfma_f32_32x32x16_f16 v[80:95], v[208:211], v[188:191], v[80:95]
  s_waitcnt lgkmcnt(6)
  ds_read_b128 v[192:195], v1 offset:20480
  ds_read_b128 v[196:199], v1 offset:21504
  v_pk_fma_f16 v56, v48, v48, s20 op_sel_hi:[1,1,0] neg_lo:[1,0,0] neg_hi:[1,0,0] clamp
  v_pk_fma_f16 v57, v49, v49, s20 op_sel_hi:[1,1,0] neg_lo:[1,0,0] neg_hi:[1,0,0] clamp
  v_pk_fma_f16 v58, v50, v50, s20 op_sel_hi:[1,1,0] neg_lo:[1,0,0] neg_hi:[1,0,0] clamp
  v_pk_fma_f16 v59, v51, v51, s20 op_sel_hi:[1,1,0] neg_lo:[1,0,0] neg_hi:[1,0,0] clamp
  v_mfma_f32_32x32x16_f16 v[96:111], v[212:215], v[188:191], v[96:111]
  s_waitcnt lgkmcnt(7)
  v_pk_fma_f16 v184, v56, v56, s20 op_sel:[0,0,1]
  v_pk_fma_f16 v185, v57, v57, s20 op_sel:[0,0,1]
  v_pk_fma_f16 v186, v58, v58, s20 op_sel:[0,0,1]
  v_pk_fma_f16 v187, v59, v59, s20 op_sel:[0,0,1]
  v_pk_fma_f16 v184, v184, v56, s21 op_sel_hi:[1,1,0]
  v_pk_fma_f16 v185, v185, v57, s21 op_sel_hi:[1,1,0]
  v_mfma_f32_32x32x16_bf16 v[112:127], a[216:219], a[192:195], 0
  s_waitcnt lgkmcnt(6)
  v_pk_fma_f16 v186, v186, v58, s21 op_sel_hi:[1,1,0]
  v_pk_fma_f16 v187, v187, v59, s21 op_sel_hi:[1,1,0]
  v_pk_fma_f16 v184, v184, v48, 0.5 op_sel_hi:[1,1,0] clamp
  v_pk_fma_f16 v185, v185, v49, 0.5 op_sel_hi:[1,1,0] clamp
  v_pk_fma_f16 v186, v186, v50, 0.5 op_sel_hi:[1,1,0] clamp
  v_pk_fma_f16 v187, v187, v51, 0.5 op_sel_hi:[1,1,0] clamp
  v_mfma_f32_32x32x16_bf16 v[112:127], a[220:223], a[196:199], v[112:127]
  s_waitcnt lgkmcnt(3)
  ds_read_b128 v[200:203], v1 offset:22528
  ds_read_b128 v[204:207], v1 offset:23552
  v_pk_mul_f16 v184, v184, v48
  v_pk_mul_f16 v185, v185, v49
  v_pk_mul_f16 v186, v186, v50
  v_pk_mul_f16 v187, v187, v51
  v_mfma_f32_32x32x16_bf16 v[128:143], a[224:227], a[200:203], 0
  s_add_u32 s30, s33, 32
  ds_read_b128 v[208:211], v1 offset:24576
  v_pk_fma_f16 v56, v52, v52, s20 op_sel_hi:[1,1,0] neg_lo:[1,0,0] neg_hi:[1,0,0] clamp
  v_pk_fma_f16 v57, v53, v53, s20 op_sel_hi:[1,1,0] neg_lo:[1,0,0] neg_hi:[1,0,0] clamp
  v_pk_fma_f16 v58, v54, v54, s20 op_sel_hi:[1,1,0] neg_lo:[1,0,0] neg_hi:[1,0,0] clamp
  v_pk_fma_f16 v59, v55, v55, s20 op_sel_hi:[1,1,0] neg_lo:[1,0,0] neg_hi:[1,0,0] clamp
  v_pk_fma_f16 v188, v56, v56, s20 op_sel:[0,0,1]
  v_mfma_f32_32x32x16_bf16 v[128:143], a[228:231], a[204:207], v[128:143]
  s_mov_b32 s33, s31
  v_pk_fma_f16 v189, v57, v57, s20 op_sel:[0,0,1]
  v_pk_fma_f16 v190, v58, v58, s20 op_sel:[0,0,1]
  v_pk_fma_f16 v191, v59, v59, s20 op_sel:[0,0,1]
  v_pk_fma_f16 v188, v188, v56, s21 op_sel_hi:[1,1,0]
  v_pk_fma_f16 v189, v189, v57, s21 op_sel_hi:[1,1,0]
  v_pk_fma_f16 v190, v190, v58, s21 op_sel_hi:[1,1,0]
  v_mfma_f32_32x32x16_bf16 v[144:159], a[232:235], a[208:211], 0
  s_waitcnt lgkmcnt(3)
  v_pk_fma_f16 v191, v191, v59, s21 op_sel_hi:[1,1,0]
  v_pk_fma_f16 v188, v188, v52, 0.5 op_sel_hi:[1,1,0] clamp
  v_pk_fma_f16 v189, v189, v53, 0.5 op_sel_hi:[1,1,0] clamp
  v_pk_fma_f16 v190, v190, v54, 0.5 op_sel_hi:[1,1,0] clamp
  v_pk_fma_f16 v191, v191, v55, 0.5 op_sel_hi:[1,1,0] clamp
  v_pk_mul_f16 v188, v188, v52
  v_mfma_f32_32x32x16_bf16 v[144:159], a[236:239], a[212:215], v[144:159]
  s_sub_u32 s31, s32, 32
  ds_read_b128 v[212:215], v1 offset:25600
  v_pk_mul_f16 v189, v189, v53
  v_pk_mul_f16 v190, v190, v54
  v_pk_mul_f16 v191, v191, v55
  v_cvt_pk_f16_f32 v112, v112, v113
  v_cvt_pk_f16_f32 v113, v114, v115
  v_mfma_f32_32x32x16_bf16 v[16:31], a[48:51], v[216:219], 0
  v_cvt_pk_f16_f32 v114, v116, v117
  v_cvt_pk_f16_f32 v115, v118, v119
  v_pk_mul_f16 v112, v112, s21 op_sel:[0,1]
  v_pk_mul_f16 v113, v113, s21 op_sel:[0,1]
  v_pk_mul_f16 v114, v114, s21 op_sel:[0,1]
  v_pk_mul_f16 v115, v115, s21 op_sel:[0,1]
  v_mfma_f32_32x32x16_bf16 v[16:31], a[52:55], v[220:223], v[16:31]
  v_cvt_pk_f16_f32 v116, v120, v121
  v_cvt_pk_f16_f32 v117, v122, v123
  v_cvt_pk_f16_f32 v118, v124, v125
  v_cvt_pk_f16_f32 v119, v126, v127
  v_pk_mul_f16 v116, v116, s21 op_sel:[0,1]
  v_pk_mul_f16 v117, v117, s21 op_sel:[0,1]
  v_mfma_f32_32x32x16_bf16 v[16:31], a[56:59], v[224:227], v[16:31]
  v_pk_mul_f16 v118, v118, s21 op_sel:[0,1]
  v_pk_mul_f16 v119, v119, s21 op_sel:[0,1]
  v_or3_b32 v12, v112, v113, v12
  v_or3_b32 v12, v114, v115, v12
  v_or3_b32 v12, v116, v117, v12
  v_or3_b32 v12, v118, v119, v12
  v_mfma_f32_32x32x16_bf16 v[16:31], a[60:63], v[228:231], v[16:31]
  ds_write_b128 v253, v[112:115]
  v_cvt_pk_f16_f32 v128, v128, v129
  v_mfma_f32_32x32x16_bf16 v[16:31], a[64:67], v[232:235], v[16:31]
  ds_write_b128 v253, v[116:119] offset:3072
  v_cvt_pk_f16_f32 v129, v130, v131
  v_mfma_f32_32x32x16_bf16 v[16:31], a[68:71], v[236:239], v[16:31]
  s_waitcnt vmcnt(0)
  ds_read_b128 a[216:219], v251 offset:24576
  ds_read_b128 a[220:223], v252 offset:24576
  ds_read_b128 a[224:227], v251 offset:24640
  v_cvt_pk_f16_f32 v130, v132, v133
  v_cvt_pk_f16_f32 v131, v134, v135
  v_pk_mul_f16 v128, v128, s21 op_sel:[0,1]
  v_mfma_f32_32x32x16_f16 v[64:79], v[192:195], v[184:187], v[64:79]
  ds_read_b128 a[228:231], v252 offset:24640
  v_pk_mul_f16 v129, v129, s21 op_sel:[0,1]
  v_pk_mul_f16 v130, v130, s21 op_sel:[0,1]
  v_pk_mul_f16 v131, v131, s21 op_sel:[0,1]
  v_cvt_pk_f16_f32 v132, v136, v137
  v_cvt_pk_f16_f32 v133, v138, v139
  v_mfma_f32_32x32x16_f16 v[80:95], v[196:199], v[184:187], v[80:95]
  s_waitcnt lgkmcnt(6)
  v_cvt_pk_f16_f32 v134, v140, v141
  v_cvt_pk_f16_f32 v135, v142, v143
  v_pk_mul_f16 v132, v132, s21 op_sel:[0,1]
  v_pk_mul_f16 v133, v133, s21 op_sel:[0,1]
  v_pk_mul_f16 v134, v134, s21 op_sel:[0,1]
  v_pk_mul_f16 v135, v135, s21 op_sel:[0,1]
  v_mfma_f32_32x32x16_f16 v[96:111], v[200:203], v[184:187], v[96:111]
  ds_read_b128 a[232:235], v251 offset:24704
  ds_write_b128 v253, v[128:131] offset:1024
  v_mfma_f32_32x32x16_f16 v[64:79], v[204:207], v[188:191], v[64:79]
  ds_write_b128 v253, v[132:135] offset:4096
  v_or3_b32 v12, v128, v129, v12
  v_mfma_f32_32x32x16_f16 v[80:95], v[208:211], v[188:191], v[80:95]
  s_nop 0
  ds_read_b128 a[236:239], v252 offset:24704
  v_or3_b32 v12, v130, v131, v12
  v_or3_b32 v12, v132, v133, v12
  v_or3_b32 v12, v134, v135, v12
  v_cvt_pk_f16_f32 v144, v144, v145
  v_cvt_pk_f16_f32 v145, v146, v147
  v_mfma_f32_32x32x16_f16 v[96:111], v[212:215], v[188:191], v[96:111]
  s_waitcnt lgkmcnt(4)
  v_cvt_pk_f16_f32 v146, v148, v149
  v_cvt_pk_f16_f32 v147, v150, v151
  v_pk_mul_f16 v144, v144, s21 op_sel:[0,1]
  v_pk_mul_f16 v145, v145, s21 op_sel:[0,1]
  v_pk_mul_f16 v146, v146, s21 op_sel:[0,1]
  v_pk_mul_f16 v147, v147, s21 op_sel:[0,1]
  v_mfma_f32_32x32x16_bf16 v[112:127], a[216:219], a[192:195], 0
  v_cvt_pk_f16_f32 v148, v152, v153
  v_cvt_pk_f16_f32 v149, v154, v155
  v_cvt_pk_f16_f32 v150, v156, v157
  v_cvt_pk_f16_f32 v151, v158, v159
  v_pk_mul_f16 v148, v148, s21 op_sel:[0,1]
  v_pk_mul_f16 v149, v149, s21 op_sel:[0,1]
  v_mfma_f32_32x32x16_bf16 v[112:127], a[220:223], a[196:199], v[112:127]
  v_pk_mul_f16 v150, v150, s21 op_sel:[0,1]
  v_pk_mul_f16 v151, v151, s21 op_sel:[0,1]
  v_or3_b32 v12, v144, v145, v12
  v_or3_b32 v12, v146, v147, v12
  v_or3_b32 v12, v148, v149, v12
  v_or3_b32 v12, v150, v151, v12
  v_mfma_f32_32x32x16_bf16 v[128:143], a[224:227], a[200:203], 0
  ds_write_b128 v253, v[144:147] offset:2048
  v_cvt_pk_f16_f32 v48, v16, v17
  v_mfma_f32_32x32x16_bf16 v[128:143], a[228:231], a[204:207], v[128:143]
  s_waitcnt lgkmcnt(1)
  ds_write_b128 v253, v[148:151] offset:5120
  v_cvt_pk_f16_f32 v49, v18, v19
  v_mfma_f32_32x32x16_bf16 v[144:159], a[232:235], a[208:211], 0
  s_nop 0
  v_cvt_pk_f16_f32 v50, v20, v21
  v_cvt_pk_f16_f32 v51, v22, v23
  v_cvt_pk_f16_f32 v52, v24, v25
  v_cvt_pk_f16_f32 v53, v26, v27
  v_cvt_pk_f16_f32 v54, v28, v29
  v_cvt_pk_f16_f32 v55, v30, v31
  v_mfma_f32_32x32x16_bf16 v[144:159], a[236:239], a[212:215], v[144:159]
  ds_read_b128 v[192:195], v1 offset:26624
  ds_read_b128 v[196:199], v1 offset:27648
  v_pk_fma_f16 v56, v48, v48, s20 op_sel_hi:[1,1,0] neg_lo:[1,0,0] neg_hi:[1,0,0] clamp
  v_pk_fma_f16 v57, v49, v49, s20 op_sel_hi:[1,1,0] neg_lo:[1,0,0] neg_hi:[1,0,0] clamp
  v_pk_fma_f16 v58, v50, v50, s20 op_sel_hi:[1,1,0] neg_lo:[1,0,0] neg_hi:[1,0,0] clamp
  v_pk_fma_f16 v59, v51, v51, s20 op_sel_hi:[1,1,0] neg_lo:[1,0,0] neg_hi:[1,0,0] clamp
  v_mfma_f32_32x32x16_bf16 v[16:31], a[72:75], v[216:219], 0
  v_pk_fma_f16 v184, v56, v56, s20 op_sel:[0,0,1]
  v_pk_fma_f16 v185, v57, v57, s20 op_sel:[0,0,1]
  v_pk_fma_f16 v186, v58, v58, s20 op_sel:[0,0,1]
  v_pk_fma_f16 v187, v59, v59, s20 op_sel:[0,0,1]
  v_pk_fma_f16 v184, v184, v56, s21 op_sel_hi:[1,1,0]
  v_pk_fma_f16 v185, v185, v57, s21 op_sel_hi:[1,1,0]
  v_mfma_f32_32x32x16_bf16 v[16:31], a[76:79], v[220:223], v[16:31]
  v_pk_fma_f16 v186, v186, v58, s21 op_sel_hi:[1,1,0]
  v_pk_fma_f16 v187, v187, v59, s21 op_sel_hi:[1,1,0]
  v_pk_fma_f16 v184, v184, v48, 0.5 op_sel_hi:[1,1,0] clamp
  v_pk_fma_f16 v185, v185, v49, 0.5 op_sel_hi:[1,1,0] clamp
  v_pk_fma_f16 v186, v186, v50, 0.5 op_sel_hi:[1,1,0] clamp
  v_pk_fma_f16 v187, v187, v51, 0.5 op_sel_hi:[1,1,0] clamp
  v_mfma_f32_32x32x16_bf16 v[16:31], a[80:83], v[224:227], v[16:31]
  ds_read_b128 v[200:203], v1 offset:28672
  ds_read_b128 v[204:207], v1 offset:29696
  v_pk_mul_f16 v184, v184, v48
  v_pk_mul_f16 v185, v185, v49
  v_pk_mul_f16 v186, v186, v50
  v_pk_mul_f16 v187, v187, v51
  v_mfma_f32_32x32x16_bf16 v[16:31], a[84:87], v[228:231], v[16:31]
  ds_read_b128 v[208:211], v1 offset:30720
  v_pk_fma_f16 v56, v52, v52, s20 op_sel_hi:[1,1,0] neg_lo:[1,0,0] neg_hi:[1,0,0] clamp
  v_pk_fma_f16 v57, v53, v53, s20 op_sel_hi:[1,1,0] neg_lo:[1,0,0] neg_hi:[1,0,0] clamp
  v_pk_fma_f16 v58, v54, v54, s20 op_sel_hi:[1,1,0] neg_lo:[1,0,0] neg_hi:[1,0,0] clamp
  v_pk_fma_f16 v59, v55, v55, s20 op_sel_hi:[1,1,0] neg_lo:[1,0,0] neg_hi:[1,0,0] clamp
  v_pk_fma_f16 v188, v56, v56, s20 op_sel:[0,0,1]
  v_mfma_f32_32x32x16_bf16 v[16:31], a[88:91], v[232:235], v[16:31]
  v_pk_fma_f16 v189, v57, v57, s20 op_sel:[0,0,1]
  v_pk_fma_f16 v190, v58, v58, s20 op_sel:[0,0,1]
  v_pk_fma_f16 v191, v59, v59, s20 op_sel:[0,0,1]
  v_pk_fma_f16 v188, v188, v56, s21 op_sel_hi:[1,1,0]
  v_pk_fma_f16 v189, v189, v57, s21 op_sel_hi:[1,1,0]
  v_pk_fma_f16 v190, v190, v58, s21 op_sel_hi:[1,1,0]
  v_mfma_f32_32x32x16_bf16 v[16:31], a[92:95], v[236:239], v[16:31]
  s_waitcnt lgkmcnt(3)
  s_nop 0
  v_pk_fma_f16 v191, v191, v59, s21 op_sel_hi:[1,1,0]
  v_pk_fma_f16 v188, v188, v52, 0.5 op_sel_hi:[1,1,0] clamp
  v_pk_fma_f16 v189, v189, v53, 0.5 op_sel_hi:[1,1,0] clamp
  v_pk_fma_f16 v190, v190, v54, 0.5 op_sel_hi:[1,1,0] clamp
  v_pk_fma_f16 v191, v191, v55, 0.5 op_sel_hi:[1,1,0] clamp
  v_pk_mul_f16 v188, v188, v52
  v_mfma_f32_32x32x16_f16 v[64:79], v[192:195], v[184:187], v[64:79]
  buffer_load_dword v249, v248, s[4:7], s29 offen
  v_pk_mul_f16 v189, v189, v53
  v_pk_mul_f16 v190, v190, v54
  v_mfma_f32_32x32x16_f16 v[80:95], v[196:199], v[184:187], v[80:95]
  s_waitcnt lgkmcnt(1)
  ds_read_b128 v[212:215], v1 offset:31744
  v_pk_mul_f16 v191, v191, v55
  v_min_u32 v5, v14, v5
  v_subrev_u32 v14, 0x4100, v4
  v_add_u32 v4, 0x8200, v4
  v_min_u32_e64 v4, v14, v4
  v_cvt_pk_f16_f32 v112, v112, v113
  v_cvt_pk_f16_f32 v113, v114, v115
  v_cvt_pk_f16_f32 v114, v116, v117
  v_cvt_pk_f16_f32 v115, v118, v119
  v_pk_mul_f16 v112, v112, s21 op_sel:[0,1]
  v_pk_mul_f16 v113, v113, s21 op_sel:[0,1]
  v_pk_mul_f16 v114, v114, s21 op_sel:[0,1]
  v_pk_mul_f16 v115, v115, s21 op_sel:[0,1]
  v_cvt_pk_f16_f32 v116, v120, v121
  v_cvt_pk_f16_f32 v117, v122, v123
  v_cvt_pk_f16_f32 v118, v124, v125
  v_cvt_pk_f16_f32 v119, v126, v127
  v_pk_mul_f16 v116, v116, s21 op_sel:[0,1]
  v_pk_mul_f16 v117, v117, s21 op_sel:[0,1]
  v_pk_mul_f16 v118, v118, s21 op_sel:[0,1]
  v_pk_mul_f16 v119, v119, s21 op_sel:[0,1]
  v_or3_b32 v12, v112, v113, v12
  v_or3_b32 v12, v114, v115, v12
  v_or3_b32 v12, v116, v117, v12
  v_or3_b32 v12, v118, v119, v12
  v_cvt_pk_f16_f32 v128, v128, v129
  v_cvt_pk_f16_f32 v129, v130, v131
  v_cvt_pk_f16_f32 v130, v132, v133
  v_cvt_pk_f16_f32 v131, v134, v135
  v_pk_mul_f16 v128, v128, s21 op_sel:[0,1]
  v_pk_mul_f16 v129, v129, s21 op_sel:[0,1]
  v_pk_mul_f16 v130, v130, s21 op_sel:[0,1]
  v_pk_mul_f16 v131, v131, s21 op_sel:[0,1]
  v_cvt_pk_f16_f32 v132, v136, v137
  v_cvt_pk_f16_f32 v133, v138, v139
  v_cvt_pk_f16_f32 v134, v140, v141
  v_cvt_pk_f16_f32 v135, v142, v143
  v_pk_mul_f16 v132, v132, s21 op_sel:[0,1]
  v_pk_mul_f16 v133, v133, s21 op_sel:[0,1]
  v_pk_mul_f16 v134, v134, s21 op_sel:[0,1]
  v_pk_mul_f16 v135, v135, s21 op_sel:[0,1]
  v_or3_b32 v12, v128, v129, v12
  v_or3_b32 v12, v130, v131, v12
  v_or3_b32 v12, v132, v133, v12
  v_or3_b32 v12, v134, v135, v12
  v_cvt_pk_f16_f32 v144, v144, v145
  v_cvt_pk_f16_f32 v145, v146, v147
  v_cvt_pk_f16_f32 v146, v148, v149
  v_cvt_pk_f16_f32 v147, v150, v151
  v_pk_mul_f16 v144, v144, s21 op_sel:[0,1]
  v_pk_mul_f16 v145, v145, s21 op_sel:[0,1]
  v_pk_mul_f16 v146, v146, s21 op_sel:[0,1]
  v_pk_mul_f16 v147, v147, s21 op_sel:[0,1]
  v_cvt_pk_f16_f32 v148, v152, v153
  v_cvt_pk_f16_f32 v149, v154, v155
  v_cvt_pk_f16_f32 v150, v156, v157
  v_cvt_pk_f16_f32 v151, v158, v159
  v_pk_mul_f16 v148, v148, s21 op_sel:[0,1]
  v_pk_mul_f16 v149, v149, s21 op_sel:[0,1]
  v_pk_mul_f16 v150, v150, s21 op_sel:[0,1]
  v_pk_mul_f16 v151, v151, s21 op_sel:[0,1]
  v_or3_b32 v12, v144, v145, v12
  v_or3_b32 v12, v146, v147, v12
  v_or3_b32 v12, v148, v149, v12
  v_or3_b32 v12, v150, v151, v12
  v_mfma_f32_32x32x16_f16 v[96:111], v[200:203], v[184:187], v[96:111]
  ds_read_b128 v[160:163], v3 offset:2400
  ds_read_b128 v[164:167], v4 offset:96
  ds_read_b128 v[168:171], v4 offset:288
  v_and_b32 v13, 0x40004000, v12
  v_and_b32 v12, 0x30003000, v12
  v_cmp_ne_u32 vcc, 0, v13
  v_mfma_f32_32x32x16_f16 v[64:79], v[204:207], v[188:191], v[64:79]
  s_waitcnt lgkmcnt(4)
  s_cmp_lg_u64 vcc, 0
  s_cselect_b32 s3, 1, s3
  ds_read_b128 v[172:175], v4 offset:480
  ds_read2_b64 v[176:179], v11 offset0:192 offset1:200
  ds_read_b128 v[32:35], v0 offset:12288
  ds_read_b128 v[36:39], v0 offset:13312
  ds_read_b128 v[40:43], v0 offset:14336
  ds_read_b128 v[44:47], v0 offset:15360
  ds_read_b128 v[60:63], v0 offset:16384
  ds_read_b128 v[244:247], v0 offset:17408
  ds_read_b128 a[192:195], v0
  ds_read_b128 a[196:199], v0 offset:1024
  ds_read_b128 a[200:203], v0 offset:2048
  ds_read_b128 a[204:207], v0 offset:3072
  ds_read_b128 a[208:211], v0 offset:4096
  ds_read_b128 a[212:215], v0 offset:5120
  ds_read_b128 a[216:219], v0 offset:6144
  ds_read_b128 a[220:223], v0 offset:7168
  ds_read_b128 a[224:227], v0 offset:8192
  ds_read_b128 a[228:231], v0 offset:9216
  ds_read_b128 a[232:235], v0 offset:10240
  ds_read_b128 a[236:239], v0 offset:11264
  v_cmp_ne_u32 vcc, 0, v12
  v_lshl_add_u32 v13, s27, 2, v2
  v_mfma_f32_32x32x16_f16 v[80:95], v[208:211], v[188:191], v[80:95]
  s_waitcnt lgkmcnt(15)
  s_cmp_eq_u64 vcc, 0
  s_cselect_b32 s3, 1, s3
  v_mov_b32 v12, s3
  v_cvt_pk_f16_f32 v48, v16, v17
  v_cvt_pk_f16_f32 v49, v18, v19
  v_cvt_pk_f16_f32 v50, v20, v21
  v_cvt_pk_f16_f32 v51, v22, v23
  v_mfma_f32_32x32x16_f16 v[96:111], v[212:215], v[188:191], v[96:111]
  s_waitcnt lgkmcnt(0)
  ds_write_b32 v13, v12 offset:384
  ds_write_b128 v253, v[112:115] offset:24576
  ds_write_b128 v253, v[116:119] offset:27648
  ds_write_b128 v253, v[128:131] offset:25600
  ds_write_b128 v253, v[132:135] offset:28672
  ds_write_b128 v253, v[144:147] offset:26624
  ds_write_b128 v253, v[148:151] offset:29696
  v_cvt_pk_f16_f32 v52, v24, v25
  v_cvt_pk_f16_f32 v53, v26, v27
  v_cvt_pk_f16_f32 v54, v28, v29
  v_cvt_pk_f16_f32 v55, v30, v31
  v_pk_fma_f16 v56, v48, v48, s20 op_sel_hi:[1,1,0] neg_lo:[1,0,0] neg_hi:[1,0,0] clamp
  v_pk_fma_f16 v57, v49, v49, s20 op_sel_hi:[1,1,0] neg_lo:[1,0,0] neg_hi:[1,0,0] clamp
  v_pk_fma_f16 v58, v50, v50, s20 op_sel_hi:[1,1,0] neg_lo:[1,0,0] neg_hi:[1,0,0] clamp
  v_pk_fma_f16 v59, v51, v51, s20 op_sel_hi:[1,1,0] neg_lo:[1,0,0] neg_hi:[1,0,0] clamp
  v_pk_fma_f16 v184, v56, v56, s20 op_sel:[0,0,1]
  v_pk_fma_f16 v185, v57, v57, s20 op_sel:[0,0,1]
  v_pk_fma_f16 v186, v58, v58, s20 op_sel:[0,0,1]
  v_pk_fma_f16 v187, v59, v59, s20 op_sel:[0,0,1]
  v_lshrrev_b32_e64 v255, 2, v0
  v_and_b32 v254, 0xe0, v255
  v_bfe_i32 v255, v0, 4, 1
  v_and_b32 v255, 0x280, v255
  v_xad_u32 v254, v254, v255, s66
  v_bfe_u32 v255, v0, 5, 1
  v_mul_u32_u24 v255, 0x810, v255
  v_add_u32_e64 v254, v254, v255
  v_bfe_u32 v255, v0, 6, 1
  v_lshl_add_u32 v254, v255, 10, v254
  v_mul_u32_u24 v255, 0x7f0, v255
  v_sub_u32 v255, v254, v255
  v_lshrrev_b32 v251, 2, v0
  v_and_b32 v251, 0x80, v251
  v_xad_u32 v251, v251, v0, s15
  v_and_b32_e64 v252, 16, v0
  v_lshl_add_u32 v252, v252, 6, v251
  s_waitcnt lgkmcnt(0)
  s_barrier
  .p2align 6
L_loop:
  v_mfma_f32_32x32x16_bf16 v[16:31], a[96:99], v[216:219], 0
  s_add_u32 s28, s28, 0x60000
  ds_read_b128 v[192:195], v0 offset:24576
  v_pk_fma_f16 v184, v184, v56, s21 op_sel_hi:[1,1,0]
  v_pk_fma_f16 v185, v185, v57, s21 op_sel_hi:[1,1,0]
  v_pk_fma_f16 v186, v186, v58, s21 op_sel_hi:[1,1,0]
  v_pk_fma_f16 v187, v187, v59, s21 op_sel_hi:[1,1,0]
  v_pk_fma_f16 v184, v184, v48, 0.5 op_sel_hi:[1,1,0] clamp
  v_mfma_f32_32x32x16_bf16 v[16:31], a[100:103], v[220:223], v[16:31]
  s_add_u32 s59, s59, 0x60000
  v_pk_fma_f16 v185, v185, v49, 0.5 op_sel_hi:[1,1,0] clamp
  v_pk_fma_f16 v186, v186, v50, 0.5 op_sel_hi:[1,1,0] clamp
  v_pk_fma_f16 v187, v187, v51, 0.5 op_sel_hi:[1,1,0] clamp
  v_pk_mul_f16 v184, v184, v48
  v_pk_mul_f16 v185, v185, v49
  v_pk_mul_f16 v186, v186, v50
  v_mfma_f32_16x16x32_bf16 v[136:139], v[160:163], v[164:167], 0
  s_mov_b32 m0, s30
  ds_read_b128 v[160:163], v3 offset:2800
  ds_read_b128 v[164:167], v4 offset:112
  v_mfma_f32_32x32x16_bf16 v[16:31], a[104:107], v[224:227], v[16:31]
  s_nop 0
  ds_read_b128 v[196:199], v0 offset:25600
  ds_read_b128 v[200:203], v0 offset:26624
  ds_read_b128 v[204:207], v0 offset:27648
  v_pk_mul_f16 v187, v187, v51
  v_pk_fma_f16 v56, v52, v52, s20 op_sel_hi:[1,1,0] neg_lo:[1,0,0] neg_hi:[1,0,0] clamp
  v_pk_fma_f16 v57, v53, v53, s20 op_sel_hi:[1,1,0] neg_lo:[1,0,0] neg_hi:[1,0,0] clamp
  v_smfmac_f32_16x16x64_bf16 v[136:139], v[176:179], v[168:175], v250
  ds_read_b128 v[168:171], v4 offset:304
  ds_read_b128 v[172:175], v4 offset:496
  v_mfma_f32_32x32x16_bf16 v[16:31], a[108:111], v[228:231], v[16:31]
  ds_read2_b64 v[176:179], v11 offset0:224 offset1:232
  ds_read_b128 v[208:211], v0 offset:28672
  v_pk_fma_f16 v58, v54, v54, s20 op_sel_hi:[1,1,0] neg_lo:[1,0,0] neg_hi:[1,0,0] clamp
  v_pk_fma_f16 v59, v55, v55, s20 op_sel_hi:[1,1,0] neg_lo:[1,0,0] neg_hi:[1,0,0] clamp
  v_pk_fma_f16 v188, v56, v56, s20 op_sel:[0,0,1]
  v_pk_fma_f16 v189, v57, v57, s20 op_sel:[0,0,1]
  v_mfma_f32_32x32x16_bf16 v[16:31], a[112:115], v[232:235], v[16:31]
  v_pk_fma_f16 v190, v58, v58, s20 op_sel:[0,0,1]
  v_pk_fma_f16 v191, v59, v59, s20 op_sel:[0,0,1]
  v_pk_fma_f16 v188, v188, v56, s21 op_sel_hi:[1,1,0]
  v_pk_fma_f16 v189, v189, v57, s21 op_sel_hi:[1,1,0]
  v_pk_fma_f16 v190, v190, v58, s21 op_sel_hi:[1,1,0]
  v_pk_fma_f16 v191, v191, v59, s21 op_sel_hi:[1,1,0]
  v_mfma_f32_32x32x16_bf16 v[16:31], a[116:119], v[236:239], v[16:31]
  s_waitcnt lgkmcnt(9)
  v_pk_fma_f16 v188, v188, v52, 0.5 op_sel_hi:[1,1,0] clamp
  v_pk_fma_f16 v189, v189, v53, 0.5 op_sel_hi:[1,1,0] clamp
  v_pk_fma_f16 v190, v190, v54, 0.5 op_sel_hi:[1,1,0] clamp
  v_pk_fma_f16 v191, v191, v55, 0.5 op_sel_hi:[1,1,0] clamp
  v_pk_mul_f16 v188, v188, v52
  v_pk_mul_f16 v189, v189, v53
  v_mfma_f32_32x32x16_f16 v[64:79], v[192:195], v[184:187], v[64:79]
  s_waitcnt lgkmcnt(7)
  ds_read_b128 v[212:215], v0 offset:29696
  ds_read_b128 v[192:195], v0 offset:30720
  v_pk_mul_f16 v190, v190, v54
  v_pk_mul_f16 v191, v191, v55
  v_add_f32_e64 v12, v136, v138
  v_cvt_pk_f16_f32 v48, v16, v17
  v_mfma_f32_16x16x32_bf16 v[140:143], v[160:163], v[164:167], 0
  s_waitcnt lgkmcnt(6)
  ds_read_b128 v[160:163], v3 offset:3200
  ds_read_b128 v[164:167], v4 offset:128
  v_mfma_f32_32x32x16_f16 v[80:95], v[196:199], v[184:187], v[80:95]
  s_waitcnt lgkmcnt(5)
  v_cvt_pk_f16_f32 v49, v18, v19
  v_cvt_pk_f16_f32 v50, v20, v21
  v_cvt_pk_f16_f32 v51, v22, v23
  v_cvt_pk_f16_f32 v52, v24, v25
  v_cvt_pk_f16_f32 v53, v26, v27
  v_cvt_pk_f16_f32 v54, v28, v29
  v_smfmac_f32_16x16x64_bf16 v[140:143], v[176:179], v[168:175], v250
  ds_read_b128 v[168:171], v4 offset:320
  ds_read_b128 v[172:175], v4 offset:512
  v_mfma_f32_32x32x16_f16 v[96:111], v[200:203], v[184:187], v[96:111]
  ds_read_b128 v[196:199], v0 offset:31744
  v_cvt_pk_f16_f32 v55, v30, v31
  v_pk_fma_f16 v56, v48, v48, s20 op_sel_hi:[1,1,0] neg_lo:[1,0,0] neg_hi:[1,0,0] clamp
  v_pk_fma_f16 v57, v49, v49, s20 op_sel_hi:[1,1,0] neg_lo:[1,0,0] neg_hi:[1,0,0] clamp
  v_pk_fma_f16 v58, v50, v50, s20 op_sel_hi:[1,1,0] neg_lo:[1,0,0] neg_hi:[1,0,0] clamp
  v_pk_fma_f16 v59, v51, v51, s20 op_sel_hi:[1,1,0] neg_lo:[1,0,0] neg_hi:[1,0,0] clamp
  v_mfma_f32_32x32x16_f16 v[64:79], v[204:207], v[188:191], v[64:79]
  s_waitcnt lgkmcnt(7)
  v_pk_fma_f16 v184, v56, v56, s20 op_sel:[0,0,1]
  v_pk_fma_f16 v185, v57, v57, s20 op_sel:[0,0,1]
  v_pk_fma_f16 v186, v58, v58, s20 op_sel:[0,0,1]
  v_pk_fma_f16 v187, v59, v59, s20 op_sel:[0,0,1]
  v_pk_fma_f16 v184, v184, v56, s21 op_sel_hi:[1,1,0]
  v_pk_fma_f16 v185, v185, v57, s21 op_sel_hi:[1,1,0]
  v_mfma_f32_32x32x16_f16 v[80:95], v[208:211], v[188:191], v[80:95]
  s_waitcnt lgkmcnt(5)
  v_pk_fma_f16 v186, v186, v58, s21 op_sel_hi:[1,1,0]
  v_pk_fma_f16 v187, v187, v59, s21 op_sel_hi:[1,1,0]
  v_pk_fma_f16 v184, v184, v48, 0.5 op_sel_hi:[1,1,0] clamp
  v_pk_fma_f16 v185, v185, v49, 0.5 op_sel_hi:[1,1,0] clamp
  v_pk_fma_f16 v186, v186, v50, 0.5 op_sel_hi:[1,1,0] clamp
  v_pk_fma_f16 v187, v187, v51, 0.5 op_sel_hi:[1,1,0] clamp
  v_mfma_f32_32x32x16_f16 v[96:111], v[212:215], v[188:191], v[96:111]
  s_waitcnt lgkmcnt(3)
  s_nop 0
  ds_read_b128 v[200:203], v0 offset:32768
  ds_read_b128 v[204:207], v0 offset:33792
  v_pk_mul_f16 v184, v184, v48
  v_pk_mul_f16 v185, v185, v49
  v_pk_mul_f16 v186, v186, v50
  v_pk_mul_f16 v187, v187, v51
  v_mfma_f32_16x16x32_bf16 v[144:147], v[160:163], v[164:167], 0
  s_nop 0
  ds_read_b128 v[160:163], v3 offset:3600
  ds_read_b128 v[164:167], v4 offset:144
  v_mfma_f32_32x32x16_bf16 v[16:31], a[120:123], v[216:219], 0
  s_waitcnt lgkmcnt(5)
  v_pk_fma_f16 v56, v52, v52, s20 op_sel_hi:[1,1,0] neg_lo:[1,0,0] neg_hi:[1,0,0] clamp
  v_pk_fma_f16 v57, v53, v53, s20 op_sel_hi:[1,1,0] neg_lo:[1,0,0] neg_hi:[1,0,0] clamp
  v_pk_fma_f16 v58, v54, v54, s20 op_sel_hi:[1,1,0] neg_lo:[1,0,0] neg_hi:[1,0,0] clamp
  v_pk_fma_f16 v59, v55, v55, s20 op_sel_hi:[1,1,0] neg_lo:[1,0,0] neg_hi:[1,0,0] clamp
  v_pk_fma_f16 v188, v56, v56, s20 op_sel:[0,0,1]
  v_pk_fma_f16 v189, v57, v57, s20 op_sel:[0,0,1]
  v_smfmac_f32_16x16x64_bf16 v[144:147], a[240:243], v[168:175], v250
  ds_read_b128 v[168:171], v4 offset:336
  ds_read_b128 v[172:175], v4 offset:528
  v_mfma_f32_32x32x16_bf16 v[16:31], a[124:127], v[220:223], v[16:31]
  v_pk_fma_f16 v190, v58, v58, s20 op_sel:[0,0,1]
  v_pk_fma_f16 v191, v59, v59, s20 op_sel:[0,0,1]
  v_pk_fma_f16 v188, v188, v56, s21 op_sel_hi:[1,1,0]
  v_pk_fma_f16 v189, v189, v57, s21 op_sel_hi:[1,1,0]
  v_pk_fma_f16 v190, v190, v58, s21 op_sel_hi:[1,1,0]
  v_pk_fma_f16 v191, v191, v59, s21 op_sel_hi:[1,1,0]
  v_mfma_f32_32x32x16_bf16 v[16:31], a[128:131], v[224:227], v[16:31]
  v_pk_fma_f16 v188, v188, v52, 0.5 op_sel_hi:[1,1,0] clamp
  v_pk_fma_f16 v189, v189, v53, 0.5 op_sel_hi:[1,1,0] clamp
  v_pk_fma_f16 v190, v190, v54, 0.5 op_sel_hi:[1,1,0] clamp
  v_pk_fma_f16 v191, v191, v55, 0.5 op_sel_hi:[1,1,0] clamp
  v_pk_mul_f16 v188, v188, v52
  v_pk_mul_f16 v189, v189, v53
  v_mfma_f32_32x32x16_bf16 v[16:31], a[132:135], v[228:231], v[16:31]
  ds_read_b128 v[208:211], v0 offset:34816
  ds_read_b128 v[212:215], v0 offset:35840
  v_pk_mul_f16 v190, v190, v54
  v_pk_mul_f16 v191, v191, v55
  v_add_f32 v13, v137, v139
  v_mul_f32 v14, v136, v136
  v_mfma_f32_32x32x16_bf16 v[16:31], a[136:139], v[232:235], v[16:31]
  s_waitcnt lgkmcnt(4)
  v_mul_f32 v15, v137, v137
  v_fmac_f32 v14, v138, v138
  v_fmac_f32 v15, v139, v139
  v_add_f32 v12, v12, v140
  v_add_f32 v13, v13, v141
  v_fmac_f32_e64 v14, v140, v140
  v_mfma_f32_16x16x32_bf16 v[148:151], v[160:163], v[164:167], 0
  ds_read_b128 v[160:163], v3 offset:4000
  ds_read_b128 v[164:167], v4 offset:160
  v_mfma_f32_32x32x16_bf16 v[16:31], a[140:143], v[236:239], v[16:31]
  s_waitcnt lgkmcnt(4)
  v_fmac_f32 v15, v141, v141
  v_add_f32 v12, v12, v142
  v_add_f32 v13, v13, v143
  v_fmac_f32_e64 v14, v142, v142
  v_fmac_f32_e64 v15, v143, v143
  v_add_f32_e64 v12, v12, v144
  v_smfmac_f32_16x16x64_bf16 v[148:151], a[244:247], v[168:175], v250
  ds_read_b128 v[168:171], v4 offset:352
  ds_read_b128 v[172:175], v4 offset:544
  v_mfma_f32_32x32x16_f16 v[64:79], v[192:195], v[184:187], v[64:79]
  ds_read_b128 v[192:195], v0 offset:36864
  v_add_f32_e64 v13, v13, v145
  v_cvt_pk_f16_f32 v48, v16, v17
  v_cvt_pk_f16_f32 v49, v18, v19
  v_cvt_pk_f16_f32 v50, v20, v21
  v_cvt_pk_f16_f32 v51, v22, v23
  v_mfma_f32_32x32x16_f16 v[80:95], v[196:199], v[184:187], v[80:95]
  ds_read_b128 v[196:199], v0 offset:37888
  v_cvt_pk_f16_f32 v52, v24, v25
  v_cvt_pk_f16_f32 v53, v26, v27
  v_cvt_pk_f16_f32 v54, v28, v29
  v_cvt_pk_f16_f32 v55, v30, v31
  v_pk_fma_f16 v56, v48, v48, s20 op_sel_hi:[1,1,0] neg_lo:[1,0,0] neg_hi:[1,0,0] clamp
  v_mfma_f32_32x32x16_f16 v[96:111], v[200:203], v[184:187], v[96:111]
  v_pk_fma_f16 v57, v49, v49, s20 op_sel_hi:[1,1,0] neg_lo:[1,0,0] neg_hi:[1,0,0] clamp
  v_pk_fma_f16 v58, v50, v50, s20 op_sel_hi:[1,1,0] neg_lo:[1,0,0] neg_hi:[1,0,0] clamp
  v_pk_fma_f16 v59, v51, v51, s20 op_sel_hi:[1,1,0] neg_lo:[1,0,0] neg_hi:[1,0,0] clamp
  v_pk_fma_f16 v184, v56, v56, s20 op_sel:[0,0,1]
  v_pk_fma_f16 v185, v57, v57, s20 op_sel:[0,0,1]
  v_pk_fma_f16 v186, v58, v58, s20 op_sel:[0,0,1]
  v_mfma_f32_32x32x16_f16 v[64:79], v[204:207], v[188:191], v[64:79]
  s_waitcnt lgkmcnt(4)
  s_nop 0
  v_pk_fma_f16 v187, v59, v59, s20 op_sel:[0,0,1]
  v_pk_fma_f16 v184, v184, v56, s21 op_sel_hi:[1,1,0]
  v_pk_fma_f16 v185, v185, v57, s21 op_sel_hi:[1,1,0]
  v_pk_fma_f16 v186, v186, v58, s21 op_sel_hi:[1,1,0]
  v_pk_fma_f16 v187, v187, v59, s21 op_sel_hi:[1,1,0]
  v_pk_fma_f16 v184, v184, v48, 0.5 op_sel_hi:[1,1,0] clamp
  v_mfma_f32_16x16x32_bf16 v[152:155], v[160:163], v[164:167], 0
  s_nop 0
  ds_read_b128 v[160:163], v3 offset:4400
  ds_read_b128 v[164:167], v4 offset:176
  v_mfma_f32_32x32x16_f16 v[80:95], v[208:211], v[188:191], v[80:95]
  s_waitcnt lgkmcnt(4)
  v_pk_fma_f16 v185, v185, v49, 0.5 op_sel_hi:[1,1,0] clamp
  v_pk_fma_f16 v186, v186, v50, 0.5 op_sel_hi:[1,1,0] clamp
  v_pk_fma_f16 v187, v187, v51, 0.5 op_sel_hi:[1,1,0] clamp
  v_pk_mul_f16 v184, v184, v48
  v_pk_mul_f16 v185, v185, v49
  v_pk_mul_f16 v186, v186, v50
  v_smfmac_f32_16x16x64_bf16 v[152:155], a[248:251], v[168:175], v250
  ds_read_b128 v[168:171], v4 offset:368
  ds_read_b128 v[172:175], v4 offset:560
  v_mfma_f32_32x32x16_f16 v[96:111], v[212:215], v[188:191], v[96:111]
  ds_read_b128 v[200:203], v0 offset:38912
  ds_read_b128 v[204:207], v0 offset:39936
  ds_read_b128 v[208:211], v0 offset:40960
  v_pk_mul_f16 v187, v187, v51
  v_pk_fma_f16 v56, v52, v52, s20 op_sel_hi:[1,1,0] neg_lo:[1,0,0] neg_hi:[1,0,0] clamp
  v_pk_fma_f16 v57, v53, v53, s20 op_sel_hi:[1,1,0] neg_lo:[1,0,0] neg_hi:[1,0,0] clamp
  v_mfma_f32_32x32x16_bf16 v[16:31], a[144:147], v[216:219], 0
  v_pk_fma_f16 v58, v54, v54, s20 op_sel_hi:[1,1,0] neg_lo:[1,0,0] neg_hi:[1,0,0] clamp
  v_pk_fma_f16 v59, v55, v55, s20 op_sel_hi:[1,1,0] neg_lo:[1,0,0] neg_hi:[1,0,0] clamp
  v_pk_fma_f16 v188, v56, v56, s20 op_sel:[0,0,1]
  v_pk_fma_f16 v189, v57, v57, s20 op_sel:[0,0,1]
  v_pk_fma_f16 v190, v58, v58, s20 op_sel:[0,0,1]
  v_pk_fma_f16 v191, v59, v59, s20 op_sel:[0,0,1]
  v_mfma_f32_32x32x16_bf16 v[16:31], a[148:151], v[220:223], v[16:31]
  s_nop 0
  v_pk_fma_f16 v188, v188, v56, s21 op_sel_hi:[1,1,0]
  v_pk_fma_f16 v189, v189, v57, s21 op_sel_hi:[1,1,0]
  v_pk_fma_f16 v190, v190, v58, s21 op_sel_hi:[1,1,0]
  v_pk_fma_f16 v191, v191, v59, s21 op_sel_hi:[1,1,0]
  v_pk_fma_f16 v188, v188, v52, 0.5 op_sel_hi:[1,1,0] clamp
  v_pk_fma_f16 v189, v189, v53, 0.5 op_sel_hi:[1,1,0] clamp
  v_mfma_f32_32x32x16_bf16 v[16:31], a[152:155], v[224:227], v[16:31]
  s_waitcnt lgkmcnt(5)
  v_pk_fma_f16 v190, v190, v54, 0.5 op_sel_hi:[1,1,0] clamp
  v_pk_fma_f16 v191, v191, v55, 0.5 op_sel_hi:[1,1,0] clamp
  v_pk_mul_f16 v188, v188, v52
  v_pk_mul_f16 v189, v189, v53
  v_pk_mul_f16 v190, v190, v54
  v_pk_mul_f16 v191, v191, v55
  v_mfma_f32_16x16x32_bf16 v[156:159], v[160:163], v[164:167], 0
  ds_read_b128 v[160:163], v3
  ds_read_b128 v[164:167], v4
  v_mfma_f32_32x32x16_bf16 v[16:31], a[156:159], v[228:231], v[16:31]
  s_waitcnt lgkmcnt(5)
  ds_read_b128 v[212:215], v0 offset:41984
  v_fmac_f32 v14, v144, v144
  v_fmac_f32 v15, v145, v145
  v_add_f32 v12, v12, v146
  v_add_f32 v13, v13, v147
  v_fmac_f32 v14, v146, v146
  v_smfmac_f32_16x16x64_bf16 v[156:159], a[252:255], v[168:175], v250
  ds_read_b128 v[168:171], v4 offset:192
  ds_read_b128 v[172:175], v4 offset:384
  v_mfma_f32_32x32x16_bf16 v[16:31], a[160:163], v[232:235], v[16:31]
  ds_read2_b64 v[176:179], v11 offset0:0 offset1:8
  v_fmac_f32 v15, v147, v147
  v_add_f32 v12, v12, v148
  v_add_f32 v13, v13, v149
  v_fmac_f32 v14, v148, v148
  v_fmac_f32_e64 v15, v149, v149
  v_mfma_f32_32x32x16_bf16 v[16:31], a[164:167], v[236:239], v[16:31]
  v_add_f32 v12, v12, v150
  v_add_f32 v13, v13, v151
  v_fmac_f32 v14, v150, v150
  v_fmac_f32 v15, v151, v151
  v_add_f32_e64 v12, v12, v152
  v_add_f32_e64 v13, v13, v153
  v_mfma_f32_32x32x16_f16 v[64:79], v[192:195], v[184:187], v[64:79]
  ds_read_b128 v[192:195], v0 offset:43008
  v_fmac_f32_e64 v14, v152, v152
  v_fmac_f32_e64 v15, v153, v153
  v_add_f32_e64 v12, v12, v154
  v_add_f32 v13, v13, v155
  v_cvt_pk_f16_f32 v48, v16, v17
  v_mfma_f32_32x32x16_f16 v[80:95], v[196:199], v[184:187], v[80:95]
  s_waitcnt lgkmcnt(5)
  v_cvt_pk_f16_f32 v49, v18, v19
  v_cvt_pk_f16_f32 v50, v20, v21
  v_cvt_pk_f16_f32 v51, v22, v23
  v_cvt_pk_f16_f32 v52, v24, v25
  v_cvt_pk_f16_f32 v53, v26, v27
  v_cvt_pk_f16_f32 v54, v28, v29
  v_mfma_f32_16x16x32_bf16 v[112:115], v[160:163], v[164:167], 0
  s_nop 0
  ds_read_b128 v[160:163], v3 offset:400
  ds_read_b128 v[164:167], v4 offset:16
  v_mfma_f32_32x32x16_f16 v[96:111], v[200:203], v[184:187], v[96:111]
  s_waitcnt lgkmcnt(3)
  ds_read_b128 v[196:199], v0 offset:44032
  v_cvt_pk_f16_f32 v55, v30, v31
  v_pk_fma_f16 v56, v48, v48, s20 op_sel_hi:[1,1,0] neg_lo:[1,0,0] neg_hi:[1,0,0] clamp
  v_pk_fma_f16 v57, v49, v49, s20 op_sel_hi:[1,1,0] neg_lo:[1,0,0] neg_hi:[1,0,0] clamp
  v_pk_fma_f16 v58, v50, v50, s20 op_sel_hi:[1,1,0] neg_lo:[1,0,0] neg_hi:[1,0,0] clamp
  v_pk_fma_f16 v59, v51, v51, s20 op_sel_hi:[1,1,0] neg_lo:[1,0,0] neg_hi:[1,0,0] clamp
  v_smfmac_f32_16x16x64_bf16 v[112:115], v[176:179], v[168:175], v250
  ds_read_b128 v[168:171], v4 offset:208
  ds_read_b128 v[172:175], v4 offset:400
  v_mfma_f32_32x32x16_f16 v[64:79], v[204:207], v[188:191], v[64:79]
  ds_read2_b64 v[176:179], v11 offset0:32 offset1:40
  v_pk_fma_f16 v184, v56, v56, s20 op_sel:[0,0,1]
  v_pk_fma_f16 v185, v57, v57, s20 op_sel:[0,0,1]
  v_pk_fma_f16 v186, v58, v58, s20 op_sel:[0,0,1]
  v_pk_fma_f16 v187, v59, v59, s20 op_sel:[0,0,1]
  v_pk_fma_f16 v184, v184, v56, s21 op_sel_hi:[1,1,0]
  v_mfma_f32_32x32x16_f16 v[80:95], v[208:211], v[188:191], v[80:95]
  v_pk_fma_f16 v185, v185, v57, s21 op_sel_hi:[1,1,0]
  v_pk_fma_f16 v186, v186, v58, s21 op_sel_hi:[1,1,0]
  v_pk_fma_f16 v187, v187, v59, s21 op_sel_hi:[1,1,0]
  v_pk_fma_f16 v184, v184, v48, 0.5 op_sel_hi:[1,1,0] clamp
  v_pk_fma_f16 v185, v185, v49, 0.5 op_sel_hi:[1,1,0] clamp
  v_pk_fma_f16 v186, v186, v50, 0.5 op_sel_hi:[1,1,0] clamp
  v_mfma_f32_32x32x16_f16 v[96:111], v[212:215], v[188:191], v[96:111]
  ds_read_b128 v[200:203], v0 offset:45056
  v_pk_fma_f16 v187, v187, v51, 0.5 op_sel_hi:[1,1,0] clamp
  v_pk_mul_f16 v184, v184, v48
  v_pk_mul_f16 v185, v185, v49
  v_pk_mul_f16 v186, v186, v50
  v_pk_mul_f16 v187, v187, v51
  v_mfma_f32_32x32x16_bf16 v[16:31], a[168:171], v[216:219], 0
  s_waitcnt lgkmcnt(5)
  ds_read_b128 v[204:207], v0 offset:46080
  ds_read_b128 v[208:211], v0 offset:47104
  v_pk_fma_f16 v56, v52, v52, s20 op_sel_hi:[1,1,0] neg_lo:[1,0,0] neg_hi:[1,0,0] clamp
  v_pk_fma_f16 v57, v53, v53, s20 op_sel_hi:[1,1,0] neg_lo:[1,0,0] neg_hi:[1,0,0] clamp
  v_pk_fma_f16 v58, v54, v54, s20 op_sel_hi:[1,1,0] neg_lo:[1,0,0] neg_hi:[1,0,0] clamp
  v_pk_fma_f16 v59, v55, v55, s20 op_sel_hi:[1,1,0] neg_lo:[1,0,0] neg_hi:[1,0,0] clamp
  v_mfma_f32_16x16x32_bf16 v[116:119], v[160:163], v[164:167], 0
  ds_read_b128 v[160:163], v3 offset:800
  ds_read_b128 v[164:167], v4 offset:32
  v_mfma_f32_32x32x16_bf16 v[16:31], a[172:175], v[220:223], v[16:31]
  s_waitcnt lgkmcnt(5)
  v_pk_fma_f16 v188, v56, v56, s20 op_sel:[0,0,1]
  v_pk_fma_f16 v189, v57, v57, s20 op_sel:[0,0,1]
  v_pk_fma_f16 v190, v58, v58, s20 op_sel:[0,0,1]
  v_pk_fma_f16 v191, v59, v59, s20 op_sel:[0,0,1]
  v_pk_fma_f16 v188, v188, v56, s21 op_sel_hi:[1,1,0]
  v_pk_fma_f16 v189, v189, v57, s21 op_sel_hi:[1,1,0]
  v_smfmac_f32_16x16x64_bf16 v[116:119], v[176:179], v[168:175], v250
  ds_read_b128 v[168:171], v4 offset:224
  ds_read_b128 v[172:175], v4 offset:416
  v_mfma_f32_32x32x16_bf16 v[16:31], a[176:179], v[224:227], v[16:31]
  ds_read2_b64 v[176:179], v11 offset0:64 offset1:72
  v_pk_fma_f16 v190, v190, v58, s21 op_sel_hi:[1,1,0]
  v_pk_fma_f16 v191, v191, v59, s21 op_sel_hi:[1,1,0]
  v_pk_fma_f16 v188, v188, v52, 0.5 op_sel_hi:[1,1,0] clamp
  v_pk_fma_f16 v189, v189, v53, 0.5 op_sel_hi:[1,1,0] clamp
  v_pk_fma_f16 v190, v190, v54, 0.5 op_sel_hi:[1,1,0] clamp
  v_mfma_f32_32x32x16_bf16 v[16:31], a[180:183], v[228:231], v[16:31]
  ds_read_b128 v[212:215], v0 offset:48128
  v_pk_fma_f16 v191, v191, v55, 0.5 op_sel_hi:[1,1,0] clamp
  v_pk_mul_f16 v188, v188, v52
  v_pk_mul_f16 v189, v189, v53
  v_pk_mul_f16 v190, v190, v54
  v_pk_mul_f16 v191, v191, v55
  v_mfma_f32_32x32x16_bf16 v[16:31], a[184:187], v[232:235], v[16:31]
  v_fmac_f32 v14, v154, v154
  v_fmac_f32 v15, v155, v155
  v_add_f32 v12, v12, v156
  v_add_f32 v13, v13, v157
  v_fmac_f32 v14, v156, v156
  v_fmac_f32 v15, v157, v157
  v_mfma_f32_32x32x16_bf16 v[16:31], a[188:191], v[236:239], v[16:31]
  s_waitcnt lgkmcnt(4)
  v_add_f32 v12, v12, v158
  v_add_f32 v13, v13, v159
  v_fmac_f32 v14, v158, v158
  v_fmac_f32_e64 v15, v159, v159
  v_add_f32_e64 v12, v12, v112
  v_add_f32_e64 v13, v13, v113
  v_mfma_f32_16x16x32_bf16 v[120:123], v[160:163], v[164:167], 0
  ds_read_b128 v[160:163], v3 offset:1200
  ds_read_b128 v[164:167], v4 offset:48
  v_mfma_f32_32x32x16_f16 v[64:79], v[192:195], v[184:187], v[64:79]
  s_waitcnt lgkmcnt(3)
  ds_read_b128 v[192:195], v0 offset:49152
  v_fmac_f32 v14, v112, v112
  v_cvt_pk_f16_f32 v48, v16, v17
  v_cvt_pk_f16_f32 v49, v18, v19
  v_cvt_pk_f16_f32 v50, v20, v21
  v_cvt_pk_f16_f32 v51, v22, v23
  v_smfmac_f32_16x16x64_bf16 v[120:123], v[176:179], v[168:175], v250
  ds_read_b128 v[168:171], v4 offset:240
  ds_read_b128 v[172:175], v4 offset:432
  v_mfma_f32_32x32x16_f16 v[80:95], v[196:199], v[184:187], v[80:95]
  ds_read2_b64 v[176:179], v11 offset0:96 offset1:104
  ds_read_b128 v[196:199], v0 offset:50176
  v_cvt_pk_f16_f32 v52, v24, v25
  v_cvt_pk_f16_f32 v53, v26, v27
  v_cvt_pk_f16_f32 v54, v28, v29
  v_cvt_pk_f16_f32 v55, v30, v31
  v_mfma_f32_32x32x16_f16 v[96:111], v[200:203], v[184:187], v[96:111]
  v_pk_fma_f16 v56, v48, v48, s20 op_sel_hi:[1,1,0] neg_lo:[1,0,0] neg_hi:[1,0,0] clamp
  v_pk_fma_f16 v57, v49, v49, s20 op_sel_hi:[1,1,0] neg_lo:[1,0,0] neg_hi:[1,0,0] clamp
  v_pk_fma_f16 v58, v50, v50, s20 op_sel_hi:[1,1,0] neg_lo:[1,0,0] neg_hi:[1,0,0] clamp
  v_pk_fma_f16 v59, v51, v51, s20 op_sel_hi:[1,1,0] neg_lo:[1,0,0] neg_hi:[1,0,0] clamp
  v_pk_fma_f16 v184, v56, v56, s20 op_sel:[0,0,1]
  v_pk_fma_f16 v185, v57, v57, s20 op_sel:[0,0,1]
  v_mfma_f32_32x32x16_f16 v[64:79], v[204:207], v[188:191], v[64:79]
  v_pk_fma_f16 v186, v58, v58, s20 op_sel:[0,0,1]
  v_pk_fma_f16 v187, v59, v59, s20 op_sel:[0,0,1]
  v_pk_fma_f16 v184, v184, v56, s21 op_sel_hi:[1,1,0]
  v_pk_fma_f16 v185, v185, v57, s21 op_sel_hi:[1,1,0]
  v_pk_fma_f16 v186, v186, v58, s21 op_sel_hi:[1,1,0]
  v_pk_fma_f16 v187, v187, v59, s21 op_sel_hi:[1,1,0]
  v_mfma_f32_32x32x16_f16 v[80:95], v[208:211], v[188:191], v[80:95]
  s_waitcnt lgkmcnt(5)
  s_nop 0
  v_pk_fma_f16 v184, v184, v48, 0.5 op_sel_hi:[1,1,0] clamp
  v_pk_fma_f16 v185, v185, v49, 0.5 op_sel_hi:[1,1,0] clamp
  v_pk_fma_f16 v186, v186, v50, 0.5 op_sel_hi:[1,1,0] clamp
  v_pk_fma_f16 v187, v187, v51, 0.5 op_sel_hi:[1,1,0] clamp
  v_pk_mul_f16 v184, v184, v48
  v_pk_mul_f16 v185, v185, v49
  v_mfma_f32_16x16x32_bf16 v[124:127], v[160:163], v[164:167], 0
  s_nop 0
  ds_read_b128 v[160:163], v3 offset:1600
  ds_read_b128 v[164:167], v4 offset:64
  v_mfma_f32_32x32x16_f16 v[96:111], v[212:215], v[188:191], v[96:111]
  s_waitcnt lgkmcnt(3)
  ds_read_b128 v[200:203], v0 offset:51200
  ds_read_b128 v[204:207], v0 offset:52224
  ds_read_b128 v[208:211], v0 offset:53248
  v_pk_mul_f16 v186, v186, v50
  v_pk_mul_f16 v187, v187, v51
  v_pk_fma_f16 v56, v52, v52, s20 op_sel_hi:[1,1,0] neg_lo:[1,0,0] neg_hi:[1,0,0] clamp
  v_smfmac_f32_16x16x64_bf16 v[124:127], v[176:179], v[168:175], v250
  ds_read_b128 v[168:171], v4 offset:256
  ds_read_b128 v[172:175], v4 offset:448
  v_mfma_f32_32x32x16_bf16 v[16:31], a[192:195], v[216:219], 0
  ds_read2_b64 v[176:179], v11 offset0:128 offset1:136
  v_pk_fma_f16 v57, v53, v53, s20 op_sel_hi:[1,1,0] neg_lo:[1,0,0] neg_hi:[1,0,0] clamp
  v_pk_fma_f16 v58, v54, v54, s20 op_sel_hi:[1,1,0] neg_lo:[1,0,0] neg_hi:[1,0,0] clamp
  v_pk_fma_f16 v59, v55, v55, s20 op_sel_hi:[1,1,0] neg_lo:[1,0,0] neg_hi:[1,0,0] clamp
  v_pk_fma_f16 v188, v56, v56, s20 op_sel:[0,0,1]
  v_pk_fma_f16 v189, v57, v57, s20 op_sel:[0,0,1]
  v_mfma_f32_32x32x16_bf16 v[16:31], a[196:199], v[220:223], v[16:31]
  v_pk_fma_f16 v190, v58, v58, s20 op_sel:[0,0,1]
  v_pk_fma_f16 v191, v59, v59, s20 op_sel:[0,0,1]
  v_pk_fma_f16 v188, v188, v56, s21 op_sel_hi:[1,1,0]
  v_pk_fma_f16 v189, v189, v57, s21 op_sel_hi:[1,1,0]
  v_pk_fma_f16 v190, v190, v58, s21 op_sel_hi:[1,1,0]
  v_pk_fma_f16 v191, v191, v59, s21 op_sel_hi:[1,1,0]
  v_mfma_f32_32x32x16_bf16 v[16:31], a[200:203], v[224:227], v[16:31]
  v_pk_fma_f16 v188, v188, v52, 0.5 op_sel_hi:[1,1,0] clamp
  v_pk_fma_f16 v189, v189, v53, 0.5 op_sel_hi:[1,1,0] clamp
  v_pk_fma_f16 v190, v190, v54, 0.5 op_sel_hi:[1,1,0] clamp
  v_pk_fma_f16 v191, v191, v55, 0.5 op_sel_hi:[1,1,0] clamp
  v_pk_mul_f16 v188, v188, v52
  v_pk_mul_f16 v189, v189, v53
  v_mfma_f32_32x32x16_bf16 v[16:31], a[204:207], v[228:231], v[16:31]
  s_waitcnt lgkmcnt(6)
  ds_read_b128 v[212:215], v0 offset:54272
  v_pk_mul_f16 v190, v190, v54
  v_pk_mul_f16 v191, v191, v55
  v_fmac_f32 v15, v113, v113
  v_add_f32 v12, v12, v114
  v_add_f32 v13, v13, v115
  v_mfma_f32_16x16x32_bf16 v[128:131], v[160:163], v[164:167], 0
  ds_read_b128 v[160:163], v3 offset:2000
  ds_read_b128 v[164:167], v4 offset:80
  v_mfma_f32_32x32x16_bf16 v[16:31], a[208:211], v[232:235], v[16:31]
  s_waitcnt lgkmcnt(3)
  v_fmac_f32 v14, v114, v114
  v_fmac_f32 v15, v115, v115
  v_add_f32 v12, v12, v116
  v_add_f32 v13, v13, v117
  v_fmac_f32 v14, v116, v116
  v_fmac_f32_e64 v15, v117, v117
  v_smfmac_f32_16x16x64_bf16 v[128:131], v[176:179], v[168:175], v250
  ds_read_b128 v[168:171], v4 offset:272
  ds_read_b128 v[172:175], v4 offset:464
  v_mfma_f32_32x32x16_bf16 v[16:31], a[212:215], v[236:239], v[16:31]
  ds_read2_b64 v[176:179], v11 offset0:160 offset1:168
  v_add_f32 v12, v12, v118
  v_add_f32 v13, v13, v119
  v_fmac_f32_e64 v14, v118, v118
  v_fmac_f32_e64 v15, v119, v119
  v_add_f32_e64 v12, v12, v120
  v_mfma_f32_32x32x16_f16 v[64:79], v[192:195], v[184:187], v[64:79]
  ds_read_b128 v[192:195], v0 offset:55296
  v_add_f32_e64 v13, v13, v121
  v_fmac_f32_e64 v14, v120, v120
  v_fmac_f32_e64 v15, v121, v121
  v_add_f32_e64 v12, v12, v122
  v_cvt_pk_f16_f32 v48, v16, v17
  v_mfma_f32_32x32x16_f16 v[80:95], v[196:199], v[184:187], v[80:95]
  v_cvt_pk_f16_f32 v49, v18, v19
  v_cvt_pk_f16_f32 v50, v20, v21
  v_cvt_pk_f16_f32 v51, v22, v23
  v_cvt_pk_f16_f32 v52, v24, v25
  v_cvt_pk_f16_f32 v53, v26, v27
  v_cvt_pk_f16_f32 v54, v28, v29
  v_mfma_f32_32x32x16_f16 v[96:111], v[200:203], v[184:187], v[96:111]
  s_waitcnt lgkmcnt(4)
  s_nop 0
  ds_read_b128 v[196:199], v0 offset:56320
  v_cvt_pk_f16_f32 v55, v30, v31
  v_pk_fma_f16 v56, v48, v48, s20 op_sel_hi:[1,1,0] neg_lo:[1,0,0] neg_hi:[1,0,0] clamp
  v_pk_fma_f16 v57, v49, v49, s20 op_sel_hi:[1,1,0] neg_lo:[1,0,0] neg_hi:[1,0,0] clamp
  v_pk_fma_f16 v58, v50, v50, s20 op_sel_hi:[1,1,0] neg_lo:[1,0,0] neg_hi:[1,0,0] clamp
  v_pk_fma_f16 v59, v51, v51, s20 op_sel_hi:[1,1,0] neg_lo:[1,0,0] neg_hi:[1,0,0] clamp
  v_mfma_f32_16x16x32_bf16 v[132:135], v[160:163], v[164:167], 0
  s_nop 0
  v_pk_fma_f16 v184, v56, v56, s20 op_sel:[0,0,1]
  v_pk_fma_f16 v185, v57, v57, s20 op_sel:[0,0,1]
  v_mfma_f32_32x32x16_f16 v[64:79], v[204:207], v[188:191], v[64:79]
  s_waitcnt lgkmcnt(2)
  v_pk_fma_f16 v186, v58, v58, s20 op_sel:[0,0,1]
  v_pk_fma_f16 v187, v59, v59, s20 op_sel:[0,0,1]
  v_pk_fma_f16 v184, v184, v56, s21 op_sel_hi:[1,1,0]
  v_pk_fma_f16 v185, v185, v57, s21 op_sel_hi:[1,1,0]
  v_pk_fma_f16 v186, v186, v58, s21 op_sel_hi:[1,1,0]
  v_pk_fma_f16 v187, v187, v59, s21 op_sel_hi:[1,1,0]
  v_smfmac_f32_16x16x64_bf16 v[132:135], v[176:179], v[168:175], v250
  ds_read_b128 v[200:203], v0 offset:57344
  v_pk_fma_f16 v184, v184, v48, 0.5 op_sel_hi:[1,1,0] clamp
  v_mfma_f32_32x32x16_f16 v[80:95], v[208:211], v[188:191], v[80:95]
  v_pk_fma_f16 v185, v185, v49, 0.5 op_sel_hi:[1,1,0] clamp
  v_pk_fma_f16 v186, v186, v50, 0.5 op_sel_hi:[1,1,0] clamp
  v_pk_fma_f16 v187, v187, v51, 0.5 op_sel_hi:[1,1,0] clamp
  v_pk_mul_f16 v184, v184, v48
  v_pk_mul_f16 v185, v185, v49
  v_pk_mul_f16 v186, v186, v50
  v_mfma_f32_32x32x16_f16 v[96:111], v[212:215], v[188:191], v[96:111]
  ds_read_b128 v[204:207], v0 offset:58368
  ds_read_b128 v[208:211], v0 offset:59392
  v_pk_mul_f16 v187, v187, v51
  v_pk_fma_f16 v56, v52, v52, s20 op_sel_hi:[1,1,0] neg_lo:[1,0,0] neg_hi:[1,0,0] clamp
  v_pk_fma_f16 v57, v53, v53, s20 op_sel_hi:[1,1,0] neg_lo:[1,0,0] neg_hi:[1,0,0] clamp
  v_pk_fma_f16 v58, v54, v54, s20 op_sel_hi:[1,1,0] neg_lo:[1,0,0] neg_hi:[1,0,0] clamp
  v_mfma_f32_32x32x16_bf16 v[16:31], a[216:219], v[216:219], 0
  v_add_f32 v13, v13, v123
  v_fmac_f32 v14, v122, v122
  v_fmac_f32 v15, v123, v123
  v_add_f32 v12, v12, v124
  v_add_f32 v13, v13, v125
  v_fmac_f32 v14, v124, v124
  v_fmac_f32 v15, v125, v125
  v_add_f32 v12, v12, v126
  v_add_f32_e64 v13, v13, v127
  v_pk_fma_f32 v[14:15], v[126:127], v[126:127], v[14:15]
  v_pk_add_f32 v[12:13], v[12:13], v[128:129]
  v_pk_fma_f32 v[14:15], v[128:129], v[128:129], v[14:15]
  v_pk_add_f32 v[12:13], v[12:13], v[130:131]
  v_pk_fma_f32 v[14:15], v[130:131], v[130:131], v[14:15]
  v_pk_add_f32 v[12:13], v[12:13], v[132:133]
  v_pk_fma_f32 v[14:15], v[132:133], v[132:133], v[14:15]
  v_pk_add_f32 v[12:13], v[12:13], v[134:135]
  v_pk_fma_f32 v[14:15], v[134:135], v[134:135], v[14:15]
  v_mfma_f32_32x32x16_bf16 v[16:31], a[220:223], v[220:223], v[16:31]
  v_pk_fma_f16 v59, v55, v55, s20 op_sel_hi:[1,1,0] neg_lo:[1,0,0] neg_hi:[1,0,0] clamp
  v_pk_fma_f16 v188, v56, v56, s20 op_sel:[0,0,1]
  v_pk_fma_f16 v189, v57, v57, s20 op_sel:[0,0,1]
  v_pk_fma_f16 v190, v58, v58, s20 op_sel:[0,0,1]
  v_pk_fma_f16 v191, v59, v59, s20 op_sel:[0,0,1]
  v_pk_fma_f16 v188, v188, v56, s21 op_sel_hi:[1,1,0]
  v_mfma_f32_32x32x16_bf16 v[16:31], a[224:227], v[224:227], v[16:31]
  v_pk_fma_f16 v189, v189, v57, s21 op_sel_hi:[1,1,0]
  v_pk_fma_f16 v190, v190, v58, s21 op_sel_hi:[1,1,0]
  v_pk_fma_f16 v191, v191, v59, s21 op_sel_hi:[1,1,0]
  v_pk_fma_f16 v188, v188, v52, 0.5 op_sel_hi:[1,1,0] clamp
  v_pk_fma_f16 v189, v189, v53, 0.5 op_sel_hi:[1,1,0] clamp
  v_pk_fma_f16 v190, v190, v54, 0.5 op_sel_hi:[1,1,0] clamp
  v_mfma_f32_32x32x16_bf16 v[16:31], a[228:231], v[228:231], v[16:31]
  ds_read_b128 v[212:215], v0 offset:60416
  v_pk_fma_f16 v191, v191, v55, 0.5 op_sel_hi:[1,1,0] clamp
  v_pk_mul_f16 v188, v188, v52
  v_pk_mul_f16 v189, v189, v53
  v_pk_mul_f16 v190, v190, v54
  v_pk_mul_f16 v191, v191, v55
  v_mfma_f32_32x32x16_bf16 v[16:31], a[232:235], v[232:235], v[16:31]
  ds_read_b128 v[160:163], v0 offset:18432
  ds_read_b128 v[164:167], v0 offset:19456
  ds_read_b128 v[168:171], v0 offset:20480
  v_add_f32_e64 v12, v12, v13
  v_add_f32 v14, v14, v15
  v_mfma_f32_32x32x16_bf16 v[16:31], a[236:239], v[236:239], v[16:31]
  s_waitcnt lgkmcnt(4)
  ds_read_b128 v[172:175], v0 offset:21504
  ds_read_b128 v[176:179], v0 offset:22528
  v_permlane32_swap_b32 v12, v14
  v_add_f32 v12, v12, v14
  v_mov_b32_e64 v14, v12
  v_mfma_f32_32x32x16_f16 v[64:79], v[192:195], v[184:187], v[64:79]
  ds_read_b128 v[192:195], v0 offset:61440
  v_permlane32_swap_b32 v12, v14
  v_mul_f32 v12, s24, v12
  v_mul_f32_e64 v13, s24, v14
  v_fma_f32 v13, -v12, v12, v13
  v_mfma_f32_32x32x16_f16 v[80:95], v[196:199], v[184:187], v[80:95]
  v_cvt_pk_f16_f32 v48, v16, v17
  v_cvt_pk_f16_f32 v49, v18, v19
  v_cvt_pk_f16_f32 v50, v20, v21
  v_cvt_pk_f16_f32 v51, v22, v23
  v_cvt_pk_f16_f32 v52, v24, v25
  v_cvt_pk_f16_f32 v53, v26, v27
  v_mfma_f32_32x32x16_f16 v[96:111], v[200:203], v[184:187], v[96:111]
  v_cvt_pk_f16_f32 v54, v28, v29
  v_cvt_pk_f16_f32 v55, v30, v31
  v_max_f32 v13, 0, v13
  v_add_f32 v13, s25, v13
  v_rsq_f32_e64 v13, v13
  v_mfma_f32_32x32x16_f16 v[64:79], v[204:207], v[188:191], v[64:79]
  ds_read_b128 v[196:199], v0 offset:62464
  v_mul_f32 v14, s22, v13
  v_mul_f32_e64 v12, -v12, v14
  v_pk_fma_f16 v56, v48, v48, s20 op_sel_hi:[1,1,0] neg_lo:[1,0,0] neg_hi:[1,0,0] clamp
  v_pk_fma_f16 v57, v49, v49, s20 op_sel_hi:[1,1,0] neg_lo:[1,0,0] neg_hi:[1,0,0] clamp
  v_pk_fma_f16 v58, v50, v50, s20 op_sel_hi:[1,1,0] neg_lo:[1,0,0] neg_hi:[1,0,0] clamp
  v_mfma_f32_32x32x16_f16 v[80:95], v[208:211], v[188:191], v[80:95]
  s_waitcnt lgkmcnt(2)
  v_pk_fma_f16 v59, v51, v51, s20 op_sel_hi:[1,1,0] neg_lo:[1,0,0] neg_hi:[1,0,0] clamp
  v_pk_fma_f16 v184, v56, v56, s20 op_sel:[0,0,1]
  v_pk_fma_f16 v185, v57, v57, s20 op_sel:[0,0,1]
  v_pk_fma_f16 v186, v58, v58, s20 op_sel:[0,0,1]
  v_pk_fma_f16 v187, v59, v59, s20 op_sel:[0,0,1]
  v_pk_fma_f16 v184, v184, v56, s21 op_sel_hi:[1,1,0]
  v_mfma_f32_32x32x16_f16 v[96:111], v[212:215], v[188:191], v[96:111]
  v_fma_f32 v112, v112, v14, v12
  v_fma_f32 v113, v113, v14, v12
  v_fma_f32 v114, v114, v14, v12
  v_fma_f32 v115, v115, v14, v12
  v_fma_f32 v116, v116, v14, v12
  v_fma_f32 v117, v117, v14, v12
  v_fma_f32 v118, v118, v14, v12
  v_fma_f32 v119, v119, v14, v12
  v_fma_f32 v120, v120, v14, v12
  v_fma_f32 v121, v121, v14, v12
  v_pk_fma_f32 v[122:123], v[122:123], v[14:15], v[12:13] op_sel_hi:[1,0,0]
  v_pk_fma_f32 v[124:125], v[124:125], v[14:15], v[12:13] op_sel_hi:[1,0,0]
  v_pk_fma_f32 v[126:127], v[126:127], v[14:15], v[12:13] op_sel_hi:[1,0,0]
  v_pk_fma_f32 v[128:129], v[128:129], v[14:15], v[12:13] op_sel_hi:[1,0,0]
  v_pk_fma_f32 v[130:131], v[130:131], v[14:15], v[12:13] op_sel_hi:[1,0,0]
  v_pk_fma_f32 v[132:133], v[132:133], v[14:15], v[12:13] op_sel_hi:[1,0,0]
  v_pk_fma_f32 v[134:135], v[134:135], v[14:15], v[12:13] op_sel_hi:[1,0,0]
  v_pk_fma_f32 v[136:137], v[136:137], v[14:15], v[12:13] op_sel_hi:[1,0,0]
  v_pk_fma_f32 v[138:139], v[138:139], v[14:15], v[12:13] op_sel_hi:[1,0,0]
  v_pk_fma_f32 v[140:141], v[140:141], v[14:15], v[12:13] op_sel_hi:[1,0,0]
  v_pk_fma_f32 v[142:143], v[142:143], v[14:15], v[12:13] op_sel_hi:[1,0,0]
  v_pk_fma_f32 v[144:145], v[144:145], v[14:15], v[12:13] op_sel_hi:[1,0,0]
  v_pk_fma_f32 v[146:147], v[146:147], v[14:15], v[12:13] op_sel_hi:[1,0,0]
  v_pk_fma_f32 v[148:149], v[148:149], v[14:15], v[12:13] op_sel_hi:[1,0,0]
  v_pk_fma_f32 v[150:151], v[150:151], v[14:15], v[12:13] op_sel_hi:[1,0,0]
  v_pk_fma_f32 v[152:153], v[152:153], v[14:15], v[12:13] op_sel_hi:[1,0,0]
  v_pk_fma_f32 v[154:155], v[154:155], v[14:15], v[12:13] op_sel_hi:[1,0,0]
  v_pk_fma_f32 v[156:157], v[156:157], v[14:15], v[12:13] op_sel_hi:[1,0,0]
  v_pk_fma_f32 v[158:159], v[158:159], v[14:15], v[12:13] op_sel_hi:[1,0,0]
  v_mfma_f32_32x32x16_bf16 v[16:31], v[32:35], v[216:219], 0
  v_pk_fma_f16 v185, v185, v57, s21 op_sel_hi:[1,1,0]
  v_pk_fma_f16 v186, v186, v58, s21 op_sel_hi:[1,1,0]
  v_pk_fma_f16 v187, v187, v59, s21 op_sel_hi:[1,1,0]
  v_pk_fma_f16 v184, v184, v48, 0.5 op_sel_hi:[1,1,0] clamp
  v_pk_fma_f16 v185, v185, v49, 0.5 op_sel_hi:[1,1,0] clamp
  v_pk_fma_f16 v186, v186, v50, 0.5 op_sel_hi:[1,1,0] clamp
  v_mfma_f32_32x32x16_bf16 v[16:31], v[36:39], v[220:223], v[16:31]
  ds_read_b128 v[200:203], v0 offset:63488
  v_pk_fma_f16 v187, v187, v51, 0.5 op_sel_hi:[1,1,0] clamp
  v_pk_mul_f16 v184, v184, v48
  v_pk_mul_f16 v185, v185, v49
  v_pk_mul_f16 v186, v186, v50
  v_pk_mul_f16 v187, v187, v51
  v_mfma_f32_32x32x16_bf16 v[16:31], v[40:43], v[224:227], v[16:31]
  ds_read_b128 v[204:207], v0 offset:64512
  ds_read_b128 v[208:211], v1
  v_pk_fma_f16 v56, v52, v52, s20 op_sel_hi:[1,1,0] neg_lo:[1,0,0] neg_hi:[1,0,0] clamp
  v_pk_fma_f16 v57, v53, v53, s20 op_sel_hi:[1,1,0] neg_lo:[1,0,0] neg_hi:[1,0,0] clamp
  v_pk_fma_f16 v58, v54, v54, s20 op_sel_hi:[1,1,0] neg_lo:[1,0,0] neg_hi:[1,0,0] clamp
  v_pk_fma_f16 v59, v55, v55, s20 op_sel_hi:[1,1,0] neg_lo:[1,0,0] neg_hi:[1,0,0] clamp
  v_mfma_f32_32x32x16_bf16 v[16:31], v[44:47], v[228:231], v[16:31]
  v_pk_fma_f16 v188, v56, v56, s20 op_sel:[0,0,1]
  v_pk_fma_f16 v189, v57, v57, s20 op_sel:[0,0,1]
  v_pk_fma_f16 v190, v58, v58, s20 op_sel:[0,0,1]
  v_pk_fma_f16 v191, v59, v59, s20 op_sel:[0,0,1]
  v_pk_fma_f16 v188, v188, v56, s21 op_sel_hi:[1,1,0]
  v_pk_fma_f16 v189, v189, v57, s21 op_sel_hi:[1,1,0]
  v_mfma_f32_32x32x16_bf16 v[16:31], v[60:63], v[232:235], v[16:31]
  s_nop 0
  v_pk_fma_f16 v190, v190, v58, s21 op_sel_hi:[1,1,0]
  v_pk_fma_f16 v191, v191, v59, s21 op_sel_hi:[1,1,0]
  v_pk_fma_f16 v188, v188, v52, 0.5 op_sel_hi:[1,1,0] clamp
  v_pk_fma_f16 v189, v189, v53, 0.5 op_sel_hi:[1,1,0] clamp
  v_pk_fma_f16 v190, v190, v54, 0.5 op_sel_hi:[1,1,0] clamp
  v_pk_fma_f16 v191, v191, v55, 0.5 op_sel_hi:[1,1,0] clamp
  v_mfma_f32_32x32x16_bf16 v[16:31], v[244:247], v[236:239], v[16:31]
  s_waitcnt lgkmcnt(3)
  ds_read_b128 v[212:215], v1 offset:1024
  v_pk_mul_f16 v188, v188, v52
  v_pk_mul_f16 v189, v189, v53
  v_pk_mul_f16 v190, v190, v54
  v_pk_mul_f16 v191, v191, v55
  v_cndmask_b32 v159, v159, v250, s[12:13]
  v_mfma_f32_32x32x16_f16 v[64:79], v[192:195], v[184:187], v[64:79]
  v_cvt_pk_bf16_f32 v216, v112, v113
  v_cvt_pk_bf16_f32 v217, v114, v115
  v_cvt_pk_bf16_f32 v218, v116, v117
  v_cvt_pk_bf16_f32 v219, v118, v119
  v_cvt_pk_bf16_f32 v220, v120, v121
  v_cvt_pk_f16_f32 v48, v16, v17
  v_mfma_f32_32x32x16_f16 v[80:95], v[196:199], v[184:187], v[80:95]
  s_waitcnt lgkmcnt(1)
  s_nop 0
  v_cvt_pk_f16_f32 v49, v18, v19
  v_cvt_pk_f16_f32 v50, v20, v21
  v_cvt_pk_f16_f32 v51, v22, v23
  v_cvt_pk_f16_f32 v52, v24, v25
  v_cvt_pk_f16_f32 v53, v26, v27
  v_cvt_pk_f16_f32 v54, v28, v29
  v_mfma_f32_32x32x16_f16 v[96:111], v[200:203], v[184:187], v[96:111]
  v_cvt_pk_f16_f32 v55, v30, v31
  v_cvt_pk_bf16_f32 v221, v122, v123
  v_cvt_pk_bf16_f32 v222, v124, v125
  v_cvt_pk_bf16_f32 v223, v126, v127
  v_cvt_pk_bf16_f32 v224, v128, v129
  v_cvt_pk_bf16_f32 v225, v130, v131
  v_mfma_f32_32x32x16_f16 v[64:79], v[204:207], v[188:191], v[64:79]
  ds_read_b128 v[180:183], v0 offset:23552
  v_cvt_pk_bf16_f32 v226, v132, v133
  v_cvt_pk_bf16_f32 v227, v134, v135
  v_cvt_pk_bf16_f32 v228, v136, v137
  v_cvt_pk_bf16_f32 v229, v138, v139
  v_cvt_pk_bf16_f32 v230, v140, v141
  v_mfma_f32_32x32x16_f16 v[80:95], v[208:211], v[188:191], v[80:95]
  s_waitcnt lgkmcnt(1)
  ds_read_b128 v[192:195], v1 offset:2048
  v_cvt_pk_bf16_f32 v231, v142, v143
  v_cvt_pk_bf16_f32 v232, v144, v145
  v_cvt_pk_bf16_f32 v233, v146, v147
  v_cvt_pk_bf16_f32 v234, v148, v149
  v_cvt_pk_bf16_f32 v235, v150, v151
  v_mfma_f32_32x32x16_f16 v[96:111], v[212:215], v[188:191], v[96:111]
  s_nop 0
  ds_read_b128 v[112:115], v5
  ds_read_b128 v[116:119], v5 offset:32
  v_cvt_pk_bf16_f32 v236, v152, v153
  v_cvt_pk_bf16_f32 v237, v154, v155
  v_cvt_pk_bf16_f32 v238, v156, v157
  v_cvt_pk_bf16_f32 v239, v158, v159
  v_mfma_f32_32x32x16_bf16 v[16:31], v[160:163], v[216:219], 0
  ds_read_b128 v[136:139], v2
  ds_read_b128 v[140:143], v2 offset:32
  ds_read_b128 v[144:147], v2 offset:64
  v_pk_fma_f16 v56, v48, v48, s20 op_sel_hi:[1,1,0] neg_lo:[1,0,0] neg_hi:[1,0,0] clamp
  v_pk_fma_f16 v57, v49, v49, s20 op_sel_hi:[1,1,0] neg_lo:[1,0,0] neg_hi:[1,0,0] clamp
  v_pk_fma_f16 v58, v50, v50, s20 op_sel_hi:[1,1,0] neg_lo:[1,0,0] neg_hi:[1,0,0] clamp
  v_mfma_f32_32x32x16_bf16 v[16:31], v[164:167], v[220:223], v[16:31]
  ds_read_b128 v[148:151], v2 offset:96
  v_pk_fma_f16 v59, v51, v51, s20 op_sel_hi:[1,1,0] neg_lo:[1,0,0] neg_hi:[1,0,0] clamp
  v_pk_fma_f16 v184, v56, v56, s20 op_sel:[0,0,1]
  v_pk_fma_f16 v185, v57, v57, s20 op_sel:[0,0,1]
  v_pk_fma_f16 v186, v58, v58, s20 op_sel:[0,0,1]
  v_pk_fma_f16 v187, v59, v59, s20 op_sel:[0,0,1]
  v_mfma_f32_32x32x16_bf16 v[16:31], v[168:171], v[224:227], v[16:31]
  v_pk_fma_f16 v184, v184, v56, s21 op_sel_hi:[1,1,0]
  v_pk_fma_f16 v185, v185, v57, s21 op_sel_hi:[1,1,0]
  v_pk_fma_f16 v186, v186, v58, s21 op_sel_hi:[1,1,0]
  v_pk_fma_f16 v187, v187, v59, s21 op_sel_hi:[1,1,0]
  v_pk_fma_f16 v184, v184, v48, 0.5 op_sel_hi:[1,1,0] clamp
  v_pk_fma_f16 v185, v185, v49, 0.5 op_sel_hi:[1,1,0] clamp
  v_mfma_f32_32x32x16_bf16 v[16:31], v[172:175], v[228:231], v[16:31]
  s_nop 0
  v_pk_fma_f16 v186, v186, v50, 0.5 op_sel_hi:[1,1,0] clamp
  v_pk_fma_f16 v187, v187, v51, 0.5 op_sel_hi:[1,1,0] clamp
  v_pk_mul_f16 v184, v184, v48
  v_pk_mul_f16 v185, v185, v49
  v_pk_mul_f16 v186, v186, v50
  v_pk_mul_f16 v187, v187, v51
  v_mfma_f32_32x32x16_bf16 v[16:31], v[176:179], v[232:235], v[16:31]
  s_waitcnt lgkmcnt(4)
  ds_read_b128 v[196:199], v1 offset:3072
  ds_read_b128 v[120:123], v5 offset:64
  ds_read_b128 v[124:127], v5 offset:96
  v_pk_fma_f16 v56, v52, v52, s20 op_sel_hi:[1,1,0] neg_lo:[1,0,0] neg_hi:[1,0,0] clamp
  v_pk_fma_f16 v57, v53, v53, s20 op_sel_hi:[1,1,0] neg_lo:[1,0,0] neg_hi:[1,0,0] clamp
  v_pk_fma_f16 v58, v54, v54, s20 op_sel_hi:[1,1,0] neg_lo:[1,0,0] neg_hi:[1,0,0] clamp
  v_mfma_f32_32x32x16_bf16 v[16:31], v[180:183], v[236:239], v[16:31]
  ds_read_b128 v[152:155], v2 offset:128
  ds_read_b128 v[156:159], v2 offset:160
  ds_read_b128 v[160:163], v2 offset:192
  ds_read_b128 v[164:167], v2 offset:224
  s_nop 0
  v_mfma_f32_32x32x16_f16 v[64:79], v[192:195], v[184:187], v[64:79]
  s_waitcnt lgkmcnt(7)
  ds_read_b128 v[200:203], v1 offset:4096
  ds_read_b128 v[204:207], v1 offset:5120
  ds_read_b128 v[208:211], v1 offset:6144
  v_pk_fma_f16 v59, v55, v55, s20 op_sel_hi:[1,1,0] neg_lo:[1,0,0] neg_hi:[1,0,0] clamp
  v_pk_fma_f16 v188, v56, v56, s20 op_sel:[0,0,1]
  v_pk_fma_f16 v189, v57, v57, s20 op_sel:[0,0,1]
  v_smfmac_f32_32x32x32_bf16 v[136:151], v[240:243], v[112:119], v250
  s_waitcnt lgkmcnt(9)
  v_pk_fma_f16 v190, v58, v58, s20 op_sel:[0,0,1]
  v_pk_fma_f16 v191, v59, v59, s20 op_sel:[0,0,1]
  v_pk_fma_f16 v188, v188, v56, s21 op_sel_hi:[1,1,0]
  v_pk_fma_f16 v189, v189, v57, s21 op_sel_hi:[1,1,0]
  v_pk_fma_f16 v190, v190, v58, s21 op_sel_hi:[1,1,0]
  v_mfma_f32_32x32x16_f16 v[80:95], v[196:199], v[184:187], v[80:95]
  s_waitcnt lgkmcnt(3)
  v_pk_fma_f16 v191, v191, v59, s21 op_sel_hi:[1,1,0]
  v_pk_fma_f16 v188, v188, v52, 0.5 op_sel_hi:[1,1,0] clamp
  v_pk_fma_f16 v189, v189, v53, 0.5 op_sel_hi:[1,1,0] clamp
  v_pk_fma_f16 v190, v190, v54, 0.5 op_sel_hi:[1,1,0] clamp
  v_pk_fma_f16 v191, v191, v55, 0.5 op_sel_hi:[1,1,0] clamp
  v_pk_mul_f16 v188, v188, v52
  v_smfmac_f32_32x32x32_bf16 v[152:167], v[240:243], v[120:127], v250
  s_waitcnt lgkmcnt(2)
  ds_read_b128 v[212:215], v1 offset:7168
  v_pk_mul_f16 v189, v189, v53
  v_pk_mul_f16 v190, v190, v54
  v_pk_mul_f16 v191, v191, v55
  v_cvt_pk_f16_f32 v48, v16, v17
  v_mfma_f32_32x32x16_f16 v[96:111], v[200:203], v[184:187], v[96:111]
  s_waitcnt lgkmcnt(2)
  ds_read_b128 v[128:131], v5 offset:128
  ds_read_b128 v[132:135], v5 offset:160
  ds_read_b128 v[168:171], v2 offset:256
  ds_read_b128 v[172:175], v2 offset:288
  ds_read_b128 v[176:179], v2 offset:320
  ds_read_b128 v[180:183], v2 offset:352
  v_mfma_f32_32x32x16_f16 v[64:79], v[204:207], v[188:191], v[64:79]
  s_waitcnt lgkmcnt(7)
  v_cvt_pk_f16_f32 v49, v18, v19
  v_cvt_pk_f16_f32 v50, v20, v21
  v_cvt_pk_f16_f32 v51, v22, v23
  v_cvt_pk_f16_f32 v52, v24, v25
  v_cvt_pk_f16_f32 v53, v26, v27
  v_cvt_pk_f16_f32 v54, v28, v29
  v_mfma_f32_32x32x16_f16 v[80:95], v[208:211], v[188:191], v[80:95]
  s_waitcnt lgkmcnt(6)
  ds_read_b128 v[192:195], v1 offset:8192
  ds_read_b128 v[196:199], v1 offset:9216
  v_cvt_pk_f16_f32 v55, v30, v31
  v_pk_fma_f16 v56, v48, v48, s20 op_sel_hi:[1,1,0] neg_lo:[1,0,0] neg_hi:[1,0,0] clamp
  v_pk_fma_f16 v57, v49, v49, s20 op_sel_hi:[1,1,0] neg_lo:[1,0,0] neg_hi:[1,0,0] clamp
  v_cvt_pk_bf16_f32 v112, v64, v65
  v_mfma_f32_32x32x16_f16 v[96:111], v[212:215], v[188:191], v[96:111]
  s_nop 0
  s_waitcnt lgkmcnt(2)
  v_cvt_pk_bf16_f32 v113, v66, v67
  v_cvt_pk_bf16_f32 v114, v68, v69
  v_cvt_pk_bf16_f32 v115, v70, v71
  v_pk_fma_f16 v58, v50, v50, s20 op_sel_hi:[1,1,0] neg_lo:[1,0,0] neg_hi:[1,0,0] clamp
  v_pk_fma_f16 v59, v51, v51, s20 op_sel_hi:[1,1,0] neg_lo:[1,0,0] neg_hi:[1,0,0] clamp
  v_pk_fma_f16 v184, v56, v56, s20 op_sel:[0,0,1]
  v_smfmac_f32_32x32x32_bf16 v[168:183], v[240:243], v[128:135], v250
  v_pk_fma_f16 v185, v57, v57, s20 op_sel:[0,0,1]
  v_pk_fma_f16 v186, v58, v58, s20 op_sel:[0,0,1]
  v_pk_fma_f16 v187, v59, v59, s20 op_sel:[0,0,1]
  v_pk_fma_f16 v184, v184, v56, s21 op_sel_hi:[1,1,0]
  v_pk_fma_f16 v185, v185, v57, s21 op_sel_hi:[1,1,0]
  v_mfma_f32_32x32x16_bf16 v[16:31], a[0:3], v[216:219], 0
  v_pk_fma_f16 v186, v186, v58, s21 op_sel_hi:[1,1,0]
  v_pk_fma_f16 v187, v187, v59, s21 op_sel_hi:[1,1,0]
  v_pk_fma_f16 v184, v184, v48, 0.5 op_sel_hi:[1,1,0] clamp
  v_pk_fma_f16 v185, v185, v49, 0.5 op_sel_hi:[1,1,0] clamp
  v_pk_fma_f16 v186, v186, v50, 0.5 op_sel_hi:[1,1,0] clamp
  v_pk_fma_f16 v187, v187, v51, 0.5 op_sel_hi:[1,1,0] clamp
  v_mfma_f32_32x32x16_bf16 v[16:31], a[4:7], v[220:223], v[16:31]
  ds_read_b128 v[200:203], v1 offset:10240
  v_pk_mul_f16 v184, v184, v48
  v_pk_mul_f16 v185, v185, v49
  v_pk_mul_f16 v186, v186, v50
  v_pk_mul_f16 v187, v187, v51
  v_cvt_pk_bf16_f32 v116, v72, v73
  v_mfma_f32_32x32x16_bf16 v[16:31], a[8:11], v[224:227], v[16:31]
  ds_read_b128 v[204:207], v1 offset:11264
  ds_read_b128 v[208:211], v1 offset:12288
  v_cvt_pk_bf16_f32 v117, v74, v75
  v_cvt_pk_bf16_f32 v118, v76, v77
  v_cvt_pk_bf16_f32 v119, v78, v79
  v_cvt_pk_bf16_f32 v120, v80, v81
  v_mfma_f32_32x32x16_bf16 v[16:31], a[12:15], v[228:231], v[16:31]
  ds_write_b128 v251, v[112:115]
  v_cvt_pk_bf16_f32 v121, v82, v83
  v_mfma_f32_32x32x16_bf16 v[16:31], a[16:19], v[232:235], v[16:31]
  v_cvt_pk_bf16_f32 v122, v84, v85
  v_cvt_pk_bf16_f32 v123, v86, v87
  v_cvt_pk_bf16_f32 v124, v88, v89
  v_cvt_pk_bf16_f32 v125, v90, v91
  v_cvt_pk_bf16_f32 v126, v92, v93
  v_cvt_pk_bf16_f32 v127, v94, v95
  v_mfma_f32_32x32x16_bf16 v[16:31], a[20:23], v[236:239], v[16:31]
  s_waitcnt lgkmcnt(4)
  ds_write_b128 v251, v[116:119] offset:2064
  v_pk_fma_f16 v56, v52, v52, s20 op_sel_hi:[1,1,0] neg_lo:[1,0,0] neg_hi:[1,0,0] clamp
  v_mfma_f32_32x32x16_f16 v[64:79], v[192:195], v[184:187], v[136:151]
  v_pk_fma_f16 v57, v53, v53, s20 op_sel_hi:[1,1,0] neg_lo:[1,0,0] neg_hi:[1,0,0] clamp
  v_pk_fma_f16 v58, v54, v54, s20 op_sel_hi:[1,1,0] neg_lo:[1,0,0] neg_hi:[1,0,0] clamp
  v_pk_fma_f16 v59, v55, v55, s20 op_sel_hi:[1,1,0] neg_lo:[1,0,0] neg_hi:[1,0,0] clamp
  v_pk_fma_f16 v188, v56, v56, s20 op_sel:[0,0,1]
  v_pk_fma_f16 v189, v57, v57, s20 op_sel:[0,0,1]
  v_pk_fma_f16 v190, v58, v58, s20 op_sel:[0,0,1]
  v_mfma_f32_32x32x16_f16 v[80:95], v[196:199], v[184:187], v[152:167]
  s_waitcnt lgkmcnt(2)
  ds_read_b128 v[212:215], v1 offset:13312
  v_pk_fma_f16 v191, v59, v59, s20 op_sel:[0,0,1]
  v_pk_fma_f16 v188, v188, v56, s21 op_sel_hi:[1,1,0]
  v_pk_fma_f16 v189, v189, v57, s21 op_sel_hi:[1,1,0]
  v_pk_fma_f16 v190, v190, v58, s21 op_sel_hi:[1,1,0]
  v_pk_fma_f16 v191, v191, v59, s21 op_sel_hi:[1,1,0]
  v_pk_fma_f16 v188, v188, v52, 0.5 op_sel_hi:[1,1,0] clamp
  v_pk_fma_f16 v189, v189, v53, 0.5 op_sel_hi:[1,1,0] clamp
  v_pk_fma_f16 v190, v190, v54, 0.5 op_sel_hi:[1,1,0] clamp
  v_pk_fma_f16 v191, v191, v55, 0.5 op_sel_hi:[1,1,0] clamp
  v_pk_mul_f16 v188, v188, v52
  v_pk_mul_f16 v189, v189, v53
  v_pk_mul_f16 v190, v190, v54
  v_pk_mul_f16 v191, v191, v55
  v_cvt_pk_bf16_f32 v128, v96, v97
  v_cvt_pk_bf16_f32 v129, v98, v99
  v_cvt_pk_bf16_f32 v130, v100, v101
  v_cvt_pk_bf16_f32 v131, v102, v103
  v_cvt_pk_bf16_f32 v132, v104, v105
  v_cvt_pk_bf16_f32 v133, v106, v107
  v_cvt_pk_bf16_f32 v134, v108, v109
  v_cvt_pk_bf16_f32 v135, v110, v111
  v_mfma_f32_32x32x16_f16 v[96:111], v[200:203], v[184:187], v[168:183]
  ds_write_b128 v251, v[120:123] offset:1024
  v_cvt_pk_f16_f32 v48, v16, v17
  v_mfma_f32_32x32x16_f16 v[64:79], v[204:207], v[188:191], v[64:79]
  v_cvt_pk_f16_f32 v49, v18, v19
  v_cvt_pk_f16_f32 v50, v20, v21
  v_cvt_pk_f16_f32 v51, v22, v23
  v_cvt_pk_f16_f32 v52, v24, v25
  v_cvt_pk_f16_f32 v53, v26, v27
  v_cvt_pk_f16_f32 v54, v28, v29
  v_mfma_f32_32x32x16_f16 v[80:95], v[208:211], v[188:191], v[80:95]
  s_waitcnt lgkmcnt(1)
  ds_write_b128 v251, v[124:127] offset:3088
  v_cvt_pk_f16_f32 v55, v30, v31
  v_mfma_f32_32x32x16_f16 v[96:111], v[212:215], v[188:191], v[96:111]
  s_nop 0
  ds_read_b128 v[112:115], v254
  ds_read_b128 v[116:119], v254 offset:256
  ds_read_b128 v[192:195], v1 offset:14336
  v_pk_fma_f16 v56, v48, v48, s20 op_sel_hi:[1,1,0] neg_lo:[1,0,0] neg_hi:[1,0,0] clamp
  v_pk_fma_f16 v57, v49, v49, s20 op_sel_hi:[1,1,0] neg_lo:[1,0,0] neg_hi:[1,0,0] clamp
  v_pk_fma_f16 v58, v50, v50, s20 op_sel_hi:[1,1,0] neg_lo:[1,0,0] neg_hi:[1,0,0] clamp
  v_mfma_f32_32x32x16_bf16 v[16:31], a[24:27], v[216:219], 0
  ds_read_b128 v[196:199], v1 offset:15360
  ds_write_b128 v252, v[128:131] offset:1024
  v_mfma_f32_32x32x16_bf16 v[16:31], a[28:31], v[220:223], v[16:31]
  v_pk_fma_f16 v59, v51, v51, s20 op_sel_hi:[1,1,0] neg_lo:[1,0,0] neg_hi:[1,0,0] clamp
  v_pk_fma_f16 v184, v56, v56, s20 op_sel:[0,0,1]
  v_pk_fma_f16 v185, v57, v57, s20 op_sel:[0,0,1]
  v_pk_fma_f16 v186, v58, v58, s20 op_sel:[0,0,1]
  v_pk_fma_f16 v187, v59, v59, s20 op_sel:[0,0,1]
  v_pk_fma_f16 v184, v184, v56, s21 op_sel_hi:[1,1,0]
  v_mfma_f32_32x32x16_bf16 v[16:31], a[32:35], v[224:227], v[16:31]
  ds_write_b128 v252, v[132:135] offset:3088
  v_pk_fma_f16 v185, v185, v57, s21 op_sel_hi:[1,1,0]
  v_mfma_f32_32x32x16_bf16 v[16:31], a[36:39], v[228:231], v[16:31]
  v_pk_fma_f16 v186, v186, v58, s21 op_sel_hi:[1,1,0]
  v_pk_fma_f16 v187, v187, v59, s21 op_sel_hi:[1,1,0]
  v_pk_fma_f16 v184, v184, v48, 0.5 op_sel_hi:[1,1,0] clamp
  v_pk_fma_f16 v185, v185, v49, 0.5 op_sel_hi:[1,1,0] clamp
  v_pk_fma_f16 v186, v186, v50, 0.5 op_sel_hi:[1,1,0] clamp
  v_pk_fma_f16 v187, v187, v51, 0.5 op_sel_hi:[1,1,0] clamp
  v_mfma_f32_32x32x16_bf16 v[16:31], a[40:43], v[232:235], v[16:31]
  ds_read_b128 v[200:203], v1 offset:16384
  buffer_load_dwordx4 v6, s[4:7], s29 offen lds
  buffer_load_dwordx4 v7, s[4:7], s29 offen offset:1024 lds
  buffer_load_dwordx4 v8, s[4:7], s29 offen offset:2048 lds
  buffer_load_dwordx4 v9, s[4:7], s29 offen offset:3072 lds
  v_pk_mul_f16 v184, v184, v48
  v_pk_mul_f16 v185, v185, v49
  v_pk_mul_f16 v186, v186, v50
  v_pk_mul_f16 v187, v187, v51
  v_mfma_f32_32x32x16_bf16 v[16:31], a[44:47], v[236:239], v[16:31]
  s_waitcnt lgkmcnt(3)
  s_nop 0
  ds_read_b128 v[204:207], v1 offset:17408
  ds_read_b128 v[208:211], v1 offset:18432
  v_pk_fma_f16 v56, v52, v52, s20 op_sel_hi:[1,1,0] neg_lo:[1,0,0] neg_hi:[1,0,0] clamp
  v_pk_fma_f16 v57, v53, v53, s20 op_sel_hi:[1,1,0] neg_lo:[1,0,0] neg_hi:[1,0,0] clamp
  v_pk_fma_f16 v58, v54, v54, s20 op_sel_hi:[1,1,0] neg_lo:[1,0,0] neg_hi:[1,0,0] clamp
  v_pk_fma_f16 v59, v55, v55, s20 op_sel_hi:[1,1,0] neg_lo:[1,0,0] neg_hi:[1,0,0] clamp
  v_mfma_f32_32x32x16_f16 v[64:79], v[192:195], v[184:187], v[64:79]
  s_mov_b32 m0, s31
  buffer_store_dwordx4 v[112:115], v10, s[8:11], s28 offen sc1 nt
  v_pk_fma_f16 v188, v56, v56, s20 op_sel:[0,0,1]
  v_mfma_f32_32x32x16_f16 v[80:95], v[196:199], v[184:187], v[80:95]
  s_waitcnt lgkmcnt(2)
  ds_read_b128 v[212:215], v1 offset:19456
  buffer_load_dwordx4 v6, s[4:7], s52 offen lds
  buffer_load_dwordx4 v7, s[4:7], s52 offen offset:1024 lds
  buffer_load_dwordx4 v8, s[4:7], s52 offen offset:2048 lds
  buffer_load_dwordx4 v9, s[4:7], s52 offen offset:3072 lds
  v_pk_fma_f16 v189, v57, v57, s20 op_sel:[0,0,1]
  v_pk_fma_f16 v190, v58, v58, s20 op_sel:[0,0,1]
  v_pk_fma_f16 v191, v59, v59, s20 op_sel:[0,0,1]
  v_pk_fma_f16 v188, v188, v56, s21 op_sel_hi:[1,1,0]
  v_pk_fma_f16 v189, v189, v57, s21 op_sel_hi:[1,1,0]
  v_pk_fma_f16 v190, v190, v58, s21 op_sel_hi:[1,1,0]
  v_pk_fma_f16 v191, v191, v59, s21 op_sel_hi:[1,1,0]
  v_pk_fma_f16 v188, v188, v52, 0.5 op_sel_hi:[1,1,0] clamp
  v_pk_fma_f16 v189, v189, v53, 0.5 op_sel_hi:[1,1,0] clamp
  v_pk_fma_f16 v190, v190, v54, 0.5 op_sel_hi:[1,1,0] clamp
  v_pk_fma_f16 v191, v191, v55, 0.5 op_sel_hi:[1,1,0] clamp
  v_pk_mul_f16 v188, v188, v52
  v_pk_mul_f16 v189, v189, v53
  v_pk_mul_f16 v190, v190, v54
  v_pk_mul_f16 v191, v191, v55
  v_mfma_f32_32x32x16_f16 v[96:111], v[200:203], v[184:187], v[96:111]
  s_waitcnt lgkmcnt(2)
  ds_read_b128 v[120:123], v255 offset:1024
  v_cvt_pk_f16_f32 v48, v16, v17
  v_cvt_pk_f16_f32 v49, v18, v19
  v_cvt_pk_f16_f32 v50, v20, v21
  v_cvt_pk_f16_f32 v51, v22, v23
  v_cvt_pk_f16_f32 v52, v24, v25
  v_mfma_f32_32x32x16_f16 v[64:79], v[204:207], v[188:191], v[64:79]
  s_waitcnt lgkmcnt(2)
  ds_read_b128 v[192:195], v1 offset:20480
  ds_read_b128 v[124:127], v255 offset:1280
  ds_read_b128 v[196:199], v1 offset:21504
  v_cvt_pk_f16_f32 v53, v26, v27
  v_cvt_pk_f16_f32 v54, v28, v29
  v_cvt_pk_f16_f32 v55, v30, v31
  v_mfma_f32_32x32x16_f16 v[80:95], v[208:211], v[188:191], v[80:95]
  s_waitcnt lgkmcnt(4)
  buffer_store_dwordx4 v[116:119], v10, s[8:11], s59 offen sc1 nt
  v_pk_fma_f16 v56, v48, v48, s20 op_sel_hi:[1,1,0] neg_lo:[1,0,0] neg_hi:[1,0,0] clamp
  v_mfma_f32_32x32x16_f16 v[96:111], v[212:215], v[188:191], v[96:111]
  s_cmp_eq_u32 s26, 1
  v_pk_fma_f16 v57, v49, v49, s20 op_sel_hi:[1,1,0] neg_lo:[1,0,0] neg_hi:[1,0,0] clamp
  v_pk_fma_f16 v58, v50, v50, s20 op_sel_hi:[1,1,0] neg_lo:[1,0,0] neg_hi:[1,0,0] clamp
  v_pk_fma_f16 v59, v51, v51, s20 op_sel_hi:[1,1,0] neg_lo:[1,0,0] neg_hi:[1,0,0] clamp
  v_pk_fma_f16 v184, v56, v56, s20 op_sel:[0,0,1]
  v_pk_fma_f16 v185, v57, v57, s20 op_sel:[0,0,1]
  v_pk_fma_f16 v186, v58, v58, s20 op_sel:[0,0,1]
  v_mfma_f32_32x32x16_bf16 v[16:31], a[48:51], v[216:219], 0
  s_cselect_b32 s35, 0x40000000, s23
  v_pk_fma_f16 v187, v59, v59, s20 op_sel:[0,0,1]
  v_pk_fma_f16 v184, v184, v56, s21 op_sel_hi:[1,1,0]
  v_pk_fma_f16 v185, v185, v57, s21 op_sel_hi:[1,1,0]
  v_pk_fma_f16 v186, v186, v58, s21 op_sel_hi:[1,1,0]
  v_pk_fma_f16 v187, v187, v59, s21 op_sel_hi:[1,1,0]
  v_pk_fma_f16 v184, v184, v48, 0.5 op_sel_hi:[1,1,0] clamp
  v_mfma_f32_32x32x16_bf16 v[16:31], a[52:55], v[220:223], v[16:31]
  s_add_u32 s29, s29, s35
  v_pk_fma_f16 v185, v185, v49, 0.5 op_sel_hi:[1,1,0] clamp
  v_pk_fma_f16 v186, v186, v50, 0.5 op_sel_hi:[1,1,0] clamp
  v_pk_fma_f16 v187, v187, v51, 0.5 op_sel_hi:[1,1,0] clamp
  v_pk_mul_f16 v184, v184, v48
  v_pk_mul_f16 v185, v185, v49
  v_pk_mul_f16 v186, v186, v50
  v_mfma_f32_32x32x16_bf16 v[16:31], a[56:59], v[224:227], v[16:31]
  s_waitcnt lgkmcnt(0)
  buffer_store_dwordx4 v[120:123], v10, s[8:11], s28 offen offset:128 sc1 nt
  v_pk_mul_f16 v187, v187, v51
  v_mfma_f32_32x32x16_bf16 v[16:31], a[60:63], v[228:231], v[16:31]
  s_add_u32 s52, s52, s35
  ds_read_b128 v[200:203], v1 offset:22528
  ds_read_b128 v[204:207], v1 offset:23552
  ds_read_b128 v[208:211], v1 offset:24576
  v_pk_fma_f16 v56, v52, v52, s20 op_sel_hi:[1,1,0] neg_lo:[1,0,0] neg_hi:[1,0,0] clamp
  v_pk_fma_f16 v57, v53, v53, s20 op_sel_hi:[1,1,0] neg_lo:[1,0,0] neg_hi:[1,0,0] clamp
  v_pk_fma_f16 v58, v54, v54, s20 op_sel_hi:[1,1,0] neg_lo:[1,0,0] neg_hi:[1,0,0] clamp
  v_mfma_f32_32x32x16_bf16 v[16:31], a[64:67], v[232:235], v[16:31]
  s_mov_b32 s32, s30
  ds_read_b128 v[128:131], v254 offset:1040
  v_pk_fma_f16 v59, v55, v55, s20 op_sel_hi:[1,1,0] neg_lo:[1,0,0] neg_hi:[1,0,0] clamp
  v_pk_fma_f16 v188, v56, v56, s20 op_sel:[0,0,1]
  v_pk_fma_f16 v189, v57, v57, s20 op_sel:[0,0,1]
  v_pk_fma_f16 v190, v58, v58, s20 op_sel:[0,0,1]
  v_pk_fma_f16 v191, v59, v59, s20 op_sel:[0,0,1]
  v_mfma_f32_32x32x16_bf16 v[16:31], a[68:71], v[236:239], v[16:31]
  s_add_u32 s30, s33, 32
  v_pk_fma_f16 v188, v188, v56, s21 op_sel_hi:[1,1,0]
  v_pk_fma_f16 v189, v189, v57, s21 op_sel_hi:[1,1,0]
  v_pk_fma_f16 v190, v190, v58, s21 op_sel_hi:[1,1,0]
  v_pk_fma_f16 v191, v191, v59, s21 op_sel_hi:[1,1,0]
  v_pk_fma_f16 v188, v188, v52, 0.5 op_sel_hi:[1,1,0] clamp
  v_pk_fma_f16 v189, v189, v53, 0.5 op_sel_hi:[1,1,0] clamp
  v_mfma_f32_32x32x16_f16 v[64:79], v[192:195], v[184:187], v[64:79]
  s_mov_b32 s33, s31
  buffer_store_dwordx4 v[124:127], v10, s[8:11], s59 offen offset:128 sc1 nt
  v_pk_fma_f16 v190, v190, v54, 0.5 op_sel_hi:[1,1,0] clamp
  v_mfma_f32_32x32x16_f16 v[80:95], v[196:199], v[184:187], v[80:95]
  s_waitcnt lgkmcnt(3)
  ds_read_b128 v[212:215], v1 offset:25600
  v_pk_fma_f16 v191, v191, v55, 0.5 op_sel_hi:[1,1,0] clamp
  v_pk_mul_f16 v188, v188, v52
  v_pk_mul_f16 v189, v189, v53
  v_pk_mul_f16 v190, v190, v54
  v_pk_mul_f16 v191, v191, v55
  v_mfma_f32_32x32x16_f16 v[96:111], v[200:203], v[184:187], v[96:111]
  s_waitcnt lgkmcnt(2)
  ds_read_b128 v[132:135], v254 offset:1296
  v_cvt_pk_f16_f32 v48, v16, v17
  v_cvt_pk_f16_f32 v49, v18, v19
  v_cvt_pk_f16_f32 v50, v20, v21
  v_cvt_pk_f16_f32 v51, v22, v23
  v_cvt_pk_f16_f32 v52, v24, v25
  v_mfma_f32_32x32x16_f16 v[64:79], v[204:207], v[188:191], v[64:79]
  s_sub_u32 s31, s32, 32
  ds_read_b128 v[192:195], v1 offset:26624
  ds_read_b128 v[196:199], v1 offset:27648
  v_cvt_pk_f16_f32 v53, v26, v27
  v_cvt_pk_f16_f32 v54, v28, v29
  v_cvt_pk_f16_f32 v55, v30, v31
  v_pk_fma_f16 v56, v48, v48, s20 op_sel_hi:[1,1,0] neg_lo:[1,0,0] neg_hi:[1,0,0] clamp
  v_mfma_f32_32x32x16_f16 v[80:95], v[208:211], v[188:191], v[80:95]
  s_waitcnt lgkmcnt(3)
  buffer_store_dwordx4 v[128:131], v10, s[8:11], s28 offen offset:256 sc1 nt
  v_pk_fma_f16 v57, v49, v49, s20 op_sel_hi:[1,1,0] neg_lo:[1,0,0] neg_hi:[1,0,0] clamp
  v_mfma_f32_32x32x16_f16 v[96:111], v[212:215], v[188:191], v[96:111]
  s_nop 0
  v_pk_fma_f16 v58, v50, v50, s20 op_sel_hi:[1,1,0] neg_lo:[1,0,0] neg_hi:[1,0,0] clamp
  v_pk_fma_f16 v59, v51, v51, s20 op_sel_hi:[1,1,0] neg_lo:[1,0,0] neg_hi:[1,0,0] clamp
  v_pk_fma_f16 v184, v56, v56, s20 op_sel:[0,0,1]
  v_pk_fma_f16 v185, v57, v57, s20 op_sel:[0,0,1]
  v_pk_fma_f16 v186, v58, v58, s20 op_sel:[0,0,1]
  v_pk_fma_f16 v187, v59, v59, s20 op_sel:[0,0,1]
  v_mfma_f32_32x32x16_bf16 v[16:31], a[72:75], v[216:219], 0
  v_pk_fma_f16 v184, v184, v56, s21 op_sel_hi:[1,1,0]
  v_pk_fma_f16 v185, v185, v57, s21 op_sel_hi:[1,1,0]
  v_pk_fma_f16 v186, v186, v58, s21 op_sel_hi:[1,1,0]
  v_pk_fma_f16 v187, v187, v59, s21 op_sel_hi:[1,1,0]
  v_pk_fma_f16 v184, v184, v48, 0.5 op_sel_hi:[1,1,0] clamp
  v_pk_fma_f16 v185, v185, v49, 0.5 op_sel_hi:[1,1,0] clamp
  v_mfma_f32_32x32x16_bf16 v[16:31], a[76:79], v[220:223], v[16:31]
  v_pk_fma_f16 v186, v186, v50, 0.5 op_sel_hi:[1,1,0] clamp
  v_pk_fma_f16 v187, v187, v51, 0.5 op_sel_hi:[1,1,0] clamp
  v_pk_mul_f16 v184, v184, v48
  v_pk_mul_f16 v185, v185, v49
  v_pk_mul_f16 v186, v186, v50
  v_pk_mul_f16 v187, v187, v51
  v_mfma_f32_32x32x16_bf16 v[16:31], a[80:83], v[224:227], v[16:31]
  s_waitcnt lgkmcnt(0)
  ds_read_b128 v[200:203], v1 offset:28672
  buffer_store_dwordx4 v[132:135], v10, s[8:11], s59 offen offset:256 sc1 nt
  v_mfma_f32_32x32x16_bf16 v[16:31], a[84:87], v[228:231], v[16:31]
  s_nop 0
  ds_read_b128 v[204:207], v1 offset:29696
  ds_read_b128 v[208:211], v1 offset:30720
  v_pk_fma_f16 v56, v52, v52, s20 op_sel_hi:[1,1,0] neg_lo:[1,0,0] neg_hi:[1,0,0] clamp
  v_pk_fma_f16 v57, v53, v53, s20 op_sel_hi:[1,1,0] neg_lo:[1,0,0] neg_hi:[1,0,0] clamp
  v_pk_fma_f16 v58, v54, v54, s20 op_sel_hi:[1,1,0] neg_lo:[1,0,0] neg_hi:[1,0,0] clamp
  v_pk_fma_f16 v59, v55, v55, s20 op_sel_hi:[1,1,0] neg_lo:[1,0,0] neg_hi:[1,0,0] clamp
  v_mfma_f32_32x32x16_bf16 v[16:31], a[88:91], v[232:235], v[16:31]
  v_pk_fma_f16 v188, v56, v56, s20 op_sel:[0,0,1]
  v_pk_fma_f16 v189, v57, v57, s20 op_sel:[0,0,1]
  v_pk_fma_f16 v190, v58, v58, s20 op_sel:[0,0,1]
  v_pk_fma_f16 v191, v59, v59, s20 op_sel:[0,0,1]
  v_pk_fma_f16 v188, v188, v56, s21 op_sel_hi:[1,1,0]
  v_pk_fma_f16 v189, v189, v57, s21 op_sel_hi:[1,1,0]
  v_mfma_f32_32x32x16_bf16 v[16:31], a[92:95], v[236:239], v[16:31]
  v_pk_fma_f16 v190, v190, v58, s21 op_sel_hi:[1,1,0]
  v_pk_fma_f16 v191, v191, v59, s21 op_sel_hi:[1,1,0]
  v_pk_fma_f16 v188, v188, v52, 0.5 op_sel_hi:[1,1,0] clamp
  v_pk_fma_f16 v189, v189, v53, 0.5 op_sel_hi:[1,1,0] clamp
  v_pk_fma_f16 v190, v190, v54, 0.5 op_sel_hi:[1,1,0] clamp
  v_pk_fma_f16 v191, v191, v55, 0.5 op_sel_hi:[1,1,0] clamp
  v_mfma_f32_32x32x16_f16 v[64:79], v[192:195], v[184:187], v[64:79]
  s_nop 0
  buffer_load_dword v249, v248, s[4:7], s29 offen
  v_pk_mul_f16 v188, v188, v52
  v_pk_mul_f16 v189, v189, v53
  v_mfma_f32_32x32x16_f16 v[80:95], v[196:199], v[184:187], v[80:95]
  s_waitcnt lgkmcnt(2)
  ds_read_b128 v[212:215], v1 offset:31744
  v_pk_mul_f16 v190, v190, v54
  v_pk_mul_f16 v191, v191, v55
  v_subrev_u32 v14, 0x4100, v5
  v_add_u32 v5, 0x8200, v5
  v_min_u32_e64 v5, v14, v5
  v_subrev_u32 v14, 0x4100, v4
  v_add_u32 v4, 0x8200, v4
  v_min_u32_e64 v4, v14, v4
  v_mfma_f32_32x32x16_f16 v[96:111], v[200:203], v[184:187], v[96:111]
  s_waitcnt vmcnt(6) lgkmcnt(1)
  ds_read_b128 v[160:163], v3 offset:2400
  ds_read_b128 v[164:167], v4 offset:96
  ds_read_b128 v[168:171], v4 offset:288
  v_cvt_pk_f16_f32 v48, v16, v17
  v_cvt_pk_f16_f32 v49, v18, v19
  v_cvt_pk_f16_f32 v50, v20, v21
  v_mfma_f32_32x32x16_f16 v[64:79], v[204:207], v[188:191], v[64:79]
  s_sub_u32 s26, s26, 1
  ds_read_b128 v[172:175], v4 offset:480
  ds_read2_b64 v[176:179], v11 offset0:192 offset1:200
  v_cvt_pk_f16_f32 v51, v22, v23
  v_cvt_pk_f16_f32 v52, v24, v25
  v_cvt_pk_f16_f32 v53, v26, v27
  v_cvt_pk_f16_f32 v54, v28, v29
  v_mfma_f32_32x32x16_f16 v[80:95], v[208:211], v[188:191], v[80:95]
  s_nop 0
  s_waitcnt lgkmcnt(5)
  v_cvt_pk_f16_f32 v55, v30, v31
  v_pk_fma_f16 v56, v48, v48, s20 op_sel_hi:[1,1,0] neg_lo:[1,0,0] neg_hi:[1,0,0] clamp
  v_pk_fma_f16 v57, v49, v49, s20 op_sel_hi:[1,1,0] neg_lo:[1,0,0] neg_hi:[1,0,0] clamp
  v_pk_fma_f16 v58, v50, v50, s20 op_sel_hi:[1,1,0] neg_lo:[1,0,0] neg_hi:[1,0,0] clamp
  v_pk_fma_f16 v59, v51, v51, s20 op_sel_hi:[1,1,0] neg_lo:[1,0,0] neg_hi:[1,0,0] clamp
  v_pk_fma_f16 v184, v56, v56, s20 op_sel:[0,0,1]
  v_mfma_f32_32x32x16_f16 v[96:111], v[212:215], v[188:191], v[96:111]
  s_waitcnt lgkmcnt(0)
  v_pk_fma_f16 v185, v57, v57, s20 op_sel:[0,0,1]
  v_pk_fma_f16 v186, v58, v58, s20 op_sel:[0,0,1]
  v_pk_fma_f16 v187, v59, v59, s20 op_sel:[0,0,1]
  s_cbranch_scc0 L_loop
  v_mfma_f32_32x32x16_bf16 v[16:31], a[96:99], v[216:219], 0
  s_add_u32 s28, s28, 0x60000
  ds_read_b128 v[192:195], v0 offset:24576
  ds_read_b128 v[196:199], v0 offset:25600
  v_pk_fma_f16 v184, v184, v56, s21 op_sel_hi:[1,1,0]
  v_pk_fma_f16 v185, v185, v57, s21 op_sel_hi:[1,1,0]
  v_pk_fma_f16 v186, v186, v58, s21 op_sel_hi:[1,1,0]
  v_pk_fma_f16 v187, v187, v59, s21 op_sel_hi:[1,1,0]
  v_mfma_f32_32x32x16_bf16 v[16:31], a[100:103], v[220:223], v[16:31]
  s_add_u32 s59, s59, 0x60000
  v_pk_fma_f16 v184, v184, v48, 0.5 op_sel_hi:[1,1,0] clamp
  v_pk_fma_f16 v185, v185, v49, 0.5 op_sel_hi:[1,1,0] clamp
  v_pk_fma_f16 v186, v186, v50, 0.5 op_sel_hi:[1,1,0] clamp
  v_pk_fma_f16 v187, v187, v51, 0.5 op_sel_hi:[1,1,0] clamp
  v_pk_mul_f16 v184, v184, v48
  v_pk_mul_f16 v185, v185, v49
  v_mfma_f32_32x32x16_bf16 v[16:31], a[104:107], v[224:227], v[16:31]
  ds_read_b128 v[200:203], v0 offset:26624
  ds_read_b128 v[204:207], v0 offset:27648
  ds_read_b128 v[208:211], v0 offset:28672
  v_pk_mul_f16 v186, v186, v50
  v_pk_mul_f16 v187, v187, v51
  v_pk_fma_f16 v56, v52, v52, s20 op_sel_hi:[1,1,0] neg_lo:[1,0,0] neg_hi:[1,0,0] clamp
  v_mfma_f32_32x32x16_bf16 v[16:31], a[108:111], v[228:231], v[16:31]
  v_pk_fma_f16 v57, v53, v53, s20 op_sel_hi:[1,1,0] neg_lo:[1,0,0] neg_hi:[1,0,0] clamp
  v_pk_fma_f16 v58, v54, v54, s20 op_sel_hi:[1,1,0] neg_lo:[1,0,0] neg_hi:[1,0,0] clamp
  v_pk_fma_f16 v59, v55, v55, s20 op_sel_hi:[1,1,0] neg_lo:[1,0,0] neg_hi:[1,0,0] clamp
  v_pk_fma_f16 v188, v56, v56, s20 op_sel:[0,0,1]
  v_pk_fma_f16 v189, v57, v57, s20 op_sel:[0,0,1]
  v_pk_fma_f16 v190, v58, v58, s20 op_sel:[0,0,1]
  v_mfma_f32_32x32x16_bf16 v[16:31], a[112:115], v[232:235], v[16:31]
  v_pk_fma_f16 v191, v59, v59, s20 op_sel:[0,0,1]
  v_pk_fma_f16 v188, v188, v56, s21 op_sel_hi:[1,1,0]
  v_pk_fma_f16 v189, v189, v57, s21 op_sel_hi:[1,1,0]
  v_pk_fma_f16 v190, v190, v58, s21 op_sel_hi:[1,1,0]
  v_pk_fma_f16 v191, v191, v59, s21 op_sel_hi:[1,1,0]
  v_pk_fma_f16 v188, v188, v52, 0.5 op_sel_hi:[1,1,0] clamp
  v_mfma_f32_32x32x16_bf16 v[16:31], a[116:119], v[236:239], v[16:31]
  s_waitcnt lgkmcnt(3)
  s_nop 0
  v_pk_fma_f16 v189, v189, v53, 0.5 op_sel_hi:[1,1,0] clamp
  v_pk_fma_f16 v190, v190, v54, 0.5 op_sel_hi:[1,1,0] clamp
  v_pk_fma_f16 v191, v191, v55, 0.5 op_sel_hi:[1,1,0] clamp
  v_pk_mul_f16 v188, v188, v52
  v_pk_mul_f16 v189, v189, v53
  v_pk_mul_f16 v190, v190, v54
  v_mfma_f32_32x32x16_f16 v[64:79], v[192:195], v[184:187], v[64:79]
  ds_read_b128 v[212:215], v0 offset:29696
  ds_read_b128 v[192:195], v0 offset:30720
  v_pk_mul_f16 v191, v191, v55
  s_nop 1
  v_cvt_pk_f16_f32 v48, v16, v17
  v_mfma_f32_32x32x16_f16 v[80:95], v[196:199], v[184:187], v[80:95]
  s_waitcnt lgkmcnt(2)
  v_cvt_pk_f16_f32 v49, v18, v19
  v_cvt_pk_f16_f32 v50, v20, v21
  v_cvt_pk_f16_f32 v51, v22, v23
  v_cvt_pk_f16_f32 v52, v24, v25
  v_cvt_pk_f16_f32 v53, v26, v27
  v_cvt_pk_f16_f32 v54, v28, v29
  v_mfma_f32_32x32x16_f16 v[96:111], v[200:203], v[184:187], v[96:111]
  ds_read_b128 v[196:199], v0 offset:31744
  v_cvt_pk_f16_f32 v55, v30, v31
  v_pk_fma_f16 v56, v48, v48, s20 op_sel_hi:[1,1,0] neg_lo:[1,0,0] neg_hi:[1,0,0] clamp
  v_pk_fma_f16 v57, v49, v49, s20 op_sel_hi:[1,1,0] neg_lo:[1,0,0] neg_hi:[1,0,0] clamp
  v_pk_fma_f16 v58, v50, v50, s20 op_sel_hi:[1,1,0] neg_lo:[1,0,0] neg_hi:[1,0,0] clamp
  v_pk_fma_f16 v59, v51, v51, s20 op_sel_hi:[1,1,0] neg_lo:[1,0,0] neg_hi:[1,0,0] clamp
  v_mfma_f32_32x32x16_f16 v[64:79], v[204:207], v[188:191], v[64:79]
  v_pk_fma_f16 v184, v56, v56, s20 op_sel:[0,0,1]
  v_pk_fma_f16 v185, v57, v57, s20 op_sel:[0,0,1]
  v_pk_fma_f16 v186, v58, v58, s20 op_sel:[0,0,1]
  v_pk_fma_f16 v187, v59, v59, s20 op_sel:[0,0,1]
  v_pk_fma_f16 v184, v184, v56, s21 op_sel_hi:[1,1,0]
  v_pk_fma_f16 v185, v185, v57, s21 op_sel_hi:[1,1,0]
  v_mfma_f32_32x32x16_f16 v[80:95], v[208:211], v[188:191], v[80:95]
  s_waitcnt lgkmcnt(2)
  v_pk_fma_f16 v186, v186, v58, s21 op_sel_hi:[1,1,0]
  v_pk_fma_f16 v187, v187, v59, s21 op_sel_hi:[1,1,0]
  v_pk_fma_f16 v184, v184, v48, 0.5 op_sel_hi:[1,1,0] clamp
  v_pk_fma_f16 v185, v185, v49, 0.5 op_sel_hi:[1,1,0] clamp
  v_pk_fma_f16 v186, v186, v50, 0.5 op_sel_hi:[1,1,0] clamp
  v_pk_fma_f16 v187, v187, v51, 0.5 op_sel_hi:[1,1,0] clamp
  v_mfma_f32_32x32x16_f16 v[96:111], v[212:215], v[188:191], v[96:111]
  s_nop 0
  ds_read_b128 v[200:203], v0 offset:32768
  ds_read_b128 v[204:207], v0 offset:33792
  v_pk_mul_f16 v184, v184, v48
  v_pk_mul_f16 v185, v185, v49
  v_pk_mul_f16 v186, v186, v50
  v_pk_mul_f16 v187, v187, v51
  v_mfma_f32_32x32x16_bf16 v[16:31], a[120:123], v[216:219], 0
  ds_read_b128 v[12:15], v2 offset:384
  ds_read_b128 v[208:211], v0 offset:34816
  v_pk_fma_f16 v56, v52, v52, s20 op_sel_hi:[1,1,0] neg_lo:[1,0,0] neg_hi:[1,0,0] clamp
  v_pk_fma_f16 v57, v53, v53, s20 op_sel_hi:[1,1,0] neg_lo:[1,0,0] neg_hi:[1,0,0] clamp
  v_pk_fma_f16 v58, v54, v54, s20 op_sel_hi:[1,1,0] neg_lo:[1,0,0] neg_hi:[1,0,0] clamp
  v_pk_fma_f16 v59, v55, v55, s20 op_sel_hi:[1,1,0] neg_lo:[1,0,0] neg_hi:[1,0,0] clamp
  v_mfma_f32_32x32x16_bf16 v[16:31], a[124:127], v[220:223], v[16:31]
  v_pk_fma_f16 v188, v56, v56, s20 op_sel:[0,0,1]
  v_pk_fma_f16 v189, v57, v57, s20 op_sel:[0,0,1]
  v_pk_fma_f16 v190, v58, v58, s20 op_sel:[0,0,1]
  v_pk_fma_f16 v191, v59, v59, s20 op_sel:[0,0,1]
  v_pk_fma_f16 v188, v188, v56, s21 op_sel_hi:[1,1,0]
  v_pk_fma_f16 v189, v189, v57, s21 op_sel_hi:[1,1,0]
  v_mfma_f32_32x32x16_bf16 v[16:31], a[128:131], v[224:227], v[16:31]
  v_pk_fma_f16 v190, v190, v58, s21 op_sel_hi:[1,1,0]
  v_pk_fma_f16 v191, v191, v59, s21 op_sel_hi:[1,1,0]
  v_pk_fma_f16 v188, v188, v52, 0.5 op_sel_hi:[1,1,0] clamp
  v_pk_fma_f16 v189, v189, v53, 0.5 op_sel_hi:[1,1,0] clamp
  v_pk_fma_f16 v190, v190, v54, 0.5 op_sel_hi:[1,1,0] clamp
  v_pk_fma_f16 v191, v191, v55, 0.5 op_sel_hi:[1,1,0] clamp
  v_mfma_f32_32x32x16_bf16 v[16:31], a[132:135], v[228:231], v[16:31]
  ds_read_b128 v[212:215], v0 offset:35840
  v_pk_mul_f16 v188, v188, v52
  v_pk_mul_f16 v189, v189, v53
  v_pk_mul_f16 v190, v190, v54
  v_pk_mul_f16 v191, v191, v55
  v_mfma_f32_32x32x16_bf16 v[16:31], a[136:139], v[232:235], v[16:31]
  s_waitcnt lgkmcnt(2)
  v_or3_b32 v12, v12, v13, v14
  v_or_b32 v12, v12, v15
  v_cmp_ne_u32 vcc, 0, v12
  s_nop 0
  v_mfma_f32_32x32x16_bf16 v[16:31], a[140:143], v[236:239], v[16:31]
  s_cbranch_vccnz L_slow
  s_nop 4
  v_mfma_f32_32x32x16_f16 v[64:79], v[192:195], v[184:187], v[64:79]
  s_nop 0
  ds_read_b128 v[192:195], v0 offset:36864
  s_nop 3
  v_cvt_pk_f16_f32 v48, v16, v17
  v_mfma_f32_32x32x16_f16 v[80:95], v[196:199], v[184:187], v[80:95]
  v_cvt_pk_f16_f32 v49, v18, v19
  v_cvt_pk_f16_f32 v50, v20, v21
  v_cvt_pk_f16_f32 v51, v22, v23
  v_cvt_pk_f16_f32 v52, v24, v25
  v_cvt_pk_f16_f32 v53, v26, v27
  v_cvt_pk_f16_f32 v54, v28, v29
  v_mfma_f32_32x32x16_f16 v[96:111], v[200:203], v[184:187], v[96:111]
  ds_read_b128 v[196:199], v0 offset:37888
  v_cvt_pk_f16_f32 v55, v30, v31
  v_pk_fma_f16 v56, v48, v48, s20 op_sel_hi:[1,1,0] neg_lo:[1,0,0] neg_hi:[1,0,0] clamp
  v_pk_fma_f16 v57, v49, v49, s20 op_sel_hi:[1,1,0] neg_lo:[1,0,0] neg_hi:[1,0,0] clamp
  v_pk_fma_f16 v58, v50, v50, s20 op_sel_hi:[1,1,0] neg_lo:[1,0,0] neg_hi:[1,0,0] clamp
  v_pk_fma_f16 v59, v51, v51, s20 op_sel_hi:[1,1,0] neg_lo:[1,0,0] neg_hi:[1,0,0] clamp
  v_mfma_f32_32x32x16_f16 v[64:79], v[204:207], v[188:191], v[64:79]
  s_waitcnt lgkmcnt(2)
  s_nop 0
  v_pk_fma_f16 v184, v56, v56, s20 op_sel:[0,0,1]
  v_pk_fma_f16 v185, v57, v57, s20 op_sel:[0,0,1]
  v_pk_fma_f16 v186, v58, v58, s20 op_sel:[0,0,1]
  v_pk_fma_f16 v187, v59, v59, s20 op_sel:[0,0,1]
  v_pk_fma_f16 v184, v184, v56, s21 op_sel_hi:[1,1,0]
  v_pk_fma_f16 v185, v185, v57, s21 op_sel_hi:[1,1,0]
  v_mfma_f32_32x32x16_f16 v[80:95], v[208:211], v[188:191], v[80:95]
  v_pk_fma_f16 v186, v186, v58, s21 op_sel_hi:[1,1,0]
  v_pk_fma_f16 v187, v187, v59, s21 op_sel_hi:[1,1,0]
  v_pk_fma_f16 v184, v184, v48, 0.5 op_sel_hi:[1,1,0] clamp
  v_pk_fma_f16 v185, v185, v49, 0.5 op_sel_hi:[1,1,0] clamp
  v_pk_fma_f16 v186, v186, v50, 0.5 op_sel_hi:[1,1,0] clamp
  v_pk_fma_f16 v187, v187, v51, 0.5 op_sel_hi:[1,1,0] clamp
  v_mfma_f32_32x32x16_f16 v[96:111], v[212:215], v[188:191], v[96:111]
  ds_read_b128 v[200:203], v0 offset:38912
  ds_read_b128 v[204:207], v0 offset:39936
  v_pk_mul_f16 v184, v184, v48
  v_pk_mul_f16 v185, v185, v49
  v_pk_mul_f16 v186, v186, v50
  v_pk_mul_f16 v187, v187, v51
  v_mfma_f32_32x32x16_bf16 v[16:31], a[144:147], v[216:219], 0
  ds_read_b128 v[208:211], v0 offset:40960
  v_pk_fma_f16 v56, v52, v52, s20 op_sel_hi:[1,1,0] neg_lo:[1,0,0] neg_hi:[1,0,0] clamp
  v_pk_fma_f16 v57, v53, v53, s20 op_sel_hi:[1,1,0] neg_lo:[1,0,0] neg_hi:[1,0,0] clamp
  v_pk_fma_f16 v58, v54, v54, s20 op_sel_hi:[1,1,0] neg_lo:[1,0,0] neg_hi:[1,0,0] clamp
  v_pk_fma_f16 v59, v55, v55, s20 op_sel_hi:[1,1,0] neg_lo:[1,0,0] neg_hi:[1,0,0] clamp
  v_pk_fma_f16 v188, v56, v56, s20 op_sel:[0,0,1]
  v_mfma_f32_32x32x16_bf16 v[16:31], a[148:151], v[220:223], v[16:31]
  v_pk_fma_f16 v189, v57, v57, s20 op_sel:[0,0,1]
  v_pk_fma_f16 v190, v58, v58, s20 op_sel:[0,0,1]
  v_pk_fma_f16 v191, v59, v59, s20 op_sel:[0,0,1]
  v_pk_fma_f16 v188, v188, v56, s21 op_sel_hi:[1,1,0]
  v_pk_fma_f16 v189, v189, v57, s21 op_sel_hi:[1,1,0]
  v_pk_fma_f16 v190, v190, v58, s21 op_sel_hi:[1,1,0]
  v_mfma_f32_32x32x16_bf16 v[16:31], a[152:155], v[224:227], v[16:31]
  v_pk_fma_f16 v191, v191, v59, s21 op_sel_hi:[1,1,0]
  v_pk_fma_f16 v188, v188, v52, 0.5 op_sel_hi:[1,1,0] clamp
  v_pk_fma_f16 v189, v189, v53, 0.5 op_sel_hi:[1,1,0] clamp
  v_pk_fma_f16 v190, v190, v54, 0.5 op_sel_hi:[1,1,0] clamp
  v_pk_fma_f16 v191, v191, v55, 0.5 op_sel_hi:[1,1,0] clamp
  v_pk_mul_f16 v188, v188, v52
  v_mfma_f32_32x32x16_bf16 v[16:31], a[156:159], v[228:231], v[16:31]
  ds_read_b128 v[212:215], v0 offset:41984
  v_pk_mul_f16 v189, v189, v53
  v_pk_mul_f16 v190, v190, v54
  v_pk_mul_f16 v191, v191, v55
  v_mfma_f32_32x32x16_bf16 v[16:31], a[160:163], v[232:235], v[16:31]
  v_mfma_f32_32x32x16_bf16 v[16:31], a[164:167], v[236:239], v[16:31]
  s_waitcnt lgkmcnt(1)
  s_nop 5
  s_nop 0
  v_mfma_f32_32x32x16_f16 v[64:79], v[192:195], v[184:187], v[64:79]
  ds_read_b128 v[192:195], v0 offset:43008
  s_nop 2
  v_cvt_pk_f16_f32 v48, v16, v17
  v_cvt_pk_f16_f32 v49, v18, v19
  v_mfma_f32_32x32x16_f16 v[80:95], v[196:199], v[184:187], v[80:95]
  v_cvt_pk_f16_f32 v50, v20, v21
  v_cvt_pk_f16_f32 v51, v22, v23
  v_cvt_pk_f16_f32 v52, v24, v25
  v_cvt_pk_f16_f32 v53, v26, v27
  v_cvt_pk_f16_f32 v54, v28, v29
  v_cvt_pk_f16_f32 v55, v30, v31
  v_mfma_f32_32x32x16_f16 v[96:111], v[200:203], v[184:187], v[96:111]
  ds_read_b128 v[196:199], v0 offset:44032
  v_pk_fma_f16 v56, v48, v48, s20 op_sel_hi:[1,1,0] neg_lo:[1,0,0] neg_hi:[1,0,0] clamp
  v_pk_fma_f16 v57, v49, v49, s20 op_sel_hi:[1,1,0] neg_lo:[1,0,0] neg_hi:[1,0,0] clamp
  v_pk_fma_f16 v58, v50, v50, s20 op_sel_hi:[1,1,0] neg_lo:[1,0,0] neg_hi:[1,0,0] clamp
  v_pk_fma_f16 v59, v51, v51, s20 op_sel_hi:[1,1,0] neg_lo:[1,0,0] neg_hi:[1,0,0] clamp
  v_pk_fma_f16 v184, v56, v56, s20 op_sel:[0,0,1]
  v_mfma_f32_32x32x16_f16 v[64:79], v[204:207], v[188:191], v[64:79]
  s_nop 0
  v_pk_fma_f16 v185, v57, v57, s20 op_sel:[0,0,1]
  v_pk_fma_f16 v186, v58, v58, s20 op_sel:[0,0,1]
  v_pk_fma_f16 v187, v59, v59, s20 op_sel:[0,0,1]
  v_pk_fma_f16 v184, v184, v56, s21 op_sel_hi:[1,1,0]
  v_pk_fma_f16 v185, v185, v57, s21 op_sel_hi:[1,1,0]
  v_pk_fma_f16 v186, v186, v58, s21 op_sel_hi:[1,1,0]
  v_mfma_f32_32x32x16_f16 v[80:95], v[208:211], v[188:191], v[80:95]
  s_waitcnt lgkmcnt(2)
  v_pk_fma_f16 v187, v187, v59, s21 op_sel_hi:[1,1,0]
  v_pk_fma_f16 v184, v184, v48, 0.5 op_sel_hi:[1,1,0] clamp
  v_pk_fma_f16 v185, v185, v49, 0.5 op_sel_hi:[1,1,0] clamp
  v_pk_fma_f16 v186, v186, v50, 0.5 op_sel_hi:[1,1,0] clamp
  v_pk_fma_f16 v187, v187, v51, 0.5 op_sel_hi:[1,1,0] clamp
  v_pk_mul_f16 v184, v184, v48
  v_mfma_f32_32x32x16_f16 v[96:111], v[212:215], v[188:191], v[96:111]
  ds_read_b128 v[200:203], v0 offset:45056
  ds_read_b128 v[204:207], v0 offset:46080
  ds_read_b128 v[208:211], v0 offset:47104
  v_pk_mul_f16 v185, v185, v49
  v_pk_mul_f16 v186, v186, v50
  v_pk_mul_f16 v187, v187, v51
  v_mfma_f32_32x32x16_bf16 v[16:31], a[168:171], v[216:219], 0
  v_pk_fma_f16 v56, v52, v52, s20 op_sel_hi:[1,1,0] neg_lo:[1,0,0] neg_hi:[1,0,0] clamp
  v_pk_fma_f16 v57, v53, v53, s20 op_sel_hi:[1,1,0] neg_lo:[1,0,0] neg_hi:[1,0,0] clamp
  v_pk_fma_f16 v58, v54, v54, s20 op_sel_hi:[1,1,0] neg_lo:[1,0,0] neg_hi:[1,0,0] clamp
  v_pk_fma_f16 v59, v55, v55, s20 op_sel_hi:[1,1,0] neg_lo:[1,0,0] neg_hi:[1,0,0] clamp
  v_pk_fma_f16 v188, v56, v56, s20 op_sel:[0,0,1]
  v_pk_fma_f16 v189, v57, v57, s20 op_sel:[0,0,1]
  v_mfma_f32_32x32x16_bf16 v[16:31], a[172:175], v[220:223], v[16:31]
  v_pk_fma_f16 v190, v58, v58, s20 op_sel:[0,0,1]
  v_pk_fma_f16 v191, v59, v59, s20 op_sel:[0,0,1]
  v_pk_fma_f16 v188, v188, v56, s21 op_sel_hi:[1,1,0]
  v_pk_fma_f16 v189, v189, v57, s21 op_sel_hi:[1,1,0]
  v_pk_fma_f16 v190, v190, v58, s21 op_sel_hi:[1,1,0]
  v_pk_fma_f16 v191, v191, v59, s21 op_sel_hi:[1,1,0]
  v_mfma_f32_32x32x16_bf16 v[16:31], a[176:179], v[224:227], v[16:31]
  v_pk_fma_f16 v188, v188, v52, 0.5 op_sel_hi:[1,1,0] clamp
  v_pk_fma_f16 v189, v189, v53, 0.5 op_sel_hi:[1,1,0] clamp
  v_pk_fma_f16 v190, v190, v54, 0.5 op_sel_hi:[1,1,0] clamp
  v_pk_fma_f16 v191, v191, v55, 0.5 op_sel_hi:[1,1,0] clamp
  v_pk_mul_f16 v188, v188, v52
  v_pk_mul_f16 v189, v189, v53
  v_mfma_f32_32x32x16_bf16 v[16:31], a[180:183], v[228:231], v[16:31]
  ds_read_b128 v[212:215], v0 offset:48128
  v_pk_mul_f16 v190, v190, v54
  v_pk_mul_f16 v191, v191, v55
  v_mfma_f32_32x32x16_bf16 v[16:31], a[184:187], v[232:235], v[16:31]
  v_mfma_f32_32x32x16_bf16 v[16:31], a[188:191], v[236:239], v[16:31]
  s_waitcnt lgkmcnt(1)
  s_nop 5
  s_nop 0
  v_mfma_f32_32x32x16_f16 v[64:79], v[192:195], v[184:187], v[64:79]
  ds_read_b128 v[192:195], v0 offset:49152
  s_nop 2
  v_cvt_pk_f16_f32 v48, v16, v17
  v_cvt_pk_f16_f32 v49, v18, v19
  v_mfma_f32_32x32x16_f16 v[80:95], v[196:199], v[184:187], v[80:95]
  v_cvt_pk_f16_f32 v50, v20, v21
  v_cvt_pk_f16_f32 v51, v22, v23
  v_cvt_pk_f16_f32 v52, v24, v25
  v_cvt_pk_f16_f32 v53, v26, v27
  v_cvt_pk_f16_f32 v54, v28, v29
  v_cvt_pk_f16_f32 v55, v30, v31
  v_mfma_f32_32x32x16_f16 v[96:111], v[200:203], v[184:187], v[96:111]
  ds_read_b128 v[196:199], v0 offset:50176
  v_pk_fma_f16 v56, v48, v48, s20 op_sel_hi:[1,1,0] neg_lo:[1,0,0] neg_hi:[1,0,0] clamp
  v_pk_fma_f16 v57, v49, v49, s20 op_sel_hi:[1,1,0] neg_lo:[1,0,0] neg_hi:[1,0,0] clamp
  v_pk_fma_f16 v58, v50, v50, s20 op_sel_hi:[1,1,0] neg_lo:[1,0,0] neg_hi:[1,0,0] clamp
  v_pk_fma_f16 v59, v51, v51, s20 op_sel_hi:[1,1,0] neg_lo:[1,0,0] neg_hi:[1,0,0] clamp
  v_pk_fma_f16 v184, v56, v56, s20 op_sel:[0,0,1]
  v_mfma_f32_32x32x16_f16 v[64:79], v[204:207], v[188:191], v[64:79]
  v_pk_fma_f16 v185, v57, v57, s20 op_sel:[0,0,1]
  v_pk_fma_f16 v186, v58, v58, s20 op_sel:[0,0,1]
  v_pk_fma_f16 v187, v59, v59, s20 op_sel:[0,0,1]
  v_pk_fma_f16 v184, v184, v56, s21 op_sel_hi:[1,1,0]
  v_pk_fma_f16 v185, v185, v57, s21 op_sel_hi:[1,1,0]
  v_pk_fma_f16 v186, v186, v58, s21 op_sel_hi:[1,1,0]
  v_mfma_f32_32x32x16_f16 v[80:95], v[208:211], v[188:191], v[80:95]
  s_waitcnt lgkmcnt(2)
  v_pk_fma_f16 v187, v187, v59, s21 op_sel_hi:[1,1,0]
  v_pk_fma_f16 v184, v184, v48, 0.5 op_sel_hi:[1,1,0] clamp
  v_pk_fma_f16 v185, v185, v49, 0.5 op_sel_hi:[1,1,0] clamp
  v_pk_fma_f16 v186, v186, v50, 0.5 op_sel_hi:[1,1,0] clamp
  v_pk_fma_f16 v187, v187, v51, 0.5 op_sel_hi:[1,1,0] clamp
  v_pk_mul_f16 v184, v184, v48
  v_mfma_f32_32x32x16_f16 v[96:111], v[212:215], v[188:191], v[96:111]
  s_nop 0
  ds_read_b128 v[200:203], v0 offset:51200
  ds_read_b128 v[204:207], v0 offset:52224
  ds_read_b128 v[208:211], v0 offset:53248
  v_pk_mul_f16 v185, v185, v49
  v_pk_mul_f16 v186, v186, v50
  v_pk_mul_f16 v187, v187, v51
  v_mfma_f32_32x32x16_bf16 v[16:31], a[192:195], v[216:219], 0
  v_pk_fma_f16 v56, v52, v52, s20 op_sel_hi:[1,1,0] neg_lo:[1,0,0] neg_hi:[1,0,0] clamp
  v_pk_fma_f16 v57, v53, v53, s20 op_sel_hi:[1,1,0] neg_lo:[1,0,0] neg_hi:[1,0,0] clamp
  v_pk_fma_f16 v58, v54, v54, s20 op_sel_hi:[1,1,0] neg_lo:[1,0,0] neg_hi:[1,0,0] clamp
  v_pk_fma_f16 v59, v55, v55, s20 op_sel_hi:[1,1,0] neg_lo:[1,0,0] neg_hi:[1,0,0] clamp
  v_pk_fma_f16 v188, v56, v56, s20 op_sel:[0,0,1]
  v_pk_fma_f16 v189, v57, v57, s20 op_sel:[0,0,1]
  v_mfma_f32_32x32x16_bf16 v[16:31], a[196:199], v[220:223], v[16:31]
  v_pk_fma_f16 v190, v58, v58, s20 op_sel:[0,0,1]
  v_pk_fma_f16 v191, v59, v59, s20 op_sel:[0,0,1]
  v_pk_fma_f16 v188, v188, v56, s21 op_sel_hi:[1,1,0]
  v_pk_fma_f16 v189, v189, v57, s21 op_sel_hi:[1,1,0]
  v_pk_fma_f16 v190, v190, v58, s21 op_sel_hi:[1,1,0]
  v_pk_fma_f16 v191, v191, v59, s21 op_sel_hi:[1,1,0]
  v_mfma_f32_32x32x16_bf16 v[16:31], a[200:203], v[224:227], v[16:31]
  v_pk_fma_f16 v188, v188, v52, 0.5 op_sel_hi:[1,1,0] clamp
  v_pk_fma_f16 v189, v189, v53, 0.5 op_sel_hi:[1,1,0] clamp
  v_pk_fma_f16 v190, v190, v54, 0.5 op_sel_hi:[1,1,0] clamp
  v_pk_fma_f16 v191, v191, v55, 0.5 op_sel_hi:[1,1,0] clamp
  v_pk_mul_f16 v188, v188, v52
  v_pk_mul_f16 v189, v189, v53
  v_mfma_f32_32x32x16_bf16 v[16:31], a[204:207], v[228:231], v[16:31]
  ds_read_b128 v[212:215], v0 offset:54272
  v_pk_mul_f16 v190, v190, v54
  v_pk_mul_f16 v191, v191, v55
  v_mfma_f32_32x32x16_bf16 v[16:31], a[208:211], v[232:235], v[16:31]
  s_nop 0
  v_mfma_f32_32x32x16_bf16 v[16:31], a[212:215], v[236:239], v[16:31]
  s_waitcnt lgkmcnt(1)
  s_nop 5
  s_nop 0
  v_mfma_f32_32x32x16_f16 v[64:79], v[192:195], v[184:187], v[64:79]
  s_nop 0
  ds_read_b128 v[192:195], v0 offset:55296
  s_nop 2
  v_cvt_pk_f16_f32 v48, v16, v17
  v_cvt_pk_f16_f32 v49, v18, v19
  v_mfma_f32_32x32x16_f16 v[80:95], v[196:199], v[184:187], v[80:95]
  v_cvt_pk_f16_f32 v50, v20, v21
  v_cvt_pk_f16_f32 v51, v22, v23
  v_cvt_pk_f16_f32 v52, v24, v25
  v_cvt_pk_f16_f32 v53, v26, v27
  v_cvt_pk_f16_f32 v54, v28, v29
  v_cvt_pk_f16_f32 v55, v30, v31
  v_mfma_f32_32x32x16_f16 v[96:111], v[200:203], v[184:187], v[96:111]
  ds_read_b128 v[196:199], v0 offset:56320
  v_pk_fma_f16 v56, v48, v48, s20 op_sel_hi:[1,1,0] neg_lo:[1,0,0] neg_hi:[1,0,0] clamp
  v_pk_fma_f16 v57, v49, v49, s20 op_sel_hi:[1,1,0] neg_lo:[1,0,0] neg_hi:[1,0,0] clamp
  v_pk_fma_f16 v58, v50, v50, s20 op_sel_hi:[1,1,0] neg_lo:[1,0,0] neg_hi:[1,0,0] clamp
  v_pk_fma_f16 v59, v51, v51, s20 op_sel_hi:[1,1,0] neg_lo:[1,0,0] neg_hi:[1,0,0] clamp
  v_pk_fma_f16 v184, v56, v56, s20 op_sel:[0,0,1]
  v_mfma_f32_32x32x16_f16 v[64:79], v[204:207], v[188:191], v[64:79]
  v_pk_fma_f16 v185, v57, v57, s20 op_sel:[0,0,1]
  v_pk_fma_f16 v186, v58, v58, s20 op_sel:[0,0,1]
  v_pk_fma_f16 v187, v59, v59, s20 op_sel:[0,0,1]
  v_pk_fma_f16 v184, v184, v56, s21 op_sel_hi:[1,1,0]
  v_pk_fma_f16 v185, v185, v57, s21 op_sel_hi:[1,1,0]
  v_pk_fma_f16 v186, v186, v58, s21 op_sel_hi:[1,1,0]
  v_mfma_f32_32x32x16_f16 v[80:95], v[208:211], v[188:191], v[80:95]
  s_waitcnt lgkmcnt(2)
  s_nop 0
  v_pk_fma_f16 v187, v187, v59, s21 op_sel_hi:[1,1,0]
  v_pk_fma_f16 v184, v184, v48, 0.5 op_sel_hi:[1,1,0] clamp
  v_pk_fma_f16 v185, v185, v49, 0.5 op_sel_hi:[1,1,0] clamp
  v_pk_fma_f16 v186, v186, v50, 0.5 op_sel_hi:[1,1,0] clamp
  v_pk_fma_f16 v187, v187, v51, 0.5 op_sel_hi:[1,1,0] clamp
  v_pk_mul_f16 v184, v184, v48
  v_mfma_f32_32x32x16_f16 v[96:111], v[212:215], v[188:191], v[96:111]
  ds_read_b128 v[200:203], v0 offset:57344
  ds_read_b128 v[204:207], v0 offset:58368
  ds_read_b128 v[208:211], v0 offset:59392
  v_pk_mul_f16 v185, v185, v49
  v_pk_mul_f16 v186, v186, v50
  v_pk_mul_f16 v187, v187, v51
  v_mfma_f32_32x32x16_bf16 v[16:31], a[216:219], v[216:219], 0
  v_pk_fma_f16 v56, v52, v52, s20 op_sel_hi:[1,1,0] neg_lo:[1,0,0] neg_hi:[1,0,0] clamp
  v_pk_fma_f16 v57, v53, v53, s20 op_sel_hi:[1,1,0] neg_lo:[1,0,0] neg_hi:[1,0,0] clamp
  v_pk_fma_f16 v58, v54, v54, s20 op_sel_hi:[1,1,0] neg_lo:[1,0,0] neg_hi:[1,0,0] clamp
  v_pk_fma_f16 v59, v55, v55, s20 op_sel_hi:[1,1,0] neg_lo:[1,0,0] neg_hi:[1,0,0] clamp
  v_pk_fma_f16 v188, v56, v56, s20 op_sel:[0,0,1]
  v_pk_fma_f16 v189, v57, v57, s20 op_sel:[0,0,1]
  v_mfma_f32_32x32x16_bf16 v[16:31], a[220:223], v[220:223], v[16:31]
  v_pk_fma_f16 v190, v58, v58, s20 op_sel:[0,0,1]
  v_pk_fma_f16 v191, v59, v59, s20 op_sel:[0,0,1]
  v_pk_fma_f16 v188, v188, v56, s21 op_sel_hi:[1,1,0]
  v_pk_fma_f16 v189, v189, v57, s21 op_sel_hi:[1,1,0]
  v_pk_fma_f16 v190, v190, v58, s21 op_sel_hi:[1,1,0]
  v_pk_fma_f16 v191, v191, v59, s21 op_sel_hi:[1,1,0]
  v_mfma_f32_32x32x16_bf16 v[16:31], a[224:227], v[224:227], v[16:31]
  v_pk_fma_f16 v188, v188, v52, 0.5 op_sel_hi:[1,1,0] clamp
  v_pk_fma_f16 v189, v189, v53, 0.5 op_sel_hi:[1,1,0] clamp
  v_pk_fma_f16 v190, v190, v54, 0.5 op_sel_hi:[1,1,0] clamp
  v_pk_fma_f16 v191, v191, v55, 0.5 op_sel_hi:[1,1,0] clamp
  v_pk_mul_f16 v188, v188, v52
  v_pk_mul_f16 v189, v189, v53
  v_mfma_f32_32x32x16_bf16 v[16:31], a[228:231], v[228:231], v[16:31]
  ds_read_b128 v[212:215], v0 offset:60416
  v_pk_mul_f16 v190, v190, v54
  v_pk_mul_f16 v191, v191, v55
  v_mfma_f32_32x32x16_bf16 v[16:31], a[232:235], v[232:235], v[16:31]
  v_mfma_f32_32x32x16_bf16 v[16:31], a[236:239], v[236:239], v[16:31]
  s_waitcnt lgkmcnt(1)
  s_nop 5
  s_nop 0
  v_mfma_f32_32x32x16_f16 v[64:79], v[192:195], v[184:187], v[64:79]
  ds_read_b128 v[192:195], v0 offset:61440
  s_nop 2
  v_cvt_pk_f16_f32 v48, v16, v17
  v_cvt_pk_f16_f32 v49, v18, v19
  v_mfma_f32_32x32x16_f16 v[80:95], v[196:199], v[184:187], v[80:95]
  v_cvt_pk_f16_f32 v50, v20, v21
  v_cvt_pk_f16_f32 v51, v22, v23
  v_cvt_pk_f16_f32 v52, v24, v25
  v_cvt_pk_f16_f32 v53, v26, v27
  v_cvt_pk_f16_f32 v54, v28, v29
  v_cvt_pk_f16_f32 v55, v30, v31
  v_mfma_f32_32x32x16_f16 v[96:111], v[200:203], v[184:187], v[96:111]
  ds_read_b128 v[196:199], v0 offset:62464
  v_pk_fma_f16 v56, v48, v48, s20 op_sel_hi:[1,1,0] neg_lo:[1,0,0] neg_hi:[1,0,0] clamp
  v_pk_fma_f16 v57, v49, v49, s20 op_sel_hi:[1,1,0] neg_lo:[1,0,0] neg_hi:[1,0,0] clamp
  v_pk_fma_f16 v58, v50, v50, s20 op_sel_hi:[1,1,0] neg_lo:[1,0,0] neg_hi:[1,0,0] clamp
  v_pk_fma_f16 v59, v51, v51, s20 op_sel_hi:[1,1,0] neg_lo:[1,0,0] neg_hi:[1,0,0] clamp
  v_pk_fma_f16 v184, v56, v56, s20 op_sel:[0,0,1]
  v_mfma_f32_32x32x16_f16 v[64:79], v[204:207], v[188:191], v[64:79]
  s_nop 0
  v_pk_fma_f16 v185, v57, v57, s20 op_sel:[0,0,1]
  v_pk_fma_f16 v186, v58, v58, s20 op_sel:[0,0,1]
  v_pk_fma_f16 v187, v59, v59, s20 op_sel:[0,0,1]
  v_pk_fma_f16 v184, v184, v56, s21 op_sel_hi:[1,1,0]
  v_pk_fma_f16 v185, v185, v57, s21 op_sel_hi:[1,1,0]
  v_pk_fma_f16 v186, v186, v58, s21 op_sel_hi:[1,1,0]
  v_mfma_f32_32x32x16_f16 v[80:95], v[208:211], v[188:191], v[80:95]
  s_waitcnt lgkmcnt(2)
  v_pk_fma_f16 v187, v187, v59, s21 op_sel_hi:[1,1,0]
  v_pk_fma_f16 v184, v184, v48, 0.5 op_sel_hi:[1,1,0] clamp
  v_pk_fma_f16 v185, v185, v49, 0.5 op_sel_hi:[1,1,0] clamp
  v_pk_fma_f16 v186, v186, v50, 0.5 op_sel_hi:[1,1,0] clamp
  v_pk_fma_f16 v187, v187, v51, 0.5 op_sel_hi:[1,1,0] clamp
  v_pk_mul_f16 v184, v184, v48
  v_mfma_f32_32x32x16_f16 v[96:111], v[212:215], v[188:191], v[96:111]
  ds_read_b128 v[200:203], v0 offset:63488
  ds_read_b128 v[204:207], v0 offset:64512
  ds_read_b128 v[208:211], v1
  v_pk_mul_f16 v185, v185, v49
  v_pk_mul_f16 v186, v186, v50
  v_pk_mul_f16 v187, v187, v51
  v_mfma_f32_32x32x16_bf16 v[16:31], v[32:35], v[216:219], 0
  v_pk_fma_f16 v56, v52, v52, s20 op_sel_hi:[1,1,0] neg_lo:[1,0,0] neg_hi:[1,0,0] clamp
  v_pk_fma_f16 v57, v53, v53, s20 op_sel_hi:[1,1,0] neg_lo:[1,0,0] neg_hi:[1,0,0] clamp
  v_pk_fma_f16 v58, v54, v54, s20 op_sel_hi:[1,1,0] neg_lo:[1,0,0] neg_hi:[1,0,0] clamp
  v_pk_fma_f16 v59, v55, v55, s20 op_sel_hi:[1,1,0] neg_lo:[1,0,0] neg_hi:[1,0,0] clamp
  v_pk_fma_f16 v188, v56, v56, s20 op_sel:[0,0,1]
  v_pk_fma_f16 v189, v57, v57, s20 op_sel:[0,0,1]
  v_mfma_f32_32x32x16_bf16 v[16:31], v[36:39], v[220:223], v[16:31]
  v_pk_fma_f16 v190, v58, v58, s20 op_sel:[0,0,1]
  v_pk_fma_f16 v191, v59, v59, s20 op_sel:[0,0,1]
  v_pk_fma_f16 v188, v188, v56, s21 op_sel_hi:[1,1,0]
  v_pk_fma_f16 v189, v189, v57, s21 op_sel_hi:[1,1,0]
  v_pk_fma_f16 v190, v190, v58, s21 op_sel_hi:[1,1,0]
  v_pk_fma_f16 v191, v191, v59, s21 op_sel_hi:[1,1,0]
  v_mfma_f32_32x32x16_bf16 v[16:31], v[40:43], v[224:227], v[16:31]
  v_pk_fma_f16 v188, v188, v52, 0.5 op_sel_hi:[1,1,0] clamp
  v_pk_fma_f16 v189, v189, v53, 0.5 op_sel_hi:[1,1,0] clamp
  v_pk_fma_f16 v190, v190, v54, 0.5 op_sel_hi:[1,1,0] clamp
  v_pk_fma_f16 v191, v191, v55, 0.5 op_sel_hi:[1,1,0] clamp
  v_pk_mul_f16 v188, v188, v52
  v_pk_mul_f16 v189, v189, v53
  v_mfma_f32_32x32x16_bf16 v[16:31], v[44:47], v[228:231], v[16:31]
  ds_read_b128 v[212:215], v1 offset:1024
  v_pk_mul_f16 v190, v190, v54
  v_pk_mul_f16 v191, v191, v55
  v_mfma_f32_32x32x16_bf16 v[16:31], v[60:63], v[232:235], v[16:31]
  v_mfma_f32_32x32x16_bf16 v[16:31], v[244:247], v[236:239], v[16:31]
  s_waitcnt lgkmcnt(1)
  s_nop 5
  s_nop 0
  v_mfma_f32_32x32x16_f16 v[64:79], v[192:195], v[184:187], v[64:79]
  ds_read_b128 v[192:195], v1 offset:2048
  s_nop 2
  v_cvt_pk_f16_f32 v48, v16, v17
  v_cvt_pk_f16_f32 v49, v18, v19
  v_mfma_f32_32x32x16_f16 v[80:95], v[196:199], v[184:187], v[80:95]
  ds_read_b128 v[196:199], v1 offset:3072
  v_cvt_pk_f16_f32 v50, v20, v21
  v_cvt_pk_f16_f32 v51, v22, v23
  v_cvt_pk_f16_f32 v52, v24, v25
  v_cvt_pk_f16_f32 v53, v26, v27
  v_cvt_pk_f16_f32 v54, v28, v29
  v_mfma_f32_32x32x16_f16 v[96:111], v[200:203], v[184:187], v[96:111]
  v_cvt_pk_f16_f32 v55, v30, v31
  v_pk_fma_f16 v56, v48, v48, s20 op_sel_hi:[1,1,0] neg_lo:[1,0,0] neg_hi:[1,0,0] clamp
  v_pk_fma_f16 v57, v49, v49, s20 op_sel_hi:[1,1,0] neg_lo:[1,0,0] neg_hi:[1,0,0] clamp
  v_pk_fma_f16 v58, v50, v50, s20 op_sel_hi:[1,1,0] neg_lo:[1,0,0] neg_hi:[1,0,0] clamp
  v_pk_fma_f16 v59, v51, v51, s20 op_sel_hi:[1,1,0] neg_lo:[1,0,0] neg_hi:[1,0,0] clamp
  v_pk_fma_f16 v184, v56, v56, s20 op_sel:[0,0,1]
  v_mfma_f32_32x32x16_f16 v[64:79], v[204:207], v[188:191], v[64:79]
  v_pk_fma_f16 v185, v57, v57, s20 op_sel:[0,0,1]
  v_pk_fma_f16 v186, v58, v58, s20 op_sel:[0,0,1]
  v_pk_fma_f16 v187, v59, v59, s20 op_sel:[0,0,1]
  v_pk_fma_f16 v184, v184, v56, s21 op_sel_hi:[1,1,0]
  v_pk_fma_f16 v185, v185, v57, s21 op_sel_hi:[1,1,0]
  v_pk_fma_f16 v186, v186, v58, s21 op_sel_hi:[1,1,0]
  v_mfma_f32_32x32x16_f16 v[80:95], v[208:211], v[188:191], v[80:95]
  s_waitcnt lgkmcnt(2)
  s_nop 0
  ds_read_b128 v[200:203], v1 offset:4096
  v_pk_fma_f16 v187, v187, v59, s21 op_sel_hi:[1,1,0]
  v_pk_fma_f16 v184, v184, v48, 0.5 op_sel_hi:[1,1,0] clamp
  v_pk_fma_f16 v185, v185, v49, 0.5 op_sel_hi:[1,1,0] clamp
  v_pk_fma_f16 v186, v186, v50, 0.5 op_sel_hi:[1,1,0] clamp
  v_pk_fma_f16 v187, v187, v51, 0.5 op_sel_hi:[1,1,0] clamp
  v_pk_mul_f16 v184, v184, v48
  v_pk_mul_f16 v185, v185, v49
  v_pk_mul_f16 v186, v186, v50
  v_pk_mul_f16 v187, v187, v51
  v_mfma_f32_32x32x16_f16 v[96:111], v[212:215], v[188:191], v[96:111]
  s_waitcnt lgkmcnt(2)
  ds_read_b128 v[204:207], v1 offset:5120
  ds_read_b128 v[208:211], v1 offset:6144
  v_pk_fma_f16 v56, v52, v52, s20 op_sel_hi:[1,1,0] neg_lo:[1,0,0] neg_hi:[1,0,0] clamp
  v_pk_fma_f16 v57, v53, v53, s20 op_sel_hi:[1,1,0] neg_lo:[1,0,0] neg_hi:[1,0,0] clamp
  v_pk_fma_f16 v58, v54, v54, s20 op_sel_hi:[1,1,0] neg_lo:[1,0,0] neg_hi:[1,0,0] clamp
  v_pk_fma_f16 v59, v55, v55, s20 op_sel_hi:[1,1,0] neg_lo:[1,0,0] neg_hi:[1,0,0] clamp
  v_mfma_f32_32x32x16_f16 v[64:79], v[192:195], v[184:187], v[64:79]
  s_waitcnt lgkmcnt(3)
  v_pk_fma_f16 v188, v56, v56, s20 op_sel:[0,0,1]
  v_pk_fma_f16 v189, v57, v57, s20 op_sel:[0,0,1]
  v_pk_fma_f16 v190, v58, v58, s20 op_sel:[0,0,1]
  v_pk_fma_f16 v191, v59, v59, s20 op_sel:[0,0,1]
  v_pk_fma_f16 v188, v188, v56, s21 op_sel_hi:[1,1,0]
  v_pk_fma_f16 v189, v189, v57, s21 op_sel_hi:[1,1,0]
  v_mfma_f32_32x32x16_f16 v[80:95], v[196:199], v[184:187], v[80:95]
  s_nop 0
  s_waitcnt lgkmcnt(2)
  ds_read_b128 v[212:215], v1 offset:7168
  v_pk_fma_f16 v190, v190, v58, s21 op_sel_hi:[1,1,0]
  v_pk_fma_f16 v191, v191, v59, s21 op_sel_hi:[1,1,0]
  v_pk_fma_f16 v188, v188, v52, 0.5 op_sel_hi:[1,1,0] clamp
  v_pk_fma_f16 v189, v189, v53, 0.5 op_sel_hi:[1,1,0] clamp
  v_pk_fma_f16 v190, v190, v54, 0.5 op_sel_hi:[1,1,0] clamp
  v_pk_fma_f16 v191, v191, v55, 0.5 op_sel_hi:[1,1,0] clamp
  v_pk_mul_f16 v188, v188, v52
  v_pk_mul_f16 v189, v189, v53
  v_pk_mul_f16 v190, v190, v54
  v_pk_mul_f16 v191, v191, v55
  v_mfma_f32_32x32x16_f16 v[96:111], v[200:203], v[184:187], v[96:111]
  s_waitcnt lgkmcnt(2)
  v_mfma_f32_32x32x16_f16 v[64:79], v[204:207], v[188:191], v[64:79]
  s_waitcnt lgkmcnt(1)
  s_nop 0
  v_mfma_f32_32x32x16_f16 v[80:95], v[208:211], v[188:191], v[80:95]
  s_waitcnt lgkmcnt(0)
  s_nop 5
  s_nop 0
  v_mfma_f32_32x32x16_f16 v[96:111], v[212:215], v[188:191], v[96:111]
  v_cvt_pk_bf16_f32 v112, v64, v65
  v_cvt_pk_bf16_f32 v113, v66, v67
  v_cvt_pk_bf16_f32 v114, v68, v69
  v_cvt_pk_bf16_f32 v115, v70, v71
  v_cvt_pk_bf16_f32 v116, v72, v73
  v_cvt_pk_bf16_f32 v117, v74, v75
  v_cvt_pk_bf16_f32 v118, v76, v77
  v_cvt_pk_bf16_f32 v119, v78, v79
  v_cvt_pk_bf16_f32 v120, v80, v81
  v_cvt_pk_bf16_f32 v121, v82, v83
  v_cvt_pk_bf16_f32 v122, v84, v85
  v_cvt_pk_bf16_f32 v123, v86, v87
  ds_write_b128 v251, v[112:115]
  ds_write_b128 v251, v[116:119] offset:2064
  v_cvt_pk_bf16_f32 v124, v88, v89
  v_cvt_pk_bf16_f32 v125, v90, v91
  v_cvt_pk_bf16_f32 v126, v92, v93
  v_cvt_pk_bf16_f32 v127, v94, v95
  ds_write_b128 v251, v[120:123] offset:1024
  ds_write_b128 v251, v[124:127] offset:3088
  ds_read_b128 v[112:115], v254
  ds_read_b128 v[116:119], v254 offset:256
  v_cvt_pk_bf16_f32 v128, v96, v97
  v_cvt_pk_bf16_f32 v129, v98, v99
  v_cvt_pk_bf16_f32 v130, v100, v101
  v_cvt_pk_bf16_f32 v131, v102, v103
  v_cvt_pk_bf16_f32 v132, v104, v105
  v_cvt_pk_bf16_f32 v133, v106, v107
  v_cvt_pk_bf16_f32 v134, v108, v109
  v_cvt_pk_bf16_f32 v135, v110, v111
  ds_write_b128 v252, v[128:131] offset:1024
  ds_write_b128 v252, v[132:135] offset:3088
  ds_read_b128 v[120:123], v255 offset:1024
  ds_read_b128 v[124:127], v255 offset:1280
  ds_read_b128 v[128:131], v254 offset:1040
  ds_read_b128 v[132:135], v254 offset:1296
  s_waitcnt lgkmcnt(7)
  buffer_store_dwordx4 v[112:115], v10, s[8:11], s28 offen sc1 nt
  s_waitcnt lgkmcnt(6)
  buffer_store_dwordx4 v[116:119], v10, s[8:11], s59 offen sc1 nt
  s_waitcnt lgkmcnt(3)
  buffer_store_dwordx4 v[120:123], v10, s[8:11], s28 offen offset:128 sc1 nt
  s_waitcnt lgkmcnt(2)
  buffer_store_dwordx4 v[124:127], v10, s[8:11], s59 offen offset:128 sc1 nt
  s_waitcnt lgkmcnt(1)
  buffer_store_dwordx4 v[128:131], v10, s[8:11], s28 offen offset:256 sc1 nt
  s_waitcnt lgkmcnt(0)
  buffer_store_dwordx4 v[132:135], v10, s[8:11], s59 offen offset:256 sc1 nt
L_end:
  s_endpgm
L_cend:
L_slow:
  s_waitcnt vmcnt(0) lgkmcnt(0)
  s_nop 15
  s_nop 15
  s_barrier
  v_mbcnt_lo_u32_b32 v0, -1, 0
  v_mbcnt_hi_u32_b32 v0, -1, v0
  v_lshl_add_u32 v0, s27, 6, v0
  s_nop 4
  .p2align 7
  s_cmp_ge_u32 s2, 0x100
  s_cbranch_scc1 S_end
  s_nop 0
  s_load_dwordx2 s[4:5], s[0:1], 0
  s_load_dwordx2 s[60:61], s[0:1], 8
  s_load_dwordx2 s[64:65], s[0:1], 16
  s_load_dwordx2 s[68:69], s[0:1], 24
  s_load_dwordx2 s[72:73], s[0:1], 32
  s_load_dwordx2 s[76:77], s[0:1], 40
  s_load_dwordx2 s[80:81], s[0:1], 48
  s_load_dwordx2 s[8:9], s[0:1], 56
  s_getpc_b64 s[40:41]
S_pc:
  s_lshl_b32 s32, s2, 9
  s_and_b32 s32, s32, 0xf000
  v_lshl_add_u32 v249, v0, 4, s32
  v_lshrrev_b32_e64 v112, 6, v0
  v_min_u32 v249, S_end-S_pc-12, v249
  v_and_b32 v113, 63, v0
  global_load_dwordx4 v[108:111], v249, s[40:41]
  v_readfirstlane_b32 s27, v112
  s_mov_b32 s62, 0x6c0
  s_mov_b32 s63, 0x20000
  s_mov_b32 s82, 0xc0
  s_mov_b32 s83, 0x20000
  s_mov_b32 s78, 0xc0
  s_mov_b32 s79, 0x20000
  s_mov_b32 s66, 0x12000
  s_mov_b32 s67, 0x20000
  s_mov_b32 s74, 0x12000
  s_mov_b32 s75, 0x20000
  v_bfe_u32 v114, v113, 3, 1
  v_bfe_u32 v115, v113, 4, 1
  v_bfe_u32 v116, v113, 2, 1
  v_and_b32 v117, 3, v113
  v_lshlrev_b32 v118, 4, v113
  s_min_u32 s44, s27, 2
  s_lshl_b32 s45, s44, 6
  s_mul_i32 s46, s44, 0x240
  v_lshlrev_b32 v119, 1, v113
  v_and_b32 v120, 31, v113
  v_lshlrev_b32_e64 v121, 1, v120
  v_lshlrev_b32_e64 v122, 4, v115
  v_lshl_add_u32 v122, v116, 3, v122
  v_lshl_add_u32 v122, v114, 2, v122
  v_add_u32_e64 v122, v122, v117
  v_lshlrev_b32_e64 v123, 1, v122
  s_lshr_b32 s35, s2, 3
  s_lshl_b32 s35, s35, 2
  s_add_u32 s35, s35, s27
  s_sub_u32 s55, s35, 0x48
  s_min_u32 s35, s35, s55
  s_lshl_b32 s47, s35, 10
  s_and_b32 s54, s2, 6
  s_lshl_b32 s54, s54, 1
  s_lshr_b32 s32, s2, 6
  s_add_u32 s54, s54, s32
  s_mul_i32 s59, s54, 0x300000
  s_and_b32 s53, s2, 1
  s_lshl_b32 s53, s53, 8
  s_and_b32 s32, s2, 56
  s_lshl_b32 s32, s32, 2
  s_add_u32 s53, s53, s32
  s_lshl_b32 s32, s27, 3
  s_add_u32 s53, s53, s32
  s_mul_i32 s3, s53, 0xc0
  s_add_u32 s3, s3, 0xf40
  s_mov_b32 s6, 0x3000000
  s_mov_b32 s7, 0x20000
  s_cmp_eq_u32 s53, 0
  s_cselect_b32 s35, 12, 0
  s_sub_u32 s55, 0x78, s35
  s_cmp_eq_u32 s53, 0x1f8
  s_cselect_b32 s55, 0x6c, s55
  s_mul_i32 s15, s27, 0x1040
  s_add_u32 s48, s59, 0x17000
  s_add_u32 s49, s59, 0x47000
  s_waitcnt lgkmcnt(0)
  v_add_u32 v124, 64, v113
  buffer_load_dwordx4 v[108:111], v118, s[64:67], s47 offen
  v_subrev_u32 v127, 57, v113
  v_cmp_le_u32 vcc, 57, v113
  buffer_load_dwordx4 v[108:111], v118, s[72:75], s47 offen
  v_add_u32_e64 v125, 7, v113
  v_add_u32 v126, 0x47, v113
  buffer_load_ushort v129, v119, s[60:63], s46 offen
  v_mov_b32 v199, 0x17c00
  v_cndmask_b32_e64 v124, v124, v127, vcc
  buffer_load_ushort v130, v119, s[60:63], s46 offen offset:128
  v_mov_b32 v127, 0xfffffc00
  v_cndmask_b32_e64 v199, v127, v199, vcc
  v_add_u32_e64 v198, s3, v118
  buffer_load_ushort v131, v119, s[60:63], s46 offen offset:256
  v_lshl_add_u32 v199, v124, 4, v199
  v_add_u32_e64 v199, s3, v199
  buffer_load_ushort v132, v119, s[60:63], s46 offen offset:384
  v_add_u32 v200, 0x17870, v198
  v_add_u32 v201, 0x17870, v198
  buffer_load_ushort v133, v121, s[60:63], s46 offen offset:512
  v_mov_b32 v128, 0x80000000
  v_subrev_u32_e64 v6, s35, v113
  buffer_load_ushort v137, v123, s[80:83], s45 offen
  v_cmp_gt_u32 s[36:37], s55, v6
  v_subrev_u32_e64 v7, s35, v124
  v_cmp_gt_u32 s[38:39], s55, v7
  buffer_load_ushort v138, v123, s[76:79], s45 offen
  v_subrev_u32_e64 v8, s35, v125
  v_cmp_gt_u32 s[40:41], s55, v8
  buffer_load_ushort v134, v123, s[80:83], 0 offen
  v_subrev_u32_e64 v9, s35, v126
  v_cmp_gt_u32 s[42:43], s55, v9
  buffer_load_ushort v135, v123, s[80:83], 0 offen offset:64
  v_cndmask_b32 v6, v128, v198, s[36:37]
  v_cndmask_b32 v7, v128, v199, s[38:39]
  buffer_load_ushort v136, v123, s[80:83], 0 offen offset:128
  v_cndmask_b32 v8, v128, v200, s[40:41]
  v_cndmask_b32 v9, v128, v201, s[42:43]
  s_add_u32 m0, s15, 0x4120
  s_nop 0
  buffer_load_dwordx4 v6, s[4:7], s48 offen lds
  buffer_load_dwordx4 v7, s[4:7], s48 offen offset:1024 lds
  buffer_load_dwordx4 v8, s[4:7], s48 offen offset:2048 lds
  buffer_load_dwordx4 v9, s[4:7], s48 offen offset:3072 lds
  s_sub_u32 s56, s59, 0x19000
  v_add_u32 v198, s56, v6
  s_add_u32 s56, s56, 0x400
  v_add_u32_e64 v199, s56, v7
  s_add_u32 s56, s56, 0x400
  v_add_u32_e64 v200, s56, v8
  s_add_u32 s56, s56, 0x400
  v_add_u32 v201, s56, v9
  v_lshrrev_b32 v139, 5, v113
  v_lshlrev_b32_e64 v202, 4, v117
  v_lshl_add_u32 v202, v139, 6, v202
  v_bfe_u32 v124, v113, 3, 2
  v_lshl_add_u32 v124, v116, 2, v124
  v_cmp_eq_u32 vcc, 7, v124
  v_mul_u32_u24 v203, 0x300, v124
  v_add_u32 v203, v203, v202
  v_cndmask_b32_e64 v204, v128, v202, vcc
  s_mov_b32 s70, 0x300
  s_mov_b32 s71, 0x20000
  s_mov_b32 s10, 0x3000000
  s_mov_b32 s11, 0x20000
  s_and_b32 s36, s27, 2
  s_add_u32 s37, s27, 1
  s_lshr_b32 s37, s37, 1
  s_and_b32 s38, s37, 1
  s_cmp_eq_u32 s27, 1
  s_cselect_b32 s39, 0, 3
  s_cselect_b32 s51, 0x1000, 0
  s_lshl_b32 s32, s36, 8
  s_lshl_b32 s33, s37, 8
  s_add_u32 s43, s32, 0x11d00
  s_add_u32 s50, s33, 0x11d00
  s_add_u32 s51, s51, s33
  s_mul_i32 s40, s38, 0x6000
  s_add_u32 s40, s40, s32
  s_mul_i32 s41, s38, 0x1800
  s_add_u32 s41, s41, s32
  s_add_u32 s41, s41, 0x3000
  s_mul_i32 s42, s39, 0x3000
  s_add_u32 s42, s42, s33
  s_mul_i32 s32, s36, 0x6000
  s_lshl_b32 s33, s38, 11
  s_add_u32 s33, s33, s32
  s_add_u32 s33, s33, 0x10000
  v_add_u32_e64 v195, s33, v118
  s_lshl_b32 s33, s38, 3
  s_add_u32 s33, s33, s32
  s_add_u32 s33, s33, 0x10400
  v_add_u32_e64 v196, s33, v118
  s_mul_i32 s32, s37, 0x6000
  s_lshl_b32 s33, s39, 10
  s_add_u32 s33, s33, s32
  s_add_u32 s33, s33, 0x10000
  v_add_u32 v197, s33, v118
  v_add_u32 v125, 16, v113
  v_lshrrev_b32_e64 v125, 6, v125
  buffer_load_dwordx4 a[72:75], v202, s[64:67], s43 offen
  v_lshlrev_b32 v125, 4, v125
  v_xor_b32 v254, v125, v118
  v_lshl_add_u32 v125, v139, 4, 16
  v_xor_b32_e64 v255, v125, v118
  v_mul_u32_u24 v125, 0x1200, v139
  v_add_u32_e64 v255, v125, v255
  v_add_u32 v125, 0xb0, v113
  v_lshrrev_b32 v125, 6, v125
  v_lshlrev_b32 v125, 4, v125
  v_xor_b32_e64 v194, v125, v118
  v_add_u32 v194, 0x1200, v194
  s_mul_i32 s14, s27, 0x1800
  s_add_u32 s32, s27, 3
  s_and_b32 s32, s32, 3
  s_mul_i32 s32, s32, 0x600
  s_cmp_eq_u32 s27, 0
  s_cselect_b32 s57, 0, 3
  s_cselect_b32 s53, 3, 6
  s_cselect_b32 s55, 6, 0
  s_lshl_b32 s57, s57, 13
  s_add_u32 s57, s57, s32
  s_add_u32 s58, s57, 0x3000
  s_lshl_b32 s53, s53, 13
  s_add_u32 s53, s53, s32
  s_add_u32 s54, s53, 0x3000
  s_lshl_b32 s55, s55, 13
  s_add_u32 s55, s55, s32
  s_add_u32 s56, s55, 0x3000
  v_and_b32_e64 v145, 7, v113
  buffer_load_dwordx4 a[76:79], v202, s[64:67], s43 offen offset:128
  v_lshrrev_b32 v146, 4, v113
  v_lshlrev_b32 v147, 4, v139
  v_and_b32 v141, 1, v113
  v_lshlrev_b32 v141, 4, v141
  v_mov_b32 v127, 0xffff
  v_lshlrev_b32_e64 v127, v141, v127
  v_bfe_u32 v125, v113, 1, 2
  buffer_load_dwordx4 a[80:83], v202, s[64:67], s50 offen
  v_lshlrev_b32 v125, v125, 1
  v_bfe_i32 v56, v125, 0, 1
  v_mov_b32 v60, 0
  v_and_b32 v56, v56, v127
  v_bfe_i32 v57, v125, 1, 1
  v_mov_b32 v61, 0
  v_and_b32 v57, v57, v127
  v_bfe_i32 v58, v125, 2, 1
  v_mov_b32 v62, 0
  v_and_b32 v58, v58, v127
  v_bfe_i32 v59, v125, 3, 1
  v_mov_b32 v63, 0
  v_and_b32 v59, v59, v127
  v_min_u32_e64 v125, 35, v113
  v_mul_u32_u24 v125, 0x190, v125
  ds_write_b128 v125, v[60:63] offset:50304
  s_lshl_b32 s32, s44, 7
  v_lshrrev_b32 v142, 3, v113
  buffer_load_dwordx4 a[84:87], v202, s[64:67], s50 offen offset:128
  v_mul_u32_u24 v142, 0x190, v142
  v_lshl_add_u32 v142, v145, 4, v142
  v_add_u32 v142, s32, v142
  v_lshrrev_b32 v143, 3, v120
  v_mul_u32_u24 v143, 0x190, v143
  v_lshl_add_u32 v143, v145, 4, v143
  v_add_u32_e64 v143, s32, v143
  v_lshl_add_u32 v144, v120, 2, s32
  v_sub_u32_e64 v125, v146, v116
  v_lshl_add_u32 v126, v114, 2, v117
  v_lshl_add_u32 v126, v125, 3, v126
  v_min_u32 v126, 24, v126
  v_lshlrev_b32 v126, 4, v126
  v_add_u32 v3, 0xc300, v126
  v_lshlrev_b32_e64 v148, 2, v115
  v_lshl_add_u32 v148, v114, 1, v148
  v_bfe_u32 v126, v113, 1, 1
  buffer_load_dwordx4 a[88:91], v204, s[68:71], s51 offen
  v_add_u32 v148, v148, v126
  v_xor_b32 v126, v116, v139
  v_lshl_add_u32 v148, v126, 3, v148
  v_lshlrev_b32 v148, v148, 1
  v_mov_b32 v126, 0x3f80
  v_lshlrev_b32_e64 v126, v141, v126
  v_mov_b32 v125, 0xbf80
  v_lshlrev_b32_e64 v125, v141, v125
  v_bfe_i32 v160, v148, 0, 1
  v_and_b32 v240, v160, v126
  v_and_b32 v184, v160, v125
  v_bfe_i32 v161, v148, 1, 1
  v_and_b32 v241, v161, v126
  v_and_b32 v185, v161, v125
  v_bfe_i32 v162, v148, 2, 1
  v_and_b32 v242, v162, v126
  v_and_b32 v186, v162, v125
  v_bfe_i32 v163, v148, 3, 1
  buffer_load_dwordx4 a[92:95], v204, s[68:71], s51 offen offset:128
  v_and_b32 v243, v163, v126
  v_and_b32 v187, v163, v125
  v_bfe_i32 v164, v148, 4, 1
  v_and_b32 v244, v164, v126
  v_and_b32 v188, v164, v125
  v_bfe_i32 v165, v148, 5, 1
  v_and_b32 v245, v165, v126
  v_and_b32 v189, v165, v125
  v_bfe_i32 v166, v148, 6, 1
  v_and_b32 v246, v166, v126
  v_and_b32 v190, v166, v125
  v_bfe_i32 v167, v148, 7, 1
  v_and_b32 v247, v167, v126
  v_and_b32 v191, v167, v125
  s_mov_b32 s22, 0x3eeff558
  s_mov_b32 s24, 0x3c2aaaab
  s_mov_b32 s25, 0x3727c5ac
  s_mov_b32 s20, 0x409d30fc
  s_mov_b32 s21, 0x409d30fc
  s_mov_b32 s23, 0x3eeff558
  s_mov_b32 s12, 0
  s_mov_b32 s13, -1
  s_add_u32 s29, s59, 0x77000
  s_add_u32 s52, s59, 0xa7000
  v_mul_u32_u24 v149, 0xc0, v145
  buffer_load_dwordx4 a[0:3], v203, s[64:67], s40 offen
  v_add_u32_e64 v127, s15, v149
  v_lshl_add_u32 v150, v114, 1, v146
  v_lshrrev_b32_e64 v125, 1, v150
  v_mul_u32_u24 v140, 0x4100, v125
  v_and_b32_e64 v125, 1, v125
  v_lshl_add_u32 v140, v125, 5, v140
  v_and_b32_e64 v125, 1, v150
  v_mul_u32_u24 v125, 0x790, v125
  v_add3_u32 v4, v140, v125, v127
  v_lshl_add_u32 v151, v114, 1, v115
  buffer_load_dwordx4 a[4:7], v203, s[64:67], s40 offen offset:128
  s_add_u32 s40, s40, 0x1800
  v_add_u32_e64 v150, 1, v151
  v_add_u32 v127, 0xc0, v127
  v_add_u32_e64 v127, v127, v147
  v_lshrrev_b32_e64 v125, 1, v150
  v_mul_u32_u24 v140, 0x4100, v125
  v_and_b32_e64 v125, 1, v125
  v_lshl_add_u32 v140, v125, 5, v140
  v_and_b32_e64 v125, 1, v150
  v_mul_u32_u24 v125, 0x790, v125
  v_add3_u32 v5, v140, v125, v127
  v_mul_u32_u24 v125, 0x18000, v151
  v_add3_u32 v10, v125, v147, v149
  s_sub_u32 s32, s3, 0xf40
  v_add_u32_e64 v10, s32, v10
  v_add_u32 v2, 0xfb40, v147
  v_add_u32 v0, 0x10000, v118
  v_add_u32 v1, 0x20000, v118
  v_and_b32_e64 v125, 15, v113
  buffer_load_dwordx4 a[8:11], v203, s[64:67], s40 offen
  v_lshlrev_b32 v125, 7, v125
  v_mul_u32_u24 v126, 0x18000, v146
  s_sub_u32 s32, s3, 64
  v_add3_u32 v248, v125, v126, s32
  v_mov_b32 v250, 0x3ef00000
  s_add_u32 s32, s14, 0x16000
  v_add_u32_e64 v253, s32, v118
  v_bfe_u32 v125, v122, 2, 2
  v_xor_b32_e64 v125, v125, v139
  v_lshl_add_u32 v125, v125, 4, s32
  v_mul_u32_u24 v126, 0xc0, v122
  v_add_u32_e64 v251, v125, v126
  v_xor_b32_e64 v252, 32, v251
  s_add_u32 s30, s15, 32
  s_add_u32 s31, s15, 0x4100
  s_mov_b32 s34, s59
  s_mov_b32 s28, 0x80000000
  s_add_u32 s33, s15, 0x8200
  buffer_load_dwordx4 a[12:15], v203, s[64:67], s40 offen offset:128
  buffer_load_dwordx4 a[16:19], v203, s[64:67], s41 offen
  buffer_load_dwordx4 a[20:23], v203, s[64:67], s41 offen offset:128
  s_waitcnt vmcnt(25)
  v_lshl_or_b32 v129, v129, 16, v129
  v_and_b32 v16, v56, v129
  v_and_b32 v17, v57, v129
  v_and_b32 v18, v58, v129
  v_and_b32_e64 v19, v59, v129
  ds_write_b128 v142, v[16:19] offset:49920
  s_waitcnt vmcnt(24)
  v_lshl_or_b32 v130, v130, 16, v130
  v_and_b32 v20, v56, v130
  v_and_b32 v21, v57, v130
  v_and_b32 v22, v58, v130
  v_and_b32 v23, v59, v130
  ds_write_b128 v142, v[20:23] offset:53120
  s_waitcnt vmcnt(23)
  v_lshl_or_b32 v131, v131, 16, v131
  v_and_b32 v24, v56, v131
  v_and_b32 v25, v57, v131
  v_and_b32 v26, v58, v131
  v_and_b32 v27, v59, v131
  ds_write_b128 v142, v[24:27] offset:56320
  s_waitcnt vmcnt(22)
  v_lshl_or_b32 v132, v132, 16, v132
  v_and_b32 v28, v56, v132
  v_and_b32 v29, v57, v132
  v_and_b32 v30, v58, v132
  v_and_b32 v31, v59, v132
  ds_write_b128 v142, v[28:31] offset:59520
  s_waitcnt vmcnt(21)
  v_lshl_or_b32 v133, v133, 16, v133
  v_and_b32 v16, v56, v133
  v_and_b32 v17, v57, v133
  v_and_b32 v18, v58, v133
  v_and_b32 v19, v59, v133
  ds_write_b128 v143, v[16:19] offset:62720
  s_waitcnt vmcnt(20)
  v_lshlrev_b32 v137, 16, v137
  s_waitcnt vmcnt(19)
  v_lshlrev_b32 v138, 16, v138
  v_mul_f32 v138, v137, v138
  s_waitcnt vmcnt(18)
  v_lshlrev_b32 v134, v141, v134
  s_waitcnt vmcnt(17)
  v_lshlrev_b32 v135, v141, v135
  s_waitcnt vmcnt(16)
  v_lshlrev_b32_e64 v136, v141, v136
  ds_write_b32 v144, v138 offset:64320
  s_waitcnt lgkmcnt(0)
  s_barrier
  ds_read_b128 a[96:99], v3
  ds_read_b128 a[100:103], v3 offset:4800
  ds_read_b128 a[104:107], v3 offset:9600
  ds_read_b128 a[108:111], v3 offset:400
  ds_read_b128 a[112:115], v3 offset:5200
  ds_read_b128 a[116:119], v3 offset:10000
  v_and_b32 v125, v160, v134
  v_and_b32 v126, v161, v134
  v_and_b32_e64 v127, v162, v134
  buffer_load_dwordx4 a[24:27], v203, s[64:67], s42 offen
  v_and_b32_e64 v140, v163, v134
  v_accvgpr_write_b32 a192, v125
  v_accvgpr_write_b32 a193, v126
  v_accvgpr_write_b32 a194, v127
  v_accvgpr_write_b32 a195, v140
  ds_read_b128 a[120:123], v3 offset:800
  ds_read_b128 a[124:127], v3 offset:5600
  ds_read_b128 a[128:131], v3 offset:10400
  ds_read_b128 a[132:135], v3 offset:1200
  ds_read_b128 a[136:139], v3 offset:6000
  ds_read_b128 a[140:143], v3 offset:10800
  buffer_load_dwordx4 a[28:31], v203, s[64:67], s42 offen offset:128
  s_add_u32 s42, s42, 0x1800
  v_and_b32 v125, v164, v134
  v_and_b32 v126, v165, v134
  v_and_b32 v127, v166, v134
  v_and_b32 v140, v167, v134
  v_accvgpr_write_b32 a196, v125
  v_accvgpr_write_b32 a197, v126
  v_accvgpr_write_b32 a198, v127
  v_accvgpr_write_b32 a199, v140
  ds_read_b128 a[144:147], v3 offset:1600
  ds_read_b128 a[148:151], v3 offset:6400
  buffer_load_dwordx4 a[32:35], v203, s[64:67], s42 offen
  ds_read_b128 a[152:155], v3 offset:11200
  ds_read_b128 a[156:159], v3 offset:2000
  ds_read_b128 a[160:163], v3 offset:6800
  ds_read_b128 a[164:167], v3 offset:11600
  v_and_b32 v125, v160, v135
  v_and_b32 v126, v161, v135
  v_and_b32 v127, v162, v135
  v_and_b32 v140, v163, v135
  v_accvgpr_write_b32 a200, v125
  v_accvgpr_write_b32 a201, v126
  v_accvgpr_write_b32 a202, v127
  buffer_load_dwordx4 a[36:39], v203, s[64:67], s42 offen offset:128
  s_add_u32 s42, s42, 0x1800
  v_accvgpr_write_b32 a203, v140
  ds_read_b128 a[240:243], v3 offset:2400
  ds_read_b128 a[244:247], v3 offset:7200
  ds_read_b128 a[248:251], v3 offset:12000
  ds_read_b128 a[168:171], v3 offset:2800
  ds_read_b128 a[172:175], v3 offset:7600
  ds_read_b128 a[176:179], v3 offset:12400
  v_and_b32 v125, v164, v135
  v_and_b32 v126, v165, v135
  v_and_b32 v127, v166, v135
  v_and_b32 v140, v167, v135
  buffer_load_dwordx4 a[40:43], v203, s[64:67], s42 offen
  v_accvgpr_write_b32 a204, v125
  v_accvgpr_write_b32 a205, v126
  v_accvgpr_write_b32 a206, v127
  v_accvgpr_write_b32 a207, v140
  ds_read_b128 a[252:255], v3 offset:3200
  ds_read_b128 a[180:183], v3 offset:8000
  ds_read_b128 a[184:187], v3 offset:12800
  ds_read_b128 a[188:191], v3 offset:3600
  ds_read_b128 a[216:219], v3 offset:8400
  ds_read_b128 a[220:223], v3 offset:13200
  buffer_load_dwordx4 a[44:47], v203, s[64:67], s42 offen offset:128
  s_add_u32 s42, s42, 0x1800
  v_and_b32 v125, v160, v136
  v_and_b32 v126, v161, v136
  v_and_b32 v127, v162, v136
  v_and_b32 v140, v163, v136
  v_accvgpr_write_b32 a208, v125
  v_accvgpr_write_b32 a209, v126
  v_accvgpr_write_b32 a210, v127
  v_accvgpr_write_b32 a211, v140
  ds_read_b128 a[224:227], v3 offset:4000
  ds_read_b128 a[228:231], v3 offset:8800
  ds_read_b128 a[232:235], v3 offset:13600
  buffer_load_dwordx4 a[48:51], v203, s[64:67], s42 offen
  ds_read_b128 a[236:239], v3 offset:4400
  ds_read_b128 v[208:211], v3 offset:9200
  ds_read_b128 v[212:215], v3 offset:14000
  v_and_b32 v125, v164, v136
  v_and_b32 v126, v165, v136
  v_and_b32 v127, v166, v136
  v_and_b32 v140, v167, v136
  v_accvgpr_write_b32 a212, v125
  v_accvgpr_write_b32 a213, v126
  v_accvgpr_write_b32 a214, v127
  buffer_load_dwordx4 a[52:55], v203, s[64:67], s42 offen offset:128
  s_add_u32 s42, s42, 0x1800
  v_accvgpr_write_b32 a215, v140
  s_waitcnt vmcnt(19)
  v_mfma_f32_32x32x16_bf16 v[16:31], a[72:75], v[184:187], 0
  buffer_load_dwordx4 a[56:59], v203, s[64:67], s42 offen
  s_waitcnt vmcnt(19)
  v_mfma_f32_32x32x16_bf16 v[16:31], a[76:79], v[188:191], v[16:31]
  s_waitcnt vmcnt(18)
  v_mfma_f32_32x32x16_bf16 v[32:47], a[80:83], v[184:187], 0
  s_nop 0
  buffer_load_dwordx4 a[60:63], v203, s[64:67], s42 offen offset:128
  s_add_u32 s42, s42, 0x1800
  s_waitcnt vmcnt(15)
  v_mfma_f32_32x32x16_bf16 v[48:63], a[0:3], v[240:243], v[16:31]
  s_nop 0
  buffer_load_dwordx4 a[64:67], v203, s[64:67], s42 offen
  v_mfma_f32_32x32x16_bf16 v[32:47], a[84:87], v[188:191], v[32:47]
  s_waitcnt vmcnt(15)
  v_mfma_f32_32x32x16_bf16 v[48:63], a[4:7], v[244:247], v[48:63]
  buffer_load_dwordx4 a[68:71], v203, s[64:67], s42 offen offset:128
  s_waitcnt vmcnt(15)
  v_mfma_f32_32x32x16_bf16 v[216:231], a[8:11], v[240:243], v[16:31]
  s_add_u32 m0, s15, 0x8200
  s_nop 0
  buffer_load_dwordx4 v6, s[4:7], s49 offen lds
  s_waitcnt vmcnt(15)
  v_mfma_f32_32x32x16_bf16 v[216:231], a[12:15], v[244:247], v[216:231]
  buffer_load_dwordx4 v7, s[4:7], s49 offen offset:1024 lds
  s_nop 2
  v_cvt_pk_bf16_f32 v64, v48, v52
  v_cvt_pk_bf16_f32 v65, v56, v60
  v_cvt_pk_bf16_f32 v68, v49, v53
  v_cvt_pk_bf16_f32 v69, v57, v61
  s_waitcnt vmcnt(15)
  v_mfma_f32_32x32x16_bf16 v[96:111], a[16:19], v[240:243], v[16:31]
  buffer_load_dwordx4 v8, s[4:7], s49 offen offset:2048 lds
  v_cvt_pk_bf16_f32 v72, v50, v54
  v_cvt_pk_bf16_f32 v73, v58, v62
  v_cvt_pk_bf16_f32 v76, v51, v55
  v_cvt_pk_bf16_f32 v77, v59, v63
  s_waitcnt vmcnt(15)
  v_mfma_f32_32x32x16_bf16 v[96:111], a[20:23], v[244:247], v[96:111]
  buffer_load_dwordx4 v9, s[4:7], s49 offen offset:3072 lds
  v_cvt_pk_bf16_f32 v66, v216, v220
  v_cvt_pk_bf16_f32 v67, v224, v228
  v_cvt_pk_bf16_f32 v70, v217, v221
  v_cvt_pk_bf16_f32 v71, v225, v229
  ds_write_b128 v195, v[64:67]
  s_waitcnt vmcnt(15)
  v_mfma_f32_32x32x16_bf16 v[48:63], a[24:27], v[240:243], v[32:47]
  s_add_u32 m0, s15, 0
  s_nop 0
  buffer_load_dwordx4 v198, s[4:7], 0 offen lds
  ds_write_b128 v195, v[68:71] offset:6144
  v_cvt_pk_bf16_f32 v74, v218, v222
  v_cvt_pk_bf16_f32 v75, v226, v230
  v_cvt_pk_bf16_f32 v78, v219, v223
  v_cvt_pk_bf16_f32 v79, v227, v231
  s_waitcnt vmcnt(15)
  v_mfma_f32_32x32x16_bf16 v[48:63], a[28:31], v[244:247], v[48:63]
  s_add_u32 m0, s15, 0x400
  s_nop 0
  buffer_load_dwordx4 v199, s[4:7], 0 offen lds
  ds_write_b128 v195, v[72:75] offset:12288
  v_cvt_pk_bf16_f32 v80, v96, v100
  v_cvt_pk_bf16_f32 v81, v104, v108
  v_cvt_pk_bf16_f32 v84, v97, v101
  v_cvt_pk_bf16_f32 v85, v105, v109
  s_waitcnt vmcnt(15)
  v_mfma_f32_32x32x16_bf16 v[216:231], a[32:35], v[240:243], v[32:47]
  s_add_u32 m0, s15, 0x800
  s_nop 0
  buffer_load_dwordx4 v200, s[4:7], 0 offen lds
  ds_write_b128 v195, v[76:79] offset:18432
  v_cvt_pk_bf16_f32 v88, v98, v102
  v_cvt_pk_bf16_f32 v89, v106, v110
  v_cvt_pk_bf16_f32 v92, v99, v103
  v_cvt_pk_bf16_f32 v93, v107, v111
  s_waitcnt vmcnt(15)
  v_mfma_f32_32x32x16_bf16 v[216:231], a[36:39], v[244:247], v[216:231]
  s_add_u32 m0, s15, 0xc00
  s_nop 0
  buffer_load_dwordx4 v201, s[4:7], 0 offen lds
  ds_write_b64 v196, v[80:81]
  ds_write_b64 v196, v[84:85] offset:6144
  v_cvt_pk_bf16_f32 v64, v48, v52
  v_cvt_pk_bf16_f32 v65, v56, v60
  v_cvt_pk_bf16_f32 v68, v49, v53
  v_cvt_pk_bf16_f32 v69, v57, v61
  s_waitcnt vmcnt(15)
  v_mfma_f32_32x32x16_bf16 v[96:111], a[40:43], v[240:243], v[32:47]
  s_add_u32 m0, s14, 0x22000
  s_nop 0
  buffer_load_dwordx4 v254, s[72:75], s57 offen lds
  ds_write_b64 v196, v[88:89] offset:12288
  ds_write_b64 v196, v[92:93] offset:18432
  v_cvt_pk_bf16_f32 v72, v50, v54
  v_cvt_pk_bf16_f32 v73, v58, v62
  v_cvt_pk_bf16_f32 v76, v51, v55
  v_cvt_pk_bf16_f32 v77, v59, v63
  s_waitcnt vmcnt(15)
  v_mfma_f32_32x32x16_bf16 v[96:111], a[44:47], v[244:247], v[96:111]
  s_nop 0
  buffer_load_dwordx4 v255, s[72:75], s57 offen offset:1024 lds
  v_cvt_pk_bf16_f32 v66, v216, v220
  v_cvt_pk_bf16_f32 v67, v224, v228
  v_cvt_pk_bf16_f32 v70, v217, v221
  v_cvt_pk_bf16_f32 v71, v225, v229
  ds_write_b128 v197, v[64:67]
  s_waitcnt vmcnt(15)
  v_mfma_f32_32x32x16_bf16 v[48:63], a[48:51], v[240:243], v[32:47]
  s_nop 0
  buffer_load_dwordx4 v194, s[72:75], s57 offen offset:2048 lds
  ds_write_b128 v197, v[68:71] offset:6144
  v_cvt_pk_bf16_f32 v74, v218, v222
  v_cvt_pk_bf16_f32 v75, v226, v230
  v_cvt_pk_bf16_f32 v78, v219, v223
  v_cvt_pk_bf16_f32 v79, v227, v231
  s_waitcnt vmcnt(15)
  v_mfma_f32_32x32x16_bf16 v[48:63], a[52:55], v[244:247], v[48:63]
  s_add_u32 m0, s14, 0x22c00
  s_nop 0
  buffer_load_dwordx4 v254, s[72:75], s58 offen lds
  ds_write_b128 v197, v[72:75] offset:12288
  v_cvt_pk_bf16_f32 v80, v96, v100
  v_cvt_pk_bf16_f32 v81, v104, v108
  v_cvt_pk_bf16_f32 v84, v97, v101
  v_cvt_pk_bf16_f32 v85, v105, v109
  s_waitcnt vmcnt(15)
  v_mfma_f32_32x32x16_bf16 v[216:231], a[56:59], v[240:243], v[32:47]
  s_nop 0
  buffer_load_dwordx4 v255, s[72:75], s58 offen offset:1024 lds
  ds_write_b128 v197, v[76:79] offset:18432
  v_cvt_pk_bf16_f32 v88, v98, v102
  v_cvt_pk_bf16_f32 v89, v106, v110
  v_cvt_pk_bf16_f32 v92, v99, v103
  v_cvt_pk_bf16_f32 v93, v107, v111
  v_mfma_f32_32x32x16_bf16 v[96:111], a[88:91], v[240:243], v[32:47]
  s_waitcnt vmcnt(15)
  v_mfma_f32_32x32x16_bf16 v[216:231], a[60:63], v[244:247], v[216:231]
  s_nop 0
  buffer_load_dwordx4 v194, s[72:75], s58 offen offset:2048 lds
  v_cvt_pk_bf16_f32 v82, v48, v52
  v_cvt_pk_bf16_f32 v83, v56, v60
  v_cvt_pk_bf16_f32 v86, v49, v53
  v_cvt_pk_bf16_f32 v87, v57, v61
  ds_write_b128 v197, v[80:83] offset:1024
  v_mfma_f32_32x32x16_bf16 v[96:111], a[92:95], v[244:247], v[96:111]
  s_waitcnt vmcnt(15)
  v_mfma_f32_32x32x16_bf16 v[96:111], a[64:67], v[240:243], v[96:111]
  s_nop 0
  ds_write_b128 v197, v[84:87] offset:7168
  v_cvt_pk_bf16_f32 v90, v50, v54
  v_cvt_pk_bf16_f32 v91, v58, v62
  v_cvt_pk_bf16_f32 v94, v51, v55
  v_cvt_pk_bf16_f32 v95, v59, v63
  s_waitcnt vmcnt(14)
  v_mfma_f32_32x32x16_bf16 v[96:111], a[68:71], v[244:247], v[96:111]
  s_nop 0
  ds_write_b128 v197, v[88:91] offset:13312
  v_cvt_pk_bf16_f32 v64, v216, v220
  v_cvt_pk_bf16_f32 v65, v224, v228
  v_cvt_pk_bf16_f32 v68, v217, v221
  v_cvt_pk_bf16_f32 v69, v225, v229
  ds_write_b128 v197, v[92:95] offset:19456
  v_cvt_pk_bf16_f32 v72, v218, v222
  v_cvt_pk_bf16_f32 v73, v226, v230
  v_cvt_pk_bf16_f32 v76, v219, v223
  v_cvt_pk_bf16_f32 v77, v227, v231
  s_nop 1
  s_nop 0
  v_cvt_pk_bf16_f32 v66, v96, v100
  v_cvt_pk_bf16_f32 v67, v104, v108
  v_cvt_pk_bf16_f32 v70, v97, v101
  v_cvt_pk_bf16_f32 v71, v105, v109
  ds_write_b128 v197, v[64:67] offset:2048
  ds_write_b128 v197, v[68:71] offset:8192
  v_cvt_pk_bf16_f32 v74, v98, v102
  v_cvt_pk_bf16_f32 v75, v106, v110
  v_cvt_pk_bf16_f32 v78, v99, v103
  v_cvt_pk_bf16_f32 v79, v107, v111
  ds_write_b128 v197, v[72:75] offset:14336
  ds_write_b128 v197, v[76:79] offset:20480
  s_waitcnt lgkmcnt(0)
  s_barrier
  ds_read_b128 a[0:3], v0 offset:24576
  ds_read_b128 a[4:7], v0 offset:25600
  ds_read_b128 a[8:11], v0 offset:26624
  ds_read_b128 a[12:15], v0 offset:27648
  ds_read_b128 a[16:19], v0 offset:28672
  ds_read_b128 a[20:23], v0 offset:29696
  ds_read_b128 a[24:27], v0 offset:30720
  ds_read_b128 a[28:31], v0 offset:31744
  ds_read_b128 a[32:35], v0 offset:32768
  ds_read_b128 a[36:39], v0 offset:33792
  ds_read_b128 a[40:43], v0 offset:34816
  ds_read_b128 a[44:47], v0 offset:35840
  ds_read_b128 a[48:51], v0 offset:36864
  ds_read_b128 a[52:55], v0 offset:37888
  ds_read_b128 a[56:59], v0 offset:38912
  ds_read_b128 a[60:63], v0 offset:39936
  ds_read_b128 a[64:67], v0 offset:40960
  ds_read_b128 a[68:71], v0 offset:41984
  ds_read_b128 a[72:75], v0 offset:43008
  ds_read_b128 a[76:79], v0 offset:44032
  ds_read_b128 a[80:83], v0 offset:45056
  ds_read_b128 a[84:87], v0 offset:46080
  ds_read_b128 a[88:91], v0 offset:47104
  ds_read_b128 a[92:95], v0 offset:48128
  s_waitcnt vmcnt(6)
  s_nop 0
  ds_read_b128 v[216:219], v4
  ds_read_b128 v[220:223], v4 offset:16
  ds_read_b128 v[224:227], v4 offset:192
  ds_read_b128 v[228:231], v4 offset:208
  ds_read_b128 v[232:235], v4 offset:384
  ds_read_b128 v[236:239], v4 offset:400
  ds_read_b128 v[160:163], v4 offset:32
  ds_read_b128 v[164:167], v4 offset:48
  ds_read_b128 v[168:171], v4 offset:224
  ds_read_b128 v[172:175], v4 offset:240
  ds_read_b128 v[176:179], v4 offset:416
  s_waitcnt lgkmcnt(10)
  v_mfma_f32_16x16x32_bf16 v[112:115], a[96:99], v[216:219], 0
  s_waitcnt lgkmcnt(9)
  ds_read_b128 v[180:183], v4 offset:432
  v_mfma_f32_16x16x32_bf16 v[116:119], a[108:111], v[220:223], 0
  s_waitcnt lgkmcnt(9)
  ds_read_b128 v[216:219], v4 offset:64
  v_mfma_f32_16x16x32_bf16 v[112:115], a[100:103], v[224:227], v[112:115]
  s_waitcnt lgkmcnt(9)
  ds_read_b128 v[220:223], v4 offset:80
  v_mfma_f32_16x16x32_bf16 v[116:119], a[112:115], v[228:231], v[116:119]
  s_waitcnt lgkmcnt(9)
  ds_read_b128 v[224:227], v4 offset:256
  v_mfma_f32_16x16x32_bf16 v[112:115], a[104:107], v[232:235], v[112:115]
  s_waitcnt lgkmcnt(9)
  ds_read_b128 v[228:231], v4 offset:272
  v_mfma_f32_16x16x32_bf16 v[116:119], a[116:119], v[236:239], v[116:119]
  s_waitcnt lgkmcnt(9)
  ds_read_b128 v[232:235], v4 offset:448
  v_mfma_f32_16x16x32_bf16 v[120:123], a[120:123], v[160:163], 0
  s_waitcnt lgkmcnt(9)
  ds_read_b128 v[236:239], v4 offset:464
  v_mfma_f32_16x16x32_bf16 v[124:127], a[132:135], v[164:167], 0
  s_waitcnt lgkmcnt(9)
  ds_read_b128 v[160:163], v4 offset:96
  v_mfma_f32_16x16x32_bf16 v[120:123], a[124:127], v[168:171], v[120:123]
  s_waitcnt lgkmcnt(9)
  ds_read_b128 v[164:167], v4 offset:112
  v_mfma_f32_16x16x32_bf16 v[124:127], a[136:139], v[172:175], v[124:127]
  s_waitcnt lgkmcnt(9)
  ds_read_b128 v[168:171], v4 offset:288
  v_mfma_f32_16x16x32_bf16 v[120:123], a[128:131], v[176:179], v[120:123]
  s_waitcnt lgkmcnt(9)
  ds_read_b128 v[172:175], v4 offset:304
  v_mfma_f32_16x16x32_bf16 v[124:127], a[140:143], v[180:183], v[124:127]
  s_waitcnt lgkmcnt(9)
  ds_read_b128 v[176:179], v4 offset:480
  v_mfma_f32_16x16x32_bf16 v[128:131], a[144:147], v[216:219], 0
  s_waitcnt lgkmcnt(9)
  ds_read_b128 v[180:183], v4 offset:496
  v_mfma_f32_16x16x32_bf16 v[132:135], a[156:159], v[220:223], 0
  s_waitcnt lgkmcnt(9)
  ds_read_b128 v[216:219], v4 offset:128
  v_mfma_f32_16x16x32_bf16 v[128:131], a[148:151], v[224:227], v[128:131]
  s_waitcnt lgkmcnt(9)
  ds_read_b128 v[220:223], v4 offset:144
  v_mfma_f32_16x16x32_bf16 v[132:135], a[160:163], v[228:231], v[132:135]
  s_waitcnt lgkmcnt(9)
  ds_read_b128 v[224:227], v4 offset:320
  v_mfma_f32_16x16x32_bf16 v[128:131], a[152:155], v[232:235], v[128:131]
  s_waitcnt lgkmcnt(9)
  ds_read_b128 v[228:231], v4 offset:336
  v_mfma_f32_16x16x32_bf16 v[132:135], a[164:167], v[236:239], v[132:135]
  s_waitcnt lgkmcnt(9)
  ds_read_b128 v[232:235], v4 offset:512
  v_mfma_f32_16x16x32_bf16 v[136:139], a[240:243], v[160:163], 0
  s_waitcnt lgkmcnt(9)
  ds_read_b128 v[236:239], v4 offset:528
  v_mfma_f32_16x16x32_bf16 v[140:143], a[168:171], v[164:167], 0
  s_waitcnt lgkmcnt(9)
  ds_read_b128 v[160:163], v4 offset:160
  v_mfma_f32_16x16x32_bf16 v[136:139], a[244:247], v[168:171], v[136:139]
  s_waitcnt lgkmcnt(9)
  ds_read_b128 v[164:167], v4 offset:176
  v_mfma_f32_16x16x32_bf16 v[140:143], a[172:175], v[172:175], v[140:143]
  s_waitcnt lgkmcnt(9)
  ds_read_b128 v[168:171], v4 offset:352
  v_mfma_f32_16x16x32_bf16 v[136:139], a[248:251], v[176:179], v[136:139]
  s_waitcnt lgkmcnt(9)
  ds_read_b128 v[172:175], v4 offset:368
  v_mfma_f32_16x16x32_bf16 v[140:143], a[176:179], v[180:183], v[140:143]
  s_waitcnt lgkmcnt(9)
  ds_read_b128 v[176:179], v4 offset:544
  v_mfma_f32_16x16x32_bf16 v[144:147], a[252:255], v[216:219], 0
  s_waitcnt lgkmcnt(9)
  ds_read_b128 v[180:183], v4 offset:560
  v_mfma_f32_16x16x32_bf16 v[148:151], a[188:191], v[220:223], 0
  s_waitcnt lgkmcnt(9)
  v_mfma_f32_16x16x32_bf16 v[144:147], a[180:183], v[224:227], v[144:147]
  s_waitcnt lgkmcnt(8)
  v_mfma_f32_16x16x32_bf16 v[148:151], a[216:219], v[228:231], v[148:151]
  s_waitcnt lgkmcnt(7)
  v_mfma_f32_16x16x32_bf16 v[144:147], a[184:187], v[232:235], v[144:147]
  s_waitcnt lgkmcnt(6)
  v_mfma_f32_16x16x32_bf16 v[148:151], a[220:223], v[236:239], v[148:151]
  s_waitcnt lgkmcnt(5)
  v_mfma_f32_16x16x32_bf16 v[152:155], a[224:227], v[160:163], 0
  s_waitcnt lgkmcnt(4)
  v_mfma_f32_16x16x32_bf16 v[156:159], a[236:239], v[164:167], 0
  s_waitcnt lgkmcnt(3)
  v_mfma_f32_16x16x32_bf16 v[152:155], a[228:231], v[168:171], v[152:155]
  s_waitcnt lgkmcnt(2)
  v_mfma_f32_16x16x32_bf16 v[156:159], v[208:211], v[172:175], v[156:159]
  s_waitcnt lgkmcnt(1)
  v_mfma_f32_16x16x32_bf16 v[152:155], a[232:235], v[176:179], v[152:155]
  s_waitcnt lgkmcnt(0)
  v_mfma_f32_16x16x32_bf16 v[156:159], v[212:215], v[180:183], v[156:159]
  buffer_load_dword v249, v248, s[4:7], s29 offen
  v_pk_add_f32 v[12:13], v[112:113], v[114:115]
  v_pk_mul_f32 v[14:15], v[112:113], v[112:113]
  v_pk_fma_f32 v[14:15], v[114:115], v[114:115], v[14:15]
  v_pk_add_f32 v[12:13], v[12:13], v[116:117]
  v_pk_fma_f32 v[14:15], v[116:117], v[116:117], v[14:15]
  v_pk_add_f32 v[12:13], v[12:13], v[118:119]
  v_pk_fma_f32 v[14:15], v[118:119], v[118:119], v[14:15]
  v_pk_add_f32 v[12:13], v[12:13], v[120:121]
  v_pk_fma_f32 v[14:15], v[120:121], v[120:121], v[14:15]
  v_pk_add_f32 v[12:13], v[12:13], v[122:123]
  v_pk_fma_f32 v[14:15], v[122:123], v[122:123], v[14:15]
  v_pk_add_f32 v[12:13], v[12:13], v[124:125]
  ds_read_b128 v[216:219], v0 offset:18432
  ds_read_b128 v[220:223], v0 offset:19456
  ds_read_b128 v[224:227], v0 offset:20480
  ds_read_b128 v[228:231], v0 offset:21504
  v_pk_fma_f32 v[14:15], v[124:125], v[124:125], v[14:15]
  v_pk_add_f32 v[12:13], v[12:13], v[126:127]
  v_pk_fma_f32 v[14:15], v[126:127], v[126:127], v[14:15]
  v_pk_add_f32 v[12:13], v[12:13], v[128:129]
  v_pk_fma_f32 v[14:15], v[128:129], v[128:129], v[14:15]
  v_pk_add_f32 v[12:13], v[12:13], v[130:131]
  v_pk_fma_f32 v[14:15], v[130:131], v[130:131], v[14:15]
  v_pk_add_f32 v[12:13], v[12:13], v[132:133]
  v_pk_fma_f32 v[14:15], v[132:133], v[132:133], v[14:15]
  v_pk_add_f32 v[12:13], v[12:13], v[134:135]
  v_pk_fma_f32 v[14:15], v[134:135], v[134:135], v[14:15]
  v_pk_add_f32 v[12:13], v[12:13], v[136:137]
  ds_read_b128 v[232:235], v0 offset:22528
  ds_read_b128 v[236:239], v0 offset:23552
  ds_read_b128 a[96:99], v0 offset:49152
  ds_read_b128 a[100:103], v0 offset:50176
  v_pk_fma_f32 v[14:15], v[136:137], v[136:137], v[14:15]
  v_pk_add_f32 v[12:13], v[12:13], v[138:139]
  v_pk_fma_f32 v[14:15], v[138:139], v[138:139], v[14:15]
  v_pk_add_f32 v[12:13], v[12:13], v[140:141]
  v_pk_fma_f32 v[14:15], v[140:141], v[140:141], v[14:15]
  v_pk_add_f32 v[12:13], v[12:13], v[142:143]
  v_pk_fma_f32 v[14:15], v[142:143], v[142:143], v[14:15]
  v_pk_add_f32 v[12:13], v[12:13], v[144:145]
  v_pk_fma_f32 v[14:15], v[144:145], v[144:145], v[14:15]
  v_pk_add_f32 v[12:13], v[12:13], v[146:147]
  v_pk_fma_f32 v[14:15], v[146:147], v[146:147], v[14:15]
  v_pk_add_f32 v[12:13], v[12:13], v[148:149]
  ds_read_b128 a[104:107], v0 offset:51200
  ds_read_b128 a[108:111], v0 offset:52224
  ds_read_b128 a[112:115], v0 offset:53248
  ds_read_b128 a[116:119], v0 offset:54272
  v_pk_fma_f32 v[14:15], v[148:149], v[148:149], v[14:15]
  v_pk_add_f32 v[12:13], v[12:13], v[150:151]
  v_pk_fma_f32 v[14:15], v[150:151], v[150:151], v[14:15]
  v_pk_add_f32 v[12:13], v[12:13], v[152:153]
  v_pk_fma_f32 v[14:15], v[152:153], v[152:153], v[14:15]
  v_pk_add_f32 v[12:13], v[12:13], v[154:155]
  v_pk_fma_f32 v[14:15], v[154:155], v[154:155], v[14:15]
  v_pk_add_f32 v[12:13], v[12:13], v[156:157]
  v_pk_fma_f32 v[14:15], v[156:157], v[156:157], v[14:15]
  v_pk_add_f32 v[12:13], v[12:13], v[158:159]
  v_pk_fma_f32 v[14:15], v[158:159], v[158:159], v[14:15]
  v_add_f32_e64 v12, v12, v13
  ds_read_b128 a[120:123], v0 offset:55296
  ds_read_b128 a[124:127], v0 offset:56320
  ds_read_b128 a[128:131], v0 offset:57344
  ds_read_b128 a[132:135], v0 offset:58368
  v_add_f32 v14, v14, v15
  s_nop 1
  v_permlane32_swap_b32 v12, v14
  v_add_f32 v12, v12, v14
  v_mov_b32 v14, v12
  s_nop 1
  v_permlane32_swap_b32 v12, v14
  v_mul_f32 v12, s24, v12
  v_mul_f32 v13, s24, v14
  v_fma_f32 v13, -v12, v12, v13
  v_max_f32 v13, 0, v13
  v_add_f32 v13, s25, v13
  v_rsq_f32 v13, v13
  s_nop 0
  v_mul_f32 v14, s22, v13
  ds_read_b128 a[136:139], v0 offset:59392
  ds_read_b128 a[140:143], v0 offset:60416
  ds_read_b128 a[144:147], v0 offset:61440
  ds_read_b128 a[148:151], v0 offset:62464
  v_mul_f32_e64 v12, -v12, v14
  v_pk_fma_f32 v[112:113], v[112:113], v[14:15], v[12:13] op_sel_hi:[1,0,0]
  v_pk_fma_f32 v[114:115], v[114:115], v[14:15], v[12:13] op_sel_hi:[1,0,0]
  v_pk_fma_f32 v[116:117], v[116:117], v[14:15], v[12:13] op_sel_hi:[1,0,0]
  v_pk_fma_f32 v[118:119], v[118:119], v[14:15], v[12:13] op_sel_hi:[1,0,0]
  v_pk_fma_f32 v[120:121], v[120:121], v[14:15], v[12:13] op_sel_hi:[1,0,0]
  v_pk_fma_f32 v[122:123], v[122:123], v[14:15], v[12:13] op_sel_hi:[1,0,0]
  v_pk_fma_f32 v[124:125], v[124:125], v[14:15], v[12:13] op_sel_hi:[1,0,0]
  v_pk_fma_f32 v[126:127], v[126:127], v[14:15], v[12:13] op_sel_hi:[1,0,0]
  v_pk_fma_f32 v[128:129], v[128:129], v[14:15], v[12:13] op_sel_hi:[1,0,0]
  v_pk_fma_f32 v[130:131], v[130:131], v[14:15], v[12:13] op_sel_hi:[1,0,0]
  v_pk_fma_f32 v[132:133], v[132:133], v[14:15], v[12:13] op_sel_hi:[1,0,0]
  ds_read_b128 a[152:155], v0 offset:63488
  ds_read_b128 a[156:159], v0 offset:64512
  ds_read_b128 a[160:163], v1
  ds_read_b128 a[164:167], v1 offset:1024
  v_pk_fma_f32 v[134:135], v[134:135], v[14:15], v[12:13] op_sel_hi:[1,0,0]
  v_pk_fma_f32 v[136:137], v[136:137], v[14:15], v[12:13] op_sel_hi:[1,0,0]
  v_pk_fma_f32 v[138:139], v[138:139], v[14:15], v[12:13] op_sel_hi:[1,0,0]
  v_pk_fma_f32 v[140:141], v[140:141], v[14:15], v[12:13] op_sel_hi:[1,0,0]
  v_pk_fma_f32 v[142:143], v[142:143], v[14:15], v[12:13] op_sel_hi:[1,0,0]
  v_pk_fma_f32 v[144:145], v[144:145], v[14:15], v[12:13] op_sel_hi:[1,0,0]
  v_pk_fma_f32 v[146:147], v[146:147], v[14:15], v[12:13] op_sel_hi:[1,0,0]
  v_pk_fma_f32 v[148:149], v[148:149], v[14:15], v[12:13] op_sel_hi:[1,0,0]
  v_pk_fma_f32 v[150:151], v[150:151], v[14:15], v[12:13] op_sel_hi:[1,0,0]
  v_pk_fma_f32 v[152:153], v[152:153], v[14:15], v[12:13] op_sel_hi:[1,0,0]
  v_pk_fma_f32 v[154:155], v[154:155], v[14:15], v[12:13] op_sel_hi:[1,0,0]
  v_pk_fma_f32 v[156:157], v[156:157], v[14:15], v[12:13] op_sel_hi:[1,0,0]
  ds_read_b128 a[168:171], v1 offset:2048
  ds_read_b128 a[172:175], v1 offset:3072
  ds_read_b128 a[176:179], v1 offset:4096
  ds_read_b128 a[180:183], v1 offset:5120
  v_pk_fma_f32 v[158:159], v[158:159], v[14:15], v[12:13] op_sel_hi:[1,0,0]
  v_cndmask_b32 v159, v159, v250, s[12:13]
  v_cvt_pk_bf16_f32 v160, v112, v113
  v_cvt_pk_bf16_f32 v161, v114, v115
  v_cvt_pk_bf16_f32 v162, v116, v117
  v_cvt_pk_bf16_f32 v163, v118, v119
  v_cvt_pk_bf16_f32 v164, v120, v121
  v_cvt_pk_bf16_f32 v165, v122, v123
  v_cvt_pk_bf16_f32 v166, v124, v125
  v_cvt_pk_bf16_f32 v167, v126, v127
  v_cvt_pk_bf16_f32 v168, v128, v129
  v_cvt_pk_bf16_f32 v169, v130, v131
  ds_read_b128 a[184:187], v1 offset:6144
  ds_read_b128 a[188:191], v1 offset:7168
  v_cvt_pk_bf16_f32 v170, v132, v133
  v_cvt_pk_bf16_f32 v171, v134, v135
  v_cvt_pk_bf16_f32 v172, v136, v137
  v_cvt_pk_bf16_f32 v173, v138, v139
  v_cvt_pk_bf16_f32 v174, v140, v141
  v_cvt_pk_bf16_f32 v175, v142, v143
  v_cvt_pk_bf16_f32 v176, v144, v145
  v_cvt_pk_bf16_f32 v177, v146, v147
  v_cvt_pk_bf16_f32 v178, v148, v149
  v_cvt_pk_bf16_f32 v179, v150, v151
  v_cvt_pk_bf16_f32 v180, v152, v153
  v_cvt_pk_bf16_f32 v181, v154, v155
  v_cvt_pk_bf16_f32 v182, v156, v157
  v_cvt_pk_bf16_f32 v183, v158, v159
  s_waitcnt lgkmcnt(15)
  v_mfma_f32_32x32x16_bf16 v[16:31], v[216:219], v[160:163], 0
  s_nop 0
  ds_read_b128 v[136:139], v5
  ds_read_b128 v[140:143], v5 offset:32
  ds_read_b128 v[144:147], v5 offset:64
  v_mfma_f32_32x32x16_bf16 v[16:31], v[220:223], v[164:167], v[16:31]
  ds_read_b128 v[148:151], v5 offset:96
  ds_read_b128 v[152:155], v5 offset:128
  ds_read_b128 v[156:159], v5 offset:160
  v_mfma_f32_32x32x16_bf16 v[16:31], v[224:227], v[168:171], v[16:31]
  s_waitcnt vmcnt(1)
  ds_read_b128 a[216:219], v251 offset:49152
  ds_read_b128 a[220:223], v252 offset:49152
  v_mfma_f32_32x32x16_bf16 v[16:31], v[228:231], v[172:175], v[16:31]
  s_nop 0
  ds_read_b128 a[224:227], v251 offset:49216
  ds_read_b128 a[228:231], v252 offset:49216
  ds_read_b128 a[232:235], v251 offset:49280
  v_mfma_f32_32x32x16_bf16 v[16:31], v[232:235], v[176:179], v[16:31]
  s_nop 0
  ds_read_b128 a[236:239], v252 offset:49280
  v_mfma_f32_32x32x16_bf16 v[16:31], v[236:239], v[180:183], v[16:31]
  s_nop 11
  v_pk_fma_f32 v[48:49], v[16:17], v[16:17], s[20:21] neg_lo:[1,0,1] neg_hi:[1,0,1]
  v_pk_fma_f32 v[50:51], v[18:19], v[18:19], s[20:21] neg_lo:[1,0,1] neg_hi:[1,0,1]
  v_pk_fma_f32 v[52:53], v[20:21], v[20:21], s[20:21] neg_lo:[1,0,1] neg_hi:[1,0,1]
  v_pk_fma_f32 v[54:55], v[22:23], v[22:23], s[20:21] neg_lo:[1,0,1] neg_hi:[1,0,1]
  v_pk_fma_f32 v[56:57], v[24:25], v[24:25], s[20:21] neg_lo:[1,0,1] neg_hi:[1,0,1]
  v_pk_fma_f32 v[58:59], v[26:27], v[26:27], s[20:21] neg_lo:[1,0,1] neg_hi:[1,0,1]
  v_pk_fma_f32 v[60:61], v[28:29], v[28:29], s[20:21] neg_lo:[1,0,1] neg_hi:[1,0,1]
  v_pk_fma_f32 v[62:63], v[30:31], v[30:31], s[20:21] neg_lo:[1,0,1] neg_hi:[1,0,1]
  v_pk_mul_f32 v[48:49], v[16:17], v[48:49]
  v_pk_mul_f32 v[50:51], v[18:19], v[50:51]
  v_pk_mul_f32 v[52:53], v[20:21], v[52:53]
  v_pk_mul_f32 v[54:55], v[22:23], v[54:55]
  v_pk_mul_f32 v[56:57], v[24:25], v[56:57]
  v_pk_mul_f32 v[58:59], v[26:27], v[58:59]
  v_pk_mul_f32 v[60:61], v[28:29], v[60:61]
  v_pk_mul_f32 v[62:63], v[30:31], v[62:63]
  s_waitcnt lgkmcnt(5)
  v_mfma_f32_32x32x16_bf16 v[64:79], a[216:219], a[192:195], 0
  s_mov_b32 m0, s30
  v_exp_f32 v48, v48
  v_exp_f32 v49, v49
  v_exp_f32 v50, v50
  v_exp_f32 v51, v51
  v_exp_f32 v52, v52
  s_waitcnt lgkmcnt(4)
  v_mfma_f32_32x32x16_bf16 v[64:79], a[220:223], a[196:199], v[64:79]
  buffer_load_dwordx4 v6, s[4:7], s29 offen lds
  v_exp_f32 v53, v53
  s_waitcnt lgkmcnt(3)
  v_mfma_f32_32x32x16_bf16 v[80:95], a[224:227], a[200:203], 0
  buffer_load_dwordx4 v7, s[4:7], s29 offen offset:1024 lds
  s_waitcnt lgkmcnt(2)
  v_mfma_f32_32x32x16_bf16 v[80:95], a[228:231], a[204:207], v[80:95]
  buffer_load_dwordx4 v8, s[4:7], s29 offen offset:2048 lds
  s_nop 3
  v_cvt_pk_bf16_f32 v64, v64, v65
  v_cvt_pk_bf16_f32 v65, v66, v67
  v_cvt_pk_bf16_f32 v66, v68, v69
  v_cvt_pk_bf16_f32 v67, v70, v71
  ds_write_b128 v253, v[64:67] offset:49152
  v_exp_f32 v54, v54
  v_exp_f32 v55, v55
  v_cvt_pk_bf16_f32 v68, v72, v73
  v_cvt_pk_bf16_f32 v69, v74, v75
  v_cvt_pk_bf16_f32 v70, v76, v77
  s_waitcnt lgkmcnt(2)
  v_mfma_f32_32x32x16_bf16 v[96:111], a[232:235], a[208:211], 0
  s_nop 0
  buffer_load_dwordx4 v9, s[4:7], s29 offen offset:3072 lds
  v_cvt_pk_bf16_f32 v71, v78, v79
  v_exp_f32_e64 v56, v56
  v_exp_f32 v57, v57
  ds_write_b128 v253, v[68:71] offset:52224
  s_waitcnt lgkmcnt(2)
  v_mfma_f32_32x32x16_bf16 v[96:111], a[236:239], a[212:215], v[96:111]
  v_cvt_pk_bf16_f32 v80, v80, v81
  v_cvt_pk_bf16_f32 v81, v82, v83
  v_cvt_pk_bf16_f32 v82, v84, v85
  v_cvt_pk_bf16_f32 v83, v86, v87
  v_exp_f32 v58, v58
  v_exp_f32 v59, v59
  ds_write_b128 v253, v[80:83] offset:50176
  v_cvt_pk_bf16_f32 v84, v88, v89
  v_cvt_pk_bf16_f32 v85, v90, v91
  v_cvt_pk_bf16_f32 v86, v92, v93
  v_cvt_pk_bf16_f32 v87, v94, v95
  v_exp_f32 v60, v60
  v_exp_f32 v61, v61
  ds_write_b128 v253, v[84:87] offset:53248
  v_cvt_pk_bf16_f32 v96, v96, v97
  v_cvt_pk_bf16_f32 v97, v98, v99
  v_cvt_pk_bf16_f32 v98, v100, v101
  v_cvt_pk_bf16_f32 v99, v102, v103
  v_exp_f32 v62, v62
  v_exp_f32 v63, v63
  v_cvt_pk_bf16_f32 v100, v104, v105
  v_cvt_pk_bf16_f32 v101, v106, v107
  v_cvt_pk_bf16_f32 v102, v108, v109
  v_cvt_pk_bf16_f32 v103, v110, v111
  ds_write_b128 v253, v[96:99] offset:51200
  v_pk_fma_f32 v[48:49], v[48:49], s[22:23], s[22:23]
  v_pk_fma_f32 v[50:51], v[50:51], s[22:23], s[22:23]
  v_pk_fma_f32 v[52:53], v[52:53], s[22:23], s[22:23]
  v_pk_fma_f32 v[54:55], v[54:55], s[22:23], s[22:23]
  v_pk_fma_f32 v[56:57], v[56:57], s[22:23], s[22:23]
  v_pk_fma_f32 v[58:59], v[58:59], s[22:23], s[22:23]
  v_pk_fma_f32 v[60:61], v[60:61], s[22:23], s[22:23]
  v_pk_fma_f32 v[62:63], v[62:63], s[22:23], s[22:23]
  ds_write_b128 v253, v[100:103] offset:54272
  s_waitcnt lgkmcnt(0)
  s_barrier
  v_mfma_f32_32x32x16_bf16 v[32:47], a[0:3], v[160:163], 0
  ds_read_b128 v[64:67], v2
  ds_read_b128 v[68:71], v2 offset:32
  ds_read_b128 v[72:75], v2 offset:64
  s_add_u32 m0, s14, 0x16000
  v_rcp_f32_e64 v48, v48
  v_mfma_f32_32x32x16_bf16 v[32:47], a[4:7], v[164:167], v[32:47]
  ds_read_b128 v[76:79], v2 offset:96
  ds_read_b128 v[80:83], v2 offset:128
  ds_read_b128 v[84:87], v2 offset:160
  buffer_load_dwordx4 v254, s[72:75], s53 offen lds
  v_rcp_f32_e64 v49, v49
  v_mfma_f32_32x32x16_bf16 v[32:47], a[8:11], v[168:171], v[32:47]
  ds_read_b128 v[88:91], v2 offset:192
  ds_read_b128 v[92:95], v2 offset:224
  ds_read_b128 v[96:99], v2 offset:256
  buffer_load_dwordx4 v255, s[72:75], s53 offen offset:1024 lds
  v_rcp_f32_e64 v50, v50
  v_mfma_f32_32x32x16_bf16 v[32:47], a[12:15], v[172:175], v[32:47]
  ds_read_b128 v[100:103], v2 offset:288
  ds_read_b128 v[104:107], v2 offset:320
  ds_read_b128 v[108:111], v2 offset:352
  v_rcp_f32_e64 v51, v51
  v_mfma_f32_32x32x16_bf16 v[32:47], a[16:19], v[176:179], v[32:47]
  buffer_load_dwordx4 v194, s[72:75], s53 offen offset:2048 lds
  s_add_u32 m0, s14, 0x16c00
  v_rcp_f32 v52, v52
  v_rcp_f32 v53, v53
  v_mfma_f32_32x32x16_bf16 v[32:47], a[20:23], v[180:183], v[32:47]
  s_waitcnt lgkmcnt(0)
  buffer_load_dwordx4 v254, s[72:75], s54 offen lds
  v_rcp_f32 v54, v54
  v_rcp_f32_e64 v55, v55
  v_mfma_f32_32x32x16_bf16 v[64:79], v[240:243], v[136:139], v[64:79]
  v_mov_b32 v112, v194
  v_rcp_f32 v56, v56
  v_rcp_f32_e64 v57, v57
  v_mfma_f32_32x32x16_bf16 v[64:79], v[244:247], v[140:143], v[64:79]
  buffer_load_dwordx4 v255, s[72:75], s54 offen offset:1024 lds
  v_rcp_f32 v58, v58
  v_rcp_f32 v59, v59
  v_mfma_f32_32x32x16_bf16 v[80:95], v[240:243], v[144:147], v[80:95]
  buffer_load_dwordx4 v194, s[72:75], s54 offen offset:2048 lds
  v_rcp_f32_e64 v60, v60
  v_rcp_f32_e64 v61, v61
  v_mfma_f32_32x32x16_bf16 v[80:95], v[244:247], v[148:151], v[80:95]
  ds_read_b128 v[192:195], v1 offset:8192
  ds_read_b128 v[196:199], v1 offset:9216
  v_rcp_f32_e64 v62, v62
  v_rcp_f32_e64 v63, v63
  v_mfma_f32_32x32x16_bf16 v[96:111], v[240:243], v[152:155], v[96:111]
  s_nop 0
  ds_read_b128 v[200:203], v1 offset:10240
  ds_read_b128 v[204:207], v1 offset:11264
  v_mfma_f32_32x32x16_bf16 v[96:111], v[244:247], v[156:159], v[96:111]
  s_waitcnt lgkmcnt(0)
  ds_read_b128 v[208:211], v1 offset:12288
  ds_read_b128 v[212:215], v1 offset:13312
  v_pk_mul_f32 v[16:17], v[16:17], v[48:49]
  v_pk_mul_f32 v[18:19], v[18:19], v[50:51]
  v_pk_mul_f32 v[20:21], v[20:21], v[52:53]
  v_pk_mul_f32 v[22:23], v[22:23], v[54:55]
  v_pk_mul_f32 v[24:25], v[24:25], v[56:57]
  v_pk_mul_f32 v[26:27], v[26:27], v[58:59]
  v_pk_mul_f32 v[28:29], v[28:29], v[60:61]
  v_pk_mul_f32 v[30:31], v[30:31], v[62:63]
  v_pk_fma_f32 v[48:49], v[32:33], v[32:33], s[20:21] neg_lo:[1,0,1] neg_hi:[1,0,1]
  v_pk_fma_f32 v[50:51], v[34:35], v[34:35], s[20:21] neg_lo:[1,0,1] neg_hi:[1,0,1]
  v_pk_fma_f32 v[52:53], v[36:37], v[36:37], s[20:21] neg_lo:[1,0,1] neg_hi:[1,0,1]
  v_pk_fma_f32 v[54:55], v[38:39], v[38:39], s[20:21] neg_lo:[1,0,1] neg_hi:[1,0,1]
  v_pk_fma_f32 v[56:57], v[40:41], v[40:41], s[20:21] neg_lo:[1,0,1] neg_hi:[1,0,1]
  v_pk_fma_f32 v[58:59], v[42:43], v[42:43], s[20:21] neg_lo:[1,0,1] neg_hi:[1,0,1]
  v_pk_fma_f32 v[60:61], v[44:45], v[44:45], s[20:21] neg_lo:[1,0,1] neg_hi:[1,0,1]
  v_pk_fma_f32 v[62:63], v[46:47], v[46:47], s[20:21] neg_lo:[1,0,1] neg_hi:[1,0,1]
  v_pk_mul_f32 v[48:49], v[32:33], v[48:49]
  v_pk_mul_f32 v[50:51], v[34:35], v[50:51]
  v_pk_mul_f32 v[52:53], v[36:37], v[52:53]
  v_pk_mul_f32 v[54:55], v[38:39], v[54:55]
  v_pk_mul_f32 v[56:57], v[40:41], v[56:57]
  v_cvt_pk_bf16_f32 v184, v16, v17
  v_cvt_pk_bf16_f32 v185, v18, v19
  v_cvt_pk_bf16_f32 v186, v20, v21
  v_cvt_pk_bf16_f32 v187, v22, v23
  v_pk_mul_f32 v[58:59], v[42:43], v[58:59]
  v_pk_mul_f32 v[60:61], v[44:45], v[60:61]
  v_pk_mul_f32 v[62:63], v[46:47], v[62:63]
  v_mfma_f32_32x32x16_bf16 v[64:79], v[192:195], v[184:187], v[64:79]
  s_mov_b32 m0, s31
  v_cvt_pk_bf16_f32 v188, v24, v25
  v_cvt_pk_bf16_f32 v189, v26, v27
  v_cvt_pk_bf16_f32 v190, v28, v29
  v_cvt_pk_bf16_f32 v191, v30, v31
  v_exp_f32 v48, v48
  v_mfma_f32_32x32x16_bf16 v[80:95], v[196:199], v[184:187], v[80:95]
  buffer_load_dwordx4 v6, s[4:7], s52 offen lds
  v_exp_f32 v49, v49
  v_exp_f32 v50, v50
  v_exp_f32_e64 v51, v51
  v_mfma_f32_32x32x16_bf16 v[96:111], v[200:203], v[184:187], v[96:111]
  buffer_load_dwordx4 v7, s[4:7], s52 offen offset:1024 lds
  v_exp_f32 v52, v52
  v_exp_f32 v53, v53
  v_mfma_f32_32x32x16_bf16 v[64:79], v[204:207], v[188:191], v[64:79]
  buffer_load_dwordx4 v8, s[4:7], s52 offen offset:2048 lds
  v_exp_f32 v54, v54
  v_exp_f32 v55, v55
  v_exp_f32 v56, v56
  s_waitcnt lgkmcnt(1)
  v_mfma_f32_32x32x16_bf16 v[80:95], v[208:211], v[188:191], v[80:95]
  buffer_load_dwordx4 v9, s[4:7], s52 offen offset:3072 lds
  v_exp_f32 v57, v57
  v_exp_f32 v58, v58
  s_waitcnt lgkmcnt(0)
  v_mfma_f32_32x32x16_bf16 v[96:111], v[212:215], v[188:191], v[96:111]
  v_exp_f32 v59, v59
  v_exp_f32 v60, v60
  v_exp_f32 v61, v61
  v_exp_f32 v62, v62
  v_exp_f32 v63, v63
  v_pk_fma_f32 v[48:49], v[48:49], s[22:23], s[22:23]
  v_pk_fma_f32 v[50:51], v[50:51], s[22:23], s[22:23]
  v_pk_fma_f32 v[52:53], v[52:53], s[22:23], s[22:23]
  v_pk_fma_f32 v[54:55], v[54:55], s[22:23], s[22:23]
  v_pk_fma_f32 v[56:57], v[56:57], s[22:23], s[22:23]
  v_pk_fma_f32 v[58:59], v[58:59], s[22:23], s[22:23]
  v_pk_fma_f32 v[60:61], v[60:61], s[22:23], s[22:23]
  v_pk_fma_f32 v[62:63], v[62:63], s[22:23], s[22:23]
  v_mfma_f32_32x32x16_bf16 v[16:31], a[24:27], v[160:163], 0
  ds_read_b128 v[192:195], v1 offset:14336
  ds_read_b128 v[196:199], v1 offset:15360
  s_add_u32 m0, s14, 0x1c000
  v_rcp_f32 v48, v48
  v_rcp_f32 v49, v49
  v_mfma_f32_32x32x16_bf16 v[16:31], a[28:31], v[164:167], v[16:31]
  ds_read_b128 v[200:203], v1 offset:16384
  ds_read_b128 v[204:207], v1 offset:17408
  buffer_load_dwordx4 v254, s[72:75], s55 offen lds
  v_rcp_f32 v50, v50
  v_rcp_f32 v51, v51
  v_mfma_f32_32x32x16_bf16 v[16:31], a[32:35], v[168:171], v[16:31]
  ds_read_b128 v[208:211], v1 offset:18432
  ds_read_b128 v[212:215], v1 offset:19456
  v_rcp_f32 v52, v52
  v_rcp_f32 v53, v53
  v_mfma_f32_32x32x16_bf16 v[16:31], a[36:39], v[172:175], v[16:31]
  buffer_load_dwordx4 v255, s[72:75], s55 offen offset:1024 lds
  v_rcp_f32 v54, v54
  v_rcp_f32 v55, v55
  v_rcp_f32_e64 v56, v56
  v_mfma_f32_32x32x16_bf16 v[16:31], a[40:43], v[176:179], v[16:31]
  v_rcp_f32 v57, v57
  v_rcp_f32 v58, v58
  v_rcp_f32 v59, v59
  v_mfma_f32_32x32x16_bf16 v[16:31], a[44:47], v[180:183], v[16:31]
  s_waitcnt lgkmcnt(0)
  buffer_load_dwordx4 v112, s[72:75], s55 offen offset:2048 lds
  v_rcp_f32 v60, v60
  v_rcp_f32 v61, v61
  v_rcp_f32 v62, v62
  v_rcp_f32 v63, v63
  v_pk_mul_f32 v[32:33], v[32:33], v[48:49]
  v_pk_mul_f32 v[34:35], v[34:35], v[50:51]
  v_pk_mul_f32 v[36:37], v[36:37], v[52:53]
  v_pk_mul_f32 v[38:39], v[38:39], v[54:55]
  v_pk_mul_f32 v[40:41], v[40:41], v[56:57]
  v_pk_mul_f32 v[42:43], v[42:43], v[58:59]
  v_pk_mul_f32 v[44:45], v[44:45], v[60:61]
  v_pk_mul_f32 v[46:47], v[46:47], v[62:63]
  v_pk_fma_f32 v[48:49], v[16:17], v[16:17], s[20:21] neg_lo:[1,0,1] neg_hi:[1,0,1]
  v_pk_fma_f32 v[50:51], v[18:19], v[18:19], s[20:21] neg_lo:[1,0,1] neg_hi:[1,0,1]
  v_pk_fma_f32 v[52:53], v[20:21], v[20:21], s[20:21] neg_lo:[1,0,1] neg_hi:[1,0,1]
  v_pk_fma_f32 v[54:55], v[22:23], v[22:23], s[20:21] neg_lo:[1,0,1] neg_hi:[1,0,1]
  v_pk_fma_f32 v[56:57], v[24:25], v[24:25], s[20:21] neg_lo:[1,0,1] neg_hi:[1,0,1]
  v_pk_fma_f32 v[58:59], v[26:27], v[26:27], s[20:21] neg_lo:[1,0,1] neg_hi:[1,0,1]
  v_pk_fma_f32 v[60:61], v[28:29], v[28:29], s[20:21] neg_lo:[1,0,1] neg_hi:[1,0,1]
  v_pk_fma_f32 v[62:63], v[30:31], v[30:31], s[20:21] neg_lo:[1,0,1] neg_hi:[1,0,1]
  v_pk_mul_f32 v[48:49], v[16:17], v[48:49]
  v_pk_mul_f32 v[50:51], v[18:19], v[50:51]
  v_pk_mul_f32 v[52:53], v[20:21], v[52:53]
  v_pk_mul_f32 v[54:55], v[22:23], v[54:55]
  v_pk_mul_f32 v[56:57], v[24:25], v[56:57]
  v_cvt_pk_bf16_f32 v184, v32, v33
  v_cvt_pk_bf16_f32 v185, v34, v35
  v_cvt_pk_bf16_f32 v186, v36, v37
  v_cvt_pk_bf16_f32 v187, v38, v39
  v_pk_mul_f32 v[58:59], v[26:27], v[58:59]
  v_pk_mul_f32 v[60:61], v[28:29], v[60:61]
  v_pk_mul_f32 v[62:63], v[30:31], v[62:63]
  v_mfma_f32_32x32x16_bf16 v[64:79], v[192:195], v[184:187], v[64:79]
  s_add_u32 m0, s14, 0x1cc00
  v_cvt_pk_bf16_f32 v188, v40, v41
  v_cvt_pk_bf16_f32 v189, v42, v43
  v_cvt_pk_bf16_f32 v190, v44, v45
  v_cvt_pk_bf16_f32 v191, v46, v47
  v_exp_f32_e64 v48, v48
  v_mfma_f32_32x32x16_bf16 v[80:95], v[196:199], v[184:187], v[80:95]
  buffer_load_dwordx4 v254, s[72:75], s56 offen lds
  v_exp_f32 v49, v49
  v_exp_f32 v50, v50
  v_exp_f32 v51, v51
  v_mfma_f32_32x32x16_bf16 v[96:111], v[200:203], v[184:187], v[96:111]
  s_waitcnt vmcnt(8)
  ds_read_b128 a[216:219], v251
  ds_read_b128 a[220:223], v252
  ds_read_b128 a[224:227], v251 offset:64
  v_exp_f32 v52, v52
  v_exp_f32 v53, v53
  v_mfma_f32_32x32x16_bf16 v[64:79], v[204:207], v[188:191], v[64:79]
  ds_read_b128 a[228:231], v252 offset:64
  ds_read_b128 a[232:235], v251 offset:128
  ds_read_b128 a[236:239], v252 offset:128
  buffer_load_dwordx4 v255, s[72:75], s56 offen offset:1024 lds
  v_subrev_u32 v11, 0x4100, v5
  v_exp_f32_e64 v54, v54
  v_mfma_f32_32x32x16_bf16 v[80:95], v[208:211], v[188:191], v[80:95]
  v_exp_f32 v55, v55
  v_exp_f32 v56, v56
  v_exp_f32_e64 v57, v57
  v_exp_f32 v58, v58
  v_mfma_f32_32x32x16_bf16 v[96:111], v[212:215], v[188:191], v[96:111]
  s_waitcnt lgkmcnt(0)
  buffer_load_dwordx4 v112, s[72:75], s56 offen offset:2048 lds
  v_add_u32 v5, 0x8200, v5
  v_exp_f32 v59, v59
  v_exp_f32 v60, v60
  v_exp_f32 v61, v61
  v_exp_f32 v62, v62
  v_exp_f32 v63, v63
  v_min_u32 v5, v11, v5
  v_pk_fma_f32 v[48:49], v[48:49], s[22:23], s[22:23]
  v_pk_fma_f32 v[50:51], v[50:51], s[22:23], s[22:23]
  v_pk_fma_f32 v[52:53], v[52:53], s[22:23], s[22:23]
  v_pk_fma_f32 v[54:55], v[54:55], s[22:23], s[22:23]
  v_pk_fma_f32 v[56:57], v[56:57], s[22:23], s[22:23]
  v_pk_fma_f32 v[58:59], v[58:59], s[22:23], s[22:23]
  v_pk_fma_f32 v[60:61], v[60:61], s[22:23], s[22:23]
  v_pk_fma_f32 v[62:63], v[62:63], s[22:23], s[22:23]
  v_mfma_f32_32x32x16_bf16 v[112:127], a[216:219], a[192:195], 0
  ds_read_b128 v[192:195], v1 offset:20480
  ds_read_b128 v[196:199], v1 offset:21504
  v_rcp_f32 v48, v48
  v_rcp_f32 v49, v49
  v_mfma_f32_32x32x16_bf16 v[112:127], a[220:223], a[196:199], v[112:127]
  ds_read_b128 v[200:203], v1 offset:22528
  ds_read_b128 v[204:207], v1 offset:23552
  v_rcp_f32 v50, v50
  v_rcp_f32 v51, v51
  v_mfma_f32_32x32x16_bf16 v[128:143], a[224:227], a[200:203], 0
  ds_read_b128 v[208:211], v1 offset:24576
  ds_read_b128 v[212:215], v1 offset:25600
  v_rcp_f32_e64 v52, v52
  v_rcp_f32 v53, v53
  v_mfma_f32_32x32x16_bf16 v[128:143], a[228:231], a[204:207], v[128:143]
  s_nop 1
  v_cvt_pk_bf16_f32 v112, v112, v113
  v_cvt_pk_bf16_f32 v113, v114, v115
  v_cvt_pk_bf16_f32 v114, v116, v117
  v_cvt_pk_bf16_f32 v115, v118, v119
  v_rcp_f32_e64 v54, v54
  v_mfma_f32_32x32x16_bf16 v[144:159], a[232:235], a[208:211], 0
  ds_write_b128 v253, v[112:115]
  v_cvt_pk_bf16_f32 v116, v120, v121
  v_cvt_pk_bf16_f32 v117, v122, v123
  v_cvt_pk_bf16_f32 v118, v124, v125
  v_cvt_pk_bf16_f32 v119, v126, v127
  v_mfma_f32_32x32x16_bf16 v[144:159], a[236:239], a[212:215], v[144:159]
  ds_write_b128 v253, v[116:119] offset:3072
  v_cvt_pk_bf16_f32 v128, v128, v129
  v_cvt_pk_bf16_f32 v129, v130, v131
  v_cvt_pk_bf16_f32 v130, v132, v133
  v_cvt_pk_bf16_f32 v131, v134, v135
  v_mfma_f32_32x32x16_bf16 v[32:47], a[48:51], v[160:163], 0
  ds_write_b128 v253, v[128:131] offset:1024
  v_cvt_pk_bf16_f32 v132, v136, v137
  v_cvt_pk_bf16_f32 v133, v138, v139
  v_cvt_pk_bf16_f32 v134, v140, v141
  v_cvt_pk_bf16_f32 v135, v142, v143
  v_mfma_f32_32x32x16_bf16 v[32:47], a[52:55], v[164:167], v[32:47]
  ds_write_b128 v253, v[132:135] offset:4096
  v_cvt_pk_bf16_f32 v144, v144, v145
  v_cvt_pk_bf16_f32 v145, v146, v147
  v_cvt_pk_bf16_f32 v146, v148, v149
  v_cvt_pk_bf16_f32 v147, v150, v151
  v_mfma_f32_32x32x16_bf16 v[32:47], a[56:59], v[168:171], v[32:47]
  ds_write_b128 v253, v[144:147] offset:2048
  v_cvt_pk_bf16_f32 v148, v152, v153
  v_cvt_pk_bf16_f32 v149, v154, v155
  v_cvt_pk_bf16_f32 v150, v156, v157
  v_cvt_pk_bf16_f32 v151, v158, v159
  v_mfma_f32_32x32x16_bf16 v[32:47], a[60:63], v[172:175], v[32:47]
  ds_write_b128 v253, v[148:151] offset:5120
  v_rcp_f32 v55, v55
  v_rcp_f32 v56, v56
  v_mfma_f32_32x32x16_bf16 v[32:47], a[64:67], v[176:179], v[32:47]
  v_rcp_f32 v57, v57
  v_rcp_f32 v58, v58
  v_rcp_f32_e64 v59, v59
  v_mfma_f32_32x32x16_bf16 v[32:47], a[68:71], v[180:183], v[32:47]
  s_waitcnt lgkmcnt(6)
  v_rcp_f32 v60, v60
  v_rcp_f32 v61, v61
  v_rcp_f32 v62, v62
  v_rcp_f32_e64 v63, v63
  v_pk_mul_f32 v[16:17], v[16:17], v[48:49]
  v_pk_mul_f32 v[18:19], v[18:19], v[50:51]
  v_pk_mul_f32 v[20:21], v[20:21], v[52:53]
  v_pk_mul_f32 v[22:23], v[22:23], v[54:55]
  v_pk_mul_f32 v[24:25], v[24:25], v[56:57]
  v_pk_mul_f32 v[26:27], v[26:27], v[58:59]
  v_pk_mul_f32 v[28:29], v[28:29], v[60:61]
  v_pk_mul_f32 v[30:31], v[30:31], v[62:63]
  v_pk_fma_f32 v[48:49], v[32:33], v[32:33], s[20:21] neg_lo:[1,0,1] neg_hi:[1,0,1]
  v_pk_fma_f32 v[50:51], v[34:35], v[34:35], s[20:21] neg_lo:[1,0,1] neg_hi:[1,0,1]
  v_pk_fma_f32 v[52:53], v[36:37], v[36:37], s[20:21] neg_lo:[1,0,1] neg_hi:[1,0,1]
  v_pk_fma_f32 v[54:55], v[38:39], v[38:39], s[20:21] neg_lo:[1,0,1] neg_hi:[1,0,1]
  v_pk_fma_f32 v[56:57], v[40:41], v[40:41], s[20:21] neg_lo:[1,0,1] neg_hi:[1,0,1]
  v_pk_fma_f32 v[58:59], v[42:43], v[42:43], s[20:21] neg_lo:[1,0,1] neg_hi:[1,0,1]
  v_pk_fma_f32 v[60:61], v[44:45], v[44:45], s[20:21] neg_lo:[1,0,1] neg_hi:[1,0,1]
  v_pk_fma_f32 v[62:63], v[46:47], v[46:47], s[20:21] neg_lo:[1,0,1] neg_hi:[1,0,1]
  v_pk_mul_f32 v[48:49], v[32:33], v[48:49]
  v_pk_mul_f32 v[50:51], v[34:35], v[50:51]
  v_pk_mul_f32 v[52:53], v[36:37], v[52:53]
  v_pk_mul_f32 v[54:55], v[38:39], v[54:55]
  v_pk_mul_f32 v[56:57], v[40:41], v[56:57]
  v_cvt_pk_bf16_f32 v184, v16, v17
  v_cvt_pk_bf16_f32 v185, v18, v19
  v_cvt_pk_bf16_f32 v186, v20, v21
  v_cvt_pk_bf16_f32 v187, v22, v23
  v_pk_mul_f32 v[58:59], v[42:43], v[58:59]
  v_pk_mul_f32 v[60:61], v[44:45], v[60:61]
  v_pk_mul_f32 v[62:63], v[46:47], v[62:63]
  v_mfma_f32_32x32x16_bf16 v[64:79], v[192:195], v[184:187], v[64:79]
  s_add_u32 s29, s29, 0x60000
  v_cvt_pk_bf16_f32 v188, v24, v25
  v_cvt_pk_bf16_f32 v189, v26, v27
  v_cvt_pk_bf16_f32 v190, v28, v29
  v_cvt_pk_bf16_f32 v191, v30, v31
  v_exp_f32_e64 v48, v48
  v_mfma_f32_32x32x16_bf16 v[80:95], v[196:199], v[184:187], v[80:95]
  s_add_u32 s52, s52, 0x60000
  v_exp_f32 v49, v49
  v_exp_f32 v50, v50
  v_exp_f32_e64 v51, v51
  v_mfma_f32_32x32x16_bf16 v[96:111], v[200:203], v[184:187], v[96:111]
  s_mov_b32 s32, s30
  s_waitcnt vmcnt(0)
  ds_read_b128 a[216:219], v251 offset:24576
  ds_read_b128 a[220:223], v252 offset:24576
  ds_read_b128 a[224:227], v251 offset:24640
  v_exp_f32_e64 v52, v52
  v_exp_f32 v53, v53
  v_mfma_f32_32x32x16_bf16 v[64:79], v[204:207], v[188:191], v[64:79]
  s_add_u32 s30, s33, 32
  ds_read_b128 a[228:231], v252 offset:24640
  ds_read_b128 a[232:235], v251 offset:24704
  ds_read_b128 a[236:239], v252 offset:24704
  v_subrev_u32 v11, 0x4100, v4
  v_exp_f32_e64 v54, v54
  v_mfma_f32_32x32x16_bf16 v[80:95], v[208:211], v[188:191], v[80:95]
  s_sub_u32 s33, s31, 0
  v_exp_f32 v55, v55
  v_exp_f32 v56, v56
  v_exp_f32 v57, v57
  v_exp_f32 v58, v58
  v_mfma_f32_32x32x16_bf16 v[96:111], v[212:215], v[188:191], v[96:111]
  s_waitcnt lgkmcnt(0)
  v_add_u32 v4, 0x8200, v4
  v_exp_f32 v59, v59
  v_exp_f32 v60, v60
  v_exp_f32 v61, v61
  v_exp_f32 v62, v62
  v_exp_f32 v63, v63
  v_min_u32 v4, v11, v4
  v_pk_fma_f32 v[48:49], v[48:49], s[22:23], s[22:23]
  v_pk_fma_f32 v[50:51], v[50:51], s[22:23], s[22:23]
  v_pk_fma_f32 v[52:53], v[52:53], s[22:23], s[22:23]
  v_pk_fma_f32 v[54:55], v[54:55], s[22:23], s[22:23]
  v_pk_fma_f32 v[56:57], v[56:57], s[22:23], s[22:23]
  v_pk_fma_f32 v[58:59], v[58:59], s[22:23], s[22:23]
  v_pk_fma_f32 v[60:61], v[60:61], s[22:23], s[22:23]
  v_pk_fma_f32 v[62:63], v[62:63], s[22:23], s[22:23]
  v_mfma_f32_32x32x16_bf16 v[112:127], a[216:219], a[192:195], 0
  ds_read_b128 v[192:195], v1 offset:26624
  ds_read_b128 v[196:199], v1 offset:27648
  v_rcp_f32 v48, v48
  v_rcp_f32 v49, v49
  v_mfma_f32_32x32x16_bf16 v[112:127], a[220:223], a[196:199], v[112:127]
  ds_read_b128 v[200:203], v1 offset:28672
  ds_read_b128 v[204:207], v1 offset:29696
  v_rcp_f32 v50, v50
  v_rcp_f32 v51, v51
  v_mfma_f32_32x32x16_bf16 v[128:143], a[224:227], a[200:203], 0
  ds_read_b128 v[208:211], v1 offset:30720
  ds_read_b128 v[212:215], v1 offset:31744
  v_rcp_f32_e64 v52, v52
  v_rcp_f32 v53, v53
  v_mfma_f32_32x32x16_bf16 v[128:143], a[228:231], a[204:207], v[128:143]
  s_nop 1
  v_cvt_pk_bf16_f32 v112, v112, v113
  v_cvt_pk_bf16_f32 v113, v114, v115
  v_cvt_pk_bf16_f32 v114, v116, v117
  v_cvt_pk_bf16_f32 v115, v118, v119
  v_rcp_f32_e64 v54, v54
  v_mfma_f32_32x32x16_bf16 v[144:159], a[232:235], a[208:211], 0
  ds_write_b128 v253, v[112:115] offset:24576
  v_cvt_pk_bf16_f32 v116, v120, v121
  v_cvt_pk_bf16_f32 v117, v122, v123
  v_cvt_pk_bf16_f32 v118, v124, v125
  v_cvt_pk_bf16_f32 v119, v126, v127
  v_mfma_f32_32x32x16_bf16 v[144:159], a[236:239], a[212:215], v[144:159]
  ds_write_b128 v253, v[116:119] offset:27648
  v_cvt_pk_bf16_f32 v128, v128, v129
  v_cvt_pk_bf16_f32 v129, v130, v131
  v_cvt_pk_bf16_f32 v130, v132, v133
  v_cvt_pk_bf16_f32 v131, v134, v135
  v_mfma_f32_32x32x16_bf16 v[16:31], a[72:75], v[160:163], 0
  ds_write_b128 v253, v[128:131] offset:25600
  v_cvt_pk_bf16_f32 v132, v136, v137
  v_cvt_pk_bf16_f32 v133, v138, v139
  v_cvt_pk_bf16_f32 v134, v140, v141
  v_cvt_pk_bf16_f32 v135, v142, v143
  v_mfma_f32_32x32x16_bf16 v[16:31], a[76:79], v[164:167], v[16:31]
  ds_write_b128 v253, v[132:135] offset:28672
  v_cvt_pk_bf16_f32 v144, v144, v145
  v_cvt_pk_bf16_f32 v145, v146, v147
  v_cvt_pk_bf16_f32 v146, v148, v149
  v_cvt_pk_bf16_f32 v147, v150, v151
  v_mfma_f32_32x32x16_bf16 v[16:31], a[80:83], v[168:171], v[16:31]
  ds_write_b128 v253, v[144:147] offset:26624
  v_cvt_pk_bf16_f32 v148, v152, v153
  v_cvt_pk_bf16_f32 v149, v154, v155
  v_cvt_pk_bf16_f32 v150, v156, v157
  v_cvt_pk_bf16_f32 v151, v158, v159
  v_mfma_f32_32x32x16_bf16 v[16:31], a[84:87], v[172:175], v[16:31]
  ds_write_b128 v253, v[148:151] offset:29696
  buffer_load_dword v249, v248, s[4:7], s29 offen
  v_rcp_f32_e64 v55, v55
  v_mfma_f32_32x32x16_bf16 v[16:31], a[88:91], v[176:179], v[16:31]
  v_rcp_f32 v56, v56
  v_rcp_f32 v57, v57
  v_rcp_f32_e64 v58, v58
  v_mfma_f32_32x32x16_bf16 v[16:31], a[92:95], v[180:183], v[16:31]
  s_waitcnt lgkmcnt(6)
  v_rcp_f32 v59, v59
  v_rcp_f32 v60, v60
  v_rcp_f32 v61, v61
  v_rcp_f32 v62, v62
  v_rcp_f32 v63, v63
  v_pk_mul_f32 v[32:33], v[32:33], v[48:49]
  v_pk_mul_f32 v[34:35], v[34:35], v[50:51]
  v_pk_mul_f32 v[36:37], v[36:37], v[52:53]
  v_pk_mul_f32 v[38:39], v[38:39], v[54:55]
  v_pk_mul_f32 v[40:41], v[40:41], v[56:57]
  v_pk_mul_f32 v[42:43], v[42:43], v[58:59]
  v_pk_mul_f32 v[44:45], v[44:45], v[60:61]
  v_pk_mul_f32 v[46:47], v[46:47], v[62:63]
  v_pk_fma_f32 v[48:49], v[16:17], v[16:17], s[20:21] neg_lo:[1,0,1] neg_hi:[1,0,1]
  v_pk_fma_f32 v[50:51], v[18:19], v[18:19], s[20:21] neg_lo:[1,0,1] neg_hi:[1,0,1]
  v_pk_fma_f32 v[52:53], v[20:21], v[20:21], s[20:21] neg_lo:[1,0,1] neg_hi:[1,0,1]
  v_pk_fma_f32 v[54:55], v[22:23], v[22:23], s[20:21] neg_lo:[1,0,1] neg_hi:[1,0,1]
  v_pk_fma_f32 v[56:57], v[24:25], v[24:25], s[20:21] neg_lo:[1,0,1] neg_hi:[1,0,1]
  v_pk_fma_f32 v[58:59], v[26:27], v[26:27], s[20:21] neg_lo:[1,0,1] neg_hi:[1,0,1]
  v_pk_fma_f32 v[60:61], v[28:29], v[28:29], s[20:21] neg_lo:[1,0,1] neg_hi:[1,0,1]
  v_pk_fma_f32 v[62:63], v[30:31], v[30:31], s[20:21] neg_lo:[1,0,1] neg_hi:[1,0,1]
  v_pk_mul_f32 v[48:49], v[16:17], v[48:49]
  v_pk_mul_f32 v[50:51], v[18:19], v[50:51]
  v_pk_mul_f32 v[52:53], v[20:21], v[52:53]
  v_pk_mul_f32 v[54:55], v[22:23], v[54:55]
  v_pk_mul_f32 v[56:57], v[24:25], v[56:57]
  v_cvt_pk_bf16_f32 v184, v32, v33
  v_cvt_pk_bf16_f32 v185, v34, v35
  v_cvt_pk_bf16_f32 v186, v36, v37
  v_cvt_pk_bf16_f32 v187, v38, v39
  v_pk_mul_f32 v[58:59], v[26:27], v[58:59]
  v_pk_mul_f32 v[60:61], v[28:29], v[60:61]
  v_pk_mul_f32 v[62:63], v[30:31], v[62:63]
  v_mfma_f32_32x32x16_bf16 v[64:79], v[192:195], v[184:187], v[64:79]
  ds_read_b128 v[220:223], v4 offset:96
  v_cvt_pk_bf16_f32 v188, v40, v41
  v_cvt_pk_bf16_f32 v189, v42, v43
  v_cvt_pk_bf16_f32 v190, v44, v45
  v_cvt_pk_bf16_f32 v191, v46, v47
  v_mfma_f32_32x32x16_bf16 v[80:95], v[196:199], v[184:187], v[80:95]
  ds_read_b128 v[228:231], v4 offset:288
  v_exp_f32 v48, v48
  v_exp_f32 v49, v49
  v_exp_f32_e64 v50, v50
  v_mfma_f32_32x32x16_bf16 v[96:111], v[200:203], v[184:187], v[96:111]
  ds_read_b128 v[236:239], v4 offset:480
  v_exp_f32 v51, v51
  v_exp_f32 v52, v52
  v_mfma_f32_32x32x16_bf16 v[64:79], v[204:207], v[188:191], v[64:79]
  v_exp_f32 v53, v53
  v_exp_f32 v54, v54
  v_exp_f32_e64 v55, v55
  v_mfma_f32_32x32x16_bf16 v[80:95], v[208:211], v[188:191], v[80:95]
  v_exp_f32 v56, v56
  v_exp_f32 v57, v57
  v_exp_f32_e64 v58, v58
  v_mfma_f32_32x32x16_bf16 v[96:111], v[212:215], v[188:191], v[96:111]
  s_waitcnt lgkmcnt(0)
  v_exp_f32 v59, v59
  v_exp_f32 v60, v60
  v_exp_f32 v61, v61
  v_exp_f32_e64 v62, v62
  v_exp_f32_e64 v63, v63
  v_pk_fma_f32 v[48:49], v[48:49], s[22:23], s[22:23]
  v_pk_fma_f32 v[50:51], v[50:51], s[22:23], s[22:23]
  v_pk_fma_f32 v[52:53], v[52:53], s[22:23], s[22:23]
  v_pk_fma_f32 v[54:55], v[54:55], s[22:23], s[22:23]
  v_pk_fma_f32 v[56:57], v[56:57], s[22:23], s[22:23]
  v_pk_fma_f32 v[58:59], v[58:59], s[22:23], s[22:23]
  v_pk_fma_f32 v[60:61], v[60:61], s[22:23], s[22:23]
  v_pk_fma_f32 v[62:63], v[62:63], s[22:23], s[22:23]
  s_barrier
  v_mfma_f32_32x32x16_bf16 v[32:47], a[96:99], v[160:163], 0
  ds_read_b128 v[192:195], v0 offset:24576
  ds_read_b128 v[196:199], v0 offset:25600
  v_rcp_f32 v48, v48
  v_rcp_f32_e64 v49, v49
  v_mfma_f32_16x16x32_bf16 v[136:139], a[240:243], v[220:223], 0
  ds_read_b128 v[216:219], v3 offset:2800
  ds_read_b128 v[220:223], v4 offset:112
  v_mfma_f32_32x32x16_bf16 v[32:47], a[100:103], v[164:167], v[32:47]
  ds_read_b128 v[200:203], v0 offset:26624
  ds_read_b128 v[204:207], v0 offset:27648
  v_rcp_f32 v50, v50
  v_rcp_f32 v51, v51
  v_mfma_f32_16x16x32_bf16 v[136:139], a[244:247], v[228:231], v[136:139]
  ds_read_b128 v[224:227], v3 offset:7600
  ds_read_b128 v[228:231], v4 offset:304
  v_mfma_f32_32x32x16_bf16 v[32:47], a[104:107], v[168:171], v[32:47]
  ds_read_b128 v[208:211], v0 offset:28672
  ds_read_b128 v[212:215], v0 offset:29696
  v_rcp_f32 v52, v52
  v_rcp_f32 v53, v53
  v_mfma_f32_16x16x32_bf16 v[136:139], a[248:251], v[236:239], v[136:139]
  ds_read_b128 v[232:235], v3 offset:12400
  ds_read_b128 v[236:239], v4 offset:496
  v_mfma_f32_32x32x16_bf16 v[32:47], a[108:111], v[172:175], v[32:47]
  v_rcp_f32 v54, v54
  v_rcp_f32 v55, v55
  v_rcp_f32_e64 v56, v56
  v_mfma_f32_32x32x16_bf16 v[32:47], a[112:115], v[176:179], v[32:47]
  v_rcp_f32 v57, v57
  v_rcp_f32 v58, v58
  v_rcp_f32_e64 v59, v59
  v_mfma_f32_32x32x16_bf16 v[32:47], a[116:119], v[180:183], v[32:47]
  s_waitcnt lgkmcnt(0)
  v_rcp_f32 v60, v60
  v_rcp_f32 v61, v61
  v_rcp_f32 v62, v62
  v_rcp_f32_e64 v63, v63
  v_pk_mul_f32 v[16:17], v[16:17], v[48:49]
  v_pk_mul_f32 v[18:19], v[18:19], v[50:51]
  v_pk_mul_f32 v[20:21], v[20:21], v[52:53]
  v_pk_mul_f32 v[22:23], v[22:23], v[54:55]
  v_pk_mul_f32 v[24:25], v[24:25], v[56:57]
  v_pk_mul_f32 v[26:27], v[26:27], v[58:59]
  v_pk_mul_f32 v[28:29], v[28:29], v[60:61]
  v_pk_mul_f32 v[30:31], v[30:31], v[62:63]
  v_pk_add_f32 v[12:13], v[136:137], v[138:139]
  v_pk_mul_f32 v[14:15], v[136:137], v[136:137]
  v_pk_fma_f32 v[14:15], v[138:139], v[138:139], v[14:15]
  v_pk_fma_f32 v[48:49], v[32:33], v[32:33], s[20:21] neg_lo:[1,0,1] neg_hi:[1,0,1]
  v_pk_fma_f32 v[50:51], v[34:35], v[34:35], s[20:21] neg_lo:[1,0,1] neg_hi:[1,0,1]
  v_pk_fma_f32 v[52:53], v[36:37], v[36:37], s[20:21] neg_lo:[1,0,1] neg_hi:[1,0,1]
  v_pk_fma_f32 v[54:55], v[38:39], v[38:39], s[20:21] neg_lo:[1,0,1] neg_hi:[1,0,1]
  v_pk_fma_f32 v[56:57], v[40:41], v[40:41], s[20:21] neg_lo:[1,0,1] neg_hi:[1,0,1]
  v_pk_fma_f32 v[58:59], v[42:43], v[42:43], s[20:21] neg_lo:[1,0,1] neg_hi:[1,0,1]
  v_pk_fma_f32 v[60:61], v[44:45], v[44:45], s[20:21] neg_lo:[1,0,1] neg_hi:[1,0,1]
  v_pk_fma_f32 v[62:63], v[46:47], v[46:47], s[20:21] neg_lo:[1,0,1] neg_hi:[1,0,1]
  v_pk_mul_f32 v[48:49], v[32:33], v[48:49]
  v_pk_mul_f32 v[50:51], v[34:35], v[50:51]
  v_pk_mul_f32 v[52:53], v[36:37], v[52:53]
  v_pk_mul_f32 v[54:55], v[38:39], v[54:55]
  v_pk_mul_f32 v[56:57], v[40:41], v[56:57]
  v_pk_mul_f32 v[58:59], v[42:43], v[58:59]
  v_pk_mul_f32 v[60:61], v[44:45], v[60:61]
  v_pk_mul_f32 v[62:63], v[46:47], v[62:63]
  v_mfma_f32_16x16x32_bf16 v[140:143], v[216:219], v[220:223], 0
  v_cvt_pk_bf16_f32 v184, v16, v17
  v_cvt_pk_bf16_f32 v185, v18, v19
  v_mfma_f32_16x16x32_bf16 v[140:143], v[224:227], v[228:231], v[140:143]
  v_cvt_pk_bf16_f32 v186, v20, v21
  v_cvt_pk_bf16_f32 v187, v22, v23
  v_mfma_f32_16x16x32_bf16 v[140:143], v[232:235], v[236:239], v[140:143]
  ds_read_b128 v[220:223], v4 offset:128
  v_mfma_f32_32x32x16_bf16 v[64:79], v[192:195], v[184:187], v[64:79]
  ds_read_b128 v[224:227], v3 offset:8000
  ds_read_b128 v[228:231], v4 offset:320
  v_cvt_pk_bf16_f32 v188, v24, v25
  v_cvt_pk_bf16_f32 v189, v26, v27
  v_cvt_pk_bf16_f32 v190, v28, v29
  v_cvt_pk_bf16_f32 v191, v30, v31
  v_mfma_f32_32x32x16_bf16 v[80:95], v[196:199], v[184:187], v[80:95]
  ds_read_b128 v[232:235], v3 offset:12800
  ds_read_b128 v[236:239], v4 offset:512
  v_exp_f32 v48, v48
  v_exp_f32 v49, v49
  v_mfma_f32_32x32x16_bf16 v[96:111], v[200:203], v[184:187], v[96:111]
  s_sub_u32 s31, s32, 32
  v_exp_f32 v50, v50
  v_exp_f32 v51, v51
  v_exp_f32 v52, v52
  v_mfma_f32_32x32x16_bf16 v[64:79], v[204:207], v[188:191], v[64:79]
  v_exp_f32 v53, v53
  v_exp_f32 v54, v54
  v_exp_f32_e64 v55, v55
  v_mfma_f32_32x32x16_bf16 v[80:95], v[208:211], v[188:191], v[80:95]
  v_exp_f32 v56, v56
  v_exp_f32 v57, v57
  v_exp_f32_e64 v58, v58
  v_mfma_f32_32x32x16_bf16 v[96:111], v[212:215], v[188:191], v[96:111]
  s_waitcnt lgkmcnt(0)
  v_exp_f32 v59, v59
  v_exp_f32 v60, v60
  v_exp_f32 v61, v61
  v_exp_f32 v62, v62
  v_exp_f32 v63, v63
  v_pk_add_f32 v[12:13], v[12:13], v[140:141]
  v_pk_fma_f32 v[14:15], v[140:141], v[140:141], v[14:15]
  v_pk_add_f32 v[12:13], v[12:13], v[142:143]
  v_pk_fma_f32 v[14:15], v[142:143], v[142:143], v[14:15]
  v_pk_fma_f32 v[48:49], v[48:49], s[22:23], s[22:23]
  v_pk_fma_f32 v[50:51], v[50:51], s[22:23], s[22:23]
  v_pk_fma_f32 v[52:53], v[52:53], s[22:23], s[22:23]
  v_pk_fma_f32 v[54:55], v[54:55], s[22:23], s[22:23]
  v_pk_fma_f32 v[56:57], v[56:57], s[22:23], s[22:23]
  v_pk_fma_f32 v[58:59], v[58:59], s[22:23], s[22:23]
  v_pk_fma_f32 v[60:61], v[60:61], s[22:23], s[22:23]
  v_pk_fma_f32 v[62:63], v[62:63], s[22:23], s[22:23]
  v_mfma_f32_32x32x16_bf16 v[16:31], a[120:123], v[160:163], 0
  ds_read_b128 v[192:195], v0 offset:30720
  ds_read_b128 v[196:199], v0 offset:31744
  v_rcp_f32 v48, v48
  v_rcp_f32 v49, v49
  v_mfma_f32_16x16x32_bf16 v[144:147], a[252:255], v[220:223], 0
  ds_read_b128 v[216:219], v3 offset:3600
  ds_read_b128 v[220:223], v4 offset:144
  v_mfma_f32_32x32x16_bf16 v[16:31], a[124:127], v[164:167], v[16:31]
  ds_read_b128 v[200:203], v0 offset:32768
  ds_read_b128 v[204:207], v0 offset:33792
  v_rcp_f32 v50, v50
  v_rcp_f32 v51, v51
  v_mfma_f32_16x16x32_bf16 v[144:147], v[224:227], v[228:231], v[144:147]
  ds_read_b128 v[224:227], v3 offset:8400
  ds_read_b128 v[228:231], v4 offset:336
  v_mfma_f32_32x32x16_bf16 v[16:31], a[128:131], v[168:171], v[16:31]
  ds_read_b128 v[208:211], v0 offset:34816
  ds_read_b128 v[212:215], v0 offset:35840
  v_rcp_f32 v52, v52
  v_rcp_f32 v53, v53
  v_mfma_f32_16x16x32_bf16 v[144:147], v[232:235], v[236:239], v[144:147]
  ds_read_b128 v[232:235], v3 offset:13200
  ds_read_b128 v[236:239], v4 offset:528
  v_mfma_f32_32x32x16_bf16 v[16:31], a[132:135], v[172:175], v[16:31]
  v_rcp_f32 v54, v54
  v_rcp_f32 v55, v55
  v_rcp_f32_e64 v56, v56
  v_mfma_f32_32x32x16_bf16 v[16:31], a[136:139], v[176:179], v[16:31]
  ds_read_b128 a[192:195], v0
  ds_read_b128 a[196:199], v0 offset:1024
  ds_read_b128 a[200:203], v0 offset:2048
  v_rcp_f32 v57, v57
  v_rcp_f32 v58, v58
  v_mfma_f32_32x32x16_bf16 v[16:31], a[140:143], v[180:183], v[16:31]
  s_waitcnt lgkmcnt(3)
  v_rcp_f32 v59, v59
  v_rcp_f32 v60, v60
  v_rcp_f32 v61, v61
  v_rcp_f32 v62, v62
  v_rcp_f32 v63, v63
  v_pk_mul_f32 v[32:33], v[32:33], v[48:49]
  v_pk_mul_f32 v[34:35], v[34:35], v[50:51]
  v_pk_mul_f32 v[36:37], v[36:37], v[52:53]
  v_pk_mul_f32 v[38:39], v[38:39], v[54:55]
  v_pk_mul_f32 v[40:41], v[40:41], v[56:57]
  v_pk_mul_f32 v[42:43], v[42:43], v[58:59]
  v_pk_mul_f32 v[44:45], v[44:45], v[60:61]
  v_pk_mul_f32 v[46:47], v[46:47], v[62:63]
  v_pk_add_f32 v[12:13], v[12:13], v[144:145]
  v_pk_fma_f32 v[14:15], v[144:145], v[144:145], v[14:15]
  v_pk_add_f32 v[12:13], v[12:13], v[146:147]
  v_pk_fma_f32 v[14:15], v[146:147], v[146:147], v[14:15]
  v_pk_fma_f32 v[48:49], v[16:17], v[16:17], s[20:21] neg_lo:[1,0,1] neg_hi:[1,0,1]
  v_pk_fma_f32 v[50:51], v[18:19], v[18:19], s[20:21] neg_lo:[1,0,1] neg_hi:[1,0,1]
  v_pk_fma_f32 v[52:53], v[20:21], v[20:21], s[20:21] neg_lo:[1,0,1] neg_hi:[1,0,1]
  v_pk_fma_f32 v[54:55], v[22:23], v[22:23], s[20:21] neg_lo:[1,0,1] neg_hi:[1,0,1]
  v_pk_fma_f32 v[56:57], v[24:25], v[24:25], s[20:21] neg_lo:[1,0,1] neg_hi:[1,0,1]
  v_pk_fma_f32 v[58:59], v[26:27], v[26:27], s[20:21] neg_lo:[1,0,1] neg_hi:[1,0,1]
  v_pk_fma_f32 v[60:61], v[28:29], v[28:29], s[20:21] neg_lo:[1,0,1] neg_hi:[1,0,1]
  v_pk_fma_f32 v[62:63], v[30:31], v[30:31], s[20:21] neg_lo:[1,0,1] neg_hi:[1,0,1]
  v_pk_mul_f32 v[48:49], v[16:17], v[48:49]
  v_pk_mul_f32 v[50:51], v[18:19], v[50:51]
  v_pk_mul_f32 v[52:53], v[20:21], v[52:53]
  v_pk_mul_f32 v[54:55], v[22:23], v[54:55]
  v_pk_mul_f32 v[56:57], v[24:25], v[56:57]
  v_pk_mul_f32 v[58:59], v[26:27], v[58:59]
  v_pk_mul_f32 v[60:61], v[28:29], v[60:61]
  v_pk_mul_f32 v[62:63], v[30:31], v[62:63]
  v_mfma_f32_16x16x32_bf16 v[148:151], v[216:219], v[220:223], 0
  v_cvt_pk_bf16_f32 v184, v32, v33
  v_cvt_pk_bf16_f32 v185, v34, v35
  v_mfma_f32_16x16x32_bf16 v[148:151], v[224:227], v[228:231], v[148:151]
  v_cvt_pk_bf16_f32 v186, v36, v37
  v_cvt_pk_bf16_f32 v187, v38, v39
  v_mfma_f32_16x16x32_bf16 v[148:151], v[232:235], v[236:239], v[148:151]
  ds_read_b128 v[216:219], v3 offset:4000
  ds_read_b128 v[220:223], v4 offset:160
  v_mfma_f32_32x32x16_bf16 v[64:79], v[192:195], v[184:187], v[64:79]
  ds_read_b128 v[224:227], v3 offset:8800
  ds_read_b128 v[228:231], v4 offset:352
  v_cvt_pk_bf16_f32 v188, v40, v41
  v_cvt_pk_bf16_f32 v189, v42, v43
  v_cvt_pk_bf16_f32 v190, v44, v45
  v_cvt_pk_bf16_f32 v191, v46, v47
  v_mfma_f32_32x32x16_bf16 v[80:95], v[196:199], v[184:187], v[80:95]
  ds_read_b128 v[232:235], v3 offset:13600
  ds_read_b128 v[236:239], v4 offset:544
  v_exp_f32 v48, v48
  v_exp_f32 v49, v49
  v_mfma_f32_32x32x16_bf16 v[96:111], v[200:203], v[184:187], v[96:111]
  v_exp_f32 v50, v50
  v_exp_f32 v51, v51
  v_exp_f32_e64 v52, v52
  v_mfma_f32_32x32x16_bf16 v[64:79], v[204:207], v[188:191], v[64:79]
  v_exp_f32 v53, v53
  v_exp_f32 v54, v54
  v_exp_f32_e64 v55, v55
  v_mfma_f32_32x32x16_bf16 v[80:95], v[208:211], v[188:191], v[80:95]
  ds_read_b128 a[204:207], v0 offset:3072
  ds_read_b128 a[208:211], v0 offset:4096
  ds_read_b128 a[212:215], v0 offset:5120
  v_exp_f32 v56, v56
  v_exp_f32 v57, v57
  v_mfma_f32_32x32x16_bf16 v[96:111], v[212:215], v[188:191], v[96:111]
  s_waitcnt lgkmcnt(3)
  v_exp_f32 v58, v58
  v_exp_f32 v59, v59
  v_exp_f32 v60, v60
  v_exp_f32 v61, v61
  v_exp_f32 v62, v62
  v_exp_f32_e64 v63, v63
  v_pk_add_f32 v[12:13], v[12:13], v[148:149]
  v_pk_fma_f32 v[14:15], v[148:149], v[148:149], v[14:15]
  v_pk_add_f32 v[12:13], v[12:13], v[150:151]
  v_pk_fma_f32 v[14:15], v[150:151], v[150:151], v[14:15]
  v_pk_fma_f32 v[48:49], v[48:49], s[22:23], s[22:23]
  v_pk_fma_f32 v[50:51], v[50:51], s[22:23], s[22:23]
  v_pk_fma_f32 v[52:53], v[52:53], s[22:23], s[22:23]
  v_pk_fma_f32 v[54:55], v[54:55], s[22:23], s[22:23]
  v_pk_fma_f32 v[56:57], v[56:57], s[22:23], s[22:23]
  v_pk_fma_f32 v[58:59], v[58:59], s[22:23], s[22:23]
  v_pk_fma_f32 v[60:61], v[60:61], s[22:23], s[22:23]
  v_pk_fma_f32 v[62:63], v[62:63], s[22:23], s[22:23]
  v_mfma_f32_32x32x16_bf16 v[32:47], a[144:147], v[160:163], 0
  ds_read_b128 v[192:195], v0 offset:36864
  ds_read_b128 v[196:199], v0 offset:37888
  v_rcp_f32 v48, v48
  v_rcp_f32 v49, v49
  v_mfma_f32_16x16x32_bf16 v[152:155], v[216:219], v[220:223], 0
  ds_read_b128 v[216:219], v3 offset:4400
  ds_read_b128 v[220:223], v4 offset:176
  v_mfma_f32_32x32x16_bf16 v[32:47], a[148:151], v[164:167], v[32:47]
  ds_read_b128 v[200:203], v0 offset:38912
  ds_read_b128 v[204:207], v0 offset:39936
  v_rcp_f32 v50, v50
  v_rcp_f32 v51, v51
  v_mfma_f32_16x16x32_bf16 v[152:155], v[224:227], v[228:231], v[152:155]
  ds_read_b128 v[224:227], v3 offset:9200
  ds_read_b128 v[228:231], v4 offset:368
  v_mfma_f32_32x32x16_bf16 v[32:47], a[152:155], v[168:171], v[32:47]
  ds_read_b128 v[208:211], v0 offset:40960
  ds_read_b128 v[212:215], v0 offset:41984
  v_rcp_f32 v52, v52
  v_rcp_f32 v53, v53
  v_mfma_f32_16x16x32_bf16 v[152:155], v[232:235], v[236:239], v[152:155]
  ds_read_b128 v[232:235], v3 offset:14000
  ds_read_b128 v[236:239], v4 offset:560
  v_mfma_f32_32x32x16_bf16 v[32:47], a[156:159], v[172:175], v[32:47]
  v_rcp_f32 v54, v54
  v_rcp_f32 v55, v55
  v_rcp_f32_e64 v56, v56
  v_mfma_f32_32x32x16_bf16 v[32:47], a[160:163], v[176:179], v[32:47]
  ds_read_b128 a[216:219], v0 offset:6144
  ds_read_b128 a[220:223], v0 offset:7168
  ds_read_b128 a[224:227], v0 offset:8192
  v_rcp_f32 v57, v57
  v_rcp_f32 v58, v58
  v_mfma_f32_32x32x16_bf16 v[32:47], a[164:167], v[180:183], v[32:47]
  s_waitcnt lgkmcnt(3)
  v_rcp_f32 v59, v59
  v_rcp_f32 v60, v60
  v_rcp_f32 v61, v61
  v_rcp_f32 v62, v62
  v_rcp_f32 v63, v63
  v_pk_mul_f32 v[16:17], v[16:17], v[48:49]
  v_pk_mul_f32 v[18:19], v[18:19], v[50:51]
  v_pk_mul_f32 v[20:21], v[20:21], v[52:53]
  v_pk_mul_f32 v[22:23], v[22:23], v[54:55]
  v_pk_mul_f32 v[24:25], v[24:25], v[56:57]
  v_pk_mul_f32 v[26:27], v[26:27], v[58:59]
  v_pk_mul_f32 v[28:29], v[28:29], v[60:61]
  v_pk_mul_f32 v[30:31], v[30:31], v[62:63]
  v_pk_add_f32 v[12:13], v[12:13], v[152:153]
  v_pk_fma_f32 v[14:15], v[152:153], v[152:153], v[14:15]
  v_pk_add_f32 v[12:13], v[12:13], v[154:155]
  v_pk_fma_f32 v[14:15], v[154:155], v[154:155], v[14:15]
  v_pk_fma_f32 v[48:49], v[32:33], v[32:33], s[20:21] neg_lo:[1,0,1] neg_hi:[1,0,1]
  v_pk_fma_f32 v[50:51], v[34:35], v[34:35], s[20:21] neg_lo:[1,0,1] neg_hi:[1,0,1]
  v_pk_fma_f32 v[52:53], v[36:37], v[36:37], s[20:21] neg_lo:[1,0,1] neg_hi:[1,0,1]
  v_pk_fma_f32 v[54:55], v[38:39], v[38:39], s[20:21] neg_lo:[1,0,1] neg_hi:[1,0,1]
  v_pk_fma_f32 v[56:57], v[40:41], v[40:41], s[20:21] neg_lo:[1,0,1] neg_hi:[1,0,1]
  v_pk_fma_f32 v[58:59], v[42:43], v[42:43], s[20:21] neg_lo:[1,0,1] neg_hi:[1,0,1]
  v_pk_fma_f32 v[60:61], v[44:45], v[44:45], s[20:21] neg_lo:[1,0,1] neg_hi:[1,0,1]
  v_pk_fma_f32 v[62:63], v[46:47], v[46:47], s[20:21] neg_lo:[1,0,1] neg_hi:[1,0,1]
  v_pk_mul_f32 v[48:49], v[32:33], v[48:49]
  v_pk_mul_f32 v[50:51], v[34:35], v[50:51]
  v_pk_mul_f32 v[52:53], v[36:37], v[52:53]
  v_pk_mul_f32 v[54:55], v[38:39], v[54:55]
  v_pk_mul_f32 v[56:57], v[40:41], v[56:57]
  v_pk_mul_f32 v[58:59], v[42:43], v[58:59]
  v_pk_mul_f32 v[60:61], v[44:45], v[60:61]
  v_pk_mul_f32 v[62:63], v[46:47], v[62:63]
  v_mfma_f32_16x16x32_bf16 v[156:159], v[216:219], v[220:223], 0
  v_cvt_pk_bf16_f32 v184, v16, v17
  v_cvt_pk_bf16_f32 v185, v18, v19
  v_mfma_f32_16x16x32_bf16 v[156:159], v[224:227], v[228:231], v[156:159]
  v_cvt_pk_bf16_f32 v186, v20, v21
  v_cvt_pk_bf16_f32 v187, v22, v23
  v_mfma_f32_16x16x32_bf16 v[156:159], v[232:235], v[236:239], v[156:159]
  ds_read_b128 v[216:219], v3
  ds_read_b128 v[220:223], v4
  v_mfma_f32_32x32x16_bf16 v[64:79], v[192:195], v[184:187], v[64:79]
  ds_read_b128 v[224:227], v3 offset:4800
  ds_read_b128 v[228:231], v4 offset:192
  v_cvt_pk_bf16_f32 v188, v24, v25
  v_cvt_pk_bf16_f32 v189, v26, v27
  v_cvt_pk_bf16_f32 v190, v28, v29
  v_cvt_pk_bf16_f32 v191, v30, v31
  v_mfma_f32_32x32x16_bf16 v[80:95], v[196:199], v[184:187], v[80:95]
  ds_read_b128 v[232:235], v3 offset:9600
  ds_read_b128 v[236:239], v4 offset:384
  v_exp_f32 v48, v48
  v_exp_f32 v49, v49
  v_mfma_f32_32x32x16_bf16 v[96:111], v[200:203], v[184:187], v[96:111]
  v_exp_f32 v50, v50
  v_exp_f32 v51, v51
  v_exp_f32_e64 v52, v52
  v_mfma_f32_32x32x16_bf16 v[64:79], v[204:207], v[188:191], v[64:79]
  v_exp_f32 v53, v53
  v_exp_f32 v54, v54
  v_exp_f32_e64 v55, v55
  v_mfma_f32_32x32x16_bf16 v[80:95], v[208:211], v[188:191], v[80:95]
  ds_read_b128 a[228:231], v0 offset:9216
  ds_read_b128 a[232:235], v0 offset:10240
  ds_read_b128 a[236:239], v0 offset:11264
  v_exp_f32 v56, v56
  v_exp_f32 v57, v57
  v_mfma_f32_32x32x16_bf16 v[96:111], v[212:215], v[188:191], v[96:111]
  s_waitcnt lgkmcnt(3)
  v_exp_f32 v58, v58
  v_exp_f32 v59, v59
  v_exp_f32 v60, v60
  v_exp_f32 v61, v61
  v_exp_f32 v62, v62
  v_exp_f32_e64 v63, v63
  v_pk_add_f32 v[12:13], v[12:13], v[156:157]
  v_pk_fma_f32 v[14:15], v[156:157], v[156:157], v[14:15]
  v_pk_add_f32 v[12:13], v[12:13], v[158:159]
  v_pk_fma_f32 v[14:15], v[158:159], v[158:159], v[14:15]
  v_pk_fma_f32 v[48:49], v[48:49], s[22:23], s[22:23]
  v_pk_fma_f32 v[50:51], v[50:51], s[22:23], s[22:23]
  v_pk_fma_f32 v[52:53], v[52:53], s[22:23], s[22:23]
  v_pk_fma_f32 v[54:55], v[54:55], s[22:23], s[22:23]
  v_pk_fma_f32 v[56:57], v[56:57], s[22:23], s[22:23]
  v_pk_fma_f32 v[58:59], v[58:59], s[22:23], s[22:23]
  v_pk_fma_f32 v[60:61], v[60:61], s[22:23], s[22:23]
  v_pk_fma_f32 v[62:63], v[62:63], s[22:23], s[22:23]
  v_mfma_f32_32x32x16_bf16 v[16:31], a[168:171], v[160:163], 0
  ds_read_b128 v[192:195], v0 offset:43008
  ds_read_b128 v[196:199], v0 offset:44032
  v_rcp_f32 v48, v48
  v_rcp_f32 v49, v49
  v_mfma_f32_16x16x32_bf16 v[112:115], v[216:219], v[220:223], 0
  ds_read_b128 v[216:219], v3 offset:400
  ds_read_b128 v[220:223], v4 offset:16
  v_mfma_f32_32x32x16_bf16 v[16:31], a[172:175], v[164:167], v[16:31]
  ds_read_b128 v[200:203], v0 offset:45056
  ds_read_b128 v[204:207], v0 offset:46080
  v_rcp_f32 v50, v50
  v_rcp_f32 v51, v51
  v_mfma_f32_16x16x32_bf16 v[112:115], v[224:227], v[228:231], v[112:115]
  ds_read_b128 v[224:227], v3 offset:5200
  ds_read_b128 v[228:231], v4 offset:208
  v_mfma_f32_32x32x16_bf16 v[16:31], a[176:179], v[168:171], v[16:31]
  ds_read_b128 v[208:211], v0 offset:47104
  ds_read_b128 v[212:215], v0 offset:48128
  v_rcp_f32 v52, v52
  v_rcp_f32 v53, v53
  v_mfma_f32_16x16x32_bf16 v[112:115], v[232:235], v[236:239], v[112:115]
  ds_read_b128 v[232:235], v3 offset:10000
  ds_read_b128 v[236:239], v4 offset:400
  v_mfma_f32_32x32x16_bf16 v[16:31], a[180:183], v[172:175], v[16:31]
  v_rcp_f32 v54, v54
  v_rcp_f32 v55, v55
  v_rcp_f32_e64 v56, v56
  v_mfma_f32_32x32x16_bf16 v[16:31], a[184:187], v[176:179], v[16:31]
  v_rcp_f32 v57, v57
  v_rcp_f32 v58, v58
  v_rcp_f32_e64 v59, v59
  v_mfma_f32_32x32x16_bf16 v[16:31], a[188:191], v[180:183], v[16:31]
  s_waitcnt lgkmcnt(0)
  v_rcp_f32 v60, v60
  v_rcp_f32 v61, v61
  v_rcp_f32 v62, v62
  v_rcp_f32_e64 v63, v63
  v_pk_mul_f32 v[32:33], v[32:33], v[48:49]
  v_pk_mul_f32 v[34:35], v[34:35], v[50:51]
  v_pk_mul_f32 v[36:37], v[36:37], v[52:53]
  v_pk_mul_f32 v[38:39], v[38:39], v[54:55]
  v_pk_mul_f32 v[40:41], v[40:41], v[56:57]
  v_pk_mul_f32 v[42:43], v[42:43], v[58:59]
  v_pk_mul_f32 v[44:45], v[44:45], v[60:61]
  v_pk_mul_f32 v[46:47], v[46:47], v[62:63]
  v_pk_add_f32 v[12:13], v[12:13], v[112:113]
  v_pk_fma_f32 v[14:15], v[112:113], v[112:113], v[14:15]
  v_pk_add_f32 v[12:13], v[12:13], v[114:115]
  v_pk_fma_f32 v[14:15], v[114:115], v[114:115], v[14:15]
  v_pk_fma_f32 v[48:49], v[16:17], v[16:17], s[20:21] neg_lo:[1,0,1] neg_hi:[1,0,1]
  v_pk_fma_f32 v[50:51], v[18:19], v[18:19], s[20:21] neg_lo:[1,0,1] neg_hi:[1,0,1]
  v_pk_fma_f32 v[52:53], v[20:21], v[20:21], s[20:21] neg_lo:[1,0,1] neg_hi:[1,0,1]
  v_pk_fma_f32 v[54:55], v[22:23], v[22:23], s[20:21] neg_lo:[1,0,1] neg_hi:[1,0,1]
  v_pk_fma_f32 v[56:57], v[24:25], v[24:25], s[20:21] neg_lo:[1,0,1] neg_hi:[1,0,1]
  v_pk_fma_f32 v[58:59], v[26:27], v[26:27], s[20:21] neg_lo:[1,0,1] neg_hi:[1,0,1]
  v_pk_fma_f32 v[60:61], v[28:29], v[28:29], s[20:21] neg_lo:[1,0,1] neg_hi:[1,0,1]
  v_pk_fma_f32 v[62:63], v[30:31], v[30:31], s[20:21] neg_lo:[1,0,1] neg_hi:[1,0,1]
  v_pk_mul_f32 v[48:49], v[16:17], v[48:49]
  v_pk_mul_f32 v[50:51], v[18:19], v[50:51]
  v_pk_mul_f32 v[52:53], v[20:21], v[52:53]
  v_pk_mul_f32 v[54:55], v[22:23], v[54:55]
  v_pk_mul_f32 v[56:57], v[24:25], v[56:57]
  v_pk_mul_f32 v[58:59], v[26:27], v[58:59]
  v_pk_mul_f32 v[60:61], v[28:29], v[60:61]
  v_pk_mul_f32 v[62:63], v[30:31], v[62:63]
  v_mfma_f32_16x16x32_bf16 v[116:119], v[216:219], v[220:223], 0
  v_cvt_pk_bf16_f32 v184, v32, v33
  v_cvt_pk_bf16_f32 v185, v34, v35
  v_mfma_f32_16x16x32_bf16 v[116:119], v[224:227], v[228:231], v[116:119]
  v_cvt_pk_bf16_f32 v186, v36, v37
  v_cvt_pk_bf16_f32 v187, v38, v39
  v_mfma_f32_16x16x32_bf16 v[116:119], v[232:235], v[236:239], v[116:119]
  ds_read_b128 v[216:219], v3 offset:800
  ds_read_b128 v[220:223], v4 offset:32
  v_mfma_f32_32x32x16_bf16 v[64:79], v[192:195], v[184:187], v[64:79]
  ds_read_b128 v[224:227], v3 offset:5600
  ds_read_b128 v[228:231], v4 offset:224
  v_cvt_pk_bf16_f32 v188, v40, v41
  v_cvt_pk_bf16_f32 v189, v42, v43
  v_cvt_pk_bf16_f32 v190, v44, v45
  v_cvt_pk_bf16_f32 v191, v46, v47
  v_mfma_f32_32x32x16_bf16 v[80:95], v[196:199], v[184:187], v[80:95]
  ds_read_b128 v[232:235], v3 offset:10400
  ds_read_b128 v[236:239], v4 offset:416
  v_exp_f32 v48, v48
  v_exp_f32 v49, v49
  v_mfma_f32_32x32x16_bf16 v[96:111], v[200:203], v[184:187], v[96:111]
  v_exp_f32 v50, v50
  v_exp_f32 v51, v51
  v_exp_f32_e64 v52, v52
  v_mfma_f32_32x32x16_bf16 v[64:79], v[204:207], v[188:191], v[64:79]
  v_exp_f32 v53, v53
  v_exp_f32 v54, v54
  v_exp_f32_e64 v55, v55
  v_mfma_f32_32x32x16_bf16 v[80:95], v[208:211], v[188:191], v[80:95]
  v_exp_f32 v56, v56
  v_exp_f32 v57, v57
  v_exp_f32_e64 v58, v58
  v_mfma_f32_32x32x16_bf16 v[96:111], v[212:215], v[188:191], v[96:111]
  s_waitcnt lgkmcnt(0)
  v_exp_f32 v59, v59
  v_exp_f32 v60, v60
  v_exp_f32 v61, v61
  v_exp_f32 v62, v62
  v_exp_f32 v63, v63
  v_pk_add_f32 v[12:13], v[12:13], v[116:117]
  v_pk_fma_f32 v[14:15], v[116:117], v[116:117], v[14:15]
  v_pk_add_f32 v[12:13], v[12:13], v[118:119]
  v_pk_fma_f32 v[14:15], v[118:119], v[118:119], v[14:15]
  v_pk_fma_f32 v[48:49], v[48:49], s[22:23], s[22:23]
  v_pk_fma_f32 v[50:51], v[50:51], s[22:23], s[22:23]
  v_pk_fma_f32 v[52:53], v[52:53], s[22:23], s[22:23]
  v_pk_fma_f32 v[54:55], v[54:55], s[22:23], s[22:23]
  v_pk_fma_f32 v[56:57], v[56:57], s[22:23], s[22:23]
  v_pk_fma_f32 v[58:59], v[58:59], s[22:23], s[22:23]
  v_pk_fma_f32 v[60:61], v[60:61], s[22:23], s[22:23]
  v_pk_fma_f32 v[62:63], v[62:63], s[22:23], s[22:23]
  v_mfma_f32_32x32x16_bf16 v[32:47], a[192:195], v[160:163], 0
  ds_read_b128 v[192:195], v0 offset:49152
  ds_read_b128 v[196:199], v0 offset:50176
  v_rcp_f32 v48, v48
  v_rcp_f32 v49, v49
  v_mfma_f32_16x16x32_bf16 v[120:123], v[216:219], v[220:223], 0
  ds_read_b128 v[216:219], v3 offset:1200
  ds_read_b128 v[220:223], v4 offset:48
  v_mfma_f32_32x32x16_bf16 v[32:47], a[196:199], v[164:167], v[32:47]
  ds_read_b128 v[200:203], v0 offset:51200
  ds_read_b128 v[204:207], v0 offset:52224
  v_rcp_f32 v50, v50
  v_rcp_f32 v51, v51
  v_mfma_f32_16x16x32_bf16 v[120:123], v[224:227], v[228:231], v[120:123]
  ds_read_b128 v[224:227], v3 offset:6000
  ds_read_b128 v[228:231], v4 offset:240
  v_mfma_f32_32x32x16_bf16 v[32:47], a[200:203], v[168:171], v[32:47]
  ds_read_b128 v[208:211], v0 offset:53248
  ds_read_b128 v[212:215], v0 offset:54272
  v_rcp_f32 v52, v52
  v_rcp_f32 v53, v53
  v_mfma_f32_16x16x32_bf16 v[120:123], v[232:235], v[236:239], v[120:123]
  ds_read_b128 v[232:235], v3 offset:10800
  ds_read_b128 v[236:239], v4 offset:432
  v_mfma_f32_32x32x16_bf16 v[32:47], a[204:207], v[172:175], v[32:47]
  v_rcp_f32 v54, v54
  v_rcp_f32 v55, v55
  v_rcp_f32_e64 v56, v56
  v_mfma_f32_32x32x16_bf16 v[32:47], a[208:211], v[176:179], v[32:47]
  v_rcp_f32 v57, v57
  v_rcp_f32 v58, v58
  v_rcp_f32_e64 v59, v59
  v_mfma_f32_32x32x16_bf16 v[32:47], a[212:215], v[180:183], v[32:47]
  s_waitcnt lgkmcnt(0)
  v_rcp_f32 v60, v60
  v_rcp_f32 v61, v61
  v_rcp_f32 v62, v62
  v_rcp_f32_e64 v63, v63
  v_pk_mul_f32 v[16:17], v[16:17], v[48:49]
  v_pk_mul_f32 v[18:19], v[18:19], v[50:51]
  v_pk_mul_f32 v[20:21], v[20:21], v[52:53]
  v_pk_mul_f32 v[22:23], v[22:23], v[54:55]
  v_pk_mul_f32 v[24:25], v[24:25], v[56:57]
  v_pk_mul_f32 v[26:27], v[26:27], v[58:59]
  v_pk_mul_f32 v[28:29], v[28:29], v[60:61]
  v_pk_mul_f32 v[30:31], v[30:31], v[62:63]
  v_pk_add_f32 v[12:13], v[12:13], v[120:121]
  v_pk_fma_f32 v[14:15], v[120:121], v[120:121], v[14:15]
  v_pk_add_f32 v[12:13], v[12:13], v[122:123]
  v_pk_fma_f32 v[14:15], v[122:123], v[122:123], v[14:15]
  v_pk_fma_f32 v[48:49], v[32:33], v[32:33], s[20:21] neg_lo:[1,0,1] neg_hi:[1,0,1]
  v_pk_fma_f32 v[50:51], v[34:35], v[34:35], s[20:21] neg_lo:[1,0,1] neg_hi:[1,0,1]
  v_pk_fma_f32 v[52:53], v[36:37], v[36:37], s[20:21] neg_lo:[1,0,1] neg_hi:[1,0,1]
  v_pk_fma_f32 v[54:55], v[38:39], v[38:39], s[20:21] neg_lo:[1,0,1] neg_hi:[1,0,1]
  v_pk_fma_f32 v[56:57], v[40:41], v[40:41], s[20:21] neg_lo:[1,0,1] neg_hi:[1,0,1]
  v_pk_fma_f32 v[58:59], v[42:43], v[42:43], s[20:21] neg_lo:[1,0,1] neg_hi:[1,0,1]
  v_pk_fma_f32 v[60:61], v[44:45], v[44:45], s[20:21] neg_lo:[1,0,1] neg_hi:[1,0,1]
  v_pk_fma_f32 v[62:63], v[46:47], v[46:47], s[20:21] neg_lo:[1,0,1] neg_hi:[1,0,1]
  v_pk_mul_f32 v[48:49], v[32:33], v[48:49]
  v_pk_mul_f32 v[50:51], v[34:35], v[50:51]
  v_pk_mul_f32 v[52:53], v[36:37], v[52:53]
  v_pk_mul_f32 v[54:55], v[38:39], v[54:55]
  v_pk_mul_f32 v[56:57], v[40:41], v[56:57]
  v_pk_mul_f32 v[58:59], v[42:43], v[58:59]
  v_pk_mul_f32 v[60:61], v[44:45], v[60:61]
  v_pk_mul_f32 v[62:63], v[46:47], v[62:63]
  v_mfma_f32_16x16x32_bf16 v[124:127], v[216:219], v[220:223], 0
  v_cvt_pk_bf16_f32 v184, v16, v17
  v_cvt_pk_bf16_f32 v185, v18, v19
  v_mfma_f32_16x16x32_bf16 v[124:127], v[224:227], v[228:231], v[124:127]
  v_cvt_pk_bf16_f32 v186, v20, v21
  v_cvt_pk_bf16_f32 v187, v22, v23
  v_mfma_f32_16x16x32_bf16 v[124:127], v[232:235], v[236:239], v[124:127]
  ds_read_b128 v[216:219], v3 offset:1600
  ds_read_b128 v[220:223], v4 offset:64
  v_mfma_f32_32x32x16_bf16 v[64:79], v[192:195], v[184:187], v[64:79]
  ds_read_b128 v[224:227], v3 offset:6400
  ds_read_b128 v[228:231], v4 offset:256
  v_cvt_pk_bf16_f32 v188, v24, v25
  v_cvt_pk_bf16_f32 v189, v26, v27
  v_cvt_pk_bf16_f32 v190, v28, v29
  v_cvt_pk_bf16_f32 v191, v30, v31
  v_mfma_f32_32x32x16_bf16 v[80:95], v[196:199], v[184:187], v[80:95]
  ds_read_b128 v[232:235], v3 offset:11200
  ds_read_b128 v[236:239], v4 offset:448
  v_exp_f32 v48, v48
  v_exp_f32 v49, v49
  v_mfma_f32_32x32x16_bf16 v[96:111], v[200:203], v[184:187], v[96:111]
  v_exp_f32 v50, v50
  v_exp_f32 v51, v51
  v_exp_f32_e64 v52, v52
  v_mfma_f32_32x32x16_bf16 v[64:79], v[204:207], v[188:191], v[64:79]
  v_exp_f32 v53, v53
  v_exp_f32 v54, v54
  v_exp_f32_e64 v55, v55
  v_mfma_f32_32x32x16_bf16 v[80:95], v[208:211], v[188:191], v[80:95]
  v_exp_f32 v56, v56
  v_exp_f32 v57, v57
  v_exp_f32_e64 v58, v58
  v_mfma_f32_32x32x16_bf16 v[96:111], v[212:215], v[188:191], v[96:111]
  s_waitcnt lgkmcnt(0)
  v_exp_f32 v59, v59
  v_exp_f32 v60, v60
  v_exp_f32 v61, v61
  v_exp_f32 v62, v62
  v_exp_f32 v63, v63
  v_pk_add_f32 v[12:13], v[12:13], v[124:125]
  v_pk_fma_f32 v[14:15], v[124:125], v[124:125], v[14:15]
  v_pk_add_f32 v[12:13], v[12:13], v[126:127]
  v_pk_fma_f32 v[14:15], v[126:127], v[126:127], v[14:15]
  v_pk_fma_f32 v[48:49], v[48:49], s[22:23], s[22:23]
  v_pk_fma_f32 v[50:51], v[50:51], s[22:23], s[22:23]
  v_pk_fma_f32 v[52:53], v[52:53], s[22:23], s[22:23]
  v_pk_fma_f32 v[54:55], v[54:55], s[22:23], s[22:23]
  v_pk_fma_f32 v[56:57], v[56:57], s[22:23], s[22:23]
  v_pk_fma_f32 v[58:59], v[58:59], s[22:23], s[22:23]
  v_pk_fma_f32 v[60:61], v[60:61], s[22:23], s[22:23]
  v_pk_fma_f32 v[62:63], v[62:63], s[22:23], s[22:23]
  v_mfma_f32_32x32x16_bf16 v[16:31], a[216:219], v[160:163], 0
  ds_read_b128 v[192:195], v0 offset:55296
  ds_read_b128 v[196:199], v0 offset:56320
  v_rcp_f32 v48, v48
  v_rcp_f32 v49, v49
  v_mfma_f32_16x16x32_bf16 v[128:131], v[216:219], v[220:223], 0
  ds_read_b128 v[216:219], v3 offset:2000
  ds_read_b128 v[220:223], v4 offset:80
  v_mfma_f32_32x32x16_bf16 v[16:31], a[220:223], v[164:167], v[16:31]
  ds_read_b128 v[200:203], v0 offset:57344
  ds_read_b128 v[204:207], v0 offset:58368
  v_rcp_f32 v50, v50
  v_rcp_f32 v51, v51
  v_mfma_f32_16x16x32_bf16 v[128:131], v[224:227], v[228:231], v[128:131]
  ds_read_b128 v[224:227], v3 offset:6800
  ds_read_b128 v[228:231], v4 offset:272
  v_mfma_f32_32x32x16_bf16 v[16:31], a[224:227], v[168:171], v[16:31]
  ds_read_b128 v[208:211], v0 offset:59392
  ds_read_b128 v[212:215], v0 offset:60416
  v_rcp_f32 v52, v52
  v_rcp_f32 v53, v53
  v_mfma_f32_16x16x32_bf16 v[128:131], v[232:235], v[236:239], v[128:131]
  ds_read_b128 v[232:235], v3 offset:11600
  ds_read_b128 v[236:239], v4 offset:464
  v_mfma_f32_32x32x16_bf16 v[16:31], a[228:231], v[172:175], v[16:31]
  v_rcp_f32 v54, v54
  v_rcp_f32 v55, v55
  v_rcp_f32_e64 v56, v56
  v_mfma_f32_32x32x16_bf16 v[16:31], a[232:235], v[176:179], v[16:31]
  v_rcp_f32 v57, v57
  v_rcp_f32 v58, v58
  v_rcp_f32_e64 v59, v59
  v_mfma_f32_32x32x16_bf16 v[16:31], a[236:239], v[180:183], v[16:31]
  s_waitcnt lgkmcnt(0)
  v_rcp_f32 v60, v60
  v_rcp_f32 v61, v61
  v_rcp_f32 v62, v62
  v_rcp_f32_e64 v63, v63
  v_pk_mul_f32 v[32:33], v[32:33], v[48:49]
  v_pk_mul_f32 v[34:35], v[34:35], v[50:51]
  v_pk_mul_f32 v[36:37], v[36:37], v[52:53]
  v_pk_mul_f32 v[38:39], v[38:39], v[54:55]
  v_pk_mul_f32 v[40:41], v[40:41], v[56:57]
  v_pk_mul_f32 v[42:43], v[42:43], v[58:59]
  v_pk_mul_f32 v[44:45], v[44:45], v[60:61]
  v_pk_mul_f32 v[46:47], v[46:47], v[62:63]
  v_pk_add_f32 v[12:13], v[12:13], v[128:129]
  v_pk_fma_f32 v[14:15], v[128:129], v[128:129], v[14:15]
  v_pk_add_f32 v[12:13], v[12:13], v[130:131]
  v_pk_fma_f32 v[14:15], v[130:131], v[130:131], v[14:15]
  v_pk_fma_f32 v[48:49], v[16:17], v[16:17], s[20:21] neg_lo:[1,0,1] neg_hi:[1,0,1]
  v_pk_fma_f32 v[50:51], v[18:19], v[18:19], s[20:21] neg_lo:[1,0,1] neg_hi:[1,0,1]
  v_pk_fma_f32 v[52:53], v[20:21], v[20:21], s[20:21] neg_lo:[1,0,1] neg_hi:[1,0,1]
  v_pk_fma_f32 v[54:55], v[22:23], v[22:23], s[20:21] neg_lo:[1,0,1] neg_hi:[1,0,1]
  v_pk_fma_f32 v[56:57], v[24:25], v[24:25], s[20:21] neg_lo:[1,0,1] neg_hi:[1,0,1]
  v_pk_fma_f32 v[58:59], v[26:27], v[26:27], s[20:21] neg_lo:[1,0,1] neg_hi:[1,0,1]
  v_pk_fma_f32 v[60:61], v[28:29], v[28:29], s[20:21] neg_lo:[1,0,1] neg_hi:[1,0,1]
  v_pk_fma_f32 v[62:63], v[30:31], v[30:31], s[20:21] neg_lo:[1,0,1] neg_hi:[1,0,1]
  v_pk_mul_f32 v[48:49], v[16:17], v[48:49]
  v_pk_mul_f32 v[50:51], v[18:19], v[50:51]
  v_pk_mul_f32 v[52:53], v[20:21], v[52:53]
  v_pk_mul_f32 v[54:55], v[22:23], v[54:55]
  v_pk_mul_f32 v[56:57], v[24:25], v[56:57]
  v_pk_mul_f32 v[58:59], v[26:27], v[58:59]
  v_pk_mul_f32 v[60:61], v[28:29], v[60:61]
  v_pk_mul_f32 v[62:63], v[30:31], v[62:63]
  v_mfma_f32_16x16x32_bf16 v[132:135], v[216:219], v[220:223], 0
  v_cvt_pk_bf16_f32 v184, v32, v33
  v_cvt_pk_bf16_f32 v185, v34, v35
  v_mfma_f32_16x16x32_bf16 v[132:135], v[224:227], v[228:231], v[132:135]
  v_cvt_pk_bf16_f32 v186, v36, v37
  v_cvt_pk_bf16_f32 v187, v38, v39
  v_mfma_f32_16x16x32_bf16 v[132:135], v[232:235], v[236:239], v[132:135]
  ds_read_b128 v[216:219], v0 offset:12288
  ds_read_b128 v[220:223], v0 offset:13312
  v_mfma_f32_32x32x16_bf16 v[64:79], v[192:195], v[184:187], v[64:79]
  ds_read_b128 v[224:227], v0 offset:14336
  ds_read_b128 v[228:231], v0 offset:15360
  v_cvt_pk_bf16_f32 v188, v40, v41
  v_cvt_pk_bf16_f32 v189, v42, v43
  v_cvt_pk_bf16_f32 v190, v44, v45
  v_cvt_pk_bf16_f32 v191, v46, v47
  v_mfma_f32_32x32x16_bf16 v[80:95], v[196:199], v[184:187], v[80:95]
  ds_read_b128 v[232:235], v0 offset:16384
  ds_read_b128 v[236:239], v0 offset:17408
  v_exp_f32 v48, v48
  v_exp_f32 v49, v49
  v_mfma_f32_32x32x16_bf16 v[96:111], v[200:203], v[184:187], v[96:111]
  v_exp_f32 v50, v50
  v_exp_f32 v51, v51
  v_exp_f32_e64 v52, v52
  v_mfma_f32_32x32x16_bf16 v[64:79], v[204:207], v[188:191], v[64:79]
  s_mov_b32 s28, s34
  v_exp_f32 v53, v53
  v_exp_f32 v54, v54
  v_exp_f32 v55, v55
  v_mfma_f32_32x32x16_bf16 v[80:95], v[208:211], v[188:191], v[80:95]
  s_add_u32 s34, s34, 0x60000
  v_exp_f32 v56, v56
  v_exp_f32 v57, v57
  v_exp_f32_e64 v58, v58
  v_mfma_f32_32x32x16_bf16 v[96:111], v[212:215], v[188:191], v[96:111]
  s_waitcnt lgkmcnt(0)
  v_exp_f32 v59, v59
  v_exp_f32 v60, v60
  v_exp_f32 v61, v61
  v_exp_f32 v62, v62
  v_exp_f32 v63, v63
  v_pk_add_f32 v[12:13], v[12:13], v[132:133]
  v_pk_fma_f32 v[14:15], v[132:133], v[132:133], v[14:15]
  v_pk_add_f32 v[12:13], v[12:13], v[134:135]
  v_pk_fma_f32 v[14:15], v[134:135], v[134:135], v[14:15]
  v_pk_fma_f32 v[48:49], v[48:49], s[22:23], s[22:23]
  v_pk_fma_f32 v[50:51], v[50:51], s[22:23], s[22:23]
  v_pk_fma_f32 v[52:53], v[52:53], s[22:23], s[22:23]
  v_pk_fma_f32 v[54:55], v[54:55], s[22:23], s[22:23]
  v_pk_fma_f32 v[56:57], v[56:57], s[22:23], s[22:23]
  v_pk_fma_f32 v[58:59], v[58:59], s[22:23], s[22:23]
  v_pk_fma_f32 v[60:61], v[60:61], s[22:23], s[22:23]
  v_pk_fma_f32 v[62:63], v[62:63], s[22:23], s[22:23]
  v_mfma_f32_32x32x16_bf16 v[32:47], v[216:219], v[160:163], 0
  ds_read_b128 v[192:195], v0 offset:61440
  ds_read_b128 v[196:199], v0 offset:62464
  v_rcp_f32 v48, v48
  v_rcp_f32 v49, v49
  v_add_f32_e64 v12, v12, v13
  v_mfma_f32_32x32x16_bf16 v[32:47], v[220:223], v[164:167], v[32:47]
  ds_read_b128 v[200:203], v0 offset:63488
  ds_read_b128 v[204:207], v0 offset:64512
  v_rcp_f32 v50, v50
  v_add_f32 v14, v14, v15
  v_rcp_f32_e64 v51, v51
  v_mfma_f32_32x32x16_bf16 v[32:47], v[224:227], v[168:171], v[32:47]
  ds_read_b128 v[208:211], v1
  ds_read_b128 v[212:215], v1 offset:1024
  v_permlane32_swap_b32 v12, v14
  v_rcp_f32 v52, v52
  v_add_f32 v12, v12, v14
  v_rcp_f32 v53, v53
  v_mfma_f32_32x32x16_bf16 v[32:47], v[228:231], v[172:175], v[32:47]
  v_mov_b32 v14, v12
  v_rcp_f32 v54, v54
  s_nop 0
  v_permlane32_swap_b32 v12, v14
  v_rcp_f32 v55, v55
  v_mul_f32 v12, s24, v12
  v_mfma_f32_32x32x16_bf16 v[32:47], v[232:235], v[176:179], v[32:47]
  v_rcp_f32 v56, v56
  v_rcp_f32 v57, v57
  v_mul_f32 v13, s24, v14
  v_rcp_f32 v58, v58
  v_fma_f32 v13, -v12, v12, v13
  v_mfma_f32_32x32x16_bf16 v[32:47], v[236:239], v[180:183], v[32:47]
  s_waitcnt lgkmcnt(0)
  v_rcp_f32 v59, v59
  v_max_f32 v13, 0, v13
  v_rcp_f32 v60, v60
  v_add_f32 v13, s25, v13
  v_rcp_f32 v61, v61
  v_rsq_f32 v13, v13
  v_rcp_f32 v62, v62
  v_mul_f32 v14, s22, v13
  v_rcp_f32 v63, v63
  v_mul_f32_e64 v12, -v12, v14
  v_pk_mul_f32 v[16:17], v[16:17], v[48:49]
  v_pk_mul_f32 v[18:19], v[18:19], v[50:51]
  v_pk_mul_f32 v[20:21], v[20:21], v[52:53]
  v_pk_mul_f32 v[22:23], v[22:23], v[54:55]
  v_pk_mul_f32 v[24:25], v[24:25], v[56:57]
  v_pk_mul_f32 v[26:27], v[26:27], v[58:59]
  v_pk_mul_f32 v[28:29], v[28:29], v[60:61]
  v_pk_mul_f32 v[30:31], v[30:31], v[62:63]
  v_pk_fma_f32 v[112:113], v[112:113], v[14:15], v[12:13] op_sel_hi:[1,0,0]
  v_pk_fma_f32 v[114:115], v[114:115], v[14:15], v[12:13] op_sel_hi:[1,0,0]
  v_pk_fma_f32 v[116:117], v[116:117], v[14:15], v[12:13] op_sel_hi:[1,0,0]
  v_pk_fma_f32 v[118:119], v[118:119], v[14:15], v[12:13] op_sel_hi:[1,0,0]
  v_pk_fma_f32 v[120:121], v[120:121], v[14:15], v[12:13] op_sel_hi:[1,0,0]
  v_pk_fma_f32 v[122:123], v[122:123], v[14:15], v[12:13] op_sel_hi:[1,0,0]
  v_pk_fma_f32 v[124:125], v[124:125], v[14:15], v[12:13] op_sel_hi:[1,0,0]
  v_pk_fma_f32 v[126:127], v[126:127], v[14:15], v[12:13] op_sel_hi:[1,0,0]
  v_pk_fma_f32 v[128:129], v[128:129], v[14:15], v[12:13] op_sel_hi:[1,0,0]
  v_pk_fma_f32 v[130:131], v[130:131], v[14:15], v[12:13] op_sel_hi:[1,0,0]
  v_pk_fma_f32 v[132:133], v[132:133], v[14:15], v[12:13] op_sel_hi:[1,0,0]
  v_pk_fma_f32 v[134:135], v[134:135], v[14:15], v[12:13] op_sel_hi:[1,0,0]
  v_pk_fma_f32 v[136:137], v[136:137], v[14:15], v[12:13] op_sel_hi:[1,0,0]
  v_pk_fma_f32 v[138:139], v[138:139], v[14:15], v[12:13] op_sel_hi:[1,0,0]
  v_pk_fma_f32 v[140:141], v[140:141], v[14:15], v[12:13] op_sel_hi:[1,0,0]
  v_pk_fma_f32 v[142:143], v[142:143], v[14:15], v[12:13] op_sel_hi:[1,0,0]
  v_pk_fma_f32 v[144:145], v[144:145], v[14:15], v[12:13] op_sel_hi:[1,0,0]
  v_pk_fma_f32 v[146:147], v[146:147], v[14:15], v[12:13] op_sel_hi:[1,0,0]
  v_pk_fma_f32 v[148:149], v[148:149], v[14:15], v[12:13] op_sel_hi:[1,0,0]
  v_pk_fma_f32 v[150:151], v[150:151], v[14:15], v[12:13] op_sel_hi:[1,0,0]
  v_pk_fma_f32 v[152:153], v[152:153], v[14:15], v[12:13] op_sel_hi:[1,0,0]
  v_pk_fma_f32 v[154:155], v[154:155], v[14:15], v[12:13] op_sel_hi:[1,0,0]
  v_pk_fma_f32 v[156:157], v[156:157], v[14:15], v[12:13] op_sel_hi:[1,0,0]
  v_pk_fma_f32 v[158:159], v[158:159], v[14:15], v[12:13] op_sel_hi:[1,0,0]
  v_pk_fma_f32 v[48:49], v[32:33], v[32:33], s[20:21] neg_lo:[1,0,1] neg_hi:[1,0,1]
  v_pk_fma_f32 v[50:51], v[34:35], v[34:35], s[20:21] neg_lo:[1,0,1] neg_hi:[1,0,1]
  v_pk_fma_f32 v[52:53], v[36:37], v[36:37], s[20:21] neg_lo:[1,0,1] neg_hi:[1,0,1]
  v_pk_fma_f32 v[54:55], v[38:39], v[38:39], s[20:21] neg_lo:[1,0,1] neg_hi:[1,0,1]
  v_pk_fma_f32 v[56:57], v[40:41], v[40:41], s[20:21] neg_lo:[1,0,1] neg_hi:[1,0,1]
  v_pk_fma_f32 v[58:59], v[42:43], v[42:43], s[20:21] neg_lo:[1,0,1] neg_hi:[1,0,1]
  v_pk_fma_f32 v[60:61], v[44:45], v[44:45], s[20:21] neg_lo:[1,0,1] neg_hi:[1,0,1]
  v_pk_fma_f32 v[62:63], v[46:47], v[46:47], s[20:21] neg_lo:[1,0,1] neg_hi:[1,0,1]
  v_pk_mul_f32 v[48:49], v[32:33], v[48:49]
  v_pk_mul_f32 v[50:51], v[34:35], v[50:51]
  v_pk_mul_f32 v[52:53], v[36:37], v[52:53]
  v_pk_mul_f32 v[54:55], v[38:39], v[54:55]
  v_pk_mul_f32 v[56:57], v[40:41], v[56:57]
  v_cvt_pk_bf16_f32 v184, v16, v17
  v_cvt_pk_bf16_f32 v185, v18, v19
  v_cvt_pk_bf16_f32 v186, v20, v21
  v_cvt_pk_bf16_f32 v187, v22, v23
  v_pk_mul_f32 v[58:59], v[42:43], v[58:59]
  v_pk_mul_f32 v[60:61], v[44:45], v[60:61]
  v_pk_mul_f32 v[62:63], v[46:47], v[62:63]
  v_mfma_f32_32x32x16_bf16 v[64:79], v[192:195], v[184:187], v[64:79]
  ds_read_b128 v[216:219], v0 offset:18432
  ds_read_b128 v[220:223], v0 offset:19456
  v_cvt_pk_bf16_f32 v188, v24, v25
  v_cvt_pk_bf16_f32 v189, v26, v27
  v_cvt_pk_bf16_f32 v190, v28, v29
  v_cvt_pk_bf16_f32 v191, v30, v31
  v_exp_f32_e64 v48, v48
  v_cndmask_b32 v159, v159, v250, s[12:13]
  v_mfma_f32_32x32x16_bf16 v[80:95], v[196:199], v[184:187], v[80:95]
  ds_read_b128 v[224:227], v0 offset:20480
  ds_read_b128 v[228:231], v0 offset:21504
  v_exp_f32_e64 v49, v49
  v_cvt_pk_bf16_f32 v160, v112, v113
  v_cvt_pk_bf16_f32 v161, v114, v115
  v_exp_f32_e64 v50, v50
  v_cvt_pk_bf16_f32 v162, v116, v117
  v_mfma_f32_32x32x16_bf16 v[96:111], v[200:203], v[184:187], v[96:111]
  ds_read_b128 v[232:235], v0 offset:22528
  ds_read_b128 v[236:239], v0 offset:23552
  v_exp_f32_e64 v51, v51
  v_cvt_pk_bf16_f32 v163, v118, v119
  v_cvt_pk_bf16_f32 v164, v120, v121
  v_exp_f32_e64 v52, v52
  v_cvt_pk_bf16_f32 v165, v122, v123
  v_mfma_f32_32x32x16_bf16 v[64:79], v[204:207], v[188:191], v[64:79]
  v_exp_f32_e64 v53, v53
  v_cvt_pk_bf16_f32 v166, v124, v125
  v_cvt_pk_bf16_f32 v167, v126, v127
  v_exp_f32_e64 v54, v54
  v_cvt_pk_bf16_f32 v168, v128, v129
  v_exp_f32_e64 v55, v55
  v_cvt_pk_bf16_f32 v169, v130, v131
  v_cvt_pk_bf16_f32 v170, v132, v133
  v_mfma_f32_32x32x16_bf16 v[80:95], v[208:211], v[188:191], v[80:95]
  v_exp_f32_e64 v56, v56
  v_cvt_pk_bf16_f32 v171, v134, v135
  v_cvt_pk_bf16_f32 v172, v136, v137
  v_exp_f32_e64 v57, v57
  v_cvt_pk_bf16_f32 v173, v138, v139
  v_exp_f32_e64 v58, v58
  v_cvt_pk_bf16_f32 v174, v140, v141
  v_cvt_pk_bf16_f32 v175, v142, v143
  v_mfma_f32_32x32x16_bf16 v[96:111], v[212:215], v[188:191], v[96:111]
  s_waitcnt lgkmcnt(0)
  v_exp_f32 v59, v59
  v_cvt_pk_bf16_f32 v176, v144, v145
  v_exp_f32_e64 v60, v60
  v_cvt_pk_bf16_f32 v177, v146, v147
  v_cvt_pk_bf16_f32 v178, v148, v149
  v_exp_f32_e64 v61, v61
  v_cvt_pk_bf16_f32 v179, v150, v151
  v_exp_f32_e64 v62, v62
  v_cvt_pk_bf16_f32 v180, v152, v153
  v_cvt_pk_bf16_f32 v181, v154, v155
  v_exp_f32_e64 v63, v63
  v_cvt_pk_bf16_f32 v182, v156, v157
  v_cvt_pk_bf16_f32 v183, v158, v159
  v_pk_fma_f32 v[48:49], v[48:49], s[22:23], s[22:23]
  v_pk_fma_f32 v[50:51], v[50:51], s[22:23], s[22:23]
  v_pk_fma_f32 v[52:53], v[52:53], s[22:23], s[22:23]
  v_pk_fma_f32 v[54:55], v[54:55], s[22:23], s[22:23]
  v_pk_fma_f32 v[56:57], v[56:57], s[22:23], s[22:23]
  v_pk_fma_f32 v[58:59], v[58:59], s[22:23], s[22:23]
  v_pk_fma_f32 v[60:61], v[60:61], s[22:23], s[22:23]
  v_pk_fma_f32 v[62:63], v[62:63], s[22:23], s[22:23]
  s_mov_b32 s26, 6
  .p2align 6
  s_waitcnt vmcnt(0)
S_loop:
  v_mfma_f32_32x32x16_bf16 v[16:31], v[216:219], v[160:163], 0
  s_nop 0
  ds_read_b128 v[192:195], v1 offset:2048
  ds_read_b128 v[196:199], v1 offset:3072
  ds_read_b128 v[200:203], v1 offset:4096
  v_rcp_f32 v48, v48
  v_rcp_f32 v49, v49
  v_mfma_f32_32x32x16_bf16 v[16:31], v[220:223], v[164:167], v[16:31]
  ds_read_b128 v[204:207], v1 offset:5120
  ds_read_b128 v[208:211], v1 offset:6144
  ds_read_b128 v[212:215], v1 offset:7168
  v_rcp_f32 v50, v50
  v_rcp_f32 v51, v51
  v_mfma_f32_32x32x16_bf16 v[16:31], v[224:227], v[168:171], v[16:31]
  ds_read_b128 v[136:139], v5
  ds_read_b128 v[140:143], v5 offset:32
  ds_read_b128 v[144:147], v5 offset:64
  v_rcp_f32 v52, v52
  v_rcp_f32 v53, v53
  v_mfma_f32_32x32x16_bf16 v[16:31], v[228:231], v[172:175], v[16:31]
  ds_read_b128 v[148:151], v5 offset:96
  ds_read_b128 v[152:155], v5 offset:128
  ds_read_b128 v[156:159], v5 offset:160
  v_rcp_f32 v54, v54
  v_rcp_f32 v55, v55
  v_mfma_f32_32x32x16_bf16 v[16:31], v[232:235], v[176:179], v[16:31]
  v_rcp_f32 v56, v56
  v_rcp_f32 v57, v57
  v_rcp_f32_e64 v58, v58
  v_mfma_f32_32x32x16_bf16 v[16:31], v[236:239], v[180:183], v[16:31]
  s_waitcnt lgkmcnt(0)
  v_rcp_f32 v59, v59
  v_rcp_f32 v60, v60
  v_rcp_f32 v61, v61
  v_rcp_f32 v62, v62
  v_rcp_f32 v63, v63
  v_pk_mul_f32 v[32:33], v[32:33], v[48:49]
  v_pk_mul_f32 v[34:35], v[34:35], v[50:51]
  v_pk_mul_f32 v[36:37], v[36:37], v[52:53]
  v_pk_mul_f32 v[38:39], v[38:39], v[54:55]
  v_pk_mul_f32 v[40:41], v[40:41], v[56:57]
  v_pk_mul_f32 v[42:43], v[42:43], v[58:59]
  v_pk_mul_f32 v[44:45], v[44:45], v[60:61]
  v_pk_mul_f32 v[46:47], v[46:47], v[62:63]
  v_pk_fma_f32 v[48:49], v[16:17], v[16:17], s[20:21] neg_lo:[1,0,1] neg_hi:[1,0,1]
  v_pk_fma_f32 v[50:51], v[18:19], v[18:19], s[20:21] neg_lo:[1,0,1] neg_hi:[1,0,1]
  v_pk_fma_f32 v[52:53], v[20:21], v[20:21], s[20:21] neg_lo:[1,0,1] neg_hi:[1,0,1]
  v_pk_fma_f32 v[54:55], v[22:23], v[22:23], s[20:21] neg_lo:[1,0,1] neg_hi:[1,0,1]
  v_pk_fma_f32 v[56:57], v[24:25], v[24:25], s[20:21] neg_lo:[1,0,1] neg_hi:[1,0,1]
  v_pk_fma_f32 v[58:59], v[26:27], v[26:27], s[20:21] neg_lo:[1,0,1] neg_hi:[1,0,1]
  v_pk_fma_f32 v[60:61], v[28:29], v[28:29], s[20:21] neg_lo:[1,0,1] neg_hi:[1,0,1]
  v_pk_fma_f32 v[62:63], v[30:31], v[30:31], s[20:21] neg_lo:[1,0,1] neg_hi:[1,0,1]
  v_pk_mul_f32 v[48:49], v[16:17], v[48:49]
  v_pk_mul_f32 v[50:51], v[18:19], v[50:51]
  v_pk_mul_f32 v[52:53], v[20:21], v[52:53]
  v_pk_mul_f32 v[54:55], v[22:23], v[54:55]
  v_pk_mul_f32 v[56:57], v[24:25], v[56:57]
  v_cvt_pk_bf16_f32 v184, v32, v33
  v_cvt_pk_bf16_f32 v185, v34, v35
  v_cvt_pk_bf16_f32 v186, v36, v37
  v_cvt_pk_bf16_f32 v187, v38, v39
  v_pk_mul_f32 v[58:59], v[26:27], v[58:59]
  v_pk_mul_f32 v[60:61], v[28:29], v[60:61]
  v_pk_mul_f32 v[62:63], v[30:31], v[62:63]
  v_mfma_f32_32x32x16_bf16 v[64:79], v[192:195], v[184:187], v[64:79]
  s_mov_b32 m0, s30
  v_cvt_pk_bf16_f32 v188, v40, v41
  v_cvt_pk_bf16_f32 v189, v42, v43
  v_cvt_pk_bf16_f32 v190, v44, v45
  v_cvt_pk_bf16_f32 v191, v46, v47
  v_exp_f32 v48, v48
  v_mfma_f32_32x32x16_bf16 v[80:95], v[196:199], v[184:187], v[80:95]
  buffer_load_dwordx4 v6, s[4:7], s29 offen lds
  v_exp_f32 v49, v49
  v_exp_f32 v50, v50
  v_exp_f32_e64 v51, v51
  v_mfma_f32_32x32x16_bf16 v[96:111], v[200:203], v[184:187], v[96:111]
  buffer_load_dwordx4 v7, s[4:7], s29 offen offset:1024 lds
  v_exp_f32 v52, v52
  v_exp_f32 v53, v53
  v_mfma_f32_32x32x16_bf16 v[64:79], v[204:207], v[188:191], v[64:79]
  buffer_load_dwordx4 v8, s[4:7], s29 offen offset:2048 lds
  v_exp_f32 v54, v54
  v_exp_f32 v55, v55
  v_exp_f32_e64 v56, v56
  v_mfma_f32_32x32x16_bf16 v[80:95], v[208:211], v[188:191], v[80:95]
  buffer_load_dwordx4 v9, s[4:7], s29 offen offset:3072 lds
  v_exp_f32 v57, v57
  v_exp_f32 v58, v58
  v_mfma_f32_32x32x16_bf16 v[96:111], v[212:215], v[188:191], v[96:111]
  v_exp_f32 v59, v59
  v_exp_f32 v60, v60
  v_exp_f32 v61, v61
  v_exp_f32 v62, v62
  v_exp_f32_e64 v63, v63
  v_pk_fma_f32 v[48:49], v[48:49], s[22:23], s[22:23]
  v_pk_fma_f32 v[50:51], v[50:51], s[22:23], s[22:23]
  v_pk_fma_f32 v[52:53], v[52:53], s[22:23], s[22:23]
  v_pk_fma_f32 v[54:55], v[54:55], s[22:23], s[22:23]
  v_pk_fma_f32 v[56:57], v[56:57], s[22:23], s[22:23]
  v_pk_fma_f32 v[58:59], v[58:59], s[22:23], s[22:23]
  v_pk_fma_f32 v[60:61], v[60:61], s[22:23], s[22:23]
  v_pk_fma_f32 v[62:63], v[62:63], s[22:23], s[22:23]
  v_mfma_f32_32x32x16_bf16 v[32:47], a[0:3], v[160:163], 0
  v_cvt_pk_bf16_f32 v112, v64, v65
  v_cvt_pk_bf16_f32 v113, v66, v67
  v_cvt_pk_bf16_f32 v114, v68, v69
  v_cvt_pk_bf16_f32 v115, v70, v71
  v_cvt_pk_bf16_f32 v116, v72, v73
  v_cvt_pk_bf16_f32 v117, v74, v75
  v_mfma_f32_32x32x16_bf16 v[32:47], a[4:7], v[164:167], v[32:47]
  v_cvt_pk_bf16_f32 v118, v76, v77
  v_cvt_pk_bf16_f32 v119, v78, v79
  v_cvt_pk_bf16_f32 v120, v80, v81
  v_cvt_pk_bf16_f32 v121, v82, v83
  v_cvt_pk_bf16_f32 v122, v84, v85
  v_cvt_pk_bf16_f32 v123, v86, v87
  v_mfma_f32_32x32x16_bf16 v[32:47], a[8:11], v[168:171], v[32:47]
  ds_read_b128 v[64:67], v2
  ds_read_b128 v[68:71], v2 offset:32
  ds_read_b128 v[72:75], v2 offset:64
  ds_read_b128 v[76:79], v2 offset:96
  v_cvt_pk_bf16_f32 v124, v88, v89
  v_cvt_pk_bf16_f32 v125, v90, v91
  v_mfma_f32_32x32x16_bf16 v[32:47], a[12:15], v[172:175], v[32:47]
  ds_read_b128 v[192:195], v1 offset:8192
  ds_read_b128 v[196:199], v1 offset:9216
  v_cvt_pk_bf16_f32 v126, v92, v93
  v_cvt_pk_bf16_f32 v127, v94, v95
  v_cvt_pk_bf16_f32 v128, v96, v97
  v_cvt_pk_bf16_f32 v129, v98, v99
  v_mfma_f32_32x32x16_bf16 v[32:47], a[16:19], v[176:179], v[32:47]
  ds_read_b128 v[80:83], v2 offset:128
  ds_read_b128 v[84:87], v2 offset:160
  ds_read_b128 v[88:91], v2 offset:192
  ds_read_b128 v[92:95], v2 offset:224
  v_cvt_pk_bf16_f32 v130, v100, v101
  v_cvt_pk_bf16_f32 v131, v102, v103
  v_mfma_f32_32x32x16_bf16 v[32:47], a[20:23], v[180:183], v[32:47]
  s_waitcnt lgkmcnt(6)
  ds_read_b128 v[200:203], v1 offset:10240
  ds_read_b128 v[204:207], v1 offset:11264
  v_cvt_pk_bf16_f32 v132, v104, v105
  v_cvt_pk_bf16_f32 v133, v106, v107
  v_cvt_pk_bf16_f32 v134, v108, v109
  v_cvt_pk_bf16_f32 v135, v110, v111
  v_mfma_f32_32x32x16_bf16 v[64:79], v[240:243], v[136:139], v[64:79]
  s_nop 0
  ds_read_b128 v[96:99], v2 offset:256
  ds_read_b128 v[100:103], v2 offset:288
  ds_read_b128 v[104:107], v2 offset:320
  ds_read_b128 v[108:111], v2 offset:352
  v_rcp_f32 v48, v48
  v_mfma_f32_32x32x16_bf16 v[64:79], v[244:247], v[140:143], v[64:79]
  s_waitcnt lgkmcnt(6)
  ds_read_b128 v[208:211], v1 offset:12288
  ds_read_b128 v[212:215], v1 offset:13312
  v_rcp_f32 v49, v49
  v_rcp_f32 v50, v50
  v_mfma_f32_32x32x16_bf16 v[80:95], v[240:243], v[144:147], v[80:95]
  v_rcp_f32 v51, v51
  v_rcp_f32 v52, v52
  v_rcp_f32_e64 v53, v53
  v_mfma_f32_32x32x16_bf16 v[80:95], v[244:247], v[148:151], v[80:95]
  s_waitcnt lgkmcnt(2)
  v_rcp_f32 v54, v54
  v_rcp_f32 v55, v55
  v_rcp_f32 v56, v56
  v_mfma_f32_32x32x16_bf16 v[96:111], v[240:243], v[152:155], v[96:111]
  v_rcp_f32 v57, v57
  v_rcp_f32 v58, v58
  v_rcp_f32_e64 v59, v59
  v_mfma_f32_32x32x16_bf16 v[96:111], v[244:247], v[156:159], v[96:111]
  s_waitcnt lgkmcnt(0)
  v_rcp_f32 v60, v60
  v_rcp_f32 v61, v61
  v_rcp_f32 v62, v62
  v_rcp_f32_e64 v63, v63
  v_pk_mul_f32 v[16:17], v[16:17], v[48:49]
  v_pk_mul_f32 v[18:19], v[18:19], v[50:51]
  v_pk_mul_f32 v[20:21], v[20:21], v[52:53]
  v_pk_mul_f32 v[22:23], v[22:23], v[54:55]
  v_pk_mul_f32 v[24:25], v[24:25], v[56:57]
  v_pk_mul_f32 v[26:27], v[26:27], v[58:59]
  v_pk_mul_f32 v[28:29], v[28:29], v[60:61]
  v_pk_mul_f32 v[30:31], v[30:31], v[62:63]
  v_pk_fma_f32 v[48:49], v[32:33], v[32:33], s[20:21] neg_lo:[1,0,1] neg_hi:[1,0,1]
  v_pk_fma_f32 v[50:51], v[34:35], v[34:35], s[20:21] neg_lo:[1,0,1] neg_hi:[1,0,1]
  v_pk_fma_f32 v[52:53], v[36:37], v[36:37], s[20:21] neg_lo:[1,0,1] neg_hi:[1,0,1]
  v_pk_fma_f32 v[54:55], v[38:39], v[38:39], s[20:21] neg_lo:[1,0,1] neg_hi:[1,0,1]
  v_pk_fma_f32 v[56:57], v[40:41], v[40:41], s[20:21] neg_lo:[1,0,1] neg_hi:[1,0,1]
  v_pk_fma_f32 v[58:59], v[42:43], v[42:43], s[20:21] neg_lo:[1,0,1] neg_hi:[1,0,1]
  v_pk_fma_f32 v[60:61], v[44:45], v[44:45], s[20:21] neg_lo:[1,0,1] neg_hi:[1,0,1]
  v_pk_fma_f32 v[62:63], v[46:47], v[46:47], s[20:21] neg_lo:[1,0,1] neg_hi:[1,0,1]
  v_pk_mul_f32 v[48:49], v[32:33], v[48:49]
  v_pk_mul_f32 v[50:51], v[34:35], v[50:51]
  v_pk_mul_f32 v[52:53], v[36:37], v[52:53]
  v_pk_mul_f32 v[54:55], v[38:39], v[54:55]
  v_pk_mul_f32 v[56:57], v[40:41], v[56:57]
  v_cvt_pk_bf16_f32 v184, v16, v17
  v_cvt_pk_bf16_f32 v185, v18, v19
  v_cvt_pk_bf16_f32 v186, v20, v21
  v_cvt_pk_bf16_f32 v187, v22, v23
  v_pk_mul_f32 v[58:59], v[42:43], v[58:59]
  v_pk_mul_f32 v[60:61], v[44:45], v[60:61]
  v_pk_mul_f32 v[62:63], v[46:47], v[62:63]
  v_mfma_f32_32x32x16_bf16 v[64:79], v[192:195], v[184:187], v[64:79]
  s_mov_b32 m0, s31
  v_cvt_pk_bf16_f32 v188, v24, v25
  v_cvt_pk_bf16_f32 v189, v26, v27
  v_cvt_pk_bf16_f32 v190, v28, v29
  v_cvt_pk_bf16_f32 v191, v30, v31
  v_exp_f32 v48, v48
  v_mfma_f32_32x32x16_bf16 v[80:95], v[196:199], v[184:187], v[80:95]
  buffer_load_dwordx4 v6, s[4:7], s52 offen lds
  v_exp_f32 v49, v49
  v_exp_f32 v50, v50
  v_exp_f32_e64 v51, v51
  v_mfma_f32_32x32x16_bf16 v[96:111], v[200:203], v[184:187], v[96:111]
  buffer_load_dwordx4 v7, s[4:7], s52 offen offset:1024 lds
  v_exp_f32 v52, v52
  v_exp_f32 v53, v53
  v_mfma_f32_32x32x16_bf16 v[64:79], v[204:207], v[188:191], v[64:79]
  buffer_load_dwordx4 v8, s[4:7], s52 offen offset:2048 lds
  v_exp_f32 v54, v54
  v_exp_f32 v55, v55
  v_exp_f32_e64 v56, v56
  v_mfma_f32_32x32x16_bf16 v[80:95], v[208:211], v[188:191], v[80:95]
  buffer_load_dwordx4 v9, s[4:7], s52 offen offset:3072 lds
  v_exp_f32 v57, v57
  v_exp_f32 v58, v58
  v_mfma_f32_32x32x16_bf16 v[96:111], v[212:215], v[188:191], v[96:111]
  v_exp_f32 v59, v59
  v_exp_f32 v60, v60
  v_exp_f32 v61, v61
  v_exp_f32 v62, v62
  v_exp_f32_e64 v63, v63
  v_pk_fma_f32 v[48:49], v[48:49], s[22:23], s[22:23]
  v_pk_fma_f32 v[50:51], v[50:51], s[22:23], s[22:23]
  v_pk_fma_f32 v[52:53], v[52:53], s[22:23], s[22:23]
  v_pk_fma_f32 v[54:55], v[54:55], s[22:23], s[22:23]
  v_pk_fma_f32 v[56:57], v[56:57], s[22:23], s[22:23]
  v_pk_fma_f32 v[58:59], v[58:59], s[22:23], s[22:23]
  v_pk_fma_f32 v[60:61], v[60:61], s[22:23], s[22:23]
  v_pk_fma_f32 v[62:63], v[62:63], s[22:23], s[22:23]
  v_mfma_f32_32x32x16_bf16 v[16:31], a[24:27], v[160:163], 0
  ds_read_b128 v[192:195], v1 offset:14336
  ds_read_b128 v[196:199], v1 offset:15360
  v_rcp_f32 v48, v48
  v_rcp_f32 v49, v49
  v_mfma_f32_32x32x16_bf16 v[16:31], a[28:31], v[164:167], v[16:31]
  ds_read_b128 v[200:203], v1 offset:16384
  ds_read_b128 v[204:207], v1 offset:17408
  v_rcp_f32 v50, v50
  v_rcp_f32 v51, v51
  v_mfma_f32_32x32x16_bf16 v[16:31], a[32:35], v[168:171], v[16:31]
  ds_read_b128 v[208:211], v1 offset:18432
  ds_read_b128 v[212:215], v1 offset:19456
  v_rcp_f32 v52, v52
  v_rcp_f32 v53, v53
  v_mfma_f32_32x32x16_bf16 v[16:31], a[36:39], v[172:175], v[16:31]
  buffer_store_dwordx4 v[112:115], v10, s[8:11], s28 offen
  v_rcp_f32 v54, v54
  v_rcp_f32 v55, v55
  v_mfma_f32_32x32x16_bf16 v[16:31], a[40:43], v[176:179], v[16:31]
  v_rcp_f32 v56, v56
  v_rcp_f32 v57, v57
  v_rcp_f32_e64 v58, v58
  v_mfma_f32_32x32x16_bf16 v[16:31], a[44:47], v[180:183], v[16:31]
  s_waitcnt lgkmcnt(0)
  v_rcp_f32 v59, v59
  v_rcp_f32 v60, v60
  v_rcp_f32 v61, v61
  v_rcp_f32 v62, v62
  v_rcp_f32 v63, v63
  v_pk_mul_f32 v[32:33], v[32:33], v[48:49]
  v_pk_mul_f32 v[34:35], v[34:35], v[50:51]
  v_pk_mul_f32 v[36:37], v[36:37], v[52:53]
  v_pk_mul_f32 v[38:39], v[38:39], v[54:55]
  v_pk_mul_f32 v[40:41], v[40:41], v[56:57]
  v_pk_mul_f32 v[42:43], v[42:43], v[58:59]
  v_pk_mul_f32 v[44:45], v[44:45], v[60:61]
  v_pk_mul_f32 v[46:47], v[46:47], v[62:63]
  v_pk_fma_f32 v[48:49], v[16:17], v[16:17], s[20:21] neg_lo:[1,0,1] neg_hi:[1,0,1]
  v_pk_fma_f32 v[50:51], v[18:19], v[18:19], s[20:21] neg_lo:[1,0,1] neg_hi:[1,0,1]
  v_pk_fma_f32 v[52:53], v[20:21], v[20:21], s[20:21] neg_lo:[1,0,1] neg_hi:[1,0,1]
  v_pk_fma_f32 v[54:55], v[22:23], v[22:23], s[20:21] neg_lo:[1,0,1] neg_hi:[1,0,1]
  v_pk_fma_f32 v[56:57], v[24:25], v[24:25], s[20:21] neg_lo:[1,0,1] neg_hi:[1,0,1]
  v_pk_fma_f32 v[58:59], v[26:27], v[26:27], s[20:21] neg_lo:[1,0,1] neg_hi:[1,0,1]
  v_pk_fma_f32 v[60:61], v[28:29], v[28:29], s[20:21] neg_lo:[1,0,1] neg_hi:[1,0,1]
  v_pk_fma_f32 v[62:63], v[30:31], v[30:31], s[20:21] neg_lo:[1,0,1] neg_hi:[1,0,1]
  v_pk_mul_f32 v[48:49], v[16:17], v[48:49]
  v_pk_mul_f32 v[50:51], v[18:19], v[50:51]
  v_pk_mul_f32 v[52:53], v[20:21], v[52:53]
  v_pk_mul_f32 v[54:55], v[22:23], v[54:55]
  v_pk_mul_f32 v[56:57], v[24:25], v[56:57]
  v_cvt_pk_bf16_f32 v184, v32, v33
  v_cvt_pk_bf16_f32 v185, v34, v35
  v_cvt_pk_bf16_f32 v186, v36, v37
  v_cvt_pk_bf16_f32 v187, v38, v39
  v_pk_mul_f32 v[58:59], v[26:27], v[58:59]
  v_pk_mul_f32 v[60:61], v[28:29], v[60:61]
  v_pk_mul_f32 v[62:63], v[30:31], v[62:63]
  v_mfma_f32_32x32x16_bf16 v[64:79], v[192:195], v[184:187], v[64:79]
  v_cvt_pk_bf16_f32 v188, v40, v41
  v_cvt_pk_bf16_f32 v189, v42, v43
  v_cvt_pk_bf16_f32 v190, v44, v45
  v_cvt_pk_bf16_f32 v191, v46, v47
  v_exp_f32_e64 v48, v48
  v_mfma_f32_32x32x16_bf16 v[80:95], v[196:199], v[184:187], v[80:95]
  v_exp_f32 v49, v49
  v_exp_f32 v50, v50
  v_exp_f32_e64 v51, v51
  v_mfma_f32_32x32x16_bf16 v[96:111], v[200:203], v[184:187], v[96:111]
  v_exp_f32 v52, v52
  v_exp_f32 v53, v53
  v_subrev_u32 v11, 0x4100, v5
  v_mfma_f32_32x32x16_bf16 v[64:79], v[204:207], v[188:191], v[64:79]
  v_exp_f32 v54, v54
  v_exp_f32 v55, v55
  v_exp_f32_e64 v56, v56
  v_mfma_f32_32x32x16_bf16 v[80:95], v[208:211], v[188:191], v[80:95]
  v_exp_f32 v57, v57
  v_exp_f32 v58, v58
  v_add_u32 v5, 0x8200, v5
  v_exp_f32_e64 v59, v59
  v_mfma_f32_32x32x16_bf16 v[96:111], v[212:215], v[188:191], v[96:111]
  v_exp_f32 v60, v60
  v_exp_f32 v61, v61
  v_exp_f32 v62, v62
  v_exp_f32 v63, v63
  v_min_u32_e64 v5, v11, v5
  v_pk_fma_f32 v[48:49], v[48:49], s[22:23], s[22:23]
  v_pk_fma_f32 v[50:51], v[50:51], s[22:23], s[22:23]
  v_pk_fma_f32 v[52:53], v[52:53], s[22:23], s[22:23]
  v_pk_fma_f32 v[54:55], v[54:55], s[22:23], s[22:23]
  v_pk_fma_f32 v[56:57], v[56:57], s[22:23], s[22:23]
  v_pk_fma_f32 v[58:59], v[58:59], s[22:23], s[22:23]
  v_pk_fma_f32 v[60:61], v[60:61], s[22:23], s[22:23]
  v_pk_fma_f32 v[62:63], v[62:63], s[22:23], s[22:23]
  v_mfma_f32_32x32x16_bf16 v[32:47], a[48:51], v[160:163], 0
  ds_read_b128 v[192:195], v1 offset:20480
  ds_read_b128 v[196:199], v1 offset:21504
  v_rcp_f32 v48, v48
  v_rcp_f32 v49, v49
  v_mfma_f32_32x32x16_bf16 v[32:47], a[52:55], v[164:167], v[32:47]
  ds_read_b128 v[200:203], v1 offset:22528
  ds_read_b128 v[204:207], v1 offset:23552
  v_rcp_f32 v50, v50
  v_rcp_f32 v51, v51
  v_mfma_f32_32x32x16_bf16 v[32:47], a[56:59], v[168:171], v[32:47]
  ds_read_b128 v[208:211], v1 offset:24576
  ds_read_b128 v[212:215], v1 offset:25600
  v_rcp_f32 v52, v52
  v_rcp_f32 v53, v53
  v_mfma_f32_32x32x16_bf16 v[32:47], a[60:63], v[172:175], v[32:47]
  buffer_store_dwordx4 v[116:119], v10, s[8:11], s28 offen offset:32
  v_rcp_f32 v54, v54
  v_rcp_f32 v55, v55
  v_mfma_f32_32x32x16_bf16 v[32:47], a[64:67], v[176:179], v[32:47]
  v_rcp_f32 v56, v56
  v_rcp_f32 v57, v57
  v_rcp_f32_e64 v58, v58
  v_mfma_f32_32x32x16_bf16 v[32:47], a[68:71], v[180:183], v[32:47]
  s_waitcnt lgkmcnt(0)
  v_rcp_f32 v59, v59
  v_rcp_f32 v60, v60
  v_rcp_f32 v61, v61
  v_rcp_f32 v62, v62
  v_rcp_f32 v63, v63
  v_pk_mul_f32 v[16:17], v[16:17], v[48:49]
  v_pk_mul_f32 v[18:19], v[18:19], v[50:51]
  v_pk_mul_f32 v[20:21], v[20:21], v[52:53]
  v_pk_mul_f32 v[22:23], v[22:23], v[54:55]
  v_pk_mul_f32 v[24:25], v[24:25], v[56:57]
  v_pk_mul_f32 v[26:27], v[26:27], v[58:59]
  v_pk_mul_f32 v[28:29], v[28:29], v[60:61]
  v_pk_mul_f32 v[30:31], v[30:31], v[62:63]
  v_pk_fma_f32 v[48:49], v[32:33], v[32:33], s[20:21] neg_lo:[1,0,1] neg_hi:[1,0,1]
  v_pk_fma_f32 v[50:51], v[34:35], v[34:35], s[20:21] neg_lo:[1,0,1] neg_hi:[1,0,1]
  v_pk_fma_f32 v[52:53], v[36:37], v[36:37], s[20:21] neg_lo:[1,0,1] neg_hi:[1,0,1]
  v_pk_fma_f32 v[54:55], v[38:39], v[38:39], s[20:21] neg_lo:[1,0,1] neg_hi:[1,0,1]
  v_pk_fma_f32 v[56:57], v[40:41], v[40:41], s[20:21] neg_lo:[1,0,1] neg_hi:[1,0,1]
  v_pk_fma_f32 v[58:59], v[42:43], v[42:43], s[20:21] neg_lo:[1,0,1] neg_hi:[1,0,1]
  v_pk_fma_f32 v[60:61], v[44:45], v[44:45], s[20:21] neg_lo:[1,0,1] neg_hi:[1,0,1]
  v_pk_fma_f32 v[62:63], v[46:47], v[46:47], s[20:21] neg_lo:[1,0,1] neg_hi:[1,0,1]
  v_pk_mul_f32 v[48:49], v[32:33], v[48:49]
  v_pk_mul_f32 v[50:51], v[34:35], v[50:51]
  v_pk_mul_f32 v[52:53], v[36:37], v[52:53]
  v_pk_mul_f32 v[54:55], v[38:39], v[54:55]
  v_pk_mul_f32 v[56:57], v[40:41], v[56:57]
  v_cvt_pk_bf16_f32 v184, v16, v17
  v_cvt_pk_bf16_f32 v185, v18, v19
  v_cvt_pk_bf16_f32 v186, v20, v21
  v_cvt_pk_bf16_f32 v187, v22, v23
  v_pk_mul_f32 v[58:59], v[42:43], v[58:59]
  v_pk_mul_f32 v[60:61], v[44:45], v[60:61]
  v_pk_mul_f32 v[62:63], v[46:47], v[62:63]
  v_mfma_f32_32x32x16_bf16 v[64:79], v[192:195], v[184:187], v[64:79]
  s_add_u32 s29, s29, 0x60000
  v_cvt_pk_bf16_f32 v188, v24, v25
  v_cvt_pk_bf16_f32 v189, v26, v27
  v_cvt_pk_bf16_f32 v190, v28, v29
  v_cvt_pk_bf16_f32 v191, v30, v31
  v_exp_f32_e64 v48, v48
  v_mfma_f32_32x32x16_bf16 v[80:95], v[196:199], v[184:187], v[80:95]
  s_add_u32 s52, s52, 0x60000
  v_exp_f32 v49, v49
  v_exp_f32 v50, v50
  v_exp_f32_e64 v51, v51
  v_mfma_f32_32x32x16_bf16 v[96:111], v[200:203], v[184:187], v[96:111]
  s_mov_b32 s32, s30
  v_exp_f32 v52, v52
  v_exp_f32_e64 v53, v53
  v_subrev_u32 v11, 0x4100, v4
  v_mfma_f32_32x32x16_bf16 v[64:79], v[204:207], v[188:191], v[64:79]
  s_add_u32 s30, s33, 32
  v_exp_f32 v54, v54
  v_exp_f32 v55, v55
  v_exp_f32 v56, v56
  v_mfma_f32_32x32x16_bf16 v[80:95], v[208:211], v[188:191], v[80:95]
  s_sub_u32 s33, s31, 0
  v_exp_f32 v57, v57
  v_exp_f32_e64 v58, v58
  v_add_u32 v4, 0x8200, v4
  v_exp_f32_e64 v59, v59
  v_mfma_f32_32x32x16_bf16 v[96:111], v[212:215], v[188:191], v[96:111]
  v_exp_f32 v60, v60
  v_exp_f32 v61, v61
  v_exp_f32 v62, v62
  v_exp_f32 v63, v63
  v_min_u32_e64 v4, v11, v4
  v_pk_fma_f32 v[48:49], v[48:49], s[22:23], s[22:23]
  v_pk_fma_f32 v[50:51], v[50:51], s[22:23], s[22:23]
  v_pk_fma_f32 v[52:53], v[52:53], s[22:23], s[22:23]
  v_pk_fma_f32 v[54:55], v[54:55], s[22:23], s[22:23]
  v_pk_fma_f32 v[56:57], v[56:57], s[22:23], s[22:23]
  v_pk_fma_f32 v[58:59], v[58:59], s[22:23], s[22:23]
  v_pk_fma_f32 v[60:61], v[60:61], s[22:23], s[22:23]
  v_pk_fma_f32 v[62:63], v[62:63], s[22:23], s[22:23]
  v_mfma_f32_32x32x16_bf16 v[16:31], a[72:75], v[160:163], 0
  ds_read_b128 v[192:195], v1 offset:26624
  ds_read_b128 v[196:199], v1 offset:27648
  v_rcp_f32 v48, v48
  v_rcp_f32 v49, v49
  v_mfma_f32_32x32x16_bf16 v[16:31], a[76:79], v[164:167], v[16:31]
  ds_read_b128 v[200:203], v1 offset:28672
  ds_read_b128 v[204:207], v1 offset:29696
  v_rcp_f32 v50, v50
  v_rcp_f32 v51, v51
  v_mfma_f32_32x32x16_bf16 v[16:31], a[80:83], v[168:171], v[16:31]
  ds_read_b128 v[208:211], v1 offset:30720
  ds_read_b128 v[212:215], v1 offset:31744
  v_rcp_f32 v52, v52
  v_rcp_f32 v53, v53
  v_mfma_f32_32x32x16_bf16 v[16:31], a[84:87], v[172:175], v[16:31]
  buffer_load_dword v249, v248, s[4:7], s29 offen
  v_rcp_f32 v54, v54
  v_rcp_f32 v55, v55
  v_mfma_f32_32x32x16_bf16 v[16:31], a[88:91], v[176:179], v[16:31]
  v_rcp_f32 v56, v56
  v_rcp_f32 v57, v57
  v_rcp_f32_e64 v58, v58
  v_mfma_f32_32x32x16_bf16 v[16:31], a[92:95], v[180:183], v[16:31]
  s_waitcnt lgkmcnt(0)
  v_rcp_f32 v59, v59
  v_rcp_f32 v60, v60
  v_rcp_f32 v61, v61
  v_rcp_f32_e64 v62, v62
  v_rcp_f32_e64 v63, v63
  v_pk_mul_f32 v[32:33], v[32:33], v[48:49]
  v_pk_mul_f32 v[34:35], v[34:35], v[50:51]
  v_pk_mul_f32 v[36:37], v[36:37], v[52:53]
  v_pk_mul_f32 v[38:39], v[38:39], v[54:55]
  v_pk_mul_f32 v[40:41], v[40:41], v[56:57]
  v_pk_mul_f32 v[42:43], v[42:43], v[58:59]
  v_pk_mul_f32 v[44:45], v[44:45], v[60:61]
  v_pk_mul_f32 v[46:47], v[46:47], v[62:63]
  v_pk_fma_f32 v[48:49], v[16:17], v[16:17], s[20:21] neg_lo:[1,0,1] neg_hi:[1,0,1]
  v_pk_fma_f32 v[50:51], v[18:19], v[18:19], s[20:21] neg_lo:[1,0,1] neg_hi:[1,0,1]
  v_pk_fma_f32 v[52:53], v[20:21], v[20:21], s[20:21] neg_lo:[1,0,1] neg_hi:[1,0,1]
  v_pk_fma_f32 v[54:55], v[22:23], v[22:23], s[20:21] neg_lo:[1,0,1] neg_hi:[1,0,1]
  v_pk_fma_f32 v[56:57], v[24:25], v[24:25], s[20:21] neg_lo:[1,0,1] neg_hi:[1,0,1]
  v_pk_fma_f32 v[58:59], v[26:27], v[26:27], s[20:21] neg_lo:[1,0,1] neg_hi:[1,0,1]
  v_pk_fma_f32 v[60:61], v[28:29], v[28:29], s[20:21] neg_lo:[1,0,1] neg_hi:[1,0,1]
  v_pk_fma_f32 v[62:63], v[30:31], v[30:31], s[20:21] neg_lo:[1,0,1] neg_hi:[1,0,1]
  v_pk_mul_f32 v[48:49], v[16:17], v[48:49]
  v_pk_mul_f32 v[50:51], v[18:19], v[50:51]
  v_pk_mul_f32 v[52:53], v[20:21], v[52:53]
  v_pk_mul_f32 v[54:55], v[22:23], v[54:55]
  v_pk_mul_f32 v[56:57], v[24:25], v[56:57]
  v_cvt_pk_bf16_f32 v184, v32, v33
  v_cvt_pk_bf16_f32 v185, v34, v35
  v_cvt_pk_bf16_f32 v186, v36, v37
  v_cvt_pk_bf16_f32 v187, v38, v39
  v_pk_mul_f32 v[58:59], v[26:27], v[58:59]
  v_pk_mul_f32 v[60:61], v[28:29], v[60:61]
  v_pk_mul_f32 v[62:63], v[30:31], v[62:63]
  v_mfma_f32_32x32x16_bf16 v[64:79], v[192:195], v[184:187], v[64:79]
  s_waitcnt vmcnt(3)
  ds_read_b128 v[220:223], v4 offset:96
  v_cvt_pk_bf16_f32 v188, v40, v41
  v_cvt_pk_bf16_f32 v189, v42, v43
  v_cvt_pk_bf16_f32 v190, v44, v45
  v_cvt_pk_bf16_f32 v191, v46, v47
  v_mfma_f32_32x32x16_bf16 v[80:95], v[196:199], v[184:187], v[80:95]
  ds_read_b128 v[228:231], v4 offset:288
  v_exp_f32 v48, v48
  v_exp_f32 v49, v49
  v_exp_f32 v50, v50
  v_mfma_f32_32x32x16_bf16 v[96:111], v[200:203], v[184:187], v[96:111]
  ds_read_b128 v[236:239], v4 offset:480
  v_exp_f32 v51, v51
  v_exp_f32 v52, v52
  v_mfma_f32_32x32x16_bf16 v[64:79], v[204:207], v[188:191], v[64:79]
  v_exp_f32 v53, v53
  v_exp_f32 v54, v54
  v_exp_f32_e64 v55, v55
  v_mfma_f32_32x32x16_bf16 v[80:95], v[208:211], v[188:191], v[80:95]
  v_exp_f32 v56, v56
  v_exp_f32 v57, v57
  v_exp_f32_e64 v58, v58
  v_mfma_f32_32x32x16_bf16 v[96:111], v[212:215], v[188:191], v[96:111]
  s_waitcnt lgkmcnt(0)
  v_exp_f32 v59, v59
  v_exp_f32 v60, v60
  v_exp_f32 v61, v61
  v_exp_f32 v62, v62
  v_exp_f32 v63, v63
  v_pk_fma_f32 v[48:49], v[48:49], s[22:23], s[22:23]
  v_pk_fma_f32 v[50:51], v[50:51], s[22:23], s[22:23]
  v_pk_fma_f32 v[52:53], v[52:53], s[22:23], s[22:23]
  v_pk_fma_f32 v[54:55], v[54:55], s[22:23], s[22:23]
  v_pk_fma_f32 v[56:57], v[56:57], s[22:23], s[22:23]
  v_pk_fma_f32 v[58:59], v[58:59], s[22:23], s[22:23]
  v_pk_fma_f32 v[60:61], v[60:61], s[22:23], s[22:23]
  v_pk_fma_f32 v[62:63], v[62:63], s[22:23], s[22:23]
  v_mfma_f32_32x32x16_bf16 v[32:47], a[96:99], v[160:163], 0
  ds_read_b128 v[192:195], v0 offset:24576
  ds_read_b128 v[196:199], v0 offset:25600
  v_rcp_f32 v48, v48
  v_rcp_f32 v49, v49
  v_mfma_f32_16x16x32_bf16 v[136:139], a[240:243], v[220:223], 0
  ds_read_b128 v[216:219], v3 offset:2800
  ds_read_b128 v[220:223], v4 offset:112
  v_mfma_f32_32x32x16_bf16 v[32:47], a[100:103], v[164:167], v[32:47]
  ds_read_b128 v[200:203], v0 offset:26624
  ds_read_b128 v[204:207], v0 offset:27648
  v_rcp_f32 v50, v50
  v_rcp_f32 v51, v51
  v_mfma_f32_16x16x32_bf16 v[136:139], a[244:247], v[228:231], v[136:139]
  ds_read_b128 v[224:227], v3 offset:7600
  ds_read_b128 v[228:231], v4 offset:304
  v_mfma_f32_32x32x16_bf16 v[32:47], a[104:107], v[168:171], v[32:47]
  ds_read_b128 v[208:211], v0 offset:28672
  ds_read_b128 v[212:215], v0 offset:29696
  v_rcp_f32 v52, v52
  v_rcp_f32 v53, v53
  v_mfma_f32_16x16x32_bf16 v[136:139], a[248:251], v[236:239], v[136:139]
  ds_read_b128 v[232:235], v3 offset:12400
  ds_read_b128 v[236:239], v4 offset:496
  v_mfma_f32_32x32x16_bf16 v[32:47], a[108:111], v[172:175], v[32:47]
  buffer_store_dwordx4 v[120:123], v10, s[8:11], s28 offen offset:64
  v_rcp_f32 v54, v54
  v_rcp_f32 v55, v55
  v_mfma_f32_32x32x16_bf16 v[32:47], a[112:115], v[176:179], v[32:47]
  v_rcp_f32 v56, v56
  v_rcp_f32 v57, v57
  v_rcp_f32_e64 v58, v58
  v_mfma_f32_32x32x16_bf16 v[32:47], a[116:119], v[180:183], v[32:47]
  s_waitcnt lgkmcnt(0)
  v_rcp_f32 v59, v59
  v_rcp_f32 v60, v60
  v_rcp_f32 v61, v61
  v_rcp_f32 v62, v62
  v_rcp_f32 v63, v63
  v_pk_mul_f32 v[16:17], v[16:17], v[48:49]
  v_pk_mul_f32 v[18:19], v[18:19], v[50:51]
  v_pk_mul_f32 v[20:21], v[20:21], v[52:53]
  v_pk_mul_f32 v[22:23], v[22:23], v[54:55]
  v_pk_mul_f32 v[24:25], v[24:25], v[56:57]
  v_pk_mul_f32 v[26:27], v[26:27], v[58:59]
  v_pk_mul_f32 v[28:29], v[28:29], v[60:61]
  v_pk_mul_f32 v[30:31], v[30:31], v[62:63]
  v_pk_add_f32 v[12:13], v[136:137], v[138:139]
  v_pk_mul_f32 v[14:15], v[136:137], v[136:137]
  v_pk_fma_f32 v[14:15], v[138:139], v[138:139], v[14:15]
  v_pk_fma_f32 v[48:49], v[32:33], v[32:33], s[20:21] neg_lo:[1,0,1] neg_hi:[1,0,1]
  v_pk_fma_f32 v[50:51], v[34:35], v[34:35], s[20:21] neg_lo:[1,0,1] neg_hi:[1,0,1]
  v_pk_fma_f32 v[52:53], v[36:37], v[36:37], s[20:21] neg_lo:[1,0,1] neg_hi:[1,0,1]
  v_pk_fma_f32 v[54:55], v[38:39], v[38:39], s[20:21] neg_lo:[1,0,1] neg_hi:[1,0,1]
  v_pk_fma_f32 v[56:57], v[40:41], v[40:41], s[20:21] neg_lo:[1,0,1] neg_hi:[1,0,1]
  v_pk_fma_f32 v[58:59], v[42:43], v[42:43], s[20:21] neg_lo:[1,0,1] neg_hi:[1,0,1]
  v_pk_fma_f32 v[60:61], v[44:45], v[44:45], s[20:21] neg_lo:[1,0,1] neg_hi:[1,0,1]
  v_pk_fma_f32 v[62:63], v[46:47], v[46:47], s[20:21] neg_lo:[1,0,1] neg_hi:[1,0,1]
  v_pk_mul_f32 v[48:49], v[32:33], v[48:49]
  v_pk_mul_f32 v[50:51], v[34:35], v[50:51]
  v_pk_mul_f32 v[52:53], v[36:37], v[52:53]
  v_pk_mul_f32 v[54:55], v[38:39], v[54:55]
  v_pk_mul_f32 v[56:57], v[40:41], v[56:57]
  v_pk_mul_f32 v[58:59], v[42:43], v[58:59]
  v_pk_mul_f32 v[60:61], v[44:45], v[60:61]
  v_pk_mul_f32 v[62:63], v[46:47], v[62:63]
  v_mfma_f32_16x16x32_bf16 v[140:143], v[216:219], v[220:223], 0
  v_cvt_pk_bf16_f32 v184, v16, v17
  v_cvt_pk_bf16_f32 v185, v18, v19
  v_mfma_f32_16x16x32_bf16 v[140:143], v[224:227], v[228:231], v[140:143]
  v_cvt_pk_bf16_f32 v186, v20, v21
  v_cvt_pk_bf16_f32 v187, v22, v23
  v_mfma_f32_16x16x32_bf16 v[140:143], v[232:235], v[236:239], v[140:143]
  ds_read_b128 v[220:223], v4 offset:128
  v_mfma_f32_32x32x16_bf16 v[64:79], v[192:195], v[184:187], v[64:79]
  ds_read_b128 v[224:227], v3 offset:8000
  ds_read_b128 v[228:231], v4 offset:320
  v_cvt_pk_bf16_f32 v188, v24, v25
  v_cvt_pk_bf16_f32 v189, v26, v27
  v_cvt_pk_bf16_f32 v190, v28, v29
  v_cvt_pk_bf16_f32 v191, v30, v31
  v_mfma_f32_32x32x16_bf16 v[80:95], v[196:199], v[184:187], v[80:95]
  ds_read_b128 v[232:235], v3 offset:12800
  ds_read_b128 v[236:239], v4 offset:512
  v_exp_f32 v48, v48
  v_exp_f32 v49, v49
  v_mfma_f32_32x32x16_bf16 v[96:111], v[200:203], v[184:187], v[96:111]
  s_sub_u32 s31, s32, 32
  v_exp_f32 v50, v50
  v_exp_f32 v51, v51
  v_exp_f32 v52, v52
  v_mfma_f32_32x32x16_bf16 v[64:79], v[204:207], v[188:191], v[64:79]
  v_exp_f32 v53, v53
  v_exp_f32 v54, v54
  v_exp_f32_e64 v55, v55
  v_mfma_f32_32x32x16_bf16 v[80:95], v[208:211], v[188:191], v[80:95]
  v_exp_f32 v56, v56
  v_exp_f32 v57, v57
  v_exp_f32_e64 v58, v58
  v_mfma_f32_32x32x16_bf16 v[96:111], v[212:215], v[188:191], v[96:111]
  s_waitcnt lgkmcnt(0)
  v_exp_f32 v59, v59
  v_exp_f32 v60, v60
  v_exp_f32 v61, v61
  v_exp_f32 v62, v62
  v_exp_f32 v63, v63
  v_pk_add_f32 v[12:13], v[12:13], v[140:141]
  v_pk_fma_f32 v[14:15], v[140:141], v[140:141], v[14:15]
  v_pk_add_f32 v[12:13], v[12:13], v[142:143]
  v_pk_fma_f32 v[14:15], v[142:143], v[142:143], v[14:15]
  v_pk_fma_f32 v[48:49], v[48:49], s[22:23], s[22:23]
  v_pk_fma_f32 v[50:51], v[50:51], s[22:23], s[22:23]
  v_pk_fma_f32 v[52:53], v[52:53], s[22:23], s[22:23]
  v_pk_fma_f32 v[54:55], v[54:55], s[22:23], s[22:23]
  v_pk_fma_f32 v[56:57], v[56:57], s[22:23], s[22:23]
  v_pk_fma_f32 v[58:59], v[58:59], s[22:23], s[22:23]
  v_pk_fma_f32 v[60:61], v[60:61], s[22:23], s[22:23]
  v_pk_fma_f32 v[62:63], v[62:63], s[22:23], s[22:23]
  v_mfma_f32_32x32x16_bf16 v[16:31], a[120:123], v[160:163], 0
  ds_read_b128 v[192:195], v0 offset:30720
  ds_read_b128 v[196:199], v0 offset:31744
  v_rcp_f32 v48, v48
  v_rcp_f32 v49, v49
  v_mfma_f32_16x16x32_bf16 v[144:147], a[252:255], v[220:223], 0
  ds_read_b128 v[216:219], v3 offset:3600
  ds_read_b128 v[220:223], v4 offset:144
  v_mfma_f32_32x32x16_bf16 v[16:31], a[124:127], v[164:167], v[16:31]
  ds_read_b128 v[200:203], v0 offset:32768
  ds_read_b128 v[204:207], v0 offset:33792
  v_rcp_f32 v50, v50
  v_rcp_f32 v51, v51
  v_mfma_f32_16x16x32_bf16 v[144:147], v[224:227], v[228:231], v[144:147]
  ds_read_b128 v[224:227], v3 offset:8400
  ds_read_b128 v[228:231], v4 offset:336
  v_mfma_f32_32x32x16_bf16 v[16:31], a[128:131], v[168:171], v[16:31]
  ds_read_b128 v[208:211], v0 offset:34816
  ds_read_b128 v[212:215], v0 offset:35840
  v_rcp_f32 v52, v52
  v_rcp_f32 v53, v53
  v_mfma_f32_16x16x32_bf16 v[144:147], v[232:235], v[236:239], v[144:147]
  ds_read_b128 v[232:235], v3 offset:13200
  ds_read_b128 v[236:239], v4 offset:528
  v_mfma_f32_32x32x16_bf16 v[16:31], a[132:135], v[172:175], v[16:31]
  buffer_store_dwordx4 v[124:127], v10, s[8:11], s28 offen offset:96
  v_rcp_f32 v54, v54
  v_rcp_f32 v55, v55
  v_mfma_f32_32x32x16_bf16 v[16:31], a[136:139], v[176:179], v[16:31]
  v_rcp_f32 v56, v56
  v_rcp_f32 v57, v57
  v_rcp_f32_e64 v58, v58
  v_mfma_f32_32x32x16_bf16 v[16:31], a[140:143], v[180:183], v[16:31]
  s_waitcnt lgkmcnt(0)
  v_rcp_f32 v59, v59
  v_rcp_f32 v60, v60
  v_rcp_f32 v61, v61
  v_rcp_f32 v62, v62
  v_rcp_f32 v63, v63
  v_pk_mul_f32 v[32:33], v[32:33], v[48:49]
  v_pk_mul_f32 v[34:35], v[34:35], v[50:51]
  v_pk_mul_f32 v[36:37], v[36:37], v[52:53]
  v_pk_mul_f32 v[38:39], v[38:39], v[54:55]
  v_pk_mul_f32 v[40:41], v[40:41], v[56:57]
  v_pk_mul_f32 v[42:43], v[42:43], v[58:59]
  v_pk_mul_f32 v[44:45], v[44:45], v[60:61]
  v_pk_mul_f32 v[46:47], v[46:47], v[62:63]
  v_pk_add_f32 v[12:13], v[12:13], v[144:145]
  v_pk_fma_f32 v[14:15], v[144:145], v[144:145], v[14:15]
  v_pk_add_f32 v[12:13], v[12:13], v[146:147]
  v_pk_fma_f32 v[14:15], v[146:147], v[146:147], v[14:15]
  v_pk_fma_f32 v[48:49], v[16:17], v[16:17], s[20:21] neg_lo:[1,0,1] neg_hi:[1,0,1]
  v_pk_fma_f32 v[50:51], v[18:19], v[18:19], s[20:21] neg_lo:[1,0,1] neg_hi:[1,0,1]
  v_pk_fma_f32 v[52:53], v[20:21], v[20:21], s[20:21] neg_lo:[1,0,1] neg_hi:[1,0,1]
  v_pk_fma_f32 v[54:55], v[22:23], v[22:23], s[20:21] neg_lo:[1,0,1] neg_hi:[1,0,1]
  v_pk_fma_f32 v[56:57], v[24:25], v[24:25], s[20:21] neg_lo:[1,0,1] neg_hi:[1,0,1]
  v_pk_fma_f32 v[58:59], v[26:27], v[26:27], s[20:21] neg_lo:[1,0,1] neg_hi:[1,0,1]
  v_pk_fma_f32 v[60:61], v[28:29], v[28:29], s[20:21] neg_lo:[1,0,1] neg_hi:[1,0,1]
  v_pk_fma_f32 v[62:63], v[30:31], v[30:31], s[20:21] neg_lo:[1,0,1] neg_hi:[1,0,1]
  v_pk_mul_f32 v[48:49], v[16:17], v[48:49]
  v_pk_mul_f32 v[50:51], v[18:19], v[50:51]
  v_pk_mul_f32 v[52:53], v[20:21], v[52:53]
  v_pk_mul_f32 v[54:55], v[22:23], v[54:55]
  v_pk_mul_f32 v[56:57], v[24:25], v[56:57]
  v_pk_mul_f32 v[58:59], v[26:27], v[58:59]
  v_pk_mul_f32 v[60:61], v[28:29], v[60:61]
  v_pk_mul_f32 v[62:63], v[30:31], v[62:63]
  v_mfma_f32_16x16x32_bf16 v[148:151], v[216:219], v[220:223], 0
  v_cvt_pk_bf16_f32 v184, v32, v33
  v_cvt_pk_bf16_f32 v185, v34, v35
  v_mfma_f32_16x16x32_bf16 v[148:151], v[224:227], v[228:231], v[148:151]
  v_cvt_pk_bf16_f32 v186, v36, v37
  v_cvt_pk_bf16_f32 v187, v38, v39
  v_mfma_f32_16x16x32_bf16 v[148:151], v[232:235], v[236:239], v[148:151]
  ds_read_b128 v[216:219], v3 offset:4000
  ds_read_b128 v[220:223], v4 offset:160
  v_mfma_f32_32x32x16_bf16 v[64:79], v[192:195], v[184:187], v[64:79]
  ds_read_b128 v[224:227], v3 offset:8800
  ds_read_b128 v[228:231], v4 offset:352
  v_cvt_pk_bf16_f32 v188, v40, v41
  v_cvt_pk_bf16_f32 v189, v42, v43
  v_cvt_pk_bf16_f32 v190, v44, v45
  v_cvt_pk_bf16_f32 v191, v46, v47
  v_mfma_f32_32x32x16_bf16 v[80:95], v[196:199], v[184:187], v[80:95]
  ds_read_b128 v[232:235], v3 offset:13600
  ds_read_b128 v[236:239], v4 offset:544
  v_exp_f32 v48, v48
  v_exp_f32 v49, v49
  v_mfma_f32_32x32x16_bf16 v[96:111], v[200:203], v[184:187], v[96:111]
  v_exp_f32 v50, v50
  v_exp_f32 v51, v51
  v_exp_f32_e64 v52, v52
  v_mfma_f32_32x32x16_bf16 v[64:79], v[204:207], v[188:191], v[64:79]
  v_exp_f32 v53, v53
  v_exp_f32 v54, v54
  v_exp_f32_e64 v55, v55
  v_mfma_f32_32x32x16_bf16 v[80:95], v[208:211], v[188:191], v[80:95]
  v_exp_f32 v56, v56
  v_exp_f32 v57, v57
  v_exp_f32_e64 v58, v58
  v_mfma_f32_32x32x16_bf16 v[96:111], v[212:215], v[188:191], v[96:111]
  s_waitcnt lgkmcnt(0)
  v_exp_f32 v59, v59
  v_exp_f32 v60, v60
  v_exp_f32 v61, v61
  v_exp_f32 v62, v62
  v_exp_f32 v63, v63
  v_pk_add_f32 v[12:13], v[12:13], v[148:149]
  v_pk_fma_f32 v[14:15], v[148:149], v[148:149], v[14:15]
  v_pk_add_f32 v[12:13], v[12:13], v[150:151]
  v_pk_fma_f32 v[14:15], v[150:151], v[150:151], v[14:15]
  v_pk_fma_f32 v[48:49], v[48:49], s[22:23], s[22:23]
  v_pk_fma_f32 v[50:51], v[50:51], s[22:23], s[22:23]
  v_pk_fma_f32 v[52:53], v[52:53], s[22:23], s[22:23]
  v_pk_fma_f32 v[54:55], v[54:55], s[22:23], s[22:23]
  v_pk_fma_f32 v[56:57], v[56:57], s[22:23], s[22:23]
  v_pk_fma_f32 v[58:59], v[58:59], s[22:23], s[22:23]
  v_pk_fma_f32 v[60:61], v[60:61], s[22:23], s[22:23]
  v_pk_fma_f32 v[62:63], v[62:63], s[22:23], s[22:23]
  v_mfma_f32_32x32x16_bf16 v[32:47], a[144:147], v[160:163], 0
  ds_read_b128 v[192:195], v0 offset:36864
  ds_read_b128 v[196:199], v0 offset:37888
  v_rcp_f32 v48, v48
  v_rcp_f32 v49, v49
  v_mfma_f32_16x16x32_bf16 v[152:155], v[216:219], v[220:223], 0
  ds_read_b128 v[216:219], v3 offset:4400
  ds_read_b128 v[220:223], v4 offset:176
  v_mfma_f32_32x32x16_bf16 v[32:47], a[148:151], v[164:167], v[32:47]
  ds_read_b128 v[200:203], v0 offset:38912
  ds_read_b128 v[204:207], v0 offset:39936
  v_rcp_f32 v50, v50
  v_rcp_f32 v51, v51
  v_mfma_f32_16x16x32_bf16 v[152:155], v[224:227], v[228:231], v[152:155]
  ds_read_b128 v[224:227], v3 offset:9200
  ds_read_b128 v[228:231], v4 offset:368
  v_mfma_f32_32x32x16_bf16 v[32:47], a[152:155], v[168:171], v[32:47]
  ds_read_b128 v[208:211], v0 offset:40960
  ds_read_b128 v[212:215], v0 offset:41984
  v_rcp_f32 v52, v52
  v_rcp_f32 v53, v53
  v_mfma_f32_16x16x32_bf16 v[152:155], v[232:235], v[236:239], v[152:155]
  ds_read_b128 v[232:235], v3 offset:14000
  ds_read_b128 v[236:239], v4 offset:560
  v_mfma_f32_32x32x16_bf16 v[32:47], a[156:159], v[172:175], v[32:47]
  v_rcp_f32 v54, v54
  v_rcp_f32 v55, v55
  v_rcp_f32_e64 v56, v56
  v_mfma_f32_32x32x16_bf16 v[32:47], a[160:163], v[176:179], v[32:47]
  v_rcp_f32 v57, v57
  v_rcp_f32 v58, v58
  v_rcp_f32_e64 v59, v59
  v_mfma_f32_32x32x16_bf16 v[32:47], a[164:167], v[180:183], v[32:47]
  s_waitcnt lgkmcnt(0)
  v_rcp_f32 v60, v60
  v_rcp_f32 v61, v61
  v_rcp_f32 v62, v62
  v_rcp_f32_e64 v63, v63
  v_pk_mul_f32 v[16:17], v[16:17], v[48:49]
  v_pk_mul_f32 v[18:19], v[18:19], v[50:51]
  v_pk_mul_f32 v[20:21], v[20:21], v[52:53]
  v_pk_mul_f32 v[22:23], v[22:23], v[54:55]
  v_pk_mul_f32 v[24:25], v[24:25], v[56:57]
  v_pk_mul_f32 v[26:27], v[26:27], v[58:59]
  v_pk_mul_f32 v[28:29], v[28:29], v[60:61]
  v_pk_mul_f32 v[30:31], v[30:31], v[62:63]
  v_pk_add_f32 v[12:13], v[12:13], v[152:153]
  v_pk_fma_f32 v[14:15], v[152:153], v[152:153], v[14:15]
  v_pk_add_f32 v[12:13], v[12:13], v[154:155]
  v_pk_fma_f32 v[14:15], v[154:155], v[154:155], v[14:15]
  v_pk_fma_f32 v[48:49], v[32:33], v[32:33], s[20:21] neg_lo:[1,0,1] neg_hi:[1,0,1]
  v_pk_fma_f32 v[50:51], v[34:35], v[34:35], s[20:21] neg_lo:[1,0,1] neg_hi:[1,0,1]
  v_pk_fma_f32 v[52:53], v[36:37], v[36:37], s[20:21] neg_lo:[1,0,1] neg_hi:[1,0,1]
  v_pk_fma_f32 v[54:55], v[38:39], v[38:39], s[20:21] neg_lo:[1,0,1] neg_hi:[1,0,1]
  v_pk_fma_f32 v[56:57], v[40:41], v[40:41], s[20:21] neg_lo:[1,0,1] neg_hi:[1,0,1]
  v_pk_fma_f32 v[58:59], v[42:43], v[42:43], s[20:21] neg_lo:[1,0,1] neg_hi:[1,0,1]
  v_pk_fma_f32 v[60:61], v[44:45], v[44:45], s[20:21] neg_lo:[1,0,1] neg_hi:[1,0,1]
  v_pk_fma_f32 v[62:63], v[46:47], v[46:47], s[20:21] neg_lo:[1,0,1] neg_hi:[1,0,1]
  v_pk_mul_f32 v[48:49], v[32:33], v[48:49]
  v_pk_mul_f32 v[50:51], v[34:35], v[50:51]
  v_pk_mul_f32 v[52:53], v[36:37], v[52:53]
  v_pk_mul_f32 v[54:55], v[38:39], v[54:55]
  v_pk_mul_f32 v[56:57], v[40:41], v[56:57]
  v_pk_mul_f32 v[58:59], v[42:43], v[58:59]
  v_pk_mul_f32 v[60:61], v[44:45], v[60:61]
  v_pk_mul_f32 v[62:63], v[46:47], v[62:63]
  v_mfma_f32_16x16x32_bf16 v[156:159], v[216:219], v[220:223], 0
  v_cvt_pk_bf16_f32 v184, v16, v17
  v_cvt_pk_bf16_f32 v185, v18, v19
  v_mfma_f32_16x16x32_bf16 v[156:159], v[224:227], v[228:231], v[156:159]
  v_cvt_pk_bf16_f32 v186, v20, v21
  v_cvt_pk_bf16_f32 v187, v22, v23
  v_mfma_f32_16x16x32_bf16 v[156:159], v[232:235], v[236:239], v[156:159]
  ds_read_b128 v[216:219], v3
  ds_read_b128 v[220:223], v4
  v_mfma_f32_32x32x16_bf16 v[64:79], v[192:195], v[184:187], v[64:79]
  ds_read_b128 v[224:227], v3 offset:4800
  ds_read_b128 v[228:231], v4 offset:192
  v_cvt_pk_bf16_f32 v188, v24, v25
  v_cvt_pk_bf16_f32 v189, v26, v27
  v_cvt_pk_bf16_f32 v190, v28, v29
  v_cvt_pk_bf16_f32 v191, v30, v31
  v_mfma_f32_32x32x16_bf16 v[80:95], v[196:199], v[184:187], v[80:95]
  ds_read_b128 v[232:235], v3 offset:9600
  ds_read_b128 v[236:239], v4 offset:384
  v_exp_f32 v48, v48
  v_exp_f32 v49, v49
  v_mfma_f32_32x32x16_bf16 v[96:111], v[200:203], v[184:187], v[96:111]
  v_exp_f32 v50, v50
  v_exp_f32 v51, v51
  v_exp_f32_e64 v52, v52
  v_mfma_f32_32x32x16_bf16 v[64:79], v[204:207], v[188:191], v[64:79]
  v_exp_f32 v53, v53
  v_exp_f32 v54, v54
  v_exp_f32_e64 v55, v55
  v_mfma_f32_32x32x16_bf16 v[80:95], v[208:211], v[188:191], v[80:95]
  v_exp_f32 v56, v56
  v_exp_f32 v57, v57
  v_exp_f32_e64 v58, v58
  v_mfma_f32_32x32x16_bf16 v[96:111], v[212:215], v[188:191], v[96:111]
  s_waitcnt lgkmcnt(0)
  v_exp_f32 v59, v59
  v_exp_f32 v60, v60
  v_exp_f32 v61, v61
  v_exp_f32 v62, v62
  v_exp_f32 v63, v63
  v_pk_add_f32 v[12:13], v[12:13], v[156:157]
  v_pk_fma_f32 v[14:15], v[156:157], v[156:157], v[14:15]
  v_pk_add_f32 v[12:13], v[12:13], v[158:159]
  v_pk_fma_f32 v[14:15], v[158:159], v[158:159], v[14:15]
  v_pk_fma_f32 v[48:49], v[48:49], s[22:23], s[22:23]
  v_pk_fma_f32 v[50:51], v[50:51], s[22:23], s[22:23]
  v_pk_fma_f32 v[52:53], v[52:53], s[22:23], s[22:23]
  v_pk_fma_f32 v[54:55], v[54:55], s[22:23], s[22:23]
  v_pk_fma_f32 v[56:57], v[56:57], s[22:23], s[22:23]
  v_pk_fma_f32 v[58:59], v[58:59], s[22:23], s[22:23]
  v_pk_fma_f32 v[60:61], v[60:61], s[22:23], s[22:23]
  v_pk_fma_f32 v[62:63], v[62:63], s[22:23], s[22:23]
  v_mfma_f32_32x32x16_bf16 v[16:31], a[168:171], v[160:163], 0
  ds_read_b128 v[192:195], v0 offset:43008
  ds_read_b128 v[196:199], v0 offset:44032
  v_rcp_f32 v48, v48
  v_rcp_f32 v49, v49
  v_mfma_f32_16x16x32_bf16 v[112:115], v[216:219], v[220:223], 0
  ds_read_b128 v[216:219], v3 offset:400
  ds_read_b128 v[220:223], v4 offset:16
  v_mfma_f32_32x32x16_bf16 v[16:31], a[172:175], v[164:167], v[16:31]
  ds_read_b128 v[200:203], v0 offset:45056
  ds_read_b128 v[204:207], v0 offset:46080
  v_rcp_f32 v50, v50
  v_rcp_f32 v51, v51
  v_mfma_f32_16x16x32_bf16 v[112:115], v[224:227], v[228:231], v[112:115]
  ds_read_b128 v[224:227], v3 offset:5200
  ds_read_b128 v[228:231], v4 offset:208
  v_mfma_f32_32x32x16_bf16 v[16:31], a[176:179], v[168:171], v[16:31]
  ds_read_b128 v[208:211], v0 offset:47104
  ds_read_b128 v[212:215], v0 offset:48128
  v_rcp_f32 v52, v52
  v_rcp_f32 v53, v53
  v_mfma_f32_16x16x32_bf16 v[112:115], v[232:235], v[236:239], v[112:115]
  ds_read_b128 v[232:235], v3 offset:10000
  ds_read_b128 v[236:239], v4 offset:400
  v_mfma_f32_32x32x16_bf16 v[16:31], a[180:183], v[172:175], v[16:31]
  buffer_store_dwordx4 v[128:131], v10, s[8:11], s28 offen offset:128
  v_rcp_f32 v54, v54
  v_rcp_f32 v55, v55
  v_mfma_f32_32x32x16_bf16 v[16:31], a[184:187], v[176:179], v[16:31]
  v_rcp_f32 v56, v56
  v_rcp_f32 v57, v57
  v_rcp_f32_e64 v58, v58
  v_mfma_f32_32x32x16_bf16 v[16:31], a[188:191], v[180:183], v[16:31]
  s_waitcnt lgkmcnt(0)
  v_rcp_f32 v59, v59
  v_rcp_f32 v60, v60
  v_rcp_f32 v61, v61
  v_rcp_f32 v62, v62
  v_rcp_f32 v63, v63
  v_pk_mul_f32 v[32:33], v[32:33], v[48:49]
  v_pk_mul_f32 v[34:35], v[34:35], v[50:51]
  v_pk_mul_f32 v[36:37], v[36:37], v[52:53]
  v_pk_mul_f32 v[38:39], v[38:39], v[54:55]
  v_pk_mul_f32 v[40:41], v[40:41], v[56:57]
  v_pk_mul_f32 v[42:43], v[42:43], v[58:59]
  v_pk_mul_f32 v[44:45], v[44:45], v[60:61]
  v_pk_mul_f32 v[46:47], v[46:47], v[62:63]
  v_pk_add_f32 v[12:13], v[12:13], v[112:113]
  v_pk_fma_f32 v[14:15], v[112:113], v[112:113], v[14:15]
  v_pk_add_f32 v[12:13], v[12:13], v[114:115]
  v_pk_fma_f32 v[14:15], v[114:115], v[114:115], v[14:15]
  v_pk_fma_f32 v[48:49], v[16:17], v[16:17], s[20:21] neg_lo:[1,0,1] neg_hi:[1,0,1]
  v_pk_fma_f32 v[50:51], v[18:19], v[18:19], s[20:21] neg_lo:[1,0,1] neg_hi:[1,0,1]
  v_pk_fma_f32 v[52:53], v[20:21], v[20:21], s[20:21] neg_lo:[1,0,1] neg_hi:[1,0,1]
  v_pk_fma_f32 v[54:55], v[22:23], v[22:23], s[20:21] neg_lo:[1,0,1] neg_hi:[1,0,1]
  v_pk_fma_f32 v[56:57], v[24:25], v[24:25], s[20:21] neg_lo:[1,0,1] neg_hi:[1,0,1]
  v_pk_fma_f32 v[58:59], v[26:27], v[26:27], s[20:21] neg_lo:[1,0,1] neg_hi:[1,0,1]
  v_pk_fma_f32 v[60:61], v[28:29], v[28:29], s[20:21] neg_lo:[1,0,1] neg_hi:[1,0,1]
  v_pk_fma_f32 v[62:63], v[30:31], v[30:31], s[20:21] neg_lo:[1,0,1] neg_hi:[1,0,1]
  v_pk_mul_f32 v[48:49], v[16:17], v[48:49]
  v_pk_mul_f32 v[50:51], v[18:19], v[50:51]
  v_pk_mul_f32 v[52:53], v[20:21], v[52:53]
  v_pk_mul_f32 v[54:55], v[22:23], v[54:55]
  v_pk_mul_f32 v[56:57], v[24:25], v[56:57]
  v_pk_mul_f32 v[58:59], v[26:27], v[58:59]
  v_pk_mul_f32 v[60:61], v[28:29], v[60:61]
  v_pk_mul_f32 v[62:63], v[30:31], v[62:63]
  v_mfma_f32_16x16x32_bf16 v[116:119], v[216:219], v[220:223], 0
  v_cvt_pk_bf16_f32 v184, v32, v33
  v_cvt_pk_bf16_f32 v185, v34, v35
  v_mfma_f32_16x16x32_bf16 v[116:119], v[224:227], v[228:231], v[116:119]
  v_cvt_pk_bf16_f32 v186, v36, v37
  v_cvt_pk_bf16_f32 v187, v38, v39
  v_mfma_f32_16x16x32_bf16 v[116:119], v[232:235], v[236:239], v[116:119]
  ds_read_b128 v[216:219], v3 offset:800
  ds_read_b128 v[220:223], v4 offset:32
  v_mfma_f32_32x32x16_bf16 v[64:79], v[192:195], v[184:187], v[64:79]
  ds_read_b128 v[224:227], v3 offset:5600
  ds_read_b128 v[228:231], v4 offset:224
  v_cvt_pk_bf16_f32 v188, v40, v41
  v_cvt_pk_bf16_f32 v189, v42, v43
  v_cvt_pk_bf16_f32 v190, v44, v45
  v_cvt_pk_bf16_f32 v191, v46, v47
  v_mfma_f32_32x32x16_bf16 v[80:95], v[196:199], v[184:187], v[80:95]
  ds_read_b128 v[232:235], v3 offset:10400
  ds_read_b128 v[236:239], v4 offset:416
  v_exp_f32 v48, v48
  v_exp_f32 v49, v49
  v_mfma_f32_32x32x16_bf16 v[96:111], v[200:203], v[184:187], v[96:111]
  v_exp_f32 v50, v50
  v_exp_f32 v51, v51
  v_exp_f32_e64 v52, v52
  v_mfma_f32_32x32x16_bf16 v[64:79], v[204:207], v[188:191], v[64:79]
  v_exp_f32 v53, v53
  v_exp_f32 v54, v54
  v_exp_f32_e64 v55, v55
  v_mfma_f32_32x32x16_bf16 v[80:95], v[208:211], v[188:191], v[80:95]
  v_exp_f32 v56, v56
  v_exp_f32 v57, v57
  v_exp_f32_e64 v58, v58
  v_mfma_f32_32x32x16_bf16 v[96:111], v[212:215], v[188:191], v[96:111]
  s_waitcnt lgkmcnt(0)
  v_exp_f32 v59, v59
  v_exp_f32 v60, v60
  v_exp_f32 v61, v61
  v_exp_f32 v62, v62
  v_exp_f32 v63, v63
  v_pk_add_f32 v[12:13], v[12:13], v[116:117]
  v_pk_fma_f32 v[14:15], v[116:117], v[116:117], v[14:15]
  v_pk_add_f32 v[12:13], v[12:13], v[118:119]
  v_pk_fma_f32 v[14:15], v[118:119], v[118:119], v[14:15]
  v_pk_fma_f32 v[48:49], v[48:49], s[22:23], s[22:23]
  v_pk_fma_f32 v[50:51], v[50:51], s[22:23], s[22:23]
  v_pk_fma_f32 v[52:53], v[52:53], s[22:23], s[22:23]
  v_pk_fma_f32 v[54:55], v[54:55], s[22:23], s[22:23]
  v_pk_fma_f32 v[56:57], v[56:57], s[22:23], s[22:23]
  v_pk_fma_f32 v[58:59], v[58:59], s[22:23], s[22:23]
  v_pk_fma_f32 v[60:61], v[60:61], s[22:23], s[22:23]
  v_pk_fma_f32 v[62:63], v[62:63], s[22:23], s[22:23]
  v_mfma_f32_32x32x16_bf16 v[32:47], a[192:195], v[160:163], 0
  ds_read_b128 v[192:195], v0 offset:49152
  ds_read_b128 v[196:199], v0 offset:50176
  v_rcp_f32 v48, v48
  v_rcp_f32 v49, v49
  v_mfma_f32_16x16x32_bf16 v[120:123], v[216:219], v[220:223], 0
  ds_read_b128 v[216:219], v3 offset:1200
  ds_read_b128 v[220:223], v4 offset:48
  v_mfma_f32_32x32x16_bf16 v[32:47], a[196:199], v[164:167], v[32:47]
  ds_read_b128 v[200:203], v0 offset:51200
  ds_read_b128 v[204:207], v0 offset:52224
  v_rcp_f32 v50, v50
  v_rcp_f32 v51, v51
  v_mfma_f32_16x16x32_bf16 v[120:123], v[224:227], v[228:231], v[120:123]
  ds_read_b128 v[224:227], v3 offset:6000
  ds_read_b128 v[228:231], v4 offset:240
  v_mfma_f32_32x32x16_bf16 v[32:47], a[200:203], v[168:171], v[32:47]
  ds_read_b128 v[208:211], v0 offset:53248
  ds_read_b128 v[212:215], v0 offset:54272
  v_rcp_f32 v52, v52
  v_rcp_f32 v53, v53
  v_mfma_f32_16x16x32_bf16 v[120:123], v[232:235], v[236:239], v[120:123]
  ds_read_b128 v[232:235], v3 offset:10800
  ds_read_b128 v[236:239], v4 offset:432
  v_mfma_f32_32x32x16_bf16 v[32:47], a[204:207], v[172:175], v[32:47]
  buffer_store_dwordx4 v[132:135], v10, s[8:11], s28 offen offset:160
  v_rcp_f32 v54, v54
  v_rcp_f32 v55, v55
  v_mfma_f32_32x32x16_bf16 v[32:47], a[208:211], v[176:179], v[32:47]
  v_rcp_f32 v56, v56
  v_rcp_f32 v57, v57
  v_rcp_f32_e64 v58, v58
  v_mfma_f32_32x32x16_bf16 v[32:47], a[212:215], v[180:183], v[32:47]
  s_waitcnt lgkmcnt(0)
  v_rcp_f32 v59, v59
  v_rcp_f32 v60, v60
  v_rcp_f32 v61, v61
  v_rcp_f32 v62, v62
  v_rcp_f32 v63, v63
  v_pk_mul_f32 v[16:17], v[16:17], v[48:49]
  v_pk_mul_f32 v[18:19], v[18:19], v[50:51]
  v_pk_mul_f32 v[20:21], v[20:21], v[52:53]
  v_pk_mul_f32 v[22:23], v[22:23], v[54:55]
  v_pk_mul_f32 v[24:25], v[24:25], v[56:57]
  v_pk_mul_f32 v[26:27], v[26:27], v[58:59]
  v_pk_mul_f32 v[28:29], v[28:29], v[60:61]
  v_pk_mul_f32 v[30:31], v[30:31], v[62:63]
  v_pk_add_f32 v[12:13], v[12:13], v[120:121]
  v_pk_fma_f32 v[14:15], v[120:121], v[120:121], v[14:15]
  v_pk_add_f32 v[12:13], v[12:13], v[122:123]
  v_pk_fma_f32 v[14:15], v[122:123], v[122:123], v[14:15]
  v_pk_fma_f32 v[48:49], v[32:33], v[32:33], s[20:21] neg_lo:[1,0,1] neg_hi:[1,0,1]
  v_pk_fma_f32 v[50:51], v[34:35], v[34:35], s[20:21] neg_lo:[1,0,1] neg_hi:[1,0,1]
  v_pk_fma_f32 v[52:53], v[36:37], v[36:37], s[20:21] neg_lo:[1,0,1] neg_hi:[1,0,1]
  v_pk_fma_f32 v[54:55], v[38:39], v[38:39], s[20:21] neg_lo:[1,0,1] neg_hi:[1,0,1]
  v_pk_fma_f32 v[56:57], v[40:41], v[40:41], s[20:21] neg_lo:[1,0,1] neg_hi:[1,0,1]
  v_pk_fma_f32 v[58:59], v[42:43], v[42:43], s[20:21] neg_lo:[1,0,1] neg_hi:[1,0,1]
  v_pk_fma_f32 v[60:61], v[44:45], v[44:45], s[20:21] neg_lo:[1,0,1] neg_hi:[1,0,1]
  v_pk_fma_f32 v[62:63], v[46:47], v[46:47], s[20:21] neg_lo:[1,0,1] neg_hi:[1,0,1]
  v_pk_mul_f32 v[48:49], v[32:33], v[48:49]
  v_pk_mul_f32 v[50:51], v[34:35], v[50:51]
  v_pk_mul_f32 v[52:53], v[36:37], v[52:53]
  v_pk_mul_f32 v[54:55], v[38:39], v[54:55]
  v_pk_mul_f32 v[56:57], v[40:41], v[56:57]
  v_pk_mul_f32 v[58:59], v[42:43], v[58:59]
  v_pk_mul_f32 v[60:61], v[44:45], v[60:61]
  v_pk_mul_f32 v[62:63], v[46:47], v[62:63]
  v_mfma_f32_16x16x32_bf16 v[124:127], v[216:219], v[220:223], 0
  v_cvt_pk_bf16_f32 v184, v16, v17
  v_cvt_pk_bf16_f32 v185, v18, v19
  v_mfma_f32_16x16x32_bf16 v[124:127], v[224:227], v[228:231], v[124:127]
  v_cvt_pk_bf16_f32 v186, v20, v21
  v_cvt_pk_bf16_f32 v187, v22, v23
  v_mfma_f32_16x16x32_bf16 v[124:127], v[232:235], v[236:239], v[124:127]
  ds_read_b128 v[216:219], v3 offset:1600
  ds_read_b128 v[220:223], v4 offset:64
  v_mfma_f32_32x32x16_bf16 v[64:79], v[192:195], v[184:187], v[64:79]
  ds_read_b128 v[224:227], v3 offset:6400
  ds_read_b128 v[228:231], v4 offset:256
  v_cvt_pk_bf16_f32 v188, v24, v25
  v_cvt_pk_bf16_f32 v189, v26, v27
  v_cvt_pk_bf16_f32 v190, v28, v29
  v_cvt_pk_bf16_f32 v191, v30, v31
  v_mfma_f32_32x32x16_bf16 v[80:95], v[196:199], v[184:187], v[80:95]
  ds_read_b128 v[232:235], v3 offset:11200
  ds_read_b128 v[236:239], v4 offset:448
  v_exp_f32 v48, v48
  v_exp_f32 v49, v49
  v_mfma_f32_32x32x16_bf16 v[96:111], v[200:203], v[184:187], v[96:111]
  v_exp_f32 v50, v50
  v_exp_f32 v51, v51
  v_exp_f32_e64 v52, v52
  v_mfma_f32_32x32x16_bf16 v[64:79], v[204:207], v[188:191], v[64:79]
  v_exp_f32 v53, v53
  v_exp_f32 v54, v54
  v_exp_f32_e64 v55, v55
  v_mfma_f32_32x32x16_bf16 v[80:95], v[208:211], v[188:191], v[80:95]
  v_exp_f32 v56, v56
  v_exp_f32 v57, v57
  v_exp_f32_e64 v58, v58
  v_mfma_f32_32x32x16_bf16 v[96:111], v[212:215], v[188:191], v[96:111]
  s_waitcnt lgkmcnt(0)
  v_exp_f32 v59, v59
  v_exp_f32 v60, v60
  v_exp_f32 v61, v61
  v_exp_f32 v62, v62
  v_exp_f32 v63, v63
  v_pk_add_f32 v[12:13], v[12:13], v[124:125]
  v_pk_fma_f32 v[14:15], v[124:125], v[124:125], v[14:15]
  v_pk_add_f32 v[12:13], v[12:13], v[126:127]
  v_pk_fma_f32 v[14:15], v[126:127], v[126:127], v[14:15]
  v_pk_fma_f32 v[48:49], v[48:49], s[22:23], s[22:23]
  v_pk_fma_f32 v[50:51], v[50:51], s[22:23], s[22:23]
  v_pk_fma_f32 v[52:53], v[52:53], s[22:23], s[22:23]
  v_pk_fma_f32 v[54:55], v[54:55], s[22:23], s[22:23]
  v_pk_fma_f32 v[56:57], v[56:57], s[22:23], s[22:23]
  v_pk_fma_f32 v[58:59], v[58:59], s[22:23], s[22:23]
  v_pk_fma_f32 v[60:61], v[60:61], s[22:23], s[22:23]
  v_pk_fma_f32 v[62:63], v[62:63], s[22:23], s[22:23]
  v_mfma_f32_32x32x16_bf16 v[16:31], a[216:219], v[160:163], 0
  ds_read_b128 v[192:195], v0 offset:55296
  ds_read_b128 v[196:199], v0 offset:56320
  v_rcp_f32 v48, v48
  v_rcp_f32 v49, v49
  v_mfma_f32_16x16x32_bf16 v[128:131], v[216:219], v[220:223], 0
  ds_read_b128 v[216:219], v3 offset:2000
  ds_read_b128 v[220:223], v4 offset:80
  v_mfma_f32_32x32x16_bf16 v[16:31], a[220:223], v[164:167], v[16:31]
  ds_read_b128 v[200:203], v0 offset:57344
  ds_read_b128 v[204:207], v0 offset:58368
  v_rcp_f32 v50, v50
  v_rcp_f32 v51, v51
  v_mfma_f32_16x16x32_bf16 v[128:131], v[224:227], v[228:231], v[128:131]
  ds_read_b128 v[224:227], v3 offset:6800
  ds_read_b128 v[228:231], v4 offset:272
  v_mfma_f32_32x32x16_bf16 v[16:31], a[224:227], v[168:171], v[16:31]
  ds_read_b128 v[208:211], v0 offset:59392
  ds_read_b128 v[212:215], v0 offset:60416
  v_rcp_f32 v52, v52
  v_rcp_f32 v53, v53
  v_mfma_f32_16x16x32_bf16 v[128:131], v[232:235], v[236:239], v[128:131]
  ds_read_b128 v[232:235], v3 offset:11600
  ds_read_b128 v[236:239], v4 offset:464
  v_mfma_f32_32x32x16_bf16 v[16:31], a[228:231], v[172:175], v[16:31]
  v_rcp_f32 v54, v54
  v_rcp_f32 v55, v55
  v_rcp_f32_e64 v56, v56
  v_mfma_f32_32x32x16_bf16 v[16:31], a[232:235], v[176:179], v[16:31]
  v_rcp_f32 v57, v57
  v_rcp_f32 v58, v58
  v_rcp_f32_e64 v59, v59
  v_mfma_f32_32x32x16_bf16 v[16:31], a[236:239], v[180:183], v[16:31]
  s_waitcnt lgkmcnt(0)
  v_rcp_f32 v60, v60
  v_rcp_f32 v61, v61
  v_rcp_f32 v62, v62
  v_rcp_f32_e64 v63, v63
  v_pk_mul_f32 v[32:33], v[32:33], v[48:49]
  v_pk_mul_f32 v[34:35], v[34:35], v[50:51]
  v_pk_mul_f32 v[36:37], v[36:37], v[52:53]
  v_pk_mul_f32 v[38:39], v[38:39], v[54:55]
  v_pk_mul_f32 v[40:41], v[40:41], v[56:57]
  v_pk_mul_f32 v[42:43], v[42:43], v[58:59]
  v_pk_mul_f32 v[44:45], v[44:45], v[60:61]
  v_pk_mul_f32 v[46:47], v[46:47], v[62:63]
  v_pk_add_f32 v[12:13], v[12:13], v[128:129]
  v_pk_fma_f32 v[14:15], v[128:129], v[128:129], v[14:15]
  v_pk_add_f32 v[12:13], v[12:13], v[130:131]
  v_pk_fma_f32 v[14:15], v[130:131], v[130:131], v[14:15]
  v_pk_fma_f32 v[48:49], v[16:17], v[16:17], s[20:21] neg_lo:[1,0,1] neg_hi:[1,0,1]
  v_pk_fma_f32 v[50:51], v[18:19], v[18:19], s[20:21] neg_lo:[1,0,1] neg_hi:[1,0,1]
  v_pk_fma_f32 v[52:53], v[20:21], v[20:21], s[20:21] neg_lo:[1,0,1] neg_hi:[1,0,1]
  v_pk_fma_f32 v[54:55], v[22:23], v[22:23], s[20:21] neg_lo:[1,0,1] neg_hi:[1,0,1]
  v_pk_fma_f32 v[56:57], v[24:25], v[24:25], s[20:21] neg_lo:[1,0,1] neg_hi:[1,0,1]
  v_pk_fma_f32 v[58:59], v[26:27], v[26:27], s[20:21] neg_lo:[1,0,1] neg_hi:[1,0,1]
  v_pk_fma_f32 v[60:61], v[28:29], v[28:29], s[20:21] neg_lo:[1,0,1] neg_hi:[1,0,1]
  v_pk_fma_f32 v[62:63], v[30:31], v[30:31], s[20:21] neg_lo:[1,0,1] neg_hi:[1,0,1]
  v_pk_mul_f32 v[48:49], v[16:17], v[48:49]
  v_pk_mul_f32 v[50:51], v[18:19], v[50:51]
  v_pk_mul_f32 v[52:53], v[20:21], v[52:53]
  v_pk_mul_f32 v[54:55], v[22:23], v[54:55]
  v_pk_mul_f32 v[56:57], v[24:25], v[56:57]
  v_pk_mul_f32 v[58:59], v[26:27], v[58:59]
  v_pk_mul_f32 v[60:61], v[28:29], v[60:61]
  v_pk_mul_f32 v[62:63], v[30:31], v[62:63]
  v_mfma_f32_16x16x32_bf16 v[132:135], v[216:219], v[220:223], 0
  v_cvt_pk_bf16_f32 v184, v32, v33
  v_cvt_pk_bf16_f32 v185, v34, v35
  v_mfma_f32_16x16x32_bf16 v[132:135], v[224:227], v[228:231], v[132:135]
  v_cvt_pk_bf16_f32 v186, v36, v37
  v_cvt_pk_bf16_f32 v187, v38, v39
  v_mfma_f32_16x16x32_bf16 v[132:135], v[232:235], v[236:239], v[132:135]
  ds_read_b128 v[216:219], v0 offset:12288
  ds_read_b128 v[220:223], v0 offset:13312
  v_mfma_f32_32x32x16_bf16 v[64:79], v[192:195], v[184:187], v[64:79]
  ds_read_b128 v[224:227], v0 offset:14336
  ds_read_b128 v[228:231], v0 offset:15360
  v_cvt_pk_bf16_f32 v188, v40, v41
  v_cvt_pk_bf16_f32 v189, v42, v43
  v_cvt_pk_bf16_f32 v190, v44, v45
  v_cvt_pk_bf16_f32 v191, v46, v47
  v_mfma_f32_32x32x16_bf16 v[80:95], v[196:199], v[184:187], v[80:95]
  ds_read_b128 v[232:235], v0 offset:16384
  ds_read_b128 v[236:239], v0 offset:17408
  v_exp_f32 v48, v48
  v_exp_f32 v49, v49
  v_mfma_f32_32x32x16_bf16 v[96:111], v[200:203], v[184:187], v[96:111]
  v_exp_f32 v50, v50
  v_exp_f32 v51, v51
  v_exp_f32_e64 v52, v52
  v_mfma_f32_32x32x16_bf16 v[64:79], v[204:207], v[188:191], v[64:79]
  s_mov_b32 s28, s34
  v_exp_f32 v53, v53
  v_exp_f32 v54, v54
  v_exp_f32 v55, v55
  v_mfma_f32_32x32x16_bf16 v[80:95], v[208:211], v[188:191], v[80:95]
  s_add_u32 s34, s34, 0x60000
  v_exp_f32 v56, v56
  v_exp_f32 v57, v57
  v_exp_f32_e64 v58, v58
  v_mfma_f32_32x32x16_bf16 v[96:111], v[212:215], v[188:191], v[96:111]
  s_waitcnt lgkmcnt(0)
  v_exp_f32 v59, v59
  v_exp_f32 v60, v60
  v_exp_f32 v61, v61
  v_exp_f32 v62, v62
  v_exp_f32 v63, v63
  v_pk_add_f32 v[12:13], v[12:13], v[132:133]
  v_pk_fma_f32 v[14:15], v[132:133], v[132:133], v[14:15]
  v_pk_add_f32 v[12:13], v[12:13], v[134:135]
  v_pk_fma_f32 v[14:15], v[134:135], v[134:135], v[14:15]
  v_pk_fma_f32 v[48:49], v[48:49], s[22:23], s[22:23]
  v_pk_fma_f32 v[50:51], v[50:51], s[22:23], s[22:23]
  v_pk_fma_f32 v[52:53], v[52:53], s[22:23], s[22:23]
  v_pk_fma_f32 v[54:55], v[54:55], s[22:23], s[22:23]
  v_pk_fma_f32 v[56:57], v[56:57], s[22:23], s[22:23]
  v_pk_fma_f32 v[58:59], v[58:59], s[22:23], s[22:23]
  v_pk_fma_f32 v[60:61], v[60:61], s[22:23], s[22:23]
  v_pk_fma_f32 v[62:63], v[62:63], s[22:23], s[22:23]
  v_mfma_f32_32x32x16_bf16 v[32:47], v[216:219], v[160:163], 0
  ds_read_b128 v[192:195], v0 offset:61440
  ds_read_b128 v[196:199], v0 offset:62464
  v_rcp_f32 v48, v48
  v_rcp_f32 v49, v49
  v_add_f32_e64 v12, v12, v13
  v_mfma_f32_32x32x16_bf16 v[32:47], v[220:223], v[164:167], v[32:47]
  ds_read_b128 v[200:203], v0 offset:63488
  ds_read_b128 v[204:207], v0 offset:64512
  v_rcp_f32 v50, v50
  v_add_f32 v14, v14, v15
  v_rcp_f32_e64 v51, v51
  v_mfma_f32_32x32x16_bf16 v[32:47], v[224:227], v[168:171], v[32:47]
  ds_read_b128 v[208:211], v1
  ds_read_b128 v[212:215], v1 offset:1024
  v_permlane32_swap_b32 v12, v14
  v_rcp_f32 v52, v52
  v_add_f32 v12, v12, v14
  v_rcp_f32 v53, v53
  v_mfma_f32_32x32x16_bf16 v[32:47], v[228:231], v[172:175], v[32:47]
  v_mov_b32 v14, v12
  v_rcp_f32 v54, v54
  s_nop 0
  v_permlane32_swap_b32 v12, v14
  v_rcp_f32 v55, v55
  v_mul_f32 v12, s24, v12
  v_mfma_f32_32x32x16_bf16 v[32:47], v[232:235], v[176:179], v[32:47]
  v_rcp_f32 v56, v56
  v_rcp_f32 v57, v57
  v_mul_f32 v13, s24, v14
  v_rcp_f32 v58, v58
  v_fma_f32 v13, -v12, v12, v13
  v_mfma_f32_32x32x16_bf16 v[32:47], v[236:239], v[180:183], v[32:47]
  s_waitcnt lgkmcnt(0)
  v_rcp_f32 v59, v59
  v_max_f32 v13, 0, v13
  v_rcp_f32 v60, v60
  v_add_f32 v13, s25, v13
  v_rcp_f32 v61, v61
  v_rsq_f32 v13, v13
  v_rcp_f32 v62, v62
  v_mul_f32 v14, s22, v13
  v_rcp_f32 v63, v63
  v_mul_f32_e64 v12, -v12, v14
  v_pk_mul_f32 v[16:17], v[16:17], v[48:49]
  v_pk_mul_f32 v[18:19], v[18:19], v[50:51]
  v_pk_mul_f32 v[20:21], v[20:21], v[52:53]
  v_pk_mul_f32 v[22:23], v[22:23], v[54:55]
  v_pk_mul_f32 v[24:25], v[24:25], v[56:57]
  v_pk_mul_f32 v[26:27], v[26:27], v[58:59]
  v_pk_mul_f32 v[28:29], v[28:29], v[60:61]
  v_pk_mul_f32 v[30:31], v[30:31], v[62:63]
  v_pk_fma_f32 v[112:113], v[112:113], v[14:15], v[12:13] op_sel_hi:[1,0,0]
  v_pk_fma_f32 v[114:115], v[114:115], v[14:15], v[12:13] op_sel_hi:[1,0,0]
  v_pk_fma_f32 v[116:117], v[116:117], v[14:15], v[12:13] op_sel_hi:[1,0,0]
  v_pk_fma_f32 v[118:119], v[118:119], v[14:15], v[12:13] op_sel_hi:[1,0,0]
  v_pk_fma_f32 v[120:121], v[120:121], v[14:15], v[12:13] op_sel_hi:[1,0,0]
  v_pk_fma_f32 v[122:123], v[122:123], v[14:15], v[12:13] op_sel_hi:[1,0,0]
  v_pk_fma_f32 v[124:125], v[124:125], v[14:15], v[12:13] op_sel_hi:[1,0,0]
  v_pk_fma_f32 v[126:127], v[126:127], v[14:15], v[12:13] op_sel_hi:[1,0,0]
  v_pk_fma_f32 v[128:129], v[128:129], v[14:15], v[12:13] op_sel_hi:[1,0,0]
  v_pk_fma_f32 v[130:131], v[130:131], v[14:15], v[12:13] op_sel_hi:[1,0,0]
  v_pk_fma_f32 v[132:133], v[132:133], v[14:15], v[12:13] op_sel_hi:[1,0,0]
  v_pk_fma_f32 v[134:135], v[134:135], v[14:15], v[12:13] op_sel_hi:[1,0,0]
  v_pk_fma_f32 v[136:137], v[136:137], v[14:15], v[12:13] op_sel_hi:[1,0,0]
  v_pk_fma_f32 v[138:139], v[138:139], v[14:15], v[12:13] op_sel_hi:[1,0,0]
  v_pk_fma_f32 v[140:141], v[140:141], v[14:15], v[12:13] op_sel_hi:[1,0,0]
  v_pk_fma_f32 v[142:143], v[142:143], v[14:15], v[12:13] op_sel_hi:[1,0,0]
  v_pk_fma_f32 v[144:145], v[144:145], v[14:15], v[12:13] op_sel_hi:[1,0,0]
  v_pk_fma_f32 v[146:147], v[146:147], v[14:15], v[12:13] op_sel_hi:[1,0,0]
  v_pk_fma_f32 v[148:149], v[148:149], v[14:15], v[12:13] op_sel_hi:[1,0,0]
  v_pk_fma_f32 v[150:151], v[150:151], v[14:15], v[12:13] op_sel_hi:[1,0,0]
  v_pk_fma_f32 v[152:153], v[152:153], v[14:15], v[12:13] op_sel_hi:[1,0,0]
  v_pk_fma_f32 v[154:155], v[154:155], v[14:15], v[12:13] op_sel_hi:[1,0,0]
  v_pk_fma_f32 v[156:157], v[156:157], v[14:15], v[12:13] op_sel_hi:[1,0,0]
  v_pk_fma_f32 v[158:159], v[158:159], v[14:15], v[12:13] op_sel_hi:[1,0,0]
  v_pk_fma_f32 v[48:49], v[32:33], v[32:33], s[20:21] neg_lo:[1,0,1] neg_hi:[1,0,1]
  v_pk_fma_f32 v[50:51], v[34:35], v[34:35], s[20:21] neg_lo:[1,0,1] neg_hi:[1,0,1]
  v_pk_fma_f32 v[52:53], v[36:37], v[36:37], s[20:21] neg_lo:[1,0,1] neg_hi:[1,0,1]
  v_pk_fma_f32 v[54:55], v[38:39], v[38:39], s[20:21] neg_lo:[1,0,1] neg_hi:[1,0,1]
  v_pk_fma_f32 v[56:57], v[40:41], v[40:41], s[20:21] neg_lo:[1,0,1] neg_hi:[1,0,1]
  v_pk_fma_f32 v[58:59], v[42:43], v[42:43], s[20:21] neg_lo:[1,0,1] neg_hi:[1,0,1]
  v_pk_fma_f32 v[60:61], v[44:45], v[44:45], s[20:21] neg_lo:[1,0,1] neg_hi:[1,0,1]
  v_pk_fma_f32 v[62:63], v[46:47], v[46:47], s[20:21] neg_lo:[1,0,1] neg_hi:[1,0,1]
  v_pk_mul_f32 v[48:49], v[32:33], v[48:49]
  v_pk_mul_f32 v[50:51], v[34:35], v[50:51]
  v_pk_mul_f32 v[52:53], v[36:37], v[52:53]
  v_pk_mul_f32 v[54:55], v[38:39], v[54:55]
  v_pk_mul_f32 v[56:57], v[40:41], v[56:57]
  v_cvt_pk_bf16_f32 v184, v16, v17
  v_cvt_pk_bf16_f32 v185, v18, v19
  v_cvt_pk_bf16_f32 v186, v20, v21
  v_cvt_pk_bf16_f32 v187, v22, v23
  v_pk_mul_f32 v[58:59], v[42:43], v[58:59]
  v_pk_mul_f32 v[60:61], v[44:45], v[60:61]
  v_pk_mul_f32 v[62:63], v[46:47], v[62:63]
  v_mfma_f32_32x32x16_bf16 v[64:79], v[192:195], v[184:187], v[64:79]
  ds_read_b128 v[216:219], v0 offset:18432
  ds_read_b128 v[220:223], v0 offset:19456
  v_cvt_pk_bf16_f32 v188, v24, v25
  v_cvt_pk_bf16_f32 v189, v26, v27
  v_cvt_pk_bf16_f32 v190, v28, v29
  v_cvt_pk_bf16_f32 v191, v30, v31
  v_exp_f32_e64 v48, v48
  v_cndmask_b32 v159, v159, v250, s[12:13]
  v_mfma_f32_32x32x16_bf16 v[80:95], v[196:199], v[184:187], v[80:95]
  ds_read_b128 v[224:227], v0 offset:20480
  ds_read_b128 v[228:231], v0 offset:21504
  v_exp_f32_e64 v49, v49
  v_cvt_pk_bf16_f32 v160, v112, v113
  v_cvt_pk_bf16_f32 v161, v114, v115
  v_exp_f32_e64 v50, v50
  v_cvt_pk_bf16_f32 v162, v116, v117
  v_mfma_f32_32x32x16_bf16 v[96:111], v[200:203], v[184:187], v[96:111]
  ds_read_b128 v[232:235], v0 offset:22528
  ds_read_b128 v[236:239], v0 offset:23552
  v_exp_f32_e64 v51, v51
  v_cvt_pk_bf16_f32 v163, v118, v119
  v_cvt_pk_bf16_f32 v164, v120, v121
  v_exp_f32_e64 v52, v52
  v_cvt_pk_bf16_f32 v165, v122, v123
  v_mfma_f32_32x32x16_bf16 v[64:79], v[204:207], v[188:191], v[64:79]
  v_exp_f32_e64 v53, v53
  v_cvt_pk_bf16_f32 v166, v124, v125
  v_cvt_pk_bf16_f32 v167, v126, v127
  v_exp_f32_e64 v54, v54
  v_cvt_pk_bf16_f32 v168, v128, v129
  v_exp_f32_e64 v55, v55
  v_cvt_pk_bf16_f32 v169, v130, v131
  v_cvt_pk_bf16_f32 v170, v132, v133
  v_mfma_f32_32x32x16_bf16 v[80:95], v[208:211], v[188:191], v[80:95]
  v_exp_f32_e64 v56, v56
  v_cvt_pk_bf16_f32 v171, v134, v135
  v_cvt_pk_bf16_f32 v172, v136, v137
  v_exp_f32_e64 v57, v57
  v_cvt_pk_bf16_f32 v173, v138, v139
  v_exp_f32_e64 v58, v58
  v_cvt_pk_bf16_f32 v174, v140, v141
  v_cvt_pk_bf16_f32 v175, v142, v143
  v_mfma_f32_32x32x16_bf16 v[96:111], v[212:215], v[188:191], v[96:111]
  s_waitcnt lgkmcnt(0)
  v_exp_f32 v59, v59
  v_cvt_pk_bf16_f32 v176, v144, v145
  v_exp_f32_e64 v60, v60
  v_cvt_pk_bf16_f32 v177, v146, v147
  v_cvt_pk_bf16_f32 v178, v148, v149
  v_exp_f32_e64 v61, v61
  v_cvt_pk_bf16_f32 v179, v150, v151
  v_exp_f32_e64 v62, v62
  v_cvt_pk_bf16_f32 v180, v152, v153
  v_cvt_pk_bf16_f32 v181, v154, v155
  v_exp_f32_e64 v63, v63
  v_cvt_pk_bf16_f32 v182, v156, v157
  v_cvt_pk_bf16_f32 v183, v158, v159
  v_pk_fma_f32 v[48:49], v[48:49], s[22:23], s[22:23]
  v_pk_fma_f32 v[50:51], v[50:51], s[22:23], s[22:23]
  v_pk_fma_f32 v[52:53], v[52:53], s[22:23], s[22:23]
  v_pk_fma_f32 v[54:55], v[54:55], s[22:23], s[22:23]
  v_pk_fma_f32 v[56:57], v[56:57], s[22:23], s[22:23]
  v_pk_fma_f32 v[58:59], v[58:59], s[22:23], s[22:23]
  v_pk_fma_f32 v[60:61], v[60:61], s[22:23], s[22:23]
  v_pk_fma_f32 v[62:63], v[62:63], s[22:23], s[22:23]
  s_sub_u32 s26, s26, 1
  s_cmp_lg_u32 s26, 0
  s_waitcnt vmcnt(4)
  s_cbranch_scc1 S_loop
  v_mfma_f32_32x32x16_bf16 v[16:31], v[216:219], v[160:163], 0
  ds_read_b128 v[192:195], v1 offset:2048
  ds_read_b128 v[196:199], v1 offset:3072
  ds_read_b128 v[200:203], v1 offset:4096
  v_rcp_f32 v48, v48
  v_rcp_f32 v49, v49
  v_mfma_f32_32x32x16_bf16 v[16:31], v[220:223], v[164:167], v[16:31]
  ds_read_b128 v[204:207], v1 offset:5120
  ds_read_b128 v[208:211], v1 offset:6144
  ds_read_b128 v[212:215], v1 offset:7168
  v_rcp_f32 v50, v50
  v_rcp_f32 v51, v51
  v_mfma_f32_32x32x16_bf16 v[16:31], v[224:227], v[168:171], v[16:31]
  ds_read_b128 v[136:139], v5
  ds_read_b128 v[140:143], v5 offset:32
  ds_read_b128 v[144:147], v5 offset:64
  v_rcp_f32 v52, v52
  v_rcp_f32 v53, v53
  v_mfma_f32_32x32x16_bf16 v[16:31], v[228:231], v[172:175], v[16:31]
  ds_read_b128 v[148:151], v5 offset:96
  ds_read_b128 v[152:155], v5 offset:128
  ds_read_b128 v[156:159], v5 offset:160
  v_rcp_f32 v54, v54
  v_rcp_f32 v55, v55
  v_mfma_f32_32x32x16_bf16 v[16:31], v[232:235], v[176:179], v[16:31]
  v_rcp_f32 v56, v56
  v_rcp_f32 v57, v57
  v_rcp_f32_e64 v58, v58
  v_mfma_f32_32x32x16_bf16 v[16:31], v[236:239], v[180:183], v[16:31]
  s_waitcnt lgkmcnt(0)
  v_rcp_f32 v59, v59
  v_rcp_f32 v60, v60
  v_rcp_f32 v61, v61
  v_rcp_f32 v62, v62
  v_rcp_f32 v63, v63
  v_pk_mul_f32 v[32:33], v[32:33], v[48:49]
  v_pk_mul_f32 v[34:35], v[34:35], v[50:51]
  v_pk_mul_f32 v[36:37], v[36:37], v[52:53]
  v_pk_mul_f32 v[38:39], v[38:39], v[54:55]
  v_pk_mul_f32 v[40:41], v[40:41], v[56:57]
  v_pk_mul_f32 v[42:43], v[42:43], v[58:59]
  v_pk_mul_f32 v[44:45], v[44:45], v[60:61]
  v_pk_mul_f32 v[46:47], v[46:47], v[62:63]
  v_pk_fma_f32 v[48:49], v[16:17], v[16:17], s[20:21] neg_lo:[1,0,1] neg_hi:[1,0,1]
  v_pk_fma_f32 v[50:51], v[18:19], v[18:19], s[20:21] neg_lo:[1,0,1] neg_hi:[1,0,1]
  v_pk_fma_f32 v[52:53], v[20:21], v[20:21], s[20:21] neg_lo:[1,0,1] neg_hi:[1,0,1]
  v_pk_fma_f32 v[54:55], v[22:23], v[22:23], s[20:21] neg_lo:[1,0,1] neg_hi:[1,0,1]
  v_pk_fma_f32 v[56:57], v[24:25], v[24:25], s[20:21] neg_lo:[1,0,1] neg_hi:[1,0,1]
  v_pk_fma_f32 v[58:59], v[26:27], v[26:27], s[20:21] neg_lo:[1,0,1] neg_hi:[1,0,1]
  v_pk_fma_f32 v[60:61], v[28:29], v[28:29], s[20:21] neg_lo:[1,0,1] neg_hi:[1,0,1]
  v_pk_fma_f32 v[62:63], v[30:31], v[30:31], s[20:21] neg_lo:[1,0,1] neg_hi:[1,0,1]
  v_pk_mul_f32 v[48:49], v[16:17], v[48:49]
  v_pk_mul_f32 v[50:51], v[18:19], v[50:51]
  v_pk_mul_f32 v[52:53], v[20:21], v[52:53]
  v_pk_mul_f32 v[54:55], v[22:23], v[54:55]
  v_pk_mul_f32 v[56:57], v[24:25], v[56:57]
  v_cvt_pk_bf16_f32 v184, v32, v33
  v_cvt_pk_bf16_f32 v185, v34, v35
  v_cvt_pk_bf16_f32 v186, v36, v37
  v_cvt_pk_bf16_f32 v187, v38, v39
  v_pk_mul_f32 v[58:59], v[26:27], v[58:59]
  v_pk_mul_f32 v[60:61], v[28:29], v[60:61]
  v_pk_mul_f32 v[62:63], v[30:31], v[62:63]
  v_mfma_f32_32x32x16_bf16 v[64:79], v[192:195], v[184:187], v[64:79]
  v_cvt_pk_bf16_f32 v188, v40, v41
  v_cvt_pk_bf16_f32 v189, v42, v43
  v_cvt_pk_bf16_f32 v190, v44, v45
  v_cvt_pk_bf16_f32 v191, v46, v47
  v_exp_f32_e64 v48, v48
  v_mfma_f32_32x32x16_bf16 v[80:95], v[196:199], v[184:187], v[80:95]
  v_exp_f32 v49, v49
  v_exp_f32 v50, v50
  v_exp_f32_e64 v51, v51
  v_mfma_f32_32x32x16_bf16 v[96:111], v[200:203], v[184:187], v[96:111]
  v_exp_f32 v52, v52
  v_exp_f32 v53, v53
  v_exp_f32_e64 v54, v54
  v_mfma_f32_32x32x16_bf16 v[64:79], v[204:207], v[188:191], v[64:79]
  v_exp_f32 v55, v55
  v_exp_f32 v56, v56
  v_exp_f32_e64 v57, v57
  v_mfma_f32_32x32x16_bf16 v[80:95], v[208:211], v[188:191], v[80:95]
  v_exp_f32_e64 v58, v58
  v_exp_f32_e64 v59, v59
  v_exp_f32_e64 v60, v60
  v_mfma_f32_32x32x16_bf16 v[96:111], v[212:215], v[188:191], v[96:111]
  v_exp_f32_e64 v61, v61
  v_exp_f32_e64 v62, v62
  v_exp_f32_e64 v63, v63
  v_pk_fma_f32 v[48:49], v[48:49], s[22:23], s[22:23]
  v_pk_fma_f32 v[50:51], v[50:51], s[22:23], s[22:23]
  v_pk_fma_f32 v[52:53], v[52:53], s[22:23], s[22:23]
  v_pk_fma_f32 v[54:55], v[54:55], s[22:23], s[22:23]
  v_pk_fma_f32 v[56:57], v[56:57], s[22:23], s[22:23]
  v_pk_fma_f32 v[58:59], v[58:59], s[22:23], s[22:23]
  v_pk_fma_f32 v[60:61], v[60:61], s[22:23], s[22:23]
  v_pk_fma_f32 v[62:63], v[62:63], s[22:23], s[22:23]
  v_mfma_f32_32x32x16_bf16 v[32:47], a[0:3], v[160:163], 0
  v_cvt_pk_bf16_f32 v112, v64, v65
  v_cvt_pk_bf16_f32 v113, v66, v67
  v_cvt_pk_bf16_f32 v114, v68, v69
  v_cvt_pk_bf16_f32 v115, v70, v71
  v_cvt_pk_bf16_f32 v116, v72, v73
  v_cvt_pk_bf16_f32 v117, v74, v75
  v_mfma_f32_32x32x16_bf16 v[32:47], a[4:7], v[164:167], v[32:47]
  v_cvt_pk_bf16_f32 v118, v76, v77
  v_cvt_pk_bf16_f32 v119, v78, v79
  v_cvt_pk_bf16_f32 v120, v80, v81
  v_cvt_pk_bf16_f32 v121, v82, v83
  v_cvt_pk_bf16_f32 v122, v84, v85
  v_cvt_pk_bf16_f32 v123, v86, v87
  v_mfma_f32_32x32x16_bf16 v[32:47], a[8:11], v[168:171], v[32:47]
  ds_read_b128 v[64:67], v2
  ds_read_b128 v[68:71], v2 offset:32
  ds_read_b128 v[72:75], v2 offset:64
  ds_read_b128 v[76:79], v2 offset:96
  v_cvt_pk_bf16_f32 v124, v88, v89
  v_cvt_pk_bf16_f32 v125, v90, v91
  v_mfma_f32_32x32x16_bf16 v[32:47], a[12:15], v[172:175], v[32:47]
  ds_read_b128 v[192:195], v1 offset:8192
  ds_read_b128 v[196:199], v1 offset:9216
  v_cvt_pk_bf16_f32 v126, v92, v93
  v_cvt_pk_bf16_f32 v127, v94, v95
  v_cvt_pk_bf16_f32 v128, v96, v97
  v_cvt_pk_bf16_f32 v129, v98, v99
  v_mfma_f32_32x32x16_bf16 v[32:47], a[16:19], v[176:179], v[32:47]
  ds_read_b128 v[80:83], v2 offset:128
  ds_read_b128 v[84:87], v2 offset:160
  ds_read_b128 v[88:91], v2 offset:192
  ds_read_b128 v[92:95], v2 offset:224
  v_cvt_pk_bf16_f32 v130, v100, v101
  v_cvt_pk_bf16_f32 v131, v102, v103
  v_mfma_f32_32x32x16_bf16 v[32:47], a[20:23], v[180:183], v[32:47]
  s_waitcnt lgkmcnt(6)
  ds_read_b128 v[200:203], v1 offset:10240
  ds_read_b128 v[204:207], v1 offset:11264
  v_cvt_pk_bf16_f32 v132, v104, v105
  v_cvt_pk_bf16_f32 v133, v106, v107
  v_cvt_pk_bf16_f32 v134, v108, v109
  v_cvt_pk_bf16_f32 v135, v110, v111
  v_mfma_f32_32x32x16_bf16 v[64:79], v[240:243], v[136:139], v[64:79]
  s_nop 0
  ds_read_b128 v[96:99], v2 offset:256
  ds_read_b128 v[100:103], v2 offset:288
  ds_read_b128 v[104:107], v2 offset:320
  ds_read_b128 v[108:111], v2 offset:352
  v_rcp_f32 v48, v48
  v_mfma_f32_32x32x16_bf16 v[64:79], v[244:247], v[140:143], v[64:79]
  s_waitcnt lgkmcnt(6)
  ds_read_b128 v[208:211], v1 offset:12288
  ds_read_b128 v[212:215], v1 offset:13312
  v_rcp_f32 v49, v49
  v_rcp_f32 v50, v50
  v_mfma_f32_32x32x16_bf16 v[80:95], v[240:243], v[144:147], v[80:95]
  v_rcp_f32 v51, v51
  v_rcp_f32 v52, v52
  v_rcp_f32_e64 v53, v53
  v_mfma_f32_32x32x16_bf16 v[80:95], v[244:247], v[148:151], v[80:95]
  s_waitcnt lgkmcnt(2)
  v_rcp_f32 v54, v54
  v_rcp_f32 v55, v55
  v_rcp_f32 v56, v56
  v_mfma_f32_32x32x16_bf16 v[96:111], v[240:243], v[152:155], v[96:111]
  v_rcp_f32 v57, v57
  v_rcp_f32 v58, v58
  v_rcp_f32_e64 v59, v59
  v_mfma_f32_32x32x16_bf16 v[96:111], v[244:247], v[156:159], v[96:111]
  s_waitcnt lgkmcnt(0)
  v_rcp_f32 v60, v60
  v_rcp_f32 v61, v61
  v_rcp_f32 v62, v62
  v_rcp_f32_e64 v63, v63
  v_pk_mul_f32 v[16:17], v[16:17], v[48:49]
  v_pk_mul_f32 v[18:19], v[18:19], v[50:51]
  v_pk_mul_f32 v[20:21], v[20:21], v[52:53]
  v_pk_mul_f32 v[22:23], v[22:23], v[54:55]
  v_pk_mul_f32 v[24:25], v[24:25], v[56:57]
  v_pk_mul_f32 v[26:27], v[26:27], v[58:59]
  v_pk_mul_f32 v[28:29], v[28:29], v[60:61]
  v_pk_mul_f32 v[30:31], v[30:31], v[62:63]
  v_pk_fma_f32 v[48:49], v[32:33], v[32:33], s[20:21] neg_lo:[1,0,1] neg_hi:[1,0,1]
  v_pk_fma_f32 v[50:51], v[34:35], v[34:35], s[20:21] neg_lo:[1,0,1] neg_hi:[1,0,1]
  v_pk_fma_f32 v[52:53], v[36:37], v[36:37], s[20:21] neg_lo:[1,0,1] neg_hi:[1,0,1]
  v_pk_fma_f32 v[54:55], v[38:39], v[38:39], s[20:21] neg_lo:[1,0,1] neg_hi:[1,0,1]
  v_pk_fma_f32 v[56:57], v[40:41], v[40:41], s[20:21] neg_lo:[1,0,1] neg_hi:[1,0,1]
  v_pk_fma_f32 v[58:59], v[42:43], v[42:43], s[20:21] neg_lo:[1,0,1] neg_hi:[1,0,1]
  v_pk_fma_f32 v[60:61], v[44:45], v[44:45], s[20:21] neg_lo:[1,0,1] neg_hi:[1,0,1]
  v_pk_fma_f32 v[62:63], v[46:47], v[46:47], s[20:21] neg_lo:[1,0,1] neg_hi:[1,0,1]
  v_pk_mul_f32 v[48:49], v[32:33], v[48:49]
  v_pk_mul_f32 v[50:51], v[34:35], v[50:51]
  v_pk_mul_f32 v[52:53], v[36:37], v[52:53]
  v_pk_mul_f32 v[54:55], v[38:39], v[54:55]
  v_pk_mul_f32 v[56:57], v[40:41], v[56:57]
  v_cvt_pk_bf16_f32 v184, v16, v17
  v_cvt_pk_bf16_f32 v185, v18, v19
  v_cvt_pk_bf16_f32 v186, v20, v21
  v_cvt_pk_bf16_f32 v187, v22, v23
  v_pk_mul_f32 v[58:59], v[42:43], v[58:59]
  v_pk_mul_f32 v[60:61], v[44:45], v[60:61]
  v_pk_mul_f32 v[62:63], v[46:47], v[62:63]
  v_mfma_f32_32x32x16_bf16 v[64:79], v[192:195], v[184:187], v[64:79]
  v_cvt_pk_bf16_f32 v188, v24, v25
  v_cvt_pk_bf16_f32 v189, v26, v27
  v_cvt_pk_bf16_f32 v190, v28, v29
  v_cvt_pk_bf16_f32 v191, v30, v31
  v_exp_f32_e64 v48, v48
  v_mfma_f32_32x32x16_bf16 v[80:95], v[196:199], v[184:187], v[80:95]
  v_exp_f32 v49, v49
  v_exp_f32 v50, v50
  v_exp_f32_e64 v51, v51
  v_mfma_f32_32x32x16_bf16 v[96:111], v[200:203], v[184:187], v[96:111]
  v_exp_f32 v52, v52
  v_exp_f32 v53, v53
  v_exp_f32_e64 v54, v54
  v_mfma_f32_32x32x16_bf16 v[64:79], v[204:207], v[188:191], v[64:79]
  v_exp_f32 v55, v55
  v_exp_f32 v56, v56
  v_exp_f32_e64 v57, v57
  v_mfma_f32_32x32x16_bf16 v[80:95], v[208:211], v[188:191], v[80:95]
  v_exp_f32 v58, v58
  v_exp_f32 v59, v59
  v_exp_f32_e64 v60, v60
  v_mfma_f32_32x32x16_bf16 v[96:111], v[212:215], v[188:191], v[96:111]
  v_exp_f32 v61, v61
  v_exp_f32 v62, v62
  v_exp_f32_e64 v63, v63
  v_pk_fma_f32 v[48:49], v[48:49], s[22:23], s[22:23]
  v_pk_fma_f32 v[50:51], v[50:51], s[22:23], s[22:23]
  v_pk_fma_f32 v[52:53], v[52:53], s[22:23], s[22:23]
  v_pk_fma_f32 v[54:55], v[54:55], s[22:23], s[22:23]
  v_pk_fma_f32 v[56:57], v[56:57], s[22:23], s[22:23]
  v_pk_fma_f32 v[58:59], v[58:59], s[22:23], s[22:23]
  v_pk_fma_f32 v[60:61], v[60:61], s[22:23], s[22:23]
  v_pk_fma_f32 v[62:63], v[62:63], s[22:23], s[22:23]
  v_mfma_f32_32x32x16_bf16 v[16:31], a[24:27], v[160:163], 0
  ds_read_b128 v[192:195], v1 offset:14336
  ds_read_b128 v[196:199], v1 offset:15360
  v_rcp_f32 v48, v48
  v_rcp_f32 v49, v49
  v_mfma_f32_32x32x16_bf16 v[16:31], a[28:31], v[164:167], v[16:31]
  ds_read_b128 v[200:203], v1 offset:16384
  ds_read_b128 v[204:207], v1 offset:17408
  v_rcp_f32 v50, v50
  v_rcp_f32 v51, v51
  v_mfma_f32_32x32x16_bf16 v[16:31], a[32:35], v[168:171], v[16:31]
  ds_read_b128 v[208:211], v1 offset:18432
  ds_read_b128 v[212:215], v1 offset:19456
  v_rcp_f32 v52, v52
  v_rcp_f32 v53, v53
  v_mfma_f32_32x32x16_bf16 v[16:31], a[36:39], v[172:175], v[16:31]
  buffer_store_dwordx4 v[112:115], v10, s[8:11], s28 offen
  v_rcp_f32 v54, v54
  v_rcp_f32 v55, v55
  v_mfma_f32_32x32x16_bf16 v[16:31], a[40:43], v[176:179], v[16:31]
  v_rcp_f32 v56, v56
  v_rcp_f32 v57, v57
  v_rcp_f32_e64 v58, v58
  v_mfma_f32_32x32x16_bf16 v[16:31], a[44:47], v[180:183], v[16:31]
  s_waitcnt lgkmcnt(0)
  v_rcp_f32 v59, v59
  v_rcp_f32 v60, v60
  v_rcp_f32 v61, v61
  v_rcp_f32 v62, v62
  v_rcp_f32 v63, v63
  v_pk_mul_f32 v[32:33], v[32:33], v[48:49]
  v_pk_mul_f32 v[34:35], v[34:35], v[50:51]
  v_pk_mul_f32 v[36:37], v[36:37], v[52:53]
  v_pk_mul_f32 v[38:39], v[38:39], v[54:55]
  v_pk_mul_f32 v[40:41], v[40:41], v[56:57]
  v_pk_mul_f32 v[42:43], v[42:43], v[58:59]
  v_pk_mul_f32 v[44:45], v[44:45], v[60:61]
  v_pk_mul_f32 v[46:47], v[46:47], v[62:63]
  v_pk_fma_f32 v[48:49], v[16:17], v[16:17], s[20:21] neg_lo:[1,0,1] neg_hi:[1,0,1]
  v_pk_fma_f32 v[50:51], v[18:19], v[18:19], s[20:21] neg_lo:[1,0,1] neg_hi:[1,0,1]
  v_pk_fma_f32 v[52:53], v[20:21], v[20:21], s[20:21] neg_lo:[1,0,1] neg_hi:[1,0,1]
  v_pk_fma_f32 v[54:55], v[22:23], v[22:23], s[20:21] neg_lo:[1,0,1] neg_hi:[1,0,1]
  v_pk_fma_f32 v[56:57], v[24:25], v[24:25], s[20:21] neg_lo:[1,0,1] neg_hi:[1,0,1]
  v_pk_fma_f32 v[58:59], v[26:27], v[26:27], s[20:21] neg_lo:[1,0,1] neg_hi:[1,0,1]
  v_pk_fma_f32 v[60:61], v[28:29], v[28:29], s[20:21] neg_lo:[1,0,1] neg_hi:[1,0,1]
  v_pk_fma_f32 v[62:63], v[30:31], v[30:31], s[20:21] neg_lo:[1,0,1] neg_hi:[1,0,1]
  v_pk_mul_f32 v[48:49], v[16:17], v[48:49]
  v_pk_mul_f32 v[50:51], v[18:19], v[50:51]
  v_pk_mul_f32 v[52:53], v[20:21], v[52:53]
  v_pk_mul_f32 v[54:55], v[22:23], v[54:55]
  v_pk_mul_f32 v[56:57], v[24:25], v[56:57]
  v_cvt_pk_bf16_f32 v184, v32, v33
  v_cvt_pk_bf16_f32 v185, v34, v35
  v_cvt_pk_bf16_f32 v186, v36, v37
  v_cvt_pk_bf16_f32 v187, v38, v39
  v_pk_mul_f32 v[58:59], v[26:27], v[58:59]
  v_pk_mul_f32 v[60:61], v[28:29], v[60:61]
  v_pk_mul_f32 v[62:63], v[30:31], v[62:63]
  v_mfma_f32_32x32x16_bf16 v[64:79], v[192:195], v[184:187], v[64:79]
  v_cvt_pk_bf16_f32 v188, v40, v41
  v_cvt_pk_bf16_f32 v189, v42, v43
  v_cvt_pk_bf16_f32 v190, v44, v45
  v_cvt_pk_bf16_f32 v191, v46, v47
  v_exp_f32_e64 v48, v48
  v_mfma_f32_32x32x16_bf16 v[80:95], v[196:199], v[184:187], v[80:95]
  v_exp_f32 v49, v49
  v_exp_f32 v50, v50
  v_exp_f32_e64 v51, v51
  v_mfma_f32_32x32x16_bf16 v[96:111], v[200:203], v[184:187], v[96:111]
  v_exp_f32 v52, v52
  v_exp_f32 v53, v53
  v_exp_f32_e64 v54, v54
  v_mfma_f32_32x32x16_bf16 v[64:79], v[204:207], v[188:191], v[64:79]
  v_exp_f32 v55, v55
  v_exp_f32 v56, v56
  v_exp_f32_e64 v57, v57
  v_mfma_f32_32x32x16_bf16 v[80:95], v[208:211], v[188:191], v[80:95]
  v_exp_f32 v58, v58
  v_exp_f32 v59, v59
  v_exp_f32_e64 v60, v60
  v_mfma_f32_32x32x16_bf16 v[96:111], v[212:215], v[188:191], v[96:111]
  v_exp_f32 v61, v61
  v_exp_f32 v62, v62
  v_exp_f32_e64 v63, v63
  v_pk_fma_f32 v[48:49], v[48:49], s[22:23], s[22:23]
  v_pk_fma_f32 v[50:51], v[50:51], s[22:23], s[22:23]
  v_pk_fma_f32 v[52:53], v[52:53], s[22:23], s[22:23]
  v_pk_fma_f32 v[54:55], v[54:55], s[22:23], s[22:23]
  v_pk_fma_f32 v[56:57], v[56:57], s[22:23], s[22:23]
  v_pk_fma_f32 v[58:59], v[58:59], s[22:23], s[22:23]
  v_pk_fma_f32 v[60:61], v[60:61], s[22:23], s[22:23]
  v_pk_fma_f32 v[62:63], v[62:63], s[22:23], s[22:23]
  v_mfma_f32_32x32x16_bf16 v[32:47], a[48:51], v[160:163], 0
  ds_read_b128 v[192:195], v1 offset:20480
  ds_read_b128 v[196:199], v1 offset:21504
  v_rcp_f32 v48, v48
  v_rcp_f32 v49, v49
  v_mfma_f32_32x32x16_bf16 v[32:47], a[52:55], v[164:167], v[32:47]
  ds_read_b128 v[200:203], v1 offset:22528
  ds_read_b128 v[204:207], v1 offset:23552
  v_rcp_f32 v50, v50
  v_rcp_f32 v51, v51
  v_mfma_f32_32x32x16_bf16 v[32:47], a[56:59], v[168:171], v[32:47]
  ds_read_b128 v[208:211], v1 offset:24576
  ds_read_b128 v[212:215], v1 offset:25600
  v_rcp_f32 v52, v52
  v_rcp_f32 v53, v53
  v_mfma_f32_32x32x16_bf16 v[32:47], a[60:63], v[172:175], v[32:47]
  buffer_store_dwordx4 v[116:119], v10, s[8:11], s28 offen offset:32
  v_rcp_f32 v54, v54
  v_rcp_f32 v55, v55
  v_mfma_f32_32x32x16_bf16 v[32:47], a[64:67], v[176:179], v[32:47]
  v_rcp_f32 v56, v56
  v_rcp_f32 v57, v57
  v_rcp_f32_e64 v58, v58
  v_mfma_f32_32x32x16_bf16 v[32:47], a[68:71], v[180:183], v[32:47]
  s_waitcnt lgkmcnt(0)
  v_rcp_f32 v59, v59
  v_rcp_f32 v60, v60
  v_rcp_f32 v61, v61
  v_rcp_f32 v62, v62
  v_rcp_f32 v63, v63
  v_pk_mul_f32 v[16:17], v[16:17], v[48:49]
  v_pk_mul_f32 v[18:19], v[18:19], v[50:51]
  v_pk_mul_f32 v[20:21], v[20:21], v[52:53]
  v_pk_mul_f32 v[22:23], v[22:23], v[54:55]
  v_pk_mul_f32 v[24:25], v[24:25], v[56:57]
  v_pk_mul_f32 v[26:27], v[26:27], v[58:59]
  v_pk_mul_f32 v[28:29], v[28:29], v[60:61]
  v_pk_mul_f32 v[30:31], v[30:31], v[62:63]
  v_pk_fma_f32 v[48:49], v[32:33], v[32:33], s[20:21] neg_lo:[1,0,1] neg_hi:[1,0,1]
  v_pk_fma_f32 v[50:51], v[34:35], v[34:35], s[20:21] neg_lo:[1,0,1] neg_hi:[1,0,1]
  v_pk_fma_f32 v[52:53], v[36:37], v[36:37], s[20:21] neg_lo:[1,0,1] neg_hi:[1,0,1]
  v_pk_fma_f32 v[54:55], v[38:39], v[38:39], s[20:21] neg_lo:[1,0,1] neg_hi:[1,0,1]
  v_pk_fma_f32 v[56:57], v[40:41], v[40:41], s[20:21] neg_lo:[1,0,1] neg_hi:[1,0,1]
  v_pk_fma_f32 v[58:59], v[42:43], v[42:43], s[20:21] neg_lo:[1,0,1] neg_hi:[1,0,1]
  v_pk_fma_f32 v[60:61], v[44:45], v[44:45], s[20:21] neg_lo:[1,0,1] neg_hi:[1,0,1]
  v_pk_fma_f32 v[62:63], v[46:47], v[46:47], s[20:21] neg_lo:[1,0,1] neg_hi:[1,0,1]
  v_pk_mul_f32 v[48:49], v[32:33], v[48:49]
  v_pk_mul_f32 v[50:51], v[34:35], v[50:51]
  v_pk_mul_f32 v[52:53], v[36:37], v[52:53]
  v_pk_mul_f32 v[54:55], v[38:39], v[54:55]
  v_pk_mul_f32 v[56:57], v[40:41], v[56:57]
  v_cvt_pk_bf16_f32 v184, v16, v17
  v_cvt_pk_bf16_f32 v185, v18, v19
  v_cvt_pk_bf16_f32 v186, v20, v21
  v_cvt_pk_bf16_f32 v187, v22, v23
  v_pk_mul_f32 v[58:59], v[42:43], v[58:59]
  v_pk_mul_f32 v[60:61], v[44:45], v[60:61]
  v_pk_mul_f32 v[62:63], v[46:47], v[62:63]
  v_mfma_f32_32x32x16_bf16 v[64:79], v[192:195], v[184:187], v[64:79]
  v_cvt_pk_bf16_f32 v188, v24, v25
  v_cvt_pk_bf16_f32 v189, v26, v27
  v_cvt_pk_bf16_f32 v190, v28, v29
  v_cvt_pk_bf16_f32 v191, v30, v31
  v_exp_f32_e64 v48, v48
  v_mfma_f32_32x32x16_bf16 v[80:95], v[196:199], v[184:187], v[80:95]
  v_exp_f32 v49, v49
  v_exp_f32 v50, v50
  v_exp_f32_e64 v51, v51
  v_mfma_f32_32x32x16_bf16 v[96:111], v[200:203], v[184:187], v[96:111]
  v_exp_f32 v52, v52
  v_exp_f32 v53, v53
  v_exp_f32_e64 v54, v54
  v_mfma_f32_32x32x16_bf16 v[64:79], v[204:207], v[188:191], v[64:79]
  v_exp_f32 v55, v55
  v_exp_f32 v56, v56
  v_exp_f32_e64 v57, v57
  v_mfma_f32_32x32x16_bf16 v[80:95], v[208:211], v[188:191], v[80:95]
  v_exp_f32 v58, v58
  v_exp_f32 v59, v59
  v_exp_f32_e64 v60, v60
  v_mfma_f32_32x32x16_bf16 v[96:111], v[212:215], v[188:191], v[96:111]
  v_exp_f32 v61, v61
  v_exp_f32 v62, v62
  v_exp_f32_e64 v63, v63
  v_pk_fma_f32 v[48:49], v[48:49], s[22:23], s[22:23]
  v_pk_fma_f32 v[50:51], v[50:51], s[22:23], s[22:23]
  v_pk_fma_f32 v[52:53], v[52:53], s[22:23], s[22:23]
  v_pk_fma_f32 v[54:55], v[54:55], s[22:23], s[22:23]
  v_pk_fma_f32 v[56:57], v[56:57], s[22:23], s[22:23]
  v_pk_fma_f32 v[58:59], v[58:59], s[22:23], s[22:23]
  v_pk_fma_f32 v[60:61], v[60:61], s[22:23], s[22:23]
  v_pk_fma_f32 v[62:63], v[62:63], s[22:23], s[22:23]
  v_mfma_f32_32x32x16_bf16 v[16:31], a[72:75], v[160:163], 0
  ds_read_b128 v[192:195], v1 offset:26624
  ds_read_b128 v[196:199], v1 offset:27648
  v_rcp_f32 v48, v48
  v_rcp_f32 v49, v49
  v_mfma_f32_32x32x16_bf16 v[16:31], a[76:79], v[164:167], v[16:31]
  ds_read_b128 v[200:203], v1 offset:28672
  ds_read_b128 v[204:207], v1 offset:29696
  v_rcp_f32 v50, v50
  v_rcp_f32 v51, v51
  v_mfma_f32_32x32x16_bf16 v[16:31], a[80:83], v[168:171], v[16:31]
  ds_read_b128 v[208:211], v1 offset:30720
  ds_read_b128 v[212:215], v1 offset:31744
  v_rcp_f32 v52, v52
  v_rcp_f32 v53, v53
  v_mfma_f32_32x32x16_bf16 v[16:31], a[84:87], v[172:175], v[16:31]
  v_rcp_f32 v54, v54
  v_rcp_f32 v55, v55
  v_rcp_f32_e64 v56, v56
  v_mfma_f32_32x32x16_bf16 v[16:31], a[88:91], v[176:179], v[16:31]
  v_rcp_f32 v57, v57
  v_rcp_f32 v58, v58
  v_rcp_f32_e64 v59, v59
  v_mfma_f32_32x32x16_bf16 v[16:31], a[92:95], v[180:183], v[16:31]
  s_waitcnt lgkmcnt(0)
  v_rcp_f32 v60, v60
  v_rcp_f32 v61, v61
  v_rcp_f32 v62, v62
  v_rcp_f32_e64 v63, v63
  v_pk_mul_f32 v[32:33], v[32:33], v[48:49]
  v_pk_mul_f32 v[34:35], v[34:35], v[50:51]
  v_pk_mul_f32 v[36:37], v[36:37], v[52:53]
  v_pk_mul_f32 v[38:39], v[38:39], v[54:55]
  v_pk_mul_f32 v[40:41], v[40:41], v[56:57]
  v_pk_mul_f32 v[42:43], v[42:43], v[58:59]
  v_pk_mul_f32 v[44:45], v[44:45], v[60:61]
  v_pk_mul_f32 v[46:47], v[46:47], v[62:63]
  v_pk_fma_f32 v[48:49], v[16:17], v[16:17], s[20:21] neg_lo:[1,0,1] neg_hi:[1,0,1]
  v_pk_fma_f32 v[50:51], v[18:19], v[18:19], s[20:21] neg_lo:[1,0,1] neg_hi:[1,0,1]
  v_pk_fma_f32 v[52:53], v[20:21], v[20:21], s[20:21] neg_lo:[1,0,1] neg_hi:[1,0,1]
  v_pk_fma_f32 v[54:55], v[22:23], v[22:23], s[20:21] neg_lo:[1,0,1] neg_hi:[1,0,1]
  v_pk_fma_f32 v[56:57], v[24:25], v[24:25], s[20:21] neg_lo:[1,0,1] neg_hi:[1,0,1]
  v_pk_fma_f32 v[58:59], v[26:27], v[26:27], s[20:21] neg_lo:[1,0,1] neg_hi:[1,0,1]
  v_pk_fma_f32 v[60:61], v[28:29], v[28:29], s[20:21] neg_lo:[1,0,1] neg_hi:[1,0,1]
  v_pk_fma_f32 v[62:63], v[30:31], v[30:31], s[20:21] neg_lo:[1,0,1] neg_hi:[1,0,1]
  v_pk_mul_f32 v[48:49], v[16:17], v[48:49]
  v_pk_mul_f32 v[50:51], v[18:19], v[50:51]
  v_pk_mul_f32 v[52:53], v[20:21], v[52:53]
  v_pk_mul_f32 v[54:55], v[22:23], v[54:55]
  v_pk_mul_f32 v[56:57], v[24:25], v[56:57]
  v_cvt_pk_bf16_f32 v184, v32, v33
  v_cvt_pk_bf16_f32 v185, v34, v35
  v_cvt_pk_bf16_f32 v186, v36, v37
  v_cvt_pk_bf16_f32 v187, v38, v39
  v_pk_mul_f32 v[58:59], v[26:27], v[58:59]
  v_pk_mul_f32 v[60:61], v[28:29], v[60:61]
  v_pk_mul_f32 v[62:63], v[30:31], v[62:63]
  v_mfma_f32_32x32x16_bf16 v[64:79], v[192:195], v[184:187], v[64:79]
  v_cvt_pk_bf16_f32 v188, v40, v41
  v_cvt_pk_bf16_f32 v189, v42, v43
  v_cvt_pk_bf16_f32 v190, v44, v45
  v_cvt_pk_bf16_f32 v191, v46, v47
  v_exp_f32_e64 v48, v48
  v_mfma_f32_32x32x16_bf16 v[80:95], v[196:199], v[184:187], v[80:95]
  v_exp_f32 v49, v49
  v_exp_f32 v50, v50
  v_exp_f32_e64 v51, v51
  v_mfma_f32_32x32x16_bf16 v[96:111], v[200:203], v[184:187], v[96:111]
  v_exp_f32 v52, v52
  v_exp_f32 v53, v53
  v_exp_f32_e64 v54, v54
  v_mfma_f32_32x32x16_bf16 v[64:79], v[204:207], v[188:191], v[64:79]
  v_exp_f32 v55, v55
  v_exp_f32 v56, v56
  v_exp_f32_e64 v57, v57
  v_mfma_f32_32x32x16_bf16 v[80:95], v[208:211], v[188:191], v[80:95]
  v_exp_f32 v58, v58
  v_exp_f32 v59, v59
  v_exp_f32_e64 v60, v60
  v_mfma_f32_32x32x16_bf16 v[96:111], v[212:215], v[188:191], v[96:111]
  v_exp_f32 v61, v61
  v_exp_f32 v62, v62
  v_exp_f32_e64 v63, v63
  v_pk_fma_f32 v[48:49], v[48:49], s[22:23], s[22:23]
  v_pk_fma_f32 v[50:51], v[50:51], s[22:23], s[22:23]
  v_pk_fma_f32 v[52:53], v[52:53], s[22:23], s[22:23]
  v_pk_fma_f32 v[54:55], v[54:55], s[22:23], s[22:23]
  v_pk_fma_f32 v[56:57], v[56:57], s[22:23], s[22:23]
  v_pk_fma_f32 v[58:59], v[58:59], s[22:23], s[22:23]
  v_pk_fma_f32 v[60:61], v[60:61], s[22:23], s[22:23]
  v_pk_fma_f32 v[62:63], v[62:63], s[22:23], s[22:23]
  v_mfma_f32_32x32x16_bf16 v[32:47], a[96:99], v[160:163], 0
  ds_read_b128 v[192:195], v0 offset:24576
  ds_read_b128 v[196:199], v0 offset:25600
  v_rcp_f32 v48, v48
  v_rcp_f32 v49, v49
  v_mfma_f32_32x32x16_bf16 v[32:47], a[100:103], v[164:167], v[32:47]
  ds_read_b128 v[200:203], v0 offset:26624
  ds_read_b128 v[204:207], v0 offset:27648
  v_rcp_f32 v50, v50
  v_rcp_f32 v51, v51
  v_mfma_f32_32x32x16_bf16 v[32:47], a[104:107], v[168:171], v[32:47]
  ds_read_b128 v[208:211], v0 offset:28672
  ds_read_b128 v[212:215], v0 offset:29696
  v_rcp_f32 v52, v52
  v_rcp_f32 v53, v53
  v_mfma_f32_32x32x16_bf16 v[32:47], a[108:111], v[172:175], v[32:47]
  buffer_store_dwordx4 v[120:123], v10, s[8:11], s28 offen offset:64
  v_rcp_f32 v54, v54
  v_rcp_f32 v55, v55
  v_mfma_f32_32x32x16_bf16 v[32:47], a[112:115], v[176:179], v[32:47]
  v_rcp_f32 v56, v56
  v_rcp_f32 v57, v57
  v_rcp_f32_e64 v58, v58
  v_mfma_f32_32x32x16_bf16 v[32:47], a[116:119], v[180:183], v[32:47]
  s_waitcnt lgkmcnt(0)
  v_rcp_f32 v59, v59
  v_rcp_f32 v60, v60
  v_rcp_f32 v61, v61
  v_rcp_f32 v62, v62
  v_rcp_f32 v63, v63
  v_pk_mul_f32 v[16:17], v[16:17], v[48:49]
  v_pk_mul_f32 v[18:19], v[18:19], v[50:51]
  v_pk_mul_f32 v[20:21], v[20:21], v[52:53]
  v_pk_mul_f32 v[22:23], v[22:23], v[54:55]
  v_pk_mul_f32 v[24:25], v[24:25], v[56:57]
  v_pk_mul_f32 v[26:27], v[26:27], v[58:59]
  v_pk_mul_f32 v[28:29], v[28:29], v[60:61]
  v_pk_mul_f32 v[30:31], v[30:31], v[62:63]
  v_pk_fma_f32 v[48:49], v[32:33], v[32:33], s[20:21] neg_lo:[1,0,1] neg_hi:[1,0,1]
  v_pk_fma_f32 v[50:51], v[34:35], v[34:35], s[20:21] neg_lo:[1,0,1] neg_hi:[1,0,1]
  v_pk_fma_f32 v[52:53], v[36:37], v[36:37], s[20:21] neg_lo:[1,0,1] neg_hi:[1,0,1]
  v_pk_fma_f32 v[54:55], v[38:39], v[38:39], s[20:21] neg_lo:[1,0,1] neg_hi:[1,0,1]
  v_pk_fma_f32 v[56:57], v[40:41], v[40:41], s[20:21] neg_lo:[1,0,1] neg_hi:[1,0,1]
  v_pk_fma_f32 v[58:59], v[42:43], v[42:43], s[20:21] neg_lo:[1,0,1] neg_hi:[1,0,1]
  v_pk_fma_f32 v[60:61], v[44:45], v[44:45], s[20:21] neg_lo:[1,0,1] neg_hi:[1,0,1]
  v_pk_fma_f32 v[62:63], v[46:47], v[46:47], s[20:21] neg_lo:[1,0,1] neg_hi:[1,0,1]
  v_pk_mul_f32 v[48:49], v[32:33], v[48:49]
  v_pk_mul_f32 v[50:51], v[34:35], v[50:51]
  v_pk_mul_f32 v[52:53], v[36:37], v[52:53]
  v_pk_mul_f32 v[54:55], v[38:39], v[54:55]
  v_pk_mul_f32 v[56:57], v[40:41], v[56:57]
  v_cvt_pk_bf16_f32 v184, v16, v17
  v_cvt_pk_bf16_f32 v185, v18, v19
  v_cvt_pk_bf16_f32 v186, v20, v21
  v_cvt_pk_bf16_f32 v187, v22, v23
  v_pk_mul_f32 v[58:59], v[42:43], v[58:59]
  v_pk_mul_f32 v[60:61], v[44:45], v[60:61]
  v_pk_mul_f32 v[62:63], v[46:47], v[62:63]
  v_mfma_f32_32x32x16_bf16 v[64:79], v[192:195], v[184:187], v[64:79]
  v_cvt_pk_bf16_f32 v188, v24, v25
  v_cvt_pk_bf16_f32 v189, v26, v27
  v_cvt_pk_bf16_f32 v190, v28, v29
  v_cvt_pk_bf16_f32 v191, v30, v31
  v_exp_f32_e64 v48, v48
  v_mfma_f32_32x32x16_bf16 v[80:95], v[196:199], v[184:187], v[80:95]
  v_exp_f32 v49, v49
  v_exp_f32 v50, v50
  v_exp_f32_e64 v51, v51
  v_mfma_f32_32x32x16_bf16 v[96:111], v[200:203], v[184:187], v[96:111]
  v_exp_f32 v52, v52
  v_exp_f32 v53, v53
  v_exp_f32_e64 v54, v54
  v_mfma_f32_32x32x16_bf16 v[64:79], v[204:207], v[188:191], v[64:79]
  v_exp_f32 v55, v55
  v_exp_f32 v56, v56
  v_exp_f32_e64 v57, v57
  v_mfma_f32_32x32x16_bf16 v[80:95], v[208:211], v[188:191], v[80:95]
  v_exp_f32 v58, v58
  v_exp_f32 v59, v59
  v_exp_f32_e64 v60, v60
  v_mfma_f32_32x32x16_bf16 v[96:111], v[212:215], v[188:191], v[96:111]
  v_exp_f32 v61, v61
  v_exp_f32 v62, v62
  v_exp_f32_e64 v63, v63
  v_pk_fma_f32 v[48:49], v[48:49], s[22:23], s[22:23]
  v_pk_fma_f32 v[50:51], v[50:51], s[22:23], s[22:23]
  v_pk_fma_f32 v[52:53], v[52:53], s[22:23], s[22:23]
  v_pk_fma_f32 v[54:55], v[54:55], s[22:23], s[22:23]
  v_pk_fma_f32 v[56:57], v[56:57], s[22:23], s[22:23]
  v_pk_fma_f32 v[58:59], v[58:59], s[22:23], s[22:23]
  v_pk_fma_f32 v[60:61], v[60:61], s[22:23], s[22:23]
  v_pk_fma_f32 v[62:63], v[62:63], s[22:23], s[22:23]
  v_mfma_f32_32x32x16_bf16 v[16:31], a[120:123], v[160:163], 0
  ds_read_b128 v[192:195], v0 offset:30720
  ds_read_b128 v[196:199], v0 offset:31744
  v_rcp_f32 v48, v48
  v_rcp_f32 v49, v49
  v_mfma_f32_32x32x16_bf16 v[16:31], a[124:127], v[164:167], v[16:31]
  ds_read_b128 v[200:203], v0 offset:32768
  ds_read_b128 v[204:207], v0 offset:33792
  v_rcp_f32 v50, v50
  v_rcp_f32 v51, v51
  v_mfma_f32_32x32x16_bf16 v[16:31], a[128:131], v[168:171], v[16:31]
  ds_read_b128 v[208:211], v0 offset:34816
  ds_read_b128 v[212:215], v0 offset:35840
  v_rcp_f32 v52, v52
  v_rcp_f32 v53, v53
  v_mfma_f32_32x32x16_bf16 v[16:31], a[132:135], v[172:175], v[16:31]
  buffer_store_dwordx4 v[124:127], v10, s[8:11], s28 offen offset:96
  v_rcp_f32 v54, v54
  v_rcp_f32 v55, v55
  v_mfma_f32_32x32x16_bf16 v[16:31], a[136:139], v[176:179], v[16:31]
  v_rcp_f32 v56, v56
  v_rcp_f32 v57, v57
  v_rcp_f32_e64 v58, v58
  v_mfma_f32_32x32x16_bf16 v[16:31], a[140:143], v[180:183], v[16:31]
  s_waitcnt lgkmcnt(0)
  v_rcp_f32 v59, v59
  v_rcp_f32 v60, v60
  v_rcp_f32 v61, v61
  v_rcp_f32 v62, v62
  v_rcp_f32 v63, v63
  v_pk_mul_f32 v[32:33], v[32:33], v[48:49]
  v_pk_mul_f32 v[34:35], v[34:35], v[50:51]
  v_pk_mul_f32 v[36:37], v[36:37], v[52:53]
  v_pk_mul_f32 v[38:39], v[38:39], v[54:55]
  v_pk_mul_f32 v[40:41], v[40:41], v[56:57]
  v_pk_mul_f32 v[42:43], v[42:43], v[58:59]
  v_pk_mul_f32 v[44:45], v[44:45], v[60:61]
  v_pk_mul_f32 v[46:47], v[46:47], v[62:63]
  v_pk_fma_f32 v[48:49], v[16:17], v[16:17], s[20:21] neg_lo:[1,0,1] neg_hi:[1,0,1]
  v_pk_fma_f32 v[50:51], v[18:19], v[18:19], s[20:21] neg_lo:[1,0,1] neg_hi:[1,0,1]
  v_pk_fma_f32 v[52:53], v[20:21], v[20:21], s[20:21] neg_lo:[1,0,1] neg_hi:[1,0,1]
  v_pk_fma_f32 v[54:55], v[22:23], v[22:23], s[20:21] neg_lo:[1,0,1] neg_hi:[1,0,1]
  v_pk_fma_f32 v[56:57], v[24:25], v[24:25], s[20:21] neg_lo:[1,0,1] neg_hi:[1,0,1]
  v_pk_fma_f32 v[58:59], v[26:27], v[26:27], s[20:21] neg_lo:[1,0,1] neg_hi:[1,0,1]
  v_pk_fma_f32 v[60:61], v[28:29], v[28:29], s[20:21] neg_lo:[1,0,1] neg_hi:[1,0,1]
  v_pk_fma_f32 v[62:63], v[30:31], v[30:31], s[20:21] neg_lo:[1,0,1] neg_hi:[1,0,1]
  v_pk_mul_f32 v[48:49], v[16:17], v[48:49]
  v_pk_mul_f32 v[50:51], v[18:19], v[50:51]
  v_pk_mul_f32 v[52:53], v[20:21], v[52:53]
  v_pk_mul_f32 v[54:55], v[22:23], v[54:55]
  v_pk_mul_f32 v[56:57], v[24:25], v[56:57]
  v_cvt_pk_bf16_f32 v184, v32, v33
  v_cvt_pk_bf16_f32 v185, v34, v35
  v_cvt_pk_bf16_f32 v186, v36, v37
  v_cvt_pk_bf16_f32 v187, v38, v39
  v_pk_mul_f32 v[58:59], v[26:27], v[58:59]
  v_pk_mul_f32 v[60:61], v[28:29], v[60:61]
  v_pk_mul_f32 v[62:63], v[30:31], v[62:63]
  v_mfma_f32_32x32x16_bf16 v[64:79], v[192:195], v[184:187], v[64:79]
  v_cvt_pk_bf16_f32 v188, v40, v41
  v_cvt_pk_bf16_f32 v189, v42, v43
  v_cvt_pk_bf16_f32 v190, v44, v45
  v_cvt_pk_bf16_f32 v191, v46, v47
  v_exp_f32_e64 v48, v48
  v_mfma_f32_32x32x16_bf16 v[80:95], v[196:199], v[184:187], v[80:95]
  v_exp_f32 v49, v49
  v_exp_f32 v50, v50
  v_exp_f32_e64 v51, v51
  v_mfma_f32_32x32x16_bf16 v[96:111], v[200:203], v[184:187], v[96:111]
  v_exp_f32 v52, v52
  v_exp_f32 v53, v53
  v_exp_f32_e64 v54, v54
  v_mfma_f32_32x32x16_bf16 v[64:79], v[204:207], v[188:191], v[64:79]
  v_exp_f32 v55, v55
  v_exp_f32 v56, v56
  v_exp_f32_e64 v57, v57
  v_mfma_f32_32x32x16_bf16 v[80:95], v[208:211], v[188:191], v[80:95]
  v_exp_f32 v58, v58
  v_exp_f32 v59, v59
  v_exp_f32_e64 v60, v60
  v_mfma_f32_32x32x16_bf16 v[96:111], v[212:215], v[188:191], v[96:111]
  v_exp_f32 v61, v61
  v_exp_f32 v62, v62
  v_exp_f32_e64 v63, v63
  v_pk_fma_f32 v[48:49], v[48:49], s[22:23], s[22:23]
  v_pk_fma_f32 v[50:51], v[50:51], s[22:23], s[22:23]
  v_pk_fma_f32 v[52:53], v[52:53], s[22:23], s[22:23]
  v_pk_fma_f32 v[54:55], v[54:55], s[22:23], s[22:23]
  v_pk_fma_f32 v[56:57], v[56:57], s[22:23], s[22:23]
  v_pk_fma_f32 v[58:59], v[58:59], s[22:23], s[22:23]
  v_pk_fma_f32 v[60:61], v[60:61], s[22:23], s[22:23]
  v_pk_fma_f32 v[62:63], v[62:63], s[22:23], s[22:23]
  v_mfma_f32_32x32x16_bf16 v[32:47], a[144:147], v[160:163], 0
  ds_read_b128 v[192:195], v0 offset:36864
  ds_read_b128 v[196:199], v0 offset:37888
  v_rcp_f32 v48, v48
  v_rcp_f32 v49, v49
  v_mfma_f32_32x32x16_bf16 v[32:47], a[148:151], v[164:167], v[32:47]
  ds_read_b128 v[200:203], v0 offset:38912
  ds_read_b128 v[204:207], v0 offset:39936
  v_rcp_f32 v50, v50
  v_rcp_f32 v51, v51
  v_mfma_f32_32x32x16_bf16 v[32:47], a[152:155], v[168:171], v[32:47]
  ds_read_b128 v[208:211], v0 offset:40960
  ds_read_b128 v[212:215], v0 offset:41984
  v_rcp_f32 v52, v52
  v_rcp_f32 v53, v53
  v_mfma_f32_32x32x16_bf16 v[32:47], a[156:159], v[172:175], v[32:47]
  v_rcp_f32 v54, v54
  v_rcp_f32 v55, v55
  v_rcp_f32_e64 v56, v56
  v_mfma_f32_32x32x16_bf16 v[32:47], a[160:163], v[176:179], v[32:47]
  v_rcp_f32 v57, v57
  v_rcp_f32 v58, v58
  v_rcp_f32_e64 v59, v59
  v_mfma_f32_32x32x16_bf16 v[32:47], a[164:167], v[180:183], v[32:47]
  s_waitcnt lgkmcnt(0)
  v_rcp_f32 v60, v60
  v_rcp_f32 v61, v61
  v_rcp_f32 v62, v62
  v_rcp_f32_e64 v63, v63
  v_pk_mul_f32 v[16:17], v[16:17], v[48:49]
  v_pk_mul_f32 v[18:19], v[18:19], v[50:51]
  v_pk_mul_f32 v[20:21], v[20:21], v[52:53]
  v_pk_mul_f32 v[22:23], v[22:23], v[54:55]
  v_pk_mul_f32 v[24:25], v[24:25], v[56:57]
  v_pk_mul_f32 v[26:27], v[26:27], v[58:59]
  v_pk_mul_f32 v[28:29], v[28:29], v[60:61]
  v_pk_mul_f32 v[30:31], v[30:31], v[62:63]
  v_pk_fma_f32 v[48:49], v[32:33], v[32:33], s[20:21] neg_lo:[1,0,1] neg_hi:[1,0,1]
  v_pk_fma_f32 v[50:51], v[34:35], v[34:35], s[20:21] neg_lo:[1,0,1] neg_hi:[1,0,1]
  v_pk_fma_f32 v[52:53], v[36:37], v[36:37], s[20:21] neg_lo:[1,0,1] neg_hi:[1,0,1]
  v_pk_fma_f32 v[54:55], v[38:39], v[38:39], s[20:21] neg_lo:[1,0,1] neg_hi:[1,0,1]
  v_pk_fma_f32 v[56:57], v[40:41], v[40:41], s[20:21] neg_lo:[1,0,1] neg_hi:[1,0,1]
  v_pk_fma_f32 v[58:59], v[42:43], v[42:43], s[20:21] neg_lo:[1,0,1] neg_hi:[1,0,1]
  v_pk_fma_f32 v[60:61], v[44:45], v[44:45], s[20:21] neg_lo:[1,0,1] neg_hi:[1,0,1]
  v_pk_fma_f32 v[62:63], v[46:47], v[46:47], s[20:21] neg_lo:[1,0,1] neg_hi:[1,0,1]
  v_pk_mul_f32 v[48:49], v[32:33], v[48:49]
  v_pk_mul_f32 v[50:51], v[34:35], v[50:51]
  v_pk_mul_f32 v[52:53], v[36:37], v[52:53]
  v_pk_mul_f32 v[54:55], v[38:39], v[54:55]
  v_pk_mul_f32 v[56:57], v[40:41], v[56:57]
  v_cvt_pk_bf16_f32 v184, v16, v17
  v_cvt_pk_bf16_f32 v185, v18, v19
  v_cvt_pk_bf16_f32 v186, v20, v21
  v_cvt_pk_bf16_f32 v187, v22, v23
  v_pk_mul_f32 v[58:59], v[42:43], v[58:59]
  v_pk_mul_f32 v[60:61], v[44:45], v[60:61]
  v_pk_mul_f32 v[62:63], v[46:47], v[62:63]
  v_mfma_f32_32x32x16_bf16 v[64:79], v[192:195], v[184:187], v[64:79]
  v_cvt_pk_bf16_f32 v188, v24, v25
  v_cvt_pk_bf16_f32 v189, v26, v27
  v_cvt_pk_bf16_f32 v190, v28, v29
  v_cvt_pk_bf16_f32 v191, v30, v31
  v_exp_f32_e64 v48, v48
  v_mfma_f32_32x32x16_bf16 v[80:95], v[196:199], v[184:187], v[80:95]
  v_exp_f32 v49, v49
  v_exp_f32 v50, v50
  v_exp_f32_e64 v51, v51
  v_mfma_f32_32x32x16_bf16 v[96:111], v[200:203], v[184:187], v[96:111]
  v_exp_f32 v52, v52
  v_exp_f32 v53, v53
  v_exp_f32_e64 v54, v54
  v_mfma_f32_32x32x16_bf16 v[64:79], v[204:207], v[188:191], v[64:79]
  v_exp_f32 v55, v55
  v_exp_f32 v56, v56
  v_exp_f32_e64 v57, v57
  v_mfma_f32_32x32x16_bf16 v[80:95], v[208:211], v[188:191], v[80:95]
  v_exp_f32 v58, v58
  v_exp_f32 v59, v59
  v_exp_f32_e64 v60, v60
  v_mfma_f32_32x32x16_bf16 v[96:111], v[212:215], v[188:191], v[96:111]
  v_exp_f32 v61, v61
  v_exp_f32 v62, v62
  v_exp_f32_e64 v63, v63
  v_pk_fma_f32 v[48:49], v[48:49], s[22:23], s[22:23]
  v_pk_fma_f32 v[50:51], v[50:51], s[22:23], s[22:23]
  v_pk_fma_f32 v[52:53], v[52:53], s[22:23], s[22:23]
  v_pk_fma_f32 v[54:55], v[54:55], s[22:23], s[22:23]
  v_pk_fma_f32 v[56:57], v[56:57], s[22:23], s[22:23]
  v_pk_fma_f32 v[58:59], v[58:59], s[22:23], s[22:23]
  v_pk_fma_f32 v[60:61], v[60:61], s[22:23], s[22:23]
  v_pk_fma_f32 v[62:63], v[62:63], s[22:23], s[22:23]
  v_mfma_f32_32x32x16_bf16 v[16:31], a[168:171], v[160:163], 0
  ds_read_b128 v[192:195], v0 offset:43008
  ds_read_b128 v[196:199], v0 offset:44032
  v_rcp_f32 v48, v48
  v_rcp_f32 v49, v49
  v_mfma_f32_32x32x16_bf16 v[16:31], a[172:175], v[164:167], v[16:31]
  ds_read_b128 v[200:203], v0 offset:45056
  ds_read_b128 v[204:207], v0 offset:46080
  v_rcp_f32 v50, v50
  v_rcp_f32 v51, v51
  v_mfma_f32_32x32x16_bf16 v[16:31], a[176:179], v[168:171], v[16:31]
  ds_read_b128 v[208:211], v0 offset:47104
  ds_read_b128 v[212:215], v0 offset:48128
  v_rcp_f32 v52, v52
  v_rcp_f32 v53, v53
  v_mfma_f32_32x32x16_bf16 v[16:31], a[180:183], v[172:175], v[16:31]
  buffer_store_dwordx4 v[128:131], v10, s[8:11], s28 offen offset:128
  v_rcp_f32 v54, v54
  v_rcp_f32 v55, v55
  v_mfma_f32_32x32x16_bf16 v[16:31], a[184:187], v[176:179], v[16:31]
  v_rcp_f32 v56, v56
  v_rcp_f32 v57, v57
  v_rcp_f32_e64 v58, v58
  v_mfma_f32_32x32x16_bf16 v[16:31], a[188:191], v[180:183], v[16:31]
  s_waitcnt lgkmcnt(0)
  v_rcp_f32 v59, v59
  v_rcp_f32 v60, v60
  v_rcp_f32 v61, v61
  v_rcp_f32 v62, v62
  v_rcp_f32 v63, v63
  v_pk_mul_f32 v[32:33], v[32:33], v[48:49]
  v_pk_mul_f32 v[34:35], v[34:35], v[50:51]
  v_pk_mul_f32 v[36:37], v[36:37], v[52:53]
  v_pk_mul_f32 v[38:39], v[38:39], v[54:55]
  v_pk_mul_f32 v[40:41], v[40:41], v[56:57]
  v_pk_mul_f32 v[42:43], v[42:43], v[58:59]
  v_pk_mul_f32 v[44:45], v[44:45], v[60:61]
  v_pk_mul_f32 v[46:47], v[46:47], v[62:63]
  v_pk_fma_f32 v[48:49], v[16:17], v[16:17], s[20:21] neg_lo:[1,0,1] neg_hi:[1,0,1]
  v_pk_fma_f32 v[50:51], v[18:19], v[18:19], s[20:21] neg_lo:[1,0,1] neg_hi:[1,0,1]
  v_pk_fma_f32 v[52:53], v[20:21], v[20:21], s[20:21] neg_lo:[1,0,1] neg_hi:[1,0,1]
  v_pk_fma_f32 v[54:55], v[22:23], v[22:23], s[20:21] neg_lo:[1,0,1] neg_hi:[1,0,1]
  v_pk_fma_f32 v[56:57], v[24:25], v[24:25], s[20:21] neg_lo:[1,0,1] neg_hi:[1,0,1]
  v_pk_fma_f32 v[58:59], v[26:27], v[26:27], s[20:21] neg_lo:[1,0,1] neg_hi:[1,0,1]
  v_pk_fma_f32 v[60:61], v[28:29], v[28:29], s[20:21] neg_lo:[1,0,1] neg_hi:[1,0,1]
  v_pk_fma_f32 v[62:63], v[30:31], v[30:31], s[20:21] neg_lo:[1,0,1] neg_hi:[1,0,1]
  v_pk_mul_f32 v[48:49], v[16:17], v[48:49]
  v_pk_mul_f32 v[50:51], v[18:19], v[50:51]
  v_pk_mul_f32 v[52:53], v[20:21], v[52:53]
  v_pk_mul_f32 v[54:55], v[22:23], v[54:55]
  v_pk_mul_f32 v[56:57], v[24:25], v[56:57]
  v_cvt_pk_bf16_f32 v184, v32, v33
  v_cvt_pk_bf16_f32 v185, v34, v35
  v_cvt_pk_bf16_f32 v186, v36, v37
  v_cvt_pk_bf16_f32 v187, v38, v39
  v_pk_mul_f32 v[58:59], v[26:27], v[58:59]
  v_pk_mul_f32 v[60:61], v[28:29], v[60:61]
  v_pk_mul_f32 v[62:63], v[30:31], v[62:63]
  v_mfma_f32_32x32x16_bf16 v[64:79], v[192:195], v[184:187], v[64:79]
  v_cvt_pk_bf16_f32 v188, v40, v41
  v_cvt_pk_bf16_f32 v189, v42, v43
  v_cvt_pk_bf16_f32 v190, v44, v45
  v_cvt_pk_bf16_f32 v191, v46, v47
  v_exp_f32_e64 v48, v48
  v_mfma_f32_32x32x16_bf16 v[80:95], v[196:199], v[184:187], v[80:95]
  v_exp_f32 v49, v49
  v_exp_f32 v50, v50
  v_exp_f32_e64 v51, v51
  v_mfma_f32_32x32x16_bf16 v[96:111], v[200:203], v[184:187], v[96:111]
  v_exp_f32 v52, v52
  v_exp_f32 v53, v53
  v_exp_f32_e64 v54, v54
  v_mfma_f32_32x32x16_bf16 v[64:79], v[204:207], v[188:191], v[64:79]
  v_exp_f32 v55, v55
  v_exp_f32 v56, v56
  v_exp_f32_e64 v57, v57
  v_mfma_f32_32x32x16_bf16 v[80:95], v[208:211], v[188:191], v[80:95]
  v_exp_f32 v58, v58
  v_exp_f32 v59, v59
  v_exp_f32_e64 v60, v60
  v_mfma_f32_32x32x16_bf16 v[96:111], v[212:215], v[188:191], v[96:111]
  v_exp_f32 v61, v61
  v_exp_f32 v62, v62
  v_exp_f32_e64 v63, v63
  v_pk_fma_f32 v[48:49], v[48:49], s[22:23], s[22:23]
  v_pk_fma_f32 v[50:51], v[50:51], s[22:23], s[22:23]
  v_pk_fma_f32 v[52:53], v[52:53], s[22:23], s[22:23]
  v_pk_fma_f32 v[54:55], v[54:55], s[22:23], s[22:23]
  v_pk_fma_f32 v[56:57], v[56:57], s[22:23], s[22:23]
  v_pk_fma_f32 v[58:59], v[58:59], s[22:23], s[22:23]
  v_pk_fma_f32 v[60:61], v[60:61], s[22:23], s[22:23]
  v_pk_fma_f32 v[62:63], v[62:63], s[22:23], s[22:23]
  v_mfma_f32_32x32x16_bf16 v[32:47], a[192:195], v[160:163], 0
  ds_read_b128 v[192:195], v0 offset:49152
  ds_read_b128 v[196:199], v0 offset:50176
  v_rcp_f32 v48, v48
  v_rcp_f32 v49, v49
  v_mfma_f32_32x32x16_bf16 v[32:47], a[196:199], v[164:167], v[32:47]
  ds_read_b128 v[200:203], v0 offset:51200
  ds_read_b128 v[204:207], v0 offset:52224
  v_rcp_f32 v50, v50
  v_rcp_f32 v51, v51
  v_mfma_f32_32x32x16_bf16 v[32:47], a[200:203], v[168:171], v[32:47]
  ds_read_b128 v[208:211], v0 offset:53248
  ds_read_b128 v[212:215], v0 offset:54272
  v_rcp_f32 v52, v52
  v_rcp_f32 v53, v53
  v_mfma_f32_32x32x16_bf16 v[32:47], a[204:207], v[172:175], v[32:47]
  buffer_store_dwordx4 v[132:135], v10, s[8:11], s28 offen offset:160
  v_rcp_f32 v54, v54
  v_rcp_f32 v55, v55
  v_mfma_f32_32x32x16_bf16 v[32:47], a[208:211], v[176:179], v[32:47]
  v_rcp_f32 v56, v56
  v_rcp_f32 v57, v57
  v_rcp_f32_e64 v58, v58
  v_mfma_f32_32x32x16_bf16 v[32:47], a[212:215], v[180:183], v[32:47]
  s_waitcnt lgkmcnt(0)
  v_rcp_f32 v59, v59
  v_rcp_f32 v60, v60
  v_rcp_f32 v61, v61
  v_rcp_f32 v62, v62
  v_rcp_f32 v63, v63
  v_pk_mul_f32 v[16:17], v[16:17], v[48:49]
  v_pk_mul_f32 v[18:19], v[18:19], v[50:51]
  v_pk_mul_f32 v[20:21], v[20:21], v[52:53]
  v_pk_mul_f32 v[22:23], v[22:23], v[54:55]
  v_pk_mul_f32 v[24:25], v[24:25], v[56:57]
  v_pk_mul_f32 v[26:27], v[26:27], v[58:59]
  v_pk_mul_f32 v[28:29], v[28:29], v[60:61]
  v_pk_mul_f32 v[30:31], v[30:31], v[62:63]
  v_pk_fma_f32 v[48:49], v[32:33], v[32:33], s[20:21] neg_lo:[1,0,1] neg_hi:[1,0,1]
  v_pk_fma_f32 v[50:51], v[34:35], v[34:35], s[20:21] neg_lo:[1,0,1] neg_hi:[1,0,1]
  v_pk_fma_f32 v[52:53], v[36:37], v[36:37], s[20:21] neg_lo:[1,0,1] neg_hi:[1,0,1]
  v_pk_fma_f32 v[54:55], v[38:39], v[38:39], s[20:21] neg_lo:[1,0,1] neg_hi:[1,0,1]
  v_pk_fma_f32 v[56:57], v[40:41], v[40:41], s[20:21] neg_lo:[1,0,1] neg_hi:[1,0,1]
  v_pk_fma_f32 v[58:59], v[42:43], v[42:43], s[20:21] neg_lo:[1,0,1] neg_hi:[1,0,1]
  v_pk_fma_f32 v[60:61], v[44:45], v[44:45], s[20:21] neg_lo:[1,0,1] neg_hi:[1,0,1]
  v_pk_fma_f32 v[62:63], v[46:47], v[46:47], s[20:21] neg_lo:[1,0,1] neg_hi:[1,0,1]
  v_pk_mul_f32 v[48:49], v[32:33], v[48:49]
  v_pk_mul_f32 v[50:51], v[34:35], v[50:51]
  v_pk_mul_f32 v[52:53], v[36:37], v[52:53]
  v_pk_mul_f32 v[54:55], v[38:39], v[54:55]
  v_pk_mul_f32 v[56:57], v[40:41], v[56:57]
  v_cvt_pk_bf16_f32 v184, v16, v17
  v_cvt_pk_bf16_f32 v185, v18, v19
  v_cvt_pk_bf16_f32 v186, v20, v21
  v_cvt_pk_bf16_f32 v187, v22, v23
  v_pk_mul_f32 v[58:59], v[42:43], v[58:59]
  v_pk_mul_f32 v[60:61], v[44:45], v[60:61]
  v_pk_mul_f32 v[62:63], v[46:47], v[62:63]
  v_mfma_f32_32x32x16_bf16 v[64:79], v[192:195], v[184:187], v[64:79]
  v_cvt_pk_bf16_f32 v188, v24, v25
  v_cvt_pk_bf16_f32 v189, v26, v27
  v_cvt_pk_bf16_f32 v190, v28, v29
  v_cvt_pk_bf16_f32 v191, v30, v31
  v_exp_f32_e64 v48, v48
  v_mfma_f32_32x32x16_bf16 v[80:95], v[196:199], v[184:187], v[80:95]
  v_exp_f32 v49, v49
  v_exp_f32 v50, v50
  v_exp_f32_e64 v51, v51
  v_mfma_f32_32x32x16_bf16 v[96:111], v[200:203], v[184:187], v[96:111]
  v_exp_f32 v52, v52
  v_exp_f32 v53, v53
  v_exp_f32_e64 v54, v54
  v_mfma_f32_32x32x16_bf16 v[64:79], v[204:207], v[188:191], v[64:79]
  v_exp_f32 v55, v55
  v_exp_f32 v56, v56
  v_exp_f32_e64 v57, v57
  v_mfma_f32_32x32x16_bf16 v[80:95], v[208:211], v[188:191], v[80:95]
  v_exp_f32 v58, v58
  v_exp_f32 v59, v59
  v_exp_f32_e64 v60, v60
  v_mfma_f32_32x32x16_bf16 v[96:111], v[212:215], v[188:191], v[96:111]
  v_exp_f32 v61, v61
  v_exp_f32 v62, v62
  v_exp_f32_e64 v63, v63
  v_pk_fma_f32 v[48:49], v[48:49], s[22:23], s[22:23]
  v_pk_fma_f32 v[50:51], v[50:51], s[22:23], s[22:23]
  v_pk_fma_f32 v[52:53], v[52:53], s[22:23], s[22:23]
  v_pk_fma_f32 v[54:55], v[54:55], s[22:23], s[22:23]
  v_pk_fma_f32 v[56:57], v[56:57], s[22:23], s[22:23]
  v_pk_fma_f32 v[58:59], v[58:59], s[22:23], s[22:23]
  v_pk_fma_f32 v[60:61], v[60:61], s[22:23], s[22:23]
  v_pk_fma_f32 v[62:63], v[62:63], s[22:23], s[22:23]
  v_mfma_f32_32x32x16_bf16 v[16:31], a[216:219], v[160:163], 0
  ds_read_b128 v[192:195], v0 offset:55296
  ds_read_b128 v[196:199], v0 offset:56320
  v_rcp_f32 v48, v48
  v_rcp_f32 v49, v49
  v_mfma_f32_32x32x16_bf16 v[16:31], a[220:223], v[164:167], v[16:31]
  ds_read_b128 v[200:203], v0 offset:57344
  ds_read_b128 v[204:207], v0 offset:58368
  v_rcp_f32 v50, v50
  v_rcp_f32 v51, v51
  v_mfma_f32_32x32x16_bf16 v[16:31], a[224:227], v[168:171], v[16:31]
  ds_read_b128 v[208:211], v0 offset:59392
  ds_read_b128 v[212:215], v0 offset:60416
  v_rcp_f32 v52, v52
  v_rcp_f32 v53, v53
  v_mfma_f32_32x32x16_bf16 v[16:31], a[228:231], v[172:175], v[16:31]
  v_rcp_f32 v54, v54
  v_rcp_f32 v55, v55
  v_rcp_f32_e64 v56, v56
  v_mfma_f32_32x32x16_bf16 v[16:31], a[232:235], v[176:179], v[16:31]
  v_rcp_f32 v57, v57
  v_rcp_f32 v58, v58
  v_rcp_f32_e64 v59, v59
  v_mfma_f32_32x32x16_bf16 v[16:31], a[236:239], v[180:183], v[16:31]
  s_waitcnt lgkmcnt(0)
  v_rcp_f32 v60, v60
  v_rcp_f32 v61, v61
  v_rcp_f32 v62, v62
  v_rcp_f32_e64 v63, v63
  v_pk_mul_f32 v[32:33], v[32:33], v[48:49]
  v_pk_mul_f32 v[34:35], v[34:35], v[50:51]
  v_pk_mul_f32 v[36:37], v[36:37], v[52:53]
  v_pk_mul_f32 v[38:39], v[38:39], v[54:55]
  v_pk_mul_f32 v[40:41], v[40:41], v[56:57]
  v_pk_mul_f32 v[42:43], v[42:43], v[58:59]
  v_pk_mul_f32 v[44:45], v[44:45], v[60:61]
  v_pk_mul_f32 v[46:47], v[46:47], v[62:63]
  v_pk_fma_f32 v[48:49], v[16:17], v[16:17], s[20:21] neg_lo:[1,0,1] neg_hi:[1,0,1]
  v_pk_fma_f32 v[50:51], v[18:19], v[18:19], s[20:21] neg_lo:[1,0,1] neg_hi:[1,0,1]
  v_pk_fma_f32 v[52:53], v[20:21], v[20:21], s[20:21] neg_lo:[1,0,1] neg_hi:[1,0,1]
  v_pk_fma_f32 v[54:55], v[22:23], v[22:23], s[20:21] neg_lo:[1,0,1] neg_hi:[1,0,1]
  v_pk_fma_f32 v[56:57], v[24:25], v[24:25], s[20:21] neg_lo:[1,0,1] neg_hi:[1,0,1]
  v_pk_fma_f32 v[58:59], v[26:27], v[26:27], s[20:21] neg_lo:[1,0,1] neg_hi:[1,0,1]
  v_pk_fma_f32 v[60:61], v[28:29], v[28:29], s[20:21] neg_lo:[1,0,1] neg_hi:[1,0,1]
  v_pk_fma_f32 v[62:63], v[30:31], v[30:31], s[20:21] neg_lo:[1,0,1] neg_hi:[1,0,1]
  v_pk_mul_f32 v[48:49], v[16:17], v[48:49]
  v_pk_mul_f32 v[50:51], v[18:19], v[50:51]
  v_pk_mul_f32 v[52:53], v[20:21], v[52:53]
  v_pk_mul_f32 v[54:55], v[22:23], v[54:55]
  v_pk_mul_f32 v[56:57], v[24:25], v[56:57]
  v_cvt_pk_bf16_f32 v184, v32, v33
  v_cvt_pk_bf16_f32 v185, v34, v35
  v_cvt_pk_bf16_f32 v186, v36, v37
  v_cvt_pk_bf16_f32 v187, v38, v39
  v_pk_mul_f32 v[58:59], v[26:27], v[58:59]
  v_pk_mul_f32 v[60:61], v[28:29], v[60:61]
  v_pk_mul_f32 v[62:63], v[30:31], v[62:63]
  v_mfma_f32_32x32x16_bf16 v[64:79], v[192:195], v[184:187], v[64:79]
  ds_read_b128 v[216:219], v0 offset:12288
  ds_read_b128 v[220:223], v0 offset:13312
  v_cvt_pk_bf16_f32 v188, v40, v41
  v_cvt_pk_bf16_f32 v189, v42, v43
  v_cvt_pk_bf16_f32 v190, v44, v45
  v_cvt_pk_bf16_f32 v191, v46, v47
  v_mfma_f32_32x32x16_bf16 v[80:95], v[196:199], v[184:187], v[80:95]
  ds_read_b128 v[224:227], v0 offset:14336
  ds_read_b128 v[228:231], v0 offset:15360
  v_exp_f32 v48, v48
  v_exp_f32 v49, v49
  v_mfma_f32_32x32x16_bf16 v[96:111], v[200:203], v[184:187], v[96:111]
  ds_read_b128 v[232:235], v0 offset:16384
  ds_read_b128 v[236:239], v0 offset:17408
  v_exp_f32 v50, v50
  v_exp_f32 v51, v51
  v_mfma_f32_32x32x16_bf16 v[64:79], v[204:207], v[188:191], v[64:79]
  s_mov_b32 s28, s34
  v_exp_f32 v52, v52
  v_exp_f32 v53, v53
  v_exp_f32 v54, v54
  v_mfma_f32_32x32x16_bf16 v[80:95], v[208:211], v[188:191], v[80:95]
  s_add_u32 s34, s34, 0x60000
  v_exp_f32 v55, v55
  v_exp_f32 v56, v56
  v_exp_f32_e64 v57, v57
  v_mfma_f32_32x32x16_bf16 v[96:111], v[212:215], v[188:191], v[96:111]
  s_waitcnt lgkmcnt(0)
  v_exp_f32 v58, v58
  v_exp_f32 v59, v59
  v_exp_f32 v60, v60
  v_exp_f32 v61, v61
  v_exp_f32 v62, v62
  v_exp_f32_e64 v63, v63
  v_pk_fma_f32 v[48:49], v[48:49], s[22:23], s[22:23]
  v_pk_fma_f32 v[50:51], v[50:51], s[22:23], s[22:23]
  v_pk_fma_f32 v[52:53], v[52:53], s[22:23], s[22:23]
  v_pk_fma_f32 v[54:55], v[54:55], s[22:23], s[22:23]
  v_pk_fma_f32 v[56:57], v[56:57], s[22:23], s[22:23]
  v_pk_fma_f32 v[58:59], v[58:59], s[22:23], s[22:23]
  v_pk_fma_f32 v[60:61], v[60:61], s[22:23], s[22:23]
  v_pk_fma_f32 v[62:63], v[62:63], s[22:23], s[22:23]
  v_mfma_f32_32x32x16_bf16 v[32:47], v[216:219], v[160:163], 0
  ds_read_b128 v[192:195], v0 offset:61440
  ds_read_b128 v[196:199], v0 offset:62464
  v_rcp_f32 v48, v48
  v_rcp_f32 v49, v49
  v_mfma_f32_32x32x16_bf16 v[32:47], v[220:223], v[164:167], v[32:47]
  ds_read_b128 v[200:203], v0 offset:63488
  ds_read_b128 v[204:207], v0 offset:64512
  v_rcp_f32 v50, v50
  v_rcp_f32 v51, v51
  v_mfma_f32_32x32x16_bf16 v[32:47], v[224:227], v[168:171], v[32:47]
  ds_read_b128 v[208:211], v1
  ds_read_b128 v[212:215], v1 offset:1024
  v_rcp_f32 v52, v52
  v_rcp_f32 v53, v53
  v_mfma_f32_32x32x16_bf16 v[32:47], v[228:231], v[172:175], v[32:47]
  v_rcp_f32 v54, v54
  v_rcp_f32 v55, v55
  v_rcp_f32_e64 v56, v56
  v_mfma_f32_32x32x16_bf16 v[32:47], v[232:235], v[176:179], v[32:47]
  v_rcp_f32 v57, v57
  v_rcp_f32 v58, v58
  v_rcp_f32_e64 v59, v59
  v_mfma_f32_32x32x16_bf16 v[32:47], v[236:239], v[180:183], v[32:47]
  s_waitcnt lgkmcnt(0)
  v_rcp_f32 v60, v60
  v_rcp_f32 v61, v61
  v_rcp_f32 v62, v62
  v_rcp_f32_e64 v63, v63
  v_pk_mul_f32 v[16:17], v[16:17], v[48:49]
  v_pk_mul_f32 v[18:19], v[18:19], v[50:51]
  v_pk_mul_f32 v[20:21], v[20:21], v[52:53]
  v_pk_mul_f32 v[22:23], v[22:23], v[54:55]
  v_pk_mul_f32 v[24:25], v[24:25], v[56:57]
  v_pk_mul_f32 v[26:27], v[26:27], v[58:59]
  v_pk_mul_f32 v[28:29], v[28:29], v[60:61]
  v_pk_mul_f32 v[30:31], v[30:31], v[62:63]
  v_pk_fma_f32 v[48:49], v[32:33], v[32:33], s[20:21] neg_lo:[1,0,1] neg_hi:[1,0,1]
  v_pk_fma_f32 v[50:51], v[34:35], v[34:35], s[20:21] neg_lo:[1,0,1] neg_hi:[1,0,1]
  v_pk_fma_f32 v[52:53], v[36:37], v[36:37], s[20:21] neg_lo:[1,0,1] neg_hi:[1,0,1]
  v_pk_fma_f32 v[54:55], v[38:39], v[38:39], s[20:21] neg_lo:[1,0,1] neg_hi:[1,0,1]
  v_pk_fma_f32 v[56:57], v[40:41], v[40:41], s[20:21] neg_lo:[1,0,1] neg_hi:[1,0,1]
  v_pk_fma_f32 v[58:59], v[42:43], v[42:43], s[20:21] neg_lo:[1,0,1] neg_hi:[1,0,1]
  v_pk_fma_f32 v[60:61], v[44:45], v[44:45], s[20:21] neg_lo:[1,0,1] neg_hi:[1,0,1]
  v_pk_fma_f32 v[62:63], v[46:47], v[46:47], s[20:21] neg_lo:[1,0,1] neg_hi:[1,0,1]
  v_pk_mul_f32 v[48:49], v[32:33], v[48:49]
  v_pk_mul_f32 v[50:51], v[34:35], v[50:51]
  v_pk_mul_f32 v[52:53], v[36:37], v[52:53]
  v_pk_mul_f32 v[54:55], v[38:39], v[54:55]
  v_pk_mul_f32 v[56:57], v[40:41], v[56:57]
  v_cvt_pk_bf16_f32 v184, v16, v17
  v_cvt_pk_bf16_f32 v185, v18, v19
  v_cvt_pk_bf16_f32 v186, v20, v21
  v_cvt_pk_bf16_f32 v187, v22, v23
  v_pk_mul_f32 v[58:59], v[42:43], v[58:59]
  v_pk_mul_f32 v[60:61], v[44:45], v[60:61]
  v_pk_mul_f32 v[62:63], v[46:47], v[62:63]
  v_mfma_f32_32x32x16_bf16 v[64:79], v[192:195], v[184:187], v[64:79]
  v_cvt_pk_bf16_f32 v188, v24, v25
  v_cvt_pk_bf16_f32 v189, v26, v27
  v_cvt_pk_bf16_f32 v190, v28, v29
  v_cvt_pk_bf16_f32 v191, v30, v31
  v_exp_f32_e64 v48, v48
  v_mfma_f32_32x32x16_bf16 v[80:95], v[196:199], v[184:187], v[80:95]
  v_exp_f32 v49, v49
  v_exp_f32 v50, v50
  v_exp_f32_e64 v51, v51
  v_mfma_f32_32x32x16_bf16 v[96:111], v[200:203], v[184:187], v[96:111]
  v_exp_f32 v52, v52
  v_exp_f32 v53, v53
  v_exp_f32_e64 v54, v54
  v_mfma_f32_32x32x16_bf16 v[64:79], v[204:207], v[188:191], v[64:79]
  v_exp_f32 v55, v55
  v_exp_f32 v56, v56
  v_exp_f32_e64 v57, v57
  v_mfma_f32_32x32x16_bf16 v[80:95], v[208:211], v[188:191], v[80:95]
  v_exp_f32 v58, v58
  v_exp_f32 v59, v59
  v_exp_f32_e64 v60, v60
  v_mfma_f32_32x32x16_bf16 v[96:111], v[212:215], v[188:191], v[96:111]
  v_exp_f32 v61, v61
  v_exp_f32 v62, v62
  v_exp_f32_e64 v63, v63
  v_pk_fma_f32 v[48:49], v[48:49], s[22:23], s[22:23]
  v_pk_fma_f32 v[50:51], v[50:51], s[22:23], s[22:23]
  v_pk_fma_f32 v[52:53], v[52:53], s[22:23], s[22:23]
  v_pk_fma_f32 v[54:55], v[54:55], s[22:23], s[22:23]
  v_pk_fma_f32 v[56:57], v[56:57], s[22:23], s[22:23]
  v_pk_fma_f32 v[58:59], v[58:59], s[22:23], s[22:23]
  v_pk_fma_f32 v[60:61], v[60:61], s[22:23], s[22:23]
  v_pk_fma_f32 v[62:63], v[62:63], s[22:23], s[22:23]
  ds_read_b128 v[192:195], v1 offset:2048
  ds_read_b128 v[196:199], v1 offset:3072
  ds_read_b128 v[200:203], v1 offset:4096
  ds_read_b128 v[204:207], v1 offset:5120
  ds_read_b128 v[208:211], v1 offset:6144
  ds_read_b128 v[212:215], v1 offset:7168
  v_rcp_f32 v48, v48
  v_rcp_f32 v49, v49
  v_rcp_f32 v50, v50
  v_rcp_f32 v51, v51
  v_rcp_f32 v52, v52
  v_rcp_f32 v53, v53
  v_rcp_f32 v54, v54
  v_rcp_f32 v55, v55
  v_rcp_f32 v56, v56
  v_rcp_f32 v57, v57
  v_rcp_f32 v58, v58
  v_rcp_f32 v59, v59
  v_rcp_f32 v60, v60
  v_rcp_f32 v61, v61
  v_rcp_f32 v62, v62
  v_rcp_f32 v63, v63
  v_pk_mul_f32 v[32:33], v[32:33], v[48:49]
  v_pk_mul_f32 v[34:35], v[34:35], v[50:51]
  v_pk_mul_f32 v[36:37], v[36:37], v[52:53]
  v_pk_mul_f32 v[38:39], v[38:39], v[54:55]
  v_pk_mul_f32 v[40:41], v[40:41], v[56:57]
  v_pk_mul_f32 v[42:43], v[42:43], v[58:59]
  v_pk_mul_f32 v[44:45], v[44:45], v[60:61]
  v_pk_mul_f32 v[46:47], v[46:47], v[62:63]
  v_cvt_pk_bf16_f32 v184, v32, v33
  v_cvt_pk_bf16_f32 v185, v34, v35
  v_cvt_pk_bf16_f32 v186, v36, v37
  v_cvt_pk_bf16_f32 v187, v38, v39
  v_cvt_pk_bf16_f32 v188, v40, v41
  v_cvt_pk_bf16_f32 v189, v42, v43
  v_cvt_pk_bf16_f32 v190, v44, v45
  v_cvt_pk_bf16_f32 v191, v46, v47
  s_waitcnt lgkmcnt(5)
  v_mfma_f32_32x32x16_bf16 v[64:79], v[192:195], v[184:187], v[64:79]
  s_waitcnt lgkmcnt(2)
  v_mfma_f32_32x32x16_bf16 v[64:79], v[204:207], v[188:191], v[64:79]
  v_mfma_f32_32x32x16_bf16 v[80:95], v[196:199], v[184:187], v[80:95]
  s_waitcnt lgkmcnt(1)
  v_mfma_f32_32x32x16_bf16 v[80:95], v[208:211], v[188:191], v[80:95]
  s_nop 0
  v_mfma_f32_32x32x16_bf16 v[96:111], v[200:203], v[184:187], v[96:111]
  s_waitcnt lgkmcnt(0)
  v_mfma_f32_32x32x16_bf16 v[96:111], v[212:215], v[188:191], v[96:111]
  s_nop 5
  v_cvt_pk_bf16_f32 v112, v64, v65
  v_cvt_pk_bf16_f32 v113, v66, v67
  v_cvt_pk_bf16_f32 v114, v68, v69
  v_cvt_pk_bf16_f32 v115, v70, v71
  buffer_store_dwordx4 v[112:115], v10, s[8:11], s28 offen
  v_cvt_pk_bf16_f32 v116, v72, v73
  v_cvt_pk_bf16_f32 v117, v74, v75
  v_cvt_pk_bf16_f32 v118, v76, v77
  v_cvt_pk_bf16_f32 v119, v78, v79
  buffer_store_dwordx4 v[116:119], v10, s[8:11], s28 offen offset:32
  v_cvt_pk_bf16_f32 v120, v80, v81
  v_cvt_pk_bf16_f32 v121, v82, v83
  v_cvt_pk_bf16_f32 v122, v84, v85
  v_cvt_pk_bf16_f32 v123, v86, v87
  buffer_store_dwordx4 v[120:123], v10, s[8:11], s28 offen offset:64
  v_cvt_pk_bf16_f32 v124, v88, v89
  v_cvt_pk_bf16_f32 v125, v90, v91
  v_cvt_pk_bf16_f32 v126, v92, v93
  v_cvt_pk_bf16_f32 v127, v94, v95
  buffer_store_dwordx4 v[124:127], v10, s[8:11], s28 offen offset:96
  v_cvt_pk_bf16_f32 v128, v96, v97
  v_cvt_pk_bf16_f32 v129, v98, v99
  v_cvt_pk_bf16_f32 v130, v100, v101
  v_cvt_pk_bf16_f32 v131, v102, v103
  buffer_store_dwordx4 v[128:131], v10, s[8:11], s28 offen offset:128
  v_cvt_pk_bf16_f32 v132, v104, v105
  v_cvt_pk_bf16_f32 v133, v106, v107
  v_cvt_pk_bf16_f32 v134, v108, v109
  v_cvt_pk_bf16_f32 v135, v110, v111
  buffer_store_dwordx4 v[132:135], v10, s[8:11], s28 offen offset:160
S_end:
  s_endpgm
.section .rodata,"a"
.p2align 6
.amdhsa_kernel standalone__modern_conv_block_convnext__vision_kernel
  .amdhsa_next_free_vgpr 512
  .amdhsa_next_free_sgpr 102
  .amdhsa_accum_offset 256
  .amdhsa_group_segment_fixed_size 0
  .amdhsa_kernarg_size 80
  .amdhsa_user_sgpr_count 2
  .amdhsa_user_sgpr_kernarg_segment_ptr 1
  .amdhsa_system_sgpr_workgroup_id_x 1
.end_amdhsa_kernel
```

```asm
; @launch grid=(256,1,1) block=(256,1,1) lds=163840
.amdgcn_target "amdgcn-amd-amdhsa--gfx950"
.text
.globl standalone__modern_conv_block_convnext__vision_kernel
.p2align 8
.type standalone__modern_conv_block_convnext__vision_kernel,@function
standalone__modern_conv_block_convnext__vision_kernel:
  s_cmp_ge_u32 s2, 0x100
  s_cbranch_scc1 L_end
  s_nop 0
  s_load_dwordx2 s[4:5], s[0:1], 0
  s_load_dwordx2 s[60:61], s[0:1], 8
  s_load_dwordx2 s[64:65], s[0:1], 16
  s_load_dwordx2 s[68:69], s[0:1], 24
  s_load_dwordx2 s[72:73], s[0:1], 32
  s_load_dwordx2 s[76:77], s[0:1], 40
  s_load_dwordx2 s[80:81], s[0:1], 48
  s_load_dwordx2 s[8:9], s[0:1], 56
  s_getpc_b64 s[40:41]
L_pc:
  s_lshl_b32 s32, s2, 9
  s_and_b32 s32, s32, 0xf000
  v_lshl_add_u32 v249, v0, 4, s32
  v_lshrrev_b32_e64 v112, 6, v0
  v_min_u32 v249, L_cend-L_pc-16, v249
  v_and_b32 v113, 63, v0
  global_load_dwordx4 v[108:111], v249, s[40:41]
  v_readfirstlane_b32 s27, v112
  s_mov_b32 s62, 0x6c0
  s_mov_b32 s63, 0x20000
  s_mov_b32 s82, 0xc0
  s_mov_b32 s83, 0x20000
  s_mov_b32 s78, 0xc0
  s_mov_b32 s79, 0x20000
  s_mov_b32 s66, 0x12000
  s_mov_b32 s67, 0x20000
  s_mov_b32 s74, 0x12000
  s_mov_b32 s75, 0x20000
  v_bfe_u32 v114, v113, 3, 1
  v_bfe_u32 v115, v113, 4, 1
  v_bfe_u32 v116, v113, 2, 1
  v_and_b32 v117, 3, v113
  v_lshlrev_b32 v118, 4, v113
  s_min_u32 s44, s27, 2
  s_lshl_b32 s45, s44, 6
  s_mul_i32 s46, s44, 0x240
  v_lshlrev_b32 v119, 1, v113
  v_and_b32 v120, 31, v113
  v_lshlrev_b32 v121, 1, v120
  v_lshlrev_b32 v122, 4, v115
  v_lshl_add_u32 v122, v116, 3, v122
  v_lshl_add_u32 v122, v114, 2, v122
  v_add_u32 v122, v122, v117
  v_bfe_u32 v123, v113, 3, 2
  v_and_b32 v124, 7, v113
  v_lshl_add_u32 v123, v124, 2, v123
  v_lshlrev_b32_e64 v125, 1, v123
  s_lshr_b32 s35, s2, 3
  s_lshl_b32 s35, s35, 2
  s_add_u32 s35, s35, s27
  s_sub_u32 s55, s35, 0x48
  s_min_u32 s35, s35, s55
  s_lshl_b32 s47, s35, 10
  s_and_b32 s54, s2, 6
  s_lshl_b32 s54, s54, 1
  s_lshr_b32 s32, s2, 6
  s_add_u32 s54, s54, s32
  s_mul_i32 s59, s54, 0x300000
  s_and_b32 s53, s2, 1
  s_lshl_b32 s53, s53, 8
  s_and_b32 s32, s2, 56
  s_lshl_b32 s32, s32, 2
  s_add_u32 s53, s53, s32
  s_lshl_b32 s32, s27, 3
  s_add_u32 s53, s53, s32
  s_mul_i32 s3, s53, 0xc0
  s_add_u32 s3, s3, 0xf40
  s_mov_b32 s6, 0x3000000
  s_mov_b32 s7, 0x20000
  s_cmp_eq_u32 s53, 0
  s_cselect_b32 s35, 12, 0
  s_sub_u32 s55, 0x78, s35
  s_cmp_eq_u32 s53, 0x1f8
  s_cselect_b32 s55, 0x6c, s55
  s_mul_i32 s15, s27, 0x1040
  s_add_u32 s48, s59, 0x17000
  s_add_u32 s49, s59, 0x47000
  s_waitcnt lgkmcnt(0)
  v_add_u32 v126, 64, v113
  buffer_load_dwordx4 v[108:111], v118, s[64:67], s47 offen
  v_subrev_u32 v129, 57, v113
  v_cmp_le_u32 vcc, 57, v113
  buffer_load_dwordx4 v[108:111], v118, s[72:75], s47 offen
  v_add_u32_e64 v127, 7, v113
  v_add_u32 v128, 0x47, v113
  buffer_load_ushort v131, v119, s[60:63], s46 offen
  v_mov_b32 v199, 0x17c00
  v_cndmask_b32_e64 v126, v126, v129, vcc
  buffer_load_ushort v132, v121, s[60:63], s46 offen offset:128
  v_mov_b32 v129, 0xfffffc00
  v_cndmask_b32 v199, v129, v199, vcc
  v_add_u32 v198, s3, v118
  buffer_load_ushort v133, v119, s[60:63], s46 offen offset:192
  v_lshl_add_u32 v199, v126, 4, v199
  v_add_u32_e64 v199, s3, v199
  buffer_load_ushort v134, v119, s[60:63], s46 offen offset:320
  v_add_u32 v200, 0x17870, v198
  v_add_u32 v201, 0x17870, v198
  buffer_load_ushort v135, v119, s[60:63], s46 offen offset:448
  v_mov_b32 v130, 0x80000000
  v_subrev_u32_e64 v6, s35, v113
  buffer_load_ushort v139, v125, s[80:83], s45 offen
  v_cmp_gt_u32 s[36:37], s55, v6
  v_subrev_u32_e64 v7, s35, v126
  v_cmp_gt_u32 s[38:39], s55, v7
  buffer_load_ushort v140, v125, s[76:79], s45 offen
  v_subrev_u32_e64 v8, s35, v127
  v_cmp_gt_u32 s[40:41], s55, v8
  buffer_load_ushort v136, v125, s[80:83], 0 offen
  v_subrev_u32_e64 v9, s35, v128
  v_cmp_gt_u32 s[42:43], s55, v9
  buffer_load_ushort v137, v125, s[80:83], 0 offen offset:64
  v_cndmask_b32 v6, v130, v198, s[36:37]
  v_cndmask_b32 v7, v130, v199, s[38:39]
  buffer_load_ushort v138, v125, s[80:83], 0 offen offset:128
  v_cndmask_b32 v8, v130, v200, s[40:41]
  v_cndmask_b32 v9, v130, v201, s[42:43]
  s_add_u32 m0, s15, 0x4120
  s_nop 0
  buffer_load_dwordx4 v6, s[4:7], s48 offen lds
  buffer_load_dwordx4 v7, s[4:7], s48 offen offset:1024 lds
  buffer_load_dwordx4 v8, s[4:7], s48 offen offset:2048 lds
  buffer_load_dwordx4 v9, s[4:7], s48 offen offset:3072 lds
  s_sub_u32 s56, s59, 0x19000
  v_add_u32 v198, s56, v6
  s_add_u32 s56, s56, 0x400
  v_add_u32_e64 v199, s56, v7
  s_add_u32 s56, s56, 0x400
  v_add_u32_e64 v200, s56, v8
  s_add_u32 s56, s56, 0x400
  v_add_u32 v201, s56, v9
  v_lshrrev_b32 v141, 5, v113
  v_lshlrev_b32 v202, 4, v117
  v_lshl_add_u32 v202, v141, 6, v202
  v_bfe_u32 v126, v113, 3, 2
  v_lshl_add_u32 v126, v116, 2, v126
  v_cmp_eq_u32 vcc, 7, v126
  v_lshl_add_u32 v126, v116, 1, v114
  v_lshl_add_u32 v126, v115, 3, v126
  v_mul_u32_u24 v203, 0x300, v126
  v_add_u32 v203, v203, v202
  v_cndmask_b32 v204, v130, v202, vcc
  s_mov_b32 s70, 0x300
  s_mov_b32 s71, 0x20000
  s_mov_b32 s10, 0x3000000
  s_mov_b32 s11, 0x20000
  s_and_b32 s36, s27, 2
  s_add_u32 s37, s27, 1
  s_lshr_b32 s37, s37, 1
  s_and_b32 s38, s37, 1
  s_cmp_eq_u32 s27, 1
  s_cselect_b32 s39, 0, 3
  s_cselect_b32 s51, 0x1000, 0
  s_cselect_b32 s18, -1, 1
  s_nop 0
  s_mul_i32 s18, s18, 0x2400
  s_lshl_b32 s32, s36, 8
  s_lshl_b32 s33, s37, 8
  s_add_u32 s43, s32, 0x11d00
  s_add_u32 s50, s33, 0x11d00
  s_add_u32 s51, s51, s33
  s_mul_i32 s40, s38, 0x6000
  s_add_u32 s40, s40, s32
  s_mul_i32 s41, s38, 0x3000
  s_add_u32 s41, s41, s32
  s_add_u32 s41, s41, 0xc00
  s_mul_i32 s42, s39, 0x2400
  s_add_u32 s42, s42, s33
  v_and_b32 v150, 0x70, v118
  v_lshl_add_u32 v150, v115, 7, v150
  v_lshl_add_u32 v150, v141, 8, v150
  v_mul_u32_u24 v127, 0xc00, v114
  v_add_u32_e64 v150, v150, v127
  v_bfe_u32 v151, v113, 1, 1
  v_and_b32_e64 v152, 1, v113
  v_lshl_add_u32 v153, v116, 1, v152
  s_mul_i32 s32, s36, 0x6000
  s_lshl_b32 s33, s38, 10
  s_add_u32 s33, s33, s32
  s_add_u32 s33, s33, 0x10000
  v_add_u32_e64 v195, s33, v150
  s_lshl_b32 s33, s38, 3
  s_add_u32 s33, s33, s32
  s_add_u32 s33, s33, 0x10200
  v_add_u32_e64 v196, s33, v150
  s_mul_i32 s32, s37, 0x6000
  s_lshl_b32 s33, s39, 9
  s_add_u32 s33, s33, s32
  s_add_u32 s33, s33, 0x10000
  v_add_u32 v197, s33, v150
  v_add_u32 v127, 16, v113
  v_lshrrev_b32 v127, 6, v127
  v_lshlrev_b32 v127, 4, v127
  buffer_load_dwordx4 a[72:75], v202, s[64:67], s43 offen
  v_xor_b32_e64 v253, v127, v118
  v_lshl_add_u32 v127, v141, 4, 16
  v_xor_b32_e64 v254, v127, v118
  v_mul_u32_u24 v127, 0x1200, v141
  v_add_u32_e64 v254, v127, v254
  v_add_u32 v127, 0xb0, v113
  v_lshrrev_b32 v127, 6, v127
  v_lshlrev_b32 v127, 4, v127
  v_xor_b32_e64 v255, v127, v118
  v_add_u32 v255, 0x1200, v255
  s_mul_i32 s14, s27, 0x1800
  s_add_u32 s32, s27, 3
  s_and_b32 s32, s32, 3
  s_mul_i32 s32, s32, 0x600
  s_cmp_eq_u32 s27, 0
  s_cselect_b32 s57, 0, 3
  s_cselect_b32 s53, 3, 6
  s_cselect_b32 s55, 6, 0
  s_lshl_b32 s57, s57, 13
  s_add_u32 s57, s57, s32
  s_add_u32 s58, s57, 0x3000
  s_lshl_b32 s53, s53, 13
  s_add_u32 s53, s53, s32
  s_add_u32 s54, s53, 0x3000
  s_lshl_b32 s55, s55, 13
  s_add_u32 s55, s55, s32
  s_add_u32 s56, s55, 0x3000
  v_and_b32_e64 v154, 7, v113
  buffer_load_dwordx4 a[76:79], v202, s[64:67], s43 offen offset:128
  v_lshrrev_b32 v155, 4, v113
  v_lshlrev_b32 v156, 4, v141
  v_and_b32 v143, 1, v113
  v_lshlrev_b32 v143, 4, v143
  v_mov_b32 v129, 0xffff
  v_lshlrev_b32_e64 v129, v143, v129
  v_bfe_u32 v127, v113, 1, 2
  v_lshlrev_b32 v127, v127, 1
  v_bfe_i32 v56, v127, 0, 1
  v_mov_b32 v60, 0
  v_and_b32 v56, v56, v129
  v_bfe_i32 v57, v127, 1, 1
  v_mov_b32 v61, 0
  v_and_b32 v57, v57, v129
  v_bfe_i32 v58, v127, 2, 1
  v_mov_b32 v62, 0
  v_and_b32 v58, v58, v129
  v_bfe_i32 v59, v127, 3, 1
  v_mov_b32 v63, 0
  v_and_b32 v59, v59, v129
  v_min_u32_e64 v127, 11, v113
  v_mul_u32_u24 v127, 0x190, v127
  ds_write_b128 v127, v[60:63] offset:50304
  v_lshrrev_b32 v127, 2, v0
  v_min_u32 v127, 24, v127
  v_lshlrev_b32_e64 v127, 4, v127
  buffer_load_dwordx4 a[80:83], v202, s[64:67], s50 offen
  v_or_b32 v127, v127, v117
  v_lshlrev_b32 v127, 4, v127
  ds_write_b128 v127, v[60:63] offset:54720
  v_bfe_i32 v149, v113, 2, 1
  v_xor_b32 v148, -1, v149
  s_lshl_b32 s32, s44, 7
  v_lshrrev_b32_e64 v144, 3, v113
  v_lshl_add_u32 v147, v144, 8, s45
  v_lshl_add_u32 v147, v154, 3, v147
  v_mul_u32_u24 v144, 0x190, v144
  v_lshl_add_u32 v144, v154, 4, v144
  v_add_u32 v144, s32, v144
  v_lshrrev_b32 v145, 3, v120
  v_mul_u32_u24 v145, 0x190, v145
  v_lshl_add_u32 v145, v154, 4, v145
  v_add_u32_e64 v145, s32, v145
  v_lshl_add_u32 v146, v120, 2, s32
  v_add_u32 v146, s45, v125
  v_mul_u32_u24 v127, 43, v146
  v_lshrrev_b32_e64 v127, 9, v127
  v_mul_u32_u24 v127, 0x5f0, v127
  v_lshlrev_b32 v146, 7, v146
  v_sub_u32 v146, v146, v127
  v_sub_u32_e64 v127, v155, v151
  v_lshl_add_u32 v128, v114, 2, v153
  v_mul_u32_u24_e64 v142, 48, v141
  v_lshl_add_u32 v142, v115, 1, v142
  buffer_load_dwordx4 a[84:87], v202, s[64:67], s50 offen offset:128
  v_sub_u32_e64 v142, v142, v151
  v_lshl_add_u32 v142, v142, 3, v128
  v_lshlrev_b32_e64 v142, 3, v142
  v_add_u32 v11, 0xd600, v142
  v_add_u32 v205, 0xde00, v142
  v_lshl_add_u32 v128, v127, 3, v128
  v_min_u32 v128, 24, v128
  v_lshlrev_b32 v128, 4, v128
  v_add_u32 v3, 0xc300, v128
  v_lshlrev_b32_e64 v157, 2, v115
  v_lshl_add_u32 v157, v114, 1, v157
  v_bfe_u32 v128, v113, 1, 1
  v_add_u32 v157, v157, v128
  v_xor_b32 v128, v116, v141
  v_lshl_add_u32 v157, v128, 3, v157
  v_lshlrev_b32 v157, v157, 1
  v_mov_b32 v128, 0x3f80
  v_lshlrev_b32_e64 v128, v143, v128
  v_mov_b32 v127, 0xbf80
  v_lshlrev_b32_e64 v127, v143, v127
  v_bfe_i32 v216, v157, 0, 1
  v_and_b32 v224, v216, v128
  v_and_b32 v184, v216, v127
  v_bfe_i32 v217, v157, 1, 1
  v_and_b32 v225, v217, v128
  v_and_b32 v185, v217, v127
  buffer_load_dwordx4 a[88:91], v204, s[68:71], s51 offen
  v_bfe_i32 v218, v157, 2, 1
  v_and_b32 v226, v218, v128
  v_and_b32 v186, v218, v127
  v_bfe_i32 v219, v157, 3, 1
  v_and_b32 v227, v219, v128
  v_and_b32 v187, v219, v127
  v_bfe_i32 v220, v157, 4, 1
  v_and_b32 v228, v220, v128
  v_and_b32 v188, v220, v127
  v_bfe_i32 v221, v157, 5, 1
  v_and_b32 v229, v221, v128
  v_and_b32 v189, v221, v127
  v_bfe_i32 v222, v157, 6, 1
  v_and_b32_e64 v230, v222, v128
  v_and_b32_e64 v190, v222, v127
  v_bfe_i32 v223, v157, 7, 1
  v_and_b32_e64 v231, v223, v128
  v_and_b32_e64 v191, v223, v127
  v_lshl_add_u32 v157, v153, 1, v115
  v_xor_b32_e64 v128, v151, v141
  v_lshl_add_u32 v157, v128, 3, v157
  v_lshlrev_b32 v157, v157, 1
  v_bfe_i32 v216, v157, 0, 1
  v_bfe_i32 v217, v157, 1, 1
  v_bfe_i32 v218, v157, 2, 1
  v_bfe_i32 v219, v157, 3, 1
  v_bfe_i32 v220, v157, 4, 1
  buffer_load_dwordx4 a[92:95], v204, s[68:71], s51 offen offset:128
  v_bfe_i32 v221, v157, 5, 1
  v_bfe_i32 v222, v157, 6, 1
  v_bfe_i32 v223, v157, 7, 1
  v_lshlrev_b32_e64 v143, 4, v114
  v_bfe_u32 v128, v113, 2, 2
  v_xor_b32_e64 v128, v155, v128
  v_lshl_add_u32 v157, v128, 2, v117
  v_lshlrev_b32 v157, v157, 1
  v_bfe_u32 v240, v157, 0, 1
  v_mul_u32_u24 v240, 0x3f80, v240
  v_bfe_u32 v241, v157, 1, 1
  v_mul_u32_u24 v241, 0x3f80, v241
  v_bfe_u32 v242, v157, 2, 1
  v_mul_u32_u24 v242, 0x3f80, v242
  v_bfe_u32 v243, v157, 3, 1
  v_mul_u32_u24 v243, 0x3f80, v243
  s_mov_b32 s22, 0x3e9a0000
  s_mov_b32 s24, 0x3c2aaaab
  s_mov_b32 s25, 0x3727c5ac
  s_mov_b32 s20, 0x36553a11
  s_mov_b32 s21, 0x3aa63895
  s_mov_b32 s12, 0
  s_mov_b32 s13, 0xffff0000
  s_add_u32 s29, s59, 0x77000
  s_add_u32 s52, s59, 0xa7000
  v_lshl_add_u32 v158, v152, 1, v116
  buffer_load_dwordx4 a[0:3], v203, s[64:67], s40 offen
  v_lshl_add_u32 v158, v114, 2, v158
  v_mul_u32_u24 v159, 48, v155
  v_mul_u32_u24 v32, 0xc0, v158
  v_add_u32_e64 v129, s15, v32
  v_lshl_add_u32 v33, v151, 1, v155
  v_lshrrev_b32_e64 v127, 1, v33
  v_mul_u32_u24 v142, 0x4100, v127
  v_and_b32_e64 v127, 1, v127
  v_lshl_add_u32 v142, v127, 5, v142
  v_and_b32_e64 v127, 1, v33
  v_mul_u32_u24 v127, 0x790, v127
  v_add3_u32 v4, v142, v127, v129
  v_lshl_add_u32 v34, v151, 1, 0
  v_add_u32_e64 v33, 1, v34
  v_add_u32 v129, 0xc0, v129
  v_add_u32 v129, v129, v159
  v_lshrrev_b32 v127, 1, v33
  v_mul_u32_u24 v142, 0x4100, v127
  v_and_b32_e64 v127, 1, v127
  v_lshl_add_u32 v142, v127, 5, v142
  v_and_b32_e64 v127, 1, v33
  v_mul_u32_u24 v127, 0x790, v127
  v_add3_u32 v5, v142, v127, v129
  v_add_u32_e64 v33, 2, v34
  v_lshrrev_b32_e64 v127, 1, v33
  v_mul_u32_u24 v142, 0x4100, v127
  v_and_b32_e64 v127, 1, v127
  buffer_load_dwordx4 a[4:7], v203, s[64:67], s40 offen offset:128
  s_add_u32 s40, s40, 0x3000
  v_lshl_add_u32 v142, v127, 5, v142
  v_and_b32_e64 v127, 1, v33
  v_mul_u32_u24 v127, 0x790, v127
  v_add3_u32 v251, v142, v127, v129
  v_mul_u32_u24_e64 v127, 12, v113
  v_mul_u32_u24 v128, 0x180, v141
  v_add_u32_e64 v10, v127, v128
  v_and_b32 v159, 0xf0, v118
  s_sub_u32 s32, s3, 0xf40
  v_add_u32_e64 v10, s32, v10
  v_add_u32 v2, 0xf000, v159
  v_add_u32 v0, 0x10000, v118
  v_add_u32 v1, 0x20000, v118
  v_and_b32_e64 v127, 15, v113
  v_lshlrev_b32 v127, 7, v127
  v_mul_u32_u24 v128, 0x18000, v155
  s_sub_u32 s32, s3, 64
  v_add3_u32 v248, v127, v128, s32
  v_mul_u32_u24 v127, 0x5555, v153
  v_and_b32 v128, 2, v153
  v_lshlrev_b32 v128, 15, v128
  v_sub_u32_e64 v127, v127, v128
  v_add_u32 v250, 0x3e9a0000, v127
  s_add_u32 s32, s14, 0x16000
  v_lshl_add_u32 v142, v141, 8, s32
  v_mul_u32_u24 v127, 43, v123
  v_lshrrev_b32 v127, 8, v127
  buffer_load_dwordx4 a[8:11], v203, s[64:67], s40 offen
  v_mul_u32_u24 v127, 0x17f0, v127
  v_lshl_add_u32 v128, v123, 10, v142
  v_sub_u32 v244, v128, v127
  v_add_u32 v128, 32, v123
  v_mul_u32_u24 v127, 43, v128
  v_lshrrev_b32 v127, 8, v127
  v_mul_u32_u24 v127, 0x17f0, v127
  v_lshl_add_u32 v128, v128, 10, v142
  v_sub_u32 v245, v128, v127
  v_add_u32 v128, 64, v123
  v_mul_u32_u24 v127, 43, v128
  v_lshrrev_b32 v127, 8, v127
  v_mul_u32_u24 v127, 0x17f0, v127
  v_lshl_add_u32 v128, v128, 10, v142
  v_sub_u32_e64 v246, v128, v127
  v_bfe_u32 v127, v122, 2, 2
  v_xor_b32_e64 v127, v127, v141
  v_lshl_add_u32 v127, v127, 4, s32
  v_mul_u32_u24 v128, 0xc0, v122
  v_add_u32_e64 v247, v127, v128
  v_xor_b32 v252, 32, v247
  s_add_u32 s30, s15, 32
  s_add_u32 s31, s15, 0x4100
  s_sub_u32 s28, s59, 0x60000
  s_add_u32 s33, s15, 0x8200
  s_mov_b32 s23, 0x60000
  s_mov_b32 s26, 6
  buffer_load_dwordx4 a[12:15], v203, s[64:67], s40 offen offset:128
  buffer_load_dwordx4 a[16:19], v203, s[64:67], s41 offen
  buffer_load_dwordx4 a[20:23], v203, s[64:67], s41 offen offset:128
  s_waitcnt vmcnt(25)
  v_lshl_or_b32 v131, v131, 16, v131
  v_and_b32 v16, v56, v131
  v_and_b32 v17, v57, v131
  v_and_b32 v18, v58, v131
  v_and_b32 v19, v59, v131
  ds_write_b128 v144, v[16:19] offset:49920
  s_waitcnt vmcnt(24)
  v_lshl_or_b32 v132, v132, 16, v132
  v_and_b32 v20, v56, v132
  v_and_b32 v21, v57, v132
  v_and_b32 v22, v58, v132
  v_and_b32_e64 v23, v59, v132
  ds_write_b128 v145, v[20:23] offset:53120
  s_waitcnt vmcnt(23)
  v_and_b32 v24, v148, v133
  v_and_b32 v25, v149, v133
  ds_write_b64 v147, v[24:25] offset:54784
  s_waitcnt vmcnt(22)
  v_and_b32 v26, v148, v134
  v_and_b32 v27, v149, v134
  ds_write_b64 v147, v[26:27] offset:56832
  s_waitcnt vmcnt(21)
  v_and_b32 v28, v148, v135
  v_and_b32_e64 v29, v149, v135
  ds_write_b64 v147, v[28:29] offset:58880
  s_waitcnt vmcnt(20)
  v_lshlrev_b32 v139, 16, v139
  s_waitcnt vmcnt(19)
  v_lshlrev_b32 v140, 16, v140
  v_mul_f32 v140, v139, v140
  s_waitcnt vmcnt(18)
  v_lshlrev_b32 v136, 16, v136
  s_waitcnt vmcnt(17)
  v_lshlrev_b32 v137, 16, v137
  s_waitcnt vmcnt(16)
  v_lshlrev_b32 v138, 16, v138
  v_xor_b32 v143, 16, v143
  v_mul_f32 v136, 4.0, v136
  v_mul_f32 v137, 4.0, v137
  v_mul_f32 v138, 4.0, v138
  v_lshrrev_b32 v136, v143, v136
  v_lshrrev_b32 v137, v143, v137
  v_lshrrev_b32 v138, v143, v138
  v_mov_b32 v16, v140
  v_mov_b32 v17, v140
  v_mov_b32 v18, v140
  v_mov_b32 v19, v140
  ds_write_b128 v146, v[16:19] offset:61440
  s_waitcnt lgkmcnt(0)
  s_barrier
  ds_read_b128 a[96:99], v3
  ds_read2_b64 a[100:103], v11 offset0:0 offset1:8
  ds_read_b128 a[104:107], v3 offset:400
  ds_read2_b64 a[108:111], v11 offset0:32 offset1:40
  ds_read_b128 a[112:115], v3 offset:800
  ds_read2_b64 a[116:119], v11 offset0:64 offset1:72
  v_and_b32 v127, v216, v136
  v_and_b32 v128, v217, v136
  buffer_load_dwordx4 a[24:27], v203, s[64:67], s42 offen
  v_and_b32 v129, v218, v136
  v_and_b32 v142, v219, v136
  v_accvgpr_write_b32 a192, v127
  v_accvgpr_write_b32 a193, v128
  v_accvgpr_write_b32 a194, v129
  v_accvgpr_write_b32 a195, v142
  v_and_b32 v127, v220, v136
  v_and_b32 v128, v221, v136
  v_and_b32_e64 v129, v222, v136
  buffer_load_dwordx4 a[28:31], v203, s[64:67], s42 offen offset:128
  s_add_u32 s42, s42, 0x3000
  v_and_b32_e64 v142, v223, v136
  ds_read_b128 a[120:123], v3 offset:1200
  ds_read2_b64 a[124:127], v11 offset0:96 offset1:104
  ds_read_b128 a[128:131], v3 offset:1600
  ds_read2_b64 a[132:135], v11 offset0:128 offset1:136
  ds_read_b128 a[136:139], v3 offset:2000
  ds_read2_b64 a[140:143], v11 offset0:160 offset1:168
  v_accvgpr_write_b32 a196, v127
  v_accvgpr_write_b32 a197, v128
  buffer_load_dwordx4 a[32:35], v203, s[64:67], s42 offen
  v_accvgpr_write_b32 a198, v129
  v_accvgpr_write_b32 a199, v142
  v_and_b32 v127, v216, v137
  v_and_b32 v128, v217, v137
  v_and_b32_e64 v129, v218, v137
  v_and_b32 v142, v219, v137
  v_accvgpr_write_b32 a200, v127
  v_accvgpr_write_b32 a201, v128
  v_accvgpr_write_b32 a202, v129
  buffer_load_dwordx4 a[36:39], v203, s[64:67], s42 offen offset:128
  s_add_u32 s42, s42, s18
  v_accvgpr_write_b32 a203, v142
  ds_read_b128 a[144:147], v3 offset:2400
  ds_read2_b64 a[148:151], v11 offset0:192 offset1:200
  ds_read_b128 a[152:155], v3 offset:2800
  ds_read2_b64 a[156:159], v11 offset0:224 offset1:232
  ds_read_b128 a[160:163], v3 offset:3200
  ds_read2_b64 a[240:243], v205 offset0:0 offset1:8
  v_and_b32 v127, v220, v137
  v_and_b32 v128, v221, v137
  buffer_load_dwordx4 a[40:43], v203, s[64:67], s42 offen
  v_and_b32 v129, v222, v137
  v_and_b32 v142, v223, v137
  v_accvgpr_write_b32 a204, v127
  v_accvgpr_write_b32 a205, v128
  v_accvgpr_write_b32 a206, v129
  v_accvgpr_write_b32 a207, v142
  v_and_b32 v127, v216, v138
  v_and_b32 v128, v217, v138
  v_and_b32_e64 v129, v218, v138
  buffer_load_dwordx4 a[44:47], v203, s[64:67], s42 offen offset:128
  s_add_u32 s42, s42, 0x3000
  v_and_b32_e64 v142, v219, v138
  ds_read_b128 a[164:167], v3 offset:3600
  ds_read2_b64 a[244:247], v205 offset0:32 offset1:40
  ds_read_b128 a[168:171], v3 offset:4000
  ds_read2_b64 a[248:251], v205 offset0:64 offset1:72
  ds_read_b128 a[172:175], v3 offset:4400
  ds_read2_b64 a[252:255], v205 offset0:96 offset1:104
  v_accvgpr_write_b32 a208, v127
  v_accvgpr_write_b32 a209, v128
  buffer_load_dwordx4 a[48:51], v203, s[64:67], s42 offen
  v_accvgpr_write_b32 a210, v129
  v_accvgpr_write_b32 a211, v142
  v_and_b32 v127, v220, v138
  v_and_b32 v128, v221, v138
  v_and_b32 v129, v222, v138
  v_and_b32 v142, v223, v138
  v_accvgpr_write_b32 a212, v127
  v_accvgpr_write_b32 a213, v128
  v_accvgpr_write_b32 a214, v129
  buffer_load_dwordx4 a[52:55], v203, s[64:67], s42 offen offset:128
  s_sub_u32 s42, s42, s18
  v_accvgpr_write_b32 a215, v142
  s_waitcnt vmcnt(19)
  v_mfma_f32_32x32x16_bf16 v[16:31], a[72:75], v[184:187], 0
  s_nop 0
  buffer_load_dwordx4 a[56:59], v203, s[64:67], s42 offen
  s_waitcnt vmcnt(19)
  v_mfma_f32_32x32x16_bf16 v[16:31], a[76:79], v[188:191], v[16:31]
  s_waitcnt vmcnt(18)
  v_mfma_f32_32x32x16_bf16 v[32:47], a[80:83], v[184:187], 0
  s_nop 0
  buffer_load_dwordx4 a[60:63], v203, s[64:67], s42 offen offset:128
  s_add_u32 s42, s42, 0x3000
  s_waitcnt vmcnt(15)
  v_mfma_f32_32x32x16_bf16 v[48:63], a[0:3], v[224:227], v[16:31]
  s_nop 0
  buffer_load_dwordx4 a[64:67], v203, s[64:67], s42 offen
  v_mfma_f32_32x32x16_bf16 v[32:47], a[84:87], v[188:191], v[32:47]
  s_waitcnt vmcnt(15)
  v_mfma_f32_32x32x16_bf16 v[48:63], a[4:7], v[228:231], v[48:63]
  buffer_load_dwordx4 a[68:71], v203, s[64:67], s42 offen offset:128
  s_waitcnt vmcnt(15)
  v_mfma_f32_32x32x16_bf16 v[160:175], a[8:11], v[224:227], v[16:31]
  s_add_u32 m0, s15, 0x8200
  s_nop 0
  buffer_load_dwordx4 v6, s[4:7], s49 offen lds
  s_waitcnt vmcnt(15)
  v_mfma_f32_32x32x16_bf16 v[160:175], a[12:15], v[228:231], v[160:175]
  s_nop 0
  buffer_load_dwordx4 v7, s[4:7], s49 offen offset:1024 lds
  s_nop 2
  v_cvt_pk_bf16_f32 v64, v48, v52
  v_cvt_pk_bf16_f32 v65, v56, v60
  v_cvt_pk_bf16_f32 v68, v49, v53
  v_cvt_pk_bf16_f32 v69, v57, v61
  v_max3_f32 v180, |v48|, |v52|, |v56|
  v_max_f32_e64 v180, |v60|, v180
  v_max3_f32 v180, |v49|, |v53|, v180
  v_max3_f32 v180, |v57|, |v61|, v180
  s_waitcnt vmcnt(15)
  v_mfma_f32_32x32x16_bf16 v[96:111], a[16:19], v[224:227], v[16:31]
  s_nop 0
  buffer_load_dwordx4 v8, s[4:7], s49 offen offset:2048 lds
  v_cvt_pk_bf16_f32 v72, v50, v54
  v_cvt_pk_bf16_f32 v73, v58, v62
  v_cvt_pk_bf16_f32 v76, v51, v55
  v_cvt_pk_bf16_f32 v77, v59, v63
  v_max3_f32 v180, |v50|, |v54|, v180
  v_max3_f32 v180, |v58|, |v62|, v180
  v_max3_f32 v180, |v51|, |v55|, v180
  v_max3_f32 v180, |v59|, |v63|, v180
  s_waitcnt vmcnt(15)
  v_mfma_f32_32x32x16_bf16 v[96:111], a[20:23], v[228:231], v[96:111]
  s_nop 0
  buffer_load_dwordx4 v9, s[4:7], s49 offen offset:3072 lds
  v_cvt_pk_bf16_f32 v66, v160, v164
  v_cvt_pk_bf16_f32 v67, v168, v172
  v_cvt_pk_bf16_f32 v70, v161, v165
  v_cvt_pk_bf16_f32 v71, v169, v173
  v_max3_f32 v180, |v160|, |v164|, v180
  v_max3_f32 v180, |v168|, |v172|, v180
  v_max3_f32 v180, |v161|, |v165|, v180
  v_max3_f32 v180, |v169|, |v173|, v180
  ds_write_b128 v195, v[64:67]
  s_waitcnt vmcnt(15)
  s_nop 0
  v_mfma_f32_32x32x16_bf16 v[48:63], a[24:27], v[224:227], v[32:47]
  s_add_u32 m0, s15, 0
  s_nop 0
  buffer_load_dwordx4 v198, s[4:7], 0 offen lds
  ds_write_b128 v195, v[68:71] offset:6144
  v_cvt_pk_bf16_f32 v74, v162, v166
  v_cvt_pk_bf16_f32 v75, v170, v174
  v_cvt_pk_bf16_f32 v78, v163, v167
  v_cvt_pk_bf16_f32 v79, v171, v175
  v_max3_f32 v180, |v162|, |v166|, v180
  v_max3_f32 v180, |v170|, |v174|, v180
  v_max3_f32 v180, |v163|, |v167|, v180
  v_max3_f32 v180, |v171|, |v175|, v180
  s_waitcnt vmcnt(15)
  v_mfma_f32_32x32x16_bf16 v[48:63], a[28:31], v[228:231], v[48:63]
  s_add_u32 m0, s15, 0x400
  s_nop 0
  buffer_load_dwordx4 v199, s[4:7], 0 offen lds
  ds_write_b128 v195, v[72:75] offset:12288
  v_cvt_pk_bf16_f32 v80, v96, v100
  v_cvt_pk_bf16_f32 v81, v104, v108
  v_cvt_pk_bf16_f32 v84, v97, v101
  v_cvt_pk_bf16_f32 v85, v105, v109
  v_max3_f32 v180, |v96|, |v100|, v180
  v_max3_f32 v180, |v104|, |v108|, v180
  v_max3_f32 v180, |v97|, |v101|, v180
  v_max3_f32 v180, |v105|, |v109|, v180
  s_waitcnt vmcnt(15)
  v_mfma_f32_32x32x16_bf16 v[160:175], a[32:35], v[224:227], v[32:47]
  s_add_u32 m0, s15, 0x800
  s_nop 0
  buffer_load_dwordx4 v200, s[4:7], 0 offen lds
  ds_write_b128 v195, v[76:79] offset:18432
  v_cvt_pk_bf16_f32 v88, v98, v102
  v_cvt_pk_bf16_f32 v89, v106, v110
  v_cvt_pk_bf16_f32 v92, v99, v103
  v_cvt_pk_bf16_f32 v93, v107, v111
  v_max3_f32 v180, |v98|, |v102|, v180
  v_max3_f32 v180, |v106|, |v110|, v180
  v_max3_f32 v180, |v99|, |v103|, v180
  v_max3_f32 v180, |v107|, |v111|, v180
  s_waitcnt vmcnt(15)
  v_mfma_f32_32x32x16_bf16 v[160:175], a[36:39], v[228:231], v[160:175]
  s_add_u32 m0, s15, 0xc00
  s_nop 0
  buffer_load_dwordx4 v201, s[4:7], 0 offen lds
  ds_write_b64 v196, v[80:81]
  ds_write_b64 v196, v[84:85] offset:6144
  v_cvt_pk_bf16_f32 v64, v48, v52
  v_cvt_pk_bf16_f32 v65, v56, v60
  v_cvt_pk_bf16_f32 v68, v49, v53
  v_cvt_pk_bf16_f32 v69, v57, v61
  v_max3_f32 v176, |v48|, |v52|, |v56|
  v_max_f32_e64 v176, |v60|, v176
  v_max3_f32 v177, |v49|, |v53|, |v57|
  v_max_f32_e64 v177, |v61|, v177
  s_waitcnt vmcnt(15)
  v_mfma_f32_32x32x16_bf16 v[96:111], a[40:43], v[224:227], v[32:47]
  s_add_u32 m0, s14, 0x22000
  s_nop 0
  buffer_load_dwordx4 v253, s[72:75], s57 offen lds
  ds_write_b64 v196, v[88:89] offset:12288
  ds_write_b64 v196, v[92:93] offset:18432
  v_cvt_pk_bf16_f32 v72, v50, v54
  v_cvt_pk_bf16_f32 v73, v58, v62
  v_cvt_pk_bf16_f32 v76, v51, v55
  v_cvt_pk_bf16_f32 v77, v59, v63
  v_max3_f32 v178, |v50|, |v54|, |v58|
  v_max_f32_e64 v178, |v62|, v178
  v_max3_f32 v179, |v51|, |v55|, |v59|
  v_max_f32_e64 v179, |v63|, v179
  s_waitcnt vmcnt(15)
  v_mfma_f32_32x32x16_bf16 v[96:111], a[44:47], v[228:231], v[96:111]
  s_nop 0
  buffer_load_dwordx4 v254, s[72:75], s57 offen offset:1024 lds
  v_cvt_pk_bf16_f32 v66, v160, v164
  v_cvt_pk_bf16_f32 v67, v168, v172
  v_cvt_pk_bf16_f32 v70, v161, v165
  v_cvt_pk_bf16_f32 v71, v169, v173
  v_max3_f32 v176, |v160|, |v164|, v176
  v_max3_f32 v176, |v168|, |v172|, v176
  v_max3_f32 v177, |v161|, |v165|, v177
  v_max3_f32 v177, |v169|, |v173|, v177
  ds_write_b128 v197, v[64:67]
  s_waitcnt vmcnt(15)
  v_mfma_f32_32x32x16_bf16 v[48:63], a[48:51], v[224:227], v[32:47]
  s_nop 0
  buffer_load_dwordx4 v255, s[72:75], s57 offen offset:2048 lds
  ds_write_b128 v197, v[68:71] offset:6144
  v_cvt_pk_bf16_f32 v74, v162, v166
  v_cvt_pk_bf16_f32 v75, v170, v174
  v_cvt_pk_bf16_f32 v78, v163, v167
  v_cvt_pk_bf16_f32 v79, v171, v175
  v_max3_f32 v178, |v162|, |v166|, v178
  v_max3_f32 v178, |v170|, |v174|, v178
  v_max3_f32 v179, |v163|, |v167|, v179
  v_max3_f32 v179, |v171|, |v175|, v179
  s_waitcnt vmcnt(15)
  v_mfma_f32_32x32x16_bf16 v[48:63], a[52:55], v[228:231], v[48:63]
  s_add_u32 m0, s14, 0x22c00
  s_nop 0
  buffer_load_dwordx4 v253, s[72:75], s58 offen lds
  ds_write_b128 v197, v[72:75] offset:12288
  v_cvt_pk_bf16_f32 v80, v96, v100
  v_cvt_pk_bf16_f32 v81, v104, v108
  v_cvt_pk_bf16_f32 v84, v97, v101
  v_cvt_pk_bf16_f32 v85, v105, v109
  v_max3_f32 v176, |v96|, |v100|, v176
  v_max3_f32 v176, |v104|, |v108|, v176
  v_max3_f32 v177, |v97|, |v101|, v177
  v_max3_f32 v177, |v105|, |v109|, v177
  s_waitcnt vmcnt(15)
  v_mfma_f32_32x32x16_bf16 v[160:175], a[56:59], v[224:227], v[32:47]
  s_nop 0
  buffer_load_dwordx4 v254, s[72:75], s58 offen offset:1024 lds
  ds_write_b128 v197, v[76:79] offset:18432
  v_cvt_pk_bf16_f32 v88, v98, v102
  v_cvt_pk_bf16_f32 v89, v106, v110
  v_cvt_pk_bf16_f32 v92, v99, v103
  v_cvt_pk_bf16_f32 v93, v107, v111
  v_max3_f32 v178, |v98|, |v102|, v178
  v_max3_f32 v178, |v106|, |v110|, v178
  v_max3_f32 v179, |v99|, |v103|, v179
  v_max3_f32 v179, |v107|, |v111|, v179
  v_mfma_f32_32x32x16_bf16 v[96:111], a[88:91], v[224:227], v[32:47]
  s_waitcnt vmcnt(15)
  v_mfma_f32_32x32x16_bf16 v[160:175], a[60:63], v[228:231], v[160:175]
  s_nop 0
  buffer_load_dwordx4 v255, s[72:75], s58 offen offset:2048 lds
  v_cvt_pk_bf16_f32 v82, v48, v52
  v_cvt_pk_bf16_f32 v83, v56, v60
  v_cvt_pk_bf16_f32 v86, v49, v53
  v_cvt_pk_bf16_f32 v87, v57, v61
  v_max3_f32 v176, |v48|, |v52|, v176
  v_max3_f32 v176, |v56|, |v60|, v176
  v_max3_f32 v177, |v49|, |v53|, v177
  v_max3_f32 v177, |v57|, |v61|, v177
  ds_write_b128 v197, v[80:83] offset:512
  v_mfma_f32_32x32x16_bf16 v[96:111], a[92:95], v[228:231], v[96:111]
  s_waitcnt vmcnt(15)
  v_mfma_f32_32x32x16_bf16 v[96:111], a[64:67], v[224:227], v[96:111]
  s_nop 0
  ds_write_b128 v197, v[84:87] offset:6656
  v_cvt_pk_bf16_f32 v90, v50, v54
  v_cvt_pk_bf16_f32 v91, v58, v62
  v_cvt_pk_bf16_f32 v94, v51, v55
  v_cvt_pk_bf16_f32 v95, v59, v63
  v_max3_f32 v178, |v50|, |v54|, v178
  v_max3_f32 v178, |v58|, |v62|, v178
  v_max3_f32 v179, |v51|, |v55|, v179
  v_max3_f32 v179, |v59|, |v63|, v179
  s_waitcnt vmcnt(14)
  v_mfma_f32_32x32x16_bf16 v[96:111], a[68:71], v[228:231], v[96:111]
  s_nop 0
  ds_write_b128 v197, v[88:91] offset:12800
  v_cvt_pk_bf16_f32 v64, v160, v164
  v_cvt_pk_bf16_f32 v65, v168, v172
  v_cvt_pk_bf16_f32 v68, v161, v165
  v_cvt_pk_bf16_f32 v69, v169, v173
  v_max3_f32 v176, |v160|, |v164|, v176
  v_max3_f32 v176, |v168|, |v172|, v176
  v_max3_f32 v177, |v161|, |v165|, v177
  v_max3_f32 v177, |v169|, |v173|, v177
  ds_write_b128 v197, v[92:95] offset:18944
  v_cvt_pk_bf16_f32 v72, v162, v166
  v_cvt_pk_bf16_f32 v73, v170, v174
  v_cvt_pk_bf16_f32 v76, v163, v167
  v_cvt_pk_bf16_f32 v77, v171, v175
  v_max3_f32 v178, |v162|, |v166|, v178
  v_max3_f32 v178, |v170|, |v174|, v178
  v_max3_f32 v179, |v163|, |v167|, v179
  v_max3_f32 v179, |v171|, |v175|, v179
  v_cvt_pk_bf16_f32 v66, v96, v100
  v_cvt_pk_bf16_f32 v67, v104, v108
  v_cvt_pk_bf16_f32 v70, v97, v101
  v_cvt_pk_bf16_f32 v71, v105, v109
  v_max3_f32 v176, |v96|, |v100|, v176
  v_max3_f32 v176, |v104|, |v108|, v176
  v_max3_f32 v177, |v97|, |v101|, v177
  v_max3_f32 v177, |v105|, |v109|, v177
  ds_write_b128 v197, v[64:67] offset:1024
  ds_write_b128 v197, v[68:71] offset:7168
  v_cvt_pk_bf16_f32 v74, v98, v102
  v_cvt_pk_bf16_f32 v75, v106, v110
  v_cvt_pk_bf16_f32 v78, v99, v103
  v_cvt_pk_bf16_f32 v79, v107, v111
  v_max3_f32 v178, |v98|, |v102|, v178
  v_max3_f32 v178, |v106|, |v110|, v178
  v_max3_f32 v179, |v99|, |v103|, v179
  v_max3_f32 v179, |v107|, |v111|, v179
  ds_write_b128 v197, v[72:75] offset:13312
  ds_write_b128 v197, v[76:79] offset:19456
  s_waitcnt lgkmcnt(0)
  s_barrier
  v_max3_f32 v180, v180, v176, v177
  v_min3_f32 v176, v176, v177, v178
  v_max3_f32 v180, v180, v178, v179
  v_min_f32_e64 v176, v176, v179
  v_cmp_le_u32 vcc, 0x43800000, v180
  s_nop 0
  s_cmp_lg_u64 vcc, 0
  s_cselect_b32 s3, 1, 0
  v_cmp_gt_u32 vcc, 0x3a000000, v176
  s_nop 0
  s_cmp_lg_u64 vcc, 0
  s_cselect_b32 s3, 1, s3
  ds_read_b128 a[0:3], v0 offset:24576
  ds_read_b128 a[4:7], v0 offset:27648
  ds_read_b128 a[8:11], v0 offset:25600
  ds_read_b128 a[12:15], v0 offset:28672
  ds_read_b128 a[16:19], v0 offset:26624
  ds_read_b128 a[20:23], v0 offset:29696
  ds_read_b128 a[24:27], v0 offset:30720
  ds_read_b128 a[28:31], v0 offset:33792
  ds_read_b128 a[32:35], v0 offset:31744
  ds_read_b128 a[36:39], v0 offset:34816
  ds_read_b128 a[40:43], v0 offset:32768
  ds_read_b128 a[44:47], v0 offset:35840
  ds_read_b128 a[48:51], v0 offset:36864
  ds_read_b128 a[52:55], v0 offset:39936
  ds_read_b128 a[56:59], v0 offset:37888
  ds_read_b128 a[60:63], v0 offset:40960
  ds_read_b128 a[64:67], v0 offset:38912
  ds_read_b128 a[68:71], v0 offset:41984
  ds_read_b128 a[72:75], v0 offset:43008
  ds_read_b128 a[76:79], v0 offset:46080
  ds_read_b128 a[80:83], v0 offset:44032
  ds_read_b128 a[84:87], v0 offset:47104
  ds_read_b128 a[88:91], v0 offset:45056
  ds_read_b128 a[92:95], v0 offset:48128
  s_waitcnt vmcnt(6)
  s_nop 0
  ds_read_b128 v[160:163], v4
  ds_read_b128 v[164:167], v4 offset:192
  ds_read_b128 v[168:171], v4 offset:384
  ds_read_b128 v[172:175], v4 offset:16
  ds_read_b128 v[176:179], v4 offset:208
  ds_read_b128 v[180:183], v4 offset:400
  ds_read_b128 v[216:219], v4 offset:32
  ds_read_b128 v[220:223], v4 offset:224
  ds_read_b128 v[224:227], v4 offset:416
  ds_read_b128 v[228:231], v4 offset:48
  ds_read_b128 v[232:235], v4 offset:240
  ds_read_b128 v[236:239], v4 offset:432
  s_waitcnt lgkmcnt(11)
  v_mfma_f32_16x16x32_bf16 v[112:115], a[96:99], v[160:163], 0
  ds_read_b128 v[160:163], v4 offset:64
  s_waitcnt lgkmcnt(9)
  v_mfma_f32_16x16x32_bf16 v[116:119], a[104:107], v[172:175], 0
  s_waitcnt lgkmcnt(0)
  ds_read_b128 v[172:175], v4 offset:80
  s_nop 0
  v_smfmac_f32_16x16x64_bf16 v[112:115], a[100:103], v[164:171], v250
  s_nop 0
  ds_read_b128 v[164:167], v4 offset:256
  ds_read_b128 v[168:171], v4 offset:448
  v_mfma_f32_16x16x32_bf16 v[120:123], a[112:115], v[216:219], 0
  s_waitcnt lgkmcnt(2)
  ds_read_b128 v[216:219], v4 offset:96
  v_smfmac_f32_16x16x64_bf16 v[116:119], a[108:111], v[176:183], v250
  ds_read_b128 v[176:179], v4 offset:272
  ds_read_b128 v[180:183], v4 offset:464
  v_mfma_f32_16x16x32_bf16 v[124:127], a[120:123], v[228:231], 0
  s_waitcnt lgkmcnt(2)
  ds_read_b128 v[228:231], v4 offset:112
  v_smfmac_f32_16x16x64_bf16 v[120:123], a[116:119], v[220:227], v250
  ds_read_b128 v[220:223], v4 offset:288
  ds_read_b128 v[224:227], v4 offset:480
  v_mfma_f32_16x16x32_bf16 v[128:131], a[128:131], v[160:163], 0
  s_waitcnt lgkmcnt(2)
  ds_read_b128 v[160:163], v4 offset:128
  v_smfmac_f32_16x16x64_bf16 v[124:127], a[124:127], v[232:239], v250
  ds_read_b128 v[232:235], v4 offset:304
  ds_read_b128 v[236:239], v4 offset:496
  v_mfma_f32_16x16x32_bf16 v[132:135], a[136:139], v[172:175], 0
  s_waitcnt lgkmcnt(2)
  ds_read_b128 v[172:175], v4 offset:144
  v_smfmac_f32_16x16x64_bf16 v[128:131], a[132:135], v[164:171], v250
  s_nop 0
  ds_read_b128 v[164:167], v4 offset:320
  ds_read_b128 v[168:171], v4 offset:512
  v_mfma_f32_16x16x32_bf16 v[136:139], a[144:147], v[216:219], 0
  s_waitcnt lgkmcnt(2)
  ds_read_b128 v[216:219], v4 offset:160
  v_smfmac_f32_16x16x64_bf16 v[132:135], a[140:143], v[176:183], v250
  ds_read_b128 v[176:179], v4 offset:336
  ds_read_b128 v[180:183], v4 offset:528
  v_mfma_f32_16x16x32_bf16 v[140:143], a[152:155], v[228:231], 0
  s_waitcnt lgkmcnt(2)
  ds_read_b128 v[228:231], v4 offset:176
  v_smfmac_f32_16x16x64_bf16 v[136:139], a[148:151], v[220:227], v250
  ds_read_b128 v[220:223], v4 offset:352
  ds_read_b128 v[224:227], v4 offset:544
  v_mfma_f32_16x16x32_bf16 v[144:147], a[160:163], v[160:163], 0
  s_waitcnt lgkmcnt(2)
  v_smfmac_f32_16x16x64_bf16 v[140:143], a[156:159], v[232:239], v250
  s_nop 0
  ds_read_b128 v[232:235], v4 offset:368
  ds_read_b128 v[236:239], v4 offset:560
  v_mfma_f32_16x16x32_bf16 v[148:151], a[164:167], v[172:175], 0
  s_nop 0
  v_smfmac_f32_16x16x64_bf16 v[144:147], a[240:243], v[164:171], v250
  s_nop 0
  v_mfma_f32_16x16x32_bf16 v[152:155], a[168:171], v[216:219], 0
  s_nop 2
  v_smfmac_f32_16x16x64_bf16 v[148:151], a[244:247], v[176:183], v250
  v_mfma_f32_16x16x32_bf16 v[156:159], a[172:175], v[228:231], 0
  s_waitcnt lgkmcnt(2)
  v_smfmac_f32_16x16x64_bf16 v[152:155], a[248:251], v[220:227], v250
  s_waitcnt lgkmcnt(0)
  s_nop 2
  v_smfmac_f32_16x16x64_bf16 v[156:159], a[252:255], v[232:239], v250
  buffer_load_dword v249, v248, s[4:7], s29 offen
  v_pk_mul_f32 v[14:15], v[112:113], v[112:113]
  v_pk_mul_f32 v[182:183], v[114:115], v[114:115]
  v_pk_add_f32 v[12:13], v[112:113], v[116:117]
  v_pk_fma_f32 v[14:15], v[116:117], v[116:117], v[14:15]
  v_pk_add_f32 v[180:181], v[114:115], v[118:119]
  v_pk_fma_f32 v[182:183], v[118:119], v[118:119], v[182:183]
  v_pk_add_f32 v[12:13], v[12:13], v[120:121]
  v_pk_fma_f32 v[14:15], v[120:121], v[120:121], v[14:15]
  v_pk_add_f32 v[180:181], v[180:181], v[122:123]
  v_pk_fma_f32 v[182:183], v[122:123], v[122:123], v[182:183]
  v_pk_add_f32 v[12:13], v[12:13], v[124:125]
  v_pk_fma_f32 v[14:15], v[124:125], v[124:125], v[14:15]
  ds_read_b128 v[160:163], v0 offset:18432
  ds_read_b128 v[164:167], v0 offset:21504
  ds_read_b128 v[168:171], v0 offset:19456
  ds_read_b128 v[172:175], v0 offset:22528
  v_pk_add_f32 v[180:181], v[180:181], v[126:127]
  v_pk_fma_f32 v[182:183], v[126:127], v[126:127], v[182:183]
  v_pk_add_f32 v[12:13], v[12:13], v[128:129]
  v_pk_fma_f32 v[14:15], v[128:129], v[128:129], v[14:15]
  v_pk_add_f32 v[180:181], v[180:181], v[130:131]
  v_pk_fma_f32 v[182:183], v[130:131], v[130:131], v[182:183]
  v_pk_add_f32 v[12:13], v[12:13], v[132:133]
  v_pk_fma_f32 v[14:15], v[132:133], v[132:133], v[14:15]
  v_pk_add_f32 v[180:181], v[180:181], v[134:135]
  v_pk_fma_f32 v[182:183], v[134:135], v[134:135], v[182:183]
  v_pk_add_f32 v[12:13], v[12:13], v[136:137]
  v_pk_fma_f32 v[14:15], v[136:137], v[136:137], v[14:15]
  ds_read_b128 v[176:179], v0 offset:20480
  ds_read_b128 a[96:99], v0 offset:49152
  ds_read_b128 a[100:103], v0 offset:52224
  ds_read_b128 a[104:107], v0 offset:50176
  v_pk_add_f32 v[180:181], v[180:181], v[138:139]
  v_pk_fma_f32 v[182:183], v[138:139], v[138:139], v[182:183]
  v_pk_add_f32 v[12:13], v[12:13], v[140:141]
  v_pk_fma_f32 v[14:15], v[140:141], v[140:141], v[14:15]
  v_pk_add_f32 v[180:181], v[180:181], v[142:143]
  v_pk_fma_f32 v[182:183], v[142:143], v[142:143], v[182:183]
  v_pk_add_f32 v[12:13], v[12:13], v[144:145]
  v_pk_fma_f32 v[14:15], v[144:145], v[144:145], v[14:15]
  v_pk_add_f32 v[180:181], v[180:181], v[146:147]
  v_pk_fma_f32 v[182:183], v[146:147], v[146:147], v[182:183]
  v_pk_add_f32 v[12:13], v[12:13], v[148:149]
  v_pk_fma_f32 v[14:15], v[148:149], v[148:149], v[14:15]
  ds_read_b128 a[108:111], v0 offset:53248
  ds_read_b128 a[112:115], v0 offset:51200
  ds_read_b128 a[116:119], v0 offset:54272
  ds_read_b128 a[120:123], v0 offset:55296
  v_pk_add_f32 v[180:181], v[180:181], v[150:151]
  v_pk_fma_f32 v[182:183], v[150:151], v[150:151], v[182:183]
  v_pk_add_f32 v[12:13], v[12:13], v[152:153]
  v_pk_fma_f32 v[14:15], v[152:153], v[152:153], v[14:15]
  v_pk_add_f32 v[180:181], v[180:181], v[154:155]
  v_pk_fma_f32 v[182:183], v[154:155], v[154:155], v[182:183]
  v_pk_add_f32 v[12:13], v[12:13], v[156:157]
  v_pk_fma_f32 v[14:15], v[156:157], v[156:157], v[14:15]
  v_pk_add_f32 v[180:181], v[180:181], v[158:159]
  v_pk_fma_f32 v[182:183], v[158:159], v[158:159], v[182:183]
  v_add_f32 v12, v12, v13
  v_add_f32 v14, v14, v15
  ds_read_b128 a[124:127], v0 offset:58368
  ds_read_b128 a[128:131], v0 offset:56320
  ds_read_b128 a[132:135], v0 offset:59392
  ds_read_b128 a[136:139], v0 offset:57344
  v_add_f32 v180, v180, v181
  v_add_f32 v182, v182, v183
  v_permlane32_swap_b32 v12, v14
  s_nop 0
  v_permlane32_swap_b32 v180, v182
  v_add_f32 v12, v12, v14
  v_add_f32 v180, v180, v182
  s_nop 1
  v_permlane16_swap_b32 v12, v180
  v_add_f32 v12, v12, v180
  v_mov_b32 v14, v12
  s_nop 1
  v_permlane32_swap_b32 v12, v14
  v_mul_f32 v12, s24, v12
  v_mul_f32_e64 v13, s24, v14
  ds_read_b128 a[140:143], v0 offset:60416
  ds_read_b128 a[144:147], v0 offset:61440
  ds_read_b128 a[148:151], v0 offset:64512
  ds_read_b128 a[152:155], v0 offset:62464
  v_fma_f32 v13, -v12, v12, v13
  v_max_f32_e64 v13, 0, v13
  v_add_f32_e64 v13, s25, v13
  v_rsq_f32 v13, v13
  s_nop 0
  v_mul_f32_e64 v14, s22, v13
  v_mul_f32_e64 v12, -v12, v14
  v_mov_b32_e64 v182, v14
  v_mov_b32 v180, v12
  s_nop 0
  v_permlane16_swap_b32_e64 v14, v182
  v_permlane16_swap_b32_e64 v12, v180
  v_pk_fma_f32 v[112:113], v[112:113], v[14:15], v[12:13] op_sel_hi:[1,0,0]
  v_pk_fma_f32 v[114:115], v[114:115], v[182:183], v[180:181] op_sel_hi:[1,0,0]
  ds_read_b128 a[156:159], v1
  ds_read_b128 a[160:163], v0 offset:63488
  ds_read_b128 a[164:167], v1 offset:1024
  ds_read_b128 a[168:171], v1 offset:2048
  v_pk_fma_f32 v[116:117], v[116:117], v[14:15], v[12:13] op_sel_hi:[1,0,0]
  v_pk_fma_f32 v[118:119], v[118:119], v[182:183], v[180:181] op_sel_hi:[1,0,0]
  v_pk_fma_f32 v[120:121], v[120:121], v[14:15], v[12:13] op_sel_hi:[1,0,0]
  v_pk_fma_f32 v[122:123], v[122:123], v[182:183], v[180:181] op_sel_hi:[1,0,0]
  v_pk_fma_f32 v[124:125], v[124:125], v[14:15], v[12:13] op_sel_hi:[1,0,0]
  v_pk_fma_f32 v[126:127], v[126:127], v[182:183], v[180:181] op_sel_hi:[1,0,0]
  v_pk_fma_f32 v[128:129], v[128:129], v[14:15], v[12:13] op_sel_hi:[1,0,0]
  v_pk_fma_f32 v[130:131], v[130:131], v[182:183], v[180:181] op_sel_hi:[1,0,0]
  v_pk_fma_f32 v[132:133], v[132:133], v[14:15], v[12:13] op_sel_hi:[1,0,0]
  v_pk_fma_f32 v[134:135], v[134:135], v[182:183], v[180:181] op_sel_hi:[1,0,0]
  v_pk_fma_f32 v[136:137], v[136:137], v[14:15], v[12:13] op_sel_hi:[1,0,0]
  v_pk_fma_f32 v[138:139], v[138:139], v[182:183], v[180:181] op_sel_hi:[1,0,0]
  ds_read_b128 a[172:175], v1 offset:5120
  ds_read_b128 a[176:179], v1 offset:3072
  ds_read_b128 a[180:183], v1 offset:6144
  ds_read_b128 a[184:187], v1 offset:4096
  v_pk_fma_f32 v[140:141], v[140:141], v[14:15], v[12:13] op_sel_hi:[1,0,0]
  v_pk_fma_f32 v[142:143], v[142:143], v[182:183], v[180:181] op_sel_hi:[1,0,0]
  v_pk_fma_f32 v[144:145], v[144:145], v[14:15], v[12:13] op_sel_hi:[1,0,0]
  v_pk_fma_f32 v[146:147], v[146:147], v[182:183], v[180:181] op_sel_hi:[1,0,0]
  v_pk_fma_f32 v[148:149], v[148:149], v[14:15], v[12:13] op_sel_hi:[1,0,0]
  v_pk_fma_f32 v[150:151], v[150:151], v[182:183], v[180:181] op_sel_hi:[1,0,0]
  v_pk_fma_f32 v[152:153], v[152:153], v[14:15], v[12:13] op_sel_hi:[1,0,0]
  v_pk_fma_f32 v[154:155], v[154:155], v[182:183], v[180:181] op_sel_hi:[1,0,0]
  v_pk_fma_f32 v[156:157], v[156:157], v[14:15], v[12:13] op_sel_hi:[1,0,0]
  v_pk_fma_f32 v[158:159], v[158:159], v[182:183], v[180:181] op_sel_hi:[1,0,0]
  v_cndmask_b32 v157, v157, v250, s[12:13]
  v_cndmask_b32 v159, v159, v250, s[12:13]
  ds_read_b128 a[188:191], v1 offset:7168
  ds_read_b128 v[180:183], v0 offset:23552
  v_cvt_pk_bf16_f32 v216, v112, v113
  v_cvt_pk_bf16_f32 v217, v116, v117
  v_cvt_pk_bf16_f32 v218, v120, v121
  v_cvt_pk_bf16_f32 v219, v124, v125
  v_cvt_pk_bf16_f32 v220, v114, v115
  v_cvt_pk_bf16_f32 v221, v118, v119
  v_cvt_pk_bf16_f32 v222, v122, v123
  v_cvt_pk_bf16_f32 v223, v126, v127
  v_cvt_pk_bf16_f32 v224, v128, v129
  v_cvt_pk_bf16_f32 v225, v132, v133
  v_cvt_pk_bf16_f32 v226, v136, v137
  v_cvt_pk_bf16_f32 v227, v140, v141
  v_cvt_pk_bf16_f32 v228, v130, v131
  v_cvt_pk_bf16_f32 v229, v134, v135
  v_cvt_pk_bf16_f32 v230, v138, v139
  v_cvt_pk_bf16_f32 v231, v142, v143
  v_cvt_pk_bf16_f32 v232, v144, v145
  v_cvt_pk_bf16_f32 v233, v148, v149
  v_cvt_pk_bf16_f32 v234, v152, v153
  v_cvt_pk_bf16_f32 v235, v156, v157
  v_cvt_pk_bf16_f32 v236, v146, v147
  v_cvt_pk_bf16_f32 v237, v150, v151
  v_cvt_pk_bf16_f32 v238, v154, v155
  v_cvt_pk_bf16_f32 v239, v158, v159
  s_waitcnt lgkmcnt(15)
  v_mfma_f32_16x16x32_bf16 v[16:19], v[160:163], v[216:219], 0
  s_waitcnt vmcnt(1)
  ds_read_b128 a[216:219], v247 offset:49152
  ds_read_b128 a[220:223], v252 offset:49152
  ds_read_b128 a[224:227], v247 offset:49216
  v_lshlrev_b32_e64 v32, 16, v240
  v_mfma_f32_16x16x32_bf16 v[24:27], v[160:163], v[220:223], 0
  s_add_u32 s59, s28, 0x18000
  ds_read_b128 a[228:231], v252 offset:49216
  ds_read_b128 a[232:235], v247 offset:49280
  ds_read_b128 a[236:239], v252 offset:49280
  v_lshlrev_b32_e64 v33, 16, v241
  v_mfma_f32_16x16x32_bf16 v[20:23], v[164:167], v[216:219], 0
  s_add_u32 s57, s28, 0x30000
  ds_read2_b32 v[136:137], v5 offset0:0 offset1:3
  ds_read2_b32 v[138:139], v5 offset0:6 offset1:9
  ds_read_b128 v[160:163], v2
  v_lshlrev_b32_e64 v34, 16, v242
  v_mfma_f32_16x16x32_bf16 v[28:31], v[164:167], v[220:223], 0
  s_add_u32 s15, s28, 0x48000
  ds_read_b128 v[164:167], v2 offset:256
  v_lshlrev_b32_e64 v35, 16, v243
  v_mfma_f32_16x16x32_bf16 v[16:19], v[168:171], v[224:227], v[16:19]
  s_add_u32 m0, s14, 0x16000
  ds_read2_b32 v[140:141], v5 offset0:1 offset1:4
  v_mfma_f32_16x16x32_bf16 v[24:27], v[168:171], v[228:231], v[24:27]
  ds_read_b128 v[168:171], v2 offset:512
  v_mfma_f32_16x16x32_bf16 v[20:23], v[172:175], v[224:227], v[20:23]
  ds_read2_b32 v[142:143], v5 offset0:7 offset1:10
  v_mfma_f32_16x16x32_bf16 v[28:31], v[172:175], v[228:231], v[28:31]
  ds_read_b128 v[172:175], v2 offset:768
  v_mfma_f32_16x16x32_bf16 v[16:19], v[176:179], v[232:235], v[16:19]
  ds_read2_b32 v[144:145], v5 offset0:2 offset1:5
  v_mfma_f32_16x16x32_bf16 v[24:27], v[176:179], v[236:239], v[24:27]
  ds_read_b128 v[176:179], v2 offset:1024
  s_nop 0
  s_waitcnt lgkmcnt(15)
  v_mfma_f32_16x16x32_bf16 v[20:23], v[180:183], v[232:235], v[20:23]
  ds_read2_b32 v[146:147], v5 offset0:8 offset1:11
  v_mfma_f32_16x16x32_bf16 v[28:31], v[180:183], v[236:239], v[28:31]
  s_waitcnt lgkmcnt(7)
  ds_read_b128 v[180:183], v2 offset:1280
  s_nop 0
  v_mfma_f32_32x32x16_bf16 v[64:79], a[216:219], a[192:195], 0
  ds_read2_b32 v[148:149], v251 offset0:0 offset1:3
  v_cvt_pk_f16_f32 v48, v16, v17
  v_cvt_pk_f16_f32 v49, v18, v19
  v_cvt_pk_f16_f32 v50, v20, v21
  v_cvt_pk_f16_f32 v51, v22, v23
  v_cvt_pk_f16_f32 v52, v24, v25
  v_mfma_f32_32x32x16_bf16 v[64:79], a[220:223], a[196:199], v[64:79]
  v_cvt_pk_f16_f32 v53, v26, v27
  v_cvt_pk_f16_f32 v54, v28, v29
  v_cvt_pk_f16_f32 v55, v30, v31
  v_pk_fma_f16 v56, v48, v48, s20 op_sel_hi:[1,1,0] neg_lo:[1,0,0] neg_hi:[1,0,0] clamp
  v_pk_fma_f16 v57, v49, v49, s20 op_sel_hi:[1,1,0] neg_lo:[1,0,0] neg_hi:[1,0,0] clamp
  v_pk_fma_f16 v58, v50, v50, s20 op_sel_hi:[1,1,0] neg_lo:[1,0,0] neg_hi:[1,0,0] clamp
  v_mfma_f32_32x32x16_bf16 v[80:95], a[224:227], a[200:203], 0
  ds_read2_b32 v[150:151], v251 offset0:6 offset1:9
  v_pk_fma_f16 v59, v51, v51, s20 op_sel_hi:[1,1,0] neg_lo:[1,0,0] neg_hi:[1,0,0] clamp
  v_pk_fma_f16 v184, v56, v56, s20 op_sel:[0,0,1]
  v_pk_fma_f16 v185, v57, v57, s20 op_sel:[0,0,1]
  v_pk_fma_f16 v186, v58, v58, s20 op_sel:[0,0,1]
  v_cvt_pk_f16_f32 v64, v64, v65
  v_mfma_f32_32x32x16_bf16 v[80:95], a[228:231], a[204:207], v[80:95]
  v_cvt_pk_f16_f32 v65, v66, v67
  v_cvt_pk_f16_f32 v66, v68, v69
  v_cvt_pk_f16_f32 v67, v70, v71
  v_pk_mul_f16 v64, v64, s21 op_sel:[0,1]
  v_pk_mul_f16 v65, v65, s21 op_sel:[0,1]
  v_pk_mul_f16 v66, v66, s21 op_sel:[0,1]
  v_mfma_f32_32x32x16_bf16 v[96:111], a[232:235], a[208:211], 0
  v_pk_mul_f16 v67, v67, s21 op_sel:[0,1]
  v_cvt_pk_f16_f32 v68, v72, v73
  v_cvt_pk_f16_f32 v69, v74, v75
  v_cvt_pk_f16_f32 v70, v76, v77
  v_cvt_pk_f16_f32 v71, v78, v79
  v_pk_mul_f16 v68, v68, s21 op_sel:[0,1]
  v_mfma_f32_32x32x16_bf16 v[96:111], a[236:239], a[212:215], v[96:111]
  v_pk_mul_f16 v69, v69, s21 op_sel:[0,1]
  v_pk_mul_f16 v70, v70, s21 op_sel:[0,1]
  v_pk_mul_f16 v71, v71, s21 op_sel:[0,1]
  v_cvt_pk_f16_f32 v80, v80, v81
  v_cvt_pk_f16_f32 v81, v82, v83
  v_cvt_pk_f16_f32 v82, v84, v85
  v_mfma_f32_16x16x32_bf16 v[16:19], a[0:3], v[216:219], 0
  ds_write_b128 v244, v[64:67] offset:49152
  v_cvt_pk_f16_f32 v83, v86, v87
  v_pk_mul_f16 v80, v80, s21 op_sel:[0,1]
  v_pk_mul_f16 v81, v81, s21 op_sel:[0,1]
  v_pk_mul_f16 v82, v82, s21 op_sel:[0,1]
  v_mfma_f32_16x16x32_bf16 v[24:27], a[0:3], v[220:223], 0
  v_pk_mul_f16 v83, v83, s21 op_sel:[0,1]
  v_cvt_pk_f16_f32 v84, v88, v89
  v_cvt_pk_f16_f32 v85, v90, v91
  v_cvt_pk_f16_f32 v86, v92, v93
  v_mfma_f32_16x16x32_bf16 v[20:23], a[4:7], v[216:219], 0
  ds_write_b128 v244, v[68:71] offset:49664
  v_cvt_pk_f16_f32 v87, v94, v95
  v_pk_mul_f16 v84, v84, s21 op_sel:[0,1]
  v_pk_mul_f16 v85, v85, s21 op_sel:[0,1]
  v_pk_mul_f16 v86, v86, s21 op_sel:[0,1]
  v_pk_mul_f16 v87, v87, s21 op_sel:[0,1]
  v_cvt_pk_f16_f32 v96, v96, v97
  v_cvt_pk_f16_f32 v97, v98, v99
  v_cvt_pk_f16_f32 v98, v100, v101
  v_cvt_pk_f16_f32 v99, v102, v103
  v_pk_mul_f16 v96, v96, s21 op_sel:[0,1]
  v_pk_mul_f16 v97, v97, s21 op_sel:[0,1]
  v_pk_mul_f16 v98, v98, s21 op_sel:[0,1]
  v_pk_mul_f16 v99, v99, s21 op_sel:[0,1]
  v_cvt_pk_f16_f32 v100, v104, v105
  v_cvt_pk_f16_f32 v101, v106, v107
  v_cvt_pk_f16_f32 v102, v108, v109
  v_cvt_pk_f16_f32 v103, v110, v111
  v_pk_mul_f16 v100, v100, s21 op_sel:[0,1]
  v_pk_mul_f16 v101, v101, s21 op_sel:[0,1]
  v_pk_mul_f16 v102, v102, s21 op_sel:[0,1]
  v_pk_mul_f16 v103, v103, s21 op_sel:[0,1]
  v_mfma_f32_16x16x32_bf16 v[28:31], a[4:7], v[220:223], 0
  ds_write_b128 v245, v[80:83] offset:49152
  ds_write_b128 v245, v[84:87] offset:49664
  ds_write_b128 v246, v[96:99] offset:49152
  ds_write_b128 v246, v[100:103] offset:49664
  v_pk_fma_f16 v187, v59, v59, s20 op_sel:[0,0,1]
  s_waitcnt lgkmcnt(0)
  s_barrier
  v_mfma_f32_16x16x32_bf16 v[16:19], a[8:11], v[224:227], v[16:19]
  ds_read2_b32 v[152:153], v251 offset0:1 offset1:4
  ds_read2_b32 v[154:155], v251 offset0:7 offset1:10
  v_pk_fma_f16 v184, v184, v56, s21 op_sel_hi:[1,1,0]
  v_pk_fma_f16 v185, v185, v57, s21 op_sel_hi:[1,1,0]
  v_mfma_f32_16x16x32_bf16 v[24:27], a[8:11], v[228:231], v[24:27]
  buffer_load_dwordx4 v253, s[72:75], s53 offen lds
  buffer_load_dwordx4 v254, s[72:75], s53 offen offset:1024 lds
  buffer_load_dwordx4 v255, s[72:75], s53 offen offset:2048 lds
  v_pk_fma_f16 v186, v186, v58, s21 op_sel_hi:[1,1,0]
  v_pk_fma_f16 v187, v187, v59, s21 op_sel_hi:[1,1,0]
  v_mfma_f32_16x16x32_bf16 v[20:23], a[12:15], v[224:227], v[20:23]
  s_add_u32 m0, s14, 0x16c00
  ds_read2_b32 v[156:157], v251 offset0:2 offset1:5
  ds_read2_b32 v[158:159], v251 offset0:8 offset1:11
  ds_read_b128 v[192:195], v1 offset:8192
  v_pk_fma_f16 v184, v184, v48, 0.5 op_sel_hi:[1,1,0] clamp
  v_pk_fma_f16 v185, v185, v49, 0.5 op_sel_hi:[1,1,0] clamp
  v_mfma_f32_16x16x32_bf16 v[28:31], a[12:15], v[228:231], v[28:31]
  ds_read_b128 v[196:199], v1 offset:9216
  ds_read_b128 v[200:203], v1 offset:10240
  v_pk_fma_f16 v186, v186, v50, 0.5 op_sel_hi:[1,1,0] clamp
  v_pk_fma_f16 v187, v187, v51, 0.5 op_sel_hi:[1,1,0] clamp
  v_mfma_f32_16x16x32_bf16 v[16:19], a[16:19], v[232:235], v[16:19]
  ds_read_b128 v[204:207], v1 offset:11264
  v_pk_mul_f16 v184, v184, v48
  v_pk_mul_f16 v185, v185, v49
  v_or_b32 v12, v64, v65
  v_mfma_f32_16x16x32_bf16 v[24:27], a[16:19], v[236:239], v[24:27]
  buffer_load_dwordx4 v253, s[72:75], s54 offen lds
  buffer_load_dwordx4 v254, s[72:75], s54 offen offset:1024 lds
  buffer_load_dwordx4 v255, s[72:75], s54 offen offset:2048 lds
  v_pk_mul_f16 v186, v186, v50
  v_pk_mul_f16 v187, v187, v51
  v_mfma_f32_16x16x32_bf16 v[20:23], a[20:23], v[232:235], v[20:23]
  s_mov_b32 m0, s30
  v_pk_fma_f16 v56, v52, v52, s20 op_sel_hi:[1,1,0] neg_lo:[1,0,0] neg_hi:[1,0,0] clamp
  v_pk_fma_f16 v57, v53, v53, s20 op_sel_hi:[1,1,0] neg_lo:[1,0,0] neg_hi:[1,0,0] clamp
  v_or3_b32 v12, v66, v67, v12
  v_or3_b32 v12, v68, v69, v12
  v_mfma_f32_16x16x32_bf16 v[28:31], a[20:23], v[236:239], v[28:31]
  s_waitcnt lgkmcnt(3)
  ds_read_b128 v[208:211], v1 offset:12288
  v_or3_b32 v12, v70, v71, v12
  v_pk_fma_f16 v58, v54, v54, s20 op_sel_hi:[1,1,0] neg_lo:[1,0,0] neg_hi:[1,0,0] clamp
  v_pk_fma_f16 v59, v55, v55, s20 op_sel_hi:[1,1,0] neg_lo:[1,0,0] neg_hi:[1,0,0] clamp
  v_mfma_f32_16x16x32_f16 v[64:67], v[184:187], v[192:195], v[160:163]
  s_waitcnt lgkmcnt(3)
  ds_read_b128 v[212:215], v1 offset:13312
  v_pk_fma_f16 v188, v56, v56, s20 op_sel:[0,0,1]
  v_pk_fma_f16 v189, v57, v57, s20 op_sel:[0,0,1]
  v_or3_b32 v12, v80, v81, v12
  v_mfma_f32_16x16x32_f16 v[68:71], v[184:187], v[196:199], v[164:167]
  s_waitcnt lgkmcnt(3)
  buffer_load_dwordx4 v6, s[4:7], s29 offen lds
  buffer_load_dwordx4 v7, s[4:7], s29 offen offset:1024 lds
  buffer_load_dwordx4 v8, s[4:7], s29 offen offset:2048 lds
  buffer_load_dwordx4 v9, s[4:7], s29 offen offset:3072 lds
  v_pk_fma_f16 v190, v58, v58, s20 op_sel:[0,0,1]
  v_pk_fma_f16 v191, v59, v59, s20 op_sel:[0,0,1]
  v_mfma_f32_16x16x32_f16 v[72:75], v[184:187], v[200:203], v[168:171]
  s_waitcnt lgkmcnt(2)
  v_pk_fma_f16 v188, v188, v56, s21 op_sel_hi:[1,1,0]
  v_pk_fma_f16 v189, v189, v57, s21 op_sel_hi:[1,1,0]
  v_or3_b32 v12, v82, v83, v12
  v_or3_b32 v12, v84, v85, v12
  v_mfma_f32_16x16x32_f16 v[76:79], v[184:187], v[204:207], v[172:175]
  s_mov_b32 m0, s31
  v_pk_fma_f16 v190, v190, v58, s21 op_sel_hi:[1,1,0]
  v_pk_fma_f16 v191, v191, v59, s21 op_sel_hi:[1,1,0]
  v_or3_b32 v12, v86, v87, v12
  v_or3_b32 v12, v96, v97, v12
  v_mfma_f32_16x16x32_bf16 v[64:67], v[136:139], v[240:243], v[64:67]
  s_cmp_eq_u32 s26, 1
  v_pk_fma_f16 v188, v188, v52, 0.5 op_sel_hi:[1,1,0] clamp
  v_pk_fma_f16 v189, v189, v53, 0.5 op_sel_hi:[1,1,0] clamp
  v_or3_b32 v12, v98, v99, v12
  v_or3_b32 v12, v100, v101, v12
  v_mfma_f32_16x16x32_bf16 v[68:71], v[136:139], v[32:35], v[68:71]
  s_waitcnt lgkmcnt(1)
  v_pk_fma_f16 v190, v190, v54, 0.5 op_sel_hi:[1,1,0] clamp
  v_pk_fma_f16 v191, v191, v55, 0.5 op_sel_hi:[1,1,0] clamp
  v_or3_b32 v12, v102, v103, v12
  v_subrev_u32 v14, 0x4100, v5
  v_mfma_f32_16x16x32_f16 v[80:83], v[184:187], v[208:211], v[176:179]
  s_waitcnt lgkmcnt(0)
  v_pk_mul_f16 v188, v188, v52
  v_pk_mul_f16 v189, v189, v53
  v_add_u32 v5, 0x8200, v5
  v_min_u32 v5, v14, v5
  v_mfma_f32_16x16x32_f16 v[84:87], v[184:187], v[212:215], v[180:183]
  s_cselect_b32 s35, 0x40000000, s23
  v_pk_mul_f16 v190, v190, v54
  v_pk_mul_f16 v191, v191, v55
  v_subrev_u32 v14, 0x4100, v251
  v_add_u32 v251, 0x8200, v251
  v_mfma_f32_16x16x32_bf16 v[72:75], v[140:143], v[240:243], v[72:75]
  s_add_u32 s29, s29, s35
  v_min_u32 v251, v14, v251
  v_subrev_u32 v14, 0x4100, v4
  v_add_u32 v4, 0x8200, v4
  v_min_u32_e64 v4, v14, v4
  v_mfma_f32_16x16x32_bf16 v[76:79], v[140:143], v[32:35], v[76:79]
  v_cvt_pk_f16_f32 v48, v16, v17
  v_cvt_pk_f16_f32 v49, v18, v19
  v_mfma_f32_16x16x32_f16 v[88:91], v[188:191], v[192:195], v[160:163]
  ds_read_b128 v[192:195], v1 offset:14336
  v_cvt_pk_f16_f32 v50, v20, v21
  v_mfma_f32_16x16x32_f16 v[92:95], v[188:191], v[196:199], v[164:167]
  ds_read_b128 v[196:199], v1 offset:15360
  v_cvt_pk_f16_f32 v51, v22, v23
  v_mfma_f32_16x16x32_bf16 v[80:83], v[144:147], v[240:243], v[80:83]
  v_cvt_pk_f16_f32 v52, v24, v25
  v_cvt_pk_f16_f32 v53, v26, v27
  v_mfma_f32_16x16x32_bf16 v[84:87], v[144:147], v[32:35], v[84:87]
  v_cvt_pk_f16_f32 v54, v28, v29
  v_cvt_pk_f16_f32 v55, v30, v31
  v_mfma_f32_16x16x32_f16 v[96:99], v[188:191], v[200:203], v[168:171]
  ds_read_b128 v[200:203], v1 offset:16384
  v_pk_fma_f16 v56, v48, v48, s20 op_sel_hi:[1,1,0] neg_lo:[1,0,0] neg_hi:[1,0,0] clamp
  v_mfma_f32_16x16x32_f16 v[100:103], v[188:191], v[204:207], v[172:175]
  buffer_load_dwordx4 v6, s[4:7], s52 offen lds
  buffer_load_dwordx4 v7, s[4:7], s52 offen offset:1024 lds
  buffer_load_dwordx4 v8, s[4:7], s52 offen offset:2048 lds
  buffer_load_dwordx4 v9, s[4:7], s52 offen offset:3072 lds
  v_mfma_f32_16x16x32_bf16 v[88:91], v[148:151], v[240:243], v[88:91]
  s_add_u32 m0, s14, 0x1c000
  ds_read_b128 v[204:207], v1 offset:17408
  v_pk_fma_f16 v57, v49, v49, s20 op_sel_hi:[1,1,0] neg_lo:[1,0,0] neg_hi:[1,0,0] clamp
  v_mfma_f32_16x16x32_bf16 v[92:95], v[148:151], v[32:35], v[92:95]
  v_pk_fma_f16 v58, v50, v50, s20 op_sel_hi:[1,1,0] neg_lo:[1,0,0] neg_hi:[1,0,0] clamp
  v_pk_fma_f16 v59, v51, v51, s20 op_sel_hi:[1,1,0] neg_lo:[1,0,0] neg_hi:[1,0,0] clamp
  v_mfma_f32_16x16x32_f16 v[104:107], v[188:191], v[208:211], v[176:179]
  ds_read_b128 v[208:211], v1 offset:18432
  v_pk_fma_f16 v184, v56, v56, s20 op_sel:[0,0,1]
  v_mfma_f32_16x16x32_f16 v[108:111], v[188:191], v[212:215], v[180:183]
  ds_read_b128 v[212:215], v1 offset:19456
  ds_read_b128 v[160:163], v3 offset:2400
  ds_read2_b64 v[176:179], v11 offset0:192 offset1:200
  v_mfma_f32_16x16x32_bf16 v[16:19], a[24:27], v[216:219], 0
  v_pk_fma_f16 v185, v57, v57, s20 op_sel:[0,0,1]
  v_pk_fma_f16 v186, v58, v58, s20 op_sel:[0,0,1]
  v_mfma_f32_16x16x32_bf16 v[24:27], a[24:27], v[220:223], 0
  v_pk_fma_f16 v187, v59, v59, s20 op_sel:[0,0,1]
  v_pk_fma_f16 v184, v184, v56, s21 op_sel_hi:[1,1,0]
  v_mfma_f32_16x16x32_bf16 v[20:23], a[28:31], v[216:219], 0
  v_pk_fma_f16 v185, v185, v57, s21 op_sel_hi:[1,1,0]
  v_pk_fma_f16 v186, v186, v58, s21 op_sel_hi:[1,1,0]
  v_mfma_f32_16x16x32_bf16 v[28:31], a[28:31], v[220:223], 0
  buffer_load_dwordx4 v253, s[72:75], s55 offen lds
  buffer_load_dwordx4 v254, s[72:75], s55 offen offset:1024 lds
  buffer_load_dwordx4 v255, s[72:75], s55 offen offset:2048 lds
  v_mfma_f32_16x16x32_bf16 v[96:99], v[152:155], v[240:243], v[96:99]
  s_add_u32 m0, s14, 0x1cc00
  v_pk_fma_f16 v187, v187, v59, s21 op_sel_hi:[1,1,0]
  v_pk_fma_f16 v184, v184, v48, 0.5 op_sel_hi:[1,1,0] clamp
  v_mfma_f32_16x16x32_bf16 v[100:103], v[152:155], v[32:35], v[100:103]
  v_pk_fma_f16 v185, v185, v49, 0.5 op_sel_hi:[1,1,0] clamp
  v_pk_fma_f16 v186, v186, v50, 0.5 op_sel_hi:[1,1,0] clamp
  v_mfma_f32_16x16x32_bf16 v[16:19], a[32:35], v[224:227], v[16:19]
  v_pk_fma_f16 v187, v187, v51, 0.5 op_sel_hi:[1,1,0] clamp
  v_pk_mul_f16 v184, v184, v48
  v_mfma_f32_16x16x32_bf16 v[24:27], a[32:35], v[228:231], v[24:27]
  v_pk_mul_f16 v185, v185, v49
  v_pk_mul_f16 v186, v186, v50
  v_mfma_f32_16x16x32_bf16 v[104:107], v[156:159], v[240:243], v[104:107]
  v_pk_mul_f16 v187, v187, v51
  v_pk_fma_f16 v56, v52, v52, s20 op_sel_hi:[1,1,0] neg_lo:[1,0,0] neg_hi:[1,0,0] clamp
  v_mfma_f32_16x16x32_bf16 v[108:111], v[156:159], v[32:35], v[108:111]
  v_pk_fma_f16 v57, v53, v53, s20 op_sel_hi:[1,1,0] neg_lo:[1,0,0] neg_hi:[1,0,0] clamp
  v_pk_fma_f16 v58, v54, v54, s20 op_sel_hi:[1,1,0] neg_lo:[1,0,0] neg_hi:[1,0,0] clamp
  v_mfma_f32_16x16x32_bf16 v[20:23], a[36:39], v[224:227], v[20:23]
  v_pk_fma_f16 v59, v55, v55, s20 op_sel_hi:[1,1,0] neg_lo:[1,0,0] neg_hi:[1,0,0] clamp
  v_pk_fma_f16 v188, v56, v56, s20 op_sel:[0,0,1]
  v_mfma_f32_16x16x32_bf16 v[28:31], a[36:39], v[228:231], v[28:31]
  buffer_load_dwordx4 v253, s[72:75], s56 offen lds
  buffer_load_dwordx4 v254, s[72:75], s56 offen offset:1024 lds
  buffer_load_dwordx4 v255, s[72:75], s56 offen offset:2048 lds
  v_mfma_f32_16x16x32_bf16 v[16:19], a[40:43], v[232:235], v[16:19]
  s_add_u32 s52, s52, s35
  ds_read_b128 v[32:35], v0 offset:12288
  ds_read_b128 v[36:39], v0 offset:15360
  ds_read_b128 v[40:43], v0 offset:13312
  v_pk_fma_f16 v189, v57, v57, s20 op_sel:[0,0,1]
  v_mfma_f32_16x16x32_bf16 v[24:27], a[40:43], v[236:239], v[24:27]
  s_mov_b32 s32, s30
  ds_read_b128 v[44:47], v0 offset:16384
  ds_read_b128 v[60:63], v0 offset:14336
  v_pk_fma_f16 v190, v58, v58, s20 op_sel:[0,0,1]
  v_pk_fma_f16 v191, v59, v59, s20 op_sel:[0,0,1]
  v_mfma_f32_16x16x32_bf16 v[20:23], a[44:47], v[232:235], v[20:23]
  s_add_u32 s30, s33, 32
  v_pk_fma_f16 v188, v188, v56, s21 op_sel_hi:[1,1,0]
  v_pk_fma_f16 v189, v189, v57, s21 op_sel_hi:[1,1,0]
  v_mfma_f32_16x16x32_bf16 v[28:31], a[44:47], v[236:239], v[28:31]
  s_waitcnt lgkmcnt(5)
  v_pk_fma_f16 v190, v190, v58, s21 op_sel_hi:[1,1,0]
  v_pk_fma_f16 v191, v191, v59, s21 op_sel_hi:[1,1,0]
  v_mfma_f32_16x16x32_f16 v[64:67], v[184:187], v[192:195], v[64:67]
  s_mov_b32 s33, s31
  v_pk_fma_f16 v188, v188, v52, 0.5 op_sel_hi:[1,1,0] clamp
  v_pk_fma_f16 v189, v189, v53, 0.5 op_sel_hi:[1,1,0] clamp
  v_mfma_f32_16x16x32_f16 v[68:71], v[184:187], v[196:199], v[68:71]
  s_sub_u32 s31, s32, 32
  v_pk_fma_f16 v190, v190, v54, 0.5 op_sel_hi:[1,1,0] clamp
  v_pk_fma_f16 v191, v191, v55, 0.5 op_sel_hi:[1,1,0] clamp
  v_mfma_f32_16x16x32_f16 v[72:75], v[184:187], v[200:203], v[72:75]
  v_pk_mul_f16 v188, v188, v52
  v_pk_mul_f16 v189, v189, v53
  v_mfma_f32_16x16x32_f16 v[76:79], v[184:187], v[204:207], v[76:79]
  v_pk_mul_f16 v190, v190, v54
  v_pk_mul_f16 v191, v191, v55
  v_mfma_f32_16x16x32_f16 v[80:83], v[184:187], v[208:211], v[80:83]
  s_nop 0
  v_cvt_pk_f16_f32 v48, v16, v17
  v_cvt_pk_f16_f32 v49, v18, v19
  v_mfma_f32_16x16x32_f16 v[84:87], v[184:187], v[212:215], v[84:87]
  s_waitcnt vmcnt(14)
  ds_read_b128 a[216:219], v247
  ds_read_b128 a[220:223], v252
  ds_read_b128 a[224:227], v247 offset:64
  v_mfma_f32_16x16x32_f16 v[88:91], v[188:191], v[192:195], v[88:91]
  ds_read_b128 a[228:231], v252 offset:64
  ds_read_b128 a[232:235], v247 offset:128
  ds_read_b128 a[236:239], v252 offset:128
  v_mfma_f32_16x16x32_f16 v[92:95], v[188:191], v[196:199], v[92:95]
  ds_read_b128 v[192:195], v1 offset:20480
  ds_read_b128 v[196:199], v1 offset:21504
  v_mfma_f32_16x16x32_f16 v[96:99], v[188:191], v[200:203], v[96:99]
  ds_read_b128 v[200:203], v1 offset:22528
  v_cvt_pk_f16_f32 v50, v20, v21
  v_mfma_f32_16x16x32_f16 v[100:103], v[188:191], v[204:207], v[100:103]
  ds_read_b128 v[204:207], v1 offset:23552
  v_cvt_pk_f16_f32 v51, v22, v23
  v_mfma_f32_16x16x32_f16 v[104:107], v[188:191], v[208:211], v[104:107]
  ds_read_b128 v[208:211], v1 offset:24576
  v_cvt_pk_f16_f32 v52, v24, v25
  v_mfma_f32_16x16x32_f16 v[108:111], v[188:191], v[212:215], v[108:111]
  s_waitcnt lgkmcnt(10)
  ds_read_b128 v[212:215], v1 offset:25600
  v_cvt_pk_f16_f32 v53, v26, v27
  v_mfma_f32_32x32x16_bf16 v[112:127], a[216:219], a[192:195], 0
  s_waitcnt lgkmcnt(10)
  v_cvt_pk_f16_f32 v54, v28, v29
  v_cvt_pk_f16_f32 v55, v30, v31
  v_pk_fma_f16 v56, v48, v48, s20 op_sel_hi:[1,1,0] neg_lo:[1,0,0] neg_hi:[1,0,0] clamp
  v_pk_fma_f16 v57, v49, v49, s20 op_sel_hi:[1,1,0] neg_lo:[1,0,0] neg_hi:[1,0,0] clamp
  v_pk_fma_f16 v58, v50, v50, s20 op_sel_hi:[1,1,0] neg_lo:[1,0,0] neg_hi:[1,0,0] clamp
  v_pk_fma_f16 v59, v51, v51, s20 op_sel_hi:[1,1,0] neg_lo:[1,0,0] neg_hi:[1,0,0] clamp
  v_mfma_f32_32x32x16_bf16 v[112:127], a[220:223], a[196:199], v[112:127]
  s_nop 0
  s_waitcnt lgkmcnt(6)
  v_pk_fma_f16 v184, v56, v56, s20 op_sel:[0,0,1]
  v_pk_fma_f16 v185, v57, v57, s20 op_sel:[0,0,1]
  v_pk_fma_f16 v186, v58, v58, s20 op_sel:[0,0,1]
  v_pk_fma_f16 v187, v59, v59, s20 op_sel:[0,0,1]
  v_pk_fma_f16 v184, v184, v56, s21 op_sel_hi:[1,1,0]
  v_pk_fma_f16 v185, v185, v57, s21 op_sel_hi:[1,1,0]
  v_mfma_f32_32x32x16_bf16 v[128:143], a[224:227], a[200:203], 0
  v_pk_fma_f16 v186, v186, v58, s21 op_sel_hi:[1,1,0]
  v_pk_fma_f16 v187, v187, v59, s21 op_sel_hi:[1,1,0]
  v_pk_fma_f16 v184, v184, v48, 0.5 op_sel_hi:[1,1,0] clamp
  v_pk_fma_f16 v185, v185, v49, 0.5 op_sel_hi:[1,1,0] clamp
  v_pk_fma_f16 v186, v186, v50, 0.5 op_sel_hi:[1,1,0] clamp
  v_cvt_pk_f16_f32 v112, v112, v113
  v_mfma_f32_32x32x16_bf16 v[128:143], a[228:231], a[204:207], v[128:143]
  v_cvt_pk_f16_f32 v113, v114, v115
  v_cvt_pk_f16_f32 v114, v116, v117
  v_cvt_pk_f16_f32 v115, v118, v119
  v_pk_mul_f16 v112, v112, s21 op_sel:[0,1]
  v_pk_mul_f16 v113, v113, s21 op_sel:[0,1]
  v_pk_mul_f16 v114, v114, s21 op_sel:[0,1]
  v_mfma_f32_32x32x16_bf16 v[144:159], a[232:235], a[208:211], 0
  v_pk_mul_f16 v115, v115, s21 op_sel:[0,1]
  v_cvt_pk_f16_f32 v116, v120, v121
  v_cvt_pk_f16_f32 v117, v122, v123
  v_cvt_pk_f16_f32 v118, v124, v125
  v_cvt_pk_f16_f32 v119, v126, v127
  v_pk_mul_f16 v116, v116, s21 op_sel:[0,1]
  v_mfma_f32_32x32x16_bf16 v[144:159], a[236:239], a[212:215], v[144:159]
  v_pk_mul_f16 v117, v117, s21 op_sel:[0,1]
  v_pk_mul_f16 v118, v118, s21 op_sel:[0,1]
  v_pk_mul_f16 v119, v119, s21 op_sel:[0,1]
  v_or3_b32 v12, v112, v113, v12
  v_or3_b32 v12, v114, v115, v12
  v_or3_b32 v12, v116, v117, v12
  v_mfma_f32_16x16x32_bf16 v[16:19], a[48:51], v[216:219], 0
  ds_write_b128 v244, v[112:115]
  v_mfma_f32_16x16x32_bf16 v[24:27], a[48:51], v[220:223], 0
  v_or3_b32 v12, v118, v119, v12
  v_cvt_pk_f16_f32 v128, v128, v129
  v_cvt_pk_f16_f32 v129, v130, v131
  v_cvt_pk_f16_f32 v130, v132, v133
  v_mfma_f32_16x16x32_bf16 v[20:23], a[52:55], v[216:219], 0
  ds_write_b128 v244, v[116:119] offset:512
  v_mfma_f32_16x16x32_bf16 v[28:31], a[52:55], v[220:223], 0
  v_pk_fma_f16 v187, v187, v51, 0.5 op_sel_hi:[1,1,0] clamp
  v_cvt_pk_f16_f32 v131, v134, v135
  v_pk_mul_f16 v128, v128, s21 op_sel:[0,1]
  v_pk_mul_f16 v129, v129, s21 op_sel:[0,1]
  v_mfma_f32_16x16x32_bf16 v[16:19], a[56:59], v[224:227], v[16:19]
  v_pk_mul_f16 v184, v184, v48
  v_pk_mul_f16 v185, v185, v49
  v_pk_mul_f16 v130, v130, s21 op_sel:[0,1]
  v_pk_mul_f16 v131, v131, s21 op_sel:[0,1]
  v_mfma_f32_16x16x32_bf16 v[24:27], a[56:59], v[228:231], v[24:27]
  ds_write_b128 v245, v[128:131]
  v_pk_mul_f16 v186, v186, v50
  v_pk_mul_f16 v187, v187, v51
  v_cvt_pk_f16_f32 v132, v136, v137
  v_cvt_pk_f16_f32 v133, v138, v139
  v_mfma_f32_16x16x32_bf16 v[20:23], a[60:63], v[224:227], v[20:23]
  v_pk_fma_f16 v56, v52, v52, s20 op_sel_hi:[1,1,0] neg_lo:[1,0,0] neg_hi:[1,0,0] clamp
  v_pk_fma_f16 v57, v53, v53, s20 op_sel_hi:[1,1,0] neg_lo:[1,0,0] neg_hi:[1,0,0] clamp
  v_cvt_pk_f16_f32 v134, v140, v141
  v_cvt_pk_f16_f32 v135, v142, v143
  v_mfma_f32_16x16x32_bf16 v[28:31], a[60:63], v[228:231], v[28:31]
  v_pk_fma_f16 v58, v54, v54, s20 op_sel_hi:[1,1,0] neg_lo:[1,0,0] neg_hi:[1,0,0] clamp
  v_pk_fma_f16 v59, v55, v55, s20 op_sel_hi:[1,1,0] neg_lo:[1,0,0] neg_hi:[1,0,0] clamp
  v_pk_mul_f16 v132, v132, s21 op_sel:[0,1]
  v_pk_mul_f16 v133, v133, s21 op_sel:[0,1]
  v_mfma_f32_16x16x32_bf16 v[16:19], a[64:67], v[232:235], v[16:19]
  v_pk_fma_f16 v188, v56, v56, s20 op_sel:[0,0,1]
  v_pk_fma_f16 v189, v57, v57, s20 op_sel:[0,0,1]
  v_pk_mul_f16 v134, v134, s21 op_sel:[0,1]
  v_pk_mul_f16 v135, v135, s21 op_sel:[0,1]
  v_mfma_f32_16x16x32_bf16 v[24:27], a[64:67], v[236:239], v[24:27]
  ds_write_b128 v245, v[132:135] offset:512
  v_pk_fma_f16 v190, v58, v58, s20 op_sel:[0,0,1]
  v_pk_fma_f16 v191, v59, v59, s20 op_sel:[0,0,1]
  v_mfma_f32_16x16x32_bf16 v[20:23], a[68:71], v[232:235], v[20:23]
  v_pk_fma_f16 v188, v188, v56, s21 op_sel_hi:[1,1,0]
  v_pk_fma_f16 v189, v189, v57, s21 op_sel_hi:[1,1,0]
  v_or3_b32 v12, v128, v129, v12
  v_or3_b32 v12, v130, v131, v12
  v_mfma_f32_16x16x32_bf16 v[28:31], a[68:71], v[236:239], v[28:31]
  s_waitcnt lgkmcnt(4)
  v_pk_fma_f16 v190, v190, v58, s21 op_sel_hi:[1,1,0]
  v_pk_fma_f16 v191, v191, v59, s21 op_sel_hi:[1,1,0]
  v_or3_b32 v12, v132, v133, v12
  v_or3_b32 v12, v134, v135, v12
  v_mfma_f32_16x16x32_f16 v[64:67], v[184:187], v[192:195], v[64:67]
  s_nop 0
  v_pk_fma_f16 v188, v188, v52, 0.5 op_sel_hi:[1,1,0] clamp
  v_pk_fma_f16 v189, v189, v53, 0.5 op_sel_hi:[1,1,0] clamp
  v_cvt_pk_f16_f32 v144, v144, v145
  v_cvt_pk_f16_f32 v145, v146, v147
  v_mfma_f32_16x16x32_f16 v[68:71], v[184:187], v[196:199], v[68:71]
  v_pk_fma_f16 v190, v190, v54, 0.5 op_sel_hi:[1,1,0] clamp
  v_pk_fma_f16 v191, v191, v55, 0.5 op_sel_hi:[1,1,0] clamp
  v_cvt_pk_f16_f32 v146, v148, v149
  v_cvt_pk_f16_f32 v147, v150, v151
  v_mfma_f32_16x16x32_f16 v[72:75], v[184:187], v[200:203], v[72:75]
  v_pk_mul_f16 v188, v188, v52
  v_pk_mul_f16 v189, v189, v53
  v_pk_mul_f16 v144, v144, s21 op_sel:[0,1]
  v_pk_mul_f16 v145, v145, s21 op_sel:[0,1]
  v_mfma_f32_16x16x32_f16 v[76:79], v[184:187], v[204:207], v[76:79]
  v_pk_mul_f16 v190, v190, v54
  v_pk_mul_f16 v191, v191, v55
  v_pk_mul_f16 v146, v146, s21 op_sel:[0,1]
  v_pk_mul_f16 v147, v147, s21 op_sel:[0,1]
  v_mfma_f32_16x16x32_f16 v[80:83], v[184:187], v[208:211], v[80:83]
  ds_write_b128 v246, v[144:147]
  v_cvt_pk_f16_f32 v148, v152, v153
  v_cvt_pk_f16_f32 v149, v154, v155
  v_cvt_pk_f16_f32 v150, v156, v157
  v_cvt_pk_f16_f32 v151, v158, v159
  v_mfma_f32_16x16x32_f16 v[84:87], v[184:187], v[212:215], v[84:87]
  s_waitcnt vmcnt(0)
  ds_read_b128 a[216:219], v247 offset:24576
  ds_read_b128 a[220:223], v252 offset:24576
  ds_read_b128 a[224:227], v247 offset:24640
  v_pk_mul_f16 v148, v148, s21 op_sel:[0,1]
  v_mfma_f32_16x16x32_f16 v[88:91], v[188:191], v[192:195], v[88:91]
  s_nop 0
  ds_read_b128 a[228:231], v252 offset:24640
  ds_read_b128 a[232:235], v247 offset:24704
  ds_read_b128 a[236:239], v252 offset:24704
  v_pk_mul_f16 v149, v149, s21 op_sel:[0,1]
  v_mfma_f32_16x16x32_f16 v[92:95], v[188:191], v[196:199], v[92:95]
  v_pk_mul_f16 v150, v150, s21 op_sel:[0,1]
  v_pk_mul_f16 v151, v151, s21 op_sel:[0,1]
  v_or3_b32 v12, v144, v145, v12
  v_or3_b32 v12, v146, v147, v12
  v_mfma_f32_16x16x32_f16 v[96:99], v[188:191], v[200:203], v[96:99]
  ds_write_b128 v246, v[148:151] offset:512
  v_mfma_f32_16x16x32_f16 v[100:103], v[188:191], v[204:207], v[100:103]
  ds_read_b128 v[192:195], v1 offset:26624
  ds_read_b128 v[196:199], v1 offset:27648
  v_or3_b32 v12, v148, v149, v12
  v_or3_b32 v12, v150, v151, v12
  v_mfma_f32_16x16x32_f16 v[104:107], v[188:191], v[208:211], v[104:107]
  ds_read_b128 v[200:203], v1 offset:28672
  ds_read_b128 v[204:207], v1 offset:29696
  ds_read_b128 v[208:211], v1 offset:30720
  v_mfma_f32_16x16x32_f16 v[108:111], v[188:191], v[212:215], v[108:111]
  s_waitcnt lgkmcnt(11)
  ds_read_b128 v[212:215], v1 offset:31744
  v_cvt_pk_f16_f32 v48, v16, v17
  v_mfma_f32_32x32x16_bf16 v[112:127], a[216:219], a[192:195], 0
  s_waitcnt lgkmcnt(11)
  v_cvt_pk_f16_f32 v49, v18, v19
  v_cvt_pk_f16_f32 v50, v20, v21
  v_cvt_pk_f16_f32 v51, v22, v23
  v_cvt_pk_f16_f32 v52, v24, v25
  v_cvt_pk_f16_f32 v53, v26, v27
  v_cvt_pk_f16_f32 v54, v28, v29
  v_mfma_f32_32x32x16_bf16 v[112:127], a[220:223], a[196:199], v[112:127]
  s_waitcnt lgkmcnt(7)
  s_nop 0
  v_cvt_pk_f16_f32 v55, v30, v31
  v_pk_fma_f16 v56, v48, v48, s20 op_sel_hi:[1,1,0] neg_lo:[1,0,0] neg_hi:[1,0,0] clamp
  v_pk_fma_f16 v57, v49, v49, s20 op_sel_hi:[1,1,0] neg_lo:[1,0,0] neg_hi:[1,0,0] clamp
  v_pk_fma_f16 v58, v50, v50, s20 op_sel_hi:[1,1,0] neg_lo:[1,0,0] neg_hi:[1,0,0] clamp
  v_pk_fma_f16 v59, v51, v51, s20 op_sel_hi:[1,1,0] neg_lo:[1,0,0] neg_hi:[1,0,0] clamp
  v_pk_fma_f16 v184, v56, v56, s20 op_sel:[0,0,1]
  v_mfma_f32_32x32x16_bf16 v[128:143], a[224:227], a[200:203], 0
  v_pk_fma_f16 v185, v57, v57, s20 op_sel:[0,0,1]
  v_pk_fma_f16 v186, v58, v58, s20 op_sel:[0,0,1]
  v_pk_fma_f16 v187, v59, v59, s20 op_sel:[0,0,1]
  v_pk_fma_f16 v184, v184, v56, s21 op_sel_hi:[1,1,0]
  v_pk_fma_f16 v185, v185, v57, s21 op_sel_hi:[1,1,0]
  v_cvt_pk_f16_f32 v112, v112, v113
  v_mfma_f32_32x32x16_bf16 v[128:143], a[228:231], a[204:207], v[128:143]
  v_cvt_pk_f16_f32 v113, v114, v115
  v_cvt_pk_f16_f32 v114, v116, v117
  v_cvt_pk_f16_f32 v115, v118, v119
  v_pk_mul_f16 v112, v112, s21 op_sel:[0,1]
  v_pk_mul_f16 v113, v113, s21 op_sel:[0,1]
  v_pk_mul_f16 v114, v114, s21 op_sel:[0,1]
  v_mfma_f32_32x32x16_bf16 v[144:159], a[232:235], a[208:211], 0
  v_pk_mul_f16 v115, v115, s21 op_sel:[0,1]
  v_cvt_pk_f16_f32 v116, v120, v121
  v_cvt_pk_f16_f32 v117, v122, v123
  v_cvt_pk_f16_f32 v118, v124, v125
  v_cvt_pk_f16_f32 v119, v126, v127
  v_pk_mul_f16 v116, v116, s21 op_sel:[0,1]
  v_mfma_f32_32x32x16_bf16 v[144:159], a[236:239], a[212:215], v[144:159]
  v_pk_mul_f16 v117, v117, s21 op_sel:[0,1]
  v_pk_mul_f16 v118, v118, s21 op_sel:[0,1]
  v_pk_mul_f16 v119, v119, s21 op_sel:[0,1]
  v_or3_b32 v12, v112, v113, v12
  v_or3_b32 v12, v114, v115, v12
  v_or3_b32 v12, v116, v117, v12
  v_mfma_f32_16x16x32_bf16 v[16:19], a[72:75], v[216:219], 0
  ds_write_b128 v244, v[112:115] offset:24576
  v_or3_b32 v12, v118, v119, v12
  v_cvt_pk_f16_f32 v128, v128, v129
  v_cvt_pk_f16_f32 v129, v130, v131
  v_cvt_pk_f16_f32 v130, v132, v133
  v_mfma_f32_16x16x32_bf16 v[24:27], a[72:75], v[220:223], 0
  v_pk_fma_f16 v186, v186, v58, s21 op_sel_hi:[1,1,0]
  v_pk_fma_f16 v187, v187, v59, s21 op_sel_hi:[1,1,0]
  v_cvt_pk_f16_f32 v131, v134, v135
  v_pk_mul_f16 v128, v128, s21 op_sel:[0,1]
  v_mfma_f32_16x16x32_bf16 v[20:23], a[76:79], v[216:219], 0
  ds_write_b128 v244, v[116:119] offset:25088
  v_pk_fma_f16 v184, v184, v48, 0.5 op_sel_hi:[1,1,0] clamp
  v_pk_fma_f16 v185, v185, v49, 0.5 op_sel_hi:[1,1,0] clamp
  v_pk_mul_f16 v129, v129, s21 op_sel:[0,1]
  v_pk_mul_f16 v130, v130, s21 op_sel:[0,1]
  v_mfma_f32_16x16x32_bf16 v[28:31], a[76:79], v[220:223], 0
  v_pk_fma_f16 v186, v186, v50, 0.5 op_sel_hi:[1,1,0] clamp
  v_pk_fma_f16 v187, v187, v51, 0.5 op_sel_hi:[1,1,0] clamp
  v_pk_mul_f16 v131, v131, s21 op_sel:[0,1]
  v_cvt_pk_f16_f32 v132, v136, v137
  v_mfma_f32_16x16x32_bf16 v[16:19], a[80:83], v[224:227], v[16:19]
  ds_write_b128 v245, v[128:131] offset:24576
  v_pk_mul_f16 v184, v184, v48
  v_pk_mul_f16 v185, v185, v49
  v_cvt_pk_f16_f32 v133, v138, v139
  v_cvt_pk_f16_f32 v134, v140, v141
  v_mfma_f32_16x16x32_bf16 v[24:27], a[80:83], v[228:231], v[24:27]
  v_pk_mul_f16 v186, v186, v50
  v_pk_mul_f16 v187, v187, v51
  v_cvt_pk_f16_f32 v135, v142, v143
  v_pk_mul_f16 v132, v132, s21 op_sel:[0,1]
  v_mfma_f32_16x16x32_bf16 v[20:23], a[84:87], v[224:227], v[20:23]
  v_pk_fma_f16 v56, v52, v52, s20 op_sel_hi:[1,1,0] neg_lo:[1,0,0] neg_hi:[1,0,0] clamp
  v_pk_fma_f16 v57, v53, v53, s20 op_sel_hi:[1,1,0] neg_lo:[1,0,0] neg_hi:[1,0,0] clamp
  v_pk_mul_f16 v133, v133, s21 op_sel:[0,1]
  v_pk_mul_f16 v134, v134, s21 op_sel:[0,1]
  v_mfma_f32_16x16x32_bf16 v[28:31], a[84:87], v[228:231], v[28:31]
  v_pk_fma_f16 v58, v54, v54, s20 op_sel_hi:[1,1,0] neg_lo:[1,0,0] neg_hi:[1,0,0] clamp
  v_pk_fma_f16 v59, v55, v55, s20 op_sel_hi:[1,1,0] neg_lo:[1,0,0] neg_hi:[1,0,0] clamp
  v_pk_mul_f16 v135, v135, s21 op_sel:[0,1]
  v_or3_b32 v12, v128, v129, v12
  v_mfma_f32_16x16x32_bf16 v[16:19], a[88:91], v[232:235], v[16:19]
  ds_write_b128 v245, v[132:135] offset:25088
  v_pk_fma_f16 v188, v56, v56, s20 op_sel:[0,0,1]
  v_pk_fma_f16 v189, v57, v57, s20 op_sel:[0,0,1]
  v_or3_b32 v12, v130, v131, v12
  v_or3_b32 v12, v132, v133, v12
  v_mfma_f32_16x16x32_bf16 v[24:27], a[88:91], v[236:239], v[24:27]
  v_pk_fma_f16 v190, v58, v58, s20 op_sel:[0,0,1]
  v_pk_fma_f16 v191, v59, v59, s20 op_sel:[0,0,1]
  v_or3_b32 v12, v134, v135, v12
  v_cvt_pk_f16_f32 v144, v144, v145
  v_mfma_f32_16x16x32_bf16 v[20:23], a[92:95], v[232:235], v[20:23]
  v_pk_fma_f16 v188, v188, v56, s21 op_sel_hi:[1,1,0]
  v_pk_fma_f16 v189, v189, v57, s21 op_sel_hi:[1,1,0]
  v_cvt_pk_f16_f32 v145, v146, v147
  v_cvt_pk_f16_f32 v146, v148, v149
  v_mfma_f32_16x16x32_bf16 v[28:31], a[92:95], v[236:239], v[28:31]
  s_waitcnt lgkmcnt(4)
  v_pk_fma_f16 v190, v190, v58, s21 op_sel_hi:[1,1,0]
  v_pk_fma_f16 v191, v191, v59, s21 op_sel_hi:[1,1,0]
  v_cvt_pk_f16_f32 v147, v150, v151
  v_pk_mul_f16 v144, v144, s21 op_sel:[0,1]
  v_mfma_f32_16x16x32_f16 v[64:67], v[184:187], v[192:195], v[64:67]
  s_nop 0
  v_pk_fma_f16 v188, v188, v52, 0.5 op_sel_hi:[1,1,0] clamp
  v_pk_fma_f16 v189, v189, v53, 0.5 op_sel_hi:[1,1,0] clamp
  v_pk_mul_f16 v145, v145, s21 op_sel:[0,1]
  v_pk_mul_f16 v146, v146, s21 op_sel:[0,1]
  v_mfma_f32_16x16x32_f16 v[68:71], v[184:187], v[196:199], v[68:71]
  buffer_load_dword v249, v248, s[4:7], s29 offen
  v_pk_fma_f16 v190, v190, v54, 0.5 op_sel_hi:[1,1,0] clamp
  v_pk_fma_f16 v191, v191, v55, 0.5 op_sel_hi:[1,1,0] clamp
  v_mfma_f32_16x16x32_f16 v[72:75], v[184:187], v[200:203], v[72:75]
  v_pk_mul_f16 v188, v188, v52
  v_pk_mul_f16 v189, v189, v53
  v_pk_mul_f16 v147, v147, s21 op_sel:[0,1]
  v_cvt_pk_f16_f32 v148, v152, v153
  v_mfma_f32_16x16x32_f16 v[76:79], v[184:187], v[204:207], v[76:79]
  ds_write_b128 v246, v[144:147] offset:24576
  v_pk_mul_f16 v190, v190, v54
  v_pk_mul_f16 v191, v191, v55
  v_cvt_pk_f16_f32 v149, v154, v155
  v_cvt_pk_f16_f32 v150, v156, v157
  v_mfma_f32_16x16x32_f16 v[80:83], v[184:187], v[208:211], v[80:83]
  v_cvt_pk_f16_f32 v48, v16, v17
  v_cvt_pk_f16_f32 v49, v18, v19
  v_cvt_pk_f16_f32 v151, v158, v159
  v_pk_mul_f16 v148, v148, s21 op_sel:[0,1]
  v_mfma_f32_16x16x32_f16 v[84:87], v[184:187], v[212:215], v[84:87]
  v_cvt_pk_f16_f32 v50, v20, v21
  v_cvt_pk_f16_f32 v51, v22, v23
  v_pk_mul_f16 v149, v149, s21 op_sel:[0,1]
  v_pk_mul_f16 v150, v150, s21 op_sel:[0,1]
  v_mfma_f32_16x16x32_f16 v[88:91], v[188:191], v[192:195], v[88:91]
  v_pk_mul_f16 v151, v151, s21 op_sel:[0,1]
  v_or3_b32 v12, v144, v145, v12
  v_or3_b32 v12, v146, v147, v12
  v_or3_b32 v12, v148, v149, v12
  v_or3_b32 v12, v150, v151, v12
  v_cvt_pk_f16_f32 v52, v24, v25
  v_cvt_pk_f16_f32 v53, v26, v27
  v_mfma_f32_16x16x32_f16 v[92:95], v[188:191], v[196:199], v[92:95]
  ds_write_b128 v246, v[148:151] offset:25088
  v_cvt_pk_f16_f32 v54, v28, v29
  v_cvt_pk_f16_f32 v55, v30, v31
  v_mfma_f32_16x16x32_f16 v[96:99], v[188:191], v[200:203], v[96:99]
  s_nop 0
  v_and_b32 v13, 0x40004000, v12
  v_and_b32 v12, 0x30003000, v12
  v_cmp_ne_u32 vcc, 0, v13
  v_pk_fma_f16 v56, v48, v48, s20 op_sel_hi:[1,1,0] neg_lo:[1,0,0] neg_hi:[1,0,0] clamp
  v_pk_fma_f16 v57, v49, v49, s20 op_sel_hi:[1,1,0] neg_lo:[1,0,0] neg_hi:[1,0,0] clamp
  v_mfma_f32_16x16x32_f16 v[100:103], v[188:191], v[204:207], v[100:103]
  s_cmp_lg_u64 vcc, 0
  s_cselect_b32 s3, 1, s3
  ds_read_b128 v[164:167], v4 offset:96
  ds_read_b128 v[168:171], v4 offset:288
  ds_read_b128 v[172:175], v4 offset:480
  ds_read_b128 v[244:247], v0 offset:17408
  ds_read_b128 a[192:195], v0
  ds_read_b128 a[196:199], v0 offset:3072
  ds_read_b128 a[200:203], v0 offset:1024
  ds_read_b128 a[204:207], v0 offset:4096
  ds_read_b128 a[208:211], v0 offset:2048
  ds_read_b128 a[212:215], v0 offset:5120
  ds_read_b128 a[216:219], v0 offset:6144
  ds_read_b128 a[220:223], v0 offset:9216
  ds_read_b128 a[224:227], v0 offset:7168
  ds_read_b128 a[228:231], v0 offset:10240
  ds_read_b128 a[232:235], v0 offset:8192
  ds_read_b128 a[236:239], v0 offset:11264
  v_cmp_ne_u32 vcc, 0, v12
  v_lshl_add_u32 v13, s27, 2, v2
  v_pk_fma_f16 v58, v50, v50, s20 op_sel_hi:[1,1,0] neg_lo:[1,0,0] neg_hi:[1,0,0] clamp
  v_pk_fma_f16 v59, v51, v51, s20 op_sel_hi:[1,1,0] neg_lo:[1,0,0] neg_hi:[1,0,0] clamp
  v_mfma_f32_16x16x32_f16 v[104:107], v[188:191], v[208:211], v[104:107]
  s_cmp_eq_u64 vcc, 0
  s_cselect_b32 s3, 1, s3
  v_mov_b32 v12, s3
  v_pk_fma_f16 v184, v56, v56, s20 op_sel:[0,0,1]
  v_pk_fma_f16 v185, v57, v57, s20 op_sel:[0,0,1]
  v_mfma_f32_16x16x32_f16 v[108:111], v[188:191], v[212:215], v[108:111]
  s_waitcnt lgkmcnt(0)
  ds_write_b32 v13, v12 offset:1536
  v_lshlrev_b32 v252, 16, v240
  v_lshlrev_b32 v253, 16, v241
  v_lshlrev_b32 v254, 16, v242
  v_lshlrev_b32_e64 v255, 16, v243
  v_pk_fma_f16 v186, v58, v58, s20 op_sel:[0,0,1]
  v_pk_fma_f16 v187, v59, v59, s20 op_sel:[0,0,1]
  s_waitcnt lgkmcnt(0)
  s_barrier
  .p2align 6
L_loop:
  v_mfma_f32_16x16x32_bf16 v[16:19], a[96:99], v[216:219], 0
  s_add_u32 s28, s28, 0x60000
  ds_read_b128 v[192:195], v0 offset:24576
  ds_read_b128 v[196:199], v0 offset:25600
  ds_read_b128 v[200:203], v0 offset:26624
  v_mfma_f32_16x16x32_bf16 v[24:27], a[96:99], v[220:223], 0
  s_add_u32 s59, s59, 0x60000
  ds_read_b128 v[204:207], v0 offset:27648
  ds_read_b128 v[208:211], v0 offset:28672
  ds_read_b128 v[212:215], v0 offset:29696
  v_mfma_f32_16x16x32_bf16 v[20:23], a[100:103], v[216:219], 0
  s_add_u32 s57, s57, 0x60000
  v_pk_fma_f16 v184, v184, v56, s21 op_sel_hi:[1,1,0]
  v_pk_fma_f16 v185, v185, v57, s21 op_sel_hi:[1,1,0]
  v_mfma_f32_16x16x32_bf16 v[28:31], a[100:103], v[220:223], 0
  s_add_u32 s15, s15, 0x60000
  v_pk_fma_f16 v186, v186, v58, s21 op_sel_hi:[1,1,0]
  v_pk_fma_f16 v187, v187, v59, s21 op_sel_hi:[1,1,0]
  v_mfma_f32_16x16x32_bf16 v[136:139], v[160:163], v[164:167], 0
  s_mov_b32 m0, s30
  ds_read_b128 v[160:163], v3 offset:2800
  ds_read_b128 v[164:167], v4 offset:112
  v_mfma_f32_16x16x32_bf16 v[16:19], a[104:107], v[224:227], v[16:19]
  s_nop 0
  v_pk_fma_f16 v184, v184, v48, 0.5 op_sel_hi:[1,1,0] clamp
  v_pk_fma_f16 v185, v185, v49, 0.5 op_sel_hi:[1,1,0] clamp
  v_mfma_f32_16x16x32_bf16 v[24:27], a[104:107], v[228:231], v[24:27]
  v_pk_fma_f16 v186, v186, v50, 0.5 op_sel_hi:[1,1,0] clamp
  v_pk_fma_f16 v187, v187, v51, 0.5 op_sel_hi:[1,1,0] clamp
  v_smfmac_f32_16x16x64_bf16 v[136:139], v[176:179], v[168:175], v250
  ds_read_b128 v[168:171], v4 offset:304
  ds_read_b128 v[172:175], v4 offset:496
  ds_read2_b64 v[176:179], v11 offset0:224 offset1:232
  v_mfma_f32_16x16x32_bf16 v[20:23], a[108:111], v[224:227], v[20:23]
  v_pk_mul_f16 v184, v184, v48
  v_pk_mul_f16 v185, v185, v49
  v_mfma_f32_16x16x32_bf16 v[28:31], a[108:111], v[228:231], v[28:31]
  v_pk_mul_f16 v186, v186, v50
  v_pk_mul_f16 v187, v187, v51
  v_mfma_f32_16x16x32_bf16 v[16:19], a[112:115], v[232:235], v[16:19]
  v_pk_fma_f16 v56, v52, v52, s20 op_sel_hi:[1,1,0] neg_lo:[1,0,0] neg_hi:[1,0,0] clamp
  v_pk_fma_f16 v57, v53, v53, s20 op_sel_hi:[1,1,0] neg_lo:[1,0,0] neg_hi:[1,0,0] clamp
  v_mfma_f32_16x16x32_bf16 v[24:27], a[112:115], v[236:239], v[24:27]
  v_pk_fma_f16 v58, v54, v54, s20 op_sel_hi:[1,1,0] neg_lo:[1,0,0] neg_hi:[1,0,0] clamp
  v_pk_fma_f16 v59, v55, v55, s20 op_sel_hi:[1,1,0] neg_lo:[1,0,0] neg_hi:[1,0,0] clamp
  v_mfma_f32_16x16x32_bf16 v[20:23], a[116:119], v[232:235], v[20:23]
  v_pk_fma_f16 v188, v56, v56, s20 op_sel:[0,0,1]
  v_pk_fma_f16 v189, v57, v57, s20 op_sel:[0,0,1]
  v_mfma_f32_16x16x32_bf16 v[28:31], a[116:119], v[236:239], v[28:31]
  s_waitcnt lgkmcnt(3)
  v_pk_fma_f16 v190, v58, v58, s20 op_sel:[0,0,1]
  v_pk_fma_f16 v191, v59, v59, s20 op_sel:[0,0,1]
  v_mfma_f32_16x16x32_f16 v[64:67], v[184:187], v[192:195], v[64:67]
  s_nop 0
  v_pk_fma_f16 v188, v188, v56, s21 op_sel_hi:[1,1,0]
  v_pk_fma_f16 v189, v189, v57, s21 op_sel_hi:[1,1,0]
  v_mfma_f32_16x16x32_f16 v[68:71], v[184:187], v[196:199], v[68:71]
  v_pk_fma_f16 v190, v190, v58, s21 op_sel_hi:[1,1,0]
  v_pk_fma_f16 v191, v191, v59, s21 op_sel_hi:[1,1,0]
  v_mfma_f32_16x16x32_bf16 v[140:143], v[160:163], v[164:167], 0
  ds_read_b128 v[160:163], v3 offset:3200
  ds_read_b128 v[164:167], v4 offset:128
  v_pk_fma_f16 v188, v188, v52, 0.5 op_sel_hi:[1,1,0] clamp
  v_pk_fma_f16 v189, v189, v53, 0.5 op_sel_hi:[1,1,0] clamp
  v_mfma_f32_16x16x32_f16 v[72:75], v[184:187], v[200:203], v[72:75]
  v_pk_fma_f16 v190, v190, v54, 0.5 op_sel_hi:[1,1,0] clamp
  v_pk_fma_f16 v191, v191, v55, 0.5 op_sel_hi:[1,1,0] clamp
  v_mfma_f32_16x16x32_f16 v[76:79], v[184:187], v[204:207], v[76:79]
  s_waitcnt lgkmcnt(2)
  v_pk_mul_f16 v188, v188, v52
  v_pk_mul_f16 v189, v189, v53
  v_smfmac_f32_16x16x64_bf16 v[140:143], v[176:179], v[168:175], v250
  s_nop 0
  ds_read_b128 v[168:171], v4 offset:320
  ds_read_b128 v[172:175], v4 offset:512
  v_pk_mul_f16 v190, v190, v54
  v_pk_mul_f16 v191, v191, v55
  v_mfma_f32_16x16x32_f16 v[80:83], v[184:187], v[208:211], v[80:83]
  v_cvt_pk_f16_f32 v48, v16, v17
  v_cvt_pk_f16_f32 v49, v18, v19
  v_mfma_f32_16x16x32_f16 v[84:87], v[184:187], v[212:215], v[84:87]
  v_cvt_pk_f16_f32 v50, v20, v21
  v_cvt_pk_f16_f32 v51, v22, v23
  v_mfma_f32_16x16x32_f16 v[88:91], v[188:191], v[192:195], v[88:91]
  ds_read_b128 v[192:195], v0 offset:30720
  v_cvt_pk_f16_f32 v52, v24, v25
  v_mfma_f32_16x16x32_f16 v[92:95], v[188:191], v[196:199], v[92:95]
  ds_read_b128 v[196:199], v0 offset:31744
  v_cvt_pk_f16_f32 v53, v26, v27
  v_mfma_f32_16x16x32_f16 v[96:99], v[188:191], v[200:203], v[96:99]
  ds_read_b128 v[200:203], v0 offset:32768
  v_cvt_pk_f16_f32 v54, v28, v29
  v_mfma_f32_16x16x32_f16 v[100:103], v[188:191], v[204:207], v[100:103]
  ds_read_b128 v[204:207], v0 offset:33792
  v_cvt_pk_f16_f32 v55, v30, v31
  v_mfma_f32_16x16x32_f16 v[104:107], v[188:191], v[208:211], v[104:107]
  ds_read_b128 v[208:211], v0 offset:34816
  v_pk_fma_f16 v56, v48, v48, s20 op_sel_hi:[1,1,0] neg_lo:[1,0,0] neg_hi:[1,0,0] clamp
  v_mfma_f32_16x16x32_f16 v[108:111], v[188:191], v[212:215], v[108:111]
  s_waitcnt lgkmcnt(5)
  ds_read_b128 v[212:215], v0 offset:35840
  v_pk_fma_f16 v57, v49, v49, s20 op_sel_hi:[1,1,0] neg_lo:[1,0,0] neg_hi:[1,0,0] clamp
  v_mfma_f32_16x16x32_bf16 v[144:147], v[160:163], v[164:167], 0
  s_nop 0
  ds_read_b128 v[160:163], v3 offset:3600
  ds_read_b128 v[164:167], v4 offset:144
  v_mfma_f32_16x16x32_bf16 v[16:19], a[120:123], v[216:219], 0
  v_pk_fma_f16 v58, v50, v50, s20 op_sel_hi:[1,1,0] neg_lo:[1,0,0] neg_hi:[1,0,0] clamp
  v_pk_fma_f16 v59, v51, v51, s20 op_sel_hi:[1,1,0] neg_lo:[1,0,0] neg_hi:[1,0,0] clamp
  v_mfma_f32_16x16x32_bf16 v[24:27], a[120:123], v[220:223], 0
  v_pk_fma_f16 v184, v56, v56, s20 op_sel:[0,0,1]
  v_pk_fma_f16 v185, v57, v57, s20 op_sel:[0,0,1]
  v_smfmac_f32_16x16x64_bf16 v[144:147], a[240:243], v[168:175], v250
  ds_read_b128 v[168:171], v4 offset:336
  ds_read_b128 v[172:175], v4 offset:528
  v_pk_fma_f16 v186, v58, v58, s20 op_sel:[0,0,1]
  v_pk_fma_f16 v187, v59, v59, s20 op_sel:[0,0,1]
  v_mfma_f32_16x16x32_bf16 v[20:23], a[124:127], v[216:219], 0
  v_pk_fma_f16 v184, v184, v56, s21 op_sel_hi:[1,1,0]
  v_pk_fma_f16 v185, v185, v57, s21 op_sel_hi:[1,1,0]
  v_mfma_f32_16x16x32_bf16 v[28:31], a[124:127], v[220:223], 0
  v_pk_fma_f16 v186, v186, v58, s21 op_sel_hi:[1,1,0]
  v_pk_fma_f16 v187, v187, v59, s21 op_sel_hi:[1,1,0]
  v_mfma_f32_16x16x32_bf16 v[16:19], a[128:131], v[224:227], v[16:19]
  s_nop 0
  v_pk_fma_f16 v184, v184, v48, 0.5 op_sel_hi:[1,1,0] clamp
  v_pk_fma_f16 v185, v185, v49, 0.5 op_sel_hi:[1,1,0] clamp
  v_mfma_f32_16x16x32_bf16 v[24:27], a[128:131], v[228:231], v[24:27]
  s_nop 0
  v_pk_fma_f16 v186, v186, v50, 0.5 op_sel_hi:[1,1,0] clamp
  v_pk_fma_f16 v187, v187, v51, 0.5 op_sel_hi:[1,1,0] clamp
  v_mfma_f32_16x16x32_bf16 v[20:23], a[132:135], v[224:227], v[20:23]
  v_pk_mul_f16 v184, v184, v48
  v_pk_mul_f16 v185, v185, v49
  v_mfma_f32_16x16x32_bf16 v[28:31], a[132:135], v[228:231], v[28:31]
  v_pk_mul_f16 v186, v186, v50
  v_pk_mul_f16 v187, v187, v51
  v_mfma_f32_16x16x32_bf16 v[16:19], a[136:139], v[232:235], v[16:19]
  v_pk_fma_f16 v56, v52, v52, s20 op_sel_hi:[1,1,0] neg_lo:[1,0,0] neg_hi:[1,0,0] clamp
  v_pk_fma_f16 v57, v53, v53, s20 op_sel_hi:[1,1,0] neg_lo:[1,0,0] neg_hi:[1,0,0] clamp
  v_mfma_f32_16x16x32_bf16 v[24:27], a[136:139], v[236:239], v[24:27]
  s_waitcnt lgkmcnt(0)
  v_pk_fma_f16 v58, v54, v54, s20 op_sel_hi:[1,1,0] neg_lo:[1,0,0] neg_hi:[1,0,0] clamp
  v_pk_fma_f16 v59, v55, v55, s20 op_sel_hi:[1,1,0] neg_lo:[1,0,0] neg_hi:[1,0,0] clamp
  v_mfma_f32_16x16x32_bf16 v[148:151], v[160:163], v[164:167], 0
  s_nop 0
  ds_read_b128 v[160:163], v3 offset:4000
  ds_read_b128 v[164:167], v4 offset:160
  v_pk_fma_f16 v188, v56, v56, s20 op_sel:[0,0,1]
  v_pk_fma_f16 v189, v57, v57, s20 op_sel:[0,0,1]
  v_mfma_f32_16x16x32_bf16 v[20:23], a[140:143], v[232:235], v[20:23]
  v_pk_fma_f16 v190, v58, v58, s20 op_sel:[0,0,1]
  v_pk_fma_f16 v191, v59, v59, s20 op_sel:[0,0,1]
  v_mfma_f32_16x16x32_bf16 v[28:31], a[140:143], v[236:239], v[28:31]
  s_nop 0
  v_pk_fma_f16 v188, v188, v56, s21 op_sel_hi:[1,1,0]
  v_pk_fma_f16 v189, v189, v57, s21 op_sel_hi:[1,1,0]
  v_smfmac_f32_16x16x64_bf16 v[148:151], a[244:247], v[168:175], v250
  s_nop 0
  ds_read_b128 v[168:171], v4 offset:352
  ds_read_b128 v[172:175], v4 offset:544
  v_pk_fma_f16 v190, v190, v58, s21 op_sel_hi:[1,1,0]
  v_pk_fma_f16 v191, v191, v59, s21 op_sel_hi:[1,1,0]
  v_mfma_f32_16x16x32_f16 v[64:67], v[184:187], v[192:195], v[64:67]
  v_pk_fma_f16 v188, v188, v52, 0.5 op_sel_hi:[1,1,0] clamp
  v_pk_fma_f16 v189, v189, v53, 0.5 op_sel_hi:[1,1,0] clamp
  v_mfma_f32_16x16x32_f16 v[68:71], v[184:187], v[196:199], v[68:71]
  s_nop 0
  v_pk_fma_f16 v190, v190, v54, 0.5 op_sel_hi:[1,1,0] clamp
  v_pk_fma_f16 v191, v191, v55, 0.5 op_sel_hi:[1,1,0] clamp
  v_mfma_f32_16x16x32_f16 v[72:75], v[184:187], v[200:203], v[72:75]
  s_nop 0
  v_pk_mul_f16 v188, v188, v52
  v_pk_mul_f16 v189, v189, v53
  v_mfma_f32_16x16x32_f16 v[76:79], v[184:187], v[204:207], v[76:79]
  v_pk_mul_f16 v190, v190, v54
  v_pk_mul_f16 v191, v191, v55
  v_mfma_f32_16x16x32_f16 v[80:83], v[184:187], v[208:211], v[80:83]
  v_cvt_pk_f16_f32 v48, v16, v17
  v_cvt_pk_f16_f32 v49, v18, v19
  v_mfma_f32_16x16x32_f16 v[84:87], v[184:187], v[212:215], v[84:87]
  v_cvt_pk_f16_f32 v50, v20, v21
  v_cvt_pk_f16_f32 v51, v22, v23
  v_mfma_f32_16x16x32_f16 v[88:91], v[188:191], v[192:195], v[88:91]
  s_nop 0
  ds_read_b128 v[192:195], v0 offset:36864
  v_cvt_pk_f16_f32 v52, v24, v25
  v_mfma_f32_16x16x32_f16 v[92:95], v[188:191], v[196:199], v[92:95]
  s_waitcnt lgkmcnt(1)
  ds_read_b128 v[196:199], v0 offset:37888
  v_cvt_pk_f16_f32 v53, v26, v27
  v_mfma_f32_16x16x32_bf16 v[152:155], v[160:163], v[164:167], 0
  ds_read_b128 v[160:163], v3 offset:4400
  ds_read_b128 v[164:167], v4 offset:176
  v_mfma_f32_16x16x32_f16 v[96:99], v[188:191], v[200:203], v[96:99]
  ds_read_b128 v[200:203], v0 offset:38912
  v_cvt_pk_f16_f32 v54, v28, v29
  v_mfma_f32_16x16x32_f16 v[100:103], v[188:191], v[204:207], v[100:103]
  ds_read_b128 v[204:207], v0 offset:39936
  v_cvt_pk_f16_f32 v55, v30, v31
  v_smfmac_f32_16x16x64_bf16 v[152:155], a[248:251], v[168:175], v250
  ds_read_b128 v[168:171], v4 offset:368
  ds_read_b128 v[172:175], v4 offset:560
  v_mfma_f32_16x16x32_f16 v[104:107], v[188:191], v[208:211], v[104:107]
  ds_read_b128 v[208:211], v0 offset:40960
  v_pk_fma_f16 v56, v48, v48, s20 op_sel_hi:[1,1,0] neg_lo:[1,0,0] neg_hi:[1,0,0] clamp
  v_mfma_f32_16x16x32_f16 v[108:111], v[188:191], v[212:215], v[108:111]
  ds_read_b128 v[212:215], v0 offset:41984
  v_pk_fma_f16 v57, v49, v49, s20 op_sel_hi:[1,1,0] neg_lo:[1,0,0] neg_hi:[1,0,0] clamp
  v_mfma_f32_16x16x32_bf16 v[16:19], a[144:147], v[216:219], 0
  v_pk_fma_f16 v58, v50, v50, s20 op_sel_hi:[1,1,0] neg_lo:[1,0,0] neg_hi:[1,0,0] clamp
  v_pk_fma_f16 v59, v51, v51, s20 op_sel_hi:[1,1,0] neg_lo:[1,0,0] neg_hi:[1,0,0] clamp
  v_mfma_f32_16x16x32_bf16 v[24:27], a[144:147], v[220:223], 0
  v_pk_fma_f16 v184, v56, v56, s20 op_sel:[0,0,1]
  v_pk_fma_f16 v185, v57, v57, s20 op_sel:[0,0,1]
  v_mfma_f32_16x16x32_bf16 v[20:23], a[148:151], v[216:219], 0
  v_pk_fma_f16 v186, v58, v58, s20 op_sel:[0,0,1]
  v_pk_fma_f16 v187, v59, v59, s20 op_sel:[0,0,1]
  v_mfma_f32_16x16x32_bf16 v[28:31], a[148:151], v[220:223], 0
  v_pk_fma_f16 v184, v184, v56, s21 op_sel_hi:[1,1,0]
  v_pk_fma_f16 v185, v185, v57, s21 op_sel_hi:[1,1,0]
  v_mfma_f32_16x16x32_bf16 v[16:19], a[152:155], v[224:227], v[16:19]
  v_pk_fma_f16 v186, v186, v58, s21 op_sel_hi:[1,1,0]
  v_pk_fma_f16 v187, v187, v59, s21 op_sel_hi:[1,1,0]
  v_mfma_f32_16x16x32_bf16 v[24:27], a[152:155], v[228:231], v[24:27]
  s_waitcnt lgkmcnt(2)
  v_pk_fma_f16 v184, v184, v48, 0.5 op_sel_hi:[1,1,0] clamp
  v_pk_fma_f16 v185, v185, v49, 0.5 op_sel_hi:[1,1,0] clamp
  v_mfma_f32_16x16x32_bf16 v[156:159], v[160:163], v[164:167], 0
  s_nop 0
  ds_read_b128 v[160:163], v3
  ds_read_b128 v[164:167], v4
  v_mfma_f32_16x16x32_bf16 v[20:23], a[156:159], v[224:227], v[20:23]
  v_pk_fma_f16 v186, v186, v50, 0.5 op_sel_hi:[1,1,0] clamp
  v_pk_fma_f16 v187, v187, v51, 0.5 op_sel_hi:[1,1,0] clamp
  v_mfma_f32_16x16x32_bf16 v[28:31], a[156:159], v[228:231], v[28:31]
  v_pk_mul_f16 v184, v184, v48
  v_pk_mul_f16 v185, v185, v49
  v_smfmac_f32_16x16x64_bf16 v[156:159], a[252:255], v[168:175], v250
  ds_read_b128 v[168:171], v4 offset:192
  ds_read_b128 v[172:175], v4 offset:384
  v_pk_mul_f16 v186, v186, v50
  v_pk_mul_f16 v187, v187, v51
  v_mfma_f32_16x16x32_bf16 v[16:19], a[160:163], v[232:235], v[16:19]
  ds_read2_b64 v[176:179], v11 offset0:0 offset1:8
  v_pk_fma_f16 v56, v52, v52, s20 op_sel_hi:[1,1,0] neg_lo:[1,0,0] neg_hi:[1,0,0] clamp
  v_pk_fma_f16 v57, v53, v53, s20 op_sel_hi:[1,1,0] neg_lo:[1,0,0] neg_hi:[1,0,0] clamp
  v_mfma_f32_16x16x32_bf16 v[24:27], a[160:163], v[236:239], v[24:27]
  v_pk_fma_f16 v58, v54, v54, s20 op_sel_hi:[1,1,0] neg_lo:[1,0,0] neg_hi:[1,0,0] clamp
  v_pk_fma_f16 v59, v55, v55, s20 op_sel_hi:[1,1,0] neg_lo:[1,0,0] neg_hi:[1,0,0] clamp
  v_mfma_f32_16x16x32_bf16 v[20:23], a[164:167], v[232:235], v[20:23]
  v_pk_fma_f16 v188, v56, v56, s20 op_sel:[0,0,1]
  v_pk_fma_f16 v189, v57, v57, s20 op_sel:[0,0,1]
  v_mfma_f32_16x16x32_bf16 v[28:31], a[164:167], v[236:239], v[28:31]
  v_pk_fma_f16 v190, v58, v58, s20 op_sel:[0,0,1]
  v_pk_fma_f16 v191, v59, v59, s20 op_sel:[0,0,1]
  v_mfma_f32_16x16x32_f16 v[64:67], v[184:187], v[192:195], v[64:67]
  v_pk_fma_f16 v188, v188, v56, s21 op_sel_hi:[1,1,0]
  v_pk_fma_f16 v189, v189, v57, s21 op_sel_hi:[1,1,0]
  v_mfma_f32_16x16x32_f16 v[68:71], v[184:187], v[196:199], v[68:71]
  v_pk_fma_f16 v190, v190, v58, s21 op_sel_hi:[1,1,0]
  v_pk_fma_f16 v191, v191, v59, s21 op_sel_hi:[1,1,0]
  v_mfma_f32_16x16x32_f16 v[72:75], v[184:187], v[200:203], v[72:75]
  v_pk_fma_f16 v188, v188, v52, 0.5 op_sel_hi:[1,1,0] clamp
  v_pk_fma_f16 v189, v189, v53, 0.5 op_sel_hi:[1,1,0] clamp
  v_mfma_f32_16x16x32_f16 v[76:79], v[184:187], v[204:207], v[76:79]
  s_waitcnt lgkmcnt(1)
  v_pk_fma_f16 v190, v190, v54, 0.5 op_sel_hi:[1,1,0] clamp
  v_pk_fma_f16 v191, v191, v55, 0.5 op_sel_hi:[1,1,0] clamp
  v_mfma_f32_16x16x32_bf16 v[112:115], v[160:163], v[164:167], 0
  s_nop 0
  ds_read_b128 v[160:163], v3 offset:400
  ds_read_b128 v[164:167], v4 offset:16
  v_pk_mul_f16 v188, v188, v52
  v_pk_mul_f16 v189, v189, v53
  v_mfma_f32_16x16x32_f16 v[80:83], v[184:187], v[208:211], v[80:83]
  v_pk_mul_f16 v190, v190, v54
  v_pk_mul_f16 v191, v191, v55
  v_mfma_f32_16x16x32_f16 v[84:87], v[184:187], v[212:215], v[84:87]
  s_waitcnt lgkmcnt(2)
  v_cvt_pk_f16_f32 v48, v16, v17
  v_cvt_pk_f16_f32 v49, v18, v19
  v_smfmac_f32_16x16x64_bf16 v[112:115], v[176:179], v[168:175], v250
  s_nop 0
  ds_read_b128 v[168:171], v4 offset:208
  ds_read_b128 v[172:175], v4 offset:400
  ds_read2_b64 v[176:179], v11 offset0:32 offset1:40
  v_mfma_f32_16x16x32_f16 v[88:91], v[188:191], v[192:195], v[88:91]
  ds_read_b128 v[192:195], v0 offset:43008
  v_cvt_pk_f16_f32 v50, v20, v21
  v_mfma_f32_16x16x32_f16 v[92:95], v[188:191], v[196:199], v[92:95]
  ds_read_b128 v[196:199], v0 offset:44032
  v_cvt_pk_f16_f32 v51, v22, v23
  v_mfma_f32_16x16x32_f16 v[96:99], v[188:191], v[200:203], v[96:99]
  ds_read_b128 v[200:203], v0 offset:45056
  v_cvt_pk_f16_f32 v52, v24, v25
  v_mfma_f32_16x16x32_f16 v[100:103], v[188:191], v[204:207], v[100:103]
  ds_read_b128 v[204:207], v0 offset:46080
  v_cvt_pk_f16_f32 v53, v26, v27
  v_mfma_f32_16x16x32_f16 v[104:107], v[188:191], v[208:211], v[104:107]
  ds_read_b128 v[208:211], v0 offset:47104
  v_cvt_pk_f16_f32 v54, v28, v29
  v_mfma_f32_16x16x32_f16 v[108:111], v[188:191], v[212:215], v[108:111]
  ds_read_b128 v[212:215], v0 offset:48128
  v_cvt_pk_f16_f32 v55, v30, v31
  v_mfma_f32_16x16x32_bf16 v[16:19], a[168:171], v[216:219], 0
  v_pk_fma_f16 v56, v48, v48, s20 op_sel_hi:[1,1,0] neg_lo:[1,0,0] neg_hi:[1,0,0] clamp
  v_pk_fma_f16 v57, v49, v49, s20 op_sel_hi:[1,1,0] neg_lo:[1,0,0] neg_hi:[1,0,0] clamp
  v_mfma_f32_16x16x32_bf16 v[24:27], a[168:171], v[220:223], 0
  s_waitcnt lgkmcnt(6)
  v_pk_fma_f16 v58, v50, v50, s20 op_sel_hi:[1,1,0] neg_lo:[1,0,0] neg_hi:[1,0,0] clamp
  v_pk_fma_f16 v59, v51, v51, s20 op_sel_hi:[1,1,0] neg_lo:[1,0,0] neg_hi:[1,0,0] clamp
  v_mfma_f32_16x16x32_bf16 v[116:119], v[160:163], v[164:167], 0
  s_nop 0
  ds_read_b128 v[160:163], v3 offset:800
  ds_read_b128 v[164:167], v4 offset:32
  v_pk_fma_f16 v184, v56, v56, s20 op_sel:[0,0,1]
  v_pk_fma_f16 v185, v57, v57, s20 op_sel:[0,0,1]
  v_mfma_f32_16x16x32_bf16 v[20:23], a[172:175], v[216:219], 0
  v_pk_fma_f16 v186, v58, v58, s20 op_sel:[0,0,1]
  v_pk_fma_f16 v187, v59, v59, s20 op_sel:[0,0,1]
  v_mfma_f32_16x16x32_bf16 v[28:31], a[172:175], v[220:223], 0
  v_pk_fma_f16 v184, v184, v56, s21 op_sel_hi:[1,1,0]
  v_pk_fma_f16 v185, v185, v57, s21 op_sel_hi:[1,1,0]
  v_smfmac_f32_16x16x64_bf16 v[116:119], v[176:179], v[168:175], v250
  ds_read_b128 v[168:171], v4 offset:224
  ds_read_b128 v[172:175], v4 offset:416
  v_pk_fma_f16 v186, v186, v58, s21 op_sel_hi:[1,1,0]
  v_pk_fma_f16 v187, v187, v59, s21 op_sel_hi:[1,1,0]
  v_mfma_f32_16x16x32_bf16 v[16:19], a[176:179], v[224:227], v[16:19]
  ds_read2_b64 v[176:179], v11 offset0:64 offset1:72
  v_pk_fma_f16 v184, v184, v48, 0.5 op_sel_hi:[1,1,0] clamp
  v_pk_fma_f16 v185, v185, v49, 0.5 op_sel_hi:[1,1,0] clamp
  v_mfma_f32_16x16x32_bf16 v[24:27], a[176:179], v[228:231], v[24:27]
  v_pk_fma_f16 v186, v186, v50, 0.5 op_sel_hi:[1,1,0] clamp
  v_pk_fma_f16 v187, v187, v51, 0.5 op_sel_hi:[1,1,0] clamp
  v_mfma_f32_16x16x32_bf16 v[20:23], a[180:183], v[224:227], v[20:23]
  v_pk_mul_f16 v184, v184, v48
  v_pk_mul_f16 v185, v185, v49
  v_mfma_f32_16x16x32_bf16 v[28:31], a[180:183], v[228:231], v[28:31]
  v_pk_mul_f16 v186, v186, v50
  v_pk_mul_f16 v187, v187, v51
  v_mfma_f32_16x16x32_bf16 v[16:19], a[184:187], v[232:235], v[16:19]
  v_pk_fma_f16 v56, v52, v52, s20 op_sel_hi:[1,1,0] neg_lo:[1,0,0] neg_hi:[1,0,0] clamp
  v_pk_fma_f16 v57, v53, v53, s20 op_sel_hi:[1,1,0] neg_lo:[1,0,0] neg_hi:[1,0,0] clamp
  v_mfma_f32_16x16x32_bf16 v[24:27], a[184:187], v[236:239], v[24:27]
  v_pk_fma_f16 v58, v54, v54, s20 op_sel_hi:[1,1,0] neg_lo:[1,0,0] neg_hi:[1,0,0] clamp
  v_pk_fma_f16 v59, v55, v55, s20 op_sel_hi:[1,1,0] neg_lo:[1,0,0] neg_hi:[1,0,0] clamp
  v_mfma_f32_16x16x32_bf16 v[20:23], a[188:191], v[232:235], v[20:23]
  s_nop 0
  v_pk_fma_f16 v188, v56, v56, s20 op_sel:[0,0,1]
  v_pk_fma_f16 v189, v57, v57, s20 op_sel:[0,0,1]
  v_mfma_f32_16x16x32_bf16 v[28:31], a[188:191], v[236:239], v[28:31]
  s_waitcnt lgkmcnt(1)
  v_pk_fma_f16 v190, v58, v58, s20 op_sel:[0,0,1]
  v_pk_fma_f16 v191, v59, v59, s20 op_sel:[0,0,1]
  v_mfma_f32_16x16x32_bf16 v[120:123], v[160:163], v[164:167], 0
  ds_read_b128 v[160:163], v3 offset:1200
  ds_read_b128 v[164:167], v4 offset:48
  v_pk_fma_f16 v188, v188, v56, s21 op_sel_hi:[1,1,0]
  v_pk_fma_f16 v189, v189, v57, s21 op_sel_hi:[1,1,0]
  v_mfma_f32_16x16x32_f16 v[64:67], v[184:187], v[192:195], v[64:67]
  s_nop 0
  v_pk_fma_f16 v190, v190, v58, s21 op_sel_hi:[1,1,0]
  v_pk_fma_f16 v191, v191, v59, s21 op_sel_hi:[1,1,0]
  v_mfma_f32_16x16x32_f16 v[68:71], v[184:187], v[196:199], v[68:71]
  s_waitcnt lgkmcnt(2)
  v_pk_fma_f16 v188, v188, v52, 0.5 op_sel_hi:[1,1,0] clamp
  v_pk_fma_f16 v189, v189, v53, 0.5 op_sel_hi:[1,1,0] clamp
  v_smfmac_f32_16x16x64_bf16 v[120:123], v[176:179], v[168:175], v250
  ds_read_b128 v[168:171], v4 offset:240
  ds_read_b128 v[172:175], v4 offset:432
  v_pk_fma_f16 v190, v190, v54, 0.5 op_sel_hi:[1,1,0] clamp
  v_pk_fma_f16 v191, v191, v55, 0.5 op_sel_hi:[1,1,0] clamp
  v_mfma_f32_16x16x32_f16 v[72:75], v[184:187], v[200:203], v[72:75]
  ds_read2_b64 v[176:179], v11 offset0:96 offset1:104
  v_pk_mul_f16 v188, v188, v52
  v_pk_mul_f16 v189, v189, v53
  v_mfma_f32_16x16x32_f16 v[76:79], v[184:187], v[204:207], v[76:79]
  v_pk_mul_f16 v190, v190, v54
  v_pk_mul_f16 v191, v191, v55
  v_mfma_f32_16x16x32_f16 v[80:83], v[184:187], v[208:211], v[80:83]
  v_cvt_pk_f16_f32 v48, v16, v17
  v_cvt_pk_f16_f32 v49, v18, v19
  v_mfma_f32_16x16x32_f16 v[84:87], v[184:187], v[212:215], v[84:87]
  v_cvt_pk_f16_f32 v50, v20, v21
  v_cvt_pk_f16_f32 v51, v22, v23
  v_mfma_f32_16x16x32_f16 v[88:91], v[188:191], v[192:195], v[88:91]
  ds_read_b128 v[192:195], v0 offset:49152
  v_cvt_pk_f16_f32 v52, v24, v25
  v_mfma_f32_16x16x32_f16 v[92:95], v[188:191], v[196:199], v[92:95]
  ds_read_b128 v[196:199], v0 offset:50176
  v_cvt_pk_f16_f32 v53, v26, v27
  v_mfma_f32_16x16x32_f16 v[96:99], v[188:191], v[200:203], v[96:99]
  ds_read_b128 v[200:203], v0 offset:51200
  v_cvt_pk_f16_f32 v54, v28, v29
  v_mfma_f32_16x16x32_f16 v[100:103], v[188:191], v[204:207], v[100:103]
  s_waitcnt lgkmcnt(4)
  ds_read_b128 v[204:207], v0 offset:52224
  v_cvt_pk_f16_f32 v55, v30, v31
  v_mfma_f32_16x16x32_bf16 v[124:127], v[160:163], v[164:167], 0
  s_nop 0
  ds_read_b128 v[160:163], v3 offset:1600
  ds_read_b128 v[164:167], v4 offset:64
  v_mfma_f32_16x16x32_f16 v[104:107], v[188:191], v[208:211], v[104:107]
  ds_read_b128 v[208:211], v0 offset:53248
  v_pk_fma_f16 v56, v48, v48, s20 op_sel_hi:[1,1,0] neg_lo:[1,0,0] neg_hi:[1,0,0] clamp
  v_mfma_f32_16x16x32_f16 v[108:111], v[188:191], v[212:215], v[108:111]
  s_waitcnt lgkmcnt(7)
  ds_read_b128 v[212:215], v0 offset:54272
  v_pk_fma_f16 v57, v49, v49, s20 op_sel_hi:[1,1,0] neg_lo:[1,0,0] neg_hi:[1,0,0] clamp
  v_smfmac_f32_16x16x64_bf16 v[124:127], v[176:179], v[168:175], v250
  s_nop 0
  ds_read_b128 v[168:171], v4 offset:256
  ds_read_b128 v[172:175], v4 offset:448
  ds_read2_b64 v[176:179], v11 offset0:128 offset1:136
  v_mfma_f32_16x16x32_bf16 v[16:19], a[192:195], v[216:219], 0
  v_pk_fma_f16 v58, v50, v50, s20 op_sel_hi:[1,1,0] neg_lo:[1,0,0] neg_hi:[1,0,0] clamp
  v_pk_fma_f16 v59, v51, v51, s20 op_sel_hi:[1,1,0] neg_lo:[1,0,0] neg_hi:[1,0,0] clamp
  v_mfma_f32_16x16x32_bf16 v[24:27], a[192:195], v[220:223], 0
  v_pk_fma_f16 v184, v56, v56, s20 op_sel:[0,0,1]
  v_pk_fma_f16 v185, v57, v57, s20 op_sel:[0,0,1]
  v_mfma_f32_16x16x32_bf16 v[20:23], a[196:199], v[216:219], 0
  v_pk_fma_f16 v186, v58, v58, s20 op_sel:[0,0,1]
  v_pk_fma_f16 v187, v59, v59, s20 op_sel:[0,0,1]
  v_mfma_f32_16x16x32_bf16 v[28:31], a[196:199], v[220:223], 0
  v_pk_fma_f16 v184, v184, v56, s21 op_sel_hi:[1,1,0]
  v_pk_fma_f16 v185, v185, v57, s21 op_sel_hi:[1,1,0]
  v_mfma_f32_16x16x32_bf16 v[16:19], a[200:203], v[224:227], v[16:19]
  v_pk_fma_f16 v186, v186, v58, s21 op_sel_hi:[1,1,0]
  v_pk_fma_f16 v187, v187, v59, s21 op_sel_hi:[1,1,0]
  v_mfma_f32_16x16x32_bf16 v[24:27], a[200:203], v[228:231], v[24:27]
  v_pk_fma_f16 v184, v184, v48, 0.5 op_sel_hi:[1,1,0] clamp
  v_pk_fma_f16 v185, v185, v49, 0.5 op_sel_hi:[1,1,0] clamp
  v_mfma_f32_16x16x32_bf16 v[20:23], a[204:207], v[224:227], v[20:23]
  v_pk_fma_f16 v186, v186, v50, 0.5 op_sel_hi:[1,1,0] clamp
  v_pk_fma_f16 v187, v187, v51, 0.5 op_sel_hi:[1,1,0] clamp
  v_mfma_f32_16x16x32_bf16 v[28:31], a[204:207], v[228:231], v[28:31]
  s_waitcnt lgkmcnt(0)
  v_pk_mul_f16 v184, v184, v48
  v_pk_mul_f16 v185, v185, v49
  v_mfma_f32_16x16x32_bf16 v[128:131], v[160:163], v[164:167], 0
  s_nop 0
  ds_read_b128 v[160:163], v3 offset:2000
  ds_read_b128 v[164:167], v4 offset:80
  v_pk_mul_f16 v186, v186, v50
  v_pk_mul_f16 v187, v187, v51
  v_mfma_f32_16x16x32_bf16 v[16:19], a[208:211], v[232:235], v[16:19]
  v_pk_fma_f16 v56, v52, v52, s20 op_sel_hi:[1,1,0] neg_lo:[1,0,0] neg_hi:[1,0,0] clamp
  v_pk_fma_f16 v57, v53, v53, s20 op_sel_hi:[1,1,0] neg_lo:[1,0,0] neg_hi:[1,0,0] clamp
  v_mfma_f32_16x16x32_bf16 v[24:27], a[208:211], v[236:239], v[24:27]
  v_pk_fma_f16 v58, v54, v54, s20 op_sel_hi:[1,1,0] neg_lo:[1,0,0] neg_hi:[1,0,0] clamp
  v_pk_fma_f16 v59, v55, v55, s20 op_sel_hi:[1,1,0] neg_lo:[1,0,0] neg_hi:[1,0,0] clamp
  v_smfmac_f32_16x16x64_bf16 v[128:131], v[176:179], v[168:175], v250
  ds_read_b128 v[168:171], v4 offset:272
  ds_read_b128 v[172:175], v4 offset:464
  v_pk_fma_f16 v188, v56, v56, s20 op_sel:[0,0,1]
  v_pk_fma_f16 v189, v57, v57, s20 op_sel:[0,0,1]
  v_mfma_f32_16x16x32_bf16 v[20:23], a[212:215], v[232:235], v[20:23]
  ds_read2_b64 v[176:179], v11 offset0:160 offset1:168
  v_pk_fma_f16 v190, v58, v58, s20 op_sel:[0,0,1]
  v_pk_fma_f16 v191, v59, v59, s20 op_sel:[0,0,1]
  v_mfma_f32_16x16x32_bf16 v[28:31], a[212:215], v[236:239], v[28:31]
  v_pk_fma_f16 v188, v188, v56, s21 op_sel_hi:[1,1,0]
  v_pk_fma_f16 v189, v189, v57, s21 op_sel_hi:[1,1,0]
  v_mfma_f32_16x16x32_f16 v[64:67], v[184:187], v[192:195], v[64:67]
  v_pk_fma_f16 v190, v190, v58, s21 op_sel_hi:[1,1,0]
  v_pk_fma_f16 v191, v191, v59, s21 op_sel_hi:[1,1,0]
  v_mfma_f32_16x16x32_f16 v[68:71], v[184:187], v[196:199], v[68:71]
  v_pk_fma_f16 v188, v188, v52, 0.5 op_sel_hi:[1,1,0] clamp
  v_pk_fma_f16 v189, v189, v53, 0.5 op_sel_hi:[1,1,0] clamp
  v_mfma_f32_16x16x32_f16 v[72:75], v[184:187], v[200:203], v[72:75]
  v_pk_fma_f16 v190, v190, v54, 0.5 op_sel_hi:[1,1,0] clamp
  v_pk_fma_f16 v191, v191, v55, 0.5 op_sel_hi:[1,1,0] clamp
  v_mfma_f32_16x16x32_f16 v[76:79], v[184:187], v[204:207], v[76:79]
  v_pk_mul_f16 v188, v188, v52
  v_pk_mul_f16 v189, v189, v53
  v_mfma_f32_16x16x32_f16 v[80:83], v[184:187], v[208:211], v[80:83]
  s_nop 0
  v_pk_mul_f16 v190, v190, v54
  v_pk_mul_f16 v191, v191, v55
  v_mfma_f32_16x16x32_f16 v[84:87], v[184:187], v[212:215], v[84:87]
  s_waitcnt lgkmcnt(1)
  v_cvt_pk_f16_f32 v48, v16, v17
  v_cvt_pk_f16_f32 v49, v18, v19
  v_mfma_f32_16x16x32_bf16 v[132:135], v[160:163], v[164:167], 0
  ds_read_b128 v[160:163], v0 offset:18432
  ds_read_b128 v[164:167], v0 offset:21504
  v_mfma_f32_16x16x32_f16 v[88:91], v[188:191], v[192:195], v[88:91]
  ds_read_b128 v[192:195], v0 offset:55296
  v_cvt_pk_f16_f32 v50, v20, v21
  v_cvt_pk_f16_f32 v51, v22, v23
  v_mfma_f32_16x16x32_f16 v[92:95], v[188:191], v[196:199], v[92:95]
  s_waitcnt lgkmcnt(3)
  ds_read_b128 v[196:199], v0 offset:56320
  v_cvt_pk_f16_f32 v52, v24, v25
  v_cvt_pk_f16_f32 v53, v26, v27
  v_smfmac_f32_16x16x64_bf16 v[132:135], v[176:179], v[168:175], v250
  s_nop 0
  ds_read_b128 v[168:171], v0 offset:19456
  ds_read_b128 v[172:175], v0 offset:22528
  v_cvt_pk_f16_f32 v54, v28, v29
  v_cvt_pk_f16_f32 v55, v30, v31
  v_mfma_f32_16x16x32_f16 v[96:99], v[188:191], v[200:203], v[96:99]
  ds_read_b128 v[200:203], v0 offset:57344
  ds_read_b128 v[176:179], v0 offset:20480
  v_pk_fma_f16 v56, v48, v48, s20 op_sel_hi:[1,1,0] neg_lo:[1,0,0] neg_hi:[1,0,0] clamp
  v_pk_fma_f16 v57, v49, v49, s20 op_sel_hi:[1,1,0] neg_lo:[1,0,0] neg_hi:[1,0,0] clamp
  v_mfma_f32_16x16x32_f16 v[100:103], v[188:191], v[204:207], v[100:103]
  ds_read_b128 v[204:207], v0 offset:58368
  v_pk_fma_f16 v58, v50, v50, s20 op_sel_hi:[1,1,0] neg_lo:[1,0,0] neg_hi:[1,0,0] clamp
  v_pk_fma_f16 v59, v51, v51, s20 op_sel_hi:[1,1,0] neg_lo:[1,0,0] neg_hi:[1,0,0] clamp
  v_mfma_f32_16x16x32_f16 v[104:107], v[188:191], v[208:211], v[104:107]
  ds_read_b128 v[208:211], v0 offset:59392
  v_pk_fma_f16 v184, v56, v56, s20 op_sel:[0,0,1]
  v_pk_fma_f16 v185, v57, v57, s20 op_sel:[0,0,1]
  v_mfma_f32_16x16x32_f16 v[108:111], v[188:191], v[212:215], v[108:111]
  ds_read_b128 v[212:215], v0 offset:60416
  v_pk_fma_f16 v186, v58, v58, s20 op_sel:[0,0,1]
  v_pk_fma_f16 v187, v59, v59, s20 op_sel:[0,0,1]
  v_mfma_f32_16x16x32_bf16 v[16:19], a[216:219], v[216:219], 0
  v_pk_fma_f16 v184, v184, v56, s21 op_sel_hi:[1,1,0]
  v_pk_fma_f16 v185, v185, v57, s21 op_sel_hi:[1,1,0]
  v_mfma_f32_16x16x32_bf16 v[24:27], a[216:219], v[220:223], 0
  v_pk_fma_f16 v186, v186, v58, s21 op_sel_hi:[1,1,0]
  v_pk_fma_f16 v187, v187, v59, s21 op_sel_hi:[1,1,0]
  v_mul_f32 v14, v136, v136
  v_mul_f32 v15, v137, v137
  v_mul_f32 v182, v138, v138
  v_mul_f32 v183, v139, v139
  v_pk_add_f32 v[12:13], v[136:137], v[140:141]
  v_pk_fma_f32 v[14:15], v[140:141], v[140:141], v[14:15]
  v_pk_add_f32 v[180:181], v[138:139], v[142:143]
  v_pk_fma_f32 v[182:183], v[142:143], v[142:143], v[182:183]
  v_pk_add_f32 v[12:13], v[12:13], v[144:145]
  v_pk_fma_f32 v[14:15], v[144:145], v[144:145], v[14:15]
  v_pk_add_f32 v[180:181], v[180:181], v[146:147]
  v_pk_fma_f32 v[182:183], v[146:147], v[146:147], v[182:183]
  v_pk_add_f32 v[12:13], v[12:13], v[148:149]
  v_pk_fma_f32 v[14:15], v[148:149], v[148:149], v[14:15]
  v_pk_add_f32 v[180:181], v[180:181], v[150:151]
  v_pk_fma_f32 v[182:183], v[150:151], v[150:151], v[182:183]
  v_pk_add_f32 v[12:13], v[12:13], v[152:153]
  v_pk_fma_f32 v[14:15], v[152:153], v[152:153], v[14:15]
  v_pk_add_f32 v[180:181], v[180:181], v[154:155]
  v_pk_fma_f32 v[182:183], v[154:155], v[154:155], v[182:183]
  v_pk_add_f32 v[12:13], v[12:13], v[156:157]
  v_pk_fma_f32 v[14:15], v[156:157], v[156:157], v[14:15]
  v_pk_add_f32 v[180:181], v[180:181], v[158:159]
  v_pk_fma_f32 v[182:183], v[158:159], v[158:159], v[182:183]
  v_pk_add_f32 v[12:13], v[12:13], v[112:113]
  v_pk_fma_f32 v[14:15], v[112:113], v[112:113], v[14:15]
  v_pk_add_f32 v[180:181], v[180:181], v[114:115]
  v_pk_fma_f32 v[182:183], v[114:115], v[114:115], v[182:183]
  v_pk_add_f32 v[12:13], v[12:13], v[116:117]
  v_pk_fma_f32 v[14:15], v[116:117], v[116:117], v[14:15]
  v_pk_add_f32 v[180:181], v[180:181], v[118:119]
  v_pk_fma_f32 v[182:183], v[118:119], v[118:119], v[182:183]
  v_pk_add_f32 v[12:13], v[12:13], v[120:121]
  v_pk_fma_f32 v[14:15], v[120:121], v[120:121], v[14:15]
  v_pk_add_f32 v[180:181], v[180:181], v[122:123]
  v_pk_fma_f32 v[182:183], v[122:123], v[122:123], v[182:183]
  v_pk_add_f32 v[12:13], v[12:13], v[124:125]
  v_pk_fma_f32 v[14:15], v[124:125], v[124:125], v[14:15]
  v_pk_add_f32 v[180:181], v[180:181], v[126:127]
  v_pk_fma_f32 v[182:183], v[126:127], v[126:127], v[182:183]
  v_pk_add_f32 v[12:13], v[12:13], v[128:129]
  v_pk_fma_f32 v[14:15], v[128:129], v[128:129], v[14:15]
  v_pk_add_f32 v[180:181], v[180:181], v[130:131]
  v_pk_fma_f32 v[182:183], v[130:131], v[130:131], v[182:183]
  v_pk_add_f32 v[12:13], v[12:13], v[132:133]
  v_pk_fma_f32 v[14:15], v[132:133], v[132:133], v[14:15]
  v_pk_add_f32 v[180:181], v[180:181], v[134:135]
  v_pk_fma_f32 v[182:183], v[134:135], v[134:135], v[182:183]
  v_mfma_f32_16x16x32_bf16 v[20:23], a[220:223], v[216:219], 0
  v_pk_fma_f16 v184, v184, v48, 0.5 op_sel_hi:[1,1,0] clamp
  v_pk_fma_f16 v185, v185, v49, 0.5 op_sel_hi:[1,1,0] clamp
  v_add_f32 v12, v12, v13
  v_add_f32 v14, v14, v15
  v_mfma_f32_16x16x32_bf16 v[28:31], a[220:223], v[220:223], 0
  v_pk_fma_f16 v186, v186, v50, 0.5 op_sel_hi:[1,1,0] clamp
  v_pk_fma_f16 v187, v187, v51, 0.5 op_sel_hi:[1,1,0] clamp
  v_add_f32 v180, v180, v181
  v_add_f32 v182, v182, v183
  v_mfma_f32_16x16x32_bf16 v[16:19], a[224:227], v[224:227], v[16:19]
  v_pk_mul_f16 v184, v184, v48
  v_pk_mul_f16 v185, v185, v49
  v_permlane32_swap_b32_e64 v12, v14
  v_mfma_f32_16x16x32_bf16 v[24:27], a[224:227], v[228:231], v[24:27]
  v_pk_mul_f16 v186, v186, v50
  v_pk_mul_f16 v187, v187, v51
  v_permlane32_swap_b32_e64 v180, v182
  v_mfma_f32_16x16x32_bf16 v[20:23], a[228:231], v[224:227], v[20:23]
  v_pk_fma_f16 v56, v52, v52, s20 op_sel_hi:[1,1,0] neg_lo:[1,0,0] neg_hi:[1,0,0] clamp
  v_pk_fma_f16 v57, v53, v53, s20 op_sel_hi:[1,1,0] neg_lo:[1,0,0] neg_hi:[1,0,0] clamp
  v_add_f32 v12, v12, v14
  v_add_f32 v180, v180, v182
  v_mfma_f32_16x16x32_bf16 v[28:31], a[228:231], v[228:231], v[28:31]
  v_pk_fma_f16 v58, v54, v54, s20 op_sel_hi:[1,1,0] neg_lo:[1,0,0] neg_hi:[1,0,0] clamp
  v_pk_fma_f16 v59, v55, v55, s20 op_sel_hi:[1,1,0] neg_lo:[1,0,0] neg_hi:[1,0,0] clamp
  v_permlane16_swap_b32_e64 v12, v180
  v_mfma_f32_16x16x32_bf16 v[16:19], a[232:235], v[232:235], v[16:19]
  v_pk_fma_f16 v188, v56, v56, s20 op_sel:[0,0,1]
  v_pk_fma_f16 v189, v57, v57, s20 op_sel:[0,0,1]
  v_add_f32 v12, v12, v180
  v_mov_b32 v14, v12
  v_mfma_f32_16x16x32_bf16 v[24:27], a[232:235], v[236:239], v[24:27]
  v_pk_fma_f16 v190, v58, v58, s20 op_sel:[0,0,1]
  v_pk_fma_f16 v191, v59, v59, s20 op_sel:[0,0,1]
  v_permlane32_swap_b32_e64 v12, v14
  v_mfma_f32_16x16x32_bf16 v[20:23], a[236:239], v[232:235], v[20:23]
  v_pk_fma_f16 v188, v188, v56, s21 op_sel_hi:[1,1,0]
  v_pk_fma_f16 v189, v189, v57, s21 op_sel_hi:[1,1,0]
  v_mul_f32_e64 v12, s24, v12
  v_mul_f32 v13, s24, v14
  v_mfma_f32_16x16x32_bf16 v[28:31], a[236:239], v[236:239], v[28:31]
  s_waitcnt lgkmcnt(0)
  v_pk_fma_f16 v190, v190, v58, s21 op_sel_hi:[1,1,0]
  v_pk_fma_f16 v191, v191, v59, s21 op_sel_hi:[1,1,0]
  v_fma_f32 v13, -v12, v12, v13
  v_max_f32_e64 v13, 0, v13
  v_mfma_f32_16x16x32_f16 v[64:67], v[184:187], v[192:195], v[64:67]
  v_pk_fma_f16 v188, v188, v52, 0.5 op_sel_hi:[1,1,0] clamp
  v_pk_fma_f16 v189, v189, v53, 0.5 op_sel_hi:[1,1,0] clamp
  v_add_f32_e64 v13, s25, v13
  v_mfma_f32_16x16x32_f16 v[68:71], v[184:187], v[196:199], v[68:71]
  v_pk_fma_f16 v190, v190, v54, 0.5 op_sel_hi:[1,1,0] clamp
  v_pk_fma_f16 v191, v191, v55, 0.5 op_sel_hi:[1,1,0] clamp
  v_rsq_f32_e64 v13, v13
  v_mfma_f32_16x16x32_f16 v[72:75], v[184:187], v[200:203], v[72:75]
  v_pk_mul_f16 v188, v188, v52
  v_pk_mul_f16 v189, v189, v53
  v_mul_f32_e64 v14, s22, v13
  v_mul_f32_e64 v12, -v12, v14
  v_mfma_f32_16x16x32_f16 v[76:79], v[184:187], v[204:207], v[76:79]
  v_pk_mul_f16 v190, v190, v54
  v_pk_mul_f16 v191, v191, v55
  v_mov_b32_e64 v182, v14
  v_mov_b32_e64 v180, v12
  v_mfma_f32_16x16x32_f16 v[80:83], v[184:187], v[208:211], v[80:83]
  v_cvt_pk_f16_f32 v48, v16, v17
  v_cvt_pk_f16_f32 v49, v18, v19
  v_permlane16_swap_b32_e64 v14, v182
  v_mfma_f32_16x16x32_f16 v[84:87], v[184:187], v[212:215], v[84:87]
  v_cvt_pk_f16_f32 v50, v20, v21
  v_cvt_pk_f16_f32 v51, v22, v23
  v_permlane16_swap_b32_e64 v12, v180
  v_mfma_f32_16x16x32_f16 v[88:91], v[188:191], v[192:195], v[88:91]
  ds_read_b128 v[192:195], v0 offset:61440
  v_cvt_pk_f16_f32 v52, v24, v25
  v_cvt_pk_f16_f32 v53, v26, v27
  v_mfma_f32_16x16x32_f16 v[92:95], v[188:191], v[196:199], v[92:95]
  ds_read_b128 v[196:199], v0 offset:62464
  v_cvt_pk_f16_f32 v54, v28, v29
  v_cvt_pk_f16_f32 v55, v30, v31
  v_mfma_f32_16x16x32_f16 v[96:99], v[188:191], v[200:203], v[96:99]
  ds_read_b128 v[200:203], v0 offset:63488
  v_pk_fma_f16 v56, v48, v48, s20 op_sel_hi:[1,1,0] neg_lo:[1,0,0] neg_hi:[1,0,0] clamp
  v_pk_fma_f16 v57, v49, v49, s20 op_sel_hi:[1,1,0] neg_lo:[1,0,0] neg_hi:[1,0,0] clamp
  v_mfma_f32_16x16x32_f16 v[100:103], v[188:191], v[204:207], v[100:103]
  ds_read_b128 v[204:207], v0 offset:64512
  v_pk_fma_f16 v58, v50, v50, s20 op_sel_hi:[1,1,0] neg_lo:[1,0,0] neg_hi:[1,0,0] clamp
  v_pk_fma_f16 v59, v51, v51, s20 op_sel_hi:[1,1,0] neg_lo:[1,0,0] neg_hi:[1,0,0] clamp
  v_mfma_f32_16x16x32_f16 v[104:107], v[188:191], v[208:211], v[104:107]
  ds_read_b128 v[208:211], v1
  v_pk_fma_f16 v184, v56, v56, s20 op_sel:[0,0,1]
  v_pk_fma_f16 v185, v57, v57, s20 op_sel:[0,0,1]
  v_mfma_f32_16x16x32_f16 v[108:111], v[188:191], v[212:215], v[108:111]
  ds_read_b128 v[212:215], v1 offset:1024
  v_pk_fma_f16 v186, v58, v58, s20 op_sel:[0,0,1]
  v_pk_fma_f16 v187, v59, v59, s20 op_sel:[0,0,1]
  v_fma_f32 v112, v112, v14, v12
  v_fma_f32 v113, v113, v14, v12
  v_fma_f32 v114, v114, v182, v180
  v_fma_f32 v115, v115, v182, v180
  v_pk_fma_f32 v[116:117], v[116:117], v[14:15], v[12:13] op_sel_hi:[1,0,0]
  v_pk_fma_f32 v[118:119], v[118:119], v[182:183], v[180:181] op_sel_hi:[1,0,0]
  v_pk_fma_f32 v[120:121], v[120:121], v[14:15], v[12:13] op_sel_hi:[1,0,0]
  v_pk_fma_f32 v[122:123], v[122:123], v[182:183], v[180:181] op_sel_hi:[1,0,0]
  v_pk_fma_f32 v[124:125], v[124:125], v[14:15], v[12:13] op_sel_hi:[1,0,0]
  v_pk_fma_f32 v[126:127], v[126:127], v[182:183], v[180:181] op_sel_hi:[1,0,0]
  v_pk_fma_f32 v[128:129], v[128:129], v[14:15], v[12:13] op_sel_hi:[1,0,0]
  v_pk_fma_f32 v[130:131], v[130:131], v[182:183], v[180:181] op_sel_hi:[1,0,0]
  v_pk_fma_f32 v[132:133], v[132:133], v[14:15], v[12:13] op_sel_hi:[1,0,0]
  v_pk_fma_f32 v[134:135], v[134:135], v[182:183], v[180:181] op_sel_hi:[1,0,0]
  v_pk_fma_f32 v[136:137], v[136:137], v[14:15], v[12:13] op_sel_hi:[1,0,0]
  v_pk_fma_f32 v[138:139], v[138:139], v[182:183], v[180:181] op_sel_hi:[1,0,0]
  v_pk_fma_f32 v[140:141], v[140:141], v[14:15], v[12:13] op_sel_hi:[1,0,0]
  v_pk_fma_f32 v[142:143], v[142:143], v[182:183], v[180:181] op_sel_hi:[1,0,0]
  v_pk_fma_f32 v[144:145], v[144:145], v[14:15], v[12:13] op_sel_hi:[1,0,0]
  v_pk_fma_f32 v[146:147], v[146:147], v[182:183], v[180:181] op_sel_hi:[1,0,0]
  v_pk_fma_f32 v[148:149], v[148:149], v[14:15], v[12:13] op_sel_hi:[1,0,0]
  v_pk_fma_f32 v[150:151], v[150:151], v[182:183], v[180:181] op_sel_hi:[1,0,0]
  v_pk_fma_f32 v[152:153], v[152:153], v[14:15], v[12:13] op_sel_hi:[1,0,0]
  v_pk_fma_f32 v[154:155], v[154:155], v[182:183], v[180:181] op_sel_hi:[1,0,0]
  v_pk_fma_f32 v[156:157], v[156:157], v[14:15], v[12:13] op_sel_hi:[1,0,0]
  v_pk_fma_f32 v[158:159], v[158:159], v[182:183], v[180:181] op_sel_hi:[1,0,0]
  v_mfma_f32_16x16x32_bf16 v[16:19], v[32:35], v[216:219], 0
  v_pk_fma_f16 v184, v184, v56, s21 op_sel_hi:[1,1,0]
  v_pk_fma_f16 v185, v185, v57, s21 op_sel_hi:[1,1,0]
  v_cndmask_b32 v157, v157, v250, s[12:13]
  v_cndmask_b32 v159, v159, v250, s[12:13]
  v_mfma_f32_16x16x32_bf16 v[24:27], v[32:35], v[220:223], 0
  ds_read_b128 v[180:183], v0 offset:23552
  v_pk_fma_f16 v186, v186, v58, s21 op_sel_hi:[1,1,0]
  v_pk_fma_f16 v187, v187, v59, s21 op_sel_hi:[1,1,0]
  v_mfma_f32_16x16x32_bf16 v[20:23], v[36:39], v[216:219], 0
  v_pk_fma_f16 v184, v184, v48, 0.5 op_sel_hi:[1,1,0] clamp
  v_pk_fma_f16 v185, v185, v49, 0.5 op_sel_hi:[1,1,0] clamp
  v_mfma_f32_16x16x32_bf16 v[28:31], v[36:39], v[220:223], 0
  v_pk_fma_f16 v186, v186, v50, 0.5 op_sel_hi:[1,1,0] clamp
  v_pk_fma_f16 v187, v187, v51, 0.5 op_sel_hi:[1,1,0] clamp
  v_cvt_pk_bf16_f32 v216, v112, v113
  v_cvt_pk_bf16_f32 v217, v116, v117
  v_mfma_f32_16x16x32_bf16 v[16:19], v[40:43], v[224:227], v[16:19]
  v_pk_mul_f16 v184, v184, v48
  v_pk_mul_f16 v185, v185, v49
  v_cvt_pk_bf16_f32 v218, v120, v121
  v_cvt_pk_bf16_f32 v219, v124, v125
  v_mfma_f32_16x16x32_bf16 v[24:27], v[40:43], v[228:231], v[24:27]
  v_pk_mul_f16 v186, v186, v50
  v_pk_mul_f16 v187, v187, v51
  v_cvt_pk_bf16_f32 v220, v114, v115
  v_cvt_pk_bf16_f32 v221, v118, v119
  v_mfma_f32_16x16x32_bf16 v[20:23], v[44:47], v[224:227], v[20:23]
  v_pk_fma_f16 v56, v52, v52, s20 op_sel_hi:[1,1,0] neg_lo:[1,0,0] neg_hi:[1,0,0] clamp
  v_pk_fma_f16 v57, v53, v53, s20 op_sel_hi:[1,1,0] neg_lo:[1,0,0] neg_hi:[1,0,0] clamp
  v_cvt_pk_bf16_f32 v222, v122, v123
  v_cvt_pk_bf16_f32 v223, v126, v127
  v_mfma_f32_16x16x32_bf16 v[28:31], v[44:47], v[228:231], v[28:31]
  v_pk_fma_f16 v58, v54, v54, s20 op_sel_hi:[1,1,0] neg_lo:[1,0,0] neg_hi:[1,0,0] clamp
  v_pk_fma_f16 v59, v55, v55, s20 op_sel_hi:[1,1,0] neg_lo:[1,0,0] neg_hi:[1,0,0] clamp
  v_cvt_pk_bf16_f32 v224, v128, v129
  v_cvt_pk_bf16_f32 v225, v132, v133
  v_mfma_f32_16x16x32_bf16 v[16:19], v[60:63], v[232:235], v[16:19]
  v_pk_fma_f16 v188, v56, v56, s20 op_sel:[0,0,1]
  v_pk_fma_f16 v189, v57, v57, s20 op_sel:[0,0,1]
  v_cvt_pk_bf16_f32 v226, v136, v137
  v_cvt_pk_bf16_f32 v227, v140, v141
  v_mfma_f32_16x16x32_bf16 v[24:27], v[60:63], v[236:239], v[24:27]
  v_pk_fma_f16 v190, v58, v58, s20 op_sel:[0,0,1]
  v_pk_fma_f16 v191, v59, v59, s20 op_sel:[0,0,1]
  v_cvt_pk_bf16_f32 v228, v130, v131
  v_cvt_pk_bf16_f32 v229, v134, v135
  v_mfma_f32_16x16x32_bf16 v[20:23], v[244:247], v[232:235], v[20:23]
  s_nop 0
  v_pk_fma_f16 v188, v188, v56, s21 op_sel_hi:[1,1,0]
  v_pk_fma_f16 v189, v189, v57, s21 op_sel_hi:[1,1,0]
  v_cvt_pk_bf16_f32 v230, v138, v139
  v_cvt_pk_bf16_f32 v231, v142, v143
  v_mfma_f32_16x16x32_bf16 v[28:31], v[244:247], v[236:239], v[28:31]
  s_waitcnt lgkmcnt(0)
  v_pk_fma_f16 v190, v190, v58, s21 op_sel_hi:[1,1,0]
  v_pk_fma_f16 v191, v191, v59, s21 op_sel_hi:[1,1,0]
  v_cvt_pk_bf16_f32 v232, v144, v145
  v_cvt_pk_bf16_f32 v233, v148, v149
  v_mfma_f32_16x16x32_f16 v[64:67], v[184:187], v[192:195], v[64:67]
  v_pk_fma_f16 v188, v188, v52, 0.5 op_sel_hi:[1,1,0] clamp
  v_pk_fma_f16 v189, v189, v53, 0.5 op_sel_hi:[1,1,0] clamp
  v_cvt_pk_bf16_f32 v234, v152, v153
  v_cvt_pk_bf16_f32 v235, v156, v157
  v_mfma_f32_16x16x32_f16 v[68:71], v[184:187], v[196:199], v[68:71]
  v_pk_fma_f16 v190, v190, v54, 0.5 op_sel_hi:[1,1,0] clamp
  v_pk_fma_f16 v191, v191, v55, 0.5 op_sel_hi:[1,1,0] clamp
  v_cvt_pk_bf16_f32 v236, v146, v147
  v_cvt_pk_bf16_f32 v237, v150, v151
  v_mfma_f32_16x16x32_f16 v[72:75], v[184:187], v[200:203], v[72:75]
  v_pk_mul_f16 v188, v188, v52
  v_pk_mul_f16 v189, v189, v53
  v_cvt_pk_bf16_f32 v238, v154, v155
  v_cvt_pk_bf16_f32 v239, v158, v159
  v_mfma_f32_16x16x32_f16 v[76:79], v[184:187], v[204:207], v[76:79]
  v_pk_mul_f16 v190, v190, v54
  v_pk_mul_f16 v191, v191, v55
  v_mfma_f32_16x16x32_f16 v[80:83], v[184:187], v[208:211], v[80:83]
  v_cvt_pk_f16_f32 v48, v16, v17
  v_cvt_pk_f16_f32 v49, v18, v19
  v_mfma_f32_16x16x32_f16 v[84:87], v[184:187], v[212:215], v[84:87]
  v_cvt_pk_f16_f32 v50, v20, v21
  v_cvt_pk_f16_f32 v51, v22, v23
  v_mfma_f32_16x16x32_f16 v[88:91], v[188:191], v[192:195], v[88:91]
  ds_read_b128 v[192:195], v1 offset:2048
  v_cvt_pk_f16_f32 v52, v24, v25
  v_cvt_pk_f16_f32 v53, v26, v27
  v_mfma_f32_16x16x32_f16 v[92:95], v[188:191], v[196:199], v[92:95]
  ds_read_b128 v[196:199], v1 offset:3072
  v_cvt_pk_f16_f32 v54, v28, v29
  v_cvt_pk_f16_f32 v55, v30, v31
  v_mfma_f32_16x16x32_f16 v[96:99], v[188:191], v[200:203], v[96:99]
  ds_read_b128 v[200:203], v1 offset:4096
  v_pk_fma_f16 v56, v48, v48, s20 op_sel_hi:[1,1,0] neg_lo:[1,0,0] neg_hi:[1,0,0] clamp
  v_pk_fma_f16 v57, v49, v49, s20 op_sel_hi:[1,1,0] neg_lo:[1,0,0] neg_hi:[1,0,0] clamp
  v_mfma_f32_16x16x32_f16 v[100:103], v[188:191], v[204:207], v[100:103]
  ds_read_b128 v[204:207], v1 offset:5120
  v_pk_fma_f16 v58, v50, v50, s20 op_sel_hi:[1,1,0] neg_lo:[1,0,0] neg_hi:[1,0,0] clamp
  v_pk_fma_f16 v59, v51, v51, s20 op_sel_hi:[1,1,0] neg_lo:[1,0,0] neg_hi:[1,0,0] clamp
  v_mfma_f32_16x16x32_f16 v[104:107], v[188:191], v[208:211], v[104:107]
  ds_read_b128 v[208:211], v1 offset:6144
  v_pk_fma_f16 v184, v56, v56, s20 op_sel:[0,0,1]
  v_pk_fma_f16 v185, v57, v57, s20 op_sel:[0,0,1]
  v_mfma_f32_16x16x32_f16 v[108:111], v[188:191], v[212:215], v[108:111]
  ds_read_b128 v[212:215], v1 offset:7168
  ds_read2_b32 v[144:145], v5 offset0:0 offset1:3
  v_pk_fma_f16 v186, v58, v58, s20 op_sel:[0,0,1]
  v_pk_fma_f16 v187, v59, v59, s20 op_sel:[0,0,1]
  v_mfma_f32_16x16x32_bf16 v[16:19], v[160:163], v[216:219], 0
  v_pk_fma_f16 v184, v184, v56, s21 op_sel_hi:[1,1,0]
  v_pk_fma_f16 v185, v185, v57, s21 op_sel_hi:[1,1,0]
  v_mfma_f32_16x16x32_bf16 v[24:27], v[160:163], v[220:223], 0
  ds_read_b128 v[160:163], v2
  v_pk_fma_f16 v186, v186, v58, s21 op_sel_hi:[1,1,0]
  v_pk_fma_f16 v187, v187, v59, s21 op_sel_hi:[1,1,0]
  v_mfma_f32_16x16x32_bf16 v[20:23], v[164:167], v[216:219], 0
  v_pk_fma_f16 v184, v184, v48, 0.5 op_sel_hi:[1,1,0] clamp
  v_pk_fma_f16 v185, v185, v49, 0.5 op_sel_hi:[1,1,0] clamp
  v_mfma_f32_16x16x32_bf16 v[28:31], v[164:167], v[220:223], 0
  ds_read_b128 v[164:167], v2 offset:256
  ds_read2_b32 v[146:147], v5 offset0:6 offset1:9
  v_pk_fma_f16 v186, v186, v50, 0.5 op_sel_hi:[1,1,0] clamp
  v_pk_fma_f16 v187, v187, v51, 0.5 op_sel_hi:[1,1,0] clamp
  v_mfma_f32_16x16x32_bf16 v[16:19], v[168:171], v[224:227], v[16:19]
  v_pk_mul_f16 v184, v184, v48
  v_pk_mul_f16 v185, v185, v49
  v_mfma_f32_16x16x32_bf16 v[24:27], v[168:171], v[228:231], v[24:27]
  ds_read_b128 v[168:171], v2 offset:512
  v_pk_mul_f16 v186, v186, v50
  v_pk_mul_f16 v187, v187, v51
  v_mfma_f32_16x16x32_bf16 v[20:23], v[172:175], v[224:227], v[20:23]
  ds_read2_b32 v[148:149], v5 offset0:1 offset1:4
  v_pk_fma_f16 v56, v52, v52, s20 op_sel_hi:[1,1,0] neg_lo:[1,0,0] neg_hi:[1,0,0] clamp
  v_pk_fma_f16 v57, v53, v53, s20 op_sel_hi:[1,1,0] neg_lo:[1,0,0] neg_hi:[1,0,0] clamp
  v_mfma_f32_16x16x32_bf16 v[28:31], v[172:175], v[228:231], v[28:31]
  ds_read_b128 v[172:175], v2 offset:768
  v_pk_fma_f16 v58, v54, v54, s20 op_sel_hi:[1,1,0] neg_lo:[1,0,0] neg_hi:[1,0,0] clamp
  v_pk_fma_f16 v59, v55, v55, s20 op_sel_hi:[1,1,0] neg_lo:[1,0,0] neg_hi:[1,0,0] clamp
  v_mfma_f32_16x16x32_bf16 v[16:19], v[176:179], v[232:235], v[16:19]
  v_pk_fma_f16 v188, v56, v56, s20 op_sel:[0,0,1]
  v_pk_fma_f16 v189, v57, v57, s20 op_sel:[0,0,1]
  v_mfma_f32_16x16x32_bf16 v[24:27], v[176:179], v[236:239], v[24:27]
  ds_read_b128 v[176:179], v2 offset:1024
  ds_read2_b32 v[150:151], v5 offset0:7 offset1:10
  v_pk_fma_f16 v190, v58, v58, s20 op_sel:[0,0,1]
  v_pk_fma_f16 v191, v59, v59, s20 op_sel:[0,0,1]
  v_mfma_f32_16x16x32_bf16 v[20:23], v[180:183], v[232:235], v[20:23]
  s_nop 0
  v_pk_fma_f16 v188, v188, v56, s21 op_sel_hi:[1,1,0]
  v_pk_fma_f16 v189, v189, v57, s21 op_sel_hi:[1,1,0]
  v_mfma_f32_16x16x32_bf16 v[28:31], v[180:183], v[236:239], v[28:31]
  s_waitcnt lgkmcnt(5)
  ds_read_b128 v[180:183], v2 offset:1280
  v_pk_fma_f16 v190, v190, v58, s21 op_sel_hi:[1,1,0]
  v_pk_fma_f16 v191, v191, v59, s21 op_sel_hi:[1,1,0]
  v_mfma_f32_16x16x32_f16 v[64:67], v[184:187], v[192:195], v[64:67]
  ds_read2_b32 v[152:153], v5 offset0:2 offset1:5
  v_pk_fma_f16 v188, v188, v52, 0.5 op_sel_hi:[1,1,0] clamp
  v_pk_fma_f16 v189, v189, v53, 0.5 op_sel_hi:[1,1,0] clamp
  v_mfma_f32_16x16x32_f16 v[68:71], v[184:187], v[196:199], v[68:71]
  v_pk_fma_f16 v190, v190, v54, 0.5 op_sel_hi:[1,1,0] clamp
  v_pk_fma_f16 v191, v191, v55, 0.5 op_sel_hi:[1,1,0] clamp
  v_mfma_f32_16x16x32_f16 v[72:75], v[184:187], v[200:203], v[72:75]
  v_pk_mul_f16 v188, v188, v52
  v_pk_mul_f16 v189, v189, v53
  v_mfma_f32_16x16x32_f16 v[76:79], v[184:187], v[204:207], v[76:79]
  v_pk_mul_f16 v190, v190, v54
  v_pk_mul_f16 v191, v191, v55
  v_cvt_pk_bf16_f32 v112, v64, v68
  v_cvt_pk_bf16_f32 v116, v65, v69
  v_mfma_f32_16x16x32_f16 v[80:83], v[184:187], v[208:211], v[80:83]
  ds_read2_b32 v[154:155], v5 offset0:8 offset1:11
  v_cvt_pk_bf16_f32 v120, v66, v70
  v_cvt_pk_bf16_f32 v124, v67, v71
  v_mfma_f32_16x16x32_f16 v[84:87], v[184:187], v[212:215], v[84:87]
  v_cvt_pk_bf16_f32 v113, v72, v76
  v_cvt_pk_bf16_f32 v117, v73, v77
  v_cvt_pk_bf16_f32 v121, v74, v78
  v_cvt_pk_bf16_f32 v125, v75, v79
  v_mfma_f32_16x16x32_f16 v[88:91], v[188:191], v[192:195], v[88:91]
  ds_read_b128 v[192:195], v1 offset:8192
  ds_read2_b32 v[156:157], v251 offset0:0 offset1:3
  v_mfma_f32_16x16x32_f16 v[92:95], v[188:191], v[196:199], v[92:95]
  ds_read_b128 v[196:199], v1 offset:9216
  v_cvt_pk_bf16_f32 v114, v80, v84
  v_cvt_pk_bf16_f32 v118, v81, v85
  v_cvt_pk_bf16_f32 v122, v82, v86
  v_mfma_f32_16x16x32_f16 v[96:99], v[188:191], v[200:203], v[96:99]
  ds_read_b128 v[200:203], v1 offset:10240
  v_cvt_pk_f16_f32 v48, v16, v17
  v_cvt_pk_f16_f32 v49, v18, v19
  v_cvt_pk_bf16_f32 v126, v83, v87
  v_mfma_f32_16x16x32_f16 v[100:103], v[188:191], v[204:207], v[100:103]
  ds_read_b128 v[204:207], v1 offset:11264
  v_cvt_pk_f16_f32 v50, v20, v21
  v_cvt_pk_f16_f32 v51, v22, v23
  v_cvt_pk_bf16_f32 v128, v88, v92
  v_mfma_f32_16x16x32_f16 v[104:107], v[188:191], v[208:211], v[104:107]
  ds_read_b128 v[208:211], v1 offset:12288
  v_cvt_pk_f16_f32 v52, v24, v25
  v_cvt_pk_f16_f32 v53, v26, v27
  v_cvt_pk_bf16_f32 v132, v89, v93
  v_mfma_f32_16x16x32_f16 v[108:111], v[188:191], v[212:215], v[108:111]
  ds_read_b128 v[212:215], v1 offset:13312
  v_cvt_pk_f16_f32 v54, v28, v29
  v_cvt_pk_f16_f32 v55, v30, v31
  v_cvt_pk_bf16_f32 v136, v90, v94
  v_mfma_f32_16x16x32_bf16 v[16:19], a[0:3], v[216:219], 0
  ds_read2_b32 v[158:159], v251 offset0:6 offset1:9
  v_pk_fma_f16 v56, v48, v48, s20 op_sel_hi:[1,1,0] neg_lo:[1,0,0] neg_hi:[1,0,0] clamp
  v_pk_fma_f16 v57, v49, v49, s20 op_sel_hi:[1,1,0] neg_lo:[1,0,0] neg_hi:[1,0,0] clamp
  v_cvt_pk_bf16_f32 v140, v91, v95
  v_mfma_f32_16x16x32_bf16 v[24:27], a[0:3], v[220:223], 0
  v_pk_fma_f16 v58, v50, v50, s20 op_sel_hi:[1,1,0] neg_lo:[1,0,0] neg_hi:[1,0,0] clamp
  v_pk_fma_f16 v59, v51, v51, s20 op_sel_hi:[1,1,0] neg_lo:[1,0,0] neg_hi:[1,0,0] clamp
  v_cvt_pk_bf16_f32 v129, v96, v100
  v_cvt_pk_bf16_f32 v133, v97, v101
  v_mfma_f32_16x16x32_bf16 v[20:23], a[4:7], v[216:219], 0
  v_pk_fma_f16 v184, v56, v56, s20 op_sel:[0,0,1]
  v_pk_fma_f16 v185, v57, v57, s20 op_sel:[0,0,1]
  v_cvt_pk_bf16_f32 v137, v98, v102
  v_cvt_pk_bf16_f32 v141, v99, v103
  v_mfma_f32_16x16x32_bf16 v[28:31], a[4:7], v[220:223], 0
  v_pk_fma_f16 v186, v58, v58, s20 op_sel:[0,0,1]
  v_pk_fma_f16 v187, v59, v59, s20 op_sel:[0,0,1]
  v_cvt_pk_bf16_f32 v130, v104, v108
  v_cvt_pk_bf16_f32 v134, v105, v109
  v_mfma_f32_16x16x32_bf16 v[16:19], a[8:11], v[224:227], v[16:19]
  v_pk_fma_f16 v184, v184, v56, s21 op_sel_hi:[1,1,0]
  v_pk_fma_f16 v185, v185, v57, s21 op_sel_hi:[1,1,0]
  v_cvt_pk_bf16_f32 v138, v106, v110
  v_cvt_pk_bf16_f32 v142, v107, v111
  v_mfma_f32_16x16x32_bf16 v[24:27], a[8:11], v[228:231], v[24:27]
  buffer_store_dwordx3 v[112:114], v10, s[8:11], s28 offen sc1 nt
  v_pk_fma_f16 v186, v186, v58, s21 op_sel_hi:[1,1,0]
  v_pk_fma_f16 v187, v187, v59, s21 op_sel_hi:[1,1,0]
  v_mfma_f32_16x16x32_bf16 v[20:23], a[12:15], v[224:227], v[20:23]
  v_pk_fma_f16 v184, v184, v48, 0.5 op_sel_hi:[1,1,0] clamp
  v_pk_fma_f16 v185, v185, v49, 0.5 op_sel_hi:[1,1,0] clamp
  v_mfma_f32_16x16x32_bf16 v[28:31], a[12:15], v[228:231], v[28:31]
  v_pk_fma_f16 v186, v186, v50, 0.5 op_sel_hi:[1,1,0] clamp
  v_pk_fma_f16 v187, v187, v51, 0.5 op_sel_hi:[1,1,0] clamp
  v_mfma_f32_16x16x32_bf16 v[16:19], a[16:19], v[232:235], v[16:19]
  v_pk_mul_f16 v184, v184, v48
  v_pk_mul_f16 v185, v185, v49
  v_mfma_f32_16x16x32_bf16 v[24:27], a[16:19], v[236:239], v[24:27]
  buffer_store_dwordx3 v[116:118], v10, s[8:11], s28 offen offset:384 sc1 nt
  v_pk_mul_f16 v186, v186, v50
  v_pk_mul_f16 v187, v187, v51
  v_mfma_f32_16x16x32_bf16 v[20:23], a[20:23], v[232:235], v[20:23]
  v_pk_fma_f16 v56, v52, v52, s20 op_sel_hi:[1,1,0] neg_lo:[1,0,0] neg_hi:[1,0,0] clamp
  v_pk_fma_f16 v57, v53, v53, s20 op_sel_hi:[1,1,0] neg_lo:[1,0,0] neg_hi:[1,0,0] clamp
  v_mfma_f32_16x16x32_bf16 v[28:31], a[20:23], v[236:239], v[28:31]
  s_waitcnt lgkmcnt(0)
  v_pk_fma_f16 v58, v54, v54, s20 op_sel_hi:[1,1,0] neg_lo:[1,0,0] neg_hi:[1,0,0] clamp
  v_pk_fma_f16 v59, v55, v55, s20 op_sel_hi:[1,1,0] neg_lo:[1,0,0] neg_hi:[1,0,0] clamp
  v_mfma_f32_16x16x32_f16 v[64:67], v[184:187], v[192:195], v[160:163]
  s_nop 0
  v_pk_fma_f16 v188, v56, v56, s20 op_sel:[0,0,1]
  v_pk_fma_f16 v189, v57, v57, s20 op_sel:[0,0,1]
  v_mfma_f32_16x16x32_f16 v[68:71], v[184:187], v[196:199], v[164:167]
  v_pk_fma_f16 v190, v58, v58, s20 op_sel:[0,0,1]
  v_pk_fma_f16 v191, v59, v59, s20 op_sel:[0,0,1]
  v_mfma_f32_16x16x32_f16 v[72:75], v[184:187], v[200:203], v[168:171]
  v_pk_fma_f16 v188, v188, v56, s21 op_sel_hi:[1,1,0]
  v_pk_fma_f16 v189, v189, v57, s21 op_sel_hi:[1,1,0]
  v_mfma_f32_16x16x32_f16 v[76:79], v[184:187], v[204:207], v[172:175]
  v_pk_fma_f16 v190, v190, v58, s21 op_sel_hi:[1,1,0]
  v_pk_fma_f16 v191, v191, v59, s21 op_sel_hi:[1,1,0]
  v_mfma_f32_16x16x32_bf16 v[64:67], v[144:147], v[240:243], v[64:67]
  v_pk_fma_f16 v188, v188, v52, 0.5 op_sel_hi:[1,1,0] clamp
  v_pk_fma_f16 v189, v189, v53, 0.5 op_sel_hi:[1,1,0] clamp
  v_mfma_f32_16x16x32_bf16 v[68:71], v[144:147], v[252:255], v[68:71]
  ds_read2_b32 v[144:145], v251 offset0:1 offset1:4
  v_pk_fma_f16 v190, v190, v54, 0.5 op_sel_hi:[1,1,0] clamp
  v_pk_fma_f16 v191, v191, v55, 0.5 op_sel_hi:[1,1,0] clamp
  v_mfma_f32_16x16x32_f16 v[80:83], v[184:187], v[208:211], v[176:179]
  v_pk_mul_f16 v188, v188, v52
  v_pk_mul_f16 v189, v189, v53
  v_mfma_f32_16x16x32_f16 v[84:87], v[184:187], v[212:215], v[180:183]
  v_pk_mul_f16 v190, v190, v54
  v_pk_mul_f16 v191, v191, v55
  v_mfma_f32_16x16x32_bf16 v[72:75], v[148:151], v[240:243], v[72:75]
  ds_read2_b32 v[146:147], v251 offset0:7 offset1:10
  v_cvt_pk_f16_f32 v48, v16, v17
  v_mfma_f32_16x16x32_bf16 v[76:79], v[148:151], v[252:255], v[76:79]
  ds_read2_b32 v[148:149], v251 offset0:2 offset1:5
  v_cvt_pk_f16_f32 v49, v18, v19
  v_mfma_f32_16x16x32_f16 v[88:91], v[188:191], v[192:195], v[160:163]
  ds_read_b128 v[192:195], v1 offset:14336
  v_cvt_pk_f16_f32 v50, v20, v21
  v_mfma_f32_16x16x32_f16 v[92:95], v[188:191], v[196:199], v[164:167]
  ds_read_b128 v[196:199], v1 offset:15360
  v_cvt_pk_f16_f32 v51, v22, v23
  v_mfma_f32_16x16x32_bf16 v[80:83], v[152:155], v[240:243], v[80:83]
  ds_read2_b32 v[150:151], v251 offset0:8 offset1:11
  v_subrev_u32 v14, 0x4100, v5
  v_add_u32 v5, 0x8200, v5
  v_min_u32_e64 v5, v14, v5
  v_mfma_f32_16x16x32_bf16 v[84:87], v[152:155], v[252:255], v[84:87]
  v_subrev_u32 v14, 0x4100, v251
  v_add_u32 v251, 0x8200, v251
  v_min_u32_e64 v251, v14, v251
  v_subrev_u32 v14, 0x4100, v4
  v_mfma_f32_16x16x32_f16 v[96:99], v[188:191], v[200:203], v[168:171]
  ds_read_b128 v[200:203], v1 offset:16384
  v_add_u32 v4, 0x8200, v4
  v_min_u32_e64 v4, v14, v4
  v_mfma_f32_16x16x32_f16 v[100:103], v[188:191], v[204:207], v[172:175]
  ds_read_b128 v[204:207], v1 offset:17408
  v_cvt_pk_f16_f32 v52, v24, v25
  v_mfma_f32_16x16x32_bf16 v[88:91], v[156:159], v[240:243], v[88:91]
  v_cvt_pk_f16_f32 v53, v26, v27
  v_cvt_pk_f16_f32 v54, v28, v29
  v_mfma_f32_16x16x32_bf16 v[92:95], v[156:159], v[252:255], v[92:95]
  v_cvt_pk_f16_f32 v55, v30, v31
  v_pk_fma_f16 v56, v48, v48, s20 op_sel_hi:[1,1,0] neg_lo:[1,0,0] neg_hi:[1,0,0] clamp
  v_mfma_f32_16x16x32_f16 v[104:107], v[188:191], v[208:211], v[176:179]
  ds_read_b128 v[208:211], v1 offset:18432
  v_pk_fma_f16 v57, v49, v49, s20 op_sel_hi:[1,1,0] neg_lo:[1,0,0] neg_hi:[1,0,0] clamp
  v_mfma_f32_16x16x32_f16 v[108:111], v[188:191], v[212:215], v[180:183]
  ds_read_b128 v[212:215], v1 offset:19456
  ds_read_b128 v[160:163], v3 offset:2400
  ds_read2_b64 v[176:179], v11 offset0:192 offset1:200
  v_mfma_f32_16x16x32_bf16 v[16:19], a[24:27], v[216:219], 0
  v_pk_fma_f16 v58, v50, v50, s20 op_sel_hi:[1,1,0] neg_lo:[1,0,0] neg_hi:[1,0,0] clamp
  v_pk_fma_f16 v59, v51, v51, s20 op_sel_hi:[1,1,0] neg_lo:[1,0,0] neg_hi:[1,0,0] clamp
  v_mfma_f32_16x16x32_bf16 v[24:27], a[24:27], v[220:223], 0
  buffer_store_dwordx3 v[120:122], v10, s[8:11], s57 offen sc1 nt
  v_mfma_f32_16x16x32_bf16 v[20:23], a[28:31], v[216:219], 0
  v_pk_fma_f16 v184, v56, v56, s20 op_sel:[0,0,1]
  v_pk_fma_f16 v185, v57, v57, s20 op_sel:[0,0,1]
  v_mfma_f32_16x16x32_bf16 v[28:31], a[28:31], v[220:223], 0
  s_waitcnt lgkmcnt(4)
  v_pk_fma_f16 v186, v58, v58, s20 op_sel:[0,0,1]
  v_pk_fma_f16 v187, v59, v59, s20 op_sel:[0,0,1]
  v_mfma_f32_16x16x32_bf16 v[96:99], v[144:147], v[240:243], v[96:99]
  s_nop 0
  v_pk_fma_f16 v184, v184, v56, s21 op_sel_hi:[1,1,0]
  v_pk_fma_f16 v185, v185, v57, s21 op_sel_hi:[1,1,0]
  v_mfma_f32_16x16x32_bf16 v[100:103], v[144:147], v[252:255], v[100:103]
  v_pk_fma_f16 v186, v186, v58, s21 op_sel_hi:[1,1,0]
  v_pk_fma_f16 v187, v187, v59, s21 op_sel_hi:[1,1,0]
  v_mfma_f32_16x16x32_bf16 v[16:19], a[32:35], v[224:227], v[16:19]
  v_pk_fma_f16 v184, v184, v48, 0.5 op_sel_hi:[1,1,0] clamp
  v_pk_fma_f16 v185, v185, v49, 0.5 op_sel_hi:[1,1,0] clamp
  v_mfma_f32_16x16x32_bf16 v[24:27], a[32:35], v[228:231], v[24:27]
  v_pk_fma_f16 v186, v186, v50, 0.5 op_sel_hi:[1,1,0] clamp
  v_pk_fma_f16 v187, v187, v51, 0.5 op_sel_hi:[1,1,0] clamp
  v_mfma_f32_16x16x32_bf16 v[104:107], v[148:151], v[240:243], v[104:107]
  s_nop 0
  v_pk_mul_f16 v184, v184, v48
  v_pk_mul_f16 v185, v185, v49
  v_mfma_f32_16x16x32_bf16 v[108:111], v[148:151], v[252:255], v[108:111]
  s_nop 0
  v_pk_mul_f16 v186, v186, v50
  v_pk_mul_f16 v187, v187, v51
  v_mfma_f32_16x16x32_bf16 v[20:23], a[36:39], v[224:227], v[20:23]
  v_pk_fma_f16 v56, v52, v52, s20 op_sel_hi:[1,1,0] neg_lo:[1,0,0] neg_hi:[1,0,0] clamp
  v_pk_fma_f16 v57, v53, v53, s20 op_sel_hi:[1,1,0] neg_lo:[1,0,0] neg_hi:[1,0,0] clamp
  v_mfma_f32_16x16x32_bf16 v[28:31], a[36:39], v[228:231], v[28:31]
  buffer_store_dwordx3 v[124:126], v10, s[8:11], s57 offen offset:384 sc1 nt
  v_pk_fma_f16 v58, v54, v54, s20 op_sel_hi:[1,1,0] neg_lo:[1,0,0] neg_hi:[1,0,0] clamp
  v_pk_fma_f16 v59, v55, v55, s20 op_sel_hi:[1,1,0] neg_lo:[1,0,0] neg_hi:[1,0,0] clamp
  v_mfma_f32_16x16x32_bf16 v[16:19], a[40:43], v[232:235], v[16:19]
  v_pk_fma_f16 v188, v56, v56, s20 op_sel:[0,0,1]
  v_pk_fma_f16 v189, v57, v57, s20 op_sel:[0,0,1]
  v_mfma_f32_16x16x32_bf16 v[24:27], a[40:43], v[236:239], v[24:27]
  buffer_load_dwordx4 v6, s[4:7], s29 offen lds
  buffer_load_dwordx4 v7, s[4:7], s29 offen offset:1024 lds
  buffer_load_dwordx4 v8, s[4:7], s29 offen offset:2048 lds
  buffer_load_dwordx4 v9, s[4:7], s29 offen offset:3072 lds
  v_pk_fma_f16 v190, v58, v58, s20 op_sel:[0,0,1]
  v_pk_fma_f16 v191, v59, v59, s20 op_sel:[0,0,1]
  v_mfma_f32_16x16x32_bf16 v[20:23], a[44:47], v[232:235], v[20:23]
  s_mov_b32 m0, s31
  v_pk_fma_f16 v188, v188, v56, s21 op_sel_hi:[1,1,0]
  v_pk_fma_f16 v189, v189, v57, s21 op_sel_hi:[1,1,0]
  v_mfma_f32_16x16x32_bf16 v[28:31], a[44:47], v[236:239], v[28:31]
  s_cmp_eq_u32 s26, 1
  v_pk_fma_f16 v190, v190, v58, s21 op_sel_hi:[1,1,0]
  v_pk_fma_f16 v191, v191, v59, s21 op_sel_hi:[1,1,0]
  v_mfma_f32_16x16x32_f16 v[64:67], v[184:187], v[192:195], v[64:67]
  s_cselect_b32 s35, 0x40000000, s23
  v_pk_fma_f16 v188, v188, v52, 0.5 op_sel_hi:[1,1,0] clamp
  v_pk_fma_f16 v189, v189, v53, 0.5 op_sel_hi:[1,1,0] clamp
  v_mfma_f32_16x16x32_f16 v[68:71], v[184:187], v[196:199], v[68:71]
  s_add_u32 s29, s29, s35
  v_pk_fma_f16 v190, v190, v54, 0.5 op_sel_hi:[1,1,0] clamp
  v_pk_fma_f16 v191, v191, v55, 0.5 op_sel_hi:[1,1,0] clamp
  v_mfma_f32_16x16x32_f16 v[72:75], v[184:187], v[200:203], v[72:75]
  v_pk_mul_f16 v188, v188, v52
  v_pk_mul_f16 v189, v189, v53
  v_mfma_f32_16x16x32_f16 v[76:79], v[184:187], v[204:207], v[76:79]
  s_waitcnt lgkmcnt(0)
  buffer_load_dwordx4 v6, s[4:7], s52 offen lds
  buffer_load_dwordx4 v7, s[4:7], s52 offen offset:1024 lds
  buffer_load_dwordx4 v8, s[4:7], s52 offen offset:2048 lds
  buffer_load_dwordx4 v9, s[4:7], s52 offen offset:3072 lds
  v_pk_mul_f16 v190, v190, v54
  v_pk_mul_f16 v191, v191, v55
  v_mfma_f32_16x16x32_f16 v[80:83], v[184:187], v[208:211], v[80:83]
  s_add_u32 s52, s52, s35
  v_cvt_pk_f16_f32 v48, v16, v17
  v_cvt_pk_f16_f32 v49, v18, v19
  v_mfma_f32_16x16x32_f16 v[84:87], v[184:187], v[212:215], v[84:87]
  s_mov_b32 s32, s30
  v_cvt_pk_f16_f32 v50, v20, v21
  v_cvt_pk_f16_f32 v51, v22, v23
  v_mfma_f32_16x16x32_f16 v[88:91], v[188:191], v[192:195], v[88:91]
  s_add_u32 s30, s33, 32
  ds_read_b128 v[192:195], v1 offset:20480
  v_cvt_pk_f16_f32 v52, v24, v25
  v_cvt_pk_f16_f32 v53, v26, v27
  v_mfma_f32_16x16x32_f16 v[92:95], v[188:191], v[196:199], v[92:95]
  s_mov_b32 s33, s31
  ds_read_b128 v[196:199], v1 offset:21504
  v_cvt_pk_f16_f32 v54, v28, v29
  v_cvt_pk_f16_f32 v55, v30, v31
  v_mfma_f32_16x16x32_f16 v[96:99], v[188:191], v[200:203], v[96:99]
  s_sub_u32 s31, s32, 32
  ds_read_b128 v[200:203], v1 offset:22528
  v_pk_fma_f16 v56, v48, v48, s20 op_sel_hi:[1,1,0] neg_lo:[1,0,0] neg_hi:[1,0,0] clamp
  v_pk_fma_f16 v57, v49, v49, s20 op_sel_hi:[1,1,0] neg_lo:[1,0,0] neg_hi:[1,0,0] clamp
  v_mfma_f32_16x16x32_f16 v[100:103], v[188:191], v[204:207], v[100:103]
  buffer_store_dwordx3 v[128:130], v10, s[8:11], s59 offen sc1 nt
  v_pk_fma_f16 v58, v50, v50, s20 op_sel_hi:[1,1,0] neg_lo:[1,0,0] neg_hi:[1,0,0] clamp
  v_pk_fma_f16 v59, v51, v51, s20 op_sel_hi:[1,1,0] neg_lo:[1,0,0] neg_hi:[1,0,0] clamp
  v_mfma_f32_16x16x32_f16 v[104:107], v[188:191], v[208:211], v[104:107]
  ds_read_b128 v[204:207], v1 offset:23552
  ds_read_b128 v[208:211], v1 offset:24576
  v_pk_fma_f16 v184, v56, v56, s20 op_sel:[0,0,1]
  v_pk_fma_f16 v185, v57, v57, s20 op_sel:[0,0,1]
  v_mfma_f32_16x16x32_f16 v[108:111], v[188:191], v[212:215], v[108:111]
  ds_read_b128 v[212:215], v1 offset:25600
  v_pk_fma_f16 v186, v58, v58, s20 op_sel:[0,0,1]
  v_pk_fma_f16 v187, v59, v59, s20 op_sel:[0,0,1]
  v_mfma_f32_16x16x32_bf16 v[16:19], a[48:51], v[216:219], 0
  v_pk_fma_f16 v184, v184, v56, s21 op_sel_hi:[1,1,0]
  v_pk_fma_f16 v185, v185, v57, s21 op_sel_hi:[1,1,0]
  v_mfma_f32_16x16x32_bf16 v[24:27], a[48:51], v[220:223], 0
  v_pk_fma_f16 v186, v186, v58, s21 op_sel_hi:[1,1,0]
  v_pk_fma_f16 v187, v187, v59, s21 op_sel_hi:[1,1,0]
  v_mfma_f32_16x16x32_bf16 v[20:23], a[52:55], v[216:219], 0
  v_pk_fma_f16 v184, v184, v48, 0.5 op_sel_hi:[1,1,0] clamp
  v_pk_fma_f16 v185, v185, v49, 0.5 op_sel_hi:[1,1,0] clamp
  v_mfma_f32_16x16x32_bf16 v[28:31], a[52:55], v[220:223], 0
  v_pk_fma_f16 v186, v186, v50, 0.5 op_sel_hi:[1,1,0] clamp
  v_pk_fma_f16 v187, v187, v51, 0.5 op_sel_hi:[1,1,0] clamp
  v_mfma_f32_16x16x32_bf16 v[16:19], a[56:59], v[224:227], v[16:19]
  v_pk_mul_f16 v184, v184, v48
  v_pk_mul_f16 v185, v185, v49
  v_mfma_f32_16x16x32_bf16 v[24:27], a[56:59], v[228:231], v[24:27]
  buffer_store_dwordx3 v[132:134], v10, s[8:11], s59 offen offset:384 sc1 nt
  v_pk_mul_f16 v186, v186, v50
  v_pk_mul_f16 v187, v187, v51
  v_mfma_f32_16x16x32_bf16 v[20:23], a[60:63], v[224:227], v[20:23]
  v_pk_fma_f16 v56, v52, v52, s20 op_sel_hi:[1,1,0] neg_lo:[1,0,0] neg_hi:[1,0,0] clamp
  v_pk_fma_f16 v57, v53, v53, s20 op_sel_hi:[1,1,0] neg_lo:[1,0,0] neg_hi:[1,0,0] clamp
  v_mfma_f32_16x16x32_bf16 v[28:31], a[60:63], v[228:231], v[28:31]
  v_pk_fma_f16 v58, v54, v54, s20 op_sel_hi:[1,1,0] neg_lo:[1,0,0] neg_hi:[1,0,0] clamp
  v_pk_fma_f16 v59, v55, v55, s20 op_sel_hi:[1,1,0] neg_lo:[1,0,0] neg_hi:[1,0,0] clamp
  v_mfma_f32_16x16x32_bf16 v[16:19], a[64:67], v[232:235], v[16:19]
  v_pk_fma_f16 v188, v56, v56, s20 op_sel:[0,0,1]
  v_pk_fma_f16 v189, v57, v57, s20 op_sel:[0,0,1]
  v_mfma_f32_16x16x32_bf16 v[24:27], a[64:67], v[236:239], v[24:27]
  v_pk_fma_f16 v190, v58, v58, s20 op_sel:[0,0,1]
  v_pk_fma_f16 v191, v59, v59, s20 op_sel:[0,0,1]
  v_mfma_f32_16x16x32_bf16 v[20:23], a[68:71], v[232:235], v[20:23]
  v_pk_fma_f16 v188, v188, v56, s21 op_sel_hi:[1,1,0]
  v_pk_fma_f16 v189, v189, v57, s21 op_sel_hi:[1,1,0]
  v_mfma_f32_16x16x32_bf16 v[28:31], a[68:71], v[236:239], v[28:31]
  s_waitcnt lgkmcnt(0)
  v_pk_fma_f16 v190, v190, v58, s21 op_sel_hi:[1,1,0]
  v_pk_fma_f16 v191, v191, v59, s21 op_sel_hi:[1,1,0]
  v_mfma_f32_16x16x32_f16 v[64:67], v[184:187], v[192:195], v[64:67]
  s_nop 0
  v_pk_fma_f16 v188, v188, v52, 0.5 op_sel_hi:[1,1,0] clamp
  v_pk_fma_f16 v189, v189, v53, 0.5 op_sel_hi:[1,1,0] clamp
  v_mfma_f32_16x16x32_f16 v[68:71], v[184:187], v[196:199], v[68:71]
  buffer_store_dwordx3 v[136:138], v10, s[8:11], s15 offen sc1 nt
  v_pk_fma_f16 v190, v190, v54, 0.5 op_sel_hi:[1,1,0] clamp
  v_pk_fma_f16 v191, v191, v55, 0.5 op_sel_hi:[1,1,0] clamp
  v_mfma_f32_16x16x32_f16 v[72:75], v[184:187], v[200:203], v[72:75]
  v_pk_mul_f16 v188, v188, v52
  v_pk_mul_f16 v189, v189, v53
  v_mfma_f32_16x16x32_f16 v[76:79], v[184:187], v[204:207], v[76:79]
  v_pk_mul_f16 v190, v190, v54
  v_pk_mul_f16 v191, v191, v55
  v_mfma_f32_16x16x32_f16 v[80:83], v[184:187], v[208:211], v[80:83]
  v_cvt_pk_f16_f32 v48, v16, v17
  v_cvt_pk_f16_f32 v49, v18, v19
  v_mfma_f32_16x16x32_f16 v[84:87], v[184:187], v[212:215], v[84:87]
  s_nop 0
  v_cvt_pk_f16_f32 v50, v20, v21
  v_cvt_pk_f16_f32 v51, v22, v23
  v_mfma_f32_16x16x32_f16 v[88:91], v[188:191], v[192:195], v[88:91]
  s_nop 0
  ds_read_b128 v[192:195], v1 offset:26624
  v_cvt_pk_f16_f32 v52, v24, v25
  v_cvt_pk_f16_f32 v53, v26, v27
  v_mfma_f32_16x16x32_f16 v[92:95], v[188:191], v[196:199], v[92:95]
  ds_read_b128 v[196:199], v1 offset:27648
  v_cvt_pk_f16_f32 v54, v28, v29
  v_cvt_pk_f16_f32 v55, v30, v31
  v_mfma_f32_16x16x32_f16 v[96:99], v[188:191], v[200:203], v[96:99]
  ds_read_b128 v[200:203], v1 offset:28672
  v_pk_fma_f16 v56, v48, v48, s20 op_sel_hi:[1,1,0] neg_lo:[1,0,0] neg_hi:[1,0,0] clamp
  v_pk_fma_f16 v57, v49, v49, s20 op_sel_hi:[1,1,0] neg_lo:[1,0,0] neg_hi:[1,0,0] clamp
  v_mfma_f32_16x16x32_f16 v[100:103], v[188:191], v[204:207], v[100:103]
  buffer_store_dwordx3 v[140:142], v10, s[8:11], s15 offen offset:384 sc1 nt
  v_pk_fma_f16 v58, v50, v50, s20 op_sel_hi:[1,1,0] neg_lo:[1,0,0] neg_hi:[1,0,0] clamp
  v_pk_fma_f16 v59, v51, v51, s20 op_sel_hi:[1,1,0] neg_lo:[1,0,0] neg_hi:[1,0,0] clamp
  v_mfma_f32_16x16x32_f16 v[104:107], v[188:191], v[208:211], v[104:107]
  ds_read_b128 v[204:207], v1 offset:29696
  ds_read_b128 v[208:211], v1 offset:30720
  v_pk_fma_f16 v184, v56, v56, s20 op_sel:[0,0,1]
  v_pk_fma_f16 v185, v57, v57, s20 op_sel:[0,0,1]
  v_mfma_f32_16x16x32_f16 v[108:111], v[188:191], v[212:215], v[108:111]
  ds_read_b128 v[212:215], v1 offset:31744
  v_pk_fma_f16 v186, v58, v58, s20 op_sel:[0,0,1]
  v_pk_fma_f16 v187, v59, v59, s20 op_sel:[0,0,1]
  v_mfma_f32_16x16x32_bf16 v[16:19], a[72:75], v[216:219], 0
  v_pk_fma_f16 v184, v184, v56, s21 op_sel_hi:[1,1,0]
  v_pk_fma_f16 v185, v185, v57, s21 op_sel_hi:[1,1,0]
  v_mfma_f32_16x16x32_bf16 v[24:27], a[72:75], v[220:223], 0
  s_nop 0
  v_pk_fma_f16 v186, v186, v58, s21 op_sel_hi:[1,1,0]
  v_pk_fma_f16 v187, v187, v59, s21 op_sel_hi:[1,1,0]
  v_mfma_f32_16x16x32_bf16 v[20:23], a[76:79], v[216:219], 0
  s_nop 0
  v_pk_fma_f16 v184, v184, v48, 0.5 op_sel_hi:[1,1,0] clamp
  v_pk_fma_f16 v185, v185, v49, 0.5 op_sel_hi:[1,1,0] clamp
  v_mfma_f32_16x16x32_bf16 v[28:31], a[76:79], v[220:223], 0
  v_pk_fma_f16 v186, v186, v50, 0.5 op_sel_hi:[1,1,0] clamp
  v_pk_fma_f16 v187, v187, v51, 0.5 op_sel_hi:[1,1,0] clamp
  v_mfma_f32_16x16x32_bf16 v[16:19], a[80:83], v[224:227], v[16:19]
  v_pk_mul_f16 v184, v184, v48
  v_pk_mul_f16 v185, v185, v49
  v_mfma_f32_16x16x32_bf16 v[24:27], a[80:83], v[228:231], v[24:27]
  v_pk_mul_f16 v186, v186, v50
  v_pk_mul_f16 v187, v187, v51
  v_mfma_f32_16x16x32_bf16 v[20:23], a[84:87], v[224:227], v[20:23]
  v_pk_fma_f16 v56, v52, v52, s20 op_sel_hi:[1,1,0] neg_lo:[1,0,0] neg_hi:[1,0,0] clamp
  v_pk_fma_f16 v57, v53, v53, s20 op_sel_hi:[1,1,0] neg_lo:[1,0,0] neg_hi:[1,0,0] clamp
  v_mfma_f32_16x16x32_bf16 v[28:31], a[84:87], v[228:231], v[28:31]
  v_pk_fma_f16 v58, v54, v54, s20 op_sel_hi:[1,1,0] neg_lo:[1,0,0] neg_hi:[1,0,0] clamp
  v_pk_fma_f16 v59, v55, v55, s20 op_sel_hi:[1,1,0] neg_lo:[1,0,0] neg_hi:[1,0,0] clamp
  v_mfma_f32_16x16x32_bf16 v[16:19], a[88:91], v[232:235], v[16:19]
  v_pk_fma_f16 v188, v56, v56, s20 op_sel:[0,0,1]
  v_pk_fma_f16 v189, v57, v57, s20 op_sel:[0,0,1]
  v_mfma_f32_16x16x32_bf16 v[24:27], a[88:91], v[236:239], v[24:27]
  v_pk_fma_f16 v190, v58, v58, s20 op_sel:[0,0,1]
  v_pk_fma_f16 v191, v59, v59, s20 op_sel:[0,0,1]
  v_mfma_f32_16x16x32_bf16 v[20:23], a[92:95], v[232:235], v[20:23]
  s_nop 0
  v_pk_fma_f16 v188, v188, v56, s21 op_sel_hi:[1,1,0]
  v_pk_fma_f16 v189, v189, v57, s21 op_sel_hi:[1,1,0]
  v_mfma_f32_16x16x32_bf16 v[28:31], a[92:95], v[236:239], v[28:31]
  s_waitcnt lgkmcnt(0)
  v_pk_fma_f16 v190, v190, v58, s21 op_sel_hi:[1,1,0]
  v_pk_fma_f16 v191, v191, v59, s21 op_sel_hi:[1,1,0]
  v_mfma_f32_16x16x32_f16 v[64:67], v[184:187], v[192:195], v[64:67]
  v_pk_fma_f16 v188, v188, v52, 0.5 op_sel_hi:[1,1,0] clamp
  v_pk_fma_f16 v189, v189, v53, 0.5 op_sel_hi:[1,1,0] clamp
  v_mfma_f32_16x16x32_f16 v[68:71], v[184:187], v[196:199], v[68:71]
  buffer_load_dword v249, v248, s[4:7], s29 offen
  v_pk_fma_f16 v190, v190, v54, 0.5 op_sel_hi:[1,1,0] clamp
  v_pk_fma_f16 v191, v191, v55, 0.5 op_sel_hi:[1,1,0] clamp
  v_mfma_f32_16x16x32_f16 v[72:75], v[184:187], v[200:203], v[72:75]
  v_pk_mul_f16 v188, v188, v52
  v_pk_mul_f16 v189, v189, v53
  v_mfma_f32_16x16x32_f16 v[76:79], v[184:187], v[204:207], v[76:79]
  v_pk_mul_f16 v190, v190, v54
  v_pk_mul_f16 v191, v191, v55
  v_mfma_f32_16x16x32_f16 v[80:83], v[184:187], v[208:211], v[80:83]
  s_nop 0
  v_cvt_pk_f16_f32 v48, v16, v17
  v_cvt_pk_f16_f32 v49, v18, v19
  v_mfma_f32_16x16x32_f16 v[84:87], v[184:187], v[212:215], v[84:87]
  s_waitcnt vmcnt(5)
  ds_read_b128 v[164:167], v4 offset:96
  ds_read_b128 v[168:171], v4 offset:288
  v_cvt_pk_f16_f32 v50, v20, v21
  v_cvt_pk_f16_f32 v51, v22, v23
  v_mfma_f32_16x16x32_f16 v[88:91], v[188:191], v[192:195], v[88:91]
  ds_read_b128 v[172:175], v4 offset:480
  v_cvt_pk_f16_f32 v52, v24, v25
  v_cvt_pk_f16_f32 v53, v26, v27
  v_mfma_f32_16x16x32_f16 v[92:95], v[188:191], v[196:199], v[92:95]
  v_cvt_pk_f16_f32 v54, v28, v29
  v_cvt_pk_f16_f32 v55, v30, v31
  v_mfma_f32_16x16x32_f16 v[96:99], v[188:191], v[200:203], v[96:99]
  s_sub_u32 s26, s26, 1
  v_pk_fma_f16 v56, v48, v48, s20 op_sel_hi:[1,1,0] neg_lo:[1,0,0] neg_hi:[1,0,0] clamp
  v_pk_fma_f16 v57, v49, v49, s20 op_sel_hi:[1,1,0] neg_lo:[1,0,0] neg_hi:[1,0,0] clamp
  v_mfma_f32_16x16x32_f16 v[100:103], v[188:191], v[204:207], v[100:103]
  s_nop 0
  v_pk_fma_f16 v58, v50, v50, s20 op_sel_hi:[1,1,0] neg_lo:[1,0,0] neg_hi:[1,0,0] clamp
  v_pk_fma_f16 v59, v51, v51, s20 op_sel_hi:[1,1,0] neg_lo:[1,0,0] neg_hi:[1,0,0] clamp
  v_mfma_f32_16x16x32_f16 v[104:107], v[188:191], v[208:211], v[104:107]
  v_pk_fma_f16 v184, v56, v56, s20 op_sel:[0,0,1]
  v_pk_fma_f16 v185, v57, v57, s20 op_sel:[0,0,1]
  v_mfma_f32_16x16x32_f16 v[108:111], v[188:191], v[212:215], v[108:111]
  s_waitcnt lgkmcnt(0)
  v_pk_fma_f16 v186, v58, v58, s20 op_sel:[0,0,1]
  v_pk_fma_f16 v187, v59, v59, s20 op_sel:[0,0,1]
  s_cbranch_scc0 L_loop
  v_mfma_f32_16x16x32_bf16 v[16:19], a[96:99], v[216:219], 0
  s_add_u32 s28, s28, 0x60000
  v_pk_fma_f16 v184, v184, v56, s21 op_sel_hi:[1,1,0]
  v_pk_fma_f16 v185, v185, v57, s21 op_sel_hi:[1,1,0]
  v_pk_fma_f16 v186, v186, v58, s21 op_sel_hi:[1,1,0]
  v_pk_fma_f16 v187, v187, v59, s21 op_sel_hi:[1,1,0]
  v_pk_fma_f16 v184, v184, v48, 0.5 op_sel_hi:[1,1,0] clamp
  v_pk_fma_f16 v185, v185, v49, 0.5 op_sel_hi:[1,1,0] clamp
  v_pk_fma_f16 v186, v186, v50, 0.5 op_sel_hi:[1,1,0] clamp
  v_pk_fma_f16 v187, v187, v51, 0.5 op_sel_hi:[1,1,0] clamp
  v_pk_mul_f16 v184, v184, v48
  v_pk_mul_f16 v185, v185, v49
  v_pk_mul_f16 v186, v186, v50
  v_pk_mul_f16 v187, v187, v51
  v_mfma_f32_16x16x32_bf16 v[24:27], a[96:99], v[220:223], 0
  s_add_u32 s59, s59, 0x60000
  ds_read_b128 v[192:195], v0 offset:24576
  ds_read_b128 v[196:199], v0 offset:25600
  v_pk_fma_f16 v56, v52, v52, s20 op_sel_hi:[1,1,0] neg_lo:[1,0,0] neg_hi:[1,0,0] clamp
  v_pk_fma_f16 v57, v53, v53, s20 op_sel_hi:[1,1,0] neg_lo:[1,0,0] neg_hi:[1,0,0] clamp
  v_mfma_f32_16x16x32_bf16 v[20:23], a[100:103], v[216:219], 0
  s_add_u32 s57, s57, 0x60000
  ds_read_b128 v[200:203], v0 offset:26624
  ds_read_b128 v[204:207], v0 offset:27648
  v_pk_fma_f16 v58, v54, v54, s20 op_sel_hi:[1,1,0] neg_lo:[1,0,0] neg_hi:[1,0,0] clamp
  v_pk_fma_f16 v59, v55, v55, s20 op_sel_hi:[1,1,0] neg_lo:[1,0,0] neg_hi:[1,0,0] clamp
  v_mfma_f32_16x16x32_bf16 v[28:31], a[100:103], v[220:223], 0
  s_add_u32 s15, s15, 0x60000
  ds_read_b128 v[208:211], v0 offset:28672
  ds_read_b128 v[212:215], v0 offset:29696
  v_pk_fma_f16 v188, v56, v56, s20 op_sel:[0,0,1]
  v_pk_fma_f16 v189, v57, v57, s20 op_sel:[0,0,1]
  v_mfma_f32_16x16x32_bf16 v[16:19], a[104:107], v[224:227], v[16:19]
  v_pk_fma_f16 v190, v58, v58, s20 op_sel:[0,0,1]
  v_pk_fma_f16 v191, v59, v59, s20 op_sel:[0,0,1]
  v_mfma_f32_16x16x32_bf16 v[24:27], a[104:107], v[228:231], v[24:27]
  v_pk_fma_f16 v188, v188, v56, s21 op_sel_hi:[1,1,0]
  v_pk_fma_f16 v189, v189, v57, s21 op_sel_hi:[1,1,0]
  v_mfma_f32_16x16x32_bf16 v[20:23], a[108:111], v[224:227], v[20:23]
  s_nop 0
  v_pk_fma_f16 v190, v190, v58, s21 op_sel_hi:[1,1,0]
  v_pk_fma_f16 v191, v191, v59, s21 op_sel_hi:[1,1,0]
  v_mfma_f32_16x16x32_bf16 v[28:31], a[108:111], v[228:231], v[28:31]
  s_nop 0
  v_pk_fma_f16 v188, v188, v52, 0.5 op_sel_hi:[1,1,0] clamp
  v_pk_fma_f16 v189, v189, v53, 0.5 op_sel_hi:[1,1,0] clamp
  v_mfma_f32_16x16x32_bf16 v[16:19], a[112:115], v[232:235], v[16:19]
  v_pk_fma_f16 v190, v190, v54, 0.5 op_sel_hi:[1,1,0] clamp
  v_pk_fma_f16 v191, v191, v55, 0.5 op_sel_hi:[1,1,0] clamp
  v_mfma_f32_16x16x32_bf16 v[24:27], a[112:115], v[236:239], v[24:27]
  v_pk_mul_f16 v188, v188, v52
  v_pk_mul_f16 v189, v189, v53
  v_mfma_f32_16x16x32_bf16 v[20:23], a[116:119], v[232:235], v[20:23]
  v_pk_mul_f16 v190, v190, v54
  v_pk_mul_f16 v191, v191, v55
  v_mfma_f32_16x16x32_bf16 v[28:31], a[116:119], v[236:239], v[28:31]
  s_waitcnt lgkmcnt(0)
  v_cvt_pk_f16_f32 v48, v16, v17
  v_cvt_pk_f16_f32 v49, v18, v19
  v_mfma_f32_16x16x32_f16 v[64:67], v[184:187], v[192:195], v[64:67]
  s_nop 0
  v_cvt_pk_f16_f32 v50, v20, v21
  v_cvt_pk_f16_f32 v51, v22, v23
  v_mfma_f32_16x16x32_f16 v[68:71], v[184:187], v[196:199], v[68:71]
  v_cvt_pk_f16_f32 v52, v24, v25
  v_cvt_pk_f16_f32 v53, v26, v27
  v_mfma_f32_16x16x32_f16 v[72:75], v[184:187], v[200:203], v[72:75]
  v_cvt_pk_f16_f32 v54, v28, v29
  v_cvt_pk_f16_f32 v55, v30, v31
  v_mfma_f32_16x16x32_f16 v[76:79], v[184:187], v[204:207], v[76:79]
  v_pk_fma_f16 v56, v48, v48, s20 op_sel_hi:[1,1,0] neg_lo:[1,0,0] neg_hi:[1,0,0] clamp
  v_pk_fma_f16 v57, v49, v49, s20 op_sel_hi:[1,1,0] neg_lo:[1,0,0] neg_hi:[1,0,0] clamp
  v_mfma_f32_16x16x32_f16 v[80:83], v[184:187], v[208:211], v[80:83]
  v_pk_fma_f16 v58, v50, v50, s20 op_sel_hi:[1,1,0] neg_lo:[1,0,0] neg_hi:[1,0,0] clamp
  v_pk_fma_f16 v59, v51, v51, s20 op_sel_hi:[1,1,0] neg_lo:[1,0,0] neg_hi:[1,0,0] clamp
  v_mfma_f32_16x16x32_f16 v[84:87], v[184:187], v[212:215], v[84:87]
  v_pk_fma_f16 v184, v56, v56, s20 op_sel:[0,0,1]
  v_pk_fma_f16 v185, v57, v57, s20 op_sel:[0,0,1]
  v_mfma_f32_16x16x32_f16 v[88:91], v[188:191], v[192:195], v[88:91]
  ds_read_b128 v[192:195], v0 offset:30720
  v_pk_fma_f16 v186, v58, v58, s20 op_sel:[0,0,1]
  v_pk_fma_f16 v187, v59, v59, s20 op_sel:[0,0,1]
  v_mfma_f32_16x16x32_f16 v[92:95], v[188:191], v[196:199], v[92:95]
  ds_read_b128 v[196:199], v0 offset:31744
  v_pk_fma_f16 v184, v184, v56, s21 op_sel_hi:[1,1,0]
  v_pk_fma_f16 v185, v185, v57, s21 op_sel_hi:[1,1,0]
  v_mfma_f32_16x16x32_f16 v[96:99], v[188:191], v[200:203], v[96:99]
  ds_read_b128 v[200:203], v0 offset:32768
  v_pk_fma_f16 v186, v186, v58, s21 op_sel_hi:[1,1,0]
  v_pk_fma_f16 v187, v187, v59, s21 op_sel_hi:[1,1,0]
  v_mfma_f32_16x16x32_f16 v[100:103], v[188:191], v[204:207], v[100:103]
  ds_read_b128 v[204:207], v0 offset:33792
  v_pk_fma_f16 v184, v184, v48, 0.5 op_sel_hi:[1,1,0] clamp
  v_pk_fma_f16 v185, v185, v49, 0.5 op_sel_hi:[1,1,0] clamp
  v_mfma_f32_16x16x32_f16 v[104:107], v[188:191], v[208:211], v[104:107]
  ds_read_b128 v[208:211], v0 offset:34816
  v_pk_fma_f16 v186, v186, v50, 0.5 op_sel_hi:[1,1,0] clamp
  v_pk_fma_f16 v187, v187, v51, 0.5 op_sel_hi:[1,1,0] clamp
  v_mfma_f32_16x16x32_f16 v[108:111], v[188:191], v[212:215], v[108:111]
  ds_read_b128 v[212:215], v0 offset:35840
  v_pk_mul_f16 v184, v184, v48
  v_pk_mul_f16 v185, v185, v49
  v_mfma_f32_16x16x32_bf16 v[16:19], a[120:123], v[216:219], 0
  v_pk_mul_f16 v186, v186, v50
  v_pk_mul_f16 v187, v187, v51
  v_mfma_f32_16x16x32_bf16 v[24:27], a[120:123], v[220:223], 0
  ds_read_b128 v[12:15], v2 offset:1536
  v_pk_fma_f16 v56, v52, v52, s20 op_sel_hi:[1,1,0] neg_lo:[1,0,0] neg_hi:[1,0,0] clamp
  v_pk_fma_f16 v57, v53, v53, s20 op_sel_hi:[1,1,0] neg_lo:[1,0,0] neg_hi:[1,0,0] clamp
  v_mfma_f32_16x16x32_bf16 v[20:23], a[124:127], v[216:219], 0
  v_pk_fma_f16 v58, v54, v54, s20 op_sel_hi:[1,1,0] neg_lo:[1,0,0] neg_hi:[1,0,0] clamp
  v_pk_fma_f16 v59, v55, v55, s20 op_sel_hi:[1,1,0] neg_lo:[1,0,0] neg_hi:[1,0,0] clamp
  v_mfma_f32_16x16x32_bf16 v[28:31], a[124:127], v[220:223], 0
  v_pk_fma_f16 v188, v56, v56, s20 op_sel:[0,0,1]
  v_pk_fma_f16 v189, v57, v57, s20 op_sel:[0,0,1]
  v_mfma_f32_16x16x32_bf16 v[16:19], a[128:131], v[224:227], v[16:19]
  v_pk_fma_f16 v190, v58, v58, s20 op_sel:[0,0,1]
  v_pk_fma_f16 v191, v59, v59, s20 op_sel:[0,0,1]
  v_mfma_f32_16x16x32_bf16 v[24:27], a[128:131], v[228:231], v[24:27]
  s_waitcnt lgkmcnt(0)
  v_or3_b32 v12, v12, v13, v14
  v_or_b32_e64 v12, v12, v15
  v_cmp_ne_u32 vcc, 0, v12
  v_pk_fma_f16 v188, v188, v56, s21 op_sel_hi:[1,1,0]
  v_pk_fma_f16 v189, v189, v57, s21 op_sel_hi:[1,1,0]
  v_mfma_f32_16x16x32_bf16 v[20:23], a[132:135], v[224:227], v[20:23]
  s_cbranch_vccnz L_slow
  v_pk_fma_f16 v190, v190, v58, s21 op_sel_hi:[1,1,0]
  v_pk_fma_f16 v191, v191, v59, s21 op_sel_hi:[1,1,0]
  v_mfma_f32_16x16x32_bf16 v[28:31], a[132:135], v[228:231], v[28:31]
  s_nop 0
  v_pk_fma_f16 v188, v188, v52, 0.5 op_sel_hi:[1,1,0] clamp
  v_pk_fma_f16 v189, v189, v53, 0.5 op_sel_hi:[1,1,0] clamp
  v_mfma_f32_16x16x32_bf16 v[16:19], a[136:139], v[232:235], v[16:19]
  v_pk_fma_f16 v190, v190, v54, 0.5 op_sel_hi:[1,1,0] clamp
  v_pk_fma_f16 v191, v191, v55, 0.5 op_sel_hi:[1,1,0] clamp
  v_mfma_f32_16x16x32_bf16 v[24:27], a[136:139], v[236:239], v[24:27]
  v_pk_mul_f16 v188, v188, v52
  v_pk_mul_f16 v189, v189, v53
  v_mfma_f32_16x16x32_bf16 v[20:23], a[140:143], v[232:235], v[20:23]
  v_pk_mul_f16 v190, v190, v54
  v_pk_mul_f16 v191, v191, v55
  v_mfma_f32_16x16x32_bf16 v[28:31], a[140:143], v[236:239], v[28:31]
  s_nop 0
  v_cvt_pk_f16_f32 v48, v16, v17
  v_cvt_pk_f16_f32 v49, v18, v19
  v_mfma_f32_16x16x32_f16 v[64:67], v[184:187], v[192:195], v[64:67]
  s_nop 1
  v_cvt_pk_f16_f32 v50, v20, v21
  v_cvt_pk_f16_f32 v51, v22, v23
  v_mfma_f32_16x16x32_f16 v[68:71], v[184:187], v[196:199], v[68:71]
  v_cvt_pk_f16_f32 v52, v24, v25
  v_cvt_pk_f16_f32 v53, v26, v27
  v_mfma_f32_16x16x32_f16 v[72:75], v[184:187], v[200:203], v[72:75]
  v_cvt_pk_f16_f32 v54, v28, v29
  v_cvt_pk_f16_f32 v55, v30, v31
  v_mfma_f32_16x16x32_f16 v[76:79], v[184:187], v[204:207], v[76:79]
  v_pk_fma_f16 v56, v48, v48, s20 op_sel_hi:[1,1,0] neg_lo:[1,0,0] neg_hi:[1,0,0] clamp
  v_pk_fma_f16 v57, v49, v49, s20 op_sel_hi:[1,1,0] neg_lo:[1,0,0] neg_hi:[1,0,0] clamp
  v_mfma_f32_16x16x32_f16 v[80:83], v[184:187], v[208:211], v[80:83]
  s_nop 0
  v_pk_fma_f16 v58, v50, v50, s20 op_sel_hi:[1,1,0] neg_lo:[1,0,0] neg_hi:[1,0,0] clamp
  v_pk_fma_f16 v59, v51, v51, s20 op_sel_hi:[1,1,0] neg_lo:[1,0,0] neg_hi:[1,0,0] clamp
  v_mfma_f32_16x16x32_f16 v[84:87], v[184:187], v[212:215], v[84:87]
  s_nop 0
  v_pk_fma_f16 v184, v56, v56, s20 op_sel:[0,0,1]
  v_pk_fma_f16 v185, v57, v57, s20 op_sel:[0,0,1]
  v_mfma_f32_16x16x32_f16 v[88:91], v[188:191], v[192:195], v[88:91]
  ds_read_b128 v[192:195], v0 offset:36864
  v_pk_fma_f16 v186, v58, v58, s20 op_sel:[0,0,1]
  v_pk_fma_f16 v187, v59, v59, s20 op_sel:[0,0,1]
  v_mfma_f32_16x16x32_f16 v[92:95], v[188:191], v[196:199], v[92:95]
  ds_read_b128 v[196:199], v0 offset:37888
  v_pk_fma_f16 v184, v184, v56, s21 op_sel_hi:[1,1,0]
  v_pk_fma_f16 v185, v185, v57, s21 op_sel_hi:[1,1,0]
  v_mfma_f32_16x16x32_f16 v[96:99], v[188:191], v[200:203], v[96:99]
  ds_read_b128 v[200:203], v0 offset:38912
  v_pk_fma_f16 v186, v186, v58, s21 op_sel_hi:[1,1,0]
  v_pk_fma_f16 v187, v187, v59, s21 op_sel_hi:[1,1,0]
  v_mfma_f32_16x16x32_f16 v[100:103], v[188:191], v[204:207], v[100:103]
  ds_read_b128 v[204:207], v0 offset:39936
  v_pk_fma_f16 v184, v184, v48, 0.5 op_sel_hi:[1,1,0] clamp
  v_pk_fma_f16 v185, v185, v49, 0.5 op_sel_hi:[1,1,0] clamp
  v_mfma_f32_16x16x32_f16 v[104:107], v[188:191], v[208:211], v[104:107]
  ds_read_b128 v[208:211], v0 offset:40960
  v_pk_fma_f16 v186, v186, v50, 0.5 op_sel_hi:[1,1,0] clamp
  v_pk_fma_f16 v187, v187, v51, 0.5 op_sel_hi:[1,1,0] clamp
  v_mfma_f32_16x16x32_f16 v[108:111], v[188:191], v[212:215], v[108:111]
  ds_read_b128 v[212:215], v0 offset:41984
  v_pk_mul_f16 v184, v184, v48
  v_pk_mul_f16 v185, v185, v49
  v_mfma_f32_16x16x32_bf16 v[16:19], a[144:147], v[216:219], 0
  v_pk_mul_f16 v186, v186, v50
  v_pk_mul_f16 v187, v187, v51
  v_mfma_f32_16x16x32_bf16 v[24:27], a[144:147], v[220:223], 0
  v_pk_fma_f16 v56, v52, v52, s20 op_sel_hi:[1,1,0] neg_lo:[1,0,0] neg_hi:[1,0,0] clamp
  v_pk_fma_f16 v57, v53, v53, s20 op_sel_hi:[1,1,0] neg_lo:[1,0,0] neg_hi:[1,0,0] clamp
  v_mfma_f32_16x16x32_bf16 v[20:23], a[148:151], v[216:219], 0
  v_pk_fma_f16 v58, v54, v54, s20 op_sel_hi:[1,1,0] neg_lo:[1,0,0] neg_hi:[1,0,0] clamp
  v_pk_fma_f16 v59, v55, v55, s20 op_sel_hi:[1,1,0] neg_lo:[1,0,0] neg_hi:[1,0,0] clamp
  v_mfma_f32_16x16x32_bf16 v[28:31], a[148:151], v[220:223], 0
  v_pk_fma_f16 v188, v56, v56, s20 op_sel:[0,0,1]
  v_pk_fma_f16 v189, v57, v57, s20 op_sel:[0,0,1]
  v_mfma_f32_16x16x32_bf16 v[16:19], a[152:155], v[224:227], v[16:19]
  v_pk_fma_f16 v190, v58, v58, s20 op_sel:[0,0,1]
  v_pk_fma_f16 v191, v59, v59, s20 op_sel:[0,0,1]
  v_mfma_f32_16x16x32_bf16 v[24:27], a[152:155], v[228:231], v[24:27]
  v_pk_fma_f16 v188, v188, v56, s21 op_sel_hi:[1,1,0]
  v_pk_fma_f16 v189, v189, v57, s21 op_sel_hi:[1,1,0]
  v_mfma_f32_16x16x32_bf16 v[20:23], a[156:159], v[224:227], v[20:23]
  v_pk_fma_f16 v190, v190, v58, s21 op_sel_hi:[1,1,0]
  v_pk_fma_f16 v191, v191, v59, s21 op_sel_hi:[1,1,0]
  v_mfma_f32_16x16x32_bf16 v[28:31], a[156:159], v[228:231], v[28:31]
  v_pk_fma_f16 v188, v188, v52, 0.5 op_sel_hi:[1,1,0] clamp
  v_pk_fma_f16 v189, v189, v53, 0.5 op_sel_hi:[1,1,0] clamp
  v_mfma_f32_16x16x32_bf16 v[16:19], a[160:163], v[232:235], v[16:19]
  v_pk_fma_f16 v190, v190, v54, 0.5 op_sel_hi:[1,1,0] clamp
  v_pk_fma_f16 v191, v191, v55, 0.5 op_sel_hi:[1,1,0] clamp
  v_mfma_f32_16x16x32_bf16 v[24:27], a[160:163], v[236:239], v[24:27]
  v_pk_mul_f16 v188, v188, v52
  v_pk_mul_f16 v189, v189, v53
  v_mfma_f32_16x16x32_bf16 v[20:23], a[164:167], v[232:235], v[20:23]
  v_pk_mul_f16 v190, v190, v54
  v_pk_mul_f16 v191, v191, v55
  v_mfma_f32_16x16x32_bf16 v[28:31], a[164:167], v[236:239], v[28:31]
  s_waitcnt lgkmcnt(0)
  v_cvt_pk_f16_f32 v48, v16, v17
  v_cvt_pk_f16_f32 v49, v18, v19
  v_mfma_f32_16x16x32_f16 v[64:67], v[184:187], v[192:195], v[64:67]
  s_nop 0
  v_cvt_pk_f16_f32 v50, v20, v21
  v_cvt_pk_f16_f32 v51, v22, v23
  v_mfma_f32_16x16x32_f16 v[68:71], v[184:187], v[196:199], v[68:71]
  v_cvt_pk_f16_f32 v52, v24, v25
  v_cvt_pk_f16_f32 v53, v26, v27
  v_mfma_f32_16x16x32_f16 v[72:75], v[184:187], v[200:203], v[72:75]
  v_cvt_pk_f16_f32 v54, v28, v29
  v_cvt_pk_f16_f32 v55, v30, v31
  v_mfma_f32_16x16x32_f16 v[76:79], v[184:187], v[204:207], v[76:79]
  v_pk_fma_f16 v56, v48, v48, s20 op_sel_hi:[1,1,0] neg_lo:[1,0,0] neg_hi:[1,0,0] clamp
  v_pk_fma_f16 v57, v49, v49, s20 op_sel_hi:[1,1,0] neg_lo:[1,0,0] neg_hi:[1,0,0] clamp
  v_mfma_f32_16x16x32_f16 v[80:83], v[184:187], v[208:211], v[80:83]
  s_nop 0
  v_pk_fma_f16 v58, v50, v50, s20 op_sel_hi:[1,1,0] neg_lo:[1,0,0] neg_hi:[1,0,0] clamp
  v_pk_fma_f16 v59, v51, v51, s20 op_sel_hi:[1,1,0] neg_lo:[1,0,0] neg_hi:[1,0,0] clamp
  v_mfma_f32_16x16x32_f16 v[84:87], v[184:187], v[212:215], v[84:87]
  s_nop 0
  v_pk_fma_f16 v184, v56, v56, s20 op_sel:[0,0,1]
  v_pk_fma_f16 v185, v57, v57, s20 op_sel:[0,0,1]
  v_mfma_f32_16x16x32_f16 v[88:91], v[188:191], v[192:195], v[88:91]
  ds_read_b128 v[192:195], v0 offset:43008
  v_pk_fma_f16 v186, v58, v58, s20 op_sel:[0,0,1]
  v_pk_fma_f16 v187, v59, v59, s20 op_sel:[0,0,1]
  v_mfma_f32_16x16x32_f16 v[92:95], v[188:191], v[196:199], v[92:95]
  ds_read_b128 v[196:199], v0 offset:44032
  v_pk_fma_f16 v184, v184, v56, s21 op_sel_hi:[1,1,0]
  v_pk_fma_f16 v185, v185, v57, s21 op_sel_hi:[1,1,0]
  v_mfma_f32_16x16x32_f16 v[96:99], v[188:191], v[200:203], v[96:99]
  ds_read_b128 v[200:203], v0 offset:45056
  v_pk_fma_f16 v186, v186, v58, s21 op_sel_hi:[1,1,0]
  v_pk_fma_f16 v187, v187, v59, s21 op_sel_hi:[1,1,0]
  v_mfma_f32_16x16x32_f16 v[100:103], v[188:191], v[204:207], v[100:103]
  ds_read_b128 v[204:207], v0 offset:46080
  v_pk_fma_f16 v184, v184, v48, 0.5 op_sel_hi:[1,1,0] clamp
  v_pk_fma_f16 v185, v185, v49, 0.5 op_sel_hi:[1,1,0] clamp
  v_mfma_f32_16x16x32_f16 v[104:107], v[188:191], v[208:211], v[104:107]
  ds_read_b128 v[208:211], v0 offset:47104
  v_pk_fma_f16 v186, v186, v50, 0.5 op_sel_hi:[1,1,0] clamp
  v_pk_fma_f16 v187, v187, v51, 0.5 op_sel_hi:[1,1,0] clamp
  v_mfma_f32_16x16x32_f16 v[108:111], v[188:191], v[212:215], v[108:111]
  ds_read_b128 v[212:215], v0 offset:48128
  v_pk_mul_f16 v184, v184, v48
  v_pk_mul_f16 v185, v185, v49
  v_mfma_f32_16x16x32_bf16 v[16:19], a[168:171], v[216:219], 0
  v_pk_mul_f16 v186, v186, v50
  v_pk_mul_f16 v187, v187, v51
  v_mfma_f32_16x16x32_bf16 v[24:27], a[168:171], v[220:223], 0
  v_pk_fma_f16 v56, v52, v52, s20 op_sel_hi:[1,1,0] neg_lo:[1,0,0] neg_hi:[1,0,0] clamp
  v_pk_fma_f16 v57, v53, v53, s20 op_sel_hi:[1,1,0] neg_lo:[1,0,0] neg_hi:[1,0,0] clamp
  v_mfma_f32_16x16x32_bf16 v[20:23], a[172:175], v[216:219], 0
  v_pk_fma_f16 v58, v54, v54, s20 op_sel_hi:[1,1,0] neg_lo:[1,0,0] neg_hi:[1,0,0] clamp
  v_pk_fma_f16 v59, v55, v55, s20 op_sel_hi:[1,1,0] neg_lo:[1,0,0] neg_hi:[1,0,0] clamp
  v_mfma_f32_16x16x32_bf16 v[28:31], a[172:175], v[220:223], 0
  v_pk_fma_f16 v188, v56, v56, s20 op_sel:[0,0,1]
  v_pk_fma_f16 v189, v57, v57, s20 op_sel:[0,0,1]
  v_mfma_f32_16x16x32_bf16 v[16:19], a[176:179], v[224:227], v[16:19]
  v_pk_fma_f16 v190, v58, v58, s20 op_sel:[0,0,1]
  v_pk_fma_f16 v191, v59, v59, s20 op_sel:[0,0,1]
  v_mfma_f32_16x16x32_bf16 v[24:27], a[176:179], v[228:231], v[24:27]
  v_pk_fma_f16 v188, v188, v56, s21 op_sel_hi:[1,1,0]
  v_pk_fma_f16 v189, v189, v57, s21 op_sel_hi:[1,1,0]
  v_mfma_f32_16x16x32_bf16 v[20:23], a[180:183], v[224:227], v[20:23]
  v_pk_fma_f16 v190, v190, v58, s21 op_sel_hi:[1,1,0]
  v_pk_fma_f16 v191, v191, v59, s21 op_sel_hi:[1,1,0]
  v_mfma_f32_16x16x32_bf16 v[28:31], a[180:183], v[228:231], v[28:31]
  v_pk_fma_f16 v188, v188, v52, 0.5 op_sel_hi:[1,1,0] clamp
  v_pk_fma_f16 v189, v189, v53, 0.5 op_sel_hi:[1,1,0] clamp
  v_mfma_f32_16x16x32_bf16 v[16:19], a[184:187], v[232:235], v[16:19]
  v_pk_fma_f16 v190, v190, v54, 0.5 op_sel_hi:[1,1,0] clamp
  v_pk_fma_f16 v191, v191, v55, 0.5 op_sel_hi:[1,1,0] clamp
  v_mfma_f32_16x16x32_bf16 v[24:27], a[184:187], v[236:239], v[24:27]
  v_pk_mul_f16 v188, v188, v52
  v_pk_mul_f16 v189, v189, v53
  v_mfma_f32_16x16x32_bf16 v[20:23], a[188:191], v[232:235], v[20:23]
  v_pk_mul_f16 v190, v190, v54
  v_pk_mul_f16 v191, v191, v55
  v_mfma_f32_16x16x32_bf16 v[28:31], a[188:191], v[236:239], v[28:31]
  s_waitcnt lgkmcnt(0)
  v_cvt_pk_f16_f32 v48, v16, v17
  v_cvt_pk_f16_f32 v49, v18, v19
  v_mfma_f32_16x16x32_f16 v[64:67], v[184:187], v[192:195], v[64:67]
  s_nop 0
  v_cvt_pk_f16_f32 v50, v20, v21
  v_cvt_pk_f16_f32 v51, v22, v23
  v_mfma_f32_16x16x32_f16 v[68:71], v[184:187], v[196:199], v[68:71]
  v_cvt_pk_f16_f32 v52, v24, v25
  v_cvt_pk_f16_f32 v53, v26, v27
  v_mfma_f32_16x16x32_f16 v[72:75], v[184:187], v[200:203], v[72:75]
  v_cvt_pk_f16_f32 v54, v28, v29
  v_cvt_pk_f16_f32 v55, v30, v31
  v_mfma_f32_16x16x32_f16 v[76:79], v[184:187], v[204:207], v[76:79]
  v_pk_fma_f16 v56, v48, v48, s20 op_sel_hi:[1,1,0] neg_lo:[1,0,0] neg_hi:[1,0,0] clamp
  v_pk_fma_f16 v57, v49, v49, s20 op_sel_hi:[1,1,0] neg_lo:[1,0,0] neg_hi:[1,0,0] clamp
  v_mfma_f32_16x16x32_f16 v[80:83], v[184:187], v[208:211], v[80:83]
  s_nop 0
  v_pk_fma_f16 v58, v50, v50, s20 op_sel_hi:[1,1,0] neg_lo:[1,0,0] neg_hi:[1,0,0] clamp
  v_pk_fma_f16 v59, v51, v51, s20 op_sel_hi:[1,1,0] neg_lo:[1,0,0] neg_hi:[1,0,0] clamp
  v_mfma_f32_16x16x32_f16 v[84:87], v[184:187], v[212:215], v[84:87]
  s_nop 0
  v_pk_fma_f16 v184, v56, v56, s20 op_sel:[0,0,1]
  v_pk_fma_f16 v185, v57, v57, s20 op_sel:[0,0,1]
  v_mfma_f32_16x16x32_f16 v[88:91], v[188:191], v[192:195], v[88:91]
  ds_read_b128 v[192:195], v0 offset:49152
  v_pk_fma_f16 v186, v58, v58, s20 op_sel:[0,0,1]
  v_pk_fma_f16 v187, v59, v59, s20 op_sel:[0,0,1]
  v_mfma_f32_16x16x32_f16 v[92:95], v[188:191], v[196:199], v[92:95]
  ds_read_b128 v[196:199], v0 offset:50176
  v_pk_fma_f16 v184, v184, v56, s21 op_sel_hi:[1,1,0]
  v_pk_fma_f16 v185, v185, v57, s21 op_sel_hi:[1,1,0]
  v_mfma_f32_16x16x32_f16 v[96:99], v[188:191], v[200:203], v[96:99]
  ds_read_b128 v[200:203], v0 offset:51200
  v_pk_fma_f16 v186, v186, v58, s21 op_sel_hi:[1,1,0]
  v_pk_fma_f16 v187, v187, v59, s21 op_sel_hi:[1,1,0]
  v_mfma_f32_16x16x32_f16 v[100:103], v[188:191], v[204:207], v[100:103]
  ds_read_b128 v[204:207], v0 offset:52224
  v_pk_fma_f16 v184, v184, v48, 0.5 op_sel_hi:[1,1,0] clamp
  v_pk_fma_f16 v185, v185, v49, 0.5 op_sel_hi:[1,1,0] clamp
  v_mfma_f32_16x16x32_f16 v[104:107], v[188:191], v[208:211], v[104:107]
  ds_read_b128 v[208:211], v0 offset:53248
  v_pk_fma_f16 v186, v186, v50, 0.5 op_sel_hi:[1,1,0] clamp
  v_pk_fma_f16 v187, v187, v51, 0.5 op_sel_hi:[1,1,0] clamp
  v_mfma_f32_16x16x32_f16 v[108:111], v[188:191], v[212:215], v[108:111]
  ds_read_b128 v[212:215], v0 offset:54272
  v_pk_mul_f16 v184, v184, v48
  v_pk_mul_f16 v185, v185, v49
  v_mfma_f32_16x16x32_bf16 v[16:19], a[192:195], v[216:219], 0
  v_pk_mul_f16 v186, v186, v50
  v_pk_mul_f16 v187, v187, v51
  v_mfma_f32_16x16x32_bf16 v[24:27], a[192:195], v[220:223], 0
  v_pk_fma_f16 v56, v52, v52, s20 op_sel_hi:[1,1,0] neg_lo:[1,0,0] neg_hi:[1,0,0] clamp
  v_pk_fma_f16 v57, v53, v53, s20 op_sel_hi:[1,1,0] neg_lo:[1,0,0] neg_hi:[1,0,0] clamp
  v_mfma_f32_16x16x32_bf16 v[20:23], a[196:199], v[216:219], 0
  v_pk_fma_f16 v58, v54, v54, s20 op_sel_hi:[1,1,0] neg_lo:[1,0,0] neg_hi:[1,0,0] clamp
  v_pk_fma_f16 v59, v55, v55, s20 op_sel_hi:[1,1,0] neg_lo:[1,0,0] neg_hi:[1,0,0] clamp
  v_mfma_f32_16x16x32_bf16 v[28:31], a[196:199], v[220:223], 0
  v_pk_fma_f16 v188, v56, v56, s20 op_sel:[0,0,1]
  v_pk_fma_f16 v189, v57, v57, s20 op_sel:[0,0,1]
  v_mfma_f32_16x16x32_bf16 v[16:19], a[200:203], v[224:227], v[16:19]
  v_pk_fma_f16 v190, v58, v58, s20 op_sel:[0,0,1]
  v_pk_fma_f16 v191, v59, v59, s20 op_sel:[0,0,1]
  v_mfma_f32_16x16x32_bf16 v[24:27], a[200:203], v[228:231], v[24:27]
  v_pk_fma_f16 v188, v188, v56, s21 op_sel_hi:[1,1,0]
  v_pk_fma_f16 v189, v189, v57, s21 op_sel_hi:[1,1,0]
  v_mfma_f32_16x16x32_bf16 v[20:23], a[204:207], v[224:227], v[20:23]
  v_pk_fma_f16 v190, v190, v58, s21 op_sel_hi:[1,1,0]
  v_pk_fma_f16 v191, v191, v59, s21 op_sel_hi:[1,1,0]
  v_mfma_f32_16x16x32_bf16 v[28:31], a[204:207], v[228:231], v[28:31]
  v_pk_fma_f16 v188, v188, v52, 0.5 op_sel_hi:[1,1,0] clamp
  v_pk_fma_f16 v189, v189, v53, 0.5 op_sel_hi:[1,1,0] clamp
  v_mfma_f32_16x16x32_bf16 v[16:19], a[208:211], v[232:235], v[16:19]
  v_pk_fma_f16 v190, v190, v54, 0.5 op_sel_hi:[1,1,0] clamp
  v_pk_fma_f16 v191, v191, v55, 0.5 op_sel_hi:[1,1,0] clamp
  v_mfma_f32_16x16x32_bf16 v[24:27], a[208:211], v[236:239], v[24:27]
  v_pk_mul_f16 v188, v188, v52
  v_pk_mul_f16 v189, v189, v53
  v_mfma_f32_16x16x32_bf16 v[20:23], a[212:215], v[232:235], v[20:23]
  v_pk_mul_f16 v190, v190, v54
  v_pk_mul_f16 v191, v191, v55
  v_mfma_f32_16x16x32_bf16 v[28:31], a[212:215], v[236:239], v[28:31]
  s_waitcnt lgkmcnt(0)
  v_cvt_pk_f16_f32 v48, v16, v17
  v_cvt_pk_f16_f32 v49, v18, v19
  v_mfma_f32_16x16x32_f16 v[64:67], v[184:187], v[192:195], v[64:67]
  s_nop 0
  v_cvt_pk_f16_f32 v50, v20, v21
  v_cvt_pk_f16_f32 v51, v22, v23
  v_mfma_f32_16x16x32_f16 v[68:71], v[184:187], v[196:199], v[68:71]
  v_cvt_pk_f16_f32 v52, v24, v25
  v_cvt_pk_f16_f32 v53, v26, v27
  v_mfma_f32_16x16x32_f16 v[72:75], v[184:187], v[200:203], v[72:75]
  v_cvt_pk_f16_f32 v54, v28, v29
  v_cvt_pk_f16_f32 v55, v30, v31
  v_mfma_f32_16x16x32_f16 v[76:79], v[184:187], v[204:207], v[76:79]
  v_pk_fma_f16 v56, v48, v48, s20 op_sel_hi:[1,1,0] neg_lo:[1,0,0] neg_hi:[1,0,0] clamp
  v_pk_fma_f16 v57, v49, v49, s20 op_sel_hi:[1,1,0] neg_lo:[1,0,0] neg_hi:[1,0,0] clamp
  v_mfma_f32_16x16x32_f16 v[80:83], v[184:187], v[208:211], v[80:83]
  s_nop 0
  v_pk_fma_f16 v58, v50, v50, s20 op_sel_hi:[1,1,0] neg_lo:[1,0,0] neg_hi:[1,0,0] clamp
  v_pk_fma_f16 v59, v51, v51, s20 op_sel_hi:[1,1,0] neg_lo:[1,0,0] neg_hi:[1,0,0] clamp
  v_mfma_f32_16x16x32_f16 v[84:87], v[184:187], v[212:215], v[84:87]
  s_nop 0
  v_pk_fma_f16 v184, v56, v56, s20 op_sel:[0,0,1]
  v_pk_fma_f16 v185, v57, v57, s20 op_sel:[0,0,1]
  v_mfma_f32_16x16x32_f16 v[88:91], v[188:191], v[192:195], v[88:91]
  ds_read_b128 v[192:195], v0 offset:55296
  v_pk_fma_f16 v186, v58, v58, s20 op_sel:[0,0,1]
  v_pk_fma_f16 v187, v59, v59, s20 op_sel:[0,0,1]
  v_mfma_f32_16x16x32_f16 v[92:95], v[188:191], v[196:199], v[92:95]
  ds_read_b128 v[196:199], v0 offset:56320
  v_pk_fma_f16 v184, v184, v56, s21 op_sel_hi:[1,1,0]
  v_pk_fma_f16 v185, v185, v57, s21 op_sel_hi:[1,1,0]
  v_mfma_f32_16x16x32_f16 v[96:99], v[188:191], v[200:203], v[96:99]
  ds_read_b128 v[200:203], v0 offset:57344
  v_pk_fma_f16 v186, v186, v58, s21 op_sel_hi:[1,1,0]
  v_pk_fma_f16 v187, v187, v59, s21 op_sel_hi:[1,1,0]
  v_mfma_f32_16x16x32_f16 v[100:103], v[188:191], v[204:207], v[100:103]
  ds_read_b128 v[204:207], v0 offset:58368
  v_pk_fma_f16 v184, v184, v48, 0.5 op_sel_hi:[1,1,0] clamp
  v_pk_fma_f16 v185, v185, v49, 0.5 op_sel_hi:[1,1,0] clamp
  v_mfma_f32_16x16x32_f16 v[104:107], v[188:191], v[208:211], v[104:107]
  ds_read_b128 v[208:211], v0 offset:59392
  v_pk_fma_f16 v186, v186, v50, 0.5 op_sel_hi:[1,1,0] clamp
  v_pk_fma_f16 v187, v187, v51, 0.5 op_sel_hi:[1,1,0] clamp
  v_mfma_f32_16x16x32_f16 v[108:111], v[188:191], v[212:215], v[108:111]
  ds_read_b128 v[212:215], v0 offset:60416
  v_pk_mul_f16 v184, v184, v48
  v_pk_mul_f16 v185, v185, v49
  v_mfma_f32_16x16x32_bf16 v[16:19], a[216:219], v[216:219], 0
  v_pk_mul_f16 v186, v186, v50
  v_pk_mul_f16 v187, v187, v51
  v_mfma_f32_16x16x32_bf16 v[24:27], a[216:219], v[220:223], 0
  v_pk_fma_f16 v56, v52, v52, s20 op_sel_hi:[1,1,0] neg_lo:[1,0,0] neg_hi:[1,0,0] clamp
  v_pk_fma_f16 v57, v53, v53, s20 op_sel_hi:[1,1,0] neg_lo:[1,0,0] neg_hi:[1,0,0] clamp
  v_mfma_f32_16x16x32_bf16 v[20:23], a[220:223], v[216:219], 0
  v_pk_fma_f16 v58, v54, v54, s20 op_sel_hi:[1,1,0] neg_lo:[1,0,0] neg_hi:[1,0,0] clamp
  v_pk_fma_f16 v59, v55, v55, s20 op_sel_hi:[1,1,0] neg_lo:[1,0,0] neg_hi:[1,0,0] clamp
  v_mfma_f32_16x16x32_bf16 v[28:31], a[220:223], v[220:223], 0
  v_pk_fma_f16 v188, v56, v56, s20 op_sel:[0,0,1]
  v_pk_fma_f16 v189, v57, v57, s20 op_sel:[0,0,1]
  v_mfma_f32_16x16x32_bf16 v[16:19], a[224:227], v[224:227], v[16:19]
  v_pk_fma_f16 v190, v58, v58, s20 op_sel:[0,0,1]
  v_pk_fma_f16 v191, v59, v59, s20 op_sel:[0,0,1]
  v_mfma_f32_16x16x32_bf16 v[24:27], a[224:227], v[228:231], v[24:27]
  v_pk_fma_f16 v188, v188, v56, s21 op_sel_hi:[1,1,0]
  v_pk_fma_f16 v189, v189, v57, s21 op_sel_hi:[1,1,0]
  v_mfma_f32_16x16x32_bf16 v[20:23], a[228:231], v[224:227], v[20:23]
  v_pk_fma_f16 v190, v190, v58, s21 op_sel_hi:[1,1,0]
  v_pk_fma_f16 v191, v191, v59, s21 op_sel_hi:[1,1,0]
  v_mfma_f32_16x16x32_bf16 v[28:31], a[228:231], v[228:231], v[28:31]
  v_pk_fma_f16 v188, v188, v52, 0.5 op_sel_hi:[1,1,0] clamp
  v_pk_fma_f16 v189, v189, v53, 0.5 op_sel_hi:[1,1,0] clamp
  v_mfma_f32_16x16x32_bf16 v[16:19], a[232:235], v[232:235], v[16:19]
  v_pk_fma_f16 v190, v190, v54, 0.5 op_sel_hi:[1,1,0] clamp
  v_pk_fma_f16 v191, v191, v55, 0.5 op_sel_hi:[1,1,0] clamp
  v_mfma_f32_16x16x32_bf16 v[24:27], a[232:235], v[236:239], v[24:27]
  v_pk_mul_f16 v188, v188, v52
  v_pk_mul_f16 v189, v189, v53
  v_mfma_f32_16x16x32_bf16 v[20:23], a[236:239], v[232:235], v[20:23]
  v_pk_mul_f16 v190, v190, v54
  v_pk_mul_f16 v191, v191, v55
  v_mfma_f32_16x16x32_bf16 v[28:31], a[236:239], v[236:239], v[28:31]
  s_waitcnt lgkmcnt(0)
  v_cvt_pk_f16_f32 v48, v16, v17
  v_cvt_pk_f16_f32 v49, v18, v19
  v_mfma_f32_16x16x32_f16 v[64:67], v[184:187], v[192:195], v[64:67]
  s_nop 0
  v_cvt_pk_f16_f32 v50, v20, v21
  v_cvt_pk_f16_f32 v51, v22, v23
  v_mfma_f32_16x16x32_f16 v[68:71], v[184:187], v[196:199], v[68:71]
  v_cvt_pk_f16_f32 v52, v24, v25
  v_cvt_pk_f16_f32 v53, v26, v27
  v_mfma_f32_16x16x32_f16 v[72:75], v[184:187], v[200:203], v[72:75]
  v_cvt_pk_f16_f32 v54, v28, v29
  v_cvt_pk_f16_f32 v55, v30, v31
  v_mfma_f32_16x16x32_f16 v[76:79], v[184:187], v[204:207], v[76:79]
  v_pk_fma_f16 v56, v48, v48, s20 op_sel_hi:[1,1,0] neg_lo:[1,0,0] neg_hi:[1,0,0] clamp
  v_pk_fma_f16 v57, v49, v49, s20 op_sel_hi:[1,1,0] neg_lo:[1,0,0] neg_hi:[1,0,0] clamp
  v_mfma_f32_16x16x32_f16 v[80:83], v[184:187], v[208:211], v[80:83]
  s_nop 0
  v_pk_fma_f16 v58, v50, v50, s20 op_sel_hi:[1,1,0] neg_lo:[1,0,0] neg_hi:[1,0,0] clamp
  v_pk_fma_f16 v59, v51, v51, s20 op_sel_hi:[1,1,0] neg_lo:[1,0,0] neg_hi:[1,0,0] clamp
  v_mfma_f32_16x16x32_f16 v[84:87], v[184:187], v[212:215], v[84:87]
  s_nop 0
  v_pk_fma_f16 v184, v56, v56, s20 op_sel:[0,0,1]
  v_pk_fma_f16 v185, v57, v57, s20 op_sel:[0,0,1]
  v_mfma_f32_16x16x32_f16 v[88:91], v[188:191], v[192:195], v[88:91]
  ds_read_b128 v[192:195], v0 offset:61440
  v_pk_fma_f16 v186, v58, v58, s20 op_sel:[0,0,1]
  v_pk_fma_f16 v187, v59, v59, s20 op_sel:[0,0,1]
  v_mfma_f32_16x16x32_f16 v[92:95], v[188:191], v[196:199], v[92:95]
  ds_read_b128 v[196:199], v0 offset:62464
  v_pk_fma_f16 v184, v184, v56, s21 op_sel_hi:[1,1,0]
  v_pk_fma_f16 v185, v185, v57, s21 op_sel_hi:[1,1,0]
  v_mfma_f32_16x16x32_f16 v[96:99], v[188:191], v[200:203], v[96:99]
  ds_read_b128 v[200:203], v0 offset:63488
  v_pk_fma_f16 v186, v186, v58, s21 op_sel_hi:[1,1,0]
  v_pk_fma_f16 v187, v187, v59, s21 op_sel_hi:[1,1,0]
  v_mfma_f32_16x16x32_f16 v[100:103], v[188:191], v[204:207], v[100:103]
  ds_read_b128 v[204:207], v0 offset:64512
  v_pk_fma_f16 v184, v184, v48, 0.5 op_sel_hi:[1,1,0] clamp
  v_pk_fma_f16 v185, v185, v49, 0.5 op_sel_hi:[1,1,0] clamp
  v_mfma_f32_16x16x32_f16 v[104:107], v[188:191], v[208:211], v[104:107]
  ds_read_b128 v[208:211], v1
  v_pk_fma_f16 v186, v186, v50, 0.5 op_sel_hi:[1,1,0] clamp
  v_pk_fma_f16 v187, v187, v51, 0.5 op_sel_hi:[1,1,0] clamp
  v_mfma_f32_16x16x32_f16 v[108:111], v[188:191], v[212:215], v[108:111]
  ds_read_b128 v[212:215], v1 offset:1024
  v_pk_mul_f16 v184, v184, v48
  v_pk_mul_f16 v185, v185, v49
  v_mfma_f32_16x16x32_bf16 v[16:19], v[32:35], v[216:219], 0
  v_pk_mul_f16 v186, v186, v50
  v_pk_mul_f16 v187, v187, v51
  v_mfma_f32_16x16x32_bf16 v[24:27], v[32:35], v[220:223], 0
  v_pk_fma_f16 v56, v52, v52, s20 op_sel_hi:[1,1,0] neg_lo:[1,0,0] neg_hi:[1,0,0] clamp
  v_pk_fma_f16 v57, v53, v53, s20 op_sel_hi:[1,1,0] neg_lo:[1,0,0] neg_hi:[1,0,0] clamp
  v_mfma_f32_16x16x32_bf16 v[20:23], v[36:39], v[216:219], 0
  v_pk_fma_f16 v58, v54, v54, s20 op_sel_hi:[1,1,0] neg_lo:[1,0,0] neg_hi:[1,0,0] clamp
  v_pk_fma_f16 v59, v55, v55, s20 op_sel_hi:[1,1,0] neg_lo:[1,0,0] neg_hi:[1,0,0] clamp
  v_mfma_f32_16x16x32_bf16 v[28:31], v[36:39], v[220:223], 0
  v_pk_fma_f16 v188, v56, v56, s20 op_sel:[0,0,1]
  v_pk_fma_f16 v189, v57, v57, s20 op_sel:[0,0,1]
  v_mfma_f32_16x16x32_bf16 v[16:19], v[40:43], v[224:227], v[16:19]
  v_pk_fma_f16 v190, v58, v58, s20 op_sel:[0,0,1]
  v_pk_fma_f16 v191, v59, v59, s20 op_sel:[0,0,1]
  v_mfma_f32_16x16x32_bf16 v[24:27], v[40:43], v[228:231], v[24:27]
  v_pk_fma_f16 v188, v188, v56, s21 op_sel_hi:[1,1,0]
  v_pk_fma_f16 v189, v189, v57, s21 op_sel_hi:[1,1,0]
  v_mfma_f32_16x16x32_bf16 v[20:23], v[44:47], v[224:227], v[20:23]
  v_pk_fma_f16 v190, v190, v58, s21 op_sel_hi:[1,1,0]
  v_pk_fma_f16 v191, v191, v59, s21 op_sel_hi:[1,1,0]
  v_mfma_f32_16x16x32_bf16 v[28:31], v[44:47], v[228:231], v[28:31]
  v_pk_fma_f16 v188, v188, v52, 0.5 op_sel_hi:[1,1,0] clamp
  v_pk_fma_f16 v189, v189, v53, 0.5 op_sel_hi:[1,1,0] clamp
  v_mfma_f32_16x16x32_bf16 v[16:19], v[60:63], v[232:235], v[16:19]
  v_pk_fma_f16 v190, v190, v54, 0.5 op_sel_hi:[1,1,0] clamp
  v_pk_fma_f16 v191, v191, v55, 0.5 op_sel_hi:[1,1,0] clamp
  v_mfma_f32_16x16x32_bf16 v[24:27], v[60:63], v[236:239], v[24:27]
  v_pk_mul_f16 v188, v188, v52
  v_pk_mul_f16 v189, v189, v53
  v_mfma_f32_16x16x32_bf16 v[20:23], v[244:247], v[232:235], v[20:23]
  v_pk_mul_f16 v190, v190, v54
  v_pk_mul_f16 v191, v191, v55
  v_mfma_f32_16x16x32_bf16 v[28:31], v[244:247], v[236:239], v[28:31]
  s_waitcnt lgkmcnt(0)
  v_cvt_pk_f16_f32 v48, v16, v17
  v_cvt_pk_f16_f32 v49, v18, v19
  v_mfma_f32_16x16x32_f16 v[64:67], v[184:187], v[192:195], v[64:67]
  s_nop 0
  v_cvt_pk_f16_f32 v50, v20, v21
  v_cvt_pk_f16_f32 v51, v22, v23
  v_mfma_f32_16x16x32_f16 v[68:71], v[184:187], v[196:199], v[68:71]
  v_cvt_pk_f16_f32 v52, v24, v25
  v_cvt_pk_f16_f32 v53, v26, v27
  v_mfma_f32_16x16x32_f16 v[72:75], v[184:187], v[200:203], v[72:75]
  v_cvt_pk_f16_f32 v54, v28, v29
  v_cvt_pk_f16_f32 v55, v30, v31
  v_mfma_f32_16x16x32_f16 v[76:79], v[184:187], v[204:207], v[76:79]
  v_pk_fma_f16 v56, v48, v48, s20 op_sel_hi:[1,1,0] neg_lo:[1,0,0] neg_hi:[1,0,0] clamp
  v_pk_fma_f16 v57, v49, v49, s20 op_sel_hi:[1,1,0] neg_lo:[1,0,0] neg_hi:[1,0,0] clamp
  v_mfma_f32_16x16x32_f16 v[80:83], v[184:187], v[208:211], v[80:83]
  v_pk_fma_f16 v58, v50, v50, s20 op_sel_hi:[1,1,0] neg_lo:[1,0,0] neg_hi:[1,0,0] clamp
  v_pk_fma_f16 v59, v51, v51, s20 op_sel_hi:[1,1,0] neg_lo:[1,0,0] neg_hi:[1,0,0] clamp
  v_mfma_f32_16x16x32_f16 v[84:87], v[184:187], v[212:215], v[84:87]
  v_pk_fma_f16 v184, v56, v56, s20 op_sel:[0,0,1]
  v_pk_fma_f16 v185, v57, v57, s20 op_sel:[0,0,1]
  v_pk_fma_f16 v186, v58, v58, s20 op_sel:[0,0,1]
  v_pk_fma_f16 v187, v59, v59, s20 op_sel:[0,0,1]
  v_pk_fma_f16 v184, v184, v56, s21 op_sel_hi:[1,1,0]
  v_pk_fma_f16 v185, v185, v57, s21 op_sel_hi:[1,1,0]
  v_pk_fma_f16 v186, v186, v58, s21 op_sel_hi:[1,1,0]
  v_pk_fma_f16 v187, v187, v59, s21 op_sel_hi:[1,1,0]
  v_pk_fma_f16 v184, v184, v48, 0.5 op_sel_hi:[1,1,0] clamp
  v_pk_fma_f16 v185, v185, v49, 0.5 op_sel_hi:[1,1,0] clamp
  v_mfma_f32_16x16x32_f16 v[88:91], v[188:191], v[192:195], v[88:91]
  ds_read_b128 v[192:195], v1 offset:2048
  v_pk_fma_f16 v186, v186, v50, 0.5 op_sel_hi:[1,1,0] clamp
  v_pk_fma_f16 v187, v187, v51, 0.5 op_sel_hi:[1,1,0] clamp
  v_mfma_f32_16x16x32_f16 v[92:95], v[188:191], v[196:199], v[92:95]
  ds_read_b128 v[196:199], v1 offset:3072
  v_pk_mul_f16 v184, v184, v48
  v_pk_mul_f16 v185, v185, v49
  v_mfma_f32_16x16x32_f16 v[96:99], v[188:191], v[200:203], v[96:99]
  ds_read_b128 v[200:203], v1 offset:4096
  v_pk_mul_f16 v186, v186, v50
  v_pk_mul_f16 v187, v187, v51
  v_mfma_f32_16x16x32_f16 v[100:103], v[188:191], v[204:207], v[100:103]
  ds_read_b128 v[204:207], v1 offset:5120
  v_pk_fma_f16 v56, v52, v52, s20 op_sel_hi:[1,1,0] neg_lo:[1,0,0] neg_hi:[1,0,0] clamp
  v_pk_fma_f16 v57, v53, v53, s20 op_sel_hi:[1,1,0] neg_lo:[1,0,0] neg_hi:[1,0,0] clamp
  v_mfma_f32_16x16x32_f16 v[104:107], v[188:191], v[208:211], v[104:107]
  s_nop 0
  ds_read_b128 v[208:211], v1 offset:6144
  v_pk_fma_f16 v58, v54, v54, s20 op_sel_hi:[1,1,0] neg_lo:[1,0,0] neg_hi:[1,0,0] clamp
  v_pk_fma_f16 v59, v55, v55, s20 op_sel_hi:[1,1,0] neg_lo:[1,0,0] neg_hi:[1,0,0] clamp
  v_mfma_f32_16x16x32_f16 v[108:111], v[188:191], v[212:215], v[108:111]
  s_waitcnt lgkmcnt(4)
  ds_read_b128 v[212:215], v1 offset:7168
  v_pk_fma_f16 v188, v56, v56, s20 op_sel:[0,0,1]
  v_pk_fma_f16 v189, v57, v57, s20 op_sel:[0,0,1]
  v_pk_fma_f16 v190, v58, v58, s20 op_sel:[0,0,1]
  v_pk_fma_f16 v191, v59, v59, s20 op_sel:[0,0,1]
  v_pk_fma_f16 v188, v188, v56, s21 op_sel_hi:[1,1,0]
  v_pk_fma_f16 v189, v189, v57, s21 op_sel_hi:[1,1,0]
  v_pk_fma_f16 v190, v190, v58, s21 op_sel_hi:[1,1,0]
  v_pk_fma_f16 v191, v191, v59, s21 op_sel_hi:[1,1,0]
  v_mfma_f32_16x16x32_f16 v[64:67], v[184:187], v[192:195], v[64:67]
  s_waitcnt lgkmcnt(4)
  v_pk_fma_f16 v188, v188, v52, 0.5 op_sel_hi:[1,1,0] clamp
  v_pk_fma_f16 v189, v189, v53, 0.5 op_sel_hi:[1,1,0] clamp
  v_mfma_f32_16x16x32_f16 v[68:71], v[184:187], v[196:199], v[68:71]
  s_waitcnt lgkmcnt(3)
  v_pk_fma_f16 v190, v190, v54, 0.5 op_sel_hi:[1,1,0] clamp
  v_pk_fma_f16 v191, v191, v55, 0.5 op_sel_hi:[1,1,0] clamp
  v_mfma_f32_16x16x32_f16 v[72:75], v[184:187], v[200:203], v[72:75]
  s_waitcnt lgkmcnt(2)
  v_pk_mul_f16 v188, v188, v52
  v_pk_mul_f16 v189, v189, v53
  v_mfma_f32_16x16x32_f16 v[76:79], v[184:187], v[204:207], v[76:79]
  s_waitcnt lgkmcnt(1)
  v_pk_mul_f16 v190, v190, v54
  v_pk_mul_f16 v191, v191, v55
  v_cvt_pk_bf16_f32 v112, v64, v68
  v_cvt_pk_bf16_f32 v116, v65, v69
  v_mfma_f32_16x16x32_f16 v[80:83], v[184:187], v[208:211], v[80:83]
  s_waitcnt lgkmcnt(0)
  v_cvt_pk_bf16_f32 v120, v66, v70
  v_cvt_pk_bf16_f32 v124, v67, v71
  v_mfma_f32_16x16x32_f16 v[84:87], v[184:187], v[212:215], v[84:87]
  s_nop 0
  v_cvt_pk_bf16_f32 v113, v72, v76
  v_cvt_pk_bf16_f32 v117, v73, v77
  v_cvt_pk_bf16_f32 v121, v74, v78
  v_cvt_pk_bf16_f32 v125, v75, v79
  v_mfma_f32_16x16x32_f16 v[88:91], v[188:191], v[192:195], v[88:91]
  s_nop 0
  v_mfma_f32_16x16x32_f16 v[92:95], v[188:191], v[196:199], v[92:95]
  s_nop 1
  v_cvt_pk_bf16_f32 v114, v80, v84
  v_cvt_pk_bf16_f32 v118, v81, v85
  v_cvt_pk_bf16_f32 v122, v82, v86
  v_mfma_f32_16x16x32_f16 v[96:99], v[188:191], v[200:203], v[96:99]
  v_cvt_pk_bf16_f32 v126, v83, v87
  s_nop 0
  v_mfma_f32_16x16x32_f16 v[100:103], v[188:191], v[204:207], v[100:103]
  s_nop 0
  v_cvt_pk_bf16_f32 v128, v88, v92
  v_cvt_pk_bf16_f32 v132, v89, v93
  v_cvt_pk_bf16_f32 v136, v90, v94
  v_cvt_pk_bf16_f32 v140, v91, v95
  v_mfma_f32_16x16x32_f16 v[104:107], v[188:191], v[208:211], v[104:107]
  s_nop 0
  s_nop 0
  v_mfma_f32_16x16x32_f16 v[108:111], v[188:191], v[212:215], v[108:111]
  buffer_store_dwordx3 v[112:114], v10, s[8:11], s28 offen sc1 nt
  v_cvt_pk_bf16_f32 v129, v96, v100
  buffer_store_dwordx3 v[116:118], v10, s[8:11], s28 offen offset:384 sc1 nt
  v_cvt_pk_bf16_f32 v133, v97, v101
  buffer_store_dwordx3 v[120:122], v10, s[8:11], s57 offen sc1 nt
  v_cvt_pk_bf16_f32 v137, v98, v102
  buffer_store_dwordx3 v[124:126], v10, s[8:11], s57 offen offset:384 sc1 nt
  v_cvt_pk_bf16_f32 v141, v99, v103
  v_cvt_pk_bf16_f32 v130, v104, v108
  v_cvt_pk_bf16_f32 v134, v105, v109
  buffer_store_dwordx3 v[128:130], v10, s[8:11], s59 offen sc1 nt
  v_cvt_pk_bf16_f32 v138, v106, v110
  buffer_store_dwordx3 v[132:134], v10, s[8:11], s59 offen offset:384 sc1 nt
  v_cvt_pk_bf16_f32 v142, v107, v111
  buffer_store_dwordx3 v[136:138], v10, s[8:11], s15 offen sc1 nt
  buffer_store_dwordx3 v[140:142], v10, s[8:11], s15 offen offset:384 sc1 nt
L_end:
  s_endpgm
L_cend:
L_slow:
  s_waitcnt vmcnt(0) lgkmcnt(0)
  s_nop 15
  s_nop 15
  s_barrier
  v_mbcnt_lo_u32_b32 v0, -1, 0
  v_mbcnt_hi_u32_b32 v0, -1, v0
  v_lshl_add_u32 v0, s27, 6, v0
  s_nop 4
  .p2align 7
  s_cmp_ge_u32 s2, 0x100
  s_cbranch_scc1 S_end
  s_nop 0
  s_load_dwordx2 s[4:5], s[0:1], 0
  s_load_dwordx2 s[60:61], s[0:1], 8
  s_load_dwordx2 s[64:65], s[0:1], 16
  s_load_dwordx2 s[68:69], s[0:1], 24
  s_load_dwordx2 s[72:73], s[0:1], 32
  s_load_dwordx2 s[76:77], s[0:1], 40
  s_load_dwordx2 s[80:81], s[0:1], 48
  s_load_dwordx2 s[8:9], s[0:1], 56
  s_getpc_b64 s[40:41]
S_pc:
  s_lshl_b32 s32, s2, 9
  s_and_b32 s32, s32, 0xf000
  v_lshl_add_u32 v249, v0, 4, s32
  v_lshrrev_b32_e64 v112, 6, v0
  v_min_u32 v249, S_end-S_pc-12, v249
  v_and_b32 v113, 63, v0
  global_load_dwordx4 v[108:111], v249, s[40:41]
  v_readfirstlane_b32 s27, v112
  s_mov_b32 s62, 0x6c0
  s_mov_b32 s63, 0x20000
  s_mov_b32 s82, 0xc0
  s_mov_b32 s83, 0x20000
  s_mov_b32 s78, 0xc0
  s_mov_b32 s79, 0x20000
  s_mov_b32 s66, 0x12000
  s_mov_b32 s67, 0x20000
  s_mov_b32 s74, 0x12000
  s_mov_b32 s75, 0x20000
  v_bfe_u32 v114, v113, 3, 1
  v_bfe_u32 v115, v113, 4, 1
  v_bfe_u32 v116, v113, 2, 1
  v_and_b32 v117, 3, v113
  v_lshlrev_b32 v118, 4, v113
  s_min_u32 s44, s27, 2
  s_lshl_b32 s45, s44, 6
  s_mul_i32 s46, s44, 0x240
  v_lshlrev_b32 v119, 1, v113
  v_and_b32 v120, 31, v113
  v_lshlrev_b32_e64 v121, 1, v120
  v_lshlrev_b32_e64 v122, 4, v115
  v_lshl_add_u32 v122, v116, 3, v122
  v_lshl_add_u32 v122, v114, 2, v122
  v_add_u32_e64 v122, v122, v117
  v_lshlrev_b32_e64 v123, 1, v122
  s_lshr_b32 s35, s2, 3
  s_lshl_b32 s35, s35, 2
  s_add_u32 s35, s35, s27
  s_sub_u32 s55, s35, 0x48
  s_min_u32 s35, s35, s55
  s_lshl_b32 s47, s35, 10
  s_and_b32 s54, s2, 6
  s_lshl_b32 s54, s54, 1
  s_lshr_b32 s32, s2, 6
  s_add_u32 s54, s54, s32
  s_mul_i32 s59, s54, 0x300000
  s_and_b32 s53, s2, 1
  s_lshl_b32 s53, s53, 8
  s_and_b32 s32, s2, 56
  s_lshl_b32 s32, s32, 2
  s_add_u32 s53, s53, s32
  s_lshl_b32 s32, s27, 3
  s_add_u32 s53, s53, s32
  s_mul_i32 s3, s53, 0xc0
  s_add_u32 s3, s3, 0xf40
  s_mov_b32 s6, 0x3000000
  s_mov_b32 s7, 0x20000
  s_cmp_eq_u32 s53, 0
  s_cselect_b32 s35, 12, 0
  s_sub_u32 s55, 0x78, s35
  s_cmp_eq_u32 s53, 0x1f8
  s_cselect_b32 s55, 0x6c, s55
  s_mul_i32 s15, s27, 0x1040
  s_add_u32 s48, s59, 0x17000
  s_add_u32 s49, s59, 0x47000
  s_waitcnt lgkmcnt(0)
  v_add_u32 v124, 64, v113
  buffer_load_dwordx4 v[108:111], v118, s[64:67], s47 offen
  v_subrev_u32 v127, 57, v113
  v_cmp_le_u32 vcc, 57, v113
  buffer_load_dwordx4 v[108:111], v118, s[72:75], s47 offen
  v_add_u32_e64 v125, 7, v113
  v_add_u32 v126, 0x47, v113
  buffer_load_ushort v129, v119, s[60:63], s46 offen
  v_mov_b32 v199, 0x17c00
  v_cndmask_b32_e64 v124, v124, v127, vcc
  buffer_load_ushort v130, v119, s[60:63], s46 offen offset:128
  v_mov_b32 v127, 0xfffffc00
  v_cndmask_b32_e64 v199, v127, v199, vcc
  v_add_u32_e64 v198, s3, v118
  buffer_load_ushort v131, v119, s[60:63], s46 offen offset:256
  v_lshl_add_u32 v199, v124, 4, v199
  v_add_u32_e64 v199, s3, v199
  buffer_load_ushort v132, v119, s[60:63], s46 offen offset:384
  v_add_u32 v200, 0x17870, v198
  v_add_u32 v201, 0x17870, v198
  buffer_load_ushort v133, v121, s[60:63], s46 offen offset:512
  v_mov_b32 v128, 0x80000000
  v_subrev_u32_e64 v6, s35, v113
  buffer_load_ushort v137, v123, s[80:83], s45 offen
  v_cmp_gt_u32 s[36:37], s55, v6
  v_subrev_u32_e64 v7, s35, v124
  v_cmp_gt_u32 s[38:39], s55, v7
  buffer_load_ushort v138, v123, s[76:79], s45 offen
  v_subrev_u32_e64 v8, s35, v125
  v_cmp_gt_u32 s[40:41], s55, v8
  buffer_load_ushort v134, v123, s[80:83], 0 offen
  v_subrev_u32_e64 v9, s35, v126
  v_cmp_gt_u32 s[42:43], s55, v9
  buffer_load_ushort v135, v123, s[80:83], 0 offen offset:64
  v_cndmask_b32 v6, v128, v198, s[36:37]
  v_cndmask_b32 v7, v128, v199, s[38:39]
  buffer_load_ushort v136, v123, s[80:83], 0 offen offset:128
  v_cndmask_b32 v8, v128, v200, s[40:41]
  v_cndmask_b32 v9, v128, v201, s[42:43]
  s_add_u32 m0, s15, 0x4120
  s_nop 0
  buffer_load_dwordx4 v6, s[4:7], s48 offen lds
  buffer_load_dwordx4 v7, s[4:7], s48 offen offset:1024 lds
  buffer_load_dwordx4 v8, s[4:7], s48 offen offset:2048 lds
  buffer_load_dwordx4 v9, s[4:7], s48 offen offset:3072 lds
  s_sub_u32 s56, s59, 0x19000
  v_add_u32 v198, s56, v6
  s_add_u32 s56, s56, 0x400
  v_add_u32_e64 v199, s56, v7
  s_add_u32 s56, s56, 0x400
  v_add_u32_e64 v200, s56, v8
  s_add_u32 s56, s56, 0x400
  v_add_u32 v201, s56, v9
  v_lshrrev_b32 v139, 5, v113
  v_lshlrev_b32_e64 v202, 4, v117
  v_lshl_add_u32 v202, v139, 6, v202
  v_bfe_u32 v124, v113, 3, 2
  v_lshl_add_u32 v124, v116, 2, v124
  v_cmp_eq_u32 vcc, 7, v124
  v_mul_u32_u24 v203, 0x300, v124
  v_add_u32 v203, v203, v202
  v_cndmask_b32_e64 v204, v128, v202, vcc
  s_mov_b32 s70, 0x300
  s_mov_b32 s71, 0x20000
  s_mov_b32 s10, 0x3000000
  s_mov_b32 s11, 0x20000
  s_and_b32 s36, s27, 2
  s_add_u32 s37, s27, 1
  s_lshr_b32 s37, s37, 1
  s_and_b32 s38, s37, 1
  s_cmp_eq_u32 s27, 1
  s_cselect_b32 s39, 0, 3
  s_cselect_b32 s51, 0x1000, 0
  s_lshl_b32 s32, s36, 8
  s_lshl_b32 s33, s37, 8
  s_add_u32 s43, s32, 0x11d00
  s_add_u32 s50, s33, 0x11d00
  s_add_u32 s51, s51, s33
  s_mul_i32 s40, s38, 0x6000
  s_add_u32 s40, s40, s32
  s_mul_i32 s41, s38, 0x1800
  s_add_u32 s41, s41, s32
  s_add_u32 s41, s41, 0x3000
  s_mul_i32 s42, s39, 0x3000
  s_add_u32 s42, s42, s33
  s_mul_i32 s32, s36, 0x6000
  s_lshl_b32 s33, s38, 11
  s_add_u32 s33, s33, s32
  s_add_u32 s33, s33, 0x10000
  v_add_u32_e64 v195, s33, v118
  s_lshl_b32 s33, s38, 3
  s_add_u32 s33, s33, s32
  s_add_u32 s33, s33, 0x10400
  v_add_u32_e64 v196, s33, v118
  s_mul_i32 s32, s37, 0x6000
  s_lshl_b32 s33, s39, 10
  s_add_u32 s33, s33, s32
  s_add_u32 s33, s33, 0x10000
  v_add_u32 v197, s33, v118
  v_add_u32 v125, 16, v113
  v_lshrrev_b32_e64 v125, 6, v125
  buffer_load_dwordx4 a[72:75], v202, s[64:67], s43 offen
  v_lshlrev_b32 v125, 4, v125
  v_xor_b32 v254, v125, v118
  v_lshl_add_u32 v125, v139, 4, 16
  v_xor_b32_e64 v255, v125, v118
  v_mul_u32_u24 v125, 0x1200, v139
  v_add_u32_e64 v255, v125, v255
  v_add_u32 v125, 0xb0, v113
  v_lshrrev_b32 v125, 6, v125
  v_lshlrev_b32 v125, 4, v125
  v_xor_b32_e64 v194, v125, v118
  v_add_u32 v194, 0x1200, v194
  s_mul_i32 s14, s27, 0x1800
  s_add_u32 s32, s27, 3
  s_and_b32 s32, s32, 3
  s_mul_i32 s32, s32, 0x600
  s_cmp_eq_u32 s27, 0
  s_cselect_b32 s57, 0, 3
  s_cselect_b32 s53, 3, 6
  s_cselect_b32 s55, 6, 0
  s_lshl_b32 s57, s57, 13
  s_add_u32 s57, s57, s32
  s_add_u32 s58, s57, 0x3000
  s_lshl_b32 s53, s53, 13
  s_add_u32 s53, s53, s32
  s_add_u32 s54, s53, 0x3000
  s_lshl_b32 s55, s55, 13
  s_add_u32 s55, s55, s32
  s_add_u32 s56, s55, 0x3000
  v_and_b32_e64 v145, 7, v113
  buffer_load_dwordx4 a[76:79], v202, s[64:67], s43 offen offset:128
  v_lshrrev_b32 v146, 4, v113
  v_lshlrev_b32 v147, 4, v139
  v_and_b32 v141, 1, v113
  v_lshlrev_b32 v141, 4, v141
  v_mov_b32 v127, 0xffff
  v_lshlrev_b32_e64 v127, v141, v127
  v_bfe_u32 v125, v113, 1, 2
  buffer_load_dwordx4 a[80:83], v202, s[64:67], s50 offen
  v_lshlrev_b32 v125, v125, 1
  v_bfe_i32 v56, v125, 0, 1
  v_mov_b32 v60, 0
  v_and_b32 v56, v56, v127
  v_bfe_i32 v57, v125, 1, 1
  v_mov_b32 v61, 0
  v_and_b32 v57, v57, v127
  v_bfe_i32 v58, v125, 2, 1
  v_mov_b32 v62, 0
  v_and_b32 v58, v58, v127
  v_bfe_i32 v59, v125, 3, 1
  v_mov_b32 v63, 0
  v_and_b32 v59, v59, v127
  v_min_u32_e64 v125, 35, v113
  v_mul_u32_u24 v125, 0x190, v125
  ds_write_b128 v125, v[60:63] offset:50304
  s_lshl_b32 s32, s44, 7
  v_lshrrev_b32 v142, 3, v113
  buffer_load_dwordx4 a[84:87], v202, s[64:67], s50 offen offset:128
  v_mul_u32_u24 v142, 0x190, v142
  v_lshl_add_u32 v142, v145, 4, v142
  v_add_u32 v142, s32, v142
  v_lshrrev_b32 v143, 3, v120
  v_mul_u32_u24 v143, 0x190, v143
  v_lshl_add_u32 v143, v145, 4, v143
  v_add_u32_e64 v143, s32, v143
  v_lshl_add_u32 v144, v120, 2, s32
  v_sub_u32_e64 v125, v146, v116
  v_lshl_add_u32 v126, v114, 2, v117
  v_lshl_add_u32 v126, v125, 3, v126
  v_min_u32 v126, 24, v126
  v_lshlrev_b32 v126, 4, v126
  v_add_u32 v3, 0xc300, v126
  v_lshlrev_b32_e64 v148, 2, v115
  v_lshl_add_u32 v148, v114, 1, v148
  v_bfe_u32 v126, v113, 1, 1
  buffer_load_dwordx4 a[88:91], v204, s[68:71], s51 offen
  v_add_u32 v148, v148, v126
  v_xor_b32 v126, v116, v139
  v_lshl_add_u32 v148, v126, 3, v148
  v_lshlrev_b32 v148, v148, 1
  v_mov_b32 v126, 0x3f80
  v_lshlrev_b32_e64 v126, v141, v126
  v_mov_b32 v125, 0xbf80
  v_lshlrev_b32_e64 v125, v141, v125
  v_bfe_i32 v160, v148, 0, 1
  v_and_b32 v240, v160, v126
  v_and_b32 v184, v160, v125
  v_bfe_i32 v161, v148, 1, 1
  v_and_b32 v241, v161, v126
  v_and_b32 v185, v161, v125
  v_bfe_i32 v162, v148, 2, 1
  v_and_b32 v242, v162, v126
  v_and_b32 v186, v162, v125
  v_bfe_i32 v163, v148, 3, 1
  buffer_load_dwordx4 a[92:95], v204, s[68:71], s51 offen offset:128
  v_and_b32 v243, v163, v126
  v_and_b32 v187, v163, v125
  v_bfe_i32 v164, v148, 4, 1
  v_and_b32 v244, v164, v126
  v_and_b32 v188, v164, v125
  v_bfe_i32 v165, v148, 5, 1
  v_and_b32 v245, v165, v126
  v_and_b32 v189, v165, v125
  v_bfe_i32 v166, v148, 6, 1
  v_and_b32 v246, v166, v126
  v_and_b32 v190, v166, v125
  v_bfe_i32 v167, v148, 7, 1
  v_and_b32 v247, v167, v126
  v_and_b32 v191, v167, v125
  s_mov_b32 s22, 0x3eeff558
  s_mov_b32 s24, 0x3c2aaaab
  s_mov_b32 s25, 0x3727c5ac
  s_mov_b32 s20, 0x409d30fc
  s_mov_b32 s21, 0x409d30fc
  s_mov_b32 s23, 0x3eeff558
  s_mov_b32 s12, 0
  s_mov_b32 s13, -1
  s_add_u32 s29, s59, 0x77000
  s_add_u32 s52, s59, 0xa7000
  v_mul_u32_u24 v149, 0xc0, v145
  buffer_load_dwordx4 a[0:3], v203, s[64:67], s40 offen
  v_add_u32_e64 v127, s15, v149
  v_lshl_add_u32 v150, v114, 1, v146
  v_lshrrev_b32_e64 v125, 1, v150
  v_mul_u32_u24 v140, 0x4100, v125
  v_and_b32_e64 v125, 1, v125
  v_lshl_add_u32 v140, v125, 5, v140
  v_and_b32_e64 v125, 1, v150
  v_mul_u32_u24 v125, 0x790, v125
  v_add3_u32 v4, v140, v125, v127
  v_lshl_add_u32 v151, v114, 1, v115
  buffer_load_dwordx4 a[4:7], v203, s[64:67], s40 offen offset:128
  s_add_u32 s40, s40, 0x1800
  v_add_u32_e64 v150, 1, v151
  v_add_u32 v127, 0xc0, v127
  v_add_u32_e64 v127, v127, v147
  v_lshrrev_b32_e64 v125, 1, v150
  v_mul_u32_u24 v140, 0x4100, v125
  v_and_b32_e64 v125, 1, v125
  v_lshl_add_u32 v140, v125, 5, v140
  v_and_b32_e64 v125, 1, v150
  v_mul_u32_u24 v125, 0x790, v125
  v_add3_u32 v5, v140, v125, v127
  v_mul_u32_u24 v125, 0x18000, v151
  v_add3_u32 v10, v125, v147, v149
  s_sub_u32 s32, s3, 0xf40
  v_add_u32_e64 v10, s32, v10
  v_add_u32 v2, 0xfb40, v147
  v_add_u32 v0, 0x10000, v118
  v_add_u32 v1, 0x20000, v118
  v_and_b32_e64 v125, 15, v113
  buffer_load_dwordx4 a[8:11], v203, s[64:67], s40 offen
  v_lshlrev_b32 v125, 7, v125
  v_mul_u32_u24 v126, 0x18000, v146
  s_sub_u32 s32, s3, 64
  v_add3_u32 v248, v125, v126, s32
  v_mov_b32 v250, 0x3ef00000
  s_add_u32 s32, s14, 0x16000
  v_add_u32_e64 v253, s32, v118
  v_bfe_u32 v125, v122, 2, 2
  v_xor_b32_e64 v125, v125, v139
  v_lshl_add_u32 v125, v125, 4, s32
  v_mul_u32_u24 v126, 0xc0, v122
  v_add_u32_e64 v251, v125, v126
  v_xor_b32_e64 v252, 32, v251
  s_add_u32 s30, s15, 32
  s_add_u32 s31, s15, 0x4100
  s_mov_b32 s34, s59
  s_mov_b32 s28, 0x80000000
  s_add_u32 s33, s15, 0x8200
  buffer_load_dwordx4 a[12:15], v203, s[64:67], s40 offen offset:128
  buffer_load_dwordx4 a[16:19], v203, s[64:67], s41 offen
  buffer_load_dwordx4 a[20:23], v203, s[64:67], s41 offen offset:128
  s_waitcnt vmcnt(25)
  v_lshl_or_b32 v129, v129, 16, v129
  v_and_b32 v16, v56, v129
  v_and_b32 v17, v57, v129
  v_and_b32 v18, v58, v129
  v_and_b32_e64 v19, v59, v129
  ds_write_b128 v142, v[16:19] offset:49920
  s_waitcnt vmcnt(24)
  v_lshl_or_b32 v130, v130, 16, v130
  v_and_b32 v20, v56, v130
  v_and_b32 v21, v57, v130
  v_and_b32 v22, v58, v130
  v_and_b32 v23, v59, v130
  ds_write_b128 v142, v[20:23] offset:53120
  s_waitcnt vmcnt(23)
  v_lshl_or_b32 v131, v131, 16, v131
  v_and_b32 v24, v56, v131
  v_and_b32 v25, v57, v131
  v_and_b32 v26, v58, v131
  v_and_b32 v27, v59, v131
  ds_write_b128 v142, v[24:27] offset:56320
  s_waitcnt vmcnt(22)
  v_lshl_or_b32 v132, v132, 16, v132
  v_and_b32 v28, v56, v132
  v_and_b32 v29, v57, v132
  v_and_b32 v30, v58, v132
  v_and_b32 v31, v59, v132
  ds_write_b128 v142, v[28:31] offset:59520
  s_waitcnt vmcnt(21)
  v_lshl_or_b32 v133, v133, 16, v133
  v_and_b32 v16, v56, v133
  v_and_b32 v17, v57, v133
  v_and_b32 v18, v58, v133
  v_and_b32 v19, v59, v133
  ds_write_b128 v143, v[16:19] offset:62720
  s_waitcnt vmcnt(20)
  v_lshlrev_b32 v137, 16, v137
  s_waitcnt vmcnt(19)
  v_lshlrev_b32 v138, 16, v138
  v_mul_f32 v138, v137, v138
  s_waitcnt vmcnt(18)
  v_lshlrev_b32 v134, v141, v134
  s_waitcnt vmcnt(17)
  v_lshlrev_b32 v135, v141, v135
  s_waitcnt vmcnt(16)
  v_lshlrev_b32_e64 v136, v141, v136
  ds_write_b32 v144, v138 offset:64320
  s_waitcnt lgkmcnt(0)
  s_barrier
  ds_read_b128 a[96:99], v3
  ds_read_b128 a[100:103], v3 offset:4800
  ds_read_b128 a[104:107], v3 offset:9600
  ds_read_b128 a[108:111], v3 offset:400
  ds_read_b128 a[112:115], v3 offset:5200
  ds_read_b128 a[116:119], v3 offset:10000
  v_and_b32 v125, v160, v134
  v_and_b32 v126, v161, v134
  v_and_b32_e64 v127, v162, v134
  buffer_load_dwordx4 a[24:27], v203, s[64:67], s42 offen
  v_and_b32_e64 v140, v163, v134
  v_accvgpr_write_b32 a192, v125
  v_accvgpr_write_b32 a193, v126
  v_accvgpr_write_b32 a194, v127
  v_accvgpr_write_b32 a195, v140
  ds_read_b128 a[120:123], v3 offset:800
  ds_read_b128 a[124:127], v3 offset:5600
  ds_read_b128 a[128:131], v3 offset:10400
  ds_read_b128 a[132:135], v3 offset:1200
  ds_read_b128 a[136:139], v3 offset:6000
  ds_read_b128 a[140:143], v3 offset:10800
  buffer_load_dwordx4 a[28:31], v203, s[64:67], s42 offen offset:128
  s_add_u32 s42, s42, 0x1800
  v_and_b32 v125, v164, v134
  v_and_b32 v126, v165, v134
  v_and_b32 v127, v166, v134
  v_and_b32 v140, v167, v134
  v_accvgpr_write_b32 a196, v125
  v_accvgpr_write_b32 a197, v126
  v_accvgpr_write_b32 a198, v127
  v_accvgpr_write_b32 a199, v140
  ds_read_b128 a[144:147], v3 offset:1600
  ds_read_b128 a[148:151], v3 offset:6400
  buffer_load_dwordx4 a[32:35], v203, s[64:67], s42 offen
  ds_read_b128 a[152:155], v3 offset:11200
  ds_read_b128 a[156:159], v3 offset:2000
  ds_read_b128 a[160:163], v3 offset:6800
  ds_read_b128 a[164:167], v3 offset:11600
  v_and_b32 v125, v160, v135
  v_and_b32 v126, v161, v135
  v_and_b32 v127, v162, v135
  v_and_b32 v140, v163, v135
  v_accvgpr_write_b32 a200, v125
  v_accvgpr_write_b32 a201, v126
  v_accvgpr_write_b32 a202, v127
  buffer_load_dwordx4 a[36:39], v203, s[64:67], s42 offen offset:128
  s_add_u32 s42, s42, 0x1800
  v_accvgpr_write_b32 a203, v140
  ds_read_b128 a[240:243], v3 offset:2400
  ds_read_b128 a[244:247], v3 offset:7200
  ds_read_b128 a[248:251], v3 offset:12000
  ds_read_b128 a[168:171], v3 offset:2800
  ds_read_b128 a[172:175], v3 offset:7600
  ds_read_b128 a[176:179], v3 offset:12400
  v_and_b32 v125, v164, v135
  v_and_b32 v126, v165, v135
  v_and_b32 v127, v166, v135
  v_and_b32 v140, v167, v135
  buffer_load_dwordx4 a[40:43], v203, s[64:67], s42 offen
  v_accvgpr_write_b32 a204, v125
  v_accvgpr_write_b32 a205, v126
  v_accvgpr_write_b32 a206, v127
  v_accvgpr_write_b32 a207, v140
  ds_read_b128 a[252:255], v3 offset:3200
  ds_read_b128 a[180:183], v3 offset:8000
  ds_read_b128 a[184:187], v3 offset:12800
  ds_read_b128 a[188:191], v3 offset:3600
  ds_read_b128 a[216:219], v3 offset:8400
  ds_read_b128 a[220:223], v3 offset:13200
  buffer_load_dwordx4 a[44:47], v203, s[64:67], s42 offen offset:128
  s_add_u32 s42, s42, 0x1800
  v_and_b32 v125, v160, v136
  v_and_b32 v126, v161, v136
  v_and_b32 v127, v162, v136
  v_and_b32 v140, v163, v136
  v_accvgpr_write_b32 a208, v125
  v_accvgpr_write_b32 a209, v126
  v_accvgpr_write_b32 a210, v127
  v_accvgpr_write_b32 a211, v140
  ds_read_b128 a[224:227], v3 offset:4000
  ds_read_b128 a[228:231], v3 offset:8800
  ds_read_b128 a[232:235], v3 offset:13600
  buffer_load_dwordx4 a[48:51], v203, s[64:67], s42 offen
  ds_read_b128 a[236:239], v3 offset:4400
  ds_read_b128 v[208:211], v3 offset:9200
  ds_read_b128 v[212:215], v3 offset:14000
  v_and_b32 v125, v164, v136
  v_and_b32 v126, v165, v136
  v_and_b32 v127, v166, v136
  v_and_b32 v140, v167, v136
  v_accvgpr_write_b32 a212, v125
  v_accvgpr_write_b32 a213, v126
  v_accvgpr_write_b32 a214, v127
  buffer_load_dwordx4 a[52:55], v203, s[64:67], s42 offen offset:128
  s_add_u32 s42, s42, 0x1800
  v_accvgpr_write_b32 a215, v140
  s_waitcnt vmcnt(19)
  v_mfma_f32_32x32x16_bf16 v[16:31], a[72:75], v[184:187], 0
  buffer_load_dwordx4 a[56:59], v203, s[64:67], s42 offen
  s_waitcnt vmcnt(19)
  v_mfma_f32_32x32x16_bf16 v[16:31], a[76:79], v[188:191], v[16:31]
  s_waitcnt vmcnt(18)
  v_mfma_f32_32x32x16_bf16 v[32:47], a[80:83], v[184:187], 0
  s_nop 0
  buffer_load_dwordx4 a[60:63], v203, s[64:67], s42 offen offset:128
  s_add_u32 s42, s42, 0x1800
  s_waitcnt vmcnt(15)
  v_mfma_f32_32x32x16_bf16 v[48:63], a[0:3], v[240:243], v[16:31]
  s_nop 0
  buffer_load_dwordx4 a[64:67], v203, s[64:67], s42 offen
  v_mfma_f32_32x32x16_bf16 v[32:47], a[84:87], v[188:191], v[32:47]
  s_waitcnt vmcnt(15)
  v_mfma_f32_32x32x16_bf16 v[48:63], a[4:7], v[244:247], v[48:63]
  buffer_load_dwordx4 a[68:71], v203, s[64:67], s42 offen offset:128
  s_waitcnt vmcnt(15)
  v_mfma_f32_32x32x16_bf16 v[216:231], a[8:11], v[240:243], v[16:31]
  s_add_u32 m0, s15, 0x8200
  s_nop 0
  buffer_load_dwordx4 v6, s[4:7], s49 offen lds
  s_waitcnt vmcnt(15)
  v_mfma_f32_32x32x16_bf16 v[216:231], a[12:15], v[244:247], v[216:231]
  buffer_load_dwordx4 v7, s[4:7], s49 offen offset:1024 lds
  s_nop 2
  v_cvt_pk_bf16_f32 v64, v48, v52
  v_cvt_pk_bf16_f32 v65, v56, v60
  v_cvt_pk_bf16_f32 v68, v49, v53
  v_cvt_pk_bf16_f32 v69, v57, v61
  s_waitcnt vmcnt(15)
  v_mfma_f32_32x32x16_bf16 v[96:111], a[16:19], v[240:243], v[16:31]
  buffer_load_dwordx4 v8, s[4:7], s49 offen offset:2048 lds
  v_cvt_pk_bf16_f32 v72, v50, v54
  v_cvt_pk_bf16_f32 v73, v58, v62
  v_cvt_pk_bf16_f32 v76, v51, v55
  v_cvt_pk_bf16_f32 v77, v59, v63
  s_waitcnt vmcnt(15)
  v_mfma_f32_32x32x16_bf16 v[96:111], a[20:23], v[244:247], v[96:111]
  buffer_load_dwordx4 v9, s[4:7], s49 offen offset:3072 lds
  v_cvt_pk_bf16_f32 v66, v216, v220
  v_cvt_pk_bf16_f32 v67, v224, v228
  v_cvt_pk_bf16_f32 v70, v217, v221
  v_cvt_pk_bf16_f32 v71, v225, v229
  ds_write_b128 v195, v[64:67]
  s_waitcnt vmcnt(15)
  v_mfma_f32_32x32x16_bf16 v[48:63], a[24:27], v[240:243], v[32:47]
  s_add_u32 m0, s15, 0
  s_nop 0
  buffer_load_dwordx4 v198, s[4:7], 0 offen lds
  ds_write_b128 v195, v[68:71] offset:6144
  v_cvt_pk_bf16_f32 v74, v218, v222
  v_cvt_pk_bf16_f32 v75, v226, v230
  v_cvt_pk_bf16_f32 v78, v219, v223
  v_cvt_pk_bf16_f32 v79, v227, v231
  s_waitcnt vmcnt(15)
  v_mfma_f32_32x32x16_bf16 v[48:63], a[28:31], v[244:247], v[48:63]
  s_add_u32 m0, s15, 0x400
  s_nop 0
  buffer_load_dwordx4 v199, s[4:7], 0 offen lds
  ds_write_b128 v195, v[72:75] offset:12288
  v_cvt_pk_bf16_f32 v80, v96, v100
  v_cvt_pk_bf16_f32 v81, v104, v108
  v_cvt_pk_bf16_f32 v84, v97, v101
  v_cvt_pk_bf16_f32 v85, v105, v109
  s_waitcnt vmcnt(15)
  v_mfma_f32_32x32x16_bf16 v[216:231], a[32:35], v[240:243], v[32:47]
  s_add_u32 m0, s15, 0x800
  s_nop 0
  buffer_load_dwordx4 v200, s[4:7], 0 offen lds
  ds_write_b128 v195, v[76:79] offset:18432
  v_cvt_pk_bf16_f32 v88, v98, v102
  v_cvt_pk_bf16_f32 v89, v106, v110
  v_cvt_pk_bf16_f32 v92, v99, v103
  v_cvt_pk_bf16_f32 v93, v107, v111
  s_waitcnt vmcnt(15)
  v_mfma_f32_32x32x16_bf16 v[216:231], a[36:39], v[244:247], v[216:231]
  s_add_u32 m0, s15, 0xc00
  s_nop 0
  buffer_load_dwordx4 v201, s[4:7], 0 offen lds
  ds_write_b64 v196, v[80:81]
  ds_write_b64 v196, v[84:85] offset:6144
  v_cvt_pk_bf16_f32 v64, v48, v52
  v_cvt_pk_bf16_f32 v65, v56, v60
  v_cvt_pk_bf16_f32 v68, v49, v53
  v_cvt_pk_bf16_f32 v69, v57, v61
  s_waitcnt vmcnt(15)
  v_mfma_f32_32x32x16_bf16 v[96:111], a[40:43], v[240:243], v[32:47]
  s_add_u32 m0, s14, 0x22000
  s_nop 0
  buffer_load_dwordx4 v254, s[72:75], s57 offen lds
  ds_write_b64 v196, v[88:89] offset:12288
  ds_write_b64 v196, v[92:93] offset:18432
  v_cvt_pk_bf16_f32 v72, v50, v54
  v_cvt_pk_bf16_f32 v73, v58, v62
  v_cvt_pk_bf16_f32 v76, v51, v55
  v_cvt_pk_bf16_f32 v77, v59, v63
  s_waitcnt vmcnt(15)
  v_mfma_f32_32x32x16_bf16 v[96:111], a[44:47], v[244:247], v[96:111]
  s_nop 0
  buffer_load_dwordx4 v255, s[72:75], s57 offen offset:1024 lds
  v_cvt_pk_bf16_f32 v66, v216, v220
  v_cvt_pk_bf16_f32 v67, v224, v228
  v_cvt_pk_bf16_f32 v70, v217, v221
  v_cvt_pk_bf16_f32 v71, v225, v229
  ds_write_b128 v197, v[64:67]
  s_waitcnt vmcnt(15)
  v_mfma_f32_32x32x16_bf16 v[48:63], a[48:51], v[240:243], v[32:47]
  s_nop 0
  buffer_load_dwordx4 v194, s[72:75], s57 offen offset:2048 lds
  ds_write_b128 v197, v[68:71] offset:6144
  v_cvt_pk_bf16_f32 v74, v218, v222
  v_cvt_pk_bf16_f32 v75, v226, v230
  v_cvt_pk_bf16_f32 v78, v219, v223
  v_cvt_pk_bf16_f32 v79, v227, v231
  s_waitcnt vmcnt(15)
  v_mfma_f32_32x32x16_bf16 v[48:63], a[52:55], v[244:247], v[48:63]
  s_add_u32 m0, s14, 0x22c00
  s_nop 0
  buffer_load_dwordx4 v254, s[72:75], s58 offen lds
  ds_write_b128 v197, v[72:75] offset:12288
  v_cvt_pk_bf16_f32 v80, v96, v100
  v_cvt_pk_bf16_f32 v81, v104, v108
  v_cvt_pk_bf16_f32 v84, v97, v101
  v_cvt_pk_bf16_f32 v85, v105, v109
  s_waitcnt vmcnt(15)
  v_mfma_f32_32x32x16_bf16 v[216:231], a[56:59], v[240:243], v[32:47]
  s_nop 0
  buffer_load_dwordx4 v255, s[72:75], s58 offen offset:1024 lds
  ds_write_b128 v197, v[76:79] offset:18432
  v_cvt_pk_bf16_f32 v88, v98, v102
  v_cvt_pk_bf16_f32 v89, v106, v110
  v_cvt_pk_bf16_f32 v92, v99, v103
  v_cvt_pk_bf16_f32 v93, v107, v111
  v_mfma_f32_32x32x16_bf16 v[96:111], a[88:91], v[240:243], v[32:47]
  s_waitcnt vmcnt(15)
  v_mfma_f32_32x32x16_bf16 v[216:231], a[60:63], v[244:247], v[216:231]
  s_nop 0
  buffer_load_dwordx4 v194, s[72:75], s58 offen offset:2048 lds
  v_cvt_pk_bf16_f32 v82, v48, v52
  v_cvt_pk_bf16_f32 v83, v56, v60
  v_cvt_pk_bf16_f32 v86, v49, v53
  v_cvt_pk_bf16_f32 v87, v57, v61
  ds_write_b128 v197, v[80:83] offset:1024
  v_mfma_f32_32x32x16_bf16 v[96:111], a[92:95], v[244:247], v[96:111]
  s_waitcnt vmcnt(15)
  v_mfma_f32_32x32x16_bf16 v[96:111], a[64:67], v[240:243], v[96:111]
  s_nop 0
  ds_write_b128 v197, v[84:87] offset:7168
  v_cvt_pk_bf16_f32 v90, v50, v54
  v_cvt_pk_bf16_f32 v91, v58, v62
  v_cvt_pk_bf16_f32 v94, v51, v55
  v_cvt_pk_bf16_f32 v95, v59, v63
  s_waitcnt vmcnt(14)
  v_mfma_f32_32x32x16_bf16 v[96:111], a[68:71], v[244:247], v[96:111]
  s_nop 0
  ds_write_b128 v197, v[88:91] offset:13312
  v_cvt_pk_bf16_f32 v64, v216, v220
  v_cvt_pk_bf16_f32 v65, v224, v228
  v_cvt_pk_bf16_f32 v68, v217, v221
  v_cvt_pk_bf16_f32 v69, v225, v229
  ds_write_b128 v197, v[92:95] offset:19456
  v_cvt_pk_bf16_f32 v72, v218, v222
  v_cvt_pk_bf16_f32 v73, v226, v230
  v_cvt_pk_bf16_f32 v76, v219, v223
  v_cvt_pk_bf16_f32 v77, v227, v231
  s_nop 1
  s_nop 0
  v_cvt_pk_bf16_f32 v66, v96, v100
  v_cvt_pk_bf16_f32 v67, v104, v108
  v_cvt_pk_bf16_f32 v70, v97, v101
  v_cvt_pk_bf16_f32 v71, v105, v109
  ds_write_b128 v197, v[64:67] offset:2048
  ds_write_b128 v197, v[68:71] offset:8192
  v_cvt_pk_bf16_f32 v74, v98, v102
  v_cvt_pk_bf16_f32 v75, v106, v110
  v_cvt_pk_bf16_f32 v78, v99, v103
  v_cvt_pk_bf16_f32 v79, v107, v111
  ds_write_b128 v197, v[72:75] offset:14336
  ds_write_b128 v197, v[76:79] offset:20480
  s_waitcnt lgkmcnt(0)
  s_barrier
  ds_read_b128 a[0:3], v0 offset:24576
  ds_read_b128 a[4:7], v0 offset:25600
  ds_read_b128 a[8:11], v0 offset:26624
  ds_read_b128 a[12:15], v0 offset:27648
  ds_read_b128 a[16:19], v0 offset:28672
  ds_read_b128 a[20:23], v0 offset:29696
  ds_read_b128 a[24:27], v0 offset:30720
  ds_read_b128 a[28:31], v0 offset:31744
  ds_read_b128 a[32:35], v0 offset:32768
  ds_read_b128 a[36:39], v0 offset:33792
  ds_read_b128 a[40:43], v0 offset:34816
  ds_read_b128 a[44:47], v0 offset:35840
  ds_read_b128 a[48:51], v0 offset:36864
  ds_read_b128 a[52:55], v0 offset:37888
  ds_read_b128 a[56:59], v0 offset:38912
  ds_read_b128 a[60:63], v0 offset:39936
  ds_read_b128 a[64:67], v0 offset:40960
  ds_read_b128 a[68:71], v0 offset:41984
  ds_read_b128 a[72:75], v0 offset:43008
  ds_read_b128 a[76:79], v0 offset:44032
  ds_read_b128 a[80:83], v0 offset:45056
  ds_read_b128 a[84:87], v0 offset:46080
  ds_read_b128 a[88:91], v0 offset:47104
  ds_read_b128 a[92:95], v0 offset:48128
  s_waitcnt vmcnt(6)
  s_nop 0
  ds_read_b128 v[216:219], v4
  ds_read_b128 v[220:223], v4 offset:16
  ds_read_b128 v[224:227], v4 offset:192
  ds_read_b128 v[228:231], v4 offset:208
  ds_read_b128 v[232:235], v4 offset:384
  ds_read_b128 v[236:239], v4 offset:400
  ds_read_b128 v[160:163], v4 offset:32
  ds_read_b128 v[164:167], v4 offset:48
  ds_read_b128 v[168:171], v4 offset:224
  ds_read_b128 v[172:175], v4 offset:240
  ds_read_b128 v[176:179], v4 offset:416
  s_waitcnt lgkmcnt(10)
  v_mfma_f32_16x16x32_bf16 v[112:115], a[96:99], v[216:219], 0
  s_waitcnt lgkmcnt(9)
  ds_read_b128 v[180:183], v4 offset:432
  v_mfma_f32_16x16x32_bf16 v[116:119], a[108:111], v[220:223], 0
  s_waitcnt lgkmcnt(9)
  ds_read_b128 v[216:219], v4 offset:64
  v_mfma_f32_16x16x32_bf16 v[112:115], a[100:103], v[224:227], v[112:115]
  s_waitcnt lgkmcnt(9)
  ds_read_b128 v[220:223], v4 offset:80
  v_mfma_f32_16x16x32_bf16 v[116:119], a[112:115], v[228:231], v[116:119]
  s_waitcnt lgkmcnt(9)
  ds_read_b128 v[224:227], v4 offset:256
  v_mfma_f32_16x16x32_bf16 v[112:115], a[104:107], v[232:235], v[112:115]
  s_waitcnt lgkmcnt(9)
  ds_read_b128 v[228:231], v4 offset:272
  v_mfma_f32_16x16x32_bf16 v[116:119], a[116:119], v[236:239], v[116:119]
  s_waitcnt lgkmcnt(9)
  ds_read_b128 v[232:235], v4 offset:448
  v_mfma_f32_16x16x32_bf16 v[120:123], a[120:123], v[160:163], 0
  s_waitcnt lgkmcnt(9)
  ds_read_b128 v[236:239], v4 offset:464
  v_mfma_f32_16x16x32_bf16 v[124:127], a[132:135], v[164:167], 0
  s_waitcnt lgkmcnt(9)
  ds_read_b128 v[160:163], v4 offset:96
  v_mfma_f32_16x16x32_bf16 v[120:123], a[124:127], v[168:171], v[120:123]
  s_waitcnt lgkmcnt(9)
  ds_read_b128 v[164:167], v4 offset:112
  v_mfma_f32_16x16x32_bf16 v[124:127], a[136:139], v[172:175], v[124:127]
  s_waitcnt lgkmcnt(9)
  ds_read_b128 v[168:171], v4 offset:288
  v_mfma_f32_16x16x32_bf16 v[120:123], a[128:131], v[176:179], v[120:123]
  s_waitcnt lgkmcnt(9)
  ds_read_b128 v[172:175], v4 offset:304
  v_mfma_f32_16x16x32_bf16 v[124:127], a[140:143], v[180:183], v[124:127]
  s_waitcnt lgkmcnt(9)
  ds_read_b128 v[176:179], v4 offset:480
  v_mfma_f32_16x16x32_bf16 v[128:131], a[144:147], v[216:219], 0
  s_waitcnt lgkmcnt(9)
  ds_read_b128 v[180:183], v4 offset:496
  v_mfma_f32_16x16x32_bf16 v[132:135], a[156:159], v[220:223], 0
  s_waitcnt lgkmcnt(9)
  ds_read_b128 v[216:219], v4 offset:128
  v_mfma_f32_16x16x32_bf16 v[128:131], a[148:151], v[224:227], v[128:131]
  s_waitcnt lgkmcnt(9)
  ds_read_b128 v[220:223], v4 offset:144
  v_mfma_f32_16x16x32_bf16 v[132:135], a[160:163], v[228:231], v[132:135]
  s_waitcnt lgkmcnt(9)
  ds_read_b128 v[224:227], v4 offset:320
  v_mfma_f32_16x16x32_bf16 v[128:131], a[152:155], v[232:235], v[128:131]
  s_waitcnt lgkmcnt(9)
  ds_read_b128 v[228:231], v4 offset:336
  v_mfma_f32_16x16x32_bf16 v[132:135], a[164:167], v[236:239], v[132:135]
  s_waitcnt lgkmcnt(9)
  ds_read_b128 v[232:235], v4 offset:512
  v_mfma_f32_16x16x32_bf16 v[136:139], a[240:243], v[160:163], 0
  s_waitcnt lgkmcnt(9)
  ds_read_b128 v[236:239], v4 offset:528
  v_mfma_f32_16x16x32_bf16 v[140:143], a[168:171], v[164:167], 0
  s_waitcnt lgkmcnt(9)
  ds_read_b128 v[160:163], v4 offset:160
  v_mfma_f32_16x16x32_bf16 v[136:139], a[244:247], v[168:171], v[136:139]
  s_waitcnt lgkmcnt(9)
  ds_read_b128 v[164:167], v4 offset:176
  v_mfma_f32_16x16x32_bf16 v[140:143], a[172:175], v[172:175], v[140:143]
  s_waitcnt lgkmcnt(9)
  ds_read_b128 v[168:171], v4 offset:352
  v_mfma_f32_16x16x32_bf16 v[136:139], a[248:251], v[176:179], v[136:139]
  s_waitcnt lgkmcnt(9)
  ds_read_b128 v[172:175], v4 offset:368
  v_mfma_f32_16x16x32_bf16 v[140:143], a[176:179], v[180:183], v[140:143]
  s_waitcnt lgkmcnt(9)
  ds_read_b128 v[176:179], v4 offset:544
  v_mfma_f32_16x16x32_bf16 v[144:147], a[252:255], v[216:219], 0
  s_waitcnt lgkmcnt(9)
  ds_read_b128 v[180:183], v4 offset:560
  v_mfma_f32_16x16x32_bf16 v[148:151], a[188:191], v[220:223], 0
  s_waitcnt lgkmcnt(9)
  v_mfma_f32_16x16x32_bf16 v[144:147], a[180:183], v[224:227], v[144:147]
  s_waitcnt lgkmcnt(8)
  v_mfma_f32_16x16x32_bf16 v[148:151], a[216:219], v[228:231], v[148:151]
  s_waitcnt lgkmcnt(7)
  v_mfma_f32_16x16x32_bf16 v[144:147], a[184:187], v[232:235], v[144:147]
  s_waitcnt lgkmcnt(6)
  v_mfma_f32_16x16x32_bf16 v[148:151], a[220:223], v[236:239], v[148:151]
  s_waitcnt lgkmcnt(5)
  v_mfma_f32_16x16x32_bf16 v[152:155], a[224:227], v[160:163], 0
  s_waitcnt lgkmcnt(4)
  v_mfma_f32_16x16x32_bf16 v[156:159], a[236:239], v[164:167], 0
  s_waitcnt lgkmcnt(3)
  v_mfma_f32_16x16x32_bf16 v[152:155], a[228:231], v[168:171], v[152:155]
  s_waitcnt lgkmcnt(2)
  v_mfma_f32_16x16x32_bf16 v[156:159], v[208:211], v[172:175], v[156:159]
  s_waitcnt lgkmcnt(1)
  v_mfma_f32_16x16x32_bf16 v[152:155], a[232:235], v[176:179], v[152:155]
  s_waitcnt lgkmcnt(0)
  v_mfma_f32_16x16x32_bf16 v[156:159], v[212:215], v[180:183], v[156:159]
  buffer_load_dword v249, v248, s[4:7], s29 offen
  v_pk_add_f32 v[12:13], v[112:113], v[114:115]
  v_pk_mul_f32 v[14:15], v[112:113], v[112:113]
  v_pk_fma_f32 v[14:15], v[114:115], v[114:115], v[14:15]
  v_pk_add_f32 v[12:13], v[12:13], v[116:117]
  v_pk_fma_f32 v[14:15], v[116:117], v[116:117], v[14:15]
  v_pk_add_f32 v[12:13], v[12:13], v[118:119]
  v_pk_fma_f32 v[14:15], v[118:119], v[118:119], v[14:15]
  v_pk_add_f32 v[12:13], v[12:13], v[120:121]
  v_pk_fma_f32 v[14:15], v[120:121], v[120:121], v[14:15]
  v_pk_add_f32 v[12:13], v[12:13], v[122:123]
  v_pk_fma_f32 v[14:15], v[122:123], v[122:123], v[14:15]
  v_pk_add_f32 v[12:13], v[12:13], v[124:125]
  ds_read_b128 v[216:219], v0 offset:18432
  ds_read_b128 v[220:223], v0 offset:19456
  ds_read_b128 v[224:227], v0 offset:20480
  ds_read_b128 v[228:231], v0 offset:21504
  v_pk_fma_f32 v[14:15], v[124:125], v[124:125], v[14:15]
  v_pk_add_f32 v[12:13], v[12:13], v[126:127]
  v_pk_fma_f32 v[14:15], v[126:127], v[126:127], v[14:15]
  v_pk_add_f32 v[12:13], v[12:13], v[128:129]
  v_pk_fma_f32 v[14:15], v[128:129], v[128:129], v[14:15]
  v_pk_add_f32 v[12:13], v[12:13], v[130:131]
  v_pk_fma_f32 v[14:15], v[130:131], v[130:131], v[14:15]
  v_pk_add_f32 v[12:13], v[12:13], v[132:133]
  v_pk_fma_f32 v[14:15], v[132:133], v[132:133], v[14:15]
  v_pk_add_f32 v[12:13], v[12:13], v[134:135]
  v_pk_fma_f32 v[14:15], v[134:135], v[134:135], v[14:15]
  v_pk_add_f32 v[12:13], v[12:13], v[136:137]
  ds_read_b128 v[232:235], v0 offset:22528
  ds_read_b128 v[236:239], v0 offset:23552
  ds_read_b128 a[96:99], v0 offset:49152
  ds_read_b128 a[100:103], v0 offset:50176
  v_pk_fma_f32 v[14:15], v[136:137], v[136:137], v[14:15]
  v_pk_add_f32 v[12:13], v[12:13], v[138:139]
  v_pk_fma_f32 v[14:15], v[138:139], v[138:139], v[14:15]
  v_pk_add_f32 v[12:13], v[12:13], v[140:141]
  v_pk_fma_f32 v[14:15], v[140:141], v[140:141], v[14:15]
  v_pk_add_f32 v[12:13], v[12:13], v[142:143]
  v_pk_fma_f32 v[14:15], v[142:143], v[142:143], v[14:15]
  v_pk_add_f32 v[12:13], v[12:13], v[144:145]
  v_pk_fma_f32 v[14:15], v[144:145], v[144:145], v[14:15]
  v_pk_add_f32 v[12:13], v[12:13], v[146:147]
  v_pk_fma_f32 v[14:15], v[146:147], v[146:147], v[14:15]
  v_pk_add_f32 v[12:13], v[12:13], v[148:149]
  ds_read_b128 a[104:107], v0 offset:51200
  ds_read_b128 a[108:111], v0 offset:52224
  ds_read_b128 a[112:115], v0 offset:53248
  ds_read_b128 a[116:119], v0 offset:54272
  v_pk_fma_f32 v[14:15], v[148:149], v[148:149], v[14:15]
  v_pk_add_f32 v[12:13], v[12:13], v[150:151]
  v_pk_fma_f32 v[14:15], v[150:151], v[150:151], v[14:15]
  v_pk_add_f32 v[12:13], v[12:13], v[152:153]
  v_pk_fma_f32 v[14:15], v[152:153], v[152:153], v[14:15]
  v_pk_add_f32 v[12:13], v[12:13], v[154:155]
  v_pk_fma_f32 v[14:15], v[154:155], v[154:155], v[14:15]
  v_pk_add_f32 v[12:13], v[12:13], v[156:157]
  v_pk_fma_f32 v[14:15], v[156:157], v[156:157], v[14:15]
  v_pk_add_f32 v[12:13], v[12:13], v[158:159]
  v_pk_fma_f32 v[14:15], v[158:159], v[158:159], v[14:15]
  v_add_f32_e64 v12, v12, v13
  ds_read_b128 a[120:123], v0 offset:55296
  ds_read_b128 a[124:127], v0 offset:56320
  ds_read_b128 a[128:131], v0 offset:57344
  ds_read_b128 a[132:135], v0 offset:58368
  v_add_f32 v14, v14, v15
  s_nop 1
  v_permlane32_swap_b32 v12, v14
  v_add_f32 v12, v12, v14
  v_mov_b32 v14, v12
  s_nop 1
  v_permlane32_swap_b32 v12, v14
  v_mul_f32 v12, s24, v12
  v_mul_f32 v13, s24, v14
  v_fma_f32 v13, -v12, v12, v13
  v_max_f32 v13, 0, v13
  v_add_f32 v13, s25, v13
  v_rsq_f32 v13, v13
  s_nop 0
  v_mul_f32 v14, s22, v13
  ds_read_b128 a[136:139], v0 offset:59392
  ds_read_b128 a[140:143], v0 offset:60416
  ds_read_b128 a[144:147], v0 offset:61440
  ds_read_b128 a[148:151], v0 offset:62464
  v_mul_f32_e64 v12, -v12, v14
  v_pk_fma_f32 v[112:113], v[112:113], v[14:15], v[12:13] op_sel_hi:[1,0,0]
  v_pk_fma_f32 v[114:115], v[114:115], v[14:15], v[12:13] op_sel_hi:[1,0,0]
  v_pk_fma_f32 v[116:117], v[116:117], v[14:15], v[12:13] op_sel_hi:[1,0,0]
  v_pk_fma_f32 v[118:119], v[118:119], v[14:15], v[12:13] op_sel_hi:[1,0,0]
  v_pk_fma_f32 v[120:121], v[120:121], v[14:15], v[12:13] op_sel_hi:[1,0,0]
  v_pk_fma_f32 v[122:123], v[122:123], v[14:15], v[12:13] op_sel_hi:[1,0,0]
  v_pk_fma_f32 v[124:125], v[124:125], v[14:15], v[12:13] op_sel_hi:[1,0,0]
  v_pk_fma_f32 v[126:127], v[126:127], v[14:15], v[12:13] op_sel_hi:[1,0,0]
  v_pk_fma_f32 v[128:129], v[128:129], v[14:15], v[12:13] op_sel_hi:[1,0,0]
  v_pk_fma_f32 v[130:131], v[130:131], v[14:15], v[12:13] op_sel_hi:[1,0,0]
  v_pk_fma_f32 v[132:133], v[132:133], v[14:15], v[12:13] op_sel_hi:[1,0,0]
  ds_read_b128 a[152:155], v0 offset:63488
  ds_read_b128 a[156:159], v0 offset:64512
  ds_read_b128 a[160:163], v1
  ds_read_b128 a[164:167], v1 offset:1024
  v_pk_fma_f32 v[134:135], v[134:135], v[14:15], v[12:13] op_sel_hi:[1,0,0]
  v_pk_fma_f32 v[136:137], v[136:137], v[14:15], v[12:13] op_sel_hi:[1,0,0]
  v_pk_fma_f32 v[138:139], v[138:139], v[14:15], v[12:13] op_sel_hi:[1,0,0]
  v_pk_fma_f32 v[140:141], v[140:141], v[14:15], v[12:13] op_sel_hi:[1,0,0]
  v_pk_fma_f32 v[142:143], v[142:143], v[14:15], v[12:13] op_sel_hi:[1,0,0]
  v_pk_fma_f32 v[144:145], v[144:145], v[14:15], v[12:13] op_sel_hi:[1,0,0]
  v_pk_fma_f32 v[146:147], v[146:147], v[14:15], v[12:13] op_sel_hi:[1,0,0]
  v_pk_fma_f32 v[148:149], v[148:149], v[14:15], v[12:13] op_sel_hi:[1,0,0]
  v_pk_fma_f32 v[150:151], v[150:151], v[14:15], v[12:13] op_sel_hi:[1,0,0]
  v_pk_fma_f32 v[152:153], v[152:153], v[14:15], v[12:13] op_sel_hi:[1,0,0]
  v_pk_fma_f32 v[154:155], v[154:155], v[14:15], v[12:13] op_sel_hi:[1,0,0]
  v_pk_fma_f32 v[156:157], v[156:157], v[14:15], v[12:13] op_sel_hi:[1,0,0]
  ds_read_b128 a[168:171], v1 offset:2048
  ds_read_b128 a[172:175], v1 offset:3072
  ds_read_b128 a[176:179], v1 offset:4096
  ds_read_b128 a[180:183], v1 offset:5120
  v_pk_fma_f32 v[158:159], v[158:159], v[14:15], v[12:13] op_sel_hi:[1,0,0]
  v_cndmask_b32 v159, v159, v250, s[12:13]
  v_cvt_pk_bf16_f32 v160, v112, v113
  v_cvt_pk_bf16_f32 v161, v114, v115
  v_cvt_pk_bf16_f32 v162, v116, v117
  v_cvt_pk_bf16_f32 v163, v118, v119
  v_cvt_pk_bf16_f32 v164, v120, v121
  v_cvt_pk_bf16_f32 v165, v122, v123
  v_cvt_pk_bf16_f32 v166, v124, v125
  v_cvt_pk_bf16_f32 v167, v126, v127
  v_cvt_pk_bf16_f32 v168, v128, v129
  v_cvt_pk_bf16_f32 v169, v130, v131
  ds_read_b128 a[184:187], v1 offset:6144
  ds_read_b128 a[188:191], v1 offset:7168
  v_cvt_pk_bf16_f32 v170, v132, v133
  v_cvt_pk_bf16_f32 v171, v134, v135
  v_cvt_pk_bf16_f32 v172, v136, v137
  v_cvt_pk_bf16_f32 v173, v138, v139
  v_cvt_pk_bf16_f32 v174, v140, v141
  v_cvt_pk_bf16_f32 v175, v142, v143
  v_cvt_pk_bf16_f32 v176, v144, v145
  v_cvt_pk_bf16_f32 v177, v146, v147
  v_cvt_pk_bf16_f32 v178, v148, v149
  v_cvt_pk_bf16_f32 v179, v150, v151
  v_cvt_pk_bf16_f32 v180, v152, v153
  v_cvt_pk_bf16_f32 v181, v154, v155
  v_cvt_pk_bf16_f32 v182, v156, v157
  v_cvt_pk_bf16_f32 v183, v158, v159
  s_waitcnt lgkmcnt(15)
  v_mfma_f32_32x32x16_bf16 v[16:31], v[216:219], v[160:163], 0
  s_nop 0
  ds_read_b128 v[136:139], v5
  ds_read_b128 v[140:143], v5 offset:32
  ds_read_b128 v[144:147], v5 offset:64
  v_mfma_f32_32x32x16_bf16 v[16:31], v[220:223], v[164:167], v[16:31]
  ds_read_b128 v[148:151], v5 offset:96
  ds_read_b128 v[152:155], v5 offset:128
  ds_read_b128 v[156:159], v5 offset:160
  v_mfma_f32_32x32x16_bf16 v[16:31], v[224:227], v[168:171], v[16:31]
  s_waitcnt vmcnt(1)
  ds_read_b128 a[216:219], v251 offset:49152
  ds_read_b128 a[220:223], v252 offset:49152
  v_mfma_f32_32x32x16_bf16 v[16:31], v[228:231], v[172:175], v[16:31]
  s_nop 0
  ds_read_b128 a[224:227], v251 offset:49216
  ds_read_b128 a[228:231], v252 offset:49216
  ds_read_b128 a[232:235], v251 offset:49280
  v_mfma_f32_32x32x16_bf16 v[16:31], v[232:235], v[176:179], v[16:31]
  s_nop 0
  ds_read_b128 a[236:239], v252 offset:49280
  v_mfma_f32_32x32x16_bf16 v[16:31], v[236:239], v[180:183], v[16:31]
  s_nop 11
  v_pk_fma_f32 v[48:49], v[16:17], v[16:17], s[20:21] neg_lo:[1,0,1] neg_hi:[1,0,1]
  v_pk_fma_f32 v[50:51], v[18:19], v[18:19], s[20:21] neg_lo:[1,0,1] neg_hi:[1,0,1]
  v_pk_fma_f32 v[52:53], v[20:21], v[20:21], s[20:21] neg_lo:[1,0,1] neg_hi:[1,0,1]
  v_pk_fma_f32 v[54:55], v[22:23], v[22:23], s[20:21] neg_lo:[1,0,1] neg_hi:[1,0,1]
  v_pk_fma_f32 v[56:57], v[24:25], v[24:25], s[20:21] neg_lo:[1,0,1] neg_hi:[1,0,1]
  v_pk_fma_f32 v[58:59], v[26:27], v[26:27], s[20:21] neg_lo:[1,0,1] neg_hi:[1,0,1]
  v_pk_fma_f32 v[60:61], v[28:29], v[28:29], s[20:21] neg_lo:[1,0,1] neg_hi:[1,0,1]
  v_pk_fma_f32 v[62:63], v[30:31], v[30:31], s[20:21] neg_lo:[1,0,1] neg_hi:[1,0,1]
  v_pk_mul_f32 v[48:49], v[16:17], v[48:49]
  v_pk_mul_f32 v[50:51], v[18:19], v[50:51]
  v_pk_mul_f32 v[52:53], v[20:21], v[52:53]
  v_pk_mul_f32 v[54:55], v[22:23], v[54:55]
  v_pk_mul_f32 v[56:57], v[24:25], v[56:57]
  v_pk_mul_f32 v[58:59], v[26:27], v[58:59]
  v_pk_mul_f32 v[60:61], v[28:29], v[60:61]
  v_pk_mul_f32 v[62:63], v[30:31], v[62:63]
  s_waitcnt lgkmcnt(5)
  v_mfma_f32_32x32x16_bf16 v[64:79], a[216:219], a[192:195], 0
  s_mov_b32 m0, s30
  v_exp_f32 v48, v48
  v_exp_f32 v49, v49
  v_exp_f32 v50, v50
  v_exp_f32 v51, v51
  v_exp_f32 v52, v52
  s_waitcnt lgkmcnt(4)
  v_mfma_f32_32x32x16_bf16 v[64:79], a[220:223], a[196:199], v[64:79]
  buffer_load_dwordx4 v6, s[4:7], s29 offen lds
  v_exp_f32 v53, v53
  s_waitcnt lgkmcnt(3)
  v_mfma_f32_32x32x16_bf16 v[80:95], a[224:227], a[200:203], 0
  buffer_load_dwordx4 v7, s[4:7], s29 offen offset:1024 lds
  s_waitcnt lgkmcnt(2)
  v_mfma_f32_32x32x16_bf16 v[80:95], a[228:231], a[204:207], v[80:95]
  buffer_load_dwordx4 v8, s[4:7], s29 offen offset:2048 lds
  s_nop 3
  v_cvt_pk_bf16_f32 v64, v64, v65
  v_cvt_pk_bf16_f32 v65, v66, v67
  v_cvt_pk_bf16_f32 v66, v68, v69
  v_cvt_pk_bf16_f32 v67, v70, v71
  ds_write_b128 v253, v[64:67] offset:49152
  v_exp_f32 v54, v54
  v_exp_f32 v55, v55
  v_cvt_pk_bf16_f32 v68, v72, v73
  v_cvt_pk_bf16_f32 v69, v74, v75
  v_cvt_pk_bf16_f32 v70, v76, v77
  s_waitcnt lgkmcnt(2)
  v_mfma_f32_32x32x16_bf16 v[96:111], a[232:235], a[208:211], 0
  s_nop 0
  buffer_load_dwordx4 v9, s[4:7], s29 offen offset:3072 lds
  v_cvt_pk_bf16_f32 v71, v78, v79
  v_exp_f32_e64 v56, v56
  v_exp_f32 v57, v57
  ds_write_b128 v253, v[68:71] offset:52224
  s_waitcnt lgkmcnt(2)
  v_mfma_f32_32x32x16_bf16 v[96:111], a[236:239], a[212:215], v[96:111]
  v_cvt_pk_bf16_f32 v80, v80, v81
  v_cvt_pk_bf16_f32 v81, v82, v83
  v_cvt_pk_bf16_f32 v82, v84, v85
  v_cvt_pk_bf16_f32 v83, v86, v87
  v_exp_f32 v58, v58
  v_exp_f32 v59, v59
  ds_write_b128 v253, v[80:83] offset:50176
  v_cvt_pk_bf16_f32 v84, v88, v89
  v_cvt_pk_bf16_f32 v85, v90, v91
  v_cvt_pk_bf16_f32 v86, v92, v93
  v_cvt_pk_bf16_f32 v87, v94, v95
  v_exp_f32 v60, v60
  v_exp_f32 v61, v61
  ds_write_b128 v253, v[84:87] offset:53248
  v_cvt_pk_bf16_f32 v96, v96, v97
  v_cvt_pk_bf16_f32 v97, v98, v99
  v_cvt_pk_bf16_f32 v98, v100, v101
  v_cvt_pk_bf16_f32 v99, v102, v103
  v_exp_f32 v62, v62
  v_exp_f32 v63, v63
  v_cvt_pk_bf16_f32 v100, v104, v105
  v_cvt_pk_bf16_f32 v101, v106, v107
  v_cvt_pk_bf16_f32 v102, v108, v109
  v_cvt_pk_bf16_f32 v103, v110, v111
  ds_write_b128 v253, v[96:99] offset:51200
  v_pk_fma_f32 v[48:49], v[48:49], s[22:23], s[22:23]
  v_pk_fma_f32 v[50:51], v[50:51], s[22:23], s[22:23]
  v_pk_fma_f32 v[52:53], v[52:53], s[22:23], s[22:23]
  v_pk_fma_f32 v[54:55], v[54:55], s[22:23], s[22:23]
  v_pk_fma_f32 v[56:57], v[56:57], s[22:23], s[22:23]
  v_pk_fma_f32 v[58:59], v[58:59], s[22:23], s[22:23]
  v_pk_fma_f32 v[60:61], v[60:61], s[22:23], s[22:23]
  v_pk_fma_f32 v[62:63], v[62:63], s[22:23], s[22:23]
  ds_write_b128 v253, v[100:103] offset:54272
  s_waitcnt lgkmcnt(0)
  s_barrier
  v_mfma_f32_32x32x16_bf16 v[32:47], a[0:3], v[160:163], 0
  ds_read_b128 v[64:67], v2
  ds_read_b128 v[68:71], v2 offset:32
  ds_read_b128 v[72:75], v2 offset:64
  s_add_u32 m0, s14, 0x16000
  v_rcp_f32_e64 v48, v48
  v_mfma_f32_32x32x16_bf16 v[32:47], a[4:7], v[164:167], v[32:47]
  ds_read_b128 v[76:79], v2 offset:96
  ds_read_b128 v[80:83], v2 offset:128
  ds_read_b128 v[84:87], v2 offset:160
  buffer_load_dwordx4 v254, s[72:75], s53 offen lds
  v_rcp_f32_e64 v49, v49
  v_mfma_f32_32x32x16_bf16 v[32:47], a[8:11], v[168:171], v[32:47]
  ds_read_b128 v[88:91], v2 offset:192
  ds_read_b128 v[92:95], v2 offset:224
  ds_read_b128 v[96:99], v2 offset:256
  buffer_load_dwordx4 v255, s[72:75], s53 offen offset:1024 lds
  v_rcp_f32_e64 v50, v50
  v_mfma_f32_32x32x16_bf16 v[32:47], a[12:15], v[172:175], v[32:47]
  ds_read_b128 v[100:103], v2 offset:288
  ds_read_b128 v[104:107], v2 offset:320
  ds_read_b128 v[108:111], v2 offset:352
  v_rcp_f32_e64 v51, v51
  v_mfma_f32_32x32x16_bf16 v[32:47], a[16:19], v[176:179], v[32:47]
  buffer_load_dwordx4 v194, s[72:75], s53 offen offset:2048 lds
  s_add_u32 m0, s14, 0x16c00
  v_rcp_f32 v52, v52
  v_rcp_f32 v53, v53
  v_mfma_f32_32x32x16_bf16 v[32:47], a[20:23], v[180:183], v[32:47]
  s_waitcnt lgkmcnt(0)
  buffer_load_dwordx4 v254, s[72:75], s54 offen lds
  v_rcp_f32 v54, v54
  v_rcp_f32_e64 v55, v55
  v_mfma_f32_32x32x16_bf16 v[64:79], v[240:243], v[136:139], v[64:79]
  v_mov_b32 v112, v194
  v_rcp_f32 v56, v56
  v_rcp_f32_e64 v57, v57
  v_mfma_f32_32x32x16_bf16 v[64:79], v[244:247], v[140:143], v[64:79]
  buffer_load_dwordx4 v255, s[72:75], s54 offen offset:1024 lds
  v_rcp_f32 v58, v58
  v_rcp_f32 v59, v59
  v_mfma_f32_32x32x16_bf16 v[80:95], v[240:243], v[144:147], v[80:95]
  buffer_load_dwordx4 v194, s[72:75], s54 offen offset:2048 lds
  v_rcp_f32_e64 v60, v60
  v_rcp_f32_e64 v61, v61
  v_mfma_f32_32x32x16_bf16 v[80:95], v[244:247], v[148:151], v[80:95]
  ds_read_b128 v[192:195], v1 offset:8192
  ds_read_b128 v[196:199], v1 offset:9216
  v_rcp_f32_e64 v62, v62
  v_rcp_f32_e64 v63, v63
  v_mfma_f32_32x32x16_bf16 v[96:111], v[240:243], v[152:155], v[96:111]
  s_nop 0
  ds_read_b128 v[200:203], v1 offset:10240
  ds_read_b128 v[204:207], v1 offset:11264
  v_mfma_f32_32x32x16_bf16 v[96:111], v[244:247], v[156:159], v[96:111]
  s_waitcnt lgkmcnt(0)
  ds_read_b128 v[208:211], v1 offset:12288
  ds_read_b128 v[212:215], v1 offset:13312
  v_pk_mul_f32 v[16:17], v[16:17], v[48:49]
  v_pk_mul_f32 v[18:19], v[18:19], v[50:51]
  v_pk_mul_f32 v[20:21], v[20:21], v[52:53]
  v_pk_mul_f32 v[22:23], v[22:23], v[54:55]
  v_pk_mul_f32 v[24:25], v[24:25], v[56:57]
  v_pk_mul_f32 v[26:27], v[26:27], v[58:59]
  v_pk_mul_f32 v[28:29], v[28:29], v[60:61]
  v_pk_mul_f32 v[30:31], v[30:31], v[62:63]
  v_pk_fma_f32 v[48:49], v[32:33], v[32:33], s[20:21] neg_lo:[1,0,1] neg_hi:[1,0,1]
  v_pk_fma_f32 v[50:51], v[34:35], v[34:35], s[20:21] neg_lo:[1,0,1] neg_hi:[1,0,1]
  v_pk_fma_f32 v[52:53], v[36:37], v[36:37], s[20:21] neg_lo:[1,0,1] neg_hi:[1,0,1]
  v_pk_fma_f32 v[54:55], v[38:39], v[38:39], s[20:21] neg_lo:[1,0,1] neg_hi:[1,0,1]
  v_pk_fma_f32 v[56:57], v[40:41], v[40:41], s[20:21] neg_lo:[1,0,1] neg_hi:[1,0,1]
  v_pk_fma_f32 v[58:59], v[42:43], v[42:43], s[20:21] neg_lo:[1,0,1] neg_hi:[1,0,1]
  v_pk_fma_f32 v[60:61], v[44:45], v[44:45], s[20:21] neg_lo:[1,0,1] neg_hi:[1,0,1]
  v_pk_fma_f32 v[62:63], v[46:47], v[46:47], s[20:21] neg_lo:[1,0,1] neg_hi:[1,0,1]
  v_pk_mul_f32 v[48:49], v[32:33], v[48:49]
  v_pk_mul_f32 v[50:51], v[34:35], v[50:51]
  v_pk_mul_f32 v[52:53], v[36:37], v[52:53]
  v_pk_mul_f32 v[54:55], v[38:39], v[54:55]
  v_pk_mul_f32 v[56:57], v[40:41], v[56:57]
  v_cvt_pk_bf16_f32 v184, v16, v17
  v_cvt_pk_bf16_f32 v185, v18, v19
  v_cvt_pk_bf16_f32 v186, v20, v21
  v_cvt_pk_bf16_f32 v187, v22, v23
  v_pk_mul_f32 v[58:59], v[42:43], v[58:59]
  v_pk_mul_f32 v[60:61], v[44:45], v[60:61]
  v_pk_mul_f32 v[62:63], v[46:47], v[62:63]
  v_mfma_f32_32x32x16_bf16 v[64:79], v[192:195], v[184:187], v[64:79]
  s_mov_b32 m0, s31
  v_cvt_pk_bf16_f32 v188, v24, v25
  v_cvt_pk_bf16_f32 v189, v26, v27
  v_cvt_pk_bf16_f32 v190, v28, v29
  v_cvt_pk_bf16_f32 v191, v30, v31
  v_exp_f32 v48, v48
  v_mfma_f32_32x32x16_bf16 v[80:95], v[196:199], v[184:187], v[80:95]
  buffer_load_dwordx4 v6, s[4:7], s52 offen lds
  v_exp_f32 v49, v49
  v_exp_f32 v50, v50
  v_exp_f32_e64 v51, v51
  v_mfma_f32_32x32x16_bf16 v[96:111], v[200:203], v[184:187], v[96:111]
  buffer_load_dwordx4 v7, s[4:7], s52 offen offset:1024 lds
  v_exp_f32 v52, v52
  v_exp_f32 v53, v53
  v_mfma_f32_32x32x16_bf16 v[64:79], v[204:207], v[188:191], v[64:79]
  buffer_load_dwordx4 v8, s[4:7], s52 offen offset:2048 lds
  v_exp_f32 v54, v54
  v_exp_f32 v55, v55
  v_exp_f32 v56, v56
  s_waitcnt lgkmcnt(1)
  v_mfma_f32_32x32x16_bf16 v[80:95], v[208:211], v[188:191], v[80:95]
  buffer_load_dwordx4 v9, s[4:7], s52 offen offset:3072 lds
  v_exp_f32 v57, v57
  v_exp_f32 v58, v58
  s_waitcnt lgkmcnt(0)
  v_mfma_f32_32x32x16_bf16 v[96:111], v[212:215], v[188:191], v[96:111]
  v_exp_f32 v59, v59
  v_exp_f32 v60, v60
  v_exp_f32 v61, v61
  v_exp_f32 v62, v62
  v_exp_f32 v63, v63
  v_pk_fma_f32 v[48:49], v[48:49], s[22:23], s[22:23]
  v_pk_fma_f32 v[50:51], v[50:51], s[22:23], s[22:23]
  v_pk_fma_f32 v[52:53], v[52:53], s[22:23], s[22:23]
  v_pk_fma_f32 v[54:55], v[54:55], s[22:23], s[22:23]
  v_pk_fma_f32 v[56:57], v[56:57], s[22:23], s[22:23]
  v_pk_fma_f32 v[58:59], v[58:59], s[22:23], s[22:23]
  v_pk_fma_f32 v[60:61], v[60:61], s[22:23], s[22:23]
  v_pk_fma_f32 v[62:63], v[62:63], s[22:23], s[22:23]
  v_mfma_f32_32x32x16_bf16 v[16:31], a[24:27], v[160:163], 0
  ds_read_b128 v[192:195], v1 offset:14336
  ds_read_b128 v[196:199], v1 offset:15360
  s_add_u32 m0, s14, 0x1c000
  v_rcp_f32 v48, v48
  v_rcp_f32 v49, v49
  v_mfma_f32_32x32x16_bf16 v[16:31], a[28:31], v[164:167], v[16:31]
  ds_read_b128 v[200:203], v1 offset:16384
  ds_read_b128 v[204:207], v1 offset:17408
  buffer_load_dwordx4 v254, s[72:75], s55 offen lds
  v_rcp_f32 v50, v50
  v_rcp_f32 v51, v51
  v_mfma_f32_32x32x16_bf16 v[16:31], a[32:35], v[168:171], v[16:31]
  ds_read_b128 v[208:211], v1 offset:18432
  ds_read_b128 v[212:215], v1 offset:19456
  v_rcp_f32 v52, v52
  v_rcp_f32 v53, v53
  v_mfma_f32_32x32x16_bf16 v[16:31], a[36:39], v[172:175], v[16:31]
  buffer_load_dwordx4 v255, s[72:75], s55 offen offset:1024 lds
  v_rcp_f32 v54, v54
  v_rcp_f32 v55, v55
  v_rcp_f32_e64 v56, v56
  v_mfma_f32_32x32x16_bf16 v[16:31], a[40:43], v[176:179], v[16:31]
  v_rcp_f32 v57, v57
  v_rcp_f32 v58, v58
  v_rcp_f32 v59, v59
  v_mfma_f32_32x32x16_bf16 v[16:31], a[44:47], v[180:183], v[16:31]
  s_waitcnt lgkmcnt(0)
  buffer_load_dwordx4 v112, s[72:75], s55 offen offset:2048 lds
  v_rcp_f32 v60, v60
  v_rcp_f32 v61, v61
  v_rcp_f32 v62, v62
  v_rcp_f32 v63, v63
  v_pk_mul_f32 v[32:33], v[32:33], v[48:49]
  v_pk_mul_f32 v[34:35], v[34:35], v[50:51]
  v_pk_mul_f32 v[36:37], v[36:37], v[52:53]
  v_pk_mul_f32 v[38:39], v[38:39], v[54:55]
  v_pk_mul_f32 v[40:41], v[40:41], v[56:57]
  v_pk_mul_f32 v[42:43], v[42:43], v[58:59]
  v_pk_mul_f32 v[44:45], v[44:45], v[60:61]
  v_pk_mul_f32 v[46:47], v[46:47], v[62:63]
  v_pk_fma_f32 v[48:49], v[16:17], v[16:17], s[20:21] neg_lo:[1,0,1] neg_hi:[1,0,1]
  v_pk_fma_f32 v[50:51], v[18:19], v[18:19], s[20:21] neg_lo:[1,0,1] neg_hi:[1,0,1]
  v_pk_fma_f32 v[52:53], v[20:21], v[20:21], s[20:21] neg_lo:[1,0,1] neg_hi:[1,0,1]
  v_pk_fma_f32 v[54:55], v[22:23], v[22:23], s[20:21] neg_lo:[1,0,1] neg_hi:[1,0,1]
  v_pk_fma_f32 v[56:57], v[24:25], v[24:25], s[20:21] neg_lo:[1,0,1] neg_hi:[1,0,1]
  v_pk_fma_f32 v[58:59], v[26:27], v[26:27], s[20:21] neg_lo:[1,0,1] neg_hi:[1,0,1]
  v_pk_fma_f32 v[60:61], v[28:29], v[28:29], s[20:21] neg_lo:[1,0,1] neg_hi:[1,0,1]
  v_pk_fma_f32 v[62:63], v[30:31], v[30:31], s[20:21] neg_lo:[1,0,1] neg_hi:[1,0,1]
  v_pk_mul_f32 v[48:49], v[16:17], v[48:49]
  v_pk_mul_f32 v[50:51], v[18:19], v[50:51]
  v_pk_mul_f32 v[52:53], v[20:21], v[52:53]
  v_pk_mul_f32 v[54:55], v[22:23], v[54:55]
  v_pk_mul_f32 v[56:57], v[24:25], v[56:57]
  v_cvt_pk_bf16_f32 v184, v32, v33
  v_cvt_pk_bf16_f32 v185, v34, v35
  v_cvt_pk_bf16_f32 v186, v36, v37
  v_cvt_pk_bf16_f32 v187, v38, v39
  v_pk_mul_f32 v[58:59], v[26:27], v[58:59]
  v_pk_mul_f32 v[60:61], v[28:29], v[60:61]
  v_pk_mul_f32 v[62:63], v[30:31], v[62:63]
  v_mfma_f32_32x32x16_bf16 v[64:79], v[192:195], v[184:187], v[64:79]
  s_add_u32 m0, s14, 0x1cc00
  v_cvt_pk_bf16_f32 v188, v40, v41
  v_cvt_pk_bf16_f32 v189, v42, v43
  v_cvt_pk_bf16_f32 v190, v44, v45
  v_cvt_pk_bf16_f32 v191, v46, v47
  v_exp_f32_e64 v48, v48
  v_mfma_f32_32x32x16_bf16 v[80:95], v[196:199], v[184:187], v[80:95]
  buffer_load_dwordx4 v254, s[72:75], s56 offen lds
  v_exp_f32 v49, v49
  v_exp_f32 v50, v50
  v_exp_f32 v51, v51
  v_mfma_f32_32x32x16_bf16 v[96:111], v[200:203], v[184:187], v[96:111]
  s_waitcnt vmcnt(8)
  ds_read_b128 a[216:219], v251
  ds_read_b128 a[220:223], v252
  ds_read_b128 a[224:227], v251 offset:64
  v_exp_f32 v52, v52
  v_exp_f32 v53, v53
  v_mfma_f32_32x32x16_bf16 v[64:79], v[204:207], v[188:191], v[64:79]
  ds_read_b128 a[228:231], v252 offset:64
  ds_read_b128 a[232:235], v251 offset:128
  ds_read_b128 a[236:239], v252 offset:128
  buffer_load_dwordx4 v255, s[72:75], s56 offen offset:1024 lds
  v_subrev_u32 v11, 0x4100, v5
  v_exp_f32_e64 v54, v54
  v_mfma_f32_32x32x16_bf16 v[80:95], v[208:211], v[188:191], v[80:95]
  v_exp_f32 v55, v55
  v_exp_f32 v56, v56
  v_exp_f32_e64 v57, v57
  v_exp_f32 v58, v58
  v_mfma_f32_32x32x16_bf16 v[96:111], v[212:215], v[188:191], v[96:111]
  s_waitcnt lgkmcnt(0)
  buffer_load_dwordx4 v112, s[72:75], s56 offen offset:2048 lds
  v_add_u32 v5, 0x8200, v5
  v_exp_f32 v59, v59
  v_exp_f32 v60, v60
  v_exp_f32 v61, v61
  v_exp_f32 v62, v62
  v_exp_f32 v63, v63
  v_min_u32 v5, v11, v5
  v_pk_fma_f32 v[48:49], v[48:49], s[22:23], s[22:23]
  v_pk_fma_f32 v[50:51], v[50:51], s[22:23], s[22:23]
  v_pk_fma_f32 v[52:53], v[52:53], s[22:23], s[22:23]
  v_pk_fma_f32 v[54:55], v[54:55], s[22:23], s[22:23]
  v_pk_fma_f32 v[56:57], v[56:57], s[22:23], s[22:23]
  v_pk_fma_f32 v[58:59], v[58:59], s[22:23], s[22:23]
  v_pk_fma_f32 v[60:61], v[60:61], s[22:23], s[22:23]
  v_pk_fma_f32 v[62:63], v[62:63], s[22:23], s[22:23]
  v_mfma_f32_32x32x16_bf16 v[112:127], a[216:219], a[192:195], 0
  ds_read_b128 v[192:195], v1 offset:20480
  ds_read_b128 v[196:199], v1 offset:21504
  v_rcp_f32 v48, v48
  v_rcp_f32 v49, v49
  v_mfma_f32_32x32x16_bf16 v[112:127], a[220:223], a[196:199], v[112:127]
  ds_read_b128 v[200:203], v1 offset:22528
  ds_read_b128 v[204:207], v1 offset:23552
  v_rcp_f32 v50, v50
  v_rcp_f32 v51, v51
  v_mfma_f32_32x32x16_bf16 v[128:143], a[224:227], a[200:203], 0
  ds_read_b128 v[208:211], v1 offset:24576
  ds_read_b128 v[212:215], v1 offset:25600
  v_rcp_f32_e64 v52, v52
  v_rcp_f32 v53, v53
  v_mfma_f32_32x32x16_bf16 v[128:143], a[228:231], a[204:207], v[128:143]
  s_nop 1
  v_cvt_pk_bf16_f32 v112, v112, v113
  v_cvt_pk_bf16_f32 v113, v114, v115
  v_cvt_pk_bf16_f32 v114, v116, v117
  v_cvt_pk_bf16_f32 v115, v118, v119
  v_rcp_f32_e64 v54, v54
  v_mfma_f32_32x32x16_bf16 v[144:159], a[232:235], a[208:211], 0
  ds_write_b128 v253, v[112:115]
  v_cvt_pk_bf16_f32 v116, v120, v121
  v_cvt_pk_bf16_f32 v117, v122, v123
  v_cvt_pk_bf16_f32 v118, v124, v125
  v_cvt_pk_bf16_f32 v119, v126, v127
  v_mfma_f32_32x32x16_bf16 v[144:159], a[236:239], a[212:215], v[144:159]
  ds_write_b128 v253, v[116:119] offset:3072
  v_cvt_pk_bf16_f32 v128, v128, v129
  v_cvt_pk_bf16_f32 v129, v130, v131
  v_cvt_pk_bf16_f32 v130, v132, v133
  v_cvt_pk_bf16_f32 v131, v134, v135
  v_mfma_f32_32x32x16_bf16 v[32:47], a[48:51], v[160:163], 0
  ds_write_b128 v253, v[128:131] offset:1024
  v_cvt_pk_bf16_f32 v132, v136, v137
  v_cvt_pk_bf16_f32 v133, v138, v139
  v_cvt_pk_bf16_f32 v134, v140, v141
  v_cvt_pk_bf16_f32 v135, v142, v143
  v_mfma_f32_32x32x16_bf16 v[32:47], a[52:55], v[164:167], v[32:47]
  ds_write_b128 v253, v[132:135] offset:4096
  v_cvt_pk_bf16_f32 v144, v144, v145
  v_cvt_pk_bf16_f32 v145, v146, v147
  v_cvt_pk_bf16_f32 v146, v148, v149
  v_cvt_pk_bf16_f32 v147, v150, v151
  v_mfma_f32_32x32x16_bf16 v[32:47], a[56:59], v[168:171], v[32:47]
  ds_write_b128 v253, v[144:147] offset:2048
  v_cvt_pk_bf16_f32 v148, v152, v153
  v_cvt_pk_bf16_f32 v149, v154, v155
  v_cvt_pk_bf16_f32 v150, v156, v157
  v_cvt_pk_bf16_f32 v151, v158, v159
  v_mfma_f32_32x32x16_bf16 v[32:47], a[60:63], v[172:175], v[32:47]
  ds_write_b128 v253, v[148:151] offset:5120
  v_rcp_f32 v55, v55
  v_rcp_f32 v56, v56
  v_mfma_f32_32x32x16_bf16 v[32:47], a[64:67], v[176:179], v[32:47]
  v_rcp_f32 v57, v57
  v_rcp_f32 v58, v58
  v_rcp_f32_e64 v59, v59
  v_mfma_f32_32x32x16_bf16 v[32:47], a[68:71], v[180:183], v[32:47]
  s_waitcnt lgkmcnt(6)
  v_rcp_f32 v60, v60
  v_rcp_f32 v61, v61
  v_rcp_f32 v62, v62
  v_rcp_f32_e64 v63, v63
  v_pk_mul_f32 v[16:17], v[16:17], v[48:49]
  v_pk_mul_f32 v[18:19], v[18:19], v[50:51]
  v_pk_mul_f32 v[20:21], v[20:21], v[52:53]
  v_pk_mul_f32 v[22:23], v[22:23], v[54:55]
  v_pk_mul_f32 v[24:25], v[24:25], v[56:57]
  v_pk_mul_f32 v[26:27], v[26:27], v[58:59]
  v_pk_mul_f32 v[28:29], v[28:29], v[60:61]
  v_pk_mul_f32 v[30:31], v[30:31], v[62:63]
  v_pk_fma_f32 v[48:49], v[32:33], v[32:33], s[20:21] neg_lo:[1,0,1] neg_hi:[1,0,1]
  v_pk_fma_f32 v[50:51], v[34:35], v[34:35], s[20:21] neg_lo:[1,0,1] neg_hi:[1,0,1]
  v_pk_fma_f32 v[52:53], v[36:37], v[36:37], s[20:21] neg_lo:[1,0,1] neg_hi:[1,0,1]
  v_pk_fma_f32 v[54:55], v[38:39], v[38:39], s[20:21] neg_lo:[1,0,1] neg_hi:[1,0,1]
  v_pk_fma_f32 v[56:57], v[40:41], v[40:41], s[20:21] neg_lo:[1,0,1] neg_hi:[1,0,1]
  v_pk_fma_f32 v[58:59], v[42:43], v[42:43], s[20:21] neg_lo:[1,0,1] neg_hi:[1,0,1]
  v_pk_fma_f32 v[60:61], v[44:45], v[44:45], s[20:21] neg_lo:[1,0,1] neg_hi:[1,0,1]
  v_pk_fma_f32 v[62:63], v[46:47], v[46:47], s[20:21] neg_lo:[1,0,1] neg_hi:[1,0,1]
  v_pk_mul_f32 v[48:49], v[32:33], v[48:49]
  v_pk_mul_f32 v[50:51], v[34:35], v[50:51]
  v_pk_mul_f32 v[52:53], v[36:37], v[52:53]
  v_pk_mul_f32 v[54:55], v[38:39], v[54:55]
  v_pk_mul_f32 v[56:57], v[40:41], v[56:57]
  v_cvt_pk_bf16_f32 v184, v16, v17
  v_cvt_pk_bf16_f32 v185, v18, v19
  v_cvt_pk_bf16_f32 v186, v20, v21
  v_cvt_pk_bf16_f32 v187, v22, v23
  v_pk_mul_f32 v[58:59], v[42:43], v[58:59]
  v_pk_mul_f32 v[60:61], v[44:45], v[60:61]
  v_pk_mul_f32 v[62:63], v[46:47], v[62:63]
  v_mfma_f32_32x32x16_bf16 v[64:79], v[192:195], v[184:187], v[64:79]
  s_add_u32 s29, s29, 0x60000
  v_cvt_pk_bf16_f32 v188, v24, v25
  v_cvt_pk_bf16_f32 v189, v26, v27
  v_cvt_pk_bf16_f32 v190, v28, v29
  v_cvt_pk_bf16_f32 v191, v30, v31
  v_exp_f32_e64 v48, v48
  v_mfma_f32_32x32x16_bf16 v[80:95], v[196:199], v[184:187], v[80:95]
  s_add_u32 s52, s52, 0x60000
  v_exp_f32 v49, v49
  v_exp_f32 v50, v50
  v_exp_f32_e64 v51, v51
  v_mfma_f32_32x32x16_bf16 v[96:111], v[200:203], v[184:187], v[96:111]
  s_mov_b32 s32, s30
  s_waitcnt vmcnt(0)
  ds_read_b128 a[216:219], v251 offset:24576
  ds_read_b128 a[220:223], v252 offset:24576
  ds_read_b128 a[224:227], v251 offset:24640
  v_exp_f32_e64 v52, v52
  v_exp_f32 v53, v53
  v_mfma_f32_32x32x16_bf16 v[64:79], v[204:207], v[188:191], v[64:79]
  s_add_u32 s30, s33, 32
  ds_read_b128 a[228:231], v252 offset:24640
  ds_read_b128 a[232:235], v251 offset:24704
  ds_read_b128 a[236:239], v252 offset:24704
  v_subrev_u32 v11, 0x4100, v4
  v_exp_f32_e64 v54, v54
  v_mfma_f32_32x32x16_bf16 v[80:95], v[208:211], v[188:191], v[80:95]
  s_sub_u32 s33, s31, 0
  v_exp_f32 v55, v55
  v_exp_f32 v56, v56
  v_exp_f32 v57, v57
  v_exp_f32 v58, v58
  v_mfma_f32_32x32x16_bf16 v[96:111], v[212:215], v[188:191], v[96:111]
  s_waitcnt lgkmcnt(0)
  v_add_u32 v4, 0x8200, v4
  v_exp_f32 v59, v59
  v_exp_f32 v60, v60
  v_exp_f32 v61, v61
  v_exp_f32 v62, v62
  v_exp_f32 v63, v63
  v_min_u32 v4, v11, v4
  v_pk_fma_f32 v[48:49], v[48:49], s[22:23], s[22:23]
  v_pk_fma_f32 v[50:51], v[50:51], s[22:23], s[22:23]
  v_pk_fma_f32 v[52:53], v[52:53], s[22:23], s[22:23]
  v_pk_fma_f32 v[54:55], v[54:55], s[22:23], s[22:23]
  v_pk_fma_f32 v[56:57], v[56:57], s[22:23], s[22:23]
  v_pk_fma_f32 v[58:59], v[58:59], s[22:23], s[22:23]
  v_pk_fma_f32 v[60:61], v[60:61], s[22:23], s[22:23]
  v_pk_fma_f32 v[62:63], v[62:63], s[22:23], s[22:23]
  v_mfma_f32_32x32x16_bf16 v[112:127], a[216:219], a[192:195], 0
  ds_read_b128 v[192:195], v1 offset:26624
  ds_read_b128 v[196:199], v1 offset:27648
  v_rcp_f32 v48, v48
  v_rcp_f32 v49, v49
  v_mfma_f32_32x32x16_bf16 v[112:127], a[220:223], a[196:199], v[112:127]
  ds_read_b128 v[200:203], v1 offset:28672
  ds_read_b128 v[204:207], v1 offset:29696
  v_rcp_f32 v50, v50
  v_rcp_f32 v51, v51
  v_mfma_f32_32x32x16_bf16 v[128:143], a[224:227], a[200:203], 0
  ds_read_b128 v[208:211], v1 offset:30720
  ds_read_b128 v[212:215], v1 offset:31744
  v_rcp_f32_e64 v52, v52
  v_rcp_f32 v53, v53
  v_mfma_f32_32x32x16_bf16 v[128:143], a[228:231], a[204:207], v[128:143]
  s_nop 1
  v_cvt_pk_bf16_f32 v112, v112, v113
  v_cvt_pk_bf16_f32 v113, v114, v115
  v_cvt_pk_bf16_f32 v114, v116, v117
  v_cvt_pk_bf16_f32 v115, v118, v119
  v_rcp_f32_e64 v54, v54
  v_mfma_f32_32x32x16_bf16 v[144:159], a[232:235], a[208:211], 0
  ds_write_b128 v253, v[112:115] offset:24576
  v_cvt_pk_bf16_f32 v116, v120, v121
  v_cvt_pk_bf16_f32 v117, v122, v123
  v_cvt_pk_bf16_f32 v118, v124, v125
  v_cvt_pk_bf16_f32 v119, v126, v127
  v_mfma_f32_32x32x16_bf16 v[144:159], a[236:239], a[212:215], v[144:159]
  ds_write_b128 v253, v[116:119] offset:27648
  v_cvt_pk_bf16_f32 v128, v128, v129
  v_cvt_pk_bf16_f32 v129, v130, v131
  v_cvt_pk_bf16_f32 v130, v132, v133
  v_cvt_pk_bf16_f32 v131, v134, v135
  v_mfma_f32_32x32x16_bf16 v[16:31], a[72:75], v[160:163], 0
  ds_write_b128 v253, v[128:131] offset:25600
  v_cvt_pk_bf16_f32 v132, v136, v137
  v_cvt_pk_bf16_f32 v133, v138, v139
  v_cvt_pk_bf16_f32 v134, v140, v141
  v_cvt_pk_bf16_f32 v135, v142, v143
  v_mfma_f32_32x32x16_bf16 v[16:31], a[76:79], v[164:167], v[16:31]
  ds_write_b128 v253, v[132:135] offset:28672
  v_cvt_pk_bf16_f32 v144, v144, v145
  v_cvt_pk_bf16_f32 v145, v146, v147
  v_cvt_pk_bf16_f32 v146, v148, v149
  v_cvt_pk_bf16_f32 v147, v150, v151
  v_mfma_f32_32x32x16_bf16 v[16:31], a[80:83], v[168:171], v[16:31]
  ds_write_b128 v253, v[144:147] offset:26624
  v_cvt_pk_bf16_f32 v148, v152, v153
  v_cvt_pk_bf16_f32 v149, v154, v155
  v_cvt_pk_bf16_f32 v150, v156, v157
  v_cvt_pk_bf16_f32 v151, v158, v159
  v_mfma_f32_32x32x16_bf16 v[16:31], a[84:87], v[172:175], v[16:31]
  ds_write_b128 v253, v[148:151] offset:29696
  buffer_load_dword v249, v248, s[4:7], s29 offen
  v_rcp_f32_e64 v55, v55
  v_mfma_f32_32x32x16_bf16 v[16:31], a[88:91], v[176:179], v[16:31]
  v_rcp_f32 v56, v56
  v_rcp_f32 v57, v57
  v_rcp_f32_e64 v58, v58
  v_mfma_f32_32x32x16_bf16 v[16:31], a[92:95], v[180:183], v[16:31]
  s_waitcnt lgkmcnt(6)
  v_rcp_f32 v59, v59
  v_rcp_f32 v60, v60
  v_rcp_f32 v61, v61
  v_rcp_f32 v62, v62
  v_rcp_f32 v63, v63
  v_pk_mul_f32 v[32:33], v[32:33], v[48:49]
  v_pk_mul_f32 v[34:35], v[34:35], v[50:51]
  v_pk_mul_f32 v[36:37], v[36:37], v[52:53]
  v_pk_mul_f32 v[38:39], v[38:39], v[54:55]
  v_pk_mul_f32 v[40:41], v[40:41], v[56:57]
  v_pk_mul_f32 v[42:43], v[42:43], v[58:59]
  v_pk_mul_f32 v[44:45], v[44:45], v[60:61]
  v_pk_mul_f32 v[46:47], v[46:47], v[62:63]
  v_pk_fma_f32 v[48:49], v[16:17], v[16:17], s[20:21] neg_lo:[1,0,1] neg_hi:[1,0,1]
  v_pk_fma_f32 v[50:51], v[18:19], v[18:19], s[20:21] neg_lo:[1,0,1] neg_hi:[1,0,1]
  v_pk_fma_f32 v[52:53], v[20:21], v[20:21], s[20:21] neg_lo:[1,0,1] neg_hi:[1,0,1]
  v_pk_fma_f32 v[54:55], v[22:23], v[22:23], s[20:21] neg_lo:[1,0,1] neg_hi:[1,0,1]
  v_pk_fma_f32 v[56:57], v[24:25], v[24:25], s[20:21] neg_lo:[1,0,1] neg_hi:[1,0,1]
  v_pk_fma_f32 v[58:59], v[26:27], v[26:27], s[20:21] neg_lo:[1,0,1] neg_hi:[1,0,1]
  v_pk_fma_f32 v[60:61], v[28:29], v[28:29], s[20:21] neg_lo:[1,0,1] neg_hi:[1,0,1]
  v_pk_fma_f32 v[62:63], v[30:31], v[30:31], s[20:21] neg_lo:[1,0,1] neg_hi:[1,0,1]
  v_pk_mul_f32 v[48:49], v[16:17], v[48:49]
  v_pk_mul_f32 v[50:51], v[18:19], v[50:51]
  v_pk_mul_f32 v[52:53], v[20:21], v[52:53]
  v_pk_mul_f32 v[54:55], v[22:23], v[54:55]
  v_pk_mul_f32 v[56:57], v[24:25], v[56:57]
  v_cvt_pk_bf16_f32 v184, v32, v33
  v_cvt_pk_bf16_f32 v185, v34, v35
  v_cvt_pk_bf16_f32 v186, v36, v37
  v_cvt_pk_bf16_f32 v187, v38, v39
  v_pk_mul_f32 v[58:59], v[26:27], v[58:59]
  v_pk_mul_f32 v[60:61], v[28:29], v[60:61]
  v_pk_mul_f32 v[62:63], v[30:31], v[62:63]
  v_mfma_f32_32x32x16_bf16 v[64:79], v[192:195], v[184:187], v[64:79]
  ds_read_b128 v[220:223], v4 offset:96
  v_cvt_pk_bf16_f32 v188, v40, v41
  v_cvt_pk_bf16_f32 v189, v42, v43
  v_cvt_pk_bf16_f32 v190, v44, v45
  v_cvt_pk_bf16_f32 v191, v46, v47
  v_mfma_f32_32x32x16_bf16 v[80:95], v[196:199], v[184:187], v[80:95]
  ds_read_b128 v[228:231], v4 offset:288
  v_exp_f32 v48, v48
  v_exp_f32 v49, v49
  v_exp_f32_e64 v50, v50
  v_mfma_f32_32x32x16_bf16 v[96:111], v[200:203], v[184:187], v[96:111]
  ds_read_b128 v[236:239], v4 offset:480
  v_exp_f32 v51, v51
  v_exp_f32 v52, v52
  v_mfma_f32_32x32x16_bf16 v[64:79], v[204:207], v[188:191], v[64:79]
  v_exp_f32 v53, v53
  v_exp_f32 v54, v54
  v_exp_f32_e64 v55, v55
  v_mfma_f32_32x32x16_bf16 v[80:95], v[208:211], v[188:191], v[80:95]
  v_exp_f32 v56, v56
  v_exp_f32 v57, v57
  v_exp_f32_e64 v58, v58
  v_mfma_f32_32x32x16_bf16 v[96:111], v[212:215], v[188:191], v[96:111]
  s_waitcnt lgkmcnt(0)
  v_exp_f32 v59, v59
  v_exp_f32 v60, v60
  v_exp_f32 v61, v61
  v_exp_f32_e64 v62, v62
  v_exp_f32_e64 v63, v63
  v_pk_fma_f32 v[48:49], v[48:49], s[22:23], s[22:23]
  v_pk_fma_f32 v[50:51], v[50:51], s[22:23], s[22:23]
  v_pk_fma_f32 v[52:53], v[52:53], s[22:23], s[22:23]
  v_pk_fma_f32 v[54:55], v[54:55], s[22:23], s[22:23]
  v_pk_fma_f32 v[56:57], v[56:57], s[22:23], s[22:23]
  v_pk_fma_f32 v[58:59], v[58:59], s[22:23], s[22:23]
  v_pk_fma_f32 v[60:61], v[60:61], s[22:23], s[22:23]
  v_pk_fma_f32 v[62:63], v[62:63], s[22:23], s[22:23]
  s_barrier
  v_mfma_f32_32x32x16_bf16 v[32:47], a[96:99], v[160:163], 0
  ds_read_b128 v[192:195], v0 offset:24576
  ds_read_b128 v[196:199], v0 offset:25600
  v_rcp_f32 v48, v48
  v_rcp_f32_e64 v49, v49
  v_mfma_f32_16x16x32_bf16 v[136:139], a[240:243], v[220:223], 0
  ds_read_b128 v[216:219], v3 offset:2800
  ds_read_b128 v[220:223], v4 offset:112
  v_mfma_f32_32x32x16_bf16 v[32:47], a[100:103], v[164:167], v[32:47]
  ds_read_b128 v[200:203], v0 offset:26624
  ds_read_b128 v[204:207], v0 offset:27648
  v_rcp_f32 v50, v50
  v_rcp_f32 v51, v51
  v_mfma_f32_16x16x32_bf16 v[136:139], a[244:247], v[228:231], v[136:139]
  ds_read_b128 v[224:227], v3 offset:7600
  ds_read_b128 v[228:231], v4 offset:304
  v_mfma_f32_32x32x16_bf16 v[32:47], a[104:107], v[168:171], v[32:47]
  ds_read_b128 v[208:211], v0 offset:28672
  ds_read_b128 v[212:215], v0 offset:29696
  v_rcp_f32 v52, v52
  v_rcp_f32 v53, v53
  v_mfma_f32_16x16x32_bf16 v[136:139], a[248:251], v[236:239], v[136:139]
  ds_read_b128 v[232:235], v3 offset:12400
  ds_read_b128 v[236:239], v4 offset:496
  v_mfma_f32_32x32x16_bf16 v[32:47], a[108:111], v[172:175], v[32:47]
  v_rcp_f32 v54, v54
  v_rcp_f32 v55, v55
  v_rcp_f32_e64 v56, v56
  v_mfma_f32_32x32x16_bf16 v[32:47], a[112:115], v[176:179], v[32:47]
  v_rcp_f32 v57, v57
  v_rcp_f32 v58, v58
  v_rcp_f32_e64 v59, v59
  v_mfma_f32_32x32x16_bf16 v[32:47], a[116:119], v[180:183], v[32:47]
  s_waitcnt lgkmcnt(0)
  v_rcp_f32 v60, v60
  v_rcp_f32 v61, v61
  v_rcp_f32 v62, v62
  v_rcp_f32_e64 v63, v63
  v_pk_mul_f32 v[16:17], v[16:17], v[48:49]
  v_pk_mul_f32 v[18:19], v[18:19], v[50:51]
  v_pk_mul_f32 v[20:21], v[20:21], v[52:53]
  v_pk_mul_f32 v[22:23], v[22:23], v[54:55]
  v_pk_mul_f32 v[24:25], v[24:25], v[56:57]
  v_pk_mul_f32 v[26:27], v[26:27], v[58:59]
  v_pk_mul_f32 v[28:29], v[28:29], v[60:61]
  v_pk_mul_f32 v[30:31], v[30:31], v[62:63]
  v_pk_add_f32 v[12:13], v[136:137], v[138:139]
  v_pk_mul_f32 v[14:15], v[136:137], v[136:137]
  v_pk_fma_f32 v[14:15], v[138:139], v[138:139], v[14:15]
  v_pk_fma_f32 v[48:49], v[32:33], v[32:33], s[20:21] neg_lo:[1,0,1] neg_hi:[1,0,1]
  v_pk_fma_f32 v[50:51], v[34:35], v[34:35], s[20:21] neg_lo:[1,0,1] neg_hi:[1,0,1]
  v_pk_fma_f32 v[52:53], v[36:37], v[36:37], s[20:21] neg_lo:[1,0,1] neg_hi:[1,0,1]
  v_pk_fma_f32 v[54:55], v[38:39], v[38:39], s[20:21] neg_lo:[1,0,1] neg_hi:[1,0,1]
  v_pk_fma_f32 v[56:57], v[40:41], v[40:41], s[20:21] neg_lo:[1,0,1] neg_hi:[1,0,1]
  v_pk_fma_f32 v[58:59], v[42:43], v[42:43], s[20:21] neg_lo:[1,0,1] neg_hi:[1,0,1]
  v_pk_fma_f32 v[60:61], v[44:45], v[44:45], s[20:21] neg_lo:[1,0,1] neg_hi:[1,0,1]
  v_pk_fma_f32 v[62:63], v[46:47], v[46:47], s[20:21] neg_lo:[1,0,1] neg_hi:[1,0,1]
  v_pk_mul_f32 v[48:49], v[32:33], v[48:49]
  v_pk_mul_f32 v[50:51], v[34:35], v[50:51]
  v_pk_mul_f32 v[52:53], v[36:37], v[52:53]
  v_pk_mul_f32 v[54:55], v[38:39], v[54:55]
  v_pk_mul_f32 v[56:57], v[40:41], v[56:57]
  v_pk_mul_f32 v[58:59], v[42:43], v[58:59]
  v_pk_mul_f32 v[60:61], v[44:45], v[60:61]
  v_pk_mul_f32 v[62:63], v[46:47], v[62:63]
  v_mfma_f32_16x16x32_bf16 v[140:143], v[216:219], v[220:223], 0
  v_cvt_pk_bf16_f32 v184, v16, v17
  v_cvt_pk_bf16_f32 v185, v18, v19
  v_mfma_f32_16x16x32_bf16 v[140:143], v[224:227], v[228:231], v[140:143]
  v_cvt_pk_bf16_f32 v186, v20, v21
  v_cvt_pk_bf16_f32 v187, v22, v23
  v_mfma_f32_16x16x32_bf16 v[140:143], v[232:235], v[236:239], v[140:143]
  ds_read_b128 v[220:223], v4 offset:128
  v_mfma_f32_32x32x16_bf16 v[64:79], v[192:195], v[184:187], v[64:79]
  ds_read_b128 v[224:227], v3 offset:8000
  ds_read_b128 v[228:231], v4 offset:320
  v_cvt_pk_bf16_f32 v188, v24, v25
  v_cvt_pk_bf16_f32 v189, v26, v27
  v_cvt_pk_bf16_f32 v190, v28, v29
  v_cvt_pk_bf16_f32 v191, v30, v31
  v_mfma_f32_32x32x16_bf16 v[80:95], v[196:199], v[184:187], v[80:95]
  ds_read_b128 v[232:235], v3 offset:12800
  ds_read_b128 v[236:239], v4 offset:512
  v_exp_f32 v48, v48
  v_exp_f32 v49, v49
  v_mfma_f32_32x32x16_bf16 v[96:111], v[200:203], v[184:187], v[96:111]
  s_sub_u32 s31, s32, 32
  v_exp_f32 v50, v50
  v_exp_f32 v51, v51
  v_exp_f32 v52, v52
  v_mfma_f32_32x32x16_bf16 v[64:79], v[204:207], v[188:191], v[64:79]
  v_exp_f32 v53, v53
  v_exp_f32 v54, v54
  v_exp_f32_e64 v55, v55
  v_mfma_f32_32x32x16_bf16 v[80:95], v[208:211], v[188:191], v[80:95]
  v_exp_f32 v56, v56
  v_exp_f32 v57, v57
  v_exp_f32_e64 v58, v58
  v_mfma_f32_32x32x16_bf16 v[96:111], v[212:215], v[188:191], v[96:111]
  s_waitcnt lgkmcnt(0)
  v_exp_f32 v59, v59
  v_exp_f32 v60, v60
  v_exp_f32 v61, v61
  v_exp_f32 v62, v62
  v_exp_f32 v63, v63
  v_pk_add_f32 v[12:13], v[12:13], v[140:141]
  v_pk_fma_f32 v[14:15], v[140:141], v[140:141], v[14:15]
  v_pk_add_f32 v[12:13], v[12:13], v[142:143]
  v_pk_fma_f32 v[14:15], v[142:143], v[142:143], v[14:15]
  v_pk_fma_f32 v[48:49], v[48:49], s[22:23], s[22:23]
  v_pk_fma_f32 v[50:51], v[50:51], s[22:23], s[22:23]
  v_pk_fma_f32 v[52:53], v[52:53], s[22:23], s[22:23]
  v_pk_fma_f32 v[54:55], v[54:55], s[22:23], s[22:23]
  v_pk_fma_f32 v[56:57], v[56:57], s[22:23], s[22:23]
  v_pk_fma_f32 v[58:59], v[58:59], s[22:23], s[22:23]
  v_pk_fma_f32 v[60:61], v[60:61], s[22:23], s[22:23]
  v_pk_fma_f32 v[62:63], v[62:63], s[22:23], s[22:23]
  v_mfma_f32_32x32x16_bf16 v[16:31], a[120:123], v[160:163], 0
  ds_read_b128 v[192:195], v0 offset:30720
  ds_read_b128 v[196:199], v0 offset:31744
  v_rcp_f32 v48, v48
  v_rcp_f32 v49, v49
  v_mfma_f32_16x16x32_bf16 v[144:147], a[252:255], v[220:223], 0
  ds_read_b128 v[216:219], v3 offset:3600
  ds_read_b128 v[220:223], v4 offset:144
  v_mfma_f32_32x32x16_bf16 v[16:31], a[124:127], v[164:167], v[16:31]
  ds_read_b128 v[200:203], v0 offset:32768
  ds_read_b128 v[204:207], v0 offset:33792
  v_rcp_f32 v50, v50
  v_rcp_f32 v51, v51
  v_mfma_f32_16x16x32_bf16 v[144:147], v[224:227], v[228:231], v[144:147]
  ds_read_b128 v[224:227], v3 offset:8400
  ds_read_b128 v[228:231], v4 offset:336
  v_mfma_f32_32x32x16_bf16 v[16:31], a[128:131], v[168:171], v[16:31]
  ds_read_b128 v[208:211], v0 offset:34816
  ds_read_b128 v[212:215], v0 offset:35840
  v_rcp_f32 v52, v52
  v_rcp_f32 v53, v53
  v_mfma_f32_16x16x32_bf16 v[144:147], v[232:235], v[236:239], v[144:147]
  ds_read_b128 v[232:235], v3 offset:13200
  ds_read_b128 v[236:239], v4 offset:528
  v_mfma_f32_32x32x16_bf16 v[16:31], a[132:135], v[172:175], v[16:31]
  v_rcp_f32 v54, v54
  v_rcp_f32 v55, v55
  v_rcp_f32_e64 v56, v56
  v_mfma_f32_32x32x16_bf16 v[16:31], a[136:139], v[176:179], v[16:31]
  ds_read_b128 a[192:195], v0
  ds_read_b128 a[196:199], v0 offset:1024
  ds_read_b128 a[200:203], v0 offset:2048
  v_rcp_f32 v57, v57
  v_rcp_f32 v58, v58
  v_mfma_f32_32x32x16_bf16 v[16:31], a[140:143], v[180:183], v[16:31]
  s_waitcnt lgkmcnt(3)
  v_rcp_f32 v59, v59
  v_rcp_f32 v60, v60
  v_rcp_f32 v61, v61
  v_rcp_f32 v62, v62
  v_rcp_f32 v63, v63
  v_pk_mul_f32 v[32:33], v[32:33], v[48:49]
  v_pk_mul_f32 v[34:35], v[34:35], v[50:51]
  v_pk_mul_f32 v[36:37], v[36:37], v[52:53]
  v_pk_mul_f32 v[38:39], v[38:39], v[54:55]
  v_pk_mul_f32 v[40:41], v[40:41], v[56:57]
  v_pk_mul_f32 v[42:43], v[42:43], v[58:59]
  v_pk_mul_f32 v[44:45], v[44:45], v[60:61]
  v_pk_mul_f32 v[46:47], v[46:47], v[62:63]
  v_pk_add_f32 v[12:13], v[12:13], v[144:145]
  v_pk_fma_f32 v[14:15], v[144:145], v[144:145], v[14:15]
  v_pk_add_f32 v[12:13], v[12:13], v[146:147]
  v_pk_fma_f32 v[14:15], v[146:147], v[146:147], v[14:15]
  v_pk_fma_f32 v[48:49], v[16:17], v[16:17], s[20:21] neg_lo:[1,0,1] neg_hi:[1,0,1]
  v_pk_fma_f32 v[50:51], v[18:19], v[18:19], s[20:21] neg_lo:[1,0,1] neg_hi:[1,0,1]
  v_pk_fma_f32 v[52:53], v[20:21], v[20:21], s[20:21] neg_lo:[1,0,1] neg_hi:[1,0,1]
  v_pk_fma_f32 v[54:55], v[22:23], v[22:23], s[20:21] neg_lo:[1,0,1] neg_hi:[1,0,1]
  v_pk_fma_f32 v[56:57], v[24:25], v[24:25], s[20:21] neg_lo:[1,0,1] neg_hi:[1,0,1]
  v_pk_fma_f32 v[58:59], v[26:27], v[26:27], s[20:21] neg_lo:[1,0,1] neg_hi:[1,0,1]
  v_pk_fma_f32 v[60:61], v[28:29], v[28:29], s[20:21] neg_lo:[1,0,1] neg_hi:[1,0,1]
  v_pk_fma_f32 v[62:63], v[30:31], v[30:31], s[20:21] neg_lo:[1,0,1] neg_hi:[1,0,1]
  v_pk_mul_f32 v[48:49], v[16:17], v[48:49]
  v_pk_mul_f32 v[50:51], v[18:19], v[50:51]
  v_pk_mul_f32 v[52:53], v[20:21], v[52:53]
  v_pk_mul_f32 v[54:55], v[22:23], v[54:55]
  v_pk_mul_f32 v[56:57], v[24:25], v[56:57]
  v_pk_mul_f32 v[58:59], v[26:27], v[58:59]
  v_pk_mul_f32 v[60:61], v[28:29], v[60:61]
  v_pk_mul_f32 v[62:63], v[30:31], v[62:63]
  v_mfma_f32_16x16x32_bf16 v[148:151], v[216:219], v[220:223], 0
  v_cvt_pk_bf16_f32 v184, v32, v33
  v_cvt_pk_bf16_f32 v185, v34, v35
  v_mfma_f32_16x16x32_bf16 v[148:151], v[224:227], v[228:231], v[148:151]
  v_cvt_pk_bf16_f32 v186, v36, v37
  v_cvt_pk_bf16_f32 v187, v38, v39
  v_mfma_f32_16x16x32_bf16 v[148:151], v[232:235], v[236:239], v[148:151]
  ds_read_b128 v[216:219], v3 offset:4000
  ds_read_b128 v[220:223], v4 offset:160
  v_mfma_f32_32x32x16_bf16 v[64:79], v[192:195], v[184:187], v[64:79]
  ds_read_b128 v[224:227], v3 offset:8800
  ds_read_b128 v[228:231], v4 offset:352
  v_cvt_pk_bf16_f32 v188, v40, v41
  v_cvt_pk_bf16_f32 v189, v42, v43
  v_cvt_pk_bf16_f32 v190, v44, v45
  v_cvt_pk_bf16_f32 v191, v46, v47
  v_mfma_f32_32x32x16_bf16 v[80:95], v[196:199], v[184:187], v[80:95]
  ds_read_b128 v[232:235], v3 offset:13600
  ds_read_b128 v[236:239], v4 offset:544
  v_exp_f32 v48, v48
  v_exp_f32 v49, v49
  v_mfma_f32_32x32x16_bf16 v[96:111], v[200:203], v[184:187], v[96:111]
  v_exp_f32 v50, v50
  v_exp_f32 v51, v51
  v_exp_f32_e64 v52, v52
  v_mfma_f32_32x32x16_bf16 v[64:79], v[204:207], v[188:191], v[64:79]
  v_exp_f32 v53, v53
  v_exp_f32 v54, v54
  v_exp_f32_e64 v55, v55
  v_mfma_f32_32x32x16_bf16 v[80:95], v[208:211], v[188:191], v[80:95]
  ds_read_b128 a[204:207], v0 offset:3072
  ds_read_b128 a[208:211], v0 offset:4096
  ds_read_b128 a[212:215], v0 offset:5120
  v_exp_f32 v56, v56
  v_exp_f32 v57, v57
  v_mfma_f32_32x32x16_bf16 v[96:111], v[212:215], v[188:191], v[96:111]
  s_waitcnt lgkmcnt(3)
  v_exp_f32 v58, v58
  v_exp_f32 v59, v59
  v_exp_f32 v60, v60
  v_exp_f32 v61, v61
  v_exp_f32 v62, v62
  v_exp_f32_e64 v63, v63
  v_pk_add_f32 v[12:13], v[12:13], v[148:149]
  v_pk_fma_f32 v[14:15], v[148:149], v[148:149], v[14:15]
  v_pk_add_f32 v[12:13], v[12:13], v[150:151]
  v_pk_fma_f32 v[14:15], v[150:151], v[150:151], v[14:15]
  v_pk_fma_f32 v[48:49], v[48:49], s[22:23], s[22:23]
  v_pk_fma_f32 v[50:51], v[50:51], s[22:23], s[22:23]
  v_pk_fma_f32 v[52:53], v[52:53], s[22:23], s[22:23]
  v_pk_fma_f32 v[54:55], v[54:55], s[22:23], s[22:23]
  v_pk_fma_f32 v[56:57], v[56:57], s[22:23], s[22:23]
  v_pk_fma_f32 v[58:59], v[58:59], s[22:23], s[22:23]
  v_pk_fma_f32 v[60:61], v[60:61], s[22:23], s[22:23]
  v_pk_fma_f32 v[62:63], v[62:63], s[22:23], s[22:23]
  v_mfma_f32_32x32x16_bf16 v[32:47], a[144:147], v[160:163], 0
  ds_read_b128 v[192:195], v0 offset:36864
  ds_read_b128 v[196:199], v0 offset:37888
  v_rcp_f32 v48, v48
  v_rcp_f32 v49, v49
  v_mfma_f32_16x16x32_bf16 v[152:155], v[216:219], v[220:223], 0
  ds_read_b128 v[216:219], v3 offset:4400
  ds_read_b128 v[220:223], v4 offset:176
  v_mfma_f32_32x32x16_bf16 v[32:47], a[148:151], v[164:167], v[32:47]
  ds_read_b128 v[200:203], v0 offset:38912
  ds_read_b128 v[204:207], v0 offset:39936
  v_rcp_f32 v50, v50
  v_rcp_f32 v51, v51
  v_mfma_f32_16x16x32_bf16 v[152:155], v[224:227], v[228:231], v[152:155]
  ds_read_b128 v[224:227], v3 offset:9200
  ds_read_b128 v[228:231], v4 offset:368
  v_mfma_f32_32x32x16_bf16 v[32:47], a[152:155], v[168:171], v[32:47]
  ds_read_b128 v[208:211], v0 offset:40960
  ds_read_b128 v[212:215], v0 offset:41984
  v_rcp_f32 v52, v52
  v_rcp_f32 v53, v53
  v_mfma_f32_16x16x32_bf16 v[152:155], v[232:235], v[236:239], v[152:155]
  ds_read_b128 v[232:235], v3 offset:14000
  ds_read_b128 v[236:239], v4 offset:560
  v_mfma_f32_32x32x16_bf16 v[32:47], a[156:159], v[172:175], v[32:47]
  v_rcp_f32 v54, v54
  v_rcp_f32 v55, v55
  v_rcp_f32_e64 v56, v56
  v_mfma_f32_32x32x16_bf16 v[32:47], a[160:163], v[176:179], v[32:47]
  ds_read_b128 a[216:219], v0 offset:6144
  ds_read_b128 a[220:223], v0 offset:7168
  ds_read_b128 a[224:227], v0 offset:8192
  v_rcp_f32 v57, v57
  v_rcp_f32 v58, v58
  v_mfma_f32_32x32x16_bf16 v[32:47], a[164:167], v[180:183], v[32:47]
  s_waitcnt lgkmcnt(3)
  v_rcp_f32 v59, v59
  v_rcp_f32 v60, v60
  v_rcp_f32 v61, v61
  v_rcp_f32 v62, v62
  v_rcp_f32 v63, v63
  v_pk_mul_f32 v[16:17], v[16:17], v[48:49]
  v_pk_mul_f32 v[18:19], v[18:19], v[50:51]
  v_pk_mul_f32 v[20:21], v[20:21], v[52:53]
  v_pk_mul_f32 v[22:23], v[22:23], v[54:55]
  v_pk_mul_f32 v[24:25], v[24:25], v[56:57]
  v_pk_mul_f32 v[26:27], v[26:27], v[58:59]
  v_pk_mul_f32 v[28:29], v[28:29], v[60:61]
  v_pk_mul_f32 v[30:31], v[30:31], v[62:63]
  v_pk_add_f32 v[12:13], v[12:13], v[152:153]
  v_pk_fma_f32 v[14:15], v[152:153], v[152:153], v[14:15]
  v_pk_add_f32 v[12:13], v[12:13], v[154:155]
  v_pk_fma_f32 v[14:15], v[154:155], v[154:155], v[14:15]
  v_pk_fma_f32 v[48:49], v[32:33], v[32:33], s[20:21] neg_lo:[1,0,1] neg_hi:[1,0,1]
  v_pk_fma_f32 v[50:51], v[34:35], v[34:35], s[20:21] neg_lo:[1,0,1] neg_hi:[1,0,1]
  v_pk_fma_f32 v[52:53], v[36:37], v[36:37], s[20:21] neg_lo:[1,0,1] neg_hi:[1,0,1]
  v_pk_fma_f32 v[54:55], v[38:39], v[38:39], s[20:21] neg_lo:[1,0,1] neg_hi:[1,0,1]
  v_pk_fma_f32 v[56:57], v[40:41], v[40:41], s[20:21] neg_lo:[1,0,1] neg_hi:[1,0,1]
  v_pk_fma_f32 v[58:59], v[42:43], v[42:43], s[20:21] neg_lo:[1,0,1] neg_hi:[1,0,1]
  v_pk_fma_f32 v[60:61], v[44:45], v[44:45], s[20:21] neg_lo:[1,0,1] neg_hi:[1,0,1]
  v_pk_fma_f32 v[62:63], v[46:47], v[46:47], s[20:21] neg_lo:[1,0,1] neg_hi:[1,0,1]
  v_pk_mul_f32 v[48:49], v[32:33], v[48:49]
  v_pk_mul_f32 v[50:51], v[34:35], v[50:51]
  v_pk_mul_f32 v[52:53], v[36:37], v[52:53]
  v_pk_mul_f32 v[54:55], v[38:39], v[54:55]
  v_pk_mul_f32 v[56:57], v[40:41], v[56:57]
  v_pk_mul_f32 v[58:59], v[42:43], v[58:59]
  v_pk_mul_f32 v[60:61], v[44:45], v[60:61]
  v_pk_mul_f32 v[62:63], v[46:47], v[62:63]
  v_mfma_f32_16x16x32_bf16 v[156:159], v[216:219], v[220:223], 0
  v_cvt_pk_bf16_f32 v184, v16, v17
  v_cvt_pk_bf16_f32 v185, v18, v19
  v_mfma_f32_16x16x32_bf16 v[156:159], v[224:227], v[228:231], v[156:159]
  v_cvt_pk_bf16_f32 v186, v20, v21
  v_cvt_pk_bf16_f32 v187, v22, v23
  v_mfma_f32_16x16x32_bf16 v[156:159], v[232:235], v[236:239], v[156:159]
  ds_read_b128 v[216:219], v3
  ds_read_b128 v[220:223], v4
  v_mfma_f32_32x32x16_bf16 v[64:79], v[192:195], v[184:187], v[64:79]
  ds_read_b128 v[224:227], v3 offset:4800
  ds_read_b128 v[228:231], v4 offset:192
  v_cvt_pk_bf16_f32 v188, v24, v25
  v_cvt_pk_bf16_f32 v189, v26, v27
  v_cvt_pk_bf16_f32 v190, v28, v29
  v_cvt_pk_bf16_f32 v191, v30, v31
  v_mfma_f32_32x32x16_bf16 v[80:95], v[196:199], v[184:187], v[80:95]
  ds_read_b128 v[232:235], v3 offset:9600
  ds_read_b128 v[236:239], v4 offset:384
  v_exp_f32 v48, v48
  v_exp_f32 v49, v49
  v_mfma_f32_32x32x16_bf16 v[96:111], v[200:203], v[184:187], v[96:111]
  v_exp_f32 v50, v50
  v_exp_f32 v51, v51
  v_exp_f32_e64 v52, v52
  v_mfma_f32_32x32x16_bf16 v[64:79], v[204:207], v[188:191], v[64:79]
  v_exp_f32 v53, v53
  v_exp_f32 v54, v54
  v_exp_f32_e64 v55, v55
  v_mfma_f32_32x32x16_bf16 v[80:95], v[208:211], v[188:191], v[80:95]
  ds_read_b128 a[228:231], v0 offset:9216
  ds_read_b128 a[232:235], v0 offset:10240
  ds_read_b128 a[236:239], v0 offset:11264
  v_exp_f32 v56, v56
  v_exp_f32 v57, v57
  v_mfma_f32_32x32x16_bf16 v[96:111], v[212:215], v[188:191], v[96:111]
  s_waitcnt lgkmcnt(3)
  v_exp_f32 v58, v58
  v_exp_f32 v59, v59
  v_exp_f32 v60, v60
  v_exp_f32 v61, v61
  v_exp_f32 v62, v62
  v_exp_f32_e64 v63, v63
  v_pk_add_f32 v[12:13], v[12:13], v[156:157]
  v_pk_fma_f32 v[14:15], v[156:157], v[156:157], v[14:15]
  v_pk_add_f32 v[12:13], v[12:13], v[158:159]
  v_pk_fma_f32 v[14:15], v[158:159], v[158:159], v[14:15]
  v_pk_fma_f32 v[48:49], v[48:49], s[22:23], s[22:23]
  v_pk_fma_f32 v[50:51], v[50:51], s[22:23], s[22:23]
  v_pk_fma_f32 v[52:53], v[52:53], s[22:23], s[22:23]
  v_pk_fma_f32 v[54:55], v[54:55], s[22:23], s[22:23]
  v_pk_fma_f32 v[56:57], v[56:57], s[22:23], s[22:23]
  v_pk_fma_f32 v[58:59], v[58:59], s[22:23], s[22:23]
  v_pk_fma_f32 v[60:61], v[60:61], s[22:23], s[22:23]
  v_pk_fma_f32 v[62:63], v[62:63], s[22:23], s[22:23]
  v_mfma_f32_32x32x16_bf16 v[16:31], a[168:171], v[160:163], 0
  ds_read_b128 v[192:195], v0 offset:43008
  ds_read_b128 v[196:199], v0 offset:44032
  v_rcp_f32 v48, v48
  v_rcp_f32 v49, v49
  v_mfma_f32_16x16x32_bf16 v[112:115], v[216:219], v[220:223], 0
  ds_read_b128 v[216:219], v3 offset:400
  ds_read_b128 v[220:223], v4 offset:16
  v_mfma_f32_32x32x16_bf16 v[16:31], a[172:175], v[164:167], v[16:31]
  ds_read_b128 v[200:203], v0 offset:45056
  ds_read_b128 v[204:207], v0 offset:46080
  v_rcp_f32 v50, v50
  v_rcp_f32 v51, v51
  v_mfma_f32_16x16x32_bf16 v[112:115], v[224:227], v[228:231], v[112:115]
  ds_read_b128 v[224:227], v3 offset:5200
  ds_read_b128 v[228:231], v4 offset:208
  v_mfma_f32_32x32x16_bf16 v[16:31], a[176:179], v[168:171], v[16:31]
  ds_read_b128 v[208:211], v0 offset:47104
  ds_read_b128 v[212:215], v0 offset:48128
  v_rcp_f32 v52, v52
  v_rcp_f32 v53, v53
  v_mfma_f32_16x16x32_bf16 v[112:115], v[232:235], v[236:239], v[112:115]
  ds_read_b128 v[232:235], v3 offset:10000
  ds_read_b128 v[236:239], v4 offset:400
  v_mfma_f32_32x32x16_bf16 v[16:31], a[180:183], v[172:175], v[16:31]
  v_rcp_f32 v54, v54
  v_rcp_f32 v55, v55
  v_rcp_f32_e64 v56, v56
  v_mfma_f32_32x32x16_bf16 v[16:31], a[184:187], v[176:179], v[16:31]
  v_rcp_f32 v57, v57
  v_rcp_f32 v58, v58
  v_rcp_f32_e64 v59, v59
  v_mfma_f32_32x32x16_bf16 v[16:31], a[188:191], v[180:183], v[16:31]
  s_waitcnt lgkmcnt(0)
  v_rcp_f32 v60, v60
  v_rcp_f32 v61, v61
  v_rcp_f32 v62, v62
  v_rcp_f32_e64 v63, v63
  v_pk_mul_f32 v[32:33], v[32:33], v[48:49]
  v_pk_mul_f32 v[34:35], v[34:35], v[50:51]
  v_pk_mul_f32 v[36:37], v[36:37], v[52:53]
  v_pk_mul_f32 v[38:39], v[38:39], v[54:55]
  v_pk_mul_f32 v[40:41], v[40:41], v[56:57]
  v_pk_mul_f32 v[42:43], v[42:43], v[58:59]
  v_pk_mul_f32 v[44:45], v[44:45], v[60:61]
  v_pk_mul_f32 v[46:47], v[46:47], v[62:63]
  v_pk_add_f32 v[12:13], v[12:13], v[112:113]
  v_pk_fma_f32 v[14:15], v[112:113], v[112:113], v[14:15]
  v_pk_add_f32 v[12:13], v[12:13], v[114:115]
  v_pk_fma_f32 v[14:15], v[114:115], v[114:115], v[14:15]
  v_pk_fma_f32 v[48:49], v[16:17], v[16:17], s[20:21] neg_lo:[1,0,1] neg_hi:[1,0,1]
  v_pk_fma_f32 v[50:51], v[18:19], v[18:19], s[20:21] neg_lo:[1,0,1] neg_hi:[1,0,1]
  v_pk_fma_f32 v[52:53], v[20:21], v[20:21], s[20:21] neg_lo:[1,0,1] neg_hi:[1,0,1]
  v_pk_fma_f32 v[54:55], v[22:23], v[22:23], s[20:21] neg_lo:[1,0,1] neg_hi:[1,0,1]
  v_pk_fma_f32 v[56:57], v[24:25], v[24:25], s[20:21] neg_lo:[1,0,1] neg_hi:[1,0,1]
  v_pk_fma_f32 v[58:59], v[26:27], v[26:27], s[20:21] neg_lo:[1,0,1] neg_hi:[1,0,1]
  v_pk_fma_f32 v[60:61], v[28:29], v[28:29], s[20:21] neg_lo:[1,0,1] neg_hi:[1,0,1]
  v_pk_fma_f32 v[62:63], v[30:31], v[30:31], s[20:21] neg_lo:[1,0,1] neg_hi:[1,0,1]
  v_pk_mul_f32 v[48:49], v[16:17], v[48:49]
  v_pk_mul_f32 v[50:51], v[18:19], v[50:51]
  v_pk_mul_f32 v[52:53], v[20:21], v[52:53]
  v_pk_mul_f32 v[54:55], v[22:23], v[54:55]
  v_pk_mul_f32 v[56:57], v[24:25], v[56:57]
  v_pk_mul_f32 v[58:59], v[26:27], v[58:59]
  v_pk_mul_f32 v[60:61], v[28:29], v[60:61]
  v_pk_mul_f32 v[62:63], v[30:31], v[62:63]
  v_mfma_f32_16x16x32_bf16 v[116:119], v[216:219], v[220:223], 0
  v_cvt_pk_bf16_f32 v184, v32, v33
  v_cvt_pk_bf16_f32 v185, v34, v35
  v_mfma_f32_16x16x32_bf16 v[116:119], v[224:227], v[228:231], v[116:119]
  v_cvt_pk_bf16_f32 v186, v36, v37
  v_cvt_pk_bf16_f32 v187, v38, v39
  v_mfma_f32_16x16x32_bf16 v[116:119], v[232:235], v[236:239], v[116:119]
  ds_read_b128 v[216:219], v3 offset:800
  ds_read_b128 v[220:223], v4 offset:32
  v_mfma_f32_32x32x16_bf16 v[64:79], v[192:195], v[184:187], v[64:79]
  ds_read_b128 v[224:227], v3 offset:5600
  ds_read_b128 v[228:231], v4 offset:224
  v_cvt_pk_bf16_f32 v188, v40, v41
  v_cvt_pk_bf16_f32 v189, v42, v43
  v_cvt_pk_bf16_f32 v190, v44, v45
  v_cvt_pk_bf16_f32 v191, v46, v47
  v_mfma_f32_32x32x16_bf16 v[80:95], v[196:199], v[184:187], v[80:95]
  ds_read_b128 v[232:235], v3 offset:10400
  ds_read_b128 v[236:239], v4 offset:416
  v_exp_f32 v48, v48
  v_exp_f32 v49, v49
  v_mfma_f32_32x32x16_bf16 v[96:111], v[200:203], v[184:187], v[96:111]
  v_exp_f32 v50, v50
  v_exp_f32 v51, v51
  v_exp_f32_e64 v52, v52
  v_mfma_f32_32x32x16_bf16 v[64:79], v[204:207], v[188:191], v[64:79]
  v_exp_f32 v53, v53
  v_exp_f32 v54, v54
  v_exp_f32_e64 v55, v55
  v_mfma_f32_32x32x16_bf16 v[80:95], v[208:211], v[188:191], v[80:95]
  v_exp_f32 v56, v56
  v_exp_f32 v57, v57
  v_exp_f32_e64 v58, v58
  v_mfma_f32_32x32x16_bf16 v[96:111], v[212:215], v[188:191], v[96:111]
  s_waitcnt lgkmcnt(0)
  v_exp_f32 v59, v59
  v_exp_f32 v60, v60
  v_exp_f32 v61, v61
  v_exp_f32 v62, v62
  v_exp_f32 v63, v63
  v_pk_add_f32 v[12:13], v[12:13], v[116:117]
  v_pk_fma_f32 v[14:15], v[116:117], v[116:117], v[14:15]
  v_pk_add_f32 v[12:13], v[12:13], v[118:119]
  v_pk_fma_f32 v[14:15], v[118:119], v[118:119], v[14:15]
  v_pk_fma_f32 v[48:49], v[48:49], s[22:23], s[22:23]
  v_pk_fma_f32 v[50:51], v[50:51], s[22:23], s[22:23]
  v_pk_fma_f32 v[52:53], v[52:53], s[22:23], s[22:23]
  v_pk_fma_f32 v[54:55], v[54:55], s[22:23], s[22:23]
  v_pk_fma_f32 v[56:57], v[56:57], s[22:23], s[22:23]
  v_pk_fma_f32 v[58:59], v[58:59], s[22:23], s[22:23]
  v_pk_fma_f32 v[60:61], v[60:61], s[22:23], s[22:23]
  v_pk_fma_f32 v[62:63], v[62:63], s[22:23], s[22:23]
  v_mfma_f32_32x32x16_bf16 v[32:47], a[192:195], v[160:163], 0
  ds_read_b128 v[192:195], v0 offset:49152
  ds_read_b128 v[196:199], v0 offset:50176
  v_rcp_f32 v48, v48
  v_rcp_f32 v49, v49
  v_mfma_f32_16x16x32_bf16 v[120:123], v[216:219], v[220:223], 0
  ds_read_b128 v[216:219], v3 offset:1200
  ds_read_b128 v[220:223], v4 offset:48
  v_mfma_f32_32x32x16_bf16 v[32:47], a[196:199], v[164:167], v[32:47]
  ds_read_b128 v[200:203], v0 offset:51200
  ds_read_b128 v[204:207], v0 offset:52224
  v_rcp_f32 v50, v50
  v_rcp_f32 v51, v51
  v_mfma_f32_16x16x32_bf16 v[120:123], v[224:227], v[228:231], v[120:123]
  ds_read_b128 v[224:227], v3 offset:6000
  ds_read_b128 v[228:231], v4 offset:240
  v_mfma_f32_32x32x16_bf16 v[32:47], a[200:203], v[168:171], v[32:47]
  ds_read_b128 v[208:211], v0 offset:53248
  ds_read_b128 v[212:215], v0 offset:54272
  v_rcp_f32 v52, v52
  v_rcp_f32 v53, v53
  v_mfma_f32_16x16x32_bf16 v[120:123], v[232:235], v[236:239], v[120:123]
  ds_read_b128 v[232:235], v3 offset:10800
  ds_read_b128 v[236:239], v4 offset:432
  v_mfma_f32_32x32x16_bf16 v[32:47], a[204:207], v[172:175], v[32:47]
  v_rcp_f32 v54, v54
  v_rcp_f32 v55, v55
  v_rcp_f32_e64 v56, v56
  v_mfma_f32_32x32x16_bf16 v[32:47], a[208:211], v[176:179], v[32:47]
  v_rcp_f32 v57, v57
  v_rcp_f32 v58, v58
  v_rcp_f32_e64 v59, v59
  v_mfma_f32_32x32x16_bf16 v[32:47], a[212:215], v[180:183], v[32:47]
  s_waitcnt lgkmcnt(0)
  v_rcp_f32 v60, v60
  v_rcp_f32 v61, v61
  v_rcp_f32 v62, v62
  v_rcp_f32_e64 v63, v63
  v_pk_mul_f32 v[16:17], v[16:17], v[48:49]
  v_pk_mul_f32 v[18:19], v[18:19], v[50:51]
  v_pk_mul_f32 v[20:21], v[20:21], v[52:53]
  v_pk_mul_f32 v[22:23], v[22:23], v[54:55]
  v_pk_mul_f32 v[24:25], v[24:25], v[56:57]
  v_pk_mul_f32 v[26:27], v[26:27], v[58:59]
  v_pk_mul_f32 v[28:29], v[28:29], v[60:61]
  v_pk_mul_f32 v[30:31], v[30:31], v[62:63]
  v_pk_add_f32 v[12:13], v[12:13], v[120:121]
  v_pk_fma_f32 v[14:15], v[120:121], v[120:121], v[14:15]
  v_pk_add_f32 v[12:13], v[12:13], v[122:123]
  v_pk_fma_f32 v[14:15], v[122:123], v[122:123], v[14:15]
  v_pk_fma_f32 v[48:49], v[32:33], v[32:33], s[20:21] neg_lo:[1,0,1] neg_hi:[1,0,1]
  v_pk_fma_f32 v[50:51], v[34:35], v[34:35], s[20:21] neg_lo:[1,0,1] neg_hi:[1,0,1]
  v_pk_fma_f32 v[52:53], v[36:37], v[36:37], s[20:21] neg_lo:[1,0,1] neg_hi:[1,0,1]
  v_pk_fma_f32 v[54:55], v[38:39], v[38:39], s[20:21] neg_lo:[1,0,1] neg_hi:[1,0,1]
  v_pk_fma_f32 v[56:57], v[40:41], v[40:41], s[20:21] neg_lo:[1,0,1] neg_hi:[1,0,1]
  v_pk_fma_f32 v[58:59], v[42:43], v[42:43], s[20:21] neg_lo:[1,0,1] neg_hi:[1,0,1]
  v_pk_fma_f32 v[60:61], v[44:45], v[44:45], s[20:21] neg_lo:[1,0,1] neg_hi:[1,0,1]
  v_pk_fma_f32 v[62:63], v[46:47], v[46:47], s[20:21] neg_lo:[1,0,1] neg_hi:[1,0,1]
  v_pk_mul_f32 v[48:49], v[32:33], v[48:49]
  v_pk_mul_f32 v[50:51], v[34:35], v[50:51]
  v_pk_mul_f32 v[52:53], v[36:37], v[52:53]
  v_pk_mul_f32 v[54:55], v[38:39], v[54:55]
  v_pk_mul_f32 v[56:57], v[40:41], v[56:57]
  v_pk_mul_f32 v[58:59], v[42:43], v[58:59]
  v_pk_mul_f32 v[60:61], v[44:45], v[60:61]
  v_pk_mul_f32 v[62:63], v[46:47], v[62:63]
  v_mfma_f32_16x16x32_bf16 v[124:127], v[216:219], v[220:223], 0
  v_cvt_pk_bf16_f32 v184, v16, v17
  v_cvt_pk_bf16_f32 v185, v18, v19
  v_mfma_f32_16x16x32_bf16 v[124:127], v[224:227], v[228:231], v[124:127]
  v_cvt_pk_bf16_f32 v186, v20, v21
  v_cvt_pk_bf16_f32 v187, v22, v23
  v_mfma_f32_16x16x32_bf16 v[124:127], v[232:235], v[236:239], v[124:127]
  ds_read_b128 v[216:219], v3 offset:1600
  ds_read_b128 v[220:223], v4 offset:64
  v_mfma_f32_32x32x16_bf16 v[64:79], v[192:195], v[184:187], v[64:79]
  ds_read_b128 v[224:227], v3 offset:6400
  ds_read_b128 v[228:231], v4 offset:256
  v_cvt_pk_bf16_f32 v188, v24, v25
  v_cvt_pk_bf16_f32 v189, v26, v27
  v_cvt_pk_bf16_f32 v190, v28, v29
  v_cvt_pk_bf16_f32 v191, v30, v31
  v_mfma_f32_32x32x16_bf16 v[80:95], v[196:199], v[184:187], v[80:95]
  ds_read_b128 v[232:235], v3 offset:11200
  ds_read_b128 v[236:239], v4 offset:448
  v_exp_f32 v48, v48
  v_exp_f32 v49, v49
  v_mfma_f32_32x32x16_bf16 v[96:111], v[200:203], v[184:187], v[96:111]
  v_exp_f32 v50, v50
  v_exp_f32 v51, v51
  v_exp_f32_e64 v52, v52
  v_mfma_f32_32x32x16_bf16 v[64:79], v[204:207], v[188:191], v[64:79]
  v_exp_f32 v53, v53
  v_exp_f32 v54, v54
  v_exp_f32_e64 v55, v55
  v_mfma_f32_32x32x16_bf16 v[80:95], v[208:211], v[188:191], v[80:95]
  v_exp_f32 v56, v56
  v_exp_f32 v57, v57
  v_exp_f32_e64 v58, v58
  v_mfma_f32_32x32x16_bf16 v[96:111], v[212:215], v[188:191], v[96:111]
  s_waitcnt lgkmcnt(0)
  v_exp_f32 v59, v59
  v_exp_f32 v60, v60
  v_exp_f32 v61, v61
  v_exp_f32 v62, v62
  v_exp_f32 v63, v63
  v_pk_add_f32 v[12:13], v[12:13], v[124:125]
  v_pk_fma_f32 v[14:15], v[124:125], v[124:125], v[14:15]
  v_pk_add_f32 v[12:13], v[12:13], v[126:127]
  v_pk_fma_f32 v[14:15], v[126:127], v[126:127], v[14:15]
  v_pk_fma_f32 v[48:49], v[48:49], s[22:23], s[22:23]
  v_pk_fma_f32 v[50:51], v[50:51], s[22:23], s[22:23]
  v_pk_fma_f32 v[52:53], v[52:53], s[22:23], s[22:23]
  v_pk_fma_f32 v[54:55], v[54:55], s[22:23], s[22:23]
  v_pk_fma_f32 v[56:57], v[56:57], s[22:23], s[22:23]
  v_pk_fma_f32 v[58:59], v[58:59], s[22:23], s[22:23]
  v_pk_fma_f32 v[60:61], v[60:61], s[22:23], s[22:23]
  v_pk_fma_f32 v[62:63], v[62:63], s[22:23], s[22:23]
  v_mfma_f32_32x32x16_bf16 v[16:31], a[216:219], v[160:163], 0
  ds_read_b128 v[192:195], v0 offset:55296
  ds_read_b128 v[196:199], v0 offset:56320
  v_rcp_f32 v48, v48
  v_rcp_f32 v49, v49
  v_mfma_f32_16x16x32_bf16 v[128:131], v[216:219], v[220:223], 0
  ds_read_b128 v[216:219], v3 offset:2000
  ds_read_b128 v[220:223], v4 offset:80
  v_mfma_f32_32x32x16_bf16 v[16:31], a[220:223], v[164:167], v[16:31]
  ds_read_b128 v[200:203], v0 offset:57344
  ds_read_b128 v[204:207], v0 offset:58368
  v_rcp_f32 v50, v50
  v_rcp_f32 v51, v51
  v_mfma_f32_16x16x32_bf16 v[128:131], v[224:227], v[228:231], v[128:131]
  ds_read_b128 v[224:227], v3 offset:6800
  ds_read_b128 v[228:231], v4 offset:272
  v_mfma_f32_32x32x16_bf16 v[16:31], a[224:227], v[168:171], v[16:31]
  ds_read_b128 v[208:211], v0 offset:59392
  ds_read_b128 v[212:215], v0 offset:60416
  v_rcp_f32 v52, v52
  v_rcp_f32 v53, v53
  v_mfma_f32_16x16x32_bf16 v[128:131], v[232:235], v[236:239], v[128:131]
  ds_read_b128 v[232:235], v3 offset:11600
  ds_read_b128 v[236:239], v4 offset:464
  v_mfma_f32_32x32x16_bf16 v[16:31], a[228:231], v[172:175], v[16:31]
  v_rcp_f32 v54, v54
  v_rcp_f32 v55, v55
  v_rcp_f32_e64 v56, v56
  v_mfma_f32_32x32x16_bf16 v[16:31], a[232:235], v[176:179], v[16:31]
  v_rcp_f32 v57, v57
  v_rcp_f32 v58, v58
  v_rcp_f32_e64 v59, v59
  v_mfma_f32_32x32x16_bf16 v[16:31], a[236:239], v[180:183], v[16:31]
  s_waitcnt lgkmcnt(0)
  v_rcp_f32 v60, v60
  v_rcp_f32 v61, v61
  v_rcp_f32 v62, v62
  v_rcp_f32_e64 v63, v63
  v_pk_mul_f32 v[32:33], v[32:33], v[48:49]
  v_pk_mul_f32 v[34:35], v[34:35], v[50:51]
  v_pk_mul_f32 v[36:37], v[36:37], v[52:53]
  v_pk_mul_f32 v[38:39], v[38:39], v[54:55]
  v_pk_mul_f32 v[40:41], v[40:41], v[56:57]
  v_pk_mul_f32 v[42:43], v[42:43], v[58:59]
  v_pk_mul_f32 v[44:45], v[44:45], v[60:61]
  v_pk_mul_f32 v[46:47], v[46:47], v[62:63]
  v_pk_add_f32 v[12:13], v[12:13], v[128:129]
  v_pk_fma_f32 v[14:15], v[128:129], v[128:129], v[14:15]
  v_pk_add_f32 v[12:13], v[12:13], v[130:131]
  v_pk_fma_f32 v[14:15], v[130:131], v[130:131], v[14:15]
  v_pk_fma_f32 v[48:49], v[16:17], v[16:17], s[20:21] neg_lo:[1,0,1] neg_hi:[1,0,1]
  v_pk_fma_f32 v[50:51], v[18:19], v[18:19], s[20:21] neg_lo:[1,0,1] neg_hi:[1,0,1]
  v_pk_fma_f32 v[52:53], v[20:21], v[20:21], s[20:21] neg_lo:[1,0,1] neg_hi:[1,0,1]
  v_pk_fma_f32 v[54:55], v[22:23], v[22:23], s[20:21] neg_lo:[1,0,1] neg_hi:[1,0,1]
  v_pk_fma_f32 v[56:57], v[24:25], v[24:25], s[20:21] neg_lo:[1,0,1] neg_hi:[1,0,1]
  v_pk_fma_f32 v[58:59], v[26:27], v[26:27], s[20:21] neg_lo:[1,0,1] neg_hi:[1,0,1]
  v_pk_fma_f32 v[60:61], v[28:29], v[28:29], s[20:21] neg_lo:[1,0,1] neg_hi:[1,0,1]
  v_pk_fma_f32 v[62:63], v[30:31], v[30:31], s[20:21] neg_lo:[1,0,1] neg_hi:[1,0,1]
  v_pk_mul_f32 v[48:49], v[16:17], v[48:49]
  v_pk_mul_f32 v[50:51], v[18:19], v[50:51]
  v_pk_mul_f32 v[52:53], v[20:21], v[52:53]
  v_pk_mul_f32 v[54:55], v[22:23], v[54:55]
  v_pk_mul_f32 v[56:57], v[24:25], v[56:57]
  v_pk_mul_f32 v[58:59], v[26:27], v[58:59]
  v_pk_mul_f32 v[60:61], v[28:29], v[60:61]
  v_pk_mul_f32 v[62:63], v[30:31], v[62:63]
  v_mfma_f32_16x16x32_bf16 v[132:135], v[216:219], v[220:223], 0
  v_cvt_pk_bf16_f32 v184, v32, v33
  v_cvt_pk_bf16_f32 v185, v34, v35
  v_mfma_f32_16x16x32_bf16 v[132:135], v[224:227], v[228:231], v[132:135]
  v_cvt_pk_bf16_f32 v186, v36, v37
  v_cvt_pk_bf16_f32 v187, v38, v39
  v_mfma_f32_16x16x32_bf16 v[132:135], v[232:235], v[236:239], v[132:135]
  ds_read_b128 v[216:219], v0 offset:12288
  ds_read_b128 v[220:223], v0 offset:13312
  v_mfma_f32_32x32x16_bf16 v[64:79], v[192:195], v[184:187], v[64:79]
  ds_read_b128 v[224:227], v0 offset:14336
  ds_read_b128 v[228:231], v0 offset:15360
  v_cvt_pk_bf16_f32 v188, v40, v41
  v_cvt_pk_bf16_f32 v189, v42, v43
  v_cvt_pk_bf16_f32 v190, v44, v45
  v_cvt_pk_bf16_f32 v191, v46, v47
  v_mfma_f32_32x32x16_bf16 v[80:95], v[196:199], v[184:187], v[80:95]
  ds_read_b128 v[232:235], v0 offset:16384
  ds_read_b128 v[236:239], v0 offset:17408
  v_exp_f32 v48, v48
  v_exp_f32 v49, v49
  v_mfma_f32_32x32x16_bf16 v[96:111], v[200:203], v[184:187], v[96:111]
  v_exp_f32 v50, v50
  v_exp_f32 v51, v51
  v_exp_f32_e64 v52, v52
  v_mfma_f32_32x32x16_bf16 v[64:79], v[204:207], v[188:191], v[64:79]
  s_mov_b32 s28, s34
  v_exp_f32 v53, v53
  v_exp_f32 v54, v54
  v_exp_f32 v55, v55
  v_mfma_f32_32x32x16_bf16 v[80:95], v[208:211], v[188:191], v[80:95]
  s_add_u32 s34, s34, 0x60000
  v_exp_f32 v56, v56
  v_exp_f32 v57, v57
  v_exp_f32_e64 v58, v58
  v_mfma_f32_32x32x16_bf16 v[96:111], v[212:215], v[188:191], v[96:111]
  s_waitcnt lgkmcnt(0)
  v_exp_f32 v59, v59
  v_exp_f32 v60, v60
  v_exp_f32 v61, v61
  v_exp_f32 v62, v62
  v_exp_f32 v63, v63
  v_pk_add_f32 v[12:13], v[12:13], v[132:133]
  v_pk_fma_f32 v[14:15], v[132:133], v[132:133], v[14:15]
  v_pk_add_f32 v[12:13], v[12:13], v[134:135]
  v_pk_fma_f32 v[14:15], v[134:135], v[134:135], v[14:15]
  v_pk_fma_f32 v[48:49], v[48:49], s[22:23], s[22:23]
  v_pk_fma_f32 v[50:51], v[50:51], s[22:23], s[22:23]
  v_pk_fma_f32 v[52:53], v[52:53], s[22:23], s[22:23]
  v_pk_fma_f32 v[54:55], v[54:55], s[22:23], s[22:23]
  v_pk_fma_f32 v[56:57], v[56:57], s[22:23], s[22:23]
  v_pk_fma_f32 v[58:59], v[58:59], s[22:23], s[22:23]
  v_pk_fma_f32 v[60:61], v[60:61], s[22:23], s[22:23]
  v_pk_fma_f32 v[62:63], v[62:63], s[22:23], s[22:23]
  v_mfma_f32_32x32x16_bf16 v[32:47], v[216:219], v[160:163], 0
  ds_read_b128 v[192:195], v0 offset:61440
  ds_read_b128 v[196:199], v0 offset:62464
  v_rcp_f32 v48, v48
  v_rcp_f32 v49, v49
  v_add_f32_e64 v12, v12, v13
  v_mfma_f32_32x32x16_bf16 v[32:47], v[220:223], v[164:167], v[32:47]
  ds_read_b128 v[200:203], v0 offset:63488
  ds_read_b128 v[204:207], v0 offset:64512
  v_rcp_f32 v50, v50
  v_add_f32 v14, v14, v15
  v_rcp_f32_e64 v51, v51
  v_mfma_f32_32x32x16_bf16 v[32:47], v[224:227], v[168:171], v[32:47]
  ds_read_b128 v[208:211], v1
  ds_read_b128 v[212:215], v1 offset:1024
  v_permlane32_swap_b32 v12, v14
  v_rcp_f32 v52, v52
  v_add_f32 v12, v12, v14
  v_rcp_f32 v53, v53
  v_mfma_f32_32x32x16_bf16 v[32:47], v[228:231], v[172:175], v[32:47]
  v_mov_b32 v14, v12
  v_rcp_f32 v54, v54
  s_nop 0
  v_permlane32_swap_b32 v12, v14
  v_rcp_f32 v55, v55
  v_mul_f32 v12, s24, v12
  v_mfma_f32_32x32x16_bf16 v[32:47], v[232:235], v[176:179], v[32:47]
  v_rcp_f32 v56, v56
  v_rcp_f32 v57, v57
  v_mul_f32 v13, s24, v14
  v_rcp_f32 v58, v58
  v_fma_f32 v13, -v12, v12, v13
  v_mfma_f32_32x32x16_bf16 v[32:47], v[236:239], v[180:183], v[32:47]
  s_waitcnt lgkmcnt(0)
  v_rcp_f32 v59, v59
  v_max_f32 v13, 0, v13
  v_rcp_f32 v60, v60
  v_add_f32 v13, s25, v13
  v_rcp_f32 v61, v61
  v_rsq_f32 v13, v13
  v_rcp_f32 v62, v62
  v_mul_f32 v14, s22, v13
  v_rcp_f32 v63, v63
  v_mul_f32_e64 v12, -v12, v14
  v_pk_mul_f32 v[16:17], v[16:17], v[48:49]
  v_pk_mul_f32 v[18:19], v[18:19], v[50:51]
  v_pk_mul_f32 v[20:21], v[20:21], v[52:53]
  v_pk_mul_f32 v[22:23], v[22:23], v[54:55]
  v_pk_mul_f32 v[24:25], v[24:25], v[56:57]
  v_pk_mul_f32 v[26:27], v[26:27], v[58:59]
  v_pk_mul_f32 v[28:29], v[28:29], v[60:61]
  v_pk_mul_f32 v[30:31], v[30:31], v[62:63]
  v_pk_fma_f32 v[112:113], v[112:113], v[14:15], v[12:13] op_sel_hi:[1,0,0]
  v_pk_fma_f32 v[114:115], v[114:115], v[14:15], v[12:13] op_sel_hi:[1,0,0]
  v_pk_fma_f32 v[116:117], v[116:117], v[14:15], v[12:13] op_sel_hi:[1,0,0]
  v_pk_fma_f32 v[118:119], v[118:119], v[14:15], v[12:13] op_sel_hi:[1,0,0]
  v_pk_fma_f32 v[120:121], v[120:121], v[14:15], v[12:13] op_sel_hi:[1,0,0]
  v_pk_fma_f32 v[122:123], v[122:123], v[14:15], v[12:13] op_sel_hi:[1,0,0]
  v_pk_fma_f32 v[124:125], v[124:125], v[14:15], v[12:13] op_sel_hi:[1,0,0]
  v_pk_fma_f32 v[126:127], v[126:127], v[14:15], v[12:13] op_sel_hi:[1,0,0]
  v_pk_fma_f32 v[128:129], v[128:129], v[14:15], v[12:13] op_sel_hi:[1,0,0]
  v_pk_fma_f32 v[130:131], v[130:131], v[14:15], v[12:13] op_sel_hi:[1,0,0]
  v_pk_fma_f32 v[132:133], v[132:133], v[14:15], v[12:13] op_sel_hi:[1,0,0]
  v_pk_fma_f32 v[134:135], v[134:135], v[14:15], v[12:13] op_sel_hi:[1,0,0]
  v_pk_fma_f32 v[136:137], v[136:137], v[14:15], v[12:13] op_sel_hi:[1,0,0]
  v_pk_fma_f32 v[138:139], v[138:139], v[14:15], v[12:13] op_sel_hi:[1,0,0]
  v_pk_fma_f32 v[140:141], v[140:141], v[14:15], v[12:13] op_sel_hi:[1,0,0]
  v_pk_fma_f32 v[142:143], v[142:143], v[14:15], v[12:13] op_sel_hi:[1,0,0]
  v_pk_fma_f32 v[144:145], v[144:145], v[14:15], v[12:13] op_sel_hi:[1,0,0]
  v_pk_fma_f32 v[146:147], v[146:147], v[14:15], v[12:13] op_sel_hi:[1,0,0]
  v_pk_fma_f32 v[148:149], v[148:149], v[14:15], v[12:13] op_sel_hi:[1,0,0]
  v_pk_fma_f32 v[150:151], v[150:151], v[14:15], v[12:13] op_sel_hi:[1,0,0]
  v_pk_fma_f32 v[152:153], v[152:153], v[14:15], v[12:13] op_sel_hi:[1,0,0]
  v_pk_fma_f32 v[154:155], v[154:155], v[14:15], v[12:13] op_sel_hi:[1,0,0]
  v_pk_fma_f32 v[156:157], v[156:157], v[14:15], v[12:13] op_sel_hi:[1,0,0]
  v_pk_fma_f32 v[158:159], v[158:159], v[14:15], v[12:13] op_sel_hi:[1,0,0]
  v_pk_fma_f32 v[48:49], v[32:33], v[32:33], s[20:21] neg_lo:[1,0,1] neg_hi:[1,0,1]
  v_pk_fma_f32 v[50:51], v[34:35], v[34:35], s[20:21] neg_lo:[1,0,1] neg_hi:[1,0,1]
  v_pk_fma_f32 v[52:53], v[36:37], v[36:37], s[20:21] neg_lo:[1,0,1] neg_hi:[1,0,1]
  v_pk_fma_f32 v[54:55], v[38:39], v[38:39], s[20:21] neg_lo:[1,0,1] neg_hi:[1,0,1]
  v_pk_fma_f32 v[56:57], v[40:41], v[40:41], s[20:21] neg_lo:[1,0,1] neg_hi:[1,0,1]
  v_pk_fma_f32 v[58:59], v[42:43], v[42:43], s[20:21] neg_lo:[1,0,1] neg_hi:[1,0,1]
  v_pk_fma_f32 v[60:61], v[44:45], v[44:45], s[20:21] neg_lo:[1,0,1] neg_hi:[1,0,1]
  v_pk_fma_f32 v[62:63], v[46:47], v[46:47], s[20:21] neg_lo:[1,0,1] neg_hi:[1,0,1]
  v_pk_mul_f32 v[48:49], v[32:33], v[48:49]
  v_pk_mul_f32 v[50:51], v[34:35], v[50:51]
  v_pk_mul_f32 v[52:53], v[36:37], v[52:53]
  v_pk_mul_f32 v[54:55], v[38:39], v[54:55]
  v_pk_mul_f32 v[56:57], v[40:41], v[56:57]
  v_cvt_pk_bf16_f32 v184, v16, v17
  v_cvt_pk_bf16_f32 v185, v18, v19
  v_cvt_pk_bf16_f32 v186, v20, v21
  v_cvt_pk_bf16_f32 v187, v22, v23
  v_pk_mul_f32 v[58:59], v[42:43], v[58:59]
  v_pk_mul_f32 v[60:61], v[44:45], v[60:61]
  v_pk_mul_f32 v[62:63], v[46:47], v[62:63]
  v_mfma_f32_32x32x16_bf16 v[64:79], v[192:195], v[184:187], v[64:79]
  ds_read_b128 v[216:219], v0 offset:18432
  ds_read_b128 v[220:223], v0 offset:19456
  v_cvt_pk_bf16_f32 v188, v24, v25
  v_cvt_pk_bf16_f32 v189, v26, v27
  v_cvt_pk_bf16_f32 v190, v28, v29
  v_cvt_pk_bf16_f32 v191, v30, v31
  v_exp_f32_e64 v48, v48
  v_cndmask_b32 v159, v159, v250, s[12:13]
  v_mfma_f32_32x32x16_bf16 v[80:95], v[196:199], v[184:187], v[80:95]
  ds_read_b128 v[224:227], v0 offset:20480
  ds_read_b128 v[228:231], v0 offset:21504
  v_exp_f32_e64 v49, v49
  v_cvt_pk_bf16_f32 v160, v112, v113
  v_cvt_pk_bf16_f32 v161, v114, v115
  v_exp_f32_e64 v50, v50
  v_cvt_pk_bf16_f32 v162, v116, v117
  v_mfma_f32_32x32x16_bf16 v[96:111], v[200:203], v[184:187], v[96:111]
  ds_read_b128 v[232:235], v0 offset:22528
  ds_read_b128 v[236:239], v0 offset:23552
  v_exp_f32_e64 v51, v51
  v_cvt_pk_bf16_f32 v163, v118, v119
  v_cvt_pk_bf16_f32 v164, v120, v121
  v_exp_f32_e64 v52, v52
  v_cvt_pk_bf16_f32 v165, v122, v123
  v_mfma_f32_32x32x16_bf16 v[64:79], v[204:207], v[188:191], v[64:79]
  v_exp_f32_e64 v53, v53
  v_cvt_pk_bf16_f32 v166, v124, v125
  v_cvt_pk_bf16_f32 v167, v126, v127
  v_exp_f32_e64 v54, v54
  v_cvt_pk_bf16_f32 v168, v128, v129
  v_exp_f32_e64 v55, v55
  v_cvt_pk_bf16_f32 v169, v130, v131
  v_cvt_pk_bf16_f32 v170, v132, v133
  v_mfma_f32_32x32x16_bf16 v[80:95], v[208:211], v[188:191], v[80:95]
  v_exp_f32_e64 v56, v56
  v_cvt_pk_bf16_f32 v171, v134, v135
  v_cvt_pk_bf16_f32 v172, v136, v137
  v_exp_f32_e64 v57, v57
  v_cvt_pk_bf16_f32 v173, v138, v139
  v_exp_f32_e64 v58, v58
  v_cvt_pk_bf16_f32 v174, v140, v141
  v_cvt_pk_bf16_f32 v175, v142, v143
  v_mfma_f32_32x32x16_bf16 v[96:111], v[212:215], v[188:191], v[96:111]
  s_waitcnt lgkmcnt(0)
  v_exp_f32 v59, v59
  v_cvt_pk_bf16_f32 v176, v144, v145
  v_exp_f32_e64 v60, v60
  v_cvt_pk_bf16_f32 v177, v146, v147
  v_cvt_pk_bf16_f32 v178, v148, v149
  v_exp_f32_e64 v61, v61
  v_cvt_pk_bf16_f32 v179, v150, v151
  v_exp_f32_e64 v62, v62
  v_cvt_pk_bf16_f32 v180, v152, v153
  v_cvt_pk_bf16_f32 v181, v154, v155
  v_exp_f32_e64 v63, v63
  v_cvt_pk_bf16_f32 v182, v156, v157
  v_cvt_pk_bf16_f32 v183, v158, v159
  v_pk_fma_f32 v[48:49], v[48:49], s[22:23], s[22:23]
  v_pk_fma_f32 v[50:51], v[50:51], s[22:23], s[22:23]
  v_pk_fma_f32 v[52:53], v[52:53], s[22:23], s[22:23]
  v_pk_fma_f32 v[54:55], v[54:55], s[22:23], s[22:23]
  v_pk_fma_f32 v[56:57], v[56:57], s[22:23], s[22:23]
  v_pk_fma_f32 v[58:59], v[58:59], s[22:23], s[22:23]
  v_pk_fma_f32 v[60:61], v[60:61], s[22:23], s[22:23]
  v_pk_fma_f32 v[62:63], v[62:63], s[22:23], s[22:23]
  s_mov_b32 s26, 6
  .p2align 6
  s_waitcnt vmcnt(0)
S_loop:
  v_mfma_f32_32x32x16_bf16 v[16:31], v[216:219], v[160:163], 0
  s_nop 0
  ds_read_b128 v[192:195], v1 offset:2048
  ds_read_b128 v[196:199], v1 offset:3072
  ds_read_b128 v[200:203], v1 offset:4096
  v_rcp_f32 v48, v48
  v_rcp_f32 v49, v49
  v_mfma_f32_32x32x16_bf16 v[16:31], v[220:223], v[164:167], v[16:31]
  ds_read_b128 v[204:207], v1 offset:5120
  ds_read_b128 v[208:211], v1 offset:6144
  ds_read_b128 v[212:215], v1 offset:7168
  v_rcp_f32 v50, v50
  v_rcp_f32 v51, v51
  v_mfma_f32_32x32x16_bf16 v[16:31], v[224:227], v[168:171], v[16:31]
  ds_read_b128 v[136:139], v5
  ds_read_b128 v[140:143], v5 offset:32
  ds_read_b128 v[144:147], v5 offset:64
  v_rcp_f32 v52, v52
  v_rcp_f32 v53, v53
  v_mfma_f32_32x32x16_bf16 v[16:31], v[228:231], v[172:175], v[16:31]
  ds_read_b128 v[148:151], v5 offset:96
  ds_read_b128 v[152:155], v5 offset:128
  ds_read_b128 v[156:159], v5 offset:160
  v_rcp_f32 v54, v54
  v_rcp_f32 v55, v55
  v_mfma_f32_32x32x16_bf16 v[16:31], v[232:235], v[176:179], v[16:31]
  v_rcp_f32 v56, v56
  v_rcp_f32 v57, v57
  v_rcp_f32_e64 v58, v58
  v_mfma_f32_32x32x16_bf16 v[16:31], v[236:239], v[180:183], v[16:31]
  s_waitcnt lgkmcnt(0)
  v_rcp_f32 v59, v59
  v_rcp_f32 v60, v60
  v_rcp_f32 v61, v61
  v_rcp_f32 v62, v62
  v_rcp_f32 v63, v63
  v_pk_mul_f32 v[32:33], v[32:33], v[48:49]
  v_pk_mul_f32 v[34:35], v[34:35], v[50:51]
  v_pk_mul_f32 v[36:37], v[36:37], v[52:53]
  v_pk_mul_f32 v[38:39], v[38:39], v[54:55]
  v_pk_mul_f32 v[40:41], v[40:41], v[56:57]
  v_pk_mul_f32 v[42:43], v[42:43], v[58:59]
  v_pk_mul_f32 v[44:45], v[44:45], v[60:61]
  v_pk_mul_f32 v[46:47], v[46:47], v[62:63]
  v_pk_fma_f32 v[48:49], v[16:17], v[16:17], s[20:21] neg_lo:[1,0,1] neg_hi:[1,0,1]
  v_pk_fma_f32 v[50:51], v[18:19], v[18:19], s[20:21] neg_lo:[1,0,1] neg_hi:[1,0,1]
  v_pk_fma_f32 v[52:53], v[20:21], v[20:21], s[20:21] neg_lo:[1,0,1] neg_hi:[1,0,1]
  v_pk_fma_f32 v[54:55], v[22:23], v[22:23], s[20:21] neg_lo:[1,0,1] neg_hi:[1,0,1]
  v_pk_fma_f32 v[56:57], v[24:25], v[24:25], s[20:21] neg_lo:[1,0,1] neg_hi:[1,0,1]
  v_pk_fma_f32 v[58:59], v[26:27], v[26:27], s[20:21] neg_lo:[1,0,1] neg_hi:[1,0,1]
  v_pk_fma_f32 v[60:61], v[28:29], v[28:29], s[20:21] neg_lo:[1,0,1] neg_hi:[1,0,1]
  v_pk_fma_f32 v[62:63], v[30:31], v[30:31], s[20:21] neg_lo:[1,0,1] neg_hi:[1,0,1]
  v_pk_mul_f32 v[48:49], v[16:17], v[48:49]
  v_pk_mul_f32 v[50:51], v[18:19], v[50:51]
  v_pk_mul_f32 v[52:53], v[20:21], v[52:53]
  v_pk_mul_f32 v[54:55], v[22:23], v[54:55]
  v_pk_mul_f32 v[56:57], v[24:25], v[56:57]
  v_cvt_pk_bf16_f32 v184, v32, v33
  v_cvt_pk_bf16_f32 v185, v34, v35
  v_cvt_pk_bf16_f32 v186, v36, v37
  v_cvt_pk_bf16_f32 v187, v38, v39
  v_pk_mul_f32 v[58:59], v[26:27], v[58:59]
  v_pk_mul_f32 v[60:61], v[28:29], v[60:61]
  v_pk_mul_f32 v[62:63], v[30:31], v[62:63]
  v_mfma_f32_32x32x16_bf16 v[64:79], v[192:195], v[184:187], v[64:79]
  s_mov_b32 m0, s30
  v_cvt_pk_bf16_f32 v188, v40, v41
  v_cvt_pk_bf16_f32 v189, v42, v43
  v_cvt_pk_bf16_f32 v190, v44, v45
  v_cvt_pk_bf16_f32 v191, v46, v47
  v_exp_f32 v48, v48
  v_mfma_f32_32x32x16_bf16 v[80:95], v[196:199], v[184:187], v[80:95]
  buffer_load_dwordx4 v6, s[4:7], s29 offen lds
  v_exp_f32 v49, v49
  v_exp_f32 v50, v50
  v_exp_f32_e64 v51, v51
  v_mfma_f32_32x32x16_bf16 v[96:111], v[200:203], v[184:187], v[96:111]
  buffer_load_dwordx4 v7, s[4:7], s29 offen offset:1024 lds
  v_exp_f32 v52, v52
  v_exp_f32 v53, v53
  v_mfma_f32_32x32x16_bf16 v[64:79], v[204:207], v[188:191], v[64:79]
  buffer_load_dwordx4 v8, s[4:7], s29 offen offset:2048 lds
  v_exp_f32 v54, v54
  v_exp_f32 v55, v55
  v_exp_f32_e64 v56, v56
  v_mfma_f32_32x32x16_bf16 v[80:95], v[208:211], v[188:191], v[80:95]
  buffer_load_dwordx4 v9, s[4:7], s29 offen offset:3072 lds
  v_exp_f32 v57, v57
  v_exp_f32 v58, v58
  v_mfma_f32_32x32x16_bf16 v[96:111], v[212:215], v[188:191], v[96:111]
  v_exp_f32 v59, v59
  v_exp_f32 v60, v60
  v_exp_f32 v61, v61
  v_exp_f32 v62, v62
  v_exp_f32_e64 v63, v63
  v_pk_fma_f32 v[48:49], v[48:49], s[22:23], s[22:23]
  v_pk_fma_f32 v[50:51], v[50:51], s[22:23], s[22:23]
  v_pk_fma_f32 v[52:53], v[52:53], s[22:23], s[22:23]
  v_pk_fma_f32 v[54:55], v[54:55], s[22:23], s[22:23]
  v_pk_fma_f32 v[56:57], v[56:57], s[22:23], s[22:23]
  v_pk_fma_f32 v[58:59], v[58:59], s[22:23], s[22:23]
  v_pk_fma_f32 v[60:61], v[60:61], s[22:23], s[22:23]
  v_pk_fma_f32 v[62:63], v[62:63], s[22:23], s[22:23]
  v_mfma_f32_32x32x16_bf16 v[32:47], a[0:3], v[160:163], 0
  v_cvt_pk_bf16_f32 v112, v64, v65
  v_cvt_pk_bf16_f32 v113, v66, v67
  v_cvt_pk_bf16_f32 v114, v68, v69
  v_cvt_pk_bf16_f32 v115, v70, v71
  v_cvt_pk_bf16_f32 v116, v72, v73
  v_cvt_pk_bf16_f32 v117, v74, v75
  v_mfma_f32_32x32x16_bf16 v[32:47], a[4:7], v[164:167], v[32:47]
  v_cvt_pk_bf16_f32 v118, v76, v77
  v_cvt_pk_bf16_f32 v119, v78, v79
  v_cvt_pk_bf16_f32 v120, v80, v81
  v_cvt_pk_bf16_f32 v121, v82, v83
  v_cvt_pk_bf16_f32 v122, v84, v85
  v_cvt_pk_bf16_f32 v123, v86, v87
  v_mfma_f32_32x32x16_bf16 v[32:47], a[8:11], v[168:171], v[32:47]
  ds_read_b128 v[64:67], v2
  ds_read_b128 v[68:71], v2 offset:32
  ds_read_b128 v[72:75], v2 offset:64
  ds_read_b128 v[76:79], v2 offset:96
  v_cvt_pk_bf16_f32 v124, v88, v89
  v_cvt_pk_bf16_f32 v125, v90, v91
  v_mfma_f32_32x32x16_bf16 v[32:47], a[12:15], v[172:175], v[32:47]
  ds_read_b128 v[192:195], v1 offset:8192
  ds_read_b128 v[196:199], v1 offset:9216
  v_cvt_pk_bf16_f32 v126, v92, v93
  v_cvt_pk_bf16_f32 v127, v94, v95
  v_cvt_pk_bf16_f32 v128, v96, v97
  v_cvt_pk_bf16_f32 v129, v98, v99
  v_mfma_f32_32x32x16_bf16 v[32:47], a[16:19], v[176:179], v[32:47]
  ds_read_b128 v[80:83], v2 offset:128
  ds_read_b128 v[84:87], v2 offset:160
  ds_read_b128 v[88:91], v2 offset:192
  ds_read_b128 v[92:95], v2 offset:224
  v_cvt_pk_bf16_f32 v130, v100, v101
  v_cvt_pk_bf16_f32 v131, v102, v103
  v_mfma_f32_32x32x16_bf16 v[32:47], a[20:23], v[180:183], v[32:47]
  s_waitcnt lgkmcnt(6)
  ds_read_b128 v[200:203], v1 offset:10240
  ds_read_b128 v[204:207], v1 offset:11264
  v_cvt_pk_bf16_f32 v132, v104, v105
  v_cvt_pk_bf16_f32 v133, v106, v107
  v_cvt_pk_bf16_f32 v134, v108, v109
  v_cvt_pk_bf16_f32 v135, v110, v111
  v_mfma_f32_32x32x16_bf16 v[64:79], v[240:243], v[136:139], v[64:79]
  s_nop 0
  ds_read_b128 v[96:99], v2 offset:256
  ds_read_b128 v[100:103], v2 offset:288
  ds_read_b128 v[104:107], v2 offset:320
  ds_read_b128 v[108:111], v2 offset:352
  v_rcp_f32 v48, v48
  v_mfma_f32_32x32x16_bf16 v[64:79], v[244:247], v[140:143], v[64:79]
  s_waitcnt lgkmcnt(6)
  ds_read_b128 v[208:211], v1 offset:12288
  ds_read_b128 v[212:215], v1 offset:13312
  v_rcp_f32 v49, v49
  v_rcp_f32 v50, v50
  v_mfma_f32_32x32x16_bf16 v[80:95], v[240:243], v[144:147], v[80:95]
  v_rcp_f32 v51, v51
  v_rcp_f32 v52, v52
  v_rcp_f32_e64 v53, v53
  v_mfma_f32_32x32x16_bf16 v[80:95], v[244:247], v[148:151], v[80:95]
  s_waitcnt lgkmcnt(2)
  v_rcp_f32 v54, v54
  v_rcp_f32 v55, v55
  v_rcp_f32 v56, v56
  v_mfma_f32_32x32x16_bf16 v[96:111], v[240:243], v[152:155], v[96:111]
  v_rcp_f32 v57, v57
  v_rcp_f32 v58, v58
  v_rcp_f32_e64 v59, v59
  v_mfma_f32_32x32x16_bf16 v[96:111], v[244:247], v[156:159], v[96:111]
  s_waitcnt lgkmcnt(0)
  v_rcp_f32 v60, v60
  v_rcp_f32 v61, v61
  v_rcp_f32 v62, v62
  v_rcp_f32_e64 v63, v63
  v_pk_mul_f32 v[16:17], v[16:17], v[48:49]
  v_pk_mul_f32 v[18:19], v[18:19], v[50:51]
  v_pk_mul_f32 v[20:21], v[20:21], v[52:53]
  v_pk_mul_f32 v[22:23], v[22:23], v[54:55]
  v_pk_mul_f32 v[24:25], v[24:25], v[56:57]
  v_pk_mul_f32 v[26:27], v[26:27], v[58:59]
  v_pk_mul_f32 v[28:29], v[28:29], v[60:61]
  v_pk_mul_f32 v[30:31], v[30:31], v[62:63]
  v_pk_fma_f32 v[48:49], v[32:33], v[32:33], s[20:21] neg_lo:[1,0,1] neg_hi:[1,0,1]
  v_pk_fma_f32 v[50:51], v[34:35], v[34:35], s[20:21] neg_lo:[1,0,1] neg_hi:[1,0,1]
  v_pk_fma_f32 v[52:53], v[36:37], v[36:37], s[20:21] neg_lo:[1,0,1] neg_hi:[1,0,1]
  v_pk_fma_f32 v[54:55], v[38:39], v[38:39], s[20:21] neg_lo:[1,0,1] neg_hi:[1,0,1]
  v_pk_fma_f32 v[56:57], v[40:41], v[40:41], s[20:21] neg_lo:[1,0,1] neg_hi:[1,0,1]
  v_pk_fma_f32 v[58:59], v[42:43], v[42:43], s[20:21] neg_lo:[1,0,1] neg_hi:[1,0,1]
  v_pk_fma_f32 v[60:61], v[44:45], v[44:45], s[20:21] neg_lo:[1,0,1] neg_hi:[1,0,1]
  v_pk_fma_f32 v[62:63], v[46:47], v[46:47], s[20:21] neg_lo:[1,0,1] neg_hi:[1,0,1]
  v_pk_mul_f32 v[48:49], v[32:33], v[48:49]
  v_pk_mul_f32 v[50:51], v[34:35], v[50:51]
  v_pk_mul_f32 v[52:53], v[36:37], v[52:53]
  v_pk_mul_f32 v[54:55], v[38:39], v[54:55]
  v_pk_mul_f32 v[56:57], v[40:41], v[56:57]
  v_cvt_pk_bf16_f32 v184, v16, v17
  v_cvt_pk_bf16_f32 v185, v18, v19
  v_cvt_pk_bf16_f32 v186, v20, v21
  v_cvt_pk_bf16_f32 v187, v22, v23
  v_pk_mul_f32 v[58:59], v[42:43], v[58:59]
  v_pk_mul_f32 v[60:61], v[44:45], v[60:61]
  v_pk_mul_f32 v[62:63], v[46:47], v[62:63]
  v_mfma_f32_32x32x16_bf16 v[64:79], v[192:195], v[184:187], v[64:79]
  s_mov_b32 m0, s31
  v_cvt_pk_bf16_f32 v188, v24, v25
  v_cvt_pk_bf16_f32 v189, v26, v27
  v_cvt_pk_bf16_f32 v190, v28, v29
  v_cvt_pk_bf16_f32 v191, v30, v31
  v_exp_f32 v48, v48
  v_mfma_f32_32x32x16_bf16 v[80:95], v[196:199], v[184:187], v[80:95]
  buffer_load_dwordx4 v6, s[4:7], s52 offen lds
  v_exp_f32 v49, v49
  v_exp_f32 v50, v50
  v_exp_f32_e64 v51, v51
  v_mfma_f32_32x32x16_bf16 v[96:111], v[200:203], v[184:187], v[96:111]
  buffer_load_dwordx4 v7, s[4:7], s52 offen offset:1024 lds
  v_exp_f32 v52, v52
  v_exp_f32 v53, v53
  v_mfma_f32_32x32x16_bf16 v[64:79], v[204:207], v[188:191], v[64:79]
  buffer_load_dwordx4 v8, s[4:7], s52 offen offset:2048 lds
  v_exp_f32 v54, v54
  v_exp_f32 v55, v55
  v_exp_f32_e64 v56, v56
  v_mfma_f32_32x32x16_bf16 v[80:95], v[208:211], v[188:191], v[80:95]
  buffer_load_dwordx4 v9, s[4:7], s52 offen offset:3072 lds
  v_exp_f32 v57, v57
  v_exp_f32 v58, v58
  v_mfma_f32_32x32x16_bf16 v[96:111], v[212:215], v[188:191], v[96:111]
  v_exp_f32 v59, v59
  v_exp_f32 v60, v60
  v_exp_f32 v61, v61
  v_exp_f32 v62, v62
  v_exp_f32_e64 v63, v63
  v_pk_fma_f32 v[48:49], v[48:49], s[22:23], s[22:23]
  v_pk_fma_f32 v[50:51], v[50:51], s[22:23], s[22:23]
  v_pk_fma_f32 v[52:53], v[52:53], s[22:23], s[22:23]
  v_pk_fma_f32 v[54:55], v[54:55], s[22:23], s[22:23]
  v_pk_fma_f32 v[56:57], v[56:57], s[22:23], s[22:23]
  v_pk_fma_f32 v[58:59], v[58:59], s[22:23], s[22:23]
  v_pk_fma_f32 v[60:61], v[60:61], s[22:23], s[22:23]
  v_pk_fma_f32 v[62:63], v[62:63], s[22:23], s[22:23]
  v_mfma_f32_32x32x16_bf16 v[16:31], a[24:27], v[160:163], 0
  ds_read_b128 v[192:195], v1 offset:14336
  ds_read_b128 v[196:199], v1 offset:15360
  v_rcp_f32 v48, v48
  v_rcp_f32 v49, v49
  v_mfma_f32_32x32x16_bf16 v[16:31], a[28:31], v[164:167], v[16:31]
  ds_read_b128 v[200:203], v1 offset:16384
  ds_read_b128 v[204:207], v1 offset:17408
  v_rcp_f32 v50, v50
  v_rcp_f32 v51, v51
  v_mfma_f32_32x32x16_bf16 v[16:31], a[32:35], v[168:171], v[16:31]
  ds_read_b128 v[208:211], v1 offset:18432
  ds_read_b128 v[212:215], v1 offset:19456
  v_rcp_f32 v52, v52
  v_rcp_f32 v53, v53
  v_mfma_f32_32x32x16_bf16 v[16:31], a[36:39], v[172:175], v[16:31]
  buffer_store_dwordx4 v[112:115], v10, s[8:11], s28 offen
  v_rcp_f32 v54, v54
  v_rcp_f32 v55, v55
  v_mfma_f32_32x32x16_bf16 v[16:31], a[40:43], v[176:179], v[16:31]
  v_rcp_f32 v56, v56
  v_rcp_f32 v57, v57
  v_rcp_f32_e64 v58, v58
  v_mfma_f32_32x32x16_bf16 v[16:31], a[44:47], v[180:183], v[16:31]
  s_waitcnt lgkmcnt(0)
  v_rcp_f32 v59, v59
  v_rcp_f32 v60, v60
  v_rcp_f32 v61, v61
  v_rcp_f32 v62, v62
  v_rcp_f32 v63, v63
  v_pk_mul_f32 v[32:33], v[32:33], v[48:49]
  v_pk_mul_f32 v[34:35], v[34:35], v[50:51]
  v_pk_mul_f32 v[36:37], v[36:37], v[52:53]
  v_pk_mul_f32 v[38:39], v[38:39], v[54:55]
  v_pk_mul_f32 v[40:41], v[40:41], v[56:57]
  v_pk_mul_f32 v[42:43], v[42:43], v[58:59]
  v_pk_mul_f32 v[44:45], v[44:45], v[60:61]
  v_pk_mul_f32 v[46:47], v[46:47], v[62:63]
  v_pk_fma_f32 v[48:49], v[16:17], v[16:17], s[20:21] neg_lo:[1,0,1] neg_hi:[1,0,1]
  v_pk_fma_f32 v[50:51], v[18:19], v[18:19], s[20:21] neg_lo:[1,0,1] neg_hi:[1,0,1]
  v_pk_fma_f32 v[52:53], v[20:21], v[20:21], s[20:21] neg_lo:[1,0,1] neg_hi:[1,0,1]
  v_pk_fma_f32 v[54:55], v[22:23], v[22:23], s[20:21] neg_lo:[1,0,1] neg_hi:[1,0,1]
  v_pk_fma_f32 v[56:57], v[24:25], v[24:25], s[20:21] neg_lo:[1,0,1] neg_hi:[1,0,1]
  v_pk_fma_f32 v[58:59], v[26:27], v[26:27], s[20:21] neg_lo:[1,0,1] neg_hi:[1,0,1]
  v_pk_fma_f32 v[60:61], v[28:29], v[28:29], s[20:21] neg_lo:[1,0,1] neg_hi:[1,0,1]
  v_pk_fma_f32 v[62:63], v[30:31], v[30:31], s[20:21] neg_lo:[1,0,1] neg_hi:[1,0,1]
  v_pk_mul_f32 v[48:49], v[16:17], v[48:49]
  v_pk_mul_f32 v[50:51], v[18:19], v[50:51]
  v_pk_mul_f32 v[52:53], v[20:21], v[52:53]
  v_pk_mul_f32 v[54:55], v[22:23], v[54:55]
  v_pk_mul_f32 v[56:57], v[24:25], v[56:57]
  v_cvt_pk_bf16_f32 v184, v32, v33
  v_cvt_pk_bf16_f32 v185, v34, v35
  v_cvt_pk_bf16_f32 v186, v36, v37
  v_cvt_pk_bf16_f32 v187, v38, v39
  v_pk_mul_f32 v[58:59], v[26:27], v[58:59]
  v_pk_mul_f32 v[60:61], v[28:29], v[60:61]
  v_pk_mul_f32 v[62:63], v[30:31], v[62:63]
  v_mfma_f32_32x32x16_bf16 v[64:79], v[192:195], v[184:187], v[64:79]
  v_cvt_pk_bf16_f32 v188, v40, v41
  v_cvt_pk_bf16_f32 v189, v42, v43
  v_cvt_pk_bf16_f32 v190, v44, v45
  v_cvt_pk_bf16_f32 v191, v46, v47
  v_exp_f32_e64 v48, v48
  v_mfma_f32_32x32x16_bf16 v[80:95], v[196:199], v[184:187], v[80:95]
  v_exp_f32 v49, v49
  v_exp_f32 v50, v50
  v_exp_f32_e64 v51, v51
  v_mfma_f32_32x32x16_bf16 v[96:111], v[200:203], v[184:187], v[96:111]
  v_exp_f32 v52, v52
  v_exp_f32 v53, v53
  v_subrev_u32 v11, 0x4100, v5
  v_mfma_f32_32x32x16_bf16 v[64:79], v[204:207], v[188:191], v[64:79]
  v_exp_f32 v54, v54
  v_exp_f32 v55, v55
  v_exp_f32_e64 v56, v56
  v_mfma_f32_32x32x16_bf16 v[80:95], v[208:211], v[188:191], v[80:95]
  v_exp_f32 v57, v57
  v_exp_f32 v58, v58
  v_add_u32 v5, 0x8200, v5
  v_exp_f32_e64 v59, v59
  v_mfma_f32_32x32x16_bf16 v[96:111], v[212:215], v[188:191], v[96:111]
  v_exp_f32 v60, v60
  v_exp_f32 v61, v61
  v_exp_f32 v62, v62
  v_exp_f32 v63, v63
  v_min_u32_e64 v5, v11, v5
  v_pk_fma_f32 v[48:49], v[48:49], s[22:23], s[22:23]
  v_pk_fma_f32 v[50:51], v[50:51], s[22:23], s[22:23]
  v_pk_fma_f32 v[52:53], v[52:53], s[22:23], s[22:23]
  v_pk_fma_f32 v[54:55], v[54:55], s[22:23], s[22:23]
  v_pk_fma_f32 v[56:57], v[56:57], s[22:23], s[22:23]
  v_pk_fma_f32 v[58:59], v[58:59], s[22:23], s[22:23]
  v_pk_fma_f32 v[60:61], v[60:61], s[22:23], s[22:23]
  v_pk_fma_f32 v[62:63], v[62:63], s[22:23], s[22:23]
  v_mfma_f32_32x32x16_bf16 v[32:47], a[48:51], v[160:163], 0
  ds_read_b128 v[192:195], v1 offset:20480
  ds_read_b128 v[196:199], v1 offset:21504
  v_rcp_f32 v48, v48
  v_rcp_f32 v49, v49
  v_mfma_f32_32x32x16_bf16 v[32:47], a[52:55], v[164:167], v[32:47]
  ds_read_b128 v[200:203], v1 offset:22528
  ds_read_b128 v[204:207], v1 offset:23552
  v_rcp_f32 v50, v50
  v_rcp_f32 v51, v51
  v_mfma_f32_32x32x16_bf16 v[32:47], a[56:59], v[168:171], v[32:47]
  ds_read_b128 v[208:211], v1 offset:24576
  ds_read_b128 v[212:215], v1 offset:25600
  v_rcp_f32 v52, v52
  v_rcp_f32 v53, v53
  v_mfma_f32_32x32x16_bf16 v[32:47], a[60:63], v[172:175], v[32:47]
  buffer_store_dwordx4 v[116:119], v10, s[8:11], s28 offen offset:32
  v_rcp_f32 v54, v54
  v_rcp_f32 v55, v55
  v_mfma_f32_32x32x16_bf16 v[32:47], a[64:67], v[176:179], v[32:47]
  v_rcp_f32 v56, v56
  v_rcp_f32 v57, v57
  v_rcp_f32_e64 v58, v58
  v_mfma_f32_32x32x16_bf16 v[32:47], a[68:71], v[180:183], v[32:47]
  s_waitcnt lgkmcnt(0)
  v_rcp_f32 v59, v59
  v_rcp_f32 v60, v60
  v_rcp_f32 v61, v61
  v_rcp_f32 v62, v62
  v_rcp_f32 v63, v63
  v_pk_mul_f32 v[16:17], v[16:17], v[48:49]
  v_pk_mul_f32 v[18:19], v[18:19], v[50:51]
  v_pk_mul_f32 v[20:21], v[20:21], v[52:53]
  v_pk_mul_f32 v[22:23], v[22:23], v[54:55]
  v_pk_mul_f32 v[24:25], v[24:25], v[56:57]
  v_pk_mul_f32 v[26:27], v[26:27], v[58:59]
  v_pk_mul_f32 v[28:29], v[28:29], v[60:61]
  v_pk_mul_f32 v[30:31], v[30:31], v[62:63]
  v_pk_fma_f32 v[48:49], v[32:33], v[32:33], s[20:21] neg_lo:[1,0,1] neg_hi:[1,0,1]
  v_pk_fma_f32 v[50:51], v[34:35], v[34:35], s[20:21] neg_lo:[1,0,1] neg_hi:[1,0,1]
  v_pk_fma_f32 v[52:53], v[36:37], v[36:37], s[20:21] neg_lo:[1,0,1] neg_hi:[1,0,1]
  v_pk_fma_f32 v[54:55], v[38:39], v[38:39], s[20:21] neg_lo:[1,0,1] neg_hi:[1,0,1]
  v_pk_fma_f32 v[56:57], v[40:41], v[40:41], s[20:21] neg_lo:[1,0,1] neg_hi:[1,0,1]
  v_pk_fma_f32 v[58:59], v[42:43], v[42:43], s[20:21] neg_lo:[1,0,1] neg_hi:[1,0,1]
  v_pk_fma_f32 v[60:61], v[44:45], v[44:45], s[20:21] neg_lo:[1,0,1] neg_hi:[1,0,1]
  v_pk_fma_f32 v[62:63], v[46:47], v[46:47], s[20:21] neg_lo:[1,0,1] neg_hi:[1,0,1]
  v_pk_mul_f32 v[48:49], v[32:33], v[48:49]
  v_pk_mul_f32 v[50:51], v[34:35], v[50:51]
  v_pk_mul_f32 v[52:53], v[36:37], v[52:53]
  v_pk_mul_f32 v[54:55], v[38:39], v[54:55]
  v_pk_mul_f32 v[56:57], v[40:41], v[56:57]
  v_cvt_pk_bf16_f32 v184, v16, v17
  v_cvt_pk_bf16_f32 v185, v18, v19
  v_cvt_pk_bf16_f32 v186, v20, v21
  v_cvt_pk_bf16_f32 v187, v22, v23
  v_pk_mul_f32 v[58:59], v[42:43], v[58:59]
  v_pk_mul_f32 v[60:61], v[44:45], v[60:61]
  v_pk_mul_f32 v[62:63], v[46:47], v[62:63]
  v_mfma_f32_32x32x16_bf16 v[64:79], v[192:195], v[184:187], v[64:79]
  s_add_u32 s29, s29, 0x60000
  v_cvt_pk_bf16_f32 v188, v24, v25
  v_cvt_pk_bf16_f32 v189, v26, v27
  v_cvt_pk_bf16_f32 v190, v28, v29
  v_cvt_pk_bf16_f32 v191, v30, v31
  v_exp_f32_e64 v48, v48
  v_mfma_f32_32x32x16_bf16 v[80:95], v[196:199], v[184:187], v[80:95]
  s_add_u32 s52, s52, 0x60000
  v_exp_f32 v49, v49
  v_exp_f32 v50, v50
  v_exp_f32_e64 v51, v51
  v_mfma_f32_32x32x16_bf16 v[96:111], v[200:203], v[184:187], v[96:111]
  s_mov_b32 s32, s30
  v_exp_f32 v52, v52
  v_exp_f32_e64 v53, v53
  v_subrev_u32 v11, 0x4100, v4
  v_mfma_f32_32x32x16_bf16 v[64:79], v[204:207], v[188:191], v[64:79]
  s_add_u32 s30, s33, 32
  v_exp_f32 v54, v54
  v_exp_f32 v55, v55
  v_exp_f32 v56, v56
  v_mfma_f32_32x32x16_bf16 v[80:95], v[208:211], v[188:191], v[80:95]
  s_sub_u32 s33, s31, 0
  v_exp_f32 v57, v57
  v_exp_f32_e64 v58, v58
  v_add_u32 v4, 0x8200, v4
  v_exp_f32_e64 v59, v59
  v_mfma_f32_32x32x16_bf16 v[96:111], v[212:215], v[188:191], v[96:111]
  v_exp_f32 v60, v60
  v_exp_f32 v61, v61
  v_exp_f32 v62, v62
  v_exp_f32 v63, v63
  v_min_u32_e64 v4, v11, v4
  v_pk_fma_f32 v[48:49], v[48:49], s[22:23], s[22:23]
  v_pk_fma_f32 v[50:51], v[50:51], s[22:23], s[22:23]
  v_pk_fma_f32 v[52:53], v[52:53], s[22:23], s[22:23]
  v_pk_fma_f32 v[54:55], v[54:55], s[22:23], s[22:23]
  v_pk_fma_f32 v[56:57], v[56:57], s[22:23], s[22:23]
  v_pk_fma_f32 v[58:59], v[58:59], s[22:23], s[22:23]
  v_pk_fma_f32 v[60:61], v[60:61], s[22:23], s[22:23]
  v_pk_fma_f32 v[62:63], v[62:63], s[22:23], s[22:23]
  v_mfma_f32_32x32x16_bf16 v[16:31], a[72:75], v[160:163], 0
  ds_read_b128 v[192:195], v1 offset:26624
  ds_read_b128 v[196:199], v1 offset:27648
  v_rcp_f32 v48, v48
  v_rcp_f32 v49, v49
  v_mfma_f32_32x32x16_bf16 v[16:31], a[76:79], v[164:167], v[16:31]
  ds_read_b128 v[200:203], v1 offset:28672
  ds_read_b128 v[204:207], v1 offset:29696
  v_rcp_f32 v50, v50
  v_rcp_f32 v51, v51
  v_mfma_f32_32x32x16_bf16 v[16:31], a[80:83], v[168:171], v[16:31]
  ds_read_b128 v[208:211], v1 offset:30720
  ds_read_b128 v[212:215], v1 offset:31744
  v_rcp_f32 v52, v52
  v_rcp_f32 v53, v53
  v_mfma_f32_32x32x16_bf16 v[16:31], a[84:87], v[172:175], v[16:31]
  buffer_load_dword v249, v248, s[4:7], s29 offen
  v_rcp_f32 v54, v54
  v_rcp_f32 v55, v55
  v_mfma_f32_32x32x16_bf16 v[16:31], a[88:91], v[176:179], v[16:31]
  v_rcp_f32 v56, v56
  v_rcp_f32 v57, v57
  v_rcp_f32_e64 v58, v58
  v_mfma_f32_32x32x16_bf16 v[16:31], a[92:95], v[180:183], v[16:31]
  s_waitcnt lgkmcnt(0)
  v_rcp_f32 v59, v59
  v_rcp_f32 v60, v60
  v_rcp_f32 v61, v61
  v_rcp_f32_e64 v62, v62
  v_rcp_f32_e64 v63, v63
  v_pk_mul_f32 v[32:33], v[32:33], v[48:49]
  v_pk_mul_f32 v[34:35], v[34:35], v[50:51]
  v_pk_mul_f32 v[36:37], v[36:37], v[52:53]
  v_pk_mul_f32 v[38:39], v[38:39], v[54:55]
  v_pk_mul_f32 v[40:41], v[40:41], v[56:57]
  v_pk_mul_f32 v[42:43], v[42:43], v[58:59]
  v_pk_mul_f32 v[44:45], v[44:45], v[60:61]
  v_pk_mul_f32 v[46:47], v[46:47], v[62:63]
  v_pk_fma_f32 v[48:49], v[16:17], v[16:17], s[20:21] neg_lo:[1,0,1] neg_hi:[1,0,1]
  v_pk_fma_f32 v[50:51], v[18:19], v[18:19], s[20:21] neg_lo:[1,0,1] neg_hi:[1,0,1]
  v_pk_fma_f32 v[52:53], v[20:21], v[20:21], s[20:21] neg_lo:[1,0,1] neg_hi:[1,0,1]
  v_pk_fma_f32 v[54:55], v[22:23], v[22:23], s[20:21] neg_lo:[1,0,1] neg_hi:[1,0,1]
  v_pk_fma_f32 v[56:57], v[24:25], v[24:25], s[20:21] neg_lo:[1,0,1] neg_hi:[1,0,1]
  v_pk_fma_f32 v[58:59], v[26:27], v[26:27], s[20:21] neg_lo:[1,0,1] neg_hi:[1,0,1]
  v_pk_fma_f32 v[60:61], v[28:29], v[28:29], s[20:21] neg_lo:[1,0,1] neg_hi:[1,0,1]
  v_pk_fma_f32 v[62:63], v[30:31], v[30:31], s[20:21] neg_lo:[1,0,1] neg_hi:[1,0,1]
  v_pk_mul_f32 v[48:49], v[16:17], v[48:49]
  v_pk_mul_f32 v[50:51], v[18:19], v[50:51]
  v_pk_mul_f32 v[52:53], v[20:21], v[52:53]
  v_pk_mul_f32 v[54:55], v[22:23], v[54:55]
  v_pk_mul_f32 v[56:57], v[24:25], v[56:57]
  v_cvt_pk_bf16_f32 v184, v32, v33
  v_cvt_pk_bf16_f32 v185, v34, v35
  v_cvt_pk_bf16_f32 v186, v36, v37
  v_cvt_pk_bf16_f32 v187, v38, v39
  v_pk_mul_f32 v[58:59], v[26:27], v[58:59]
  v_pk_mul_f32 v[60:61], v[28:29], v[60:61]
  v_pk_mul_f32 v[62:63], v[30:31], v[62:63]
  v_mfma_f32_32x32x16_bf16 v[64:79], v[192:195], v[184:187], v[64:79]
  s_waitcnt vmcnt(3)
  ds_read_b128 v[220:223], v4 offset:96
  v_cvt_pk_bf16_f32 v188, v40, v41
  v_cvt_pk_bf16_f32 v189, v42, v43
  v_cvt_pk_bf16_f32 v190, v44, v45
  v_cvt_pk_bf16_f32 v191, v46, v47
  v_mfma_f32_32x32x16_bf16 v[80:95], v[196:199], v[184:187], v[80:95]
  ds_read_b128 v[228:231], v4 offset:288
  v_exp_f32 v48, v48
  v_exp_f32 v49, v49
  v_exp_f32 v50, v50
  v_mfma_f32_32x32x16_bf16 v[96:111], v[200:203], v[184:187], v[96:111]
  ds_read_b128 v[236:239], v4 offset:480
  v_exp_f32 v51, v51
  v_exp_f32 v52, v52
  v_mfma_f32_32x32x16_bf16 v[64:79], v[204:207], v[188:191], v[64:79]
  v_exp_f32 v53, v53
  v_exp_f32 v54, v54
  v_exp_f32_e64 v55, v55
  v_mfma_f32_32x32x16_bf16 v[80:95], v[208:211], v[188:191], v[80:95]
  v_exp_f32 v56, v56
  v_exp_f32 v57, v57
  v_exp_f32_e64 v58, v58
  v_mfma_f32_32x32x16_bf16 v[96:111], v[212:215], v[188:191], v[96:111]
  s_waitcnt lgkmcnt(0)
  v_exp_f32 v59, v59
  v_exp_f32 v60, v60
  v_exp_f32 v61, v61
  v_exp_f32 v62, v62
  v_exp_f32 v63, v63
  v_pk_fma_f32 v[48:49], v[48:49], s[22:23], s[22:23]
  v_pk_fma_f32 v[50:51], v[50:51], s[22:23], s[22:23]
  v_pk_fma_f32 v[52:53], v[52:53], s[22:23], s[22:23]
  v_pk_fma_f32 v[54:55], v[54:55], s[22:23], s[22:23]
  v_pk_fma_f32 v[56:57], v[56:57], s[22:23], s[22:23]
  v_pk_fma_f32 v[58:59], v[58:59], s[22:23], s[22:23]
  v_pk_fma_f32 v[60:61], v[60:61], s[22:23], s[22:23]
  v_pk_fma_f32 v[62:63], v[62:63], s[22:23], s[22:23]
  v_mfma_f32_32x32x16_bf16 v[32:47], a[96:99], v[160:163], 0
  ds_read_b128 v[192:195], v0 offset:24576
  ds_read_b128 v[196:199], v0 offset:25600
  v_rcp_f32 v48, v48
  v_rcp_f32 v49, v49
  v_mfma_f32_16x16x32_bf16 v[136:139], a[240:243], v[220:223], 0
  ds_read_b128 v[216:219], v3 offset:2800
  ds_read_b128 v[220:223], v4 offset:112
  v_mfma_f32_32x32x16_bf16 v[32:47], a[100:103], v[164:167], v[32:47]
  ds_read_b128 v[200:203], v0 offset:26624
  ds_read_b128 v[204:207], v0 offset:27648
  v_rcp_f32 v50, v50
  v_rcp_f32 v51, v51
  v_mfma_f32_16x16x32_bf16 v[136:139], a[244:247], v[228:231], v[136:139]
  ds_read_b128 v[224:227], v3 offset:7600
  ds_read_b128 v[228:231], v4 offset:304
  v_mfma_f32_32x32x16_bf16 v[32:47], a[104:107], v[168:171], v[32:47]
  ds_read_b128 v[208:211], v0 offset:28672
  ds_read_b128 v[212:215], v0 offset:29696
  v_rcp_f32 v52, v52
  v_rcp_f32 v53, v53
  v_mfma_f32_16x16x32_bf16 v[136:139], a[248:251], v[236:239], v[136:139]
  ds_read_b128 v[232:235], v3 offset:12400
  ds_read_b128 v[236:239], v4 offset:496
  v_mfma_f32_32x32x16_bf16 v[32:47], a[108:111], v[172:175], v[32:47]
  buffer_store_dwordx4 v[120:123], v10, s[8:11], s28 offen offset:64
  v_rcp_f32 v54, v54
  v_rcp_f32 v55, v55
  v_mfma_f32_32x32x16_bf16 v[32:47], a[112:115], v[176:179], v[32:47]
  v_rcp_f32 v56, v56
  v_rcp_f32 v57, v57
  v_rcp_f32_e64 v58, v58
  v_mfma_f32_32x32x16_bf16 v[32:47], a[116:119], v[180:183], v[32:47]
  s_waitcnt lgkmcnt(0)
  v_rcp_f32 v59, v59
  v_rcp_f32 v60, v60
  v_rcp_f32 v61, v61
  v_rcp_f32 v62, v62
  v_rcp_f32 v63, v63
  v_pk_mul_f32 v[16:17], v[16:17], v[48:49]
  v_pk_mul_f32 v[18:19], v[18:19], v[50:51]
  v_pk_mul_f32 v[20:21], v[20:21], v[52:53]
  v_pk_mul_f32 v[22:23], v[22:23], v[54:55]
  v_pk_mul_f32 v[24:25], v[24:25], v[56:57]
  v_pk_mul_f32 v[26:27], v[26:27], v[58:59]
  v_pk_mul_f32 v[28:29], v[28:29], v[60:61]
  v_pk_mul_f32 v[30:31], v[30:31], v[62:63]
  v_pk_add_f32 v[12:13], v[136:137], v[138:139]
  v_pk_mul_f32 v[14:15], v[136:137], v[136:137]
  v_pk_fma_f32 v[14:15], v[138:139], v[138:139], v[14:15]
  v_pk_fma_f32 v[48:49], v[32:33], v[32:33], s[20:21] neg_lo:[1,0,1] neg_hi:[1,0,1]
  v_pk_fma_f32 v[50:51], v[34:35], v[34:35], s[20:21] neg_lo:[1,0,1] neg_hi:[1,0,1]
  v_pk_fma_f32 v[52:53], v[36:37], v[36:37], s[20:21] neg_lo:[1,0,1] neg_hi:[1,0,1]
  v_pk_fma_f32 v[54:55], v[38:39], v[38:39], s[20:21] neg_lo:[1,0,1] neg_hi:[1,0,1]
  v_pk_fma_f32 v[56:57], v[40:41], v[40:41], s[20:21] neg_lo:[1,0,1] neg_hi:[1,0,1]
  v_pk_fma_f32 v[58:59], v[42:43], v[42:43], s[20:21] neg_lo:[1,0,1] neg_hi:[1,0,1]
  v_pk_fma_f32 v[60:61], v[44:45], v[44:45], s[20:21] neg_lo:[1,0,1] neg_hi:[1,0,1]
  v_pk_fma_f32 v[62:63], v[46:47], v[46:47], s[20:21] neg_lo:[1,0,1] neg_hi:[1,0,1]
  v_pk_mul_f32 v[48:49], v[32:33], v[48:49]
  v_pk_mul_f32 v[50:51], v[34:35], v[50:51]
  v_pk_mul_f32 v[52:53], v[36:37], v[52:53]
  v_pk_mul_f32 v[54:55], v[38:39], v[54:55]
  v_pk_mul_f32 v[56:57], v[40:41], v[56:57]
  v_pk_mul_f32 v[58:59], v[42:43], v[58:59]
  v_pk_mul_f32 v[60:61], v[44:45], v[60:61]
  v_pk_mul_f32 v[62:63], v[46:47], v[62:63]
  v_mfma_f32_16x16x32_bf16 v[140:143], v[216:219], v[220:223], 0
  v_cvt_pk_bf16_f32 v184, v16, v17
  v_cvt_pk_bf16_f32 v185, v18, v19
  v_mfma_f32_16x16x32_bf16 v[140:143], v[224:227], v[228:231], v[140:143]
  v_cvt_pk_bf16_f32 v186, v20, v21
  v_cvt_pk_bf16_f32 v187, v22, v23
  v_mfma_f32_16x16x32_bf16 v[140:143], v[232:235], v[236:239], v[140:143]
  ds_read_b128 v[220:223], v4 offset:128
  v_mfma_f32_32x32x16_bf16 v[64:79], v[192:195], v[184:187], v[64:79]
  ds_read_b128 v[224:227], v3 offset:8000
  ds_read_b128 v[228:231], v4 offset:320
  v_cvt_pk_bf16_f32 v188, v24, v25
  v_cvt_pk_bf16_f32 v189, v26, v27
  v_cvt_pk_bf16_f32 v190, v28, v29
  v_cvt_pk_bf16_f32 v191, v30, v31
  v_mfma_f32_32x32x16_bf16 v[80:95], v[196:199], v[184:187], v[80:95]
  ds_read_b128 v[232:235], v3 offset:12800
  ds_read_b128 v[236:239], v4 offset:512
  v_exp_f32 v48, v48
  v_exp_f32 v49, v49
  v_mfma_f32_32x32x16_bf16 v[96:111], v[200:203], v[184:187], v[96:111]
  s_sub_u32 s31, s32, 32
  v_exp_f32 v50, v50
  v_exp_f32 v51, v51
  v_exp_f32 v52, v52
  v_mfma_f32_32x32x16_bf16 v[64:79], v[204:207], v[188:191], v[64:79]
  v_exp_f32 v53, v53
  v_exp_f32 v54, v54
  v_exp_f32_e64 v55, v55
  v_mfma_f32_32x32x16_bf16 v[80:95], v[208:211], v[188:191], v[80:95]
  v_exp_f32 v56, v56
  v_exp_f32 v57, v57
  v_exp_f32_e64 v58, v58
  v_mfma_f32_32x32x16_bf16 v[96:111], v[212:215], v[188:191], v[96:111]
  s_waitcnt lgkmcnt(0)
  v_exp_f32 v59, v59
  v_exp_f32 v60, v60
  v_exp_f32 v61, v61
  v_exp_f32 v62, v62
  v_exp_f32 v63, v63
  v_pk_add_f32 v[12:13], v[12:13], v[140:141]
  v_pk_fma_f32 v[14:15], v[140:141], v[140:141], v[14:15]
  v_pk_add_f32 v[12:13], v[12:13], v[142:143]
  v_pk_fma_f32 v[14:15], v[142:143], v[142:143], v[14:15]
  v_pk_fma_f32 v[48:49], v[48:49], s[22:23], s[22:23]
  v_pk_fma_f32 v[50:51], v[50:51], s[22:23], s[22:23]
  v_pk_fma_f32 v[52:53], v[52:53], s[22:23], s[22:23]
  v_pk_fma_f32 v[54:55], v[54:55], s[22:23], s[22:23]
  v_pk_fma_f32 v[56:57], v[56:57], s[22:23], s[22:23]
  v_pk_fma_f32 v[58:59], v[58:59], s[22:23], s[22:23]
  v_pk_fma_f32 v[60:61], v[60:61], s[22:23], s[22:23]
  v_pk_fma_f32 v[62:63], v[62:63], s[22:23], s[22:23]
  v_mfma_f32_32x32x16_bf16 v[16:31], a[120:123], v[160:163], 0
  ds_read_b128 v[192:195], v0 offset:30720
  ds_read_b128 v[196:199], v0 offset:31744
  v_rcp_f32 v48, v48
  v_rcp_f32 v49, v49
  v_mfma_f32_16x16x32_bf16 v[144:147], a[252:255], v[220:223], 0
  ds_read_b128 v[216:219], v3 offset:3600
  ds_read_b128 v[220:223], v4 offset:144
  v_mfma_f32_32x32x16_bf16 v[16:31], a[124:127], v[164:167], v[16:31]
  ds_read_b128 v[200:203], v0 offset:32768
  ds_read_b128 v[204:207], v0 offset:33792
  v_rcp_f32 v50, v50
  v_rcp_f32 v51, v51
  v_mfma_f32_16x16x32_bf16 v[144:147], v[224:227], v[228:231], v[144:147]
  ds_read_b128 v[224:227], v3 offset:8400
  ds_read_b128 v[228:231], v4 offset:336
  v_mfma_f32_32x32x16_bf16 v[16:31], a[128:131], v[168:171], v[16:31]
  ds_read_b128 v[208:211], v0 offset:34816
  ds_read_b128 v[212:215], v0 offset:35840
  v_rcp_f32 v52, v52
  v_rcp_f32 v53, v53
  v_mfma_f32_16x16x32_bf16 v[144:147], v[232:235], v[236:239], v[144:147]
  ds_read_b128 v[232:235], v3 offset:13200
  ds_read_b128 v[236:239], v4 offset:528
  v_mfma_f32_32x32x16_bf16 v[16:31], a[132:135], v[172:175], v[16:31]
  buffer_store_dwordx4 v[124:127], v10, s[8:11], s28 offen offset:96
  v_rcp_f32 v54, v54
  v_rcp_f32 v55, v55
  v_mfma_f32_32x32x16_bf16 v[16:31], a[136:139], v[176:179], v[16:31]
  v_rcp_f32 v56, v56
  v_rcp_f32 v57, v57
  v_rcp_f32_e64 v58, v58
  v_mfma_f32_32x32x16_bf16 v[16:31], a[140:143], v[180:183], v[16:31]
  s_waitcnt lgkmcnt(0)
  v_rcp_f32 v59, v59
  v_rcp_f32 v60, v60
  v_rcp_f32 v61, v61
  v_rcp_f32 v62, v62
  v_rcp_f32 v63, v63
  v_pk_mul_f32 v[32:33], v[32:33], v[48:49]
  v_pk_mul_f32 v[34:35], v[34:35], v[50:51]
  v_pk_mul_f32 v[36:37], v[36:37], v[52:53]
  v_pk_mul_f32 v[38:39], v[38:39], v[54:55]
  v_pk_mul_f32 v[40:41], v[40:41], v[56:57]
  v_pk_mul_f32 v[42:43], v[42:43], v[58:59]
  v_pk_mul_f32 v[44:45], v[44:45], v[60:61]
  v_pk_mul_f32 v[46:47], v[46:47], v[62:63]
  v_pk_add_f32 v[12:13], v[12:13], v[144:145]
  v_pk_fma_f32 v[14:15], v[144:145], v[144:145], v[14:15]
  v_pk_add_f32 v[12:13], v[12:13], v[146:147]
  v_pk_fma_f32 v[14:15], v[146:147], v[146:147], v[14:15]
  v_pk_fma_f32 v[48:49], v[16:17], v[16:17], s[20:21] neg_lo:[1,0,1] neg_hi:[1,0,1]
  v_pk_fma_f32 v[50:51], v[18:19], v[18:19], s[20:21] neg_lo:[1,0,1] neg_hi:[1,0,1]
  v_pk_fma_f32 v[52:53], v[20:21], v[20:21], s[20:21] neg_lo:[1,0,1] neg_hi:[1,0,1]
  v_pk_fma_f32 v[54:55], v[22:23], v[22:23], s[20:21] neg_lo:[1,0,1] neg_hi:[1,0,1]
  v_pk_fma_f32 v[56:57], v[24:25], v[24:25], s[20:21] neg_lo:[1,0,1] neg_hi:[1,0,1]
  v_pk_fma_f32 v[58:59], v[26:27], v[26:27], s[20:21] neg_lo:[1,0,1] neg_hi:[1,0,1]
  v_pk_fma_f32 v[60:61], v[28:29], v[28:29], s[20:21] neg_lo:[1,0,1] neg_hi:[1,0,1]
  v_pk_fma_f32 v[62:63], v[30:31], v[30:31], s[20:21] neg_lo:[1,0,1] neg_hi:[1,0,1]
  v_pk_mul_f32 v[48:49], v[16:17], v[48:49]
  v_pk_mul_f32 v[50:51], v[18:19], v[50:51]
  v_pk_mul_f32 v[52:53], v[20:21], v[52:53]
  v_pk_mul_f32 v[54:55], v[22:23], v[54:55]
  v_pk_mul_f32 v[56:57], v[24:25], v[56:57]
  v_pk_mul_f32 v[58:59], v[26:27], v[58:59]
  v_pk_mul_f32 v[60:61], v[28:29], v[60:61]
  v_pk_mul_f32 v[62:63], v[30:31], v[62:63]
  v_mfma_f32_16x16x32_bf16 v[148:151], v[216:219], v[220:223], 0
  v_cvt_pk_bf16_f32 v184, v32, v33
  v_cvt_pk_bf16_f32 v185, v34, v35
  v_mfma_f32_16x16x32_bf16 v[148:151], v[224:227], v[228:231], v[148:151]
  v_cvt_pk_bf16_f32 v186, v36, v37
  v_cvt_pk_bf16_f32 v187, v38, v39
  v_mfma_f32_16x16x32_bf16 v[148:151], v[232:235], v[236:239], v[148:151]
  ds_read_b128 v[216:219], v3 offset:4000
  ds_read_b128 v[220:223], v4 offset:160
  v_mfma_f32_32x32x16_bf16 v[64:79], v[192:195], v[184:187], v[64:79]
  ds_read_b128 v[224:227], v3 offset:8800
  ds_read_b128 v[228:231], v4 offset:352
  v_cvt_pk_bf16_f32 v188, v40, v41
  v_cvt_pk_bf16_f32 v189, v42, v43
  v_cvt_pk_bf16_f32 v190, v44, v45
  v_cvt_pk_bf16_f32 v191, v46, v47
  v_mfma_f32_32x32x16_bf16 v[80:95], v[196:199], v[184:187], v[80:95]
  ds_read_b128 v[232:235], v3 offset:13600
  ds_read_b128 v[236:239], v4 offset:544
  v_exp_f32 v48, v48
  v_exp_f32 v49, v49
  v_mfma_f32_32x32x16_bf16 v[96:111], v[200:203], v[184:187], v[96:111]
  v_exp_f32 v50, v50
  v_exp_f32 v51, v51
  v_exp_f32_e64 v52, v52
  v_mfma_f32_32x32x16_bf16 v[64:79], v[204:207], v[188:191], v[64:79]
  v_exp_f32 v53, v53
  v_exp_f32 v54, v54
  v_exp_f32_e64 v55, v55
  v_mfma_f32_32x32x16_bf16 v[80:95], v[208:211], v[188:191], v[80:95]
  v_exp_f32 v56, v56
  v_exp_f32 v57, v57
  v_exp_f32_e64 v58, v58
  v_mfma_f32_32x32x16_bf16 v[96:111], v[212:215], v[188:191], v[96:111]
  s_waitcnt lgkmcnt(0)
  v_exp_f32 v59, v59
  v_exp_f32 v60, v60
  v_exp_f32 v61, v61
  v_exp_f32 v62, v62
  v_exp_f32 v63, v63
  v_pk_add_f32 v[12:13], v[12:13], v[148:149]
  v_pk_fma_f32 v[14:15], v[148:149], v[148:149], v[14:15]
  v_pk_add_f32 v[12:13], v[12:13], v[150:151]
  v_pk_fma_f32 v[14:15], v[150:151], v[150:151], v[14:15]
  v_pk_fma_f32 v[48:49], v[48:49], s[22:23], s[22:23]
  v_pk_fma_f32 v[50:51], v[50:51], s[22:23], s[22:23]
  v_pk_fma_f32 v[52:53], v[52:53], s[22:23], s[22:23]
  v_pk_fma_f32 v[54:55], v[54:55], s[22:23], s[22:23]
  v_pk_fma_f32 v[56:57], v[56:57], s[22:23], s[22:23]
  v_pk_fma_f32 v[58:59], v[58:59], s[22:23], s[22:23]
  v_pk_fma_f32 v[60:61], v[60:61], s[22:23], s[22:23]
  v_pk_fma_f32 v[62:63], v[62:63], s[22:23], s[22:23]
  v_mfma_f32_32x32x16_bf16 v[32:47], a[144:147], v[160:163], 0
  ds_read_b128 v[192:195], v0 offset:36864
  ds_read_b128 v[196:199], v0 offset:37888
  v_rcp_f32 v48, v48
  v_rcp_f32 v49, v49
  v_mfma_f32_16x16x32_bf16 v[152:155], v[216:219], v[220:223], 0
  ds_read_b128 v[216:219], v3 offset:4400
  ds_read_b128 v[220:223], v4 offset:176
  v_mfma_f32_32x32x16_bf16 v[32:47], a[148:151], v[164:167], v[32:47]
  ds_read_b128 v[200:203], v0 offset:38912
  ds_read_b128 v[204:207], v0 offset:39936
  v_rcp_f32 v50, v50
  v_rcp_f32 v51, v51
  v_mfma_f32_16x16x32_bf16 v[152:155], v[224:227], v[228:231], v[152:155]
  ds_read_b128 v[224:227], v3 offset:9200
  ds_read_b128 v[228:231], v4 offset:368
  v_mfma_f32_32x32x16_bf16 v[32:47], a[152:155], v[168:171], v[32:47]
  ds_read_b128 v[208:211], v0 offset:40960
  ds_read_b128 v[212:215], v0 offset:41984
  v_rcp_f32 v52, v52
  v_rcp_f32 v53, v53
  v_mfma_f32_16x16x32_bf16 v[152:155], v[232:235], v[236:239], v[152:155]
  ds_read_b128 v[232:235], v3 offset:14000
  ds_read_b128 v[236:239], v4 offset:560
  v_mfma_f32_32x32x16_bf16 v[32:47], a[156:159], v[172:175], v[32:47]
  v_rcp_f32 v54, v54
  v_rcp_f32 v55, v55
  v_rcp_f32_e64 v56, v56
  v_mfma_f32_32x32x16_bf16 v[32:47], a[160:163], v[176:179], v[32:47]
  v_rcp_f32 v57, v57
  v_rcp_f32 v58, v58
  v_rcp_f32_e64 v59, v59
  v_mfma_f32_32x32x16_bf16 v[32:47], a[164:167], v[180:183], v[32:47]
  s_waitcnt lgkmcnt(0)
  v_rcp_f32 v60, v60
  v_rcp_f32 v61, v61
  v_rcp_f32 v62, v62
  v_rcp_f32_e64 v63, v63
  v_pk_mul_f32 v[16:17], v[16:17], v[48:49]
  v_pk_mul_f32 v[18:19], v[18:19], v[50:51]
  v_pk_mul_f32 v[20:21], v[20:21], v[52:53]
  v_pk_mul_f32 v[22:23], v[22:23], v[54:55]
  v_pk_mul_f32 v[24:25], v[24:25], v[56:57]
  v_pk_mul_f32 v[26:27], v[26:27], v[58:59]
  v_pk_mul_f32 v[28:29], v[28:29], v[60:61]
  v_pk_mul_f32 v[30:31], v[30:31], v[62:63]
  v_pk_add_f32 v[12:13], v[12:13], v[152:153]
  v_pk_fma_f32 v[14:15], v[152:153], v[152:153], v[14:15]
  v_pk_add_f32 v[12:13], v[12:13], v[154:155]
  v_pk_fma_f32 v[14:15], v[154:155], v[154:155], v[14:15]
  v_pk_fma_f32 v[48:49], v[32:33], v[32:33], s[20:21] neg_lo:[1,0,1] neg_hi:[1,0,1]
  v_pk_fma_f32 v[50:51], v[34:35], v[34:35], s[20:21] neg_lo:[1,0,1] neg_hi:[1,0,1]
  v_pk_fma_f32 v[52:53], v[36:37], v[36:37], s[20:21] neg_lo:[1,0,1] neg_hi:[1,0,1]
  v_pk_fma_f32 v[54:55], v[38:39], v[38:39], s[20:21] neg_lo:[1,0,1] neg_hi:[1,0,1]
  v_pk_fma_f32 v[56:57], v[40:41], v[40:41], s[20:21] neg_lo:[1,0,1] neg_hi:[1,0,1]
  v_pk_fma_f32 v[58:59], v[42:43], v[42:43], s[20:21] neg_lo:[1,0,1] neg_hi:[1,0,1]
  v_pk_fma_f32 v[60:61], v[44:45], v[44:45], s[20:21] neg_lo:[1,0,1] neg_hi:[1,0,1]
  v_pk_fma_f32 v[62:63], v[46:47], v[46:47], s[20:21] neg_lo:[1,0,1] neg_hi:[1,0,1]
  v_pk_mul_f32 v[48:49], v[32:33], v[48:49]
  v_pk_mul_f32 v[50:51], v[34:35], v[50:51]
  v_pk_mul_f32 v[52:53], v[36:37], v[52:53]
  v_pk_mul_f32 v[54:55], v[38:39], v[54:55]
  v_pk_mul_f32 v[56:57], v[40:41], v[56:57]
  v_pk_mul_f32 v[58:59], v[42:43], v[58:59]
  v_pk_mul_f32 v[60:61], v[44:45], v[60:61]
  v_pk_mul_f32 v[62:63], v[46:47], v[62:63]
  v_mfma_f32_16x16x32_bf16 v[156:159], v[216:219], v[220:223], 0
  v_cvt_pk_bf16_f32 v184, v16, v17
  v_cvt_pk_bf16_f32 v185, v18, v19
  v_mfma_f32_16x16x32_bf16 v[156:159], v[224:227], v[228:231], v[156:159]
  v_cvt_pk_bf16_f32 v186, v20, v21
  v_cvt_pk_bf16_f32 v187, v22, v23
  v_mfma_f32_16x16x32_bf16 v[156:159], v[232:235], v[236:239], v[156:159]
  ds_read_b128 v[216:219], v3
  ds_read_b128 v[220:223], v4
  v_mfma_f32_32x32x16_bf16 v[64:79], v[192:195], v[184:187], v[64:79]
  ds_read_b128 v[224:227], v3 offset:4800
  ds_read_b128 v[228:231], v4 offset:192
  v_cvt_pk_bf16_f32 v188, v24, v25
  v_cvt_pk_bf16_f32 v189, v26, v27
  v_cvt_pk_bf16_f32 v190, v28, v29
  v_cvt_pk_bf16_f32 v191, v30, v31
  v_mfma_f32_32x32x16_bf16 v[80:95], v[196:199], v[184:187], v[80:95]
  ds_read_b128 v[232:235], v3 offset:9600
  ds_read_b128 v[236:239], v4 offset:384
  v_exp_f32 v48, v48
  v_exp_f32 v49, v49
  v_mfma_f32_32x32x16_bf16 v[96:111], v[200:203], v[184:187], v[96:111]
  v_exp_f32 v50, v50
  v_exp_f32 v51, v51
  v_exp_f32_e64 v52, v52
  v_mfma_f32_32x32x16_bf16 v[64:79], v[204:207], v[188:191], v[64:79]
  v_exp_f32 v53, v53
  v_exp_f32 v54, v54
  v_exp_f32_e64 v55, v55
  v_mfma_f32_32x32x16_bf16 v[80:95], v[208:211], v[188:191], v[80:95]
  v_exp_f32 v56, v56
  v_exp_f32 v57, v57
  v_exp_f32_e64 v58, v58
  v_mfma_f32_32x32x16_bf16 v[96:111], v[212:215], v[188:191], v[96:111]
  s_waitcnt lgkmcnt(0)
  v_exp_f32 v59, v59
  v_exp_f32 v60, v60
  v_exp_f32 v61, v61
  v_exp_f32 v62, v62
  v_exp_f32 v63, v63
  v_pk_add_f32 v[12:13], v[12:13], v[156:157]
  v_pk_fma_f32 v[14:15], v[156:157], v[156:157], v[14:15]
  v_pk_add_f32 v[12:13], v[12:13], v[158:159]
  v_pk_fma_f32 v[14:15], v[158:159], v[158:159], v[14:15]
  v_pk_fma_f32 v[48:49], v[48:49], s[22:23], s[22:23]
  v_pk_fma_f32 v[50:51], v[50:51], s[22:23], s[22:23]
  v_pk_fma_f32 v[52:53], v[52:53], s[22:23], s[22:23]
  v_pk_fma_f32 v[54:55], v[54:55], s[22:23], s[22:23]
  v_pk_fma_f32 v[56:57], v[56:57], s[22:23], s[22:23]
  v_pk_fma_f32 v[58:59], v[58:59], s[22:23], s[22:23]
  v_pk_fma_f32 v[60:61], v[60:61], s[22:23], s[22:23]
  v_pk_fma_f32 v[62:63], v[62:63], s[22:23], s[22:23]
  v_mfma_f32_32x32x16_bf16 v[16:31], a[168:171], v[160:163], 0
  ds_read_b128 v[192:195], v0 offset:43008
  ds_read_b128 v[196:199], v0 offset:44032
  v_rcp_f32 v48, v48
  v_rcp_f32 v49, v49
  v_mfma_f32_16x16x32_bf16 v[112:115], v[216:219], v[220:223], 0
  ds_read_b128 v[216:219], v3 offset:400
  ds_read_b128 v[220:223], v4 offset:16
  v_mfma_f32_32x32x16_bf16 v[16:31], a[172:175], v[164:167], v[16:31]
  ds_read_b128 v[200:203], v0 offset:45056
  ds_read_b128 v[204:207], v0 offset:46080
  v_rcp_f32 v50, v50
  v_rcp_f32 v51, v51
  v_mfma_f32_16x16x32_bf16 v[112:115], v[224:227], v[228:231], v[112:115]
  ds_read_b128 v[224:227], v3 offset:5200
  ds_read_b128 v[228:231], v4 offset:208
  v_mfma_f32_32x32x16_bf16 v[16:31], a[176:179], v[168:171], v[16:31]
  ds_read_b128 v[208:211], v0 offset:47104
  ds_read_b128 v[212:215], v0 offset:48128
  v_rcp_f32 v52, v52
  v_rcp_f32 v53, v53
  v_mfma_f32_16x16x32_bf16 v[112:115], v[232:235], v[236:239], v[112:115]
  ds_read_b128 v[232:235], v3 offset:10000
  ds_read_b128 v[236:239], v4 offset:400
  v_mfma_f32_32x32x16_bf16 v[16:31], a[180:183], v[172:175], v[16:31]
  buffer_store_dwordx4 v[128:131], v10, s[8:11], s28 offen offset:128
  v_rcp_f32 v54, v54
  v_rcp_f32 v55, v55
  v_mfma_f32_32x32x16_bf16 v[16:31], a[184:187], v[176:179], v[16:31]
  v_rcp_f32 v56, v56
  v_rcp_f32 v57, v57
  v_rcp_f32_e64 v58, v58
  v_mfma_f32_32x32x16_bf16 v[16:31], a[188:191], v[180:183], v[16:31]
  s_waitcnt lgkmcnt(0)
  v_rcp_f32 v59, v59
  v_rcp_f32 v60, v60
  v_rcp_f32 v61, v61
  v_rcp_f32 v62, v62
  v_rcp_f32 v63, v63
  v_pk_mul_f32 v[32:33], v[32:33], v[48:49]
  v_pk_mul_f32 v[34:35], v[34:35], v[50:51]
  v_pk_mul_f32 v[36:37], v[36:37], v[52:53]
  v_pk_mul_f32 v[38:39], v[38:39], v[54:55]
  v_pk_mul_f32 v[40:41], v[40:41], v[56:57]
  v_pk_mul_f32 v[42:43], v[42:43], v[58:59]
  v_pk_mul_f32 v[44:45], v[44:45], v[60:61]
  v_pk_mul_f32 v[46:47], v[46:47], v[62:63]
  v_pk_add_f32 v[12:13], v[12:13], v[112:113]
  v_pk_fma_f32 v[14:15], v[112:113], v[112:113], v[14:15]
  v_pk_add_f32 v[12:13], v[12:13], v[114:115]
  v_pk_fma_f32 v[14:15], v[114:115], v[114:115], v[14:15]
  v_pk_fma_f32 v[48:49], v[16:17], v[16:17], s[20:21] neg_lo:[1,0,1] neg_hi:[1,0,1]
  v_pk_fma_f32 v[50:51], v[18:19], v[18:19], s[20:21] neg_lo:[1,0,1] neg_hi:[1,0,1]
  v_pk_fma_f32 v[52:53], v[20:21], v[20:21], s[20:21] neg_lo:[1,0,1] neg_hi:[1,0,1]
  v_pk_fma_f32 v[54:55], v[22:23], v[22:23], s[20:21] neg_lo:[1,0,1] neg_hi:[1,0,1]
  v_pk_fma_f32 v[56:57], v[24:25], v[24:25], s[20:21] neg_lo:[1,0,1] neg_hi:[1,0,1]
  v_pk_fma_f32 v[58:59], v[26:27], v[26:27], s[20:21] neg_lo:[1,0,1] neg_hi:[1,0,1]
  v_pk_fma_f32 v[60:61], v[28:29], v[28:29], s[20:21] neg_lo:[1,0,1] neg_hi:[1,0,1]
  v_pk_fma_f32 v[62:63], v[30:31], v[30:31], s[20:21] neg_lo:[1,0,1] neg_hi:[1,0,1]
  v_pk_mul_f32 v[48:49], v[16:17], v[48:49]
  v_pk_mul_f32 v[50:51], v[18:19], v[50:51]
  v_pk_mul_f32 v[52:53], v[20:21], v[52:53]
  v_pk_mul_f32 v[54:55], v[22:23], v[54:55]
  v_pk_mul_f32 v[56:57], v[24:25], v[56:57]
  v_pk_mul_f32 v[58:59], v[26:27], v[58:59]
  v_pk_mul_f32 v[60:61], v[28:29], v[60:61]
  v_pk_mul_f32 v[62:63], v[30:31], v[62:63]
  v_mfma_f32_16x16x32_bf16 v[116:119], v[216:219], v[220:223], 0
  v_cvt_pk_bf16_f32 v184, v32, v33
  v_cvt_pk_bf16_f32 v185, v34, v35
  v_mfma_f32_16x16x32_bf16 v[116:119], v[224:227], v[228:231], v[116:119]
  v_cvt_pk_bf16_f32 v186, v36, v37
  v_cvt_pk_bf16_f32 v187, v38, v39
  v_mfma_f32_16x16x32_bf16 v[116:119], v[232:235], v[236:239], v[116:119]
  ds_read_b128 v[216:219], v3 offset:800
  ds_read_b128 v[220:223], v4 offset:32
  v_mfma_f32_32x32x16_bf16 v[64:79], v[192:195], v[184:187], v[64:79]
  ds_read_b128 v[224:227], v3 offset:5600
  ds_read_b128 v[228:231], v4 offset:224
  v_cvt_pk_bf16_f32 v188, v40, v41
  v_cvt_pk_bf16_f32 v189, v42, v43
  v_cvt_pk_bf16_f32 v190, v44, v45
  v_cvt_pk_bf16_f32 v191, v46, v47
  v_mfma_f32_32x32x16_bf16 v[80:95], v[196:199], v[184:187], v[80:95]
  ds_read_b128 v[232:235], v3 offset:10400
  ds_read_b128 v[236:239], v4 offset:416
  v_exp_f32 v48, v48
  v_exp_f32 v49, v49
  v_mfma_f32_32x32x16_bf16 v[96:111], v[200:203], v[184:187], v[96:111]
  v_exp_f32 v50, v50
  v_exp_f32 v51, v51
  v_exp_f32_e64 v52, v52
  v_mfma_f32_32x32x16_bf16 v[64:79], v[204:207], v[188:191], v[64:79]
  v_exp_f32 v53, v53
  v_exp_f32 v54, v54
  v_exp_f32_e64 v55, v55
  v_mfma_f32_32x32x16_bf16 v[80:95], v[208:211], v[188:191], v[80:95]
  v_exp_f32 v56, v56
  v_exp_f32 v57, v57
  v_exp_f32_e64 v58, v58
  v_mfma_f32_32x32x16_bf16 v[96:111], v[212:215], v[188:191], v[96:111]
  s_waitcnt lgkmcnt(0)
  v_exp_f32 v59, v59
  v_exp_f32 v60, v60
  v_exp_f32 v61, v61
  v_exp_f32 v62, v62
  v_exp_f32 v63, v63
  v_pk_add_f32 v[12:13], v[12:13], v[116:117]
  v_pk_fma_f32 v[14:15], v[116:117], v[116:117], v[14:15]
  v_pk_add_f32 v[12:13], v[12:13], v[118:119]
  v_pk_fma_f32 v[14:15], v[118:119], v[118:119], v[14:15]
  v_pk_fma_f32 v[48:49], v[48:49], s[22:23], s[22:23]
  v_pk_fma_f32 v[50:51], v[50:51], s[22:23], s[22:23]
  v_pk_fma_f32 v[52:53], v[52:53], s[22:23], s[22:23]
  v_pk_fma_f32 v[54:55], v[54:55], s[22:23], s[22:23]
  v_pk_fma_f32 v[56:57], v[56:57], s[22:23], s[22:23]
  v_pk_fma_f32 v[58:59], v[58:59], s[22:23], s[22:23]
  v_pk_fma_f32 v[60:61], v[60:61], s[22:23], s[22:23]
  v_pk_fma_f32 v[62:63], v[62:63], s[22:23], s[22:23]
  v_mfma_f32_32x32x16_bf16 v[32:47], a[192:195], v[160:163], 0
  ds_read_b128 v[192:195], v0 offset:49152
  ds_read_b128 v[196:199], v0 offset:50176
  v_rcp_f32 v48, v48
  v_rcp_f32 v49, v49
  v_mfma_f32_16x16x32_bf16 v[120:123], v[216:219], v[220:223], 0
  ds_read_b128 v[216:219], v3 offset:1200
  ds_read_b128 v[220:223], v4 offset:48
  v_mfma_f32_32x32x16_bf16 v[32:47], a[196:199], v[164:167], v[32:47]
  ds_read_b128 v[200:203], v0 offset:51200
  ds_read_b128 v[204:207], v0 offset:52224
  v_rcp_f32 v50, v50
  v_rcp_f32 v51, v51
  v_mfma_f32_16x16x32_bf16 v[120:123], v[224:227], v[228:231], v[120:123]
  ds_read_b128 v[224:227], v3 offset:6000
  ds_read_b128 v[228:231], v4 offset:240
  v_mfma_f32_32x32x16_bf16 v[32:47], a[200:203], v[168:171], v[32:47]
  ds_read_b128 v[208:211], v0 offset:53248
  ds_read_b128 v[212:215], v0 offset:54272
  v_rcp_f32 v52, v52
  v_rcp_f32 v53, v53
  v_mfma_f32_16x16x32_bf16 v[120:123], v[232:235], v[236:239], v[120:123]
  ds_read_b128 v[232:235], v3 offset:10800
  ds_read_b128 v[236:239], v4 offset:432
  v_mfma_f32_32x32x16_bf16 v[32:47], a[204:207], v[172:175], v[32:47]
  buffer_store_dwordx4 v[132:135], v10, s[8:11], s28 offen offset:160
  v_rcp_f32 v54, v54
  v_rcp_f32 v55, v55
  v_mfma_f32_32x32x16_bf16 v[32:47], a[208:211], v[176:179], v[32:47]
  v_rcp_f32 v56, v56
  v_rcp_f32 v57, v57
  v_rcp_f32_e64 v58, v58
  v_mfma_f32_32x32x16_bf16 v[32:47], a[212:215], v[180:183], v[32:47]
  s_waitcnt lgkmcnt(0)
  v_rcp_f32 v59, v59
  v_rcp_f32 v60, v60
  v_rcp_f32 v61, v61
  v_rcp_f32 v62, v62
  v_rcp_f32 v63, v63
  v_pk_mul_f32 v[16:17], v[16:17], v[48:49]
  v_pk_mul_f32 v[18:19], v[18:19], v[50:51]
  v_pk_mul_f32 v[20:21], v[20:21], v[52:53]
  v_pk_mul_f32 v[22:23], v[22:23], v[54:55]
  v_pk_mul_f32 v[24:25], v[24:25], v[56:57]
  v_pk_mul_f32 v[26:27], v[26:27], v[58:59]
  v_pk_mul_f32 v[28:29], v[28:29], v[60:61]
  v_pk_mul_f32 v[30:31], v[30:31], v[62:63]
  v_pk_add_f32 v[12:13], v[12:13], v[120:121]
  v_pk_fma_f32 v[14:15], v[120:121], v[120:121], v[14:15]
  v_pk_add_f32 v[12:13], v[12:13], v[122:123]
  v_pk_fma_f32 v[14:15], v[122:123], v[122:123], v[14:15]
  v_pk_fma_f32 v[48:49], v[32:33], v[32:33], s[20:21] neg_lo:[1,0,1] neg_hi:[1,0,1]
  v_pk_fma_f32 v[50:51], v[34:35], v[34:35], s[20:21] neg_lo:[1,0,1] neg_hi:[1,0,1]
  v_pk_fma_f32 v[52:53], v[36:37], v[36:37], s[20:21] neg_lo:[1,0,1] neg_hi:[1,0,1]
  v_pk_fma_f32 v[54:55], v[38:39], v[38:39], s[20:21] neg_lo:[1,0,1] neg_hi:[1,0,1]
  v_pk_fma_f32 v[56:57], v[40:41], v[40:41], s[20:21] neg_lo:[1,0,1] neg_hi:[1,0,1]
  v_pk_fma_f32 v[58:59], v[42:43], v[42:43], s[20:21] neg_lo:[1,0,1] neg_hi:[1,0,1]
  v_pk_fma_f32 v[60:61], v[44:45], v[44:45], s[20:21] neg_lo:[1,0,1] neg_hi:[1,0,1]
  v_pk_fma_f32 v[62:63], v[46:47], v[46:47], s[20:21] neg_lo:[1,0,1] neg_hi:[1,0,1]
  v_pk_mul_f32 v[48:49], v[32:33], v[48:49]
  v_pk_mul_f32 v[50:51], v[34:35], v[50:51]
  v_pk_mul_f32 v[52:53], v[36:37], v[52:53]
  v_pk_mul_f32 v[54:55], v[38:39], v[54:55]
  v_pk_mul_f32 v[56:57], v[40:41], v[56:57]
  v_pk_mul_f32 v[58:59], v[42:43], v[58:59]
  v_pk_mul_f32 v[60:61], v[44:45], v[60:61]
  v_pk_mul_f32 v[62:63], v[46:47], v[62:63]
  v_mfma_f32_16x16x32_bf16 v[124:127], v[216:219], v[220:223], 0
  v_cvt_pk_bf16_f32 v184, v16, v17
  v_cvt_pk_bf16_f32 v185, v18, v19
  v_mfma_f32_16x16x32_bf16 v[124:127], v[224:227], v[228:231], v[124:127]
  v_cvt_pk_bf16_f32 v186, v20, v21
  v_cvt_pk_bf16_f32 v187, v22, v23
  v_mfma_f32_16x16x32_bf16 v[124:127], v[232:235], v[236:239], v[124:127]
  ds_read_b128 v[216:219], v3 offset:1600
  ds_read_b128 v[220:223], v4 offset:64
  v_mfma_f32_32x32x16_bf16 v[64:79], v[192:195], v[184:187], v[64:79]
  ds_read_b128 v[224:227], v3 offset:6400
  ds_read_b128 v[228:231], v4 offset:256
  v_cvt_pk_bf16_f32 v188, v24, v25
  v_cvt_pk_bf16_f32 v189, v26, v27
  v_cvt_pk_bf16_f32 v190, v28, v29
  v_cvt_pk_bf16_f32 v191, v30, v31
  v_mfma_f32_32x32x16_bf16 v[80:95], v[196:199], v[184:187], v[80:95]
  ds_read_b128 v[232:235], v3 offset:11200
  ds_read_b128 v[236:239], v4 offset:448
  v_exp_f32 v48, v48
  v_exp_f32 v49, v49
  v_mfma_f32_32x32x16_bf16 v[96:111], v[200:203], v[184:187], v[96:111]
  v_exp_f32 v50, v50
  v_exp_f32 v51, v51
  v_exp_f32_e64 v52, v52
  v_mfma_f32_32x32x16_bf16 v[64:79], v[204:207], v[188:191], v[64:79]
  v_exp_f32 v53, v53
  v_exp_f32 v54, v54
  v_exp_f32_e64 v55, v55
  v_mfma_f32_32x32x16_bf16 v[80:95], v[208:211], v[188:191], v[80:95]
  v_exp_f32 v56, v56
  v_exp_f32 v57, v57
  v_exp_f32_e64 v58, v58
  v_mfma_f32_32x32x16_bf16 v[96:111], v[212:215], v[188:191], v[96:111]
  s_waitcnt lgkmcnt(0)
  v_exp_f32 v59, v59
  v_exp_f32 v60, v60
  v_exp_f32 v61, v61
  v_exp_f32 v62, v62
  v_exp_f32 v63, v63
  v_pk_add_f32 v[12:13], v[12:13], v[124:125]
  v_pk_fma_f32 v[14:15], v[124:125], v[124:125], v[14:15]
  v_pk_add_f32 v[12:13], v[12:13], v[126:127]
  v_pk_fma_f32 v[14:15], v[126:127], v[126:127], v[14:15]
  v_pk_fma_f32 v[48:49], v[48:49], s[22:23], s[22:23]
  v_pk_fma_f32 v[50:51], v[50:51], s[22:23], s[22:23]
  v_pk_fma_f32 v[52:53], v[52:53], s[22:23], s[22:23]
  v_pk_fma_f32 v[54:55], v[54:55], s[22:23], s[22:23]
  v_pk_fma_f32 v[56:57], v[56:57], s[22:23], s[22:23]
  v_pk_fma_f32 v[58:59], v[58:59], s[22:23], s[22:23]
  v_pk_fma_f32 v[60:61], v[60:61], s[22:23], s[22:23]
  v_pk_fma_f32 v[62:63], v[62:63], s[22:23], s[22:23]
  v_mfma_f32_32x32x16_bf16 v[16:31], a[216:219], v[160:163], 0
  ds_read_b128 v[192:195], v0 offset:55296
  ds_read_b128 v[196:199], v0 offset:56320
  v_rcp_f32 v48, v48
  v_rcp_f32 v49, v49
  v_mfma_f32_16x16x32_bf16 v[128:131], v[216:219], v[220:223], 0
  ds_read_b128 v[216:219], v3 offset:2000
  ds_read_b128 v[220:223], v4 offset:80
  v_mfma_f32_32x32x16_bf16 v[16:31], a[220:223], v[164:167], v[16:31]
  ds_read_b128 v[200:203], v0 offset:57344
  ds_read_b128 v[204:207], v0 offset:58368
  v_rcp_f32 v50, v50
  v_rcp_f32 v51, v51
  v_mfma_f32_16x16x32_bf16 v[128:131], v[224:227], v[228:231], v[128:131]
  ds_read_b128 v[224:227], v3 offset:6800
  ds_read_b128 v[228:231], v4 offset:272
  v_mfma_f32_32x32x16_bf16 v[16:31], a[224:227], v[168:171], v[16:31]
  ds_read_b128 v[208:211], v0 offset:59392
  ds_read_b128 v[212:215], v0 offset:60416
  v_rcp_f32 v52, v52
  v_rcp_f32 v53, v53
  v_mfma_f32_16x16x32_bf16 v[128:131], v[232:235], v[236:239], v[128:131]
  ds_read_b128 v[232:235], v3 offset:11600
  ds_read_b128 v[236:239], v4 offset:464
  v_mfma_f32_32x32x16_bf16 v[16:31], a[228:231], v[172:175], v[16:31]
  v_rcp_f32 v54, v54
  v_rcp_f32 v55, v55
  v_rcp_f32_e64 v56, v56
  v_mfma_f32_32x32x16_bf16 v[16:31], a[232:235], v[176:179], v[16:31]
  v_rcp_f32 v57, v57
  v_rcp_f32 v58, v58
  v_rcp_f32_e64 v59, v59
  v_mfma_f32_32x32x16_bf16 v[16:31], a[236:239], v[180:183], v[16:31]
  s_waitcnt lgkmcnt(0)
  v_rcp_f32 v60, v60
  v_rcp_f32 v61, v61
  v_rcp_f32 v62, v62
  v_rcp_f32_e64 v63, v63
  v_pk_mul_f32 v[32:33], v[32:33], v[48:49]
  v_pk_mul_f32 v[34:35], v[34:35], v[50:51]
  v_pk_mul_f32 v[36:37], v[36:37], v[52:53]
  v_pk_mul_f32 v[38:39], v[38:39], v[54:55]
  v_pk_mul_f32 v[40:41], v[40:41], v[56:57]
  v_pk_mul_f32 v[42:43], v[42:43], v[58:59]
  v_pk_mul_f32 v[44:45], v[44:45], v[60:61]
  v_pk_mul_f32 v[46:47], v[46:47], v[62:63]
  v_pk_add_f32 v[12:13], v[12:13], v[128:129]
  v_pk_fma_f32 v[14:15], v[128:129], v[128:129], v[14:15]
  v_pk_add_f32 v[12:13], v[12:13], v[130:131]
  v_pk_fma_f32 v[14:15], v[130:131], v[130:131], v[14:15]
  v_pk_fma_f32 v[48:49], v[16:17], v[16:17], s[20:21] neg_lo:[1,0,1] neg_hi:[1,0,1]
  v_pk_fma_f32 v[50:51], v[18:19], v[18:19], s[20:21] neg_lo:[1,0,1] neg_hi:[1,0,1]
  v_pk_fma_f32 v[52:53], v[20:21], v[20:21], s[20:21] neg_lo:[1,0,1] neg_hi:[1,0,1]
  v_pk_fma_f32 v[54:55], v[22:23], v[22:23], s[20:21] neg_lo:[1,0,1] neg_hi:[1,0,1]
  v_pk_fma_f32 v[56:57], v[24:25], v[24:25], s[20:21] neg_lo:[1,0,1] neg_hi:[1,0,1]
  v_pk_fma_f32 v[58:59], v[26:27], v[26:27], s[20:21] neg_lo:[1,0,1] neg_hi:[1,0,1]
  v_pk_fma_f32 v[60:61], v[28:29], v[28:29], s[20:21] neg_lo:[1,0,1] neg_hi:[1,0,1]
  v_pk_fma_f32 v[62:63], v[30:31], v[30:31], s[20:21] neg_lo:[1,0,1] neg_hi:[1,0,1]
  v_pk_mul_f32 v[48:49], v[16:17], v[48:49]
  v_pk_mul_f32 v[50:51], v[18:19], v[50:51]
  v_pk_mul_f32 v[52:53], v[20:21], v[52:53]
  v_pk_mul_f32 v[54:55], v[22:23], v[54:55]
  v_pk_mul_f32 v[56:57], v[24:25], v[56:57]
  v_pk_mul_f32 v[58:59], v[26:27], v[58:59]
  v_pk_mul_f32 v[60:61], v[28:29], v[60:61]
  v_pk_mul_f32 v[62:63], v[30:31], v[62:63]
  v_mfma_f32_16x16x32_bf16 v[132:135], v[216:219], v[220:223], 0
  v_cvt_pk_bf16_f32 v184, v32, v33
  v_cvt_pk_bf16_f32 v185, v34, v35
  v_mfma_f32_16x16x32_bf16 v[132:135], v[224:227], v[228:231], v[132:135]
  v_cvt_pk_bf16_f32 v186, v36, v37
  v_cvt_pk_bf16_f32 v187, v38, v39
  v_mfma_f32_16x16x32_bf16 v[132:135], v[232:235], v[236:239], v[132:135]
  ds_read_b128 v[216:219], v0 offset:12288
  ds_read_b128 v[220:223], v0 offset:13312
  v_mfma_f32_32x32x16_bf16 v[64:79], v[192:195], v[184:187], v[64:79]
  ds_read_b128 v[224:227], v0 offset:14336
  ds_read_b128 v[228:231], v0 offset:15360
  v_cvt_pk_bf16_f32 v188, v40, v41
  v_cvt_pk_bf16_f32 v189, v42, v43
  v_cvt_pk_bf16_f32 v190, v44, v45
  v_cvt_pk_bf16_f32 v191, v46, v47
  v_mfma_f32_32x32x16_bf16 v[80:95], v[196:199], v[184:187], v[80:95]
  ds_read_b128 v[232:235], v0 offset:16384
  ds_read_b128 v[236:239], v0 offset:17408
  v_exp_f32 v48, v48
  v_exp_f32 v49, v49
  v_mfma_f32_32x32x16_bf16 v[96:111], v[200:203], v[184:187], v[96:111]
  v_exp_f32 v50, v50
  v_exp_f32 v51, v51
  v_exp_f32_e64 v52, v52
  v_mfma_f32_32x32x16_bf16 v[64:79], v[204:207], v[188:191], v[64:79]
  s_mov_b32 s28, s34
  v_exp_f32 v53, v53
  v_exp_f32 v54, v54
  v_exp_f32 v55, v55
  v_mfma_f32_32x32x16_bf16 v[80:95], v[208:211], v[188:191], v[80:95]
  s_add_u32 s34, s34, 0x60000
  v_exp_f32 v56, v56
  v_exp_f32 v57, v57
  v_exp_f32_e64 v58, v58
  v_mfma_f32_32x32x16_bf16 v[96:111], v[212:215], v[188:191], v[96:111]
  s_waitcnt lgkmcnt(0)
  v_exp_f32 v59, v59
  v_exp_f32 v60, v60
  v_exp_f32 v61, v61
  v_exp_f32 v62, v62
  v_exp_f32 v63, v63
  v_pk_add_f32 v[12:13], v[12:13], v[132:133]
  v_pk_fma_f32 v[14:15], v[132:133], v[132:133], v[14:15]
  v_pk_add_f32 v[12:13], v[12:13], v[134:135]
  v_pk_fma_f32 v[14:15], v[134:135], v[134:135], v[14:15]
  v_pk_fma_f32 v[48:49], v[48:49], s[22:23], s[22:23]
  v_pk_fma_f32 v[50:51], v[50:51], s[22:23], s[22:23]
  v_pk_fma_f32 v[52:53], v[52:53], s[22:23], s[22:23]
  v_pk_fma_f32 v[54:55], v[54:55], s[22:23], s[22:23]
  v_pk_fma_f32 v[56:57], v[56:57], s[22:23], s[22:23]
  v_pk_fma_f32 v[58:59], v[58:59], s[22:23], s[22:23]
  v_pk_fma_f32 v[60:61], v[60:61], s[22:23], s[22:23]
  v_pk_fma_f32 v[62:63], v[62:63], s[22:23], s[22:23]
  v_mfma_f32_32x32x16_bf16 v[32:47], v[216:219], v[160:163], 0
  ds_read_b128 v[192:195], v0 offset:61440
  ds_read_b128 v[196:199], v0 offset:62464
  v_rcp_f32 v48, v48
  v_rcp_f32 v49, v49
  v_add_f32_e64 v12, v12, v13
  v_mfma_f32_32x32x16_bf16 v[32:47], v[220:223], v[164:167], v[32:47]
  ds_read_b128 v[200:203], v0 offset:63488
  ds_read_b128 v[204:207], v0 offset:64512
  v_rcp_f32 v50, v50
  v_add_f32 v14, v14, v15
  v_rcp_f32_e64 v51, v51
  v_mfma_f32_32x32x16_bf16 v[32:47], v[224:227], v[168:171], v[32:47]
  ds_read_b128 v[208:211], v1
  ds_read_b128 v[212:215], v1 offset:1024
  v_permlane32_swap_b32 v12, v14
  v_rcp_f32 v52, v52
  v_add_f32 v12, v12, v14
  v_rcp_f32 v53, v53
  v_mfma_f32_32x32x16_bf16 v[32:47], v[228:231], v[172:175], v[32:47]
  v_mov_b32 v14, v12
  v_rcp_f32 v54, v54
  s_nop 0
  v_permlane32_swap_b32 v12, v14
  v_rcp_f32 v55, v55
  v_mul_f32 v12, s24, v12
  v_mfma_f32_32x32x16_bf16 v[32:47], v[232:235], v[176:179], v[32:47]
  v_rcp_f32 v56, v56
  v_rcp_f32 v57, v57
  v_mul_f32 v13, s24, v14
  v_rcp_f32 v58, v58
  v_fma_f32 v13, -v12, v12, v13
  v_mfma_f32_32x32x16_bf16 v[32:47], v[236:239], v[180:183], v[32:47]
  s_waitcnt lgkmcnt(0)
  v_rcp_f32 v59, v59
  v_max_f32 v13, 0, v13
  v_rcp_f32 v60, v60
  v_add_f32 v13, s25, v13
  v_rcp_f32 v61, v61
  v_rsq_f32 v13, v13
  v_rcp_f32 v62, v62
  v_mul_f32 v14, s22, v13
  v_rcp_f32 v63, v63
  v_mul_f32_e64 v12, -v12, v14
  v_pk_mul_f32 v[16:17], v[16:17], v[48:49]
  v_pk_mul_f32 v[18:19], v[18:19], v[50:51]
  v_pk_mul_f32 v[20:21], v[20:21], v[52:53]
  v_pk_mul_f32 v[22:23], v[22:23], v[54:55]
  v_pk_mul_f32 v[24:25], v[24:25], v[56:57]
  v_pk_mul_f32 v[26:27], v[26:27], v[58:59]
  v_pk_mul_f32 v[28:29], v[28:29], v[60:61]
  v_pk_mul_f32 v[30:31], v[30:31], v[62:63]
  v_pk_fma_f32 v[112:113], v[112:113], v[14:15], v[12:13] op_sel_hi:[1,0,0]
  v_pk_fma_f32 v[114:115], v[114:115], v[14:15], v[12:13] op_sel_hi:[1,0,0]
  v_pk_fma_f32 v[116:117], v[116:117], v[14:15], v[12:13] op_sel_hi:[1,0,0]
  v_pk_fma_f32 v[118:119], v[118:119], v[14:15], v[12:13] op_sel_hi:[1,0,0]
  v_pk_fma_f32 v[120:121], v[120:121], v[14:15], v[12:13] op_sel_hi:[1,0,0]
  v_pk_fma_f32 v[122:123], v[122:123], v[14:15], v[12:13] op_sel_hi:[1,0,0]
  v_pk_fma_f32 v[124:125], v[124:125], v[14:15], v[12:13] op_sel_hi:[1,0,0]
  v_pk_fma_f32 v[126:127], v[126:127], v[14:15], v[12:13] op_sel_hi:[1,0,0]
  v_pk_fma_f32 v[128:129], v[128:129], v[14:15], v[12:13] op_sel_hi:[1,0,0]
  v_pk_fma_f32 v[130:131], v[130:131], v[14:15], v[12:13] op_sel_hi:[1,0,0]
  v_pk_fma_f32 v[132:133], v[132:133], v[14:15], v[12:13] op_sel_hi:[1,0,0]
  v_pk_fma_f32 v[134:135], v[134:135], v[14:15], v[12:13] op_sel_hi:[1,0,0]
  v_pk_fma_f32 v[136:137], v[136:137], v[14:15], v[12:13] op_sel_hi:[1,0,0]
  v_pk_fma_f32 v[138:139], v[138:139], v[14:15], v[12:13] op_sel_hi:[1,0,0]
  v_pk_fma_f32 v[140:141], v[140:141], v[14:15], v[12:13] op_sel_hi:[1,0,0]
  v_pk_fma_f32 v[142:143], v[142:143], v[14:15], v[12:13] op_sel_hi:[1,0,0]
  v_pk_fma_f32 v[144:145], v[144:145], v[14:15], v[12:13] op_sel_hi:[1,0,0]
  v_pk_fma_f32 v[146:147], v[146:147], v[14:15], v[12:13] op_sel_hi:[1,0,0]
  v_pk_fma_f32 v[148:149], v[148:149], v[14:15], v[12:13] op_sel_hi:[1,0,0]
  v_pk_fma_f32 v[150:151], v[150:151], v[14:15], v[12:13] op_sel_hi:[1,0,0]
  v_pk_fma_f32 v[152:153], v[152:153], v[14:15], v[12:13] op_sel_hi:[1,0,0]
  v_pk_fma_f32 v[154:155], v[154:155], v[14:15], v[12:13] op_sel_hi:[1,0,0]
  v_pk_fma_f32 v[156:157], v[156:157], v[14:15], v[12:13] op_sel_hi:[1,0,0]
  v_pk_fma_f32 v[158:159], v[158:159], v[14:15], v[12:13] op_sel_hi:[1,0,0]
  v_pk_fma_f32 v[48:49], v[32:33], v[32:33], s[20:21] neg_lo:[1,0,1] neg_hi:[1,0,1]
  v_pk_fma_f32 v[50:51], v[34:35], v[34:35], s[20:21] neg_lo:[1,0,1] neg_hi:[1,0,1]
  v_pk_fma_f32 v[52:53], v[36:37], v[36:37], s[20:21] neg_lo:[1,0,1] neg_hi:[1,0,1]
  v_pk_fma_f32 v[54:55], v[38:39], v[38:39], s[20:21] neg_lo:[1,0,1] neg_hi:[1,0,1]
  v_pk_fma_f32 v[56:57], v[40:41], v[40:41], s[20:21] neg_lo:[1,0,1] neg_hi:[1,0,1]
  v_pk_fma_f32 v[58:59], v[42:43], v[42:43], s[20:21] neg_lo:[1,0,1] neg_hi:[1,0,1]
  v_pk_fma_f32 v[60:61], v[44:45], v[44:45], s[20:21] neg_lo:[1,0,1] neg_hi:[1,0,1]
  v_pk_fma_f32 v[62:63], v[46:47], v[46:47], s[20:21] neg_lo:[1,0,1] neg_hi:[1,0,1]
  v_pk_mul_f32 v[48:49], v[32:33], v[48:49]
  v_pk_mul_f32 v[50:51], v[34:35], v[50:51]
  v_pk_mul_f32 v[52:53], v[36:37], v[52:53]
  v_pk_mul_f32 v[54:55], v[38:39], v[54:55]
  v_pk_mul_f32 v[56:57], v[40:41], v[56:57]
  v_cvt_pk_bf16_f32 v184, v16, v17
  v_cvt_pk_bf16_f32 v185, v18, v19
  v_cvt_pk_bf16_f32 v186, v20, v21
  v_cvt_pk_bf16_f32 v187, v22, v23
  v_pk_mul_f32 v[58:59], v[42:43], v[58:59]
  v_pk_mul_f32 v[60:61], v[44:45], v[60:61]
  v_pk_mul_f32 v[62:63], v[46:47], v[62:63]
  v_mfma_f32_32x32x16_bf16 v[64:79], v[192:195], v[184:187], v[64:79]
  ds_read_b128 v[216:219], v0 offset:18432
  ds_read_b128 v[220:223], v0 offset:19456
  v_cvt_pk_bf16_f32 v188, v24, v25
  v_cvt_pk_bf16_f32 v189, v26, v27
  v_cvt_pk_bf16_f32 v190, v28, v29
  v_cvt_pk_bf16_f32 v191, v30, v31
  v_exp_f32_e64 v48, v48
  v_cndmask_b32 v159, v159, v250, s[12:13]
  v_mfma_f32_32x32x16_bf16 v[80:95], v[196:199], v[184:187], v[80:95]
  ds_read_b128 v[224:227], v0 offset:20480
  ds_read_b128 v[228:231], v0 offset:21504
  v_exp_f32_e64 v49, v49
  v_cvt_pk_bf16_f32 v160, v112, v113
  v_cvt_pk_bf16_f32 v161, v114, v115
  v_exp_f32_e64 v50, v50
  v_cvt_pk_bf16_f32 v162, v116, v117
  v_mfma_f32_32x32x16_bf16 v[96:111], v[200:203], v[184:187], v[96:111]
  ds_read_b128 v[232:235], v0 offset:22528
  ds_read_b128 v[236:239], v0 offset:23552
  v_exp_f32_e64 v51, v51
  v_cvt_pk_bf16_f32 v163, v118, v119
  v_cvt_pk_bf16_f32 v164, v120, v121
  v_exp_f32_e64 v52, v52
  v_cvt_pk_bf16_f32 v165, v122, v123
  v_mfma_f32_32x32x16_bf16 v[64:79], v[204:207], v[188:191], v[64:79]
  v_exp_f32_e64 v53, v53
  v_cvt_pk_bf16_f32 v166, v124, v125
  v_cvt_pk_bf16_f32 v167, v126, v127
  v_exp_f32_e64 v54, v54
  v_cvt_pk_bf16_f32 v168, v128, v129
  v_exp_f32_e64 v55, v55
  v_cvt_pk_bf16_f32 v169, v130, v131
  v_cvt_pk_bf16_f32 v170, v132, v133
  v_mfma_f32_32x32x16_bf16 v[80:95], v[208:211], v[188:191], v[80:95]
  v_exp_f32_e64 v56, v56
  v_cvt_pk_bf16_f32 v171, v134, v135
  v_cvt_pk_bf16_f32 v172, v136, v137
  v_exp_f32_e64 v57, v57
  v_cvt_pk_bf16_f32 v173, v138, v139
  v_exp_f32_e64 v58, v58
  v_cvt_pk_bf16_f32 v174, v140, v141
  v_cvt_pk_bf16_f32 v175, v142, v143
  v_mfma_f32_32x32x16_bf16 v[96:111], v[212:215], v[188:191], v[96:111]
  s_waitcnt lgkmcnt(0)
  v_exp_f32 v59, v59
  v_cvt_pk_bf16_f32 v176, v144, v145
  v_exp_f32_e64 v60, v60
  v_cvt_pk_bf16_f32 v177, v146, v147
  v_cvt_pk_bf16_f32 v178, v148, v149
  v_exp_f32_e64 v61, v61
  v_cvt_pk_bf16_f32 v179, v150, v151
  v_exp_f32_e64 v62, v62
  v_cvt_pk_bf16_f32 v180, v152, v153
  v_cvt_pk_bf16_f32 v181, v154, v155
  v_exp_f32_e64 v63, v63
  v_cvt_pk_bf16_f32 v182, v156, v157
  v_cvt_pk_bf16_f32 v183, v158, v159
  v_pk_fma_f32 v[48:49], v[48:49], s[22:23], s[22:23]
  v_pk_fma_f32 v[50:51], v[50:51], s[22:23], s[22:23]
  v_pk_fma_f32 v[52:53], v[52:53], s[22:23], s[22:23]
  v_pk_fma_f32 v[54:55], v[54:55], s[22:23], s[22:23]
  v_pk_fma_f32 v[56:57], v[56:57], s[22:23], s[22:23]
  v_pk_fma_f32 v[58:59], v[58:59], s[22:23], s[22:23]
  v_pk_fma_f32 v[60:61], v[60:61], s[22:23], s[22:23]
  v_pk_fma_f32 v[62:63], v[62:63], s[22:23], s[22:23]
  s_sub_u32 s26, s26, 1
  s_cmp_lg_u32 s26, 0
  s_waitcnt vmcnt(4)
  s_cbranch_scc1 S_loop
  v_mfma_f32_32x32x16_bf16 v[16:31], v[216:219], v[160:163], 0
  ds_read_b128 v[192:195], v1 offset:2048
  ds_read_b128 v[196:199], v1 offset:3072
  ds_read_b128 v[200:203], v1 offset:4096
  v_rcp_f32 v48, v48
  v_rcp_f32 v49, v49
  v_mfma_f32_32x32x16_bf16 v[16:31], v[220:223], v[164:167], v[16:31]
  ds_read_b128 v[204:207], v1 offset:5120
  ds_read_b128 v[208:211], v1 offset:6144
  ds_read_b128 v[212:215], v1 offset:7168
  v_rcp_f32 v50, v50
  v_rcp_f32 v51, v51
  v_mfma_f32_32x32x16_bf16 v[16:31], v[224:227], v[168:171], v[16:31]
  ds_read_b128 v[136:139], v5
  ds_read_b128 v[140:143], v5 offset:32
  ds_read_b128 v[144:147], v5 offset:64
  v_rcp_f32 v52, v52
  v_rcp_f32 v53, v53
  v_mfma_f32_32x32x16_bf16 v[16:31], v[228:231], v[172:175], v[16:31]
  ds_read_b128 v[148:151], v5 offset:96
  ds_read_b128 v[152:155], v5 offset:128
  ds_read_b128 v[156:159], v5 offset:160
  v_rcp_f32 v54, v54
  v_rcp_f32 v55, v55
  v_mfma_f32_32x32x16_bf16 v[16:31], v[232:235], v[176:179], v[16:31]
  v_rcp_f32 v56, v56
  v_rcp_f32 v57, v57
  v_rcp_f32_e64 v58, v58
  v_mfma_f32_32x32x16_bf16 v[16:31], v[236:239], v[180:183], v[16:31]
  s_waitcnt lgkmcnt(0)
  v_rcp_f32 v59, v59
  v_rcp_f32 v60, v60
  v_rcp_f32 v61, v61
  v_rcp_f32 v62, v62
  v_rcp_f32 v63, v63
  v_pk_mul_f32 v[32:33], v[32:33], v[48:49]
  v_pk_mul_f32 v[34:35], v[34:35], v[50:51]
  v_pk_mul_f32 v[36:37], v[36:37], v[52:53]
  v_pk_mul_f32 v[38:39], v[38:39], v[54:55]
  v_pk_mul_f32 v[40:41], v[40:41], v[56:57]
  v_pk_mul_f32 v[42:43], v[42:43], v[58:59]
  v_pk_mul_f32 v[44:45], v[44:45], v[60:61]
  v_pk_mul_f32 v[46:47], v[46:47], v[62:63]
  v_pk_fma_f32 v[48:49], v[16:17], v[16:17], s[20:21] neg_lo:[1,0,1] neg_hi:[1,0,1]
  v_pk_fma_f32 v[50:51], v[18:19], v[18:19], s[20:21] neg_lo:[1,0,1] neg_hi:[1,0,1]
  v_pk_fma_f32 v[52:53], v[20:21], v[20:21], s[20:21] neg_lo:[1,0,1] neg_hi:[1,0,1]
  v_pk_fma_f32 v[54:55], v[22:23], v[22:23], s[20:21] neg_lo:[1,0,1] neg_hi:[1,0,1]
  v_pk_fma_f32 v[56:57], v[24:25], v[24:25], s[20:21] neg_lo:[1,0,1] neg_hi:[1,0,1]
  v_pk_fma_f32 v[58:59], v[26:27], v[26:27], s[20:21] neg_lo:[1,0,1] neg_hi:[1,0,1]
  v_pk_fma_f32 v[60:61], v[28:29], v[28:29], s[20:21] neg_lo:[1,0,1] neg_hi:[1,0,1]
  v_pk_fma_f32 v[62:63], v[30:31], v[30:31], s[20:21] neg_lo:[1,0,1] neg_hi:[1,0,1]
  v_pk_mul_f32 v[48:49], v[16:17], v[48:49]
  v_pk_mul_f32 v[50:51], v[18:19], v[50:51]
  v_pk_mul_f32 v[52:53], v[20:21], v[52:53]
  v_pk_mul_f32 v[54:55], v[22:23], v[54:55]
  v_pk_mul_f32 v[56:57], v[24:25], v[56:57]
  v_cvt_pk_bf16_f32 v184, v32, v33
  v_cvt_pk_bf16_f32 v185, v34, v35
  v_cvt_pk_bf16_f32 v186, v36, v37
  v_cvt_pk_bf16_f32 v187, v38, v39
  v_pk_mul_f32 v[58:59], v[26:27], v[58:59]
  v_pk_mul_f32 v[60:61], v[28:29], v[60:61]
  v_pk_mul_f32 v[62:63], v[30:31], v[62:63]
  v_mfma_f32_32x32x16_bf16 v[64:79], v[192:195], v[184:187], v[64:79]
  v_cvt_pk_bf16_f32 v188, v40, v41
  v_cvt_pk_bf16_f32 v189, v42, v43
  v_cvt_pk_bf16_f32 v190, v44, v45
  v_cvt_pk_bf16_f32 v191, v46, v47
  v_exp_f32_e64 v48, v48
  v_mfma_f32_32x32x16_bf16 v[80:95], v[196:199], v[184:187], v[80:95]
  v_exp_f32 v49, v49
  v_exp_f32 v50, v50
  v_exp_f32_e64 v51, v51
  v_mfma_f32_32x32x16_bf16 v[96:111], v[200:203], v[184:187], v[96:111]
  v_exp_f32 v52, v52
  v_exp_f32 v53, v53
  v_exp_f32_e64 v54, v54
  v_mfma_f32_32x32x16_bf16 v[64:79], v[204:207], v[188:191], v[64:79]
  v_exp_f32 v55, v55
  v_exp_f32 v56, v56
  v_exp_f32_e64 v57, v57
  v_mfma_f32_32x32x16_bf16 v[80:95], v[208:211], v[188:191], v[80:95]
  v_exp_f32_e64 v58, v58
  v_exp_f32_e64 v59, v59
  v_exp_f32_e64 v60, v60
  v_mfma_f32_32x32x16_bf16 v[96:111], v[212:215], v[188:191], v[96:111]
  v_exp_f32_e64 v61, v61
  v_exp_f32_e64 v62, v62
  v_exp_f32_e64 v63, v63
  v_pk_fma_f32 v[48:49], v[48:49], s[22:23], s[22:23]
  v_pk_fma_f32 v[50:51], v[50:51], s[22:23], s[22:23]
  v_pk_fma_f32 v[52:53], v[52:53], s[22:23], s[22:23]
  v_pk_fma_f32 v[54:55], v[54:55], s[22:23], s[22:23]
  v_pk_fma_f32 v[56:57], v[56:57], s[22:23], s[22:23]
  v_pk_fma_f32 v[58:59], v[58:59], s[22:23], s[22:23]
  v_pk_fma_f32 v[60:61], v[60:61], s[22:23], s[22:23]
  v_pk_fma_f32 v[62:63], v[62:63], s[22:23], s[22:23]
  v_mfma_f32_32x32x16_bf16 v[32:47], a[0:3], v[160:163], 0
  v_cvt_pk_bf16_f32 v112, v64, v65
  v_cvt_pk_bf16_f32 v113, v66, v67
  v_cvt_pk_bf16_f32 v114, v68, v69
  v_cvt_pk_bf16_f32 v115, v70, v71
  v_cvt_pk_bf16_f32 v116, v72, v73
  v_cvt_pk_bf16_f32 v117, v74, v75
  v_mfma_f32_32x32x16_bf16 v[32:47], a[4:7], v[164:167], v[32:47]
  v_cvt_pk_bf16_f32 v118, v76, v77
  v_cvt_pk_bf16_f32 v119, v78, v79
  v_cvt_pk_bf16_f32 v120, v80, v81
  v_cvt_pk_bf16_f32 v121, v82, v83
  v_cvt_pk_bf16_f32 v122, v84, v85
  v_cvt_pk_bf16_f32 v123, v86, v87
  v_mfma_f32_32x32x16_bf16 v[32:47], a[8:11], v[168:171], v[32:47]
  ds_read_b128 v[64:67], v2
  ds_read_b128 v[68:71], v2 offset:32
  ds_read_b128 v[72:75], v2 offset:64
  ds_read_b128 v[76:79], v2 offset:96
  v_cvt_pk_bf16_f32 v124, v88, v89
  v_cvt_pk_bf16_f32 v125, v90, v91
  v_mfma_f32_32x32x16_bf16 v[32:47], a[12:15], v[172:175], v[32:47]
  ds_read_b128 v[192:195], v1 offset:8192
  ds_read_b128 v[196:199], v1 offset:9216
  v_cvt_pk_bf16_f32 v126, v92, v93
  v_cvt_pk_bf16_f32 v127, v94, v95
  v_cvt_pk_bf16_f32 v128, v96, v97
  v_cvt_pk_bf16_f32 v129, v98, v99
  v_mfma_f32_32x32x16_bf16 v[32:47], a[16:19], v[176:179], v[32:47]
  ds_read_b128 v[80:83], v2 offset:128
  ds_read_b128 v[84:87], v2 offset:160
  ds_read_b128 v[88:91], v2 offset:192
  ds_read_b128 v[92:95], v2 offset:224
  v_cvt_pk_bf16_f32 v130, v100, v101
  v_cvt_pk_bf16_f32 v131, v102, v103
  v_mfma_f32_32x32x16_bf16 v[32:47], a[20:23], v[180:183], v[32:47]
  s_waitcnt lgkmcnt(6)
  ds_read_b128 v[200:203], v1 offset:10240
  ds_read_b128 v[204:207], v1 offset:11264
  v_cvt_pk_bf16_f32 v132, v104, v105
  v_cvt_pk_bf16_f32 v133, v106, v107
  v_cvt_pk_bf16_f32 v134, v108, v109
  v_cvt_pk_bf16_f32 v135, v110, v111
  v_mfma_f32_32x32x16_bf16 v[64:79], v[240:243], v[136:139], v[64:79]
  s_nop 0
  ds_read_b128 v[96:99], v2 offset:256
  ds_read_b128 v[100:103], v2 offset:288
  ds_read_b128 v[104:107], v2 offset:320
  ds_read_b128 v[108:111], v2 offset:352
  v_rcp_f32 v48, v48
  v_mfma_f32_32x32x16_bf16 v[64:79], v[244:247], v[140:143], v[64:79]
  s_waitcnt lgkmcnt(6)
  ds_read_b128 v[208:211], v1 offset:12288
  ds_read_b128 v[212:215], v1 offset:13312
  v_rcp_f32 v49, v49
  v_rcp_f32 v50, v50
  v_mfma_f32_32x32x16_bf16 v[80:95], v[240:243], v[144:147], v[80:95]
  v_rcp_f32 v51, v51
  v_rcp_f32 v52, v52
  v_rcp_f32_e64 v53, v53
  v_mfma_f32_32x32x16_bf16 v[80:95], v[244:247], v[148:151], v[80:95]
  s_waitcnt lgkmcnt(2)
  v_rcp_f32 v54, v54
  v_rcp_f32 v55, v55
  v_rcp_f32 v56, v56
  v_mfma_f32_32x32x16_bf16 v[96:111], v[240:243], v[152:155], v[96:111]
  v_rcp_f32 v57, v57
  v_rcp_f32 v58, v58
  v_rcp_f32_e64 v59, v59
  v_mfma_f32_32x32x16_bf16 v[96:111], v[244:247], v[156:159], v[96:111]
  s_waitcnt lgkmcnt(0)
  v_rcp_f32 v60, v60
  v_rcp_f32 v61, v61
  v_rcp_f32 v62, v62
  v_rcp_f32_e64 v63, v63
  v_pk_mul_f32 v[16:17], v[16:17], v[48:49]
  v_pk_mul_f32 v[18:19], v[18:19], v[50:51]
  v_pk_mul_f32 v[20:21], v[20:21], v[52:53]
  v_pk_mul_f32 v[22:23], v[22:23], v[54:55]
  v_pk_mul_f32 v[24:25], v[24:25], v[56:57]
  v_pk_mul_f32 v[26:27], v[26:27], v[58:59]
  v_pk_mul_f32 v[28:29], v[28:29], v[60:61]
  v_pk_mul_f32 v[30:31], v[30:31], v[62:63]
  v_pk_fma_f32 v[48:49], v[32:33], v[32:33], s[20:21] neg_lo:[1,0,1] neg_hi:[1,0,1]
  v_pk_fma_f32 v[50:51], v[34:35], v[34:35], s[20:21] neg_lo:[1,0,1] neg_hi:[1,0,1]
  v_pk_fma_f32 v[52:53], v[36:37], v[36:37], s[20:21] neg_lo:[1,0,1] neg_hi:[1,0,1]
  v_pk_fma_f32 v[54:55], v[38:39], v[38:39], s[20:21] neg_lo:[1,0,1] neg_hi:[1,0,1]
  v_pk_fma_f32 v[56:57], v[40:41], v[40:41], s[20:21] neg_lo:[1,0,1] neg_hi:[1,0,1]
  v_pk_fma_f32 v[58:59], v[42:43], v[42:43], s[20:21] neg_lo:[1,0,1] neg_hi:[1,0,1]
  v_pk_fma_f32 v[60:61], v[44:45], v[44:45], s[20:21] neg_lo:[1,0,1] neg_hi:[1,0,1]
  v_pk_fma_f32 v[62:63], v[46:47], v[46:47], s[20:21] neg_lo:[1,0,1] neg_hi:[1,0,1]
  v_pk_mul_f32 v[48:49], v[32:33], v[48:49]
  v_pk_mul_f32 v[50:51], v[34:35], v[50:51]
  v_pk_mul_f32 v[52:53], v[36:37], v[52:53]
  v_pk_mul_f32 v[54:55], v[38:39], v[54:55]
  v_pk_mul_f32 v[56:57], v[40:41], v[56:57]
  v_cvt_pk_bf16_f32 v184, v16, v17
  v_cvt_pk_bf16_f32 v185, v18, v19
  v_cvt_pk_bf16_f32 v186, v20, v21
  v_cvt_pk_bf16_f32 v187, v22, v23
  v_pk_mul_f32 v[58:59], v[42:43], v[58:59]
  v_pk_mul_f32 v[60:61], v[44:45], v[60:61]
  v_pk_mul_f32 v[62:63], v[46:47], v[62:63]
  v_mfma_f32_32x32x16_bf16 v[64:79], v[192:195], v[184:187], v[64:79]
  v_cvt_pk_bf16_f32 v188, v24, v25
  v_cvt_pk_bf16_f32 v189, v26, v27
  v_cvt_pk_bf16_f32 v190, v28, v29
  v_cvt_pk_bf16_f32 v191, v30, v31
  v_exp_f32_e64 v48, v48
  v_mfma_f32_32x32x16_bf16 v[80:95], v[196:199], v[184:187], v[80:95]
  v_exp_f32 v49, v49
  v_exp_f32 v50, v50
  v_exp_f32_e64 v51, v51
  v_mfma_f32_32x32x16_bf16 v[96:111], v[200:203], v[184:187], v[96:111]
  v_exp_f32 v52, v52
  v_exp_f32 v53, v53
  v_exp_f32_e64 v54, v54
  v_mfma_f32_32x32x16_bf16 v[64:79], v[204:207], v[188:191], v[64:79]
  v_exp_f32 v55, v55
  v_exp_f32 v56, v56
  v_exp_f32_e64 v57, v57
  v_mfma_f32_32x32x16_bf16 v[80:95], v[208:211], v[188:191], v[80:95]
  v_exp_f32 v58, v58
  v_exp_f32 v59, v59
  v_exp_f32_e64 v60, v60
  v_mfma_f32_32x32x16_bf16 v[96:111], v[212:215], v[188:191], v[96:111]
  v_exp_f32 v61, v61
  v_exp_f32 v62, v62
  v_exp_f32_e64 v63, v63
  v_pk_fma_f32 v[48:49], v[48:49], s[22:23], s[22:23]
  v_pk_fma_f32 v[50:51], v[50:51], s[22:23], s[22:23]
  v_pk_fma_f32 v[52:53], v[52:53], s[22:23], s[22:23]
  v_pk_fma_f32 v[54:55], v[54:55], s[22:23], s[22:23]
  v_pk_fma_f32 v[56:57], v[56:57], s[22:23], s[22:23]
  v_pk_fma_f32 v[58:59], v[58:59], s[22:23], s[22:23]
  v_pk_fma_f32 v[60:61], v[60:61], s[22:23], s[22:23]
  v_pk_fma_f32 v[62:63], v[62:63], s[22:23], s[22:23]
  v_mfma_f32_32x32x16_bf16 v[16:31], a[24:27], v[160:163], 0
  ds_read_b128 v[192:195], v1 offset:14336
  ds_read_b128 v[196:199], v1 offset:15360
  v_rcp_f32 v48, v48
  v_rcp_f32 v49, v49
  v_mfma_f32_32x32x16_bf16 v[16:31], a[28:31], v[164:167], v[16:31]
  ds_read_b128 v[200:203], v1 offset:16384
  ds_read_b128 v[204:207], v1 offset:17408
  v_rcp_f32 v50, v50
  v_rcp_f32 v51, v51
  v_mfma_f32_32x32x16_bf16 v[16:31], a[32:35], v[168:171], v[16:31]
  ds_read_b128 v[208:211], v1 offset:18432
  ds_read_b128 v[212:215], v1 offset:19456
  v_rcp_f32 v52, v52
  v_rcp_f32 v53, v53
  v_mfma_f32_32x32x16_bf16 v[16:31], a[36:39], v[172:175], v[16:31]
  buffer_store_dwordx4 v[112:115], v10, s[8:11], s28 offen
  v_rcp_f32 v54, v54
  v_rcp_f32 v55, v55
  v_mfma_f32_32x32x16_bf16 v[16:31], a[40:43], v[176:179], v[16:31]
  v_rcp_f32 v56, v56
  v_rcp_f32 v57, v57
  v_rcp_f32_e64 v58, v58
  v_mfma_f32_32x32x16_bf16 v[16:31], a[44:47], v[180:183], v[16:31]
  s_waitcnt lgkmcnt(0)
  v_rcp_f32 v59, v59
  v_rcp_f32 v60, v60
  v_rcp_f32 v61, v61
  v_rcp_f32 v62, v62
  v_rcp_f32 v63, v63
  v_pk_mul_f32 v[32:33], v[32:33], v[48:49]
  v_pk_mul_f32 v[34:35], v[34:35], v[50:51]
  v_pk_mul_f32 v[36:37], v[36:37], v[52:53]
  v_pk_mul_f32 v[38:39], v[38:39], v[54:55]
  v_pk_mul_f32 v[40:41], v[40:41], v[56:57]
  v_pk_mul_f32 v[42:43], v[42:43], v[58:59]
  v_pk_mul_f32 v[44:45], v[44:45], v[60:61]
  v_pk_mul_f32 v[46:47], v[46:47], v[62:63]
  v_pk_fma_f32 v[48:49], v[16:17], v[16:17], s[20:21] neg_lo:[1,0,1] neg_hi:[1,0,1]
  v_pk_fma_f32 v[50:51], v[18:19], v[18:19], s[20:21] neg_lo:[1,0,1] neg_hi:[1,0,1]
  v_pk_fma_f32 v[52:53], v[20:21], v[20:21], s[20:21] neg_lo:[1,0,1] neg_hi:[1,0,1]
  v_pk_fma_f32 v[54:55], v[22:23], v[22:23], s[20:21] neg_lo:[1,0,1] neg_hi:[1,0,1]
  v_pk_fma_f32 v[56:57], v[24:25], v[24:25], s[20:21] neg_lo:[1,0,1] neg_hi:[1,0,1]
  v_pk_fma_f32 v[58:59], v[26:27], v[26:27], s[20:21] neg_lo:[1,0,1] neg_hi:[1,0,1]
  v_pk_fma_f32 v[60:61], v[28:29], v[28:29], s[20:21] neg_lo:[1,0,1] neg_hi:[1,0,1]
  v_pk_fma_f32 v[62:63], v[30:31], v[30:31], s[20:21] neg_lo:[1,0,1] neg_hi:[1,0,1]
  v_pk_mul_f32 v[48:49], v[16:17], v[48:49]
  v_pk_mul_f32 v[50:51], v[18:19], v[50:51]
  v_pk_mul_f32 v[52:53], v[20:21], v[52:53]
  v_pk_mul_f32 v[54:55], v[22:23], v[54:55]
  v_pk_mul_f32 v[56:57], v[24:25], v[56:57]
  v_cvt_pk_bf16_f32 v184, v32, v33
  v_cvt_pk_bf16_f32 v185, v34, v35
  v_cvt_pk_bf16_f32 v186, v36, v37
  v_cvt_pk_bf16_f32 v187, v38, v39
  v_pk_mul_f32 v[58:59], v[26:27], v[58:59]
  v_pk_mul_f32 v[60:61], v[28:29], v[60:61]
  v_pk_mul_f32 v[62:63], v[30:31], v[62:63]
  v_mfma_f32_32x32x16_bf16 v[64:79], v[192:195], v[184:187], v[64:79]
  v_cvt_pk_bf16_f32 v188, v40, v41
  v_cvt_pk_bf16_f32 v189, v42, v43
  v_cvt_pk_bf16_f32 v190, v44, v45
  v_cvt_pk_bf16_f32 v191, v46, v47
  v_exp_f32_e64 v48, v48
  v_mfma_f32_32x32x16_bf16 v[80:95], v[196:199], v[184:187], v[80:95]
  v_exp_f32 v49, v49
  v_exp_f32 v50, v50
  v_exp_f32_e64 v51, v51
  v_mfma_f32_32x32x16_bf16 v[96:111], v[200:203], v[184:187], v[96:111]
  v_exp_f32 v52, v52
  v_exp_f32 v53, v53
  v_exp_f32_e64 v54, v54
  v_mfma_f32_32x32x16_bf16 v[64:79], v[204:207], v[188:191], v[64:79]
  v_exp_f32 v55, v55
  v_exp_f32 v56, v56
  v_exp_f32_e64 v57, v57
  v_mfma_f32_32x32x16_bf16 v[80:95], v[208:211], v[188:191], v[80:95]
  v_exp_f32 v58, v58
  v_exp_f32 v59, v59
  v_exp_f32_e64 v60, v60
  v_mfma_f32_32x32x16_bf16 v[96:111], v[212:215], v[188:191], v[96:111]
  v_exp_f32 v61, v61
  v_exp_f32 v62, v62
  v_exp_f32_e64 v63, v63
  v_pk_fma_f32 v[48:49], v[48:49], s[22:23], s[22:23]
  v_pk_fma_f32 v[50:51], v[50:51], s[22:23], s[22:23]
  v_pk_fma_f32 v[52:53], v[52:53], s[22:23], s[22:23]
  v_pk_fma_f32 v[54:55], v[54:55], s[22:23], s[22:23]
  v_pk_fma_f32 v[56:57], v[56:57], s[22:23], s[22:23]
  v_pk_fma_f32 v[58:59], v[58:59], s[22:23], s[22:23]
  v_pk_fma_f32 v[60:61], v[60:61], s[22:23], s[22:23]
  v_pk_fma_f32 v[62:63], v[62:63], s[22:23], s[22:23]
  v_mfma_f32_32x32x16_bf16 v[32:47], a[48:51], v[160:163], 0
  ds_read_b128 v[192:195], v1 offset:20480
  ds_read_b128 v[196:199], v1 offset:21504
  v_rcp_f32 v48, v48
  v_rcp_f32 v49, v49
  v_mfma_f32_32x32x16_bf16 v[32:47], a[52:55], v[164:167], v[32:47]
  ds_read_b128 v[200:203], v1 offset:22528
  ds_read_b128 v[204:207], v1 offset:23552
  v_rcp_f32 v50, v50
  v_rcp_f32 v51, v51
  v_mfma_f32_32x32x16_bf16 v[32:47], a[56:59], v[168:171], v[32:47]
  ds_read_b128 v[208:211], v1 offset:24576
  ds_read_b128 v[212:215], v1 offset:25600
  v_rcp_f32 v52, v52
  v_rcp_f32 v53, v53
  v_mfma_f32_32x32x16_bf16 v[32:47], a[60:63], v[172:175], v[32:47]
  buffer_store_dwordx4 v[116:119], v10, s[8:11], s28 offen offset:32
  v_rcp_f32 v54, v54
  v_rcp_f32 v55, v55
  v_mfma_f32_32x32x16_bf16 v[32:47], a[64:67], v[176:179], v[32:47]
  v_rcp_f32 v56, v56
  v_rcp_f32 v57, v57
  v_rcp_f32_e64 v58, v58
  v_mfma_f32_32x32x16_bf16 v[32:47], a[68:71], v[180:183], v[32:47]
  s_waitcnt lgkmcnt(0)
  v_rcp_f32 v59, v59
  v_rcp_f32 v60, v60
  v_rcp_f32 v61, v61
  v_rcp_f32 v62, v62
  v_rcp_f32 v63, v63
  v_pk_mul_f32 v[16:17], v[16:17], v[48:49]
  v_pk_mul_f32 v[18:19], v[18:19], v[50:51]
  v_pk_mul_f32 v[20:21], v[20:21], v[52:53]
  v_pk_mul_f32 v[22:23], v[22:23], v[54:55]
  v_pk_mul_f32 v[24:25], v[24:25], v[56:57]
  v_pk_mul_f32 v[26:27], v[26:27], v[58:59]
  v_pk_mul_f32 v[28:29], v[28:29], v[60:61]
  v_pk_mul_f32 v[30:31], v[30:31], v[62:63]
  v_pk_fma_f32 v[48:49], v[32:33], v[32:33], s[20:21] neg_lo:[1,0,1] neg_hi:[1,0,1]
  v_pk_fma_f32 v[50:51], v[34:35], v[34:35], s[20:21] neg_lo:[1,0,1] neg_hi:[1,0,1]
  v_pk_fma_f32 v[52:53], v[36:37], v[36:37], s[20:21] neg_lo:[1,0,1] neg_hi:[1,0,1]
  v_pk_fma_f32 v[54:55], v[38:39], v[38:39], s[20:21] neg_lo:[1,0,1] neg_hi:[1,0,1]
  v_pk_fma_f32 v[56:57], v[40:41], v[40:41], s[20:21] neg_lo:[1,0,1] neg_hi:[1,0,1]
  v_pk_fma_f32 v[58:59], v[42:43], v[42:43], s[20:21] neg_lo:[1,0,1] neg_hi:[1,0,1]
  v_pk_fma_f32 v[60:61], v[44:45], v[44:45], s[20:21] neg_lo:[1,0,1] neg_hi:[1,0,1]
  v_pk_fma_f32 v[62:63], v[46:47], v[46:47], s[20:21] neg_lo:[1,0,1] neg_hi:[1,0,1]
  v_pk_mul_f32 v[48:49], v[32:33], v[48:49]
  v_pk_mul_f32 v[50:51], v[34:35], v[50:51]
  v_pk_mul_f32 v[52:53], v[36:37], v[52:53]
  v_pk_mul_f32 v[54:55], v[38:39], v[54:55]
  v_pk_mul_f32 v[56:57], v[40:41], v[56:57]
  v_cvt_pk_bf16_f32 v184, v16, v17
  v_cvt_pk_bf16_f32 v185, v18, v19
  v_cvt_pk_bf16_f32 v186, v20, v21
  v_cvt_pk_bf16_f32 v187, v22, v23
  v_pk_mul_f32 v[58:59], v[42:43], v[58:59]
  v_pk_mul_f32 v[60:61], v[44:45], v[60:61]
  v_pk_mul_f32 v[62:63], v[46:47], v[62:63]
  v_mfma_f32_32x32x16_bf16 v[64:79], v[192:195], v[184:187], v[64:79]
  v_cvt_pk_bf16_f32 v188, v24, v25
  v_cvt_pk_bf16_f32 v189, v26, v27
  v_cvt_pk_bf16_f32 v190, v28, v29
  v_cvt_pk_bf16_f32 v191, v30, v31
  v_exp_f32_e64 v48, v48
  v_mfma_f32_32x32x16_bf16 v[80:95], v[196:199], v[184:187], v[80:95]
  v_exp_f32 v49, v49
  v_exp_f32 v50, v50
  v_exp_f32_e64 v51, v51
  v_mfma_f32_32x32x16_bf16 v[96:111], v[200:203], v[184:187], v[96:111]
  v_exp_f32 v52, v52
  v_exp_f32 v53, v53
  v_exp_f32_e64 v54, v54
  v_mfma_f32_32x32x16_bf16 v[64:79], v[204:207], v[188:191], v[64:79]
  v_exp_f32 v55, v55
  v_exp_f32 v56, v56
  v_exp_f32_e64 v57, v57
  v_mfma_f32_32x32x16_bf16 v[80:95], v[208:211], v[188:191], v[80:95]
  v_exp_f32 v58, v58
  v_exp_f32 v59, v59
  v_exp_f32_e64 v60, v60
  v_mfma_f32_32x32x16_bf16 v[96:111], v[212:215], v[188:191], v[96:111]
  v_exp_f32 v61, v61
  v_exp_f32 v62, v62
  v_exp_f32_e64 v63, v63
  v_pk_fma_f32 v[48:49], v[48:49], s[22:23], s[22:23]
  v_pk_fma_f32 v[50:51], v[50:51], s[22:23], s[22:23]
  v_pk_fma_f32 v[52:53], v[52:53], s[22:23], s[22:23]
  v_pk_fma_f32 v[54:55], v[54:55], s[22:23], s[22:23]
  v_pk_fma_f32 v[56:57], v[56:57], s[22:23], s[22:23]
  v_pk_fma_f32 v[58:59], v[58:59], s[22:23], s[22:23]
  v_pk_fma_f32 v[60:61], v[60:61], s[22:23], s[22:23]
  v_pk_fma_f32 v[62:63], v[62:63], s[22:23], s[22:23]
  v_mfma_f32_32x32x16_bf16 v[16:31], a[72:75], v[160:163], 0
  ds_read_b128 v[192:195], v1 offset:26624
  ds_read_b128 v[196:199], v1 offset:27648
  v_rcp_f32 v48, v48
  v_rcp_f32 v49, v49
  v_mfma_f32_32x32x16_bf16 v[16:31], a[76:79], v[164:167], v[16:31]
  ds_read_b128 v[200:203], v1 offset:28672
  ds_read_b128 v[204:207], v1 offset:29696
  v_rcp_f32 v50, v50
  v_rcp_f32 v51, v51
  v_mfma_f32_32x32x16_bf16 v[16:31], a[80:83], v[168:171], v[16:31]
  ds_read_b128 v[208:211], v1 offset:30720
  ds_read_b128 v[212:215], v1 offset:31744
  v_rcp_f32 v52, v52
  v_rcp_f32 v53, v53
  v_mfma_f32_32x32x16_bf16 v[16:31], a[84:87], v[172:175], v[16:31]
  v_rcp_f32 v54, v54
  v_rcp_f32 v55, v55
  v_rcp_f32_e64 v56, v56
  v_mfma_f32_32x32x16_bf16 v[16:31], a[88:91], v[176:179], v[16:31]
  v_rcp_f32 v57, v57
  v_rcp_f32 v58, v58
  v_rcp_f32_e64 v59, v59
  v_mfma_f32_32x32x16_bf16 v[16:31], a[92:95], v[180:183], v[16:31]
  s_waitcnt lgkmcnt(0)
  v_rcp_f32 v60, v60
  v_rcp_f32 v61, v61
  v_rcp_f32 v62, v62
  v_rcp_f32_e64 v63, v63
  v_pk_mul_f32 v[32:33], v[32:33], v[48:49]
  v_pk_mul_f32 v[34:35], v[34:35], v[50:51]
  v_pk_mul_f32 v[36:37], v[36:37], v[52:53]
  v_pk_mul_f32 v[38:39], v[38:39], v[54:55]
  v_pk_mul_f32 v[40:41], v[40:41], v[56:57]
  v_pk_mul_f32 v[42:43], v[42:43], v[58:59]
  v_pk_mul_f32 v[44:45], v[44:45], v[60:61]
  v_pk_mul_f32 v[46:47], v[46:47], v[62:63]
  v_pk_fma_f32 v[48:49], v[16:17], v[16:17], s[20:21] neg_lo:[1,0,1] neg_hi:[1,0,1]
  v_pk_fma_f32 v[50:51], v[18:19], v[18:19], s[20:21] neg_lo:[1,0,1] neg_hi:[1,0,1]
  v_pk_fma_f32 v[52:53], v[20:21], v[20:21], s[20:21] neg_lo:[1,0,1] neg_hi:[1,0,1]
  v_pk_fma_f32 v[54:55], v[22:23], v[22:23], s[20:21] neg_lo:[1,0,1] neg_hi:[1,0,1]
  v_pk_fma_f32 v[56:57], v[24:25], v[24:25], s[20:21] neg_lo:[1,0,1] neg_hi:[1,0,1]
  v_pk_fma_f32 v[58:59], v[26:27], v[26:27], s[20:21] neg_lo:[1,0,1] neg_hi:[1,0,1]
  v_pk_fma_f32 v[60:61], v[28:29], v[28:29], s[20:21] neg_lo:[1,0,1] neg_hi:[1,0,1]
  v_pk_fma_f32 v[62:63], v[30:31], v[30:31], s[20:21] neg_lo:[1,0,1] neg_hi:[1,0,1]
  v_pk_mul_f32 v[48:49], v[16:17], v[48:49]
  v_pk_mul_f32 v[50:51], v[18:19], v[50:51]
  v_pk_mul_f32 v[52:53], v[20:21], v[52:53]
  v_pk_mul_f32 v[54:55], v[22:23], v[54:55]
  v_pk_mul_f32 v[56:57], v[24:25], v[56:57]
  v_cvt_pk_bf16_f32 v184, v32, v33
  v_cvt_pk_bf16_f32 v185, v34, v35
  v_cvt_pk_bf16_f32 v186, v36, v37
  v_cvt_pk_bf16_f32 v187, v38, v39
  v_pk_mul_f32 v[58:59], v[26:27], v[58:59]
  v_pk_mul_f32 v[60:61], v[28:29], v[60:61]
  v_pk_mul_f32 v[62:63], v[30:31], v[62:63]
  v_mfma_f32_32x32x16_bf16 v[64:79], v[192:195], v[184:187], v[64:79]
  v_cvt_pk_bf16_f32 v188, v40, v41
  v_cvt_pk_bf16_f32 v189, v42, v43
  v_cvt_pk_bf16_f32 v190, v44, v45
  v_cvt_pk_bf16_f32 v191, v46, v47
  v_exp_f32_e64 v48, v48
  v_mfma_f32_32x32x16_bf16 v[80:95], v[196:199], v[184:187], v[80:95]
  v_exp_f32 v49, v49
  v_exp_f32 v50, v50
  v_exp_f32_e64 v51, v51
  v_mfma_f32_32x32x16_bf16 v[96:111], v[200:203], v[184:187], v[96:111]
  v_exp_f32 v52, v52
  v_exp_f32 v53, v53
  v_exp_f32_e64 v54, v54
  v_mfma_f32_32x32x16_bf16 v[64:79], v[204:207], v[188:191], v[64:79]
  v_exp_f32 v55, v55
  v_exp_f32 v56, v56
  v_exp_f32_e64 v57, v57
  v_mfma_f32_32x32x16_bf16 v[80:95], v[208:211], v[188:191], v[80:95]
  v_exp_f32 v58, v58
  v_exp_f32 v59, v59
  v_exp_f32_e64 v60, v60
  v_mfma_f32_32x32x16_bf16 v[96:111], v[212:215], v[188:191], v[96:111]
  v_exp_f32 v61, v61
  v_exp_f32 v62, v62
  v_exp_f32_e64 v63, v63
  v_pk_fma_f32 v[48:49], v[48:49], s[22:23], s[22:23]
  v_pk_fma_f32 v[50:51], v[50:51], s[22:23], s[22:23]
  v_pk_fma_f32 v[52:53], v[52:53], s[22:23], s[22:23]
  v_pk_fma_f32 v[54:55], v[54:55], s[22:23], s[22:23]
  v_pk_fma_f32 v[56:57], v[56:57], s[22:23], s[22:23]
  v_pk_fma_f32 v[58:59], v[58:59], s[22:23], s[22:23]
  v_pk_fma_f32 v[60:61], v[60:61], s[22:23], s[22:23]
  v_pk_fma_f32 v[62:63], v[62:63], s[22:23], s[22:23]
  v_mfma_f32_32x32x16_bf16 v[32:47], a[96:99], v[160:163], 0
  ds_read_b128 v[192:195], v0 offset:24576
  ds_read_b128 v[196:199], v0 offset:25600
  v_rcp_f32 v48, v48
  v_rcp_f32 v49, v49
  v_mfma_f32_32x32x16_bf16 v[32:47], a[100:103], v[164:167], v[32:47]
  ds_read_b128 v[200:203], v0 offset:26624
  ds_read_b128 v[204:207], v0 offset:27648
  v_rcp_f32 v50, v50
  v_rcp_f32 v51, v51
  v_mfma_f32_32x32x16_bf16 v[32:47], a[104:107], v[168:171], v[32:47]
  ds_read_b128 v[208:211], v0 offset:28672
  ds_read_b128 v[212:215], v0 offset:29696
  v_rcp_f32 v52, v52
  v_rcp_f32 v53, v53
  v_mfma_f32_32x32x16_bf16 v[32:47], a[108:111], v[172:175], v[32:47]
  buffer_store_dwordx4 v[120:123], v10, s[8:11], s28 offen offset:64
  v_rcp_f32 v54, v54
  v_rcp_f32 v55, v55
  v_mfma_f32_32x32x16_bf16 v[32:47], a[112:115], v[176:179], v[32:47]
  v_rcp_f32 v56, v56
  v_rcp_f32 v57, v57
  v_rcp_f32_e64 v58, v58
  v_mfma_f32_32x32x16_bf16 v[32:47], a[116:119], v[180:183], v[32:47]
  s_waitcnt lgkmcnt(0)
  v_rcp_f32 v59, v59
  v_rcp_f32 v60, v60
  v_rcp_f32 v61, v61
  v_rcp_f32 v62, v62
  v_rcp_f32 v63, v63
  v_pk_mul_f32 v[16:17], v[16:17], v[48:49]
  v_pk_mul_f32 v[18:19], v[18:19], v[50:51]
  v_pk_mul_f32 v[20:21], v[20:21], v[52:53]
  v_pk_mul_f32 v[22:23], v[22:23], v[54:55]
  v_pk_mul_f32 v[24:25], v[24:25], v[56:57]
  v_pk_mul_f32 v[26:27], v[26:27], v[58:59]
  v_pk_mul_f32 v[28:29], v[28:29], v[60:61]
  v_pk_mul_f32 v[30:31], v[30:31], v[62:63]
  v_pk_fma_f32 v[48:49], v[32:33], v[32:33], s[20:21] neg_lo:[1,0,1] neg_hi:[1,0,1]
  v_pk_fma_f32 v[50:51], v[34:35], v[34:35], s[20:21] neg_lo:[1,0,1] neg_hi:[1,0,1]
  v_pk_fma_f32 v[52:53], v[36:37], v[36:37], s[20:21] neg_lo:[1,0,1] neg_hi:[1,0,1]
  v_pk_fma_f32 v[54:55], v[38:39], v[38:39], s[20:21] neg_lo:[1,0,1] neg_hi:[1,0,1]
  v_pk_fma_f32 v[56:57], v[40:41], v[40:41], s[20:21] neg_lo:[1,0,1] neg_hi:[1,0,1]
  v_pk_fma_f32 v[58:59], v[42:43], v[42:43], s[20:21] neg_lo:[1,0,1] neg_hi:[1,0,1]
  v_pk_fma_f32 v[60:61], v[44:45], v[44:45], s[20:21] neg_lo:[1,0,1] neg_hi:[1,0,1]
  v_pk_fma_f32 v[62:63], v[46:47], v[46:47], s[20:21] neg_lo:[1,0,1] neg_hi:[1,0,1]
  v_pk_mul_f32 v[48:49], v[32:33], v[48:49]
  v_pk_mul_f32 v[50:51], v[34:35], v[50:51]
  v_pk_mul_f32 v[52:53], v[36:37], v[52:53]
  v_pk_mul_f32 v[54:55], v[38:39], v[54:55]
  v_pk_mul_f32 v[56:57], v[40:41], v[56:57]
  v_cvt_pk_bf16_f32 v184, v16, v17
  v_cvt_pk_bf16_f32 v185, v18, v19
  v_cvt_pk_bf16_f32 v186, v20, v21
  v_cvt_pk_bf16_f32 v187, v22, v23
  v_pk_mul_f32 v[58:59], v[42:43], v[58:59]
  v_pk_mul_f32 v[60:61], v[44:45], v[60:61]
  v_pk_mul_f32 v[62:63], v[46:47], v[62:63]
  v_mfma_f32_32x32x16_bf16 v[64:79], v[192:195], v[184:187], v[64:79]
  v_cvt_pk_bf16_f32 v188, v24, v25
  v_cvt_pk_bf16_f32 v189, v26, v27
  v_cvt_pk_bf16_f32 v190, v28, v29
  v_cvt_pk_bf16_f32 v191, v30, v31
  v_exp_f32_e64 v48, v48
  v_mfma_f32_32x32x16_bf16 v[80:95], v[196:199], v[184:187], v[80:95]
  v_exp_f32 v49, v49
  v_exp_f32 v50, v50
  v_exp_f32_e64 v51, v51
  v_mfma_f32_32x32x16_bf16 v[96:111], v[200:203], v[184:187], v[96:111]
  v_exp_f32 v52, v52
  v_exp_f32 v53, v53
  v_exp_f32_e64 v54, v54
  v_mfma_f32_32x32x16_bf16 v[64:79], v[204:207], v[188:191], v[64:79]
  v_exp_f32 v55, v55
  v_exp_f32 v56, v56
  v_exp_f32_e64 v57, v57
  v_mfma_f32_32x32x16_bf16 v[80:95], v[208:211], v[188:191], v[80:95]
  v_exp_f32 v58, v58
  v_exp_f32 v59, v59
  v_exp_f32_e64 v60, v60
  v_mfma_f32_32x32x16_bf16 v[96:111], v[212:215], v[188:191], v[96:111]
  v_exp_f32 v61, v61
  v_exp_f32 v62, v62
  v_exp_f32_e64 v63, v63
  v_pk_fma_f32 v[48:49], v[48:49], s[22:23], s[22:23]
  v_pk_fma_f32 v[50:51], v[50:51], s[22:23], s[22:23]
  v_pk_fma_f32 v[52:53], v[52:53], s[22:23], s[22:23]
  v_pk_fma_f32 v[54:55], v[54:55], s[22:23], s[22:23]
  v_pk_fma_f32 v[56:57], v[56:57], s[22:23], s[22:23]
  v_pk_fma_f32 v[58:59], v[58:59], s[22:23], s[22:23]
  v_pk_fma_f32 v[60:61], v[60:61], s[22:23], s[22:23]
  v_pk_fma_f32 v[62:63], v[62:63], s[22:23], s[22:23]
  v_mfma_f32_32x32x16_bf16 v[16:31], a[120:123], v[160:163], 0
  ds_read_b128 v[192:195], v0 offset:30720
  ds_read_b128 v[196:199], v0 offset:31744
  v_rcp_f32 v48, v48
  v_rcp_f32 v49, v49
  v_mfma_f32_32x32x16_bf16 v[16:31], a[124:127], v[164:167], v[16:31]
  ds_read_b128 v[200:203], v0 offset:32768
  ds_read_b128 v[204:207], v0 offset:33792
  v_rcp_f32 v50, v50
  v_rcp_f32 v51, v51
  v_mfma_f32_32x32x16_bf16 v[16:31], a[128:131], v[168:171], v[16:31]
  ds_read_b128 v[208:211], v0 offset:34816
  ds_read_b128 v[212:215], v0 offset:35840
  v_rcp_f32 v52, v52
  v_rcp_f32 v53, v53
  v_mfma_f32_32x32x16_bf16 v[16:31], a[132:135], v[172:175], v[16:31]
  buffer_store_dwordx4 v[124:127], v10, s[8:11], s28 offen offset:96
  v_rcp_f32 v54, v54
  v_rcp_f32 v55, v55
  v_mfma_f32_32x32x16_bf16 v[16:31], a[136:139], v[176:179], v[16:31]
  v_rcp_f32 v56, v56
  v_rcp_f32 v57, v57
  v_rcp_f32_e64 v58, v58
  v_mfma_f32_32x32x16_bf16 v[16:31], a[140:143], v[180:183], v[16:31]
  s_waitcnt lgkmcnt(0)
  v_rcp_f32 v59, v59
  v_rcp_f32 v60, v60
  v_rcp_f32 v61, v61
  v_rcp_f32 v62, v62
  v_rcp_f32 v63, v63
  v_pk_mul_f32 v[32:33], v[32:33], v[48:49]
  v_pk_mul_f32 v[34:35], v[34:35], v[50:51]
  v_pk_mul_f32 v[36:37], v[36:37], v[52:53]
  v_pk_mul_f32 v[38:39], v[38:39], v[54:55]
  v_pk_mul_f32 v[40:41], v[40:41], v[56:57]
  v_pk_mul_f32 v[42:43], v[42:43], v[58:59]
  v_pk_mul_f32 v[44:45], v[44:45], v[60:61]
  v_pk_mul_f32 v[46:47], v[46:47], v[62:63]
  v_pk_fma_f32 v[48:49], v[16:17], v[16:17], s[20:21] neg_lo:[1,0,1] neg_hi:[1,0,1]
  v_pk_fma_f32 v[50:51], v[18:19], v[18:19], s[20:21] neg_lo:[1,0,1] neg_hi:[1,0,1]
  v_pk_fma_f32 v[52:53], v[20:21], v[20:21], s[20:21] neg_lo:[1,0,1] neg_hi:[1,0,1]
  v_pk_fma_f32 v[54:55], v[22:23], v[22:23], s[20:21] neg_lo:[1,0,1] neg_hi:[1,0,1]
  v_pk_fma_f32 v[56:57], v[24:25], v[24:25], s[20:21] neg_lo:[1,0,1] neg_hi:[1,0,1]
  v_pk_fma_f32 v[58:59], v[26:27], v[26:27], s[20:21] neg_lo:[1,0,1] neg_hi:[1,0,1]
  v_pk_fma_f32 v[60:61], v[28:29], v[28:29], s[20:21] neg_lo:[1,0,1] neg_hi:[1,0,1]
  v_pk_fma_f32 v[62:63], v[30:31], v[30:31], s[20:21] neg_lo:[1,0,1] neg_hi:[1,0,1]
  v_pk_mul_f32 v[48:49], v[16:17], v[48:49]
  v_pk_mul_f32 v[50:51], v[18:19], v[50:51]
  v_pk_mul_f32 v[52:53], v[20:21], v[52:53]
  v_pk_mul_f32 v[54:55], v[22:23], v[54:55]
  v_pk_mul_f32 v[56:57], v[24:25], v[56:57]
  v_cvt_pk_bf16_f32 v184, v32, v33
  v_cvt_pk_bf16_f32 v185, v34, v35
  v_cvt_pk_bf16_f32 v186, v36, v37
  v_cvt_pk_bf16_f32 v187, v38, v39
  v_pk_mul_f32 v[58:59], v[26:27], v[58:59]
  v_pk_mul_f32 v[60:61], v[28:29], v[60:61]
  v_pk_mul_f32 v[62:63], v[30:31], v[62:63]
  v_mfma_f32_32x32x16_bf16 v[64:79], v[192:195], v[184:187], v[64:79]
  v_cvt_pk_bf16_f32 v188, v40, v41
  v_cvt_pk_bf16_f32 v189, v42, v43
  v_cvt_pk_bf16_f32 v190, v44, v45
  v_cvt_pk_bf16_f32 v191, v46, v47
  v_exp_f32_e64 v48, v48
  v_mfma_f32_32x32x16_bf16 v[80:95], v[196:199], v[184:187], v[80:95]
  v_exp_f32 v49, v49
  v_exp_f32 v50, v50
  v_exp_f32_e64 v51, v51
  v_mfma_f32_32x32x16_bf16 v[96:111], v[200:203], v[184:187], v[96:111]
  v_exp_f32 v52, v52
  v_exp_f32 v53, v53
  v_exp_f32_e64 v54, v54
  v_mfma_f32_32x32x16_bf16 v[64:79], v[204:207], v[188:191], v[64:79]
  v_exp_f32 v55, v55
  v_exp_f32 v56, v56
  v_exp_f32_e64 v57, v57
  v_mfma_f32_32x32x16_bf16 v[80:95], v[208:211], v[188:191], v[80:95]
  v_exp_f32 v58, v58
  v_exp_f32 v59, v59
  v_exp_f32_e64 v60, v60
  v_mfma_f32_32x32x16_bf16 v[96:111], v[212:215], v[188:191], v[96:111]
  v_exp_f32 v61, v61
  v_exp_f32 v62, v62
  v_exp_f32_e64 v63, v63
  v_pk_fma_f32 v[48:49], v[48:49], s[22:23], s[22:23]
  v_pk_fma_f32 v[50:51], v[50:51], s[22:23], s[22:23]
  v_pk_fma_f32 v[52:53], v[52:53], s[22:23], s[22:23]
  v_pk_fma_f32 v[54:55], v[54:55], s[22:23], s[22:23]
  v_pk_fma_f32 v[56:57], v[56:57], s[22:23], s[22:23]
  v_pk_fma_f32 v[58:59], v[58:59], s[22:23], s[22:23]
  v_pk_fma_f32 v[60:61], v[60:61], s[22:23], s[22:23]
  v_pk_fma_f32 v[62:63], v[62:63], s[22:23], s[22:23]
  v_mfma_f32_32x32x16_bf16 v[32:47], a[144:147], v[160:163], 0
  ds_read_b128 v[192:195], v0 offset:36864
  ds_read_b128 v[196:199], v0 offset:37888
  v_rcp_f32 v48, v48
  v_rcp_f32 v49, v49
  v_mfma_f32_32x32x16_bf16 v[32:47], a[148:151], v[164:167], v[32:47]
  ds_read_b128 v[200:203], v0 offset:38912
  ds_read_b128 v[204:207], v0 offset:39936
  v_rcp_f32 v50, v50
  v_rcp_f32 v51, v51
  v_mfma_f32_32x32x16_bf16 v[32:47], a[152:155], v[168:171], v[32:47]
  ds_read_b128 v[208:211], v0 offset:40960
  ds_read_b128 v[212:215], v0 offset:41984
  v_rcp_f32 v52, v52
  v_rcp_f32 v53, v53
  v_mfma_f32_32x32x16_bf16 v[32:47], a[156:159], v[172:175], v[32:47]
  v_rcp_f32 v54, v54
  v_rcp_f32 v55, v55
  v_rcp_f32_e64 v56, v56
  v_mfma_f32_32x32x16_bf16 v[32:47], a[160:163], v[176:179], v[32:47]
  v_rcp_f32 v57, v57
  v_rcp_f32 v58, v58
  v_rcp_f32_e64 v59, v59
  v_mfma_f32_32x32x16_bf16 v[32:47], a[164:167], v[180:183], v[32:47]
  s_waitcnt lgkmcnt(0)
  v_rcp_f32 v60, v60
  v_rcp_f32 v61, v61
  v_rcp_f32 v62, v62
  v_rcp_f32_e64 v63, v63
  v_pk_mul_f32 v[16:17], v[16:17], v[48:49]
  v_pk_mul_f32 v[18:19], v[18:19], v[50:51]
  v_pk_mul_f32 v[20:21], v[20:21], v[52:53]
  v_pk_mul_f32 v[22:23], v[22:23], v[54:55]
  v_pk_mul_f32 v[24:25], v[24:25], v[56:57]
  v_pk_mul_f32 v[26:27], v[26:27], v[58:59]
  v_pk_mul_f32 v[28:29], v[28:29], v[60:61]
  v_pk_mul_f32 v[30:31], v[30:31], v[62:63]
  v_pk_fma_f32 v[48:49], v[32:33], v[32:33], s[20:21] neg_lo:[1,0,1] neg_hi:[1,0,1]
  v_pk_fma_f32 v[50:51], v[34:35], v[34:35], s[20:21] neg_lo:[1,0,1] neg_hi:[1,0,1]
  v_pk_fma_f32 v[52:53], v[36:37], v[36:37], s[20:21] neg_lo:[1,0,1] neg_hi:[1,0,1]
  v_pk_fma_f32 v[54:55], v[38:39], v[38:39], s[20:21] neg_lo:[1,0,1] neg_hi:[1,0,1]
  v_pk_fma_f32 v[56:57], v[40:41], v[40:41], s[20:21] neg_lo:[1,0,1] neg_hi:[1,0,1]
  v_pk_fma_f32 v[58:59], v[42:43], v[42:43], s[20:21] neg_lo:[1,0,1] neg_hi:[1,0,1]
  v_pk_fma_f32 v[60:61], v[44:45], v[44:45], s[20:21] neg_lo:[1,0,1] neg_hi:[1,0,1]
  v_pk_fma_f32 v[62:63], v[46:47], v[46:47], s[20:21] neg_lo:[1,0,1] neg_hi:[1,0,1]
  v_pk_mul_f32 v[48:49], v[32:33], v[48:49]
  v_pk_mul_f32 v[50:51], v[34:35], v[50:51]
  v_pk_mul_f32 v[52:53], v[36:37], v[52:53]
  v_pk_mul_f32 v[54:55], v[38:39], v[54:55]
  v_pk_mul_f32 v[56:57], v[40:41], v[56:57]
  v_cvt_pk_bf16_f32 v184, v16, v17
  v_cvt_pk_bf16_f32 v185, v18, v19
  v_cvt_pk_bf16_f32 v186, v20, v21
  v_cvt_pk_bf16_f32 v187, v22, v23
  v_pk_mul_f32 v[58:59], v[42:43], v[58:59]
  v_pk_mul_f32 v[60:61], v[44:45], v[60:61]
  v_pk_mul_f32 v[62:63], v[46:47], v[62:63]
  v_mfma_f32_32x32x16_bf16 v[64:79], v[192:195], v[184:187], v[64:79]
  v_cvt_pk_bf16_f32 v188, v24, v25
  v_cvt_pk_bf16_f32 v189, v26, v27
  v_cvt_pk_bf16_f32 v190, v28, v29
  v_cvt_pk_bf16_f32 v191, v30, v31
  v_exp_f32_e64 v48, v48
  v_mfma_f32_32x32x16_bf16 v[80:95], v[196:199], v[184:187], v[80:95]
  v_exp_f32 v49, v49
  v_exp_f32 v50, v50
  v_exp_f32_e64 v51, v51
  v_mfma_f32_32x32x16_bf16 v[96:111], v[200:203], v[184:187], v[96:111]
  v_exp_f32 v52, v52
  v_exp_f32 v53, v53
  v_exp_f32_e64 v54, v54
  v_mfma_f32_32x32x16_bf16 v[64:79], v[204:207], v[188:191], v[64:79]
  v_exp_f32 v55, v55
  v_exp_f32 v56, v56
  v_exp_f32_e64 v57, v57
  v_mfma_f32_32x32x16_bf16 v[80:95], v[208:211], v[188:191], v[80:95]
  v_exp_f32 v58, v58
  v_exp_f32 v59, v59
  v_exp_f32_e64 v60, v60
  v_mfma_f32_32x32x16_bf16 v[96:111], v[212:215], v[188:191], v[96:111]
  v_exp_f32 v61, v61
  v_exp_f32 v62, v62
  v_exp_f32_e64 v63, v63
  v_pk_fma_f32 v[48:49], v[48:49], s[22:23], s[22:23]
  v_pk_fma_f32 v[50:51], v[50:51], s[22:23], s[22:23]
  v_pk_fma_f32 v[52:53], v[52:53], s[22:23], s[22:23]
  v_pk_fma_f32 v[54:55], v[54:55], s[22:23], s[22:23]
  v_pk_fma_f32 v[56:57], v[56:57], s[22:23], s[22:23]
  v_pk_fma_f32 v[58:59], v[58:59], s[22:23], s[22:23]
  v_pk_fma_f32 v[60:61], v[60:61], s[22:23], s[22:23]
  v_pk_fma_f32 v[62:63], v[62:63], s[22:23], s[22:23]
  v_mfma_f32_32x32x16_bf16 v[16:31], a[168:171], v[160:163], 0
  ds_read_b128 v[192:195], v0 offset:43008
  ds_read_b128 v[196:199], v0 offset:44032
  v_rcp_f32 v48, v48
  v_rcp_f32 v49, v49
  v_mfma_f32_32x32x16_bf16 v[16:31], a[172:175], v[164:167], v[16:31]
  ds_read_b128 v[200:203], v0 offset:45056
  ds_read_b128 v[204:207], v0 offset:46080
  v_rcp_f32 v50, v50
  v_rcp_f32 v51, v51
  v_mfma_f32_32x32x16_bf16 v[16:31], a[176:179], v[168:171], v[16:31]
  ds_read_b128 v[208:211], v0 offset:47104
  ds_read_b128 v[212:215], v0 offset:48128
  v_rcp_f32 v52, v52
  v_rcp_f32 v53, v53
  v_mfma_f32_32x32x16_bf16 v[16:31], a[180:183], v[172:175], v[16:31]
  buffer_store_dwordx4 v[128:131], v10, s[8:11], s28 offen offset:128
  v_rcp_f32 v54, v54
  v_rcp_f32 v55, v55
  v_mfma_f32_32x32x16_bf16 v[16:31], a[184:187], v[176:179], v[16:31]
  v_rcp_f32 v56, v56
  v_rcp_f32 v57, v57
  v_rcp_f32_e64 v58, v58
  v_mfma_f32_32x32x16_bf16 v[16:31], a[188:191], v[180:183], v[16:31]
  s_waitcnt lgkmcnt(0)
  v_rcp_f32 v59, v59
  v_rcp_f32 v60, v60
  v_rcp_f32 v61, v61
  v_rcp_f32 v62, v62
  v_rcp_f32 v63, v63
  v_pk_mul_f32 v[32:33], v[32:33], v[48:49]
  v_pk_mul_f32 v[34:35], v[34:35], v[50:51]
  v_pk_mul_f32 v[36:37], v[36:37], v[52:53]
  v_pk_mul_f32 v[38:39], v[38:39], v[54:55]
  v_pk_mul_f32 v[40:41], v[40:41], v[56:57]
  v_pk_mul_f32 v[42:43], v[42:43], v[58:59]
  v_pk_mul_f32 v[44:45], v[44:45], v[60:61]
  v_pk_mul_f32 v[46:47], v[46:47], v[62:63]
  v_pk_fma_f32 v[48:49], v[16:17], v[16:17], s[20:21] neg_lo:[1,0,1] neg_hi:[1,0,1]
  v_pk_fma_f32 v[50:51], v[18:19], v[18:19], s[20:21] neg_lo:[1,0,1] neg_hi:[1,0,1]
  v_pk_fma_f32 v[52:53], v[20:21], v[20:21], s[20:21] neg_lo:[1,0,1] neg_hi:[1,0,1]
  v_pk_fma_f32 v[54:55], v[22:23], v[22:23], s[20:21] neg_lo:[1,0,1] neg_hi:[1,0,1]
  v_pk_fma_f32 v[56:57], v[24:25], v[24:25], s[20:21] neg_lo:[1,0,1] neg_hi:[1,0,1]
  v_pk_fma_f32 v[58:59], v[26:27], v[26:27], s[20:21] neg_lo:[1,0,1] neg_hi:[1,0,1]
  v_pk_fma_f32 v[60:61], v[28:29], v[28:29], s[20:21] neg_lo:[1,0,1] neg_hi:[1,0,1]
  v_pk_fma_f32 v[62:63], v[30:31], v[30:31], s[20:21] neg_lo:[1,0,1] neg_hi:[1,0,1]
  v_pk_mul_f32 v[48:49], v[16:17], v[48:49]
  v_pk_mul_f32 v[50:51], v[18:19], v[50:51]
  v_pk_mul_f32 v[52:53], v[20:21], v[52:53]
  v_pk_mul_f32 v[54:55], v[22:23], v[54:55]
  v_pk_mul_f32 v[56:57], v[24:25], v[56:57]
  v_cvt_pk_bf16_f32 v184, v32, v33
  v_cvt_pk_bf16_f32 v185, v34, v35
  v_cvt_pk_bf16_f32 v186, v36, v37
  v_cvt_pk_bf16_f32 v187, v38, v39
  v_pk_mul_f32 v[58:59], v[26:27], v[58:59]
  v_pk_mul_f32 v[60:61], v[28:29], v[60:61]
  v_pk_mul_f32 v[62:63], v[30:31], v[62:63]
  v_mfma_f32_32x32x16_bf16 v[64:79], v[192:195], v[184:187], v[64:79]
  v_cvt_pk_bf16_f32 v188, v40, v41
  v_cvt_pk_bf16_f32 v189, v42, v43
  v_cvt_pk_bf16_f32 v190, v44, v45
  v_cvt_pk_bf16_f32 v191, v46, v47
  v_exp_f32_e64 v48, v48
  v_mfma_f32_32x32x16_bf16 v[80:95], v[196:199], v[184:187], v[80:95]
  v_exp_f32 v49, v49
  v_exp_f32 v50, v50
  v_exp_f32_e64 v51, v51
  v_mfma_f32_32x32x16_bf16 v[96:111], v[200:203], v[184:187], v[96:111]
  v_exp_f32 v52, v52
  v_exp_f32 v53, v53
  v_exp_f32_e64 v54, v54
  v_mfma_f32_32x32x16_bf16 v[64:79], v[204:207], v[188:191], v[64:79]
  v_exp_f32 v55, v55
  v_exp_f32 v56, v56
  v_exp_f32_e64 v57, v57
  v_mfma_f32_32x32x16_bf16 v[80:95], v[208:211], v[188:191], v[80:95]
  v_exp_f32 v58, v58
  v_exp_f32 v59, v59
  v_exp_f32_e64 v60, v60
  v_mfma_f32_32x32x16_bf16 v[96:111], v[212:215], v[188:191], v[96:111]
  v_exp_f32 v61, v61
  v_exp_f32 v62, v62
  v_exp_f32_e64 v63, v63
  v_pk_fma_f32 v[48:49], v[48:49], s[22:23], s[22:23]
  v_pk_fma_f32 v[50:51], v[50:51], s[22:23], s[22:23]
  v_pk_fma_f32 v[52:53], v[52:53], s[22:23], s[22:23]
  v_pk_fma_f32 v[54:55], v[54:55], s[22:23], s[22:23]
  v_pk_fma_f32 v[56:57], v[56:57], s[22:23], s[22:23]
  v_pk_fma_f32 v[58:59], v[58:59], s[22:23], s[22:23]
  v_pk_fma_f32 v[60:61], v[60:61], s[22:23], s[22:23]
  v_pk_fma_f32 v[62:63], v[62:63], s[22:23], s[22:23]
  v_mfma_f32_32x32x16_bf16 v[32:47], a[192:195], v[160:163], 0
  ds_read_b128 v[192:195], v0 offset:49152
  ds_read_b128 v[196:199], v0 offset:50176
  v_rcp_f32 v48, v48
  v_rcp_f32 v49, v49
  v_mfma_f32_32x32x16_bf16 v[32:47], a[196:199], v[164:167], v[32:47]
  ds_read_b128 v[200:203], v0 offset:51200
  ds_read_b128 v[204:207], v0 offset:52224
  v_rcp_f32 v50, v50
  v_rcp_f32 v51, v51
  v_mfma_f32_32x32x16_bf16 v[32:47], a[200:203], v[168:171], v[32:47]
  ds_read_b128 v[208:211], v0 offset:53248
  ds_read_b128 v[212:215], v0 offset:54272
  v_rcp_f32 v52, v52
  v_rcp_f32 v53, v53
  v_mfma_f32_32x32x16_bf16 v[32:47], a[204:207], v[172:175], v[32:47]
  buffer_store_dwordx4 v[132:135], v10, s[8:11], s28 offen offset:160
  v_rcp_f32 v54, v54
  v_rcp_f32 v55, v55
  v_mfma_f32_32x32x16_bf16 v[32:47], a[208:211], v[176:179], v[32:47]
  v_rcp_f32 v56, v56
  v_rcp_f32 v57, v57
  v_rcp_f32_e64 v58, v58
  v_mfma_f32_32x32x16_bf16 v[32:47], a[212:215], v[180:183], v[32:47]
  s_waitcnt lgkmcnt(0)
  v_rcp_f32 v59, v59
  v_rcp_f32 v60, v60
  v_rcp_f32 v61, v61
  v_rcp_f32 v62, v62
  v_rcp_f32 v63, v63
  v_pk_mul_f32 v[16:17], v[16:17], v[48:49]
  v_pk_mul_f32 v[18:19], v[18:19], v[50:51]
  v_pk_mul_f32 v[20:21], v[20:21], v[52:53]
  v_pk_mul_f32 v[22:23], v[22:23], v[54:55]
  v_pk_mul_f32 v[24:25], v[24:25], v[56:57]
  v_pk_mul_f32 v[26:27], v[26:27], v[58:59]
  v_pk_mul_f32 v[28:29], v[28:29], v[60:61]
  v_pk_mul_f32 v[30:31], v[30:31], v[62:63]
  v_pk_fma_f32 v[48:49], v[32:33], v[32:33], s[20:21] neg_lo:[1,0,1] neg_hi:[1,0,1]
  v_pk_fma_f32 v[50:51], v[34:35], v[34:35], s[20:21] neg_lo:[1,0,1] neg_hi:[1,0,1]
  v_pk_fma_f32 v[52:53], v[36:37], v[36:37], s[20:21] neg_lo:[1,0,1] neg_hi:[1,0,1]
  v_pk_fma_f32 v[54:55], v[38:39], v[38:39], s[20:21] neg_lo:[1,0,1] neg_hi:[1,0,1]
  v_pk_fma_f32 v[56:57], v[40:41], v[40:41], s[20:21] neg_lo:[1,0,1] neg_hi:[1,0,1]
  v_pk_fma_f32 v[58:59], v[42:43], v[42:43], s[20:21] neg_lo:[1,0,1] neg_hi:[1,0,1]
  v_pk_fma_f32 v[60:61], v[44:45], v[44:45], s[20:21] neg_lo:[1,0,1] neg_hi:[1,0,1]
  v_pk_fma_f32 v[62:63], v[46:47], v[46:47], s[20:21] neg_lo:[1,0,1] neg_hi:[1,0,1]
  v_pk_mul_f32 v[48:49], v[32:33], v[48:49]
  v_pk_mul_f32 v[50:51], v[34:35], v[50:51]
  v_pk_mul_f32 v[52:53], v[36:37], v[52:53]
  v_pk_mul_f32 v[54:55], v[38:39], v[54:55]
  v_pk_mul_f32 v[56:57], v[40:41], v[56:57]
  v_cvt_pk_bf16_f32 v184, v16, v17
  v_cvt_pk_bf16_f32 v185, v18, v19
  v_cvt_pk_bf16_f32 v186, v20, v21
  v_cvt_pk_bf16_f32 v187, v22, v23
  v_pk_mul_f32 v[58:59], v[42:43], v[58:59]
  v_pk_mul_f32 v[60:61], v[44:45], v[60:61]
  v_pk_mul_f32 v[62:63], v[46:47], v[62:63]
  v_mfma_f32_32x32x16_bf16 v[64:79], v[192:195], v[184:187], v[64:79]
  v_cvt_pk_bf16_f32 v188, v24, v25
  v_cvt_pk_bf16_f32 v189, v26, v27
  v_cvt_pk_bf16_f32 v190, v28, v29
  v_cvt_pk_bf16_f32 v191, v30, v31
  v_exp_f32_e64 v48, v48
  v_mfma_f32_32x32x16_bf16 v[80:95], v[196:199], v[184:187], v[80:95]
  v_exp_f32 v49, v49
  v_exp_f32 v50, v50
  v_exp_f32_e64 v51, v51
  v_mfma_f32_32x32x16_bf16 v[96:111], v[200:203], v[184:187], v[96:111]
  v_exp_f32 v52, v52
  v_exp_f32 v53, v53
  v_exp_f32_e64 v54, v54
  v_mfma_f32_32x32x16_bf16 v[64:79], v[204:207], v[188:191], v[64:79]
  v_exp_f32 v55, v55
  v_exp_f32 v56, v56
  v_exp_f32_e64 v57, v57
  v_mfma_f32_32x32x16_bf16 v[80:95], v[208:211], v[188:191], v[80:95]
  v_exp_f32 v58, v58
  v_exp_f32 v59, v59
  v_exp_f32_e64 v60, v60
  v_mfma_f32_32x32x16_bf16 v[96:111], v[212:215], v[188:191], v[96:111]
  v_exp_f32 v61, v61
  v_exp_f32 v62, v62
  v_exp_f32_e64 v63, v63
  v_pk_fma_f32 v[48:49], v[48:49], s[22:23], s[22:23]
  v_pk_fma_f32 v[50:51], v[50:51], s[22:23], s[22:23]
  v_pk_fma_f32 v[52:53], v[52:53], s[22:23], s[22:23]
  v_pk_fma_f32 v[54:55], v[54:55], s[22:23], s[22:23]
  v_pk_fma_f32 v[56:57], v[56:57], s[22:23], s[22:23]
  v_pk_fma_f32 v[58:59], v[58:59], s[22:23], s[22:23]
  v_pk_fma_f32 v[60:61], v[60:61], s[22:23], s[22:23]
  v_pk_fma_f32 v[62:63], v[62:63], s[22:23], s[22:23]
  v_mfma_f32_32x32x16_bf16 v[16:31], a[216:219], v[160:163], 0
  ds_read_b128 v[192:195], v0 offset:55296
  ds_read_b128 v[196:199], v0 offset:56320
  v_rcp_f32 v48, v48
  v_rcp_f32 v49, v49
  v_mfma_f32_32x32x16_bf16 v[16:31], a[220:223], v[164:167], v[16:31]
  ds_read_b128 v[200:203], v0 offset:57344
  ds_read_b128 v[204:207], v0 offset:58368
  v_rcp_f32 v50, v50
  v_rcp_f32 v51, v51
  v_mfma_f32_32x32x16_bf16 v[16:31], a[224:227], v[168:171], v[16:31]
  ds_read_b128 v[208:211], v0 offset:59392
  ds_read_b128 v[212:215], v0 offset:60416
  v_rcp_f32 v52, v52
  v_rcp_f32 v53, v53
  v_mfma_f32_32x32x16_bf16 v[16:31], a[228:231], v[172:175], v[16:31]
  v_rcp_f32 v54, v54
  v_rcp_f32 v55, v55
  v_rcp_f32_e64 v56, v56
  v_mfma_f32_32x32x16_bf16 v[16:31], a[232:235], v[176:179], v[16:31]
  v_rcp_f32 v57, v57
  v_rcp_f32 v58, v58
  v_rcp_f32_e64 v59, v59
  v_mfma_f32_32x32x16_bf16 v[16:31], a[236:239], v[180:183], v[16:31]
  s_waitcnt lgkmcnt(0)
  v_rcp_f32 v60, v60
  v_rcp_f32 v61, v61
  v_rcp_f32 v62, v62
  v_rcp_f32_e64 v63, v63
  v_pk_mul_f32 v[32:33], v[32:33], v[48:49]
  v_pk_mul_f32 v[34:35], v[34:35], v[50:51]
  v_pk_mul_f32 v[36:37], v[36:37], v[52:53]
  v_pk_mul_f32 v[38:39], v[38:39], v[54:55]
  v_pk_mul_f32 v[40:41], v[40:41], v[56:57]
  v_pk_mul_f32 v[42:43], v[42:43], v[58:59]
  v_pk_mul_f32 v[44:45], v[44:45], v[60:61]
  v_pk_mul_f32 v[46:47], v[46:47], v[62:63]
  v_pk_fma_f32 v[48:49], v[16:17], v[16:17], s[20:21] neg_lo:[1,0,1] neg_hi:[1,0,1]
  v_pk_fma_f32 v[50:51], v[18:19], v[18:19], s[20:21] neg_lo:[1,0,1] neg_hi:[1,0,1]
  v_pk_fma_f32 v[52:53], v[20:21], v[20:21], s[20:21] neg_lo:[1,0,1] neg_hi:[1,0,1]
  v_pk_fma_f32 v[54:55], v[22:23], v[22:23], s[20:21] neg_lo:[1,0,1] neg_hi:[1,0,1]
  v_pk_fma_f32 v[56:57], v[24:25], v[24:25], s[20:21] neg_lo:[1,0,1] neg_hi:[1,0,1]
  v_pk_fma_f32 v[58:59], v[26:27], v[26:27], s[20:21] neg_lo:[1,0,1] neg_hi:[1,0,1]
  v_pk_fma_f32 v[60:61], v[28:29], v[28:29], s[20:21] neg_lo:[1,0,1] neg_hi:[1,0,1]
  v_pk_fma_f32 v[62:63], v[30:31], v[30:31], s[20:21] neg_lo:[1,0,1] neg_hi:[1,0,1]
  v_pk_mul_f32 v[48:49], v[16:17], v[48:49]
  v_pk_mul_f32 v[50:51], v[18:19], v[50:51]
  v_pk_mul_f32 v[52:53], v[20:21], v[52:53]
  v_pk_mul_f32 v[54:55], v[22:23], v[54:55]
  v_pk_mul_f32 v[56:57], v[24:25], v[56:57]
  v_cvt_pk_bf16_f32 v184, v32, v33
  v_cvt_pk_bf16_f32 v185, v34, v35
  v_cvt_pk_bf16_f32 v186, v36, v37
  v_cvt_pk_bf16_f32 v187, v38, v39
  v_pk_mul_f32 v[58:59], v[26:27], v[58:59]
  v_pk_mul_f32 v[60:61], v[28:29], v[60:61]
  v_pk_mul_f32 v[62:63], v[30:31], v[62:63]
  v_mfma_f32_32x32x16_bf16 v[64:79], v[192:195], v[184:187], v[64:79]
  ds_read_b128 v[216:219], v0 offset:12288
  ds_read_b128 v[220:223], v0 offset:13312
  v_cvt_pk_bf16_f32 v188, v40, v41
  v_cvt_pk_bf16_f32 v189, v42, v43
  v_cvt_pk_bf16_f32 v190, v44, v45
  v_cvt_pk_bf16_f32 v191, v46, v47
  v_mfma_f32_32x32x16_bf16 v[80:95], v[196:199], v[184:187], v[80:95]
  ds_read_b128 v[224:227], v0 offset:14336
  ds_read_b128 v[228:231], v0 offset:15360
  v_exp_f32 v48, v48
  v_exp_f32 v49, v49
  v_mfma_f32_32x32x16_bf16 v[96:111], v[200:203], v[184:187], v[96:111]
  ds_read_b128 v[232:235], v0 offset:16384
  ds_read_b128 v[236:239], v0 offset:17408
  v_exp_f32 v50, v50
  v_exp_f32 v51, v51
  v_mfma_f32_32x32x16_bf16 v[64:79], v[204:207], v[188:191], v[64:79]
  s_mov_b32 s28, s34
  v_exp_f32 v52, v52
  v_exp_f32 v53, v53
  v_exp_f32 v54, v54
  v_mfma_f32_32x32x16_bf16 v[80:95], v[208:211], v[188:191], v[80:95]
  s_add_u32 s34, s34, 0x60000
  v_exp_f32 v55, v55
  v_exp_f32 v56, v56
  v_exp_f32_e64 v57, v57
  v_mfma_f32_32x32x16_bf16 v[96:111], v[212:215], v[188:191], v[96:111]
  s_waitcnt lgkmcnt(0)
  v_exp_f32 v58, v58
  v_exp_f32 v59, v59
  v_exp_f32 v60, v60
  v_exp_f32 v61, v61
  v_exp_f32 v62, v62
  v_exp_f32_e64 v63, v63
  v_pk_fma_f32 v[48:49], v[48:49], s[22:23], s[22:23]
  v_pk_fma_f32 v[50:51], v[50:51], s[22:23], s[22:23]
  v_pk_fma_f32 v[52:53], v[52:53], s[22:23], s[22:23]
  v_pk_fma_f32 v[54:55], v[54:55], s[22:23], s[22:23]
  v_pk_fma_f32 v[56:57], v[56:57], s[22:23], s[22:23]
  v_pk_fma_f32 v[58:59], v[58:59], s[22:23], s[22:23]
  v_pk_fma_f32 v[60:61], v[60:61], s[22:23], s[22:23]
  v_pk_fma_f32 v[62:63], v[62:63], s[22:23], s[22:23]
  v_mfma_f32_32x32x16_bf16 v[32:47], v[216:219], v[160:163], 0
  ds_read_b128 v[192:195], v0 offset:61440
  ds_read_b128 v[196:199], v0 offset:62464
  v_rcp_f32 v48, v48
  v_rcp_f32 v49, v49
  v_mfma_f32_32x32x16_bf16 v[32:47], v[220:223], v[164:167], v[32:47]
  ds_read_b128 v[200:203], v0 offset:63488
  ds_read_b128 v[204:207], v0 offset:64512
  v_rcp_f32 v50, v50
  v_rcp_f32 v51, v51
  v_mfma_f32_32x32x16_bf16 v[32:47], v[224:227], v[168:171], v[32:47]
  ds_read_b128 v[208:211], v1
  ds_read_b128 v[212:215], v1 offset:1024
  v_rcp_f32 v52, v52
  v_rcp_f32 v53, v53
  v_mfma_f32_32x32x16_bf16 v[32:47], v[228:231], v[172:175], v[32:47]
  v_rcp_f32 v54, v54
  v_rcp_f32 v55, v55
  v_rcp_f32_e64 v56, v56
  v_mfma_f32_32x32x16_bf16 v[32:47], v[232:235], v[176:179], v[32:47]
  v_rcp_f32 v57, v57
  v_rcp_f32 v58, v58
  v_rcp_f32_e64 v59, v59
  v_mfma_f32_32x32x16_bf16 v[32:47], v[236:239], v[180:183], v[32:47]
  s_waitcnt lgkmcnt(0)
  v_rcp_f32 v60, v60
  v_rcp_f32 v61, v61
  v_rcp_f32 v62, v62
  v_rcp_f32_e64 v63, v63
  v_pk_mul_f32 v[16:17], v[16:17], v[48:49]
  v_pk_mul_f32 v[18:19], v[18:19], v[50:51]
  v_pk_mul_f32 v[20:21], v[20:21], v[52:53]
  v_pk_mul_f32 v[22:23], v[22:23], v[54:55]
  v_pk_mul_f32 v[24:25], v[24:25], v[56:57]
  v_pk_mul_f32 v[26:27], v[26:27], v[58:59]
  v_pk_mul_f32 v[28:29], v[28:29], v[60:61]
  v_pk_mul_f32 v[30:31], v[30:31], v[62:63]
  v_pk_fma_f32 v[48:49], v[32:33], v[32:33], s[20:21] neg_lo:[1,0,1] neg_hi:[1,0,1]
  v_pk_fma_f32 v[50:51], v[34:35], v[34:35], s[20:21] neg_lo:[1,0,1] neg_hi:[1,0,1]
  v_pk_fma_f32 v[52:53], v[36:37], v[36:37], s[20:21] neg_lo:[1,0,1] neg_hi:[1,0,1]
  v_pk_fma_f32 v[54:55], v[38:39], v[38:39], s[20:21] neg_lo:[1,0,1] neg_hi:[1,0,1]
  v_pk_fma_f32 v[56:57], v[40:41], v[40:41], s[20:21] neg_lo:[1,0,1] neg_hi:[1,0,1]
  v_pk_fma_f32 v[58:59], v[42:43], v[42:43], s[20:21] neg_lo:[1,0,1] neg_hi:[1,0,1]
  v_pk_fma_f32 v[60:61], v[44:45], v[44:45], s[20:21] neg_lo:[1,0,1] neg_hi:[1,0,1]
  v_pk_fma_f32 v[62:63], v[46:47], v[46:47], s[20:21] neg_lo:[1,0,1] neg_hi:[1,0,1]
  v_pk_mul_f32 v[48:49], v[32:33], v[48:49]
  v_pk_mul_f32 v[50:51], v[34:35], v[50:51]
  v_pk_mul_f32 v[52:53], v[36:37], v[52:53]
  v_pk_mul_f32 v[54:55], v[38:39], v[54:55]
  v_pk_mul_f32 v[56:57], v[40:41], v[56:57]
  v_cvt_pk_bf16_f32 v184, v16, v17
  v_cvt_pk_bf16_f32 v185, v18, v19
  v_cvt_pk_bf16_f32 v186, v20, v21
  v_cvt_pk_bf16_f32 v187, v22, v23
  v_pk_mul_f32 v[58:59], v[42:43], v[58:59]
  v_pk_mul_f32 v[60:61], v[44:45], v[60:61]
  v_pk_mul_f32 v[62:63], v[46:47], v[62:63]
  v_mfma_f32_32x32x16_bf16 v[64:79], v[192:195], v[184:187], v[64:79]
  v_cvt_pk_bf16_f32 v188, v24, v25
  v_cvt_pk_bf16_f32 v189, v26, v27
  v_cvt_pk_bf16_f32 v190, v28, v29
  v_cvt_pk_bf16_f32 v191, v30, v31
  v_exp_f32_e64 v48, v48
  v_mfma_f32_32x32x16_bf16 v[80:95], v[196:199], v[184:187], v[80:95]
  v_exp_f32 v49, v49
  v_exp_f32 v50, v50
  v_exp_f32_e64 v51, v51
  v_mfma_f32_32x32x16_bf16 v[96:111], v[200:203], v[184:187], v[96:111]
  v_exp_f32 v52, v52
  v_exp_f32 v53, v53
  v_exp_f32_e64 v54, v54
  v_mfma_f32_32x32x16_bf16 v[64:79], v[204:207], v[188:191], v[64:79]
  v_exp_f32 v55, v55
  v_exp_f32 v56, v56
  v_exp_f32_e64 v57, v57
  v_mfma_f32_32x32x16_bf16 v[80:95], v[208:211], v[188:191], v[80:95]
  v_exp_f32 v58, v58
  v_exp_f32 v59, v59
  v_exp_f32_e64 v60, v60
  v_mfma_f32_32x32x16_bf16 v[96:111], v[212:215], v[188:191], v[96:111]
  v_exp_f32 v61, v61
  v_exp_f32 v62, v62
  v_exp_f32_e64 v63, v63
  v_pk_fma_f32 v[48:49], v[48:49], s[22:23], s[22:23]
  v_pk_fma_f32 v[50:51], v[50:51], s[22:23], s[22:23]
  v_pk_fma_f32 v[52:53], v[52:53], s[22:23], s[22:23]
  v_pk_fma_f32 v[54:55], v[54:55], s[22:23], s[22:23]
  v_pk_fma_f32 v[56:57], v[56:57], s[22:23], s[22:23]
  v_pk_fma_f32 v[58:59], v[58:59], s[22:23], s[22:23]
  v_pk_fma_f32 v[60:61], v[60:61], s[22:23], s[22:23]
  v_pk_fma_f32 v[62:63], v[62:63], s[22:23], s[22:23]
  ds_read_b128 v[192:195], v1 offset:2048
  ds_read_b128 v[196:199], v1 offset:3072
  ds_read_b128 v[200:203], v1 offset:4096
  ds_read_b128 v[204:207], v1 offset:5120
  ds_read_b128 v[208:211], v1 offset:6144
  ds_read_b128 v[212:215], v1 offset:7168
  v_rcp_f32 v48, v48
  v_rcp_f32 v49, v49
  v_rcp_f32 v50, v50
  v_rcp_f32 v51, v51
  v_rcp_f32 v52, v52
  v_rcp_f32 v53, v53
  v_rcp_f32 v54, v54
  v_rcp_f32 v55, v55
  v_rcp_f32 v56, v56
  v_rcp_f32 v57, v57
  v_rcp_f32 v58, v58
  v_rcp_f32 v59, v59
  v_rcp_f32 v60, v60
  v_rcp_f32 v61, v61
  v_rcp_f32 v62, v62
  v_rcp_f32 v63, v63
  v_pk_mul_f32 v[32:33], v[32:33], v[48:49]
  v_pk_mul_f32 v[34:35], v[34:35], v[50:51]
  v_pk_mul_f32 v[36:37], v[36:37], v[52:53]
  v_pk_mul_f32 v[38:39], v[38:39], v[54:55]
  v_pk_mul_f32 v[40:41], v[40:41], v[56:57]
  v_pk_mul_f32 v[42:43], v[42:43], v[58:59]
  v_pk_mul_f32 v[44:45], v[44:45], v[60:61]
  v_pk_mul_f32 v[46:47], v[46:47], v[62:63]
  v_cvt_pk_bf16_f32 v184, v32, v33
  v_cvt_pk_bf16_f32 v185, v34, v35
  v_cvt_pk_bf16_f32 v186, v36, v37
  v_cvt_pk_bf16_f32 v187, v38, v39
  v_cvt_pk_bf16_f32 v188, v40, v41
  v_cvt_pk_bf16_f32 v189, v42, v43
  v_cvt_pk_bf16_f32 v190, v44, v45
  v_cvt_pk_bf16_f32 v191, v46, v47
  s_waitcnt lgkmcnt(5)
  v_mfma_f32_32x32x16_bf16 v[64:79], v[192:195], v[184:187], v[64:79]
  s_waitcnt lgkmcnt(2)
  v_mfma_f32_32x32x16_bf16 v[64:79], v[204:207], v[188:191], v[64:79]
  v_mfma_f32_32x32x16_bf16 v[80:95], v[196:199], v[184:187], v[80:95]
  s_waitcnt lgkmcnt(1)
  v_mfma_f32_32x32x16_bf16 v[80:95], v[208:211], v[188:191], v[80:95]
  s_nop 0
  v_mfma_f32_32x32x16_bf16 v[96:111], v[200:203], v[184:187], v[96:111]
  s_waitcnt lgkmcnt(0)
  v_mfma_f32_32x32x16_bf16 v[96:111], v[212:215], v[188:191], v[96:111]
  s_nop 5
  v_cvt_pk_bf16_f32 v112, v64, v65
  v_cvt_pk_bf16_f32 v113, v66, v67
  v_cvt_pk_bf16_f32 v114, v68, v69
  v_cvt_pk_bf16_f32 v115, v70, v71
  buffer_store_dwordx4 v[112:115], v10, s[8:11], s28 offen
  v_cvt_pk_bf16_f32 v116, v72, v73
  v_cvt_pk_bf16_f32 v117, v74, v75
  v_cvt_pk_bf16_f32 v118, v76, v77
  v_cvt_pk_bf16_f32 v119, v78, v79
  buffer_store_dwordx4 v[116:119], v10, s[8:11], s28 offen offset:32
  v_cvt_pk_bf16_f32 v120, v80, v81
  v_cvt_pk_bf16_f32 v121, v82, v83
  v_cvt_pk_bf16_f32 v122, v84, v85
  v_cvt_pk_bf16_f32 v123, v86, v87
  buffer_store_dwordx4 v[120:123], v10, s[8:11], s28 offen offset:64
  v_cvt_pk_bf16_f32 v124, v88, v89
  v_cvt_pk_bf16_f32 v125, v90, v91
  v_cvt_pk_bf16_f32 v126, v92, v93
  v_cvt_pk_bf16_f32 v127, v94, v95
  buffer_store_dwordx4 v[124:127], v10, s[8:11], s28 offen offset:96
  v_cvt_pk_bf16_f32 v128, v96, v97
  v_cvt_pk_bf16_f32 v129, v98, v99
  v_cvt_pk_bf16_f32 v130, v100, v101
  v_cvt_pk_bf16_f32 v131, v102, v103
  buffer_store_dwordx4 v[128:131], v10, s[8:11], s28 offen offset:128
  v_cvt_pk_bf16_f32 v132, v104, v105
  v_cvt_pk_bf16_f32 v133, v106, v107
  v_cvt_pk_bf16_f32 v134, v108, v109
  v_cvt_pk_bf16_f32 v135, v110, v111
  buffer_store_dwordx4 v[132:135], v10, s[8:11], s28 offen offset:160
S_end:
  s_endpgm
.section .rodata,"a"
.p2align 6
.amdhsa_kernel standalone__modern_conv_block_convnext__vision_kernel
  .amdhsa_next_free_vgpr 512
  .amdhsa_next_free_sgpr 102
  .amdhsa_accum_offset 256
  .amdhsa_group_segment_fixed_size 0
  .amdhsa_kernarg_size 80
  .amdhsa_user_sgpr_count 2
  .amdhsa_user_sgpr_kernarg_segment_ptr 1
  .amdhsa_system_sgpr_workgroup_id_x 1
.end_amdhsa_kernel
```

```asm
; @launch grid=(256,1,1) block=(256,1,1) lds=163840
.amdgcn_target "amdgcn-amd-amdhsa--gfx950"
.text
.globl standalone__modern_conv_block_convnext__vision_kernel
.p2align 8
.type standalone__modern_conv_block_convnext__vision_kernel,@function
standalone__modern_conv_block_convnext__vision_kernel:
  s_cmp_ge_u32 s2, 0x100
  s_cbranch_scc1 L_end
  s_nop 0
  s_load_dwordx2 s[4:5], s[0:1], 0
  s_load_dwordx2 s[60:61], s[0:1], 8
  s_load_dwordx2 s[64:65], s[0:1], 16
  s_load_dwordx2 s[68:69], s[0:1], 24
  s_load_dwordx2 s[72:73], s[0:1], 32
  s_load_dwordx2 s[76:77], s[0:1], 40
  s_load_dwordx2 s[80:81], s[0:1], 48
  s_load_dwordx2 s[8:9], s[0:1], 56
  s_getpc_b64 s[40:41]
L_pc:
  s_lshl_b32 s32, s2, 9
  s_and_b32 s32, s32, 0xf000
  v_lshl_add_u32 v249, v0, 4, s32
  v_lshrrev_b32_e64 v112, 6, v0
  v_min_u32 v249, L_cend-L_pc-16, v249
  v_and_b32 v113, 63, v0
  global_load_dwordx4 v[108:111], v249, s[40:41]
  v_readfirstlane_b32 s27, v112
  s_mov_b32 s62, 0x6c0
  s_mov_b32 s63, 0x20000
  s_mov_b32 s82, 0xc0
  s_mov_b32 s83, 0x20000
  s_mov_b32 s78, 0xc0
  s_mov_b32 s79, 0x20000
  s_mov_b32 s66, 0x12000
  s_mov_b32 s67, 0x20000
  s_mov_b32 s74, 0x12000
  s_mov_b32 s75, 0x20000
  v_bfe_u32 v114, v113, 3, 1
  v_bfe_u32 v115, v113, 4, 1
  v_bfe_u32 v116, v113, 2, 1
  v_and_b32 v117, 3, v113
  v_lshlrev_b32 v118, 4, v113
  s_min_u32 s44, s27, 2
  s_lshl_b32 s45, s44, 6
  s_mul_i32 s46, s44, 0x240
  v_lshlrev_b32 v119, 1, v113
  v_and_b32 v120, 31, v113
  v_lshlrev_b32 v121, 1, v120
  v_lshlrev_b32 v122, 4, v115
  v_lshl_add_u32 v122, v116, 3, v122
  v_lshl_add_u32 v122, v114, 2, v122
  v_add_u32 v122, v122, v117
  v_bfe_u32 v123, v113, 3, 2
  v_and_b32 v124, 7, v113
  v_lshl_add_u32 v123, v124, 2, v123
  v_lshlrev_b32_e64 v125, 1, v123
  s_lshr_b32 s35, s2, 3
  s_lshl_b32 s35, s35, 2
  s_add_u32 s35, s35, s27
  s_sub_u32 s55, s35, 0x48
  s_min_u32 s35, s35, s55
  s_lshl_b32 s47, s35, 10
  s_and_b32 s54, s2, 6
  s_lshl_b32 s54, s54, 1
  s_lshr_b32 s32, s2, 6
  s_add_u32 s54, s54, s32
  s_mul_i32 s59, s54, 0x300000
  s_and_b32 s53, s2, 1
  s_lshl_b32 s53, s53, 8
  s_and_b32 s32, s2, 56
  s_lshl_b32 s32, s32, 2
  s_add_u32 s53, s53, s32
  s_lshl_b32 s32, s27, 3
  s_add_u32 s53, s53, s32
  s_mul_i32 s3, s53, 0xc0
  s_add_u32 s3, s3, 0xf40
  s_mov_b32 s6, 0x3000000
  s_mov_b32 s7, 0x20000
  s_cmp_eq_u32 s53, 0
  s_cselect_b32 s35, 12, 0
  s_sub_u32 s55, 0x78, s35
  s_cmp_eq_u32 s53, 0x1f8
  s_cselect_b32 s55, 0x6c, s55
  s_mul_i32 s15, s27, 0x1040
  s_add_u32 s48, s59, 0x17000
  s_add_u32 s49, s59, 0x47000
  s_waitcnt lgkmcnt(0)
  v_add_u32 v126, 64, v113
  buffer_load_dwordx4 v[108:111], v118, s[64:67], s47 offen
  v_subrev_u32 v129, 57, v113
  v_cmp_le_u32 vcc, 57, v113
  buffer_load_dwordx4 v[108:111], v118, s[72:75], s47 offen
  v_add_u32_e64 v127, 7, v113
  v_add_u32 v128, 0x47, v113
  buffer_load_ushort v131, v119, s[60:63], s46 offen
  v_mov_b32 v199, 0x17c00
  v_cndmask_b32_e64 v126, v126, v129, vcc
  buffer_load_ushort v132, v121, s[60:63], s46 offen offset:128
  v_mov_b32 v129, 0xfffffc00
  v_cndmask_b32 v199, v129, v199, vcc
  v_add_u32 v198, s3, v118
  buffer_load_ushort v133, v119, s[60:63], s46 offen offset:192
  v_lshl_add_u32 v199, v126, 4, v199
  v_add_u32_e64 v199, s3, v199
  buffer_load_ushort v134, v119, s[60:63], s46 offen offset:320
  v_add_u32 v200, 0x17870, v198
  v_add_u32 v201, 0x17870, v198
  buffer_load_ushort v135, v119, s[60:63], s46 offen offset:448
  v_mov_b32 v130, 0x80000000
  v_subrev_u32_e64 v6, s35, v113
  buffer_load_ushort v139, v125, s[80:83], s45 offen
  v_cmp_gt_u32 s[36:37], s55, v6
  v_subrev_u32_e64 v7, s35, v126
  v_cmp_gt_u32 s[38:39], s55, v7
  buffer_load_ushort v140, v125, s[76:79], s45 offen
  v_subrev_u32_e64 v8, s35, v127
  v_cmp_gt_u32 s[40:41], s55, v8
  buffer_load_ushort v136, v125, s[80:83], 0 offen
  v_subrev_u32_e64 v9, s35, v128
  v_cmp_gt_u32 s[42:43], s55, v9
  buffer_load_ushort v137, v125, s[80:83], 0 offen offset:64
  v_cndmask_b32 v6, v130, v198, s[36:37]
  v_cndmask_b32 v7, v130, v199, s[38:39]
  buffer_load_ushort v138, v125, s[80:83], 0 offen offset:128
  v_cndmask_b32 v8, v130, v200, s[40:41]
  v_cndmask_b32 v9, v130, v201, s[42:43]
  s_add_u32 m0, s15, 0x4120
  s_nop 0
  buffer_load_dwordx4 v6, s[4:7], s48 offen lds
  buffer_load_dwordx4 v7, s[4:7], s48 offen offset:1024 lds
  buffer_load_dwordx4 v8, s[4:7], s48 offen offset:2048 lds
  buffer_load_dwordx4 v9, s[4:7], s48 offen offset:3072 lds
  s_sub_u32 s56, s59, 0x19000
  v_add_u32 v198, s56, v6
  s_add_u32 s56, s56, 0x400
  v_add_u32_e64 v199, s56, v7
  s_add_u32 s56, s56, 0x400
  v_add_u32_e64 v200, s56, v8
  s_add_u32 s56, s56, 0x400
  v_add_u32 v201, s56, v9
  v_lshrrev_b32 v141, 5, v113
  v_lshlrev_b32 v202, 4, v117
  v_lshl_add_u32 v202, v141, 6, v202
  v_bfe_u32 v126, v113, 3, 2
  v_lshl_add_u32 v126, v116, 2, v126
  v_cmp_eq_u32 vcc, 7, v126
  v_lshl_add_u32 v126, v116, 1, v114
  v_lshl_add_u32 v126, v115, 3, v126
  v_mul_u32_u24 v203, 0x300, v126
  v_add_u32 v203, v203, v202
  v_cndmask_b32 v204, v130, v202, vcc
  s_mov_b32 s70, 0x300
  s_mov_b32 s71, 0x20000
  s_mov_b32 s10, 0x3000000
  s_mov_b32 s11, 0x20000
  s_and_b32 s36, s27, 2
  s_add_u32 s37, s27, 1
  s_lshr_b32 s37, s37, 1
  s_and_b32 s38, s37, 1
  s_cmp_eq_u32 s27, 1
  s_cselect_b32 s39, 0, 3
  s_cselect_b32 s51, 0x1000, 0
  s_cselect_b32 s18, -1, 1
  s_nop 0
  s_mul_i32 s18, s18, 0x2400
  s_lshl_b32 s32, s36, 8
  s_lshl_b32 s33, s37, 8
  s_add_u32 s43, s32, 0x11d00
  s_add_u32 s50, s33, 0x11d00
  s_add_u32 s51, s51, s33
  s_mul_i32 s40, s38, 0x6000
  s_add_u32 s40, s40, s32
  s_mul_i32 s41, s38, 0x3000
  s_add_u32 s41, s41, s32
  s_add_u32 s41, s41, 0xc00
  s_mul_i32 s42, s39, 0x2400
  s_add_u32 s42, s42, s33
  v_and_b32 v150, 0x70, v118
  v_lshl_add_u32 v150, v115, 7, v150
  v_lshl_add_u32 v150, v141, 8, v150
  v_mul_u32_u24 v127, 0xc00, v114
  v_add_u32_e64 v150, v150, v127
  v_bfe_u32 v151, v113, 1, 1
  v_and_b32_e64 v152, 1, v113
  v_lshl_add_u32 v153, v116, 1, v152
  s_mul_i32 s32, s36, 0x6000
  s_lshl_b32 s33, s38, 10
  s_add_u32 s33, s33, s32
  s_add_u32 s33, s33, 0x10000
  v_add_u32_e64 v195, s33, v150
  s_lshl_b32 s33, s38, 3
  s_add_u32 s33, s33, s32
  s_add_u32 s33, s33, 0x10200
  v_add_u32_e64 v196, s33, v150
  s_mul_i32 s32, s37, 0x6000
  s_lshl_b32 s33, s39, 9
  s_add_u32 s33, s33, s32
  s_add_u32 s33, s33, 0x10000
  v_add_u32 v197, s33, v150
  v_add_u32 v127, 16, v113
  v_lshrrev_b32 v127, 6, v127
  v_lshlrev_b32 v127, 4, v127
  buffer_load_dwordx4 a[72:75], v202, s[64:67], s43 offen
  v_xor_b32_e64 v253, v127, v118
  v_lshl_add_u32 v127, v141, 4, 16
  v_xor_b32_e64 v254, v127, v118
  v_mul_u32_u24 v127, 0x1200, v141
  v_add_u32_e64 v254, v127, v254
  v_add_u32 v127, 0xb0, v113
  v_lshrrev_b32 v127, 6, v127
  v_lshlrev_b32 v127, 4, v127
  v_xor_b32_e64 v255, v127, v118
  v_add_u32 v255, 0x1200, v255
  s_mul_i32 s14, s27, 0x1800
  s_add_u32 s32, s27, 3
  s_and_b32 s32, s32, 3
  s_mul_i32 s32, s32, 0x600
  s_cmp_eq_u32 s27, 0
  s_cselect_b32 s57, 0, 3
  s_cselect_b32 s53, 3, 6
  s_cselect_b32 s55, 6, 0
  s_lshl_b32 s57, s57, 13
  s_add_u32 s57, s57, s32
  s_add_u32 s58, s57, 0x3000
  s_lshl_b32 s53, s53, 13
  s_add_u32 s53, s53, s32
  s_add_u32 s54, s53, 0x3000
  s_lshl_b32 s55, s55, 13
  s_add_u32 s55, s55, s32
  s_add_u32 s56, s55, 0x3000
  v_and_b32_e64 v154, 7, v113
  buffer_load_dwordx4 a[76:79], v202, s[64:67], s43 offen offset:128
  v_lshrrev_b32 v155, 4, v113
  v_lshlrev_b32 v156, 4, v141
  v_and_b32 v143, 1, v113
  v_lshlrev_b32 v143, 4, v143
  v_mov_b32 v129, 0xffff
  v_lshlrev_b32_e64 v129, v143, v129
  v_bfe_u32 v127, v113, 1, 2
  v_lshlrev_b32 v127, v127, 1
  v_bfe_i32 v56, v127, 0, 1
  v_mov_b32 v60, 0
  v_and_b32 v56, v56, v129
  v_bfe_i32 v57, v127, 1, 1
  v_mov_b32 v61, 0
  v_and_b32 v57, v57, v129
  v_bfe_i32 v58, v127, 2, 1
  v_mov_b32 v62, 0
  v_and_b32 v58, v58, v129
  v_bfe_i32 v59, v127, 3, 1
  v_mov_b32 v63, 0
  v_and_b32 v59, v59, v129
  v_min_u32_e64 v127, 11, v113
  v_mul_u32_u24 v127, 0x190, v127
  ds_write_b128 v127, v[60:63] offset:50304
  v_lshrrev_b32 v127, 2, v0
  v_min_u32 v127, 24, v127
  v_lshlrev_b32_e64 v127, 4, v127
  buffer_load_dwordx4 a[80:83], v202, s[64:67], s50 offen
  v_or_b32 v127, v127, v117
  v_lshlrev_b32 v127, 4, v127
  ds_write_b128 v127, v[60:63] offset:54720
  v_bfe_i32 v149, v113, 2, 1
  v_xor_b32 v148, -1, v149
  s_lshl_b32 s32, s44, 7
  v_lshrrev_b32_e64 v144, 3, v113
  v_lshl_add_u32 v147, v144, 8, s45
  v_lshl_add_u32 v147, v154, 3, v147
  v_mul_u32_u24 v144, 0x190, v144
  v_lshl_add_u32 v144, v154, 4, v144
  v_add_u32 v144, s32, v144
  v_lshrrev_b32 v145, 3, v120
  v_mul_u32_u24 v145, 0x190, v145
  v_lshl_add_u32 v145, v154, 4, v145
  v_add_u32_e64 v145, s32, v145
  v_lshl_add_u32 v146, v120, 2, s32
  v_add_u32 v146, s45, v125
  v_mul_u32_u24 v127, 43, v146
  v_lshrrev_b32_e64 v127, 9, v127
  v_mul_u32_u24 v127, 0x5f0, v127
  v_lshlrev_b32 v146, 7, v146
  v_sub_u32 v146, v146, v127
  v_sub_u32_e64 v127, v155, v151
  v_lshl_add_u32 v128, v114, 2, v153
  v_mul_u32_u24_e64 v142, 48, v141
  v_lshl_add_u32 v142, v115, 1, v142
  buffer_load_dwordx4 a[84:87], v202, s[64:67], s50 offen offset:128
  v_sub_u32_e64 v142, v142, v151
  v_lshl_add_u32 v142, v142, 3, v128
  v_lshlrev_b32_e64 v142, 3, v142
  v_add_u32 v11, 0xd600, v142
  v_add_u32 v205, 0xde00, v142
  v_lshl_add_u32 v128, v127, 3, v128
  v_min_u32 v128, 24, v128
  v_lshlrev_b32 v128, 4, v128
  v_add_u32 v3, 0xc300, v128
  v_lshlrev_b32_e64 v157, 2, v115
  v_lshl_add_u32 v157, v114, 1, v157
  v_bfe_u32 v128, v113, 1, 1
  v_add_u32 v157, v157, v128
  v_xor_b32 v128, v116, v141
  v_lshl_add_u32 v157, v128, 3, v157
  v_lshlrev_b32 v157, v157, 1
  v_mov_b32 v128, 0x3f80
  v_lshlrev_b32_e64 v128, v143, v128
  v_mov_b32 v127, 0xbf80
  v_lshlrev_b32_e64 v127, v143, v127
  v_bfe_i32 v216, v157, 0, 1
  v_and_b32 v224, v216, v128
  v_and_b32 v184, v216, v127
  v_bfe_i32 v217, v157, 1, 1
  v_and_b32 v225, v217, v128
  v_and_b32 v185, v217, v127
  buffer_load_dwordx4 a[88:91], v204, s[68:71], s51 offen
  v_bfe_i32 v218, v157, 2, 1
  v_and_b32 v226, v218, v128
  v_and_b32 v186, v218, v127
  v_bfe_i32 v219, v157, 3, 1
  v_and_b32 v227, v219, v128
  v_and_b32 v187, v219, v127
  v_bfe_i32 v220, v157, 4, 1
  v_and_b32 v228, v220, v128
  v_and_b32 v188, v220, v127
  v_bfe_i32 v221, v157, 5, 1
  v_and_b32 v229, v221, v128
  v_and_b32 v189, v221, v127
  v_bfe_i32 v222, v157, 6, 1
  v_and_b32_e64 v230, v222, v128
  v_and_b32_e64 v190, v222, v127
  v_bfe_i32 v223, v157, 7, 1
  v_and_b32_e64 v231, v223, v128
  v_and_b32_e64 v191, v223, v127
  v_lshl_add_u32 v157, v153, 1, v115
  v_xor_b32_e64 v128, v151, v141
  v_lshl_add_u32 v157, v128, 3, v157
  v_lshlrev_b32 v157, v157, 1
  v_bfe_i32 v216, v157, 0, 1
  v_bfe_i32 v217, v157, 1, 1
  v_bfe_i32 v218, v157, 2, 1
  v_bfe_i32 v219, v157, 3, 1
  v_bfe_i32 v220, v157, 4, 1
  buffer_load_dwordx4 a[92:95], v204, s[68:71], s51 offen offset:128
  v_bfe_i32 v221, v157, 5, 1
  v_bfe_i32 v222, v157, 6, 1
  v_bfe_i32 v223, v157, 7, 1
  v_lshlrev_b32_e64 v143, 4, v114
  v_bfe_u32 v128, v113, 2, 2
  v_xor_b32_e64 v128, v155, v128
  v_lshl_add_u32 v157, v128, 2, v117
  v_lshlrev_b32 v157, v157, 1
  v_bfe_u32 v240, v157, 0, 1
  v_mul_u32_u24 v240, 0x3f80, v240
  v_bfe_u32 v241, v157, 1, 1
  v_mul_u32_u24 v241, 0x3f80, v241
  v_bfe_u32 v242, v157, 2, 1
  v_mul_u32_u24 v242, 0x3f80, v242
  v_bfe_u32 v243, v157, 3, 1
  v_mul_u32_u24 v243, 0x3f80, v243
  s_mov_b32 s22, 0x3e9a0000
  s_mov_b32 s24, 0x3c2aaaab
  s_mov_b32 s25, 0x3727c5ac
  s_mov_b32 s20, 0x36553a11
  s_mov_b32 s21, 0x3aa63895
  s_mov_b32 s12, 0
  s_mov_b32 s13, 0xffff0000
  s_add_u32 s29, s59, 0x77000
  s_add_u32 s52, s59, 0xa7000
  v_lshl_add_u32 v158, v152, 1, v116
  buffer_load_dwordx4 a[0:3], v203, s[64:67], s40 offen
  v_lshl_add_u32 v158, v114, 2, v158
  v_mul_u32_u24 v159, 48, v155
  v_mul_u32_u24 v32, 0xc0, v158
  v_add_u32_e64 v129, s15, v32
  v_lshl_add_u32 v33, v151, 1, v155
  v_lshrrev_b32_e64 v127, 1, v33
  v_mul_u32_u24 v142, 0x4100, v127
  v_and_b32_e64 v127, 1, v127
  v_lshl_add_u32 v142, v127, 5, v142
  v_and_b32_e64 v127, 1, v33
  v_mul_u32_u24 v127, 0x790, v127
  v_add3_u32 v4, v142, v127, v129
  v_lshl_add_u32 v34, v151, 1, 0
  v_add_u32_e64 v33, 1, v34
  v_add_u32 v129, 0xc0, v129
  v_add_u32 v129, v129, v159
  v_lshrrev_b32 v127, 1, v33
  v_mul_u32_u24 v142, 0x4100, v127
  v_and_b32_e64 v127, 1, v127
  v_lshl_add_u32 v142, v127, 5, v142
  v_and_b32_e64 v127, 1, v33
  v_mul_u32_u24 v127, 0x790, v127
  v_add3_u32 v5, v142, v127, v129
  v_add_u32_e64 v33, 2, v34
  v_lshrrev_b32_e64 v127, 1, v33
  v_mul_u32_u24 v142, 0x4100, v127
  v_and_b32_e64 v127, 1, v127
  buffer_load_dwordx4 a[4:7], v203, s[64:67], s40 offen offset:128
  s_add_u32 s40, s40, 0x3000
  v_lshl_add_u32 v142, v127, 5, v142
  v_and_b32_e64 v127, 1, v33
  v_mul_u32_u24 v127, 0x790, v127
  v_add3_u32 v251, v142, v127, v129
  v_mul_u32_u24_e64 v127, 12, v113
  v_mul_u32_u24 v128, 0x180, v141
  v_add_u32_e64 v10, v127, v128
  v_and_b32 v159, 0xf0, v118
  s_sub_u32 s32, s3, 0xf40
  v_add_u32_e64 v10, s32, v10
  v_add_u32 v2, 0xf000, v159
  v_add_u32 v0, 0x10000, v118
  v_add_u32 v1, 0x20000, v118
  v_and_b32_e64 v127, 15, v113
  v_lshlrev_b32 v127, 7, v127
  v_mul_u32_u24 v128, 0x18000, v155
  s_sub_u32 s32, s3, 64
  v_add3_u32 v248, v127, v128, s32
  v_mul_u32_u24 v127, 0x5555, v153
  v_and_b32 v128, 2, v153
  v_lshlrev_b32 v128, 15, v128
  v_sub_u32_e64 v127, v127, v128
  v_add_u32 v250, 0x3e9a0000, v127
  s_add_u32 s32, s14, 0x16000
  v_lshl_add_u32 v142, v141, 8, s32
  v_mul_u32_u24 v127, 43, v123
  v_lshrrev_b32 v127, 8, v127
  buffer_load_dwordx4 a[8:11], v203, s[64:67], s40 offen
  v_mul_u32_u24 v127, 0x17f0, v127
  v_lshl_add_u32 v128, v123, 10, v142
  v_sub_u32 v244, v128, v127
  v_add_u32 v128, 32, v123
  v_mul_u32_u24 v127, 43, v128
  v_lshrrev_b32 v127, 8, v127
  v_mul_u32_u24 v127, 0x17f0, v127
  v_lshl_add_u32 v128, v128, 10, v142
  v_sub_u32 v245, v128, v127
  v_add_u32 v128, 64, v123
  v_mul_u32_u24 v127, 43, v128
  v_lshrrev_b32 v127, 8, v127
  v_mul_u32_u24 v127, 0x17f0, v127
  v_lshl_add_u32 v128, v128, 10, v142
  v_sub_u32_e64 v246, v128, v127
  v_bfe_u32 v127, v122, 2, 2
  v_xor_b32_e64 v127, v127, v141
  v_lshl_add_u32 v127, v127, 4, s32
  v_mul_u32_u24 v128, 0xc0, v122
  v_add_u32_e64 v247, v127, v128
  v_xor_b32 v252, 32, v247
  s_add_u32 s30, s15, 32
  s_add_u32 s31, s15, 0x4100
  s_sub_u32 s28, s59, 0x60000
  s_add_u32 s33, s15, 0x8200
  s_mov_b32 s23, 0x60000
  s_mov_b32 s26, 6
  buffer_load_dwordx4 a[12:15], v203, s[64:67], s40 offen offset:128
  buffer_load_dwordx4 a[16:19], v203, s[64:67], s41 offen
  buffer_load_dwordx4 a[20:23], v203, s[64:67], s41 offen offset:128
  s_waitcnt vmcnt(25)
  v_lshl_or_b32 v131, v131, 16, v131
  v_and_b32 v16, v56, v131
  v_and_b32 v17, v57, v131
  v_and_b32 v18, v58, v131
  v_and_b32 v19, v59, v131
  ds_write_b128 v144, v[16:19] offset:49920
  s_waitcnt vmcnt(24)
  v_lshl_or_b32 v132, v132, 16, v132
  v_and_b32 v20, v56, v132
  v_and_b32 v21, v57, v132
  v_and_b32 v22, v58, v132
  v_and_b32_e64 v23, v59, v132
  ds_write_b128 v145, v[20:23] offset:53120
  s_waitcnt vmcnt(23)
  v_and_b32 v24, v148, v133
  v_and_b32_e64 v25, v149, v133
  ds_write_b64 v147, v[24:25] offset:54784
  s_waitcnt vmcnt(22)
  v_and_b32 v26, v148, v134
  v_and_b32_e64 v27, v149, v134
  ds_write_b64 v147, v[26:27] offset:56832
  s_waitcnt vmcnt(21)
  v_and_b32 v28, v148, v135
  v_and_b32_e64 v29, v149, v135
  ds_write_b64 v147, v[28:29] offset:58880
  s_waitcnt vmcnt(20)
  v_lshlrev_b32 v139, 16, v139
  s_waitcnt vmcnt(19)
  v_lshlrev_b32 v140, 16, v140
  v_mul_f32 v140, v139, v140
  s_waitcnt vmcnt(18)
  v_lshlrev_b32 v136, 16, v136
  s_waitcnt vmcnt(17)
  v_lshlrev_b32 v137, 16, v137
  s_waitcnt vmcnt(16)
  v_lshlrev_b32 v138, 16, v138
  v_xor_b32 v143, 16, v143
  v_mul_f32 v136, 4.0, v136
  v_mul_f32 v137, 4.0, v137
  v_mul_f32 v138, 4.0, v138
  v_lshrrev_b32 v136, v143, v136
  v_lshrrev_b32 v137, v143, v137
  v_lshrrev_b32 v138, v143, v138
  v_mov_b32 v16, v140
  v_mov_b32 v17, v140
  v_mov_b32 v18, v140
  v_mov_b32 v19, v140
  ds_write_b128 v146, v[16:19] offset:61440
  s_waitcnt lgkmcnt(0)
  s_barrier
  ds_read_b128 a[96:99], v3
  ds_read2_b64 a[100:103], v11 offset0:0 offset1:8
  ds_read_b128 a[104:107], v3 offset:400
  ds_read2_b64 a[108:111], v11 offset0:32 offset1:40
  ds_read_b128 a[112:115], v3 offset:800
  ds_read2_b64 a[116:119], v11 offset0:64 offset1:72
  v_and_b32 v127, v216, v136
  v_and_b32 v128, v217, v136
  buffer_load_dwordx4 a[24:27], v203, s[64:67], s42 offen
  v_and_b32 v129, v218, v136
  v_and_b32 v142, v219, v136
  v_accvgpr_write_b32 a192, v127
  v_accvgpr_write_b32 a193, v128
  v_accvgpr_write_b32 a194, v129
  v_accvgpr_write_b32 a195, v142
  v_and_b32 v127, v220, v136
  v_and_b32 v128, v221, v136
  v_and_b32_e64 v129, v222, v136
  buffer_load_dwordx4 a[28:31], v203, s[64:67], s42 offen offset:128
  s_add_u32 s42, s42, 0x3000
  v_and_b32_e64 v142, v223, v136
  ds_read_b128 a[120:123], v3 offset:1200
  ds_read2_b64 a[124:127], v11 offset0:96 offset1:104
  ds_read_b128 a[128:131], v3 offset:1600
  ds_read2_b64 a[132:135], v11 offset0:128 offset1:136
  ds_read_b128 a[136:139], v3 offset:2000
  ds_read2_b64 a[140:143], v11 offset0:160 offset1:168
  v_accvgpr_write_b32 a196, v127
  v_accvgpr_write_b32 a197, v128
  buffer_load_dwordx4 a[32:35], v203, s[64:67], s42 offen
  v_accvgpr_write_b32 a198, v129
  v_accvgpr_write_b32 a199, v142
  v_and_b32 v127, v216, v137
  v_and_b32 v128, v217, v137
  v_and_b32_e64 v129, v218, v137
  v_and_b32 v142, v219, v137
  v_accvgpr_write_b32 a200, v127
  v_accvgpr_write_b32 a201, v128
  v_accvgpr_write_b32 a202, v129
  buffer_load_dwordx4 a[36:39], v203, s[64:67], s42 offen offset:128
  s_add_u32 s42, s42, s18
  v_accvgpr_write_b32 a203, v142
  ds_read_b128 a[144:147], v3 offset:2400
  ds_read2_b64 a[148:151], v11 offset0:192 offset1:200
  ds_read_b128 a[152:155], v3 offset:2800
  ds_read2_b64 a[156:159], v11 offset0:224 offset1:232
  ds_read_b128 a[160:163], v3 offset:3200
  ds_read2_b64 a[240:243], v205 offset0:0 offset1:8
  v_and_b32 v127, v220, v137
  v_and_b32 v128, v221, v137
  buffer_load_dwordx4 a[40:43], v203, s[64:67], s42 offen
  v_and_b32 v129, v222, v137
  v_and_b32 v142, v223, v137
  v_accvgpr_write_b32 a204, v127
  v_accvgpr_write_b32 a205, v128
  v_accvgpr_write_b32 a206, v129
  v_accvgpr_write_b32 a207, v142
  v_and_b32 v127, v216, v138
  v_and_b32 v128, v217, v138
  v_and_b32_e64 v129, v218, v138
  buffer_load_dwordx4 a[44:47], v203, s[64:67], s42 offen offset:128
  s_add_u32 s42, s42, 0x3000
  v_and_b32_e64 v142, v219, v138
  ds_read_b128 a[164:167], v3 offset:3600
  ds_read2_b64 a[244:247], v205 offset0:32 offset1:40
  ds_read_b128 a[168:171], v3 offset:4000
  ds_read2_b64 a[248:251], v205 offset0:64 offset1:72
  ds_read_b128 a[172:175], v3 offset:4400
  ds_read2_b64 a[252:255], v205 offset0:96 offset1:104
  v_accvgpr_write_b32 a208, v127
  v_accvgpr_write_b32 a209, v128
  buffer_load_dwordx4 a[48:51], v203, s[64:67], s42 offen
  v_accvgpr_write_b32 a210, v129
  v_accvgpr_write_b32 a211, v142
  v_and_b32_e64 v127, v220, v138
  v_and_b32_e64 v128, v221, v138
  v_and_b32_e64 v129, v222, v138
  v_and_b32_e64 v142, v223, v138
  v_accvgpr_write_b32 a212, v127
  v_accvgpr_write_b32 a213, v128
  v_accvgpr_write_b32 a214, v129
  buffer_load_dwordx4 a[52:55], v203, s[64:67], s42 offen offset:128
  s_sub_u32 s42, s42, s18
  v_accvgpr_write_b32 a215, v142
  s_waitcnt vmcnt(19)
  v_mfma_f32_32x32x16_bf16 v[16:31], a[72:75], v[184:187], 0
  buffer_load_dwordx4 a[56:59], v203, s[64:67], s42 offen
  s_waitcnt vmcnt(19)
  v_mfma_f32_32x32x16_bf16 v[16:31], a[76:79], v[188:191], v[16:31]
  s_waitcnt vmcnt(18)
  v_mfma_f32_32x32x16_bf16 v[32:47], a[80:83], v[184:187], 0
  buffer_load_dwordx4 a[60:63], v203, s[64:67], s42 offen offset:128
  s_add_u32 s42, s42, 0x3000
  s_waitcnt vmcnt(15)
  v_mfma_f32_32x32x16_bf16 v[48:63], a[0:3], v[224:227], v[16:31]
  s_nop 0
  buffer_load_dwordx4 a[64:67], v203, s[64:67], s42 offen
  v_mfma_f32_32x32x16_bf16 v[32:47], a[84:87], v[188:191], v[32:47]
  s_waitcnt vmcnt(15)
  v_mfma_f32_32x32x16_bf16 v[48:63], a[4:7], v[228:231], v[48:63]
  s_nop 0
  buffer_load_dwordx4 a[68:71], v203, s[64:67], s42 offen offset:128
  s_waitcnt vmcnt(15)
  v_mfma_f32_32x32x16_bf16 v[160:175], a[8:11], v[224:227], v[16:31]
  s_add_u32 m0, s15, 0x8200
  s_nop 0
  buffer_load_dwordx4 v6, s[4:7], s49 offen lds
  s_waitcnt vmcnt(15)
  v_mfma_f32_32x32x16_bf16 v[160:175], a[12:15], v[228:231], v[160:175]
  buffer_load_dwordx4 v7, s[4:7], s49 offen offset:1024 lds
  s_nop 2
  v_cvt_pk_bf16_f32 v64, v48, v52
  v_cvt_pk_bf16_f32 v65, v56, v60
  v_cvt_pk_bf16_f32 v68, v49, v53
  v_cvt_pk_bf16_f32 v69, v57, v61
  v_max3_f32 v180, |v48|, |v52|, |v56|
  v_max_f32_e64 v180, |v60|, v180
  v_max3_f32 v180, |v49|, |v53|, v180
  v_max3_f32 v180, |v57|, |v61|, v180
  s_waitcnt vmcnt(15)
  v_mfma_f32_32x32x16_bf16 v[96:111], a[16:19], v[224:227], v[16:31]
  s_nop 0
  buffer_load_dwordx4 v8, s[4:7], s49 offen offset:2048 lds
  v_cvt_pk_bf16_f32 v72, v50, v54
  v_cvt_pk_bf16_f32 v73, v58, v62
  v_cvt_pk_bf16_f32 v76, v51, v55
  v_cvt_pk_bf16_f32 v77, v59, v63
  v_max3_f32 v180, |v50|, |v54|, v180
  v_max3_f32 v180, |v58|, |v62|, v180
  v_max3_f32 v180, |v51|, |v55|, v180
  v_max3_f32 v180, |v59|, |v63|, v180
  s_waitcnt vmcnt(15)
  v_mfma_f32_32x32x16_bf16 v[96:111], a[20:23], v[228:231], v[96:111]
  s_nop 0
  buffer_load_dwordx4 v9, s[4:7], s49 offen offset:3072 lds
  v_cvt_pk_bf16_f32 v66, v160, v164
  v_cvt_pk_bf16_f32 v67, v168, v172
  v_cvt_pk_bf16_f32 v70, v161, v165
  v_cvt_pk_bf16_f32 v71, v169, v173
  v_max3_f32 v180, |v160|, |v164|, v180
  v_max3_f32 v180, |v168|, |v172|, v180
  v_max3_f32 v180, |v161|, |v165|, v180
  v_max3_f32 v180, |v169|, |v173|, v180
  ds_write_b128 v195, v[64:67]
  s_nop 0
  s_waitcnt vmcnt(15)
  v_mfma_f32_32x32x16_bf16 v[48:63], a[24:27], v[224:227], v[32:47]
  s_add_u32 m0, s15, 0
  s_nop 0
  buffer_load_dwordx4 v198, s[4:7], 0 offen lds
  ds_write_b128 v195, v[68:71] offset:6144
  v_cvt_pk_bf16_f32 v74, v162, v166
  v_cvt_pk_bf16_f32 v75, v170, v174
  v_cvt_pk_bf16_f32 v78, v163, v167
  v_cvt_pk_bf16_f32 v79, v171, v175
  v_max3_f32 v180, |v162|, |v166|, v180
  v_max3_f32 v180, |v170|, |v174|, v180
  v_max3_f32 v180, |v163|, |v167|, v180
  v_max3_f32 v180, |v171|, |v175|, v180
  s_waitcnt vmcnt(15)
  v_mfma_f32_32x32x16_bf16 v[48:63], a[28:31], v[228:231], v[48:63]
  s_add_u32 m0, s15, 0x400
  s_nop 0
  buffer_load_dwordx4 v199, s[4:7], 0 offen lds
  ds_write_b128 v195, v[72:75] offset:12288
  v_cvt_pk_bf16_f32 v80, v96, v100
  v_cvt_pk_bf16_f32 v81, v104, v108
  v_cvt_pk_bf16_f32 v84, v97, v101
  v_cvt_pk_bf16_f32 v85, v105, v109
  v_max3_f32 v180, |v96|, |v100|, v180
  v_max3_f32 v180, |v104|, |v108|, v180
  v_max3_f32 v180, |v97|, |v101|, v180
  v_max3_f32 v180, |v105|, |v109|, v180
  s_waitcnt vmcnt(15)
  v_mfma_f32_32x32x16_bf16 v[160:175], a[32:35], v[224:227], v[32:47]
  s_add_u32 m0, s15, 0x800
  s_nop 0
  buffer_load_dwordx4 v200, s[4:7], 0 offen lds
  ds_write_b128 v195, v[76:79] offset:18432
  v_cvt_pk_bf16_f32 v88, v98, v102
  v_cvt_pk_bf16_f32 v89, v106, v110
  v_cvt_pk_bf16_f32 v92, v99, v103
  v_cvt_pk_bf16_f32 v93, v107, v111
  v_max3_f32 v180, |v98|, |v102|, v180
  v_max3_f32 v180, |v106|, |v110|, v180
  v_max3_f32 v180, |v99|, |v103|, v180
  v_max3_f32 v180, |v107|, |v111|, v180
  s_waitcnt vmcnt(15)
  v_mfma_f32_32x32x16_bf16 v[160:175], a[36:39], v[228:231], v[160:175]
  s_add_u32 m0, s15, 0xc00
  s_nop 0
  buffer_load_dwordx4 v201, s[4:7], 0 offen lds
  ds_write_b64 v196, v[80:81]
  ds_write_b64 v196, v[84:85] offset:6144
  v_cvt_pk_bf16_f32 v64, v48, v52
  v_cvt_pk_bf16_f32 v65, v56, v60
  v_cvt_pk_bf16_f32 v68, v49, v53
  v_cvt_pk_bf16_f32 v69, v57, v61
  v_max3_f32 v176, |v48|, |v52|, |v56|
  v_max_f32_e64 v176, |v60|, v176
  v_max3_f32 v177, |v49|, |v53|, |v57|
  v_max_f32_e64 v177, |v61|, v177
  s_waitcnt vmcnt(15)
  v_mfma_f32_32x32x16_bf16 v[96:111], a[40:43], v[224:227], v[32:47]
  s_add_u32 m0, s14, 0x22000
  s_nop 0
  buffer_load_dwordx4 v253, s[72:75], s57 offen lds
  ds_write_b64 v196, v[88:89] offset:12288
  ds_write_b64 v196, v[92:93] offset:18432
  v_cvt_pk_bf16_f32 v72, v50, v54
  v_cvt_pk_bf16_f32 v73, v58, v62
  v_cvt_pk_bf16_f32 v76, v51, v55
  v_cvt_pk_bf16_f32 v77, v59, v63
  v_max3_f32 v178, |v50|, |v54|, |v58|
  v_max_f32_e64 v178, |v62|, v178
  v_max3_f32 v179, |v51|, |v55|, |v59|
  v_max_f32_e64 v179, |v63|, v179
  s_waitcnt vmcnt(15)
  v_mfma_f32_32x32x16_bf16 v[96:111], a[44:47], v[228:231], v[96:111]
  s_nop 0
  buffer_load_dwordx4 v254, s[72:75], s57 offen offset:1024 lds
  v_cvt_pk_bf16_f32 v66, v160, v164
  v_cvt_pk_bf16_f32 v67, v168, v172
  v_cvt_pk_bf16_f32 v70, v161, v165
  v_cvt_pk_bf16_f32 v71, v169, v173
  v_max3_f32 v176, |v160|, |v164|, v176
  v_max3_f32 v176, |v168|, |v172|, v176
  v_max3_f32 v177, |v161|, |v165|, v177
  v_max3_f32 v177, |v169|, |v173|, v177
  ds_write_b128 v197, v[64:67]
  s_waitcnt vmcnt(15)
  v_mfma_f32_32x32x16_bf16 v[48:63], a[48:51], v[224:227], v[32:47]
  s_nop 0
  buffer_load_dwordx4 v255, s[72:75], s57 offen offset:2048 lds
  ds_write_b128 v197, v[68:71] offset:6144
  v_cvt_pk_bf16_f32 v74, v162, v166
  v_cvt_pk_bf16_f32 v75, v170, v174
  v_cvt_pk_bf16_f32 v78, v163, v167
  v_cvt_pk_bf16_f32 v79, v171, v175
  v_max3_f32 v178, |v162|, |v166|, v178
  v_max3_f32 v178, |v170|, |v174|, v178
  v_max3_f32 v179, |v163|, |v167|, v179
  v_max3_f32 v179, |v171|, |v175|, v179
  s_waitcnt vmcnt(15)
  v_mfma_f32_32x32x16_bf16 v[48:63], a[52:55], v[228:231], v[48:63]
  s_add_u32 m0, s14, 0x22c00
  s_nop 0
  buffer_load_dwordx4 v253, s[72:75], s58 offen lds
  ds_write_b128 v197, v[72:75] offset:12288
  v_cvt_pk_bf16_f32 v80, v96, v100
  v_cvt_pk_bf16_f32 v81, v104, v108
  v_cvt_pk_bf16_f32 v84, v97, v101
  v_cvt_pk_bf16_f32 v85, v105, v109
  v_max3_f32 v176, |v96|, |v100|, v176
  v_max3_f32 v176, |v104|, |v108|, v176
  v_max3_f32 v177, |v97|, |v101|, v177
  v_max3_f32 v177, |v105|, |v109|, v177
  s_waitcnt vmcnt(15)
  v_mfma_f32_32x32x16_bf16 v[160:175], a[56:59], v[224:227], v[32:47]
  s_nop 0
  buffer_load_dwordx4 v254, s[72:75], s58 offen offset:1024 lds
  ds_write_b128 v197, v[76:79] offset:18432
  v_cvt_pk_bf16_f32 v88, v98, v102
  v_cvt_pk_bf16_f32 v89, v106, v110
  v_cvt_pk_bf16_f32 v92, v99, v103
  v_cvt_pk_bf16_f32 v93, v107, v111
  v_max3_f32 v178, |v98|, |v102|, v178
  v_max3_f32 v178, |v106|, |v110|, v178
  v_max3_f32 v179, |v99|, |v103|, v179
  v_max3_f32 v179, |v107|, |v111|, v179
  v_mfma_f32_32x32x16_bf16 v[96:111], a[88:91], v[224:227], v[32:47]
  s_waitcnt vmcnt(15)
  v_mfma_f32_32x32x16_bf16 v[160:175], a[60:63], v[228:231], v[160:175]
  s_nop 0
  buffer_load_dwordx4 v255, s[72:75], s58 offen offset:2048 lds
  v_cvt_pk_bf16_f32 v82, v48, v52
  v_cvt_pk_bf16_f32 v83, v56, v60
  v_cvt_pk_bf16_f32 v86, v49, v53
  v_cvt_pk_bf16_f32 v87, v57, v61
  v_max3_f32 v176, |v48|, |v52|, v176
  v_max3_f32 v176, |v56|, |v60|, v176
  v_max3_f32 v177, |v49|, |v53|, v177
  v_max3_f32 v177, |v57|, |v61|, v177
  ds_write_b128 v197, v[80:83] offset:512
  v_mfma_f32_32x32x16_bf16 v[96:111], a[92:95], v[228:231], v[96:111]
  s_waitcnt vmcnt(15)
  v_mfma_f32_32x32x16_bf16 v[96:111], a[64:67], v[224:227], v[96:111]
  s_nop 0
  ds_write_b128 v197, v[84:87] offset:6656
  v_cvt_pk_bf16_f32 v90, v50, v54
  v_cvt_pk_bf16_f32 v91, v58, v62
  v_cvt_pk_bf16_f32 v94, v51, v55
  v_cvt_pk_bf16_f32 v95, v59, v63
  v_max3_f32 v178, |v50|, |v54|, v178
  v_max3_f32 v178, |v58|, |v62|, v178
  v_max3_f32 v179, |v51|, |v55|, v179
  v_max3_f32 v179, |v59|, |v63|, v179
  s_waitcnt vmcnt(14)
  v_mfma_f32_32x32x16_bf16 v[96:111], a[68:71], v[228:231], v[96:111]
  s_nop 0
  ds_write_b128 v197, v[88:91] offset:12800
  v_cvt_pk_bf16_f32 v64, v160, v164
  v_cvt_pk_bf16_f32 v65, v168, v172
  v_cvt_pk_bf16_f32 v68, v161, v165
  v_cvt_pk_bf16_f32 v69, v169, v173
  v_max3_f32 v176, |v160|, |v164|, v176
  v_max3_f32 v176, |v168|, |v172|, v176
  v_max3_f32 v177, |v161|, |v165|, v177
  v_max3_f32 v177, |v169|, |v173|, v177
  ds_write_b128 v197, v[92:95] offset:18944
  v_cvt_pk_bf16_f32 v72, v162, v166
  v_cvt_pk_bf16_f32 v73, v170, v174
  v_cvt_pk_bf16_f32 v76, v163, v167
  v_cvt_pk_bf16_f32 v77, v171, v175
  v_max3_f32 v178, |v162|, |v166|, v178
  v_max3_f32 v178, |v170|, |v174|, v178
  v_max3_f32 v179, |v163|, |v167|, v179
  v_max3_f32 v179, |v171|, |v175|, v179
  v_cvt_pk_bf16_f32 v66, v96, v100
  v_cvt_pk_bf16_f32 v67, v104, v108
  v_cvt_pk_bf16_f32 v70, v97, v101
  v_cvt_pk_bf16_f32 v71, v105, v109
  v_max3_f32 v176, |v96|, |v100|, v176
  v_max3_f32 v176, |v104|, |v108|, v176
  v_max3_f32 v177, |v97|, |v101|, v177
  v_max3_f32 v177, |v105|, |v109|, v177
  ds_write_b128 v197, v[64:67] offset:1024
  ds_write_b128 v197, v[68:71] offset:7168
  v_cvt_pk_bf16_f32 v74, v98, v102
  v_cvt_pk_bf16_f32 v75, v106, v110
  v_cvt_pk_bf16_f32 v78, v99, v103
  v_cvt_pk_bf16_f32 v79, v107, v111
  v_max3_f32 v178, |v98|, |v102|, v178
  v_max3_f32 v178, |v106|, |v110|, v178
  v_max3_f32 v179, |v99|, |v103|, v179
  v_max3_f32 v179, |v107|, |v111|, v179
  ds_write_b128 v197, v[72:75] offset:13312
  ds_write_b128 v197, v[76:79] offset:19456
  buffer_load_dword v249, v248, s[4:7], s29 offen
  s_waitcnt lgkmcnt(0)
  s_barrier
  v_max3_f32 v180, v180, v176, v177
  v_min3_f32 v176, v176, v177, v178
  v_max3_f32 v180, v180, v178, v179
  v_min_f32_e64 v176, v176, v179
  v_cmp_le_u32 vcc, 0x43800000, v180
  s_nop 0
  s_cmp_lg_u64 vcc, 0
  s_cselect_b32 s3, 1, 0
  v_cmp_gt_u32 vcc, 0x3a000000, v176
  s_nop 0
  s_cmp_lg_u64 vcc, 0
  s_cselect_b32 s3, 1, s3
  ds_read_b128 a[0:3], v0 offset:24576
  ds_read_b128 a[4:7], v0 offset:27648
  ds_read_b128 a[8:11], v0 offset:25600
  ds_read_b128 a[12:15], v0 offset:28672
  ds_read_b128 a[16:19], v0 offset:26624
  ds_read_b128 a[20:23], v0 offset:29696
  ds_read_b128 a[24:27], v0 offset:30720
  ds_read_b128 a[28:31], v0 offset:33792
  ds_read_b128 a[32:35], v0 offset:31744
  ds_read_b128 a[36:39], v0 offset:34816
  ds_read_b128 a[40:43], v0 offset:32768
  ds_read_b128 a[44:47], v0 offset:35840
  ds_read_b128 a[48:51], v0 offset:36864
  ds_read_b128 a[52:55], v0 offset:39936
  ds_read_b128 a[56:59], v0 offset:37888
  ds_read_b128 a[60:63], v0 offset:40960
  ds_read_b128 a[64:67], v0 offset:38912
  ds_read_b128 a[68:71], v0 offset:41984
  ds_read_b128 a[72:75], v0 offset:43008
  ds_read_b128 a[76:79], v0 offset:46080
  ds_read_b128 a[80:83], v0 offset:44032
  ds_read_b128 a[84:87], v0 offset:47104
  ds_read_b128 a[88:91], v0 offset:45056
  ds_read_b128 a[92:95], v0 offset:48128
  s_nop 0
  s_waitcnt vmcnt(7)
  ds_read_b128 v[160:163], v4
  ds_read_b128 v[164:167], v4 offset:192
  ds_read_b128 v[168:171], v4 offset:384
  ds_read_b128 v[172:175], v4 offset:16
  ds_read_b128 v[176:179], v4 offset:208
  ds_read_b128 v[180:183], v4 offset:400
  ds_read_b128 v[216:219], v4 offset:32
  ds_read_b128 v[220:223], v4 offset:224
  ds_read_b128 v[224:227], v4 offset:416
  ds_read_b128 v[228:231], v4 offset:48
  ds_read_b128 v[232:235], v4 offset:240
  ds_read_b128 v[236:239], v4 offset:432
  s_waitcnt lgkmcnt(11)
  v_mfma_f32_16x16x32_bf16 v[112:115], a[96:99], v[160:163], 0
  ds_read_b128 v[160:163], v4 offset:64
  s_waitcnt lgkmcnt(9)
  v_mfma_f32_16x16x32_bf16 v[116:119], a[104:107], v[172:175], 0
  s_waitcnt lgkmcnt(0)
  ds_read_b128 v[172:175], v4 offset:80
  s_nop 0
  v_smfmac_f32_16x16x64_bf16 v[112:115], a[100:103], v[164:171], v250
  ds_read_b128 v[164:167], v4 offset:256
  ds_read_b128 v[168:171], v4 offset:448
  v_mfma_f32_16x16x32_bf16 v[120:123], a[112:115], v[216:219], 0
  s_waitcnt lgkmcnt(2)
  ds_read_b128 v[216:219], v4 offset:96
  v_smfmac_f32_16x16x64_bf16 v[116:119], a[108:111], v[176:183], v250
  ds_read_b128 v[176:179], v4 offset:272
  ds_read_b128 v[180:183], v4 offset:464
  v_mfma_f32_16x16x32_bf16 v[124:127], a[120:123], v[228:231], 0
  s_waitcnt lgkmcnt(2)
  ds_read_b128 v[228:231], v4 offset:112
  v_smfmac_f32_16x16x64_bf16 v[120:123], a[116:119], v[220:227], v250
  ds_read_b128 v[220:223], v4 offset:288
  ds_read_b128 v[224:227], v4 offset:480
  v_mfma_f32_16x16x32_bf16 v[128:131], a[128:131], v[160:163], 0
  s_waitcnt lgkmcnt(2)
  ds_read_b128 v[160:163], v4 offset:128
  v_smfmac_f32_16x16x64_bf16 v[124:127], a[124:127], v[232:239], v250
  ds_read_b128 v[232:235], v4 offset:304
  ds_read_b128 v[236:239], v4 offset:496
  v_mfma_f32_16x16x32_bf16 v[132:135], a[136:139], v[172:175], 0
  s_waitcnt lgkmcnt(2)
  ds_read_b128 v[172:175], v4 offset:144
  v_smfmac_f32_16x16x64_bf16 v[128:131], a[132:135], v[164:171], v250
  ds_read_b128 v[164:167], v4 offset:320
  ds_read_b128 v[168:171], v4 offset:512
  v_mfma_f32_16x16x32_bf16 v[136:139], a[144:147], v[216:219], 0
  s_waitcnt lgkmcnt(2)
  ds_read_b128 v[216:219], v4 offset:160
  v_smfmac_f32_16x16x64_bf16 v[132:135], a[140:143], v[176:183], v250
  s_nop 0
  ds_read_b128 v[176:179], v4 offset:336
  ds_read_b128 v[180:183], v4 offset:528
  v_mfma_f32_16x16x32_bf16 v[140:143], a[152:155], v[228:231], 0
  s_waitcnt lgkmcnt(2)
  ds_read_b128 v[228:231], v4 offset:176
  v_smfmac_f32_16x16x64_bf16 v[136:139], a[148:151], v[220:227], v250
  ds_read_b128 v[220:223], v4 offset:352
  ds_read_b128 v[224:227], v4 offset:544
  v_mfma_f32_16x16x32_bf16 v[144:147], a[160:163], v[160:163], 0
  s_waitcnt lgkmcnt(2)
  v_smfmac_f32_16x16x64_bf16 v[140:143], a[156:159], v[232:239], v250
  ds_read_b128 v[232:235], v4 offset:368
  ds_read_b128 v[236:239], v4 offset:560
  v_mfma_f32_16x16x32_bf16 v[148:151], a[164:167], v[172:175], 0
  s_nop 0
  v_smfmac_f32_16x16x64_bf16 v[144:147], a[240:243], v[164:171], v250
  v_mfma_f32_16x16x32_bf16 v[152:155], a[168:171], v[216:219], 0
  s_nop 2
  v_smfmac_f32_16x16x64_bf16 v[148:151], a[244:247], v[176:183], v250
  s_nop 0
  v_mfma_f32_16x16x32_bf16 v[156:159], a[172:175], v[228:231], 0
  s_waitcnt lgkmcnt(2)
  v_smfmac_f32_16x16x64_bf16 v[152:155], a[248:251], v[220:227], v250
  s_waitcnt lgkmcnt(0)
  s_nop 2
  v_smfmac_f32_16x16x64_bf16 v[156:159], a[252:255], v[232:239], v250
  v_pk_mul_f32 v[14:15], v[112:113], v[112:113]
  v_pk_mul_f32 v[182:183], v[114:115], v[114:115]
  v_pk_add_f32 v[12:13], v[112:113], v[116:117]
  v_pk_fma_f32 v[14:15], v[116:117], v[116:117], v[14:15]
  v_pk_add_f32 v[180:181], v[114:115], v[118:119]
  v_pk_fma_f32 v[182:183], v[118:119], v[118:119], v[182:183]
  v_pk_add_f32 v[12:13], v[12:13], v[120:121]
  v_pk_fma_f32 v[14:15], v[120:121], v[120:121], v[14:15]
  v_pk_add_f32 v[180:181], v[180:181], v[122:123]
  v_pk_fma_f32 v[182:183], v[122:123], v[122:123], v[182:183]
  v_pk_add_f32 v[12:13], v[12:13], v[124:125]
  v_pk_fma_f32 v[14:15], v[124:125], v[124:125], v[14:15]
  ds_read_b128 v[160:163], v0 offset:18432
  ds_read_b128 v[164:167], v0 offset:21504
  ds_read_b128 v[168:171], v0 offset:19456
  ds_read_b128 v[172:175], v0 offset:22528
  v_pk_add_f32 v[180:181], v[180:181], v[126:127]
  v_pk_fma_f32 v[182:183], v[126:127], v[126:127], v[182:183]
  v_pk_add_f32 v[12:13], v[12:13], v[128:129]
  v_pk_fma_f32 v[14:15], v[128:129], v[128:129], v[14:15]
  v_pk_add_f32 v[180:181], v[180:181], v[130:131]
  v_pk_fma_f32 v[182:183], v[130:131], v[130:131], v[182:183]
  v_pk_add_f32 v[12:13], v[12:13], v[132:133]
  v_pk_fma_f32 v[14:15], v[132:133], v[132:133], v[14:15]
  v_pk_add_f32 v[180:181], v[180:181], v[134:135]
  v_pk_fma_f32 v[182:183], v[134:135], v[134:135], v[182:183]
  v_pk_add_f32 v[12:13], v[12:13], v[136:137]
  v_pk_fma_f32 v[14:15], v[136:137], v[136:137], v[14:15]
  ds_read_b128 v[176:179], v0 offset:20480
  ds_read_b128 a[96:99], v0 offset:49152
  ds_read_b128 a[100:103], v0 offset:52224
  ds_read_b128 a[104:107], v0 offset:50176
  v_pk_add_f32 v[180:181], v[180:181], v[138:139]
  v_pk_fma_f32 v[182:183], v[138:139], v[138:139], v[182:183]
  v_pk_add_f32 v[12:13], v[12:13], v[140:141]
  v_pk_fma_f32 v[14:15], v[140:141], v[140:141], v[14:15]
  v_pk_add_f32 v[180:181], v[180:181], v[142:143]
  v_pk_fma_f32 v[182:183], v[142:143], v[142:143], v[182:183]
  v_pk_add_f32 v[12:13], v[12:13], v[144:145]
  v_pk_fma_f32 v[14:15], v[144:145], v[144:145], v[14:15]
  v_pk_add_f32 v[180:181], v[180:181], v[146:147]
  v_pk_fma_f32 v[182:183], v[146:147], v[146:147], v[182:183]
  v_pk_add_f32 v[12:13], v[12:13], v[148:149]
  v_pk_fma_f32 v[14:15], v[148:149], v[148:149], v[14:15]
  ds_read_b128 a[108:111], v0 offset:53248
  ds_read_b128 a[112:115], v0 offset:51200
  ds_read_b128 a[116:119], v0 offset:54272
  ds_read_b128 a[120:123], v0 offset:55296
  v_pk_add_f32 v[180:181], v[180:181], v[150:151]
  v_pk_fma_f32 v[182:183], v[150:151], v[150:151], v[182:183]
  v_pk_add_f32 v[12:13], v[12:13], v[152:153]
  v_pk_fma_f32 v[14:15], v[152:153], v[152:153], v[14:15]
  v_pk_add_f32 v[180:181], v[180:181], v[154:155]
  v_pk_fma_f32 v[182:183], v[154:155], v[154:155], v[182:183]
  v_pk_add_f32 v[12:13], v[12:13], v[156:157]
  v_pk_fma_f32 v[14:15], v[156:157], v[156:157], v[14:15]
  v_pk_add_f32 v[180:181], v[180:181], v[158:159]
  v_pk_fma_f32 v[182:183], v[158:159], v[158:159], v[182:183]
  v_add_f32 v12, v12, v13
  v_add_f32 v14, v14, v15
  ds_read_b128 a[124:127], v0 offset:58368
  ds_read_b128 a[128:131], v0 offset:56320
  ds_read_b128 a[132:135], v0 offset:59392
  ds_read_b128 a[136:139], v0 offset:57344
  v_add_f32 v180, v180, v181
  v_add_f32 v182, v182, v183
  v_permlane32_swap_b32 v12, v14
  s_nop 0
  v_permlane32_swap_b32 v180, v182
  v_add_f32 v12, v12, v14
  v_add_f32 v180, v180, v182
  s_nop 1
  v_permlane16_swap_b32 v12, v180
  v_add_f32 v12, v12, v180
  v_mov_b32 v14, v12
  s_nop 1
  v_permlane32_swap_b32 v12, v14
  v_mul_f32 v12, s24, v12
  v_mul_f32_e64 v13, s24, v14
  ds_read_b128 a[140:143], v0 offset:60416
  ds_read_b128 a[144:147], v0 offset:61440
  ds_read_b128 a[148:151], v0 offset:64512
  ds_read_b128 a[152:155], v0 offset:62464
  v_fma_f32 v13, -v12, v12, v13
  v_max_f32 v13, 0, v13
  v_add_f32 v13, s25, v13
  v_rsq_f32 v13, v13
  s_nop 0
  v_mul_f32_e64 v14, s22, v13
  v_mul_f32_e64 v12, -v12, v14
  v_mov_b32 v182, v14
  v_mov_b32 v180, v12
  s_nop 0
  v_permlane16_swap_b32 v14, v182
  v_permlane16_swap_b32_e64 v12, v180
  v_pk_fma_f32 v[112:113], v[112:113], v[14:15], v[12:13] op_sel_hi:[1,0,0]
  v_pk_fma_f32 v[114:115], v[114:115], v[182:183], v[180:181] op_sel_hi:[1,0,0]
  ds_read_b128 a[156:159], v1
  ds_read_b128 a[160:163], v0 offset:63488
  ds_read_b128 a[164:167], v1 offset:1024
  ds_read_b128 a[168:171], v1 offset:2048
  v_pk_fma_f32 v[116:117], v[116:117], v[14:15], v[12:13] op_sel_hi:[1,0,0]
  v_pk_fma_f32 v[118:119], v[118:119], v[182:183], v[180:181] op_sel_hi:[1,0,0]
  v_pk_fma_f32 v[120:121], v[120:121], v[14:15], v[12:13] op_sel_hi:[1,0,0]
  v_pk_fma_f32 v[122:123], v[122:123], v[182:183], v[180:181] op_sel_hi:[1,0,0]
  v_pk_fma_f32 v[124:125], v[124:125], v[14:15], v[12:13] op_sel_hi:[1,0,0]
  v_pk_fma_f32 v[126:127], v[126:127], v[182:183], v[180:181] op_sel_hi:[1,0,0]
  v_pk_fma_f32 v[128:129], v[128:129], v[14:15], v[12:13] op_sel_hi:[1,0,0]
  v_pk_fma_f32 v[130:131], v[130:131], v[182:183], v[180:181] op_sel_hi:[1,0,0]
  v_pk_fma_f32 v[132:133], v[132:133], v[14:15], v[12:13] op_sel_hi:[1,0,0]
  v_pk_fma_f32 v[134:135], v[134:135], v[182:183], v[180:181] op_sel_hi:[1,0,0]
  v_pk_fma_f32 v[136:137], v[136:137], v[14:15], v[12:13] op_sel_hi:[1,0,0]
  v_pk_fma_f32 v[138:139], v[138:139], v[182:183], v[180:181] op_sel_hi:[1,0,0]
  ds_read_b128 a[172:175], v1 offset:5120
  ds_read_b128 a[176:179], v1 offset:3072
  ds_read_b128 a[180:183], v1 offset:6144
  ds_read_b128 a[184:187], v1 offset:4096
  v_pk_fma_f32 v[140:141], v[140:141], v[14:15], v[12:13] op_sel_hi:[1,0,0]
  v_pk_fma_f32 v[142:143], v[142:143], v[182:183], v[180:181] op_sel_hi:[1,0,0]
  v_pk_fma_f32 v[144:145], v[144:145], v[14:15], v[12:13] op_sel_hi:[1,0,0]
  v_pk_fma_f32 v[146:147], v[146:147], v[182:183], v[180:181] op_sel_hi:[1,0,0]
  v_pk_fma_f32 v[148:149], v[148:149], v[14:15], v[12:13] op_sel_hi:[1,0,0]
  v_pk_fma_f32 v[150:151], v[150:151], v[182:183], v[180:181] op_sel_hi:[1,0,0]
  v_pk_fma_f32 v[152:153], v[152:153], v[14:15], v[12:13] op_sel_hi:[1,0,0]
  v_pk_fma_f32 v[154:155], v[154:155], v[182:183], v[180:181] op_sel_hi:[1,0,0]
  v_pk_fma_f32 v[156:157], v[156:157], v[14:15], v[12:13] op_sel_hi:[1,0,0]
  v_pk_fma_f32 v[158:159], v[158:159], v[182:183], v[180:181] op_sel_hi:[1,0,0]
  v_cndmask_b32 v157, v157, v250, s[12:13]
  v_cndmask_b32 v159, v159, v250, s[12:13]
  ds_read_b128 a[188:191], v1 offset:7168
  s_nop 0
  s_waitcnt vmcnt(1)
  ds_read_b128 a[216:219], v247 offset:49152
  ds_read_b128 a[220:223], v252 offset:49152
  v_cvt_pk_bf16_f32 v216, v112, v113
  v_cvt_pk_bf16_f32 v217, v116, v117
  v_cvt_pk_bf16_f32 v218, v120, v121
  v_cvt_pk_bf16_f32 v219, v124, v125
  v_cvt_pk_bf16_f32 v220, v114, v115
  v_cvt_pk_bf16_f32 v221, v118, v119
  v_cvt_pk_bf16_f32 v222, v122, v123
  v_cvt_pk_bf16_f32 v223, v126, v127
  v_cvt_pk_bf16_f32 v224, v128, v129
  v_cvt_pk_bf16_f32 v225, v132, v133
  v_cvt_pk_bf16_f32 v226, v136, v137
  v_cvt_pk_bf16_f32 v227, v140, v141
  ds_read_b128 a[224:227], v247 offset:49216
  ds_read_b128 a[228:231], v252 offset:49216
  ds_read_b128 a[232:235], v247 offset:49280
  ds_read_b128 a[236:239], v252 offset:49280
  v_cvt_pk_bf16_f32 v228, v130, v131
  v_cvt_pk_bf16_f32 v229, v134, v135
  v_cvt_pk_bf16_f32 v230, v138, v139
  v_cvt_pk_bf16_f32 v231, v142, v143
  v_cvt_pk_bf16_f32 v232, v144, v145
  v_cvt_pk_bf16_f32 v233, v148, v149
  v_cvt_pk_bf16_f32 v234, v152, v153
  v_cvt_pk_bf16_f32 v235, v156, v157
  v_cvt_pk_bf16_f32 v236, v146, v147
  v_cvt_pk_bf16_f32 v237, v150, v151
  v_cvt_pk_bf16_f32 v238, v154, v155
  v_cvt_pk_bf16_f32 v239, v158, v159
  ds_read_b128 v[180:183], v0 offset:23552
  s_waitcnt lgkmcnt(6)
  v_mfma_f32_32x32x16_bf16 v[64:79], a[216:219], a[192:195], 0
  s_add_u32 s59, s28, 0x18000
  ds_read_b128 v[112:115], v5
  ds_read_b128 v[116:119], v5 offset:16
  v_lshlrev_b32 v32, 16, v240
  v_lshlrev_b32_e64 v33, 16, v241
  v_lshlrev_b32_e64 v34, 16, v242
  v_lshlrev_b32 v35, 16, v243
  s_waitcnt lgkmcnt(7)
  v_mfma_f32_32x32x16_bf16 v[64:79], a[220:223], a[196:199], v[64:79]
  s_add_u32 s57, s28, 0x30000
  ds_read_b128 v[120:123], v5 offset:32
  ds_read_b128 v[124:127], v251
  s_nop 0
  s_waitcnt lgkmcnt(8)
  v_mfma_f32_32x32x16_bf16 v[80:95], a[224:227], a[200:203], 0
  s_add_u32 s15, s28, 0x48000
  ds_read_b128 v[128:131], v251 offset:16
  ds_read_b128 v[132:135], v251 offset:32
  v_subrev_u32 v14, 0x4100, v5
  v_add_u32 v5, 0x8200, v5
  v_min_u32 v5, v14, v5
  v_subrev_u32 v14, 0x4100, v251
  s_waitcnt lgkmcnt(9)
  v_mfma_f32_32x32x16_bf16 v[80:95], a[228:231], a[204:207], v[80:95]
  s_add_u32 m0, s14, 0x16000
  v_add_u32 v251, 0x8200, v251
  v_min_u32_e64 v251, v14, v251
  v_cvt_pk_f16_f32 v64, v64, v65
  v_cvt_pk_f16_f32 v65, v66, v67
  v_cvt_pk_f16_f32 v66, v68, v69
  v_cvt_pk_f16_f32 v67, v70, v71
  s_waitcnt lgkmcnt(8)
  v_mfma_f32_32x32x16_bf16 v[96:111], a[232:235], a[208:211], 0
  s_nop 0
  v_pk_mul_f16 v64, v64, s21 op_sel:[0,1]
  v_pk_mul_f16 v65, v65, s21 op_sel:[0,1]
  v_pk_mul_f16 v66, v66, s21 op_sel:[0,1]
  v_pk_mul_f16 v67, v67, s21 op_sel:[0,1]
  v_cvt_pk_f16_f32 v68, v72, v73
  v_cvt_pk_f16_f32 v69, v74, v75
  s_waitcnt lgkmcnt(7)
  v_mfma_f32_32x32x16_bf16 v[96:111], a[236:239], a[212:215], v[96:111]
  s_nop 0
  ds_write_b128 v244, v[64:67] offset:49152
  v_cvt_pk_f16_f32 v70, v76, v77
  v_mfma_f32_16x16x32_bf16 v[16:19], v[160:163], v[216:219], 0
  v_cvt_pk_f16_f32 v71, v78, v79
  v_pk_mul_f16 v68, v68, s21 op_sel:[0,1]
  v_pk_mul_f16 v69, v69, s21 op_sel:[0,1]
  v_pk_mul_f16 v70, v70, s21 op_sel:[0,1]
  v_mfma_f32_16x16x32_bf16 v[24:27], v[160:163], v[220:223], 0
  v_pk_mul_f16 v71, v71, s21 op_sel:[0,1]
  v_cvt_pk_f16_f32 v80, v80, v81
  v_cvt_pk_f16_f32 v81, v82, v83
  v_cvt_pk_f16_f32 v82, v84, v85
  v_mfma_f32_16x16x32_bf16 v[20:23], v[164:167], v[216:219], 0
  ds_write_b128 v244, v[68:71] offset:49664
  v_mfma_f32_16x16x32_bf16 v[28:31], v[164:167], v[220:223], 0
  v_cvt_pk_f16_f32 v83, v86, v87
  v_pk_mul_f16 v80, v80, s21 op_sel:[0,1]
  v_pk_mul_f16 v81, v81, s21 op_sel:[0,1]
  v_pk_mul_f16 v82, v82, s21 op_sel:[0,1]
  v_mfma_f32_16x16x32_bf16 v[16:19], v[168:171], v[224:227], v[16:19]
  v_pk_mul_f16 v83, v83, s21 op_sel:[0,1]
  v_cvt_pk_f16_f32 v84, v88, v89
  v_cvt_pk_f16_f32 v85, v90, v91
  v_cvt_pk_f16_f32 v86, v92, v93
  v_mfma_f32_16x16x32_bf16 v[24:27], v[168:171], v[228:231], v[24:27]
  ds_write_b128 v245, v[80:83] offset:49152
  v_mfma_f32_16x16x32_bf16 v[20:23], v[172:175], v[224:227], v[20:23]
  v_cvt_pk_f16_f32 v87, v94, v95
  v_pk_mul_f16 v84, v84, s21 op_sel:[0,1]
  v_pk_mul_f16 v85, v85, s21 op_sel:[0,1]
  v_pk_mul_f16 v86, v86, s21 op_sel:[0,1]
  v_mfma_f32_16x16x32_bf16 v[28:31], v[172:175], v[228:231], v[28:31]
  v_pk_mul_f16 v87, v87, s21 op_sel:[0,1]
  v_cvt_pk_f16_f32 v96, v96, v97
  v_cvt_pk_f16_f32 v97, v98, v99
  v_cvt_pk_f16_f32 v98, v100, v101
  v_mfma_f32_16x16x32_bf16 v[16:19], v[176:179], v[232:235], v[16:19]
  ds_write_b128 v245, v[84:87] offset:49664
  v_mfma_f32_16x16x32_bf16 v[24:27], v[176:179], v[236:239], v[24:27]
  v_cvt_pk_f16_f32 v99, v102, v103
  v_pk_mul_f16 v96, v96, s21 op_sel:[0,1]
  v_pk_mul_f16 v97, v97, s21 op_sel:[0,1]
  v_pk_mul_f16 v98, v98, s21 op_sel:[0,1]
  v_pk_mul_f16 v99, v99, s21 op_sel:[0,1]
  s_waitcnt lgkmcnt(10)
  v_mfma_f32_16x16x32_bf16 v[20:23], v[180:183], v[232:235], v[20:23]
  s_nop 0
  ds_write_b128 v246, v[96:99] offset:49152
  v_cvt_pk_f16_f32 v100, v104, v105
  v_cvt_pk_f16_f32 v101, v106, v107
  v_cvt_pk_f16_f32 v102, v108, v109
  v_cvt_pk_f16_f32 v103, v110, v111
  v_pk_mul_f16 v100, v100, s21 op_sel:[0,1]
  v_pk_mul_f16 v101, v101, s21 op_sel:[0,1]
  v_pk_mul_f16 v102, v102, s21 op_sel:[0,1]
  v_pk_mul_f16 v103, v103, s21 op_sel:[0,1]
  v_mfma_f32_16x16x32_bf16 v[28:31], v[180:183], v[236:239], v[28:31]
  ds_write_b128 v246, v[100:103] offset:49664
  v_cvt_pk_f16_f32 v48, v16, v17
  v_cvt_pk_f16_f32 v49, v18, v19
  v_cvt_pk_f16_f32 v50, v20, v21
  v_cvt_pk_f16_f32 v51, v22, v23
  v_cvt_pk_f16_f32 v52, v24, v25
  v_cvt_pk_f16_f32 v53, v26, v27
  s_nop 0
  v_cvt_pk_f16_f32 v54, v28, v29
  v_cvt_pk_f16_f32 v55, v30, v31
  s_waitcnt lgkmcnt(0)
  s_barrier
  v_mfma_f32_16x16x32_bf16 v[16:19], a[0:3], v[216:219], 0
  s_nop 0
  ds_read_b128 v[160:163], v2
  ds_read_b128 v[164:167], v2 offset:256
  v_pk_fma_f16 v56, v48, v48, s20 op_sel_hi:[1,1,0] neg_lo:[1,0,0] neg_hi:[1,0,0] clamp
  v_pk_fma_f16 v57, v49, v49, s20 op_sel_hi:[1,1,0] neg_lo:[1,0,0] neg_hi:[1,0,0] clamp
  v_mfma_f32_16x16x32_bf16 v[24:27], a[0:3], v[220:223], 0
  ds_read_b128 v[192:195], v1 offset:8192
  ds_read_b128 v[196:199], v1 offset:9216
  v_pk_fma_f16 v58, v50, v50, s20 op_sel_hi:[1,1,0] neg_lo:[1,0,0] neg_hi:[1,0,0] clamp
  v_pk_fma_f16 v59, v51, v51, s20 op_sel_hi:[1,1,0] neg_lo:[1,0,0] neg_hi:[1,0,0] clamp
  v_mfma_f32_16x16x32_bf16 v[20:23], a[4:7], v[216:219], 0
  ds_read_b128 v[168:171], v2 offset:512
  ds_read_b128 v[172:175], v2 offset:768
  v_pk_fma_f16 v184, v56, v56, s20 op_sel:[0,0,1]
  v_pk_fma_f16 v185, v57, v57, s20 op_sel:[0,0,1]
  v_mfma_f32_16x16x32_bf16 v[28:31], a[4:7], v[220:223], 0
  ds_read_b128 v[200:203], v1 offset:10240
  ds_read_b128 v[204:207], v1 offset:11264
  v_pk_fma_f16 v186, v58, v58, s20 op_sel:[0,0,1]
  v_pk_fma_f16 v187, v59, v59, s20 op_sel:[0,0,1]
  v_mfma_f32_16x16x32_bf16 v[16:19], a[8:11], v[224:227], v[16:19]
  v_pk_fma_f16 v184, v184, v56, s21 op_sel_hi:[1,1,0]
  v_pk_fma_f16 v185, v185, v57, s21 op_sel_hi:[1,1,0]
  v_or_b32_e64 v12, v64, v65
  v_or3_b32 v12, v66, v67, v12
  v_mfma_f32_16x16x32_bf16 v[24:27], a[8:11], v[228:231], v[24:27]
  buffer_load_dwordx4 v253, s[72:75], s53 offen lds
  buffer_load_dwordx4 v254, s[72:75], s53 offen offset:1024 lds
  buffer_load_dwordx4 v255, s[72:75], s53 offen offset:2048 lds
  v_pk_fma_f16 v186, v186, v58, s21 op_sel_hi:[1,1,0]
  v_pk_fma_f16 v187, v187, v59, s21 op_sel_hi:[1,1,0]
  v_mfma_f32_16x16x32_bf16 v[20:23], a[12:15], v[224:227], v[20:23]
  s_add_u32 m0, s14, 0x16c00
  v_pk_fma_f16 v184, v184, v48, 0.5 op_sel_hi:[1,1,0] clamp
  v_pk_fma_f16 v185, v185, v49, 0.5 op_sel_hi:[1,1,0] clamp
  v_or3_b32 v12, v68, v69, v12
  v_or3_b32 v12, v70, v71, v12
  v_mfma_f32_16x16x32_bf16 v[28:31], a[12:15], v[228:231], v[28:31]
  ds_read_b128 v[176:179], v2 offset:1024
  ds_read_b128 v[180:183], v2 offset:1280
  v_pk_fma_f16 v186, v186, v50, 0.5 op_sel_hi:[1,1,0] clamp
  v_pk_fma_f16 v187, v187, v51, 0.5 op_sel_hi:[1,1,0] clamp
  v_mfma_f32_16x16x32_bf16 v[16:19], a[16:19], v[232:235], v[16:19]
  ds_read_b128 v[208:211], v1 offset:12288
  ds_read_b128 v[212:215], v1 offset:13312
  v_pk_mul_f16 v184, v184, v48
  v_pk_mul_f16 v185, v185, v49
  v_mfma_f32_16x16x32_bf16 v[24:27], a[16:19], v[236:239], v[24:27]
  buffer_load_dwordx4 v253, s[72:75], s54 offen lds
  buffer_load_dwordx4 v254, s[72:75], s54 offen offset:1024 lds
  buffer_load_dwordx4 v255, s[72:75], s54 offen offset:2048 lds
  v_pk_mul_f16 v186, v186, v50
  v_pk_mul_f16 v187, v187, v51
  v_mfma_f32_16x16x32_bf16 v[20:23], a[20:23], v[232:235], v[20:23]
  s_mov_b32 m0, s30
  v_pk_fma_f16 v56, v52, v52, s20 op_sel_hi:[1,1,0] neg_lo:[1,0,0] neg_hi:[1,0,0] clamp
  v_pk_fma_f16 v57, v53, v53, s20 op_sel_hi:[1,1,0] neg_lo:[1,0,0] neg_hi:[1,0,0] clamp
  v_mov_b32 v136, v112
  v_mov_b32 v140, v113
  v_mfma_f32_16x16x32_bf16 v[28:31], a[20:23], v[236:239], v[28:31]
  s_waitcnt lgkmcnt(4)
  v_pk_fma_f16 v58, v54, v54, s20 op_sel_hi:[1,1,0] neg_lo:[1,0,0] neg_hi:[1,0,0] clamp
  v_pk_fma_f16 v59, v55, v55, s20 op_sel_hi:[1,1,0] neg_lo:[1,0,0] neg_hi:[1,0,0] clamp
  v_mov_b32 v144, v114
  v_mov_b32 v137, v115
  v_mfma_f32_16x16x32_f16 v[64:67], v[184:187], v[192:195], v[160:163]
  v_pk_fma_f16 v188, v56, v56, s20 op_sel:[0,0,1]
  v_pk_fma_f16 v189, v57, v57, s20 op_sel:[0,0,1]
  v_mov_b32 v141, v116
  v_mov_b32 v145, v117
  v_mfma_f32_16x16x32_f16 v[68:71], v[184:187], v[196:199], v[164:167]
  buffer_load_dwordx4 v6, s[4:7], s29 offen lds
  buffer_load_dwordx4 v7, s[4:7], s29 offen offset:1024 lds
  buffer_load_dwordx4 v8, s[4:7], s29 offen offset:2048 lds
  buffer_load_dwordx4 v9, s[4:7], s29 offen offset:3072 lds
  v_pk_fma_f16 v190, v58, v58, s20 op_sel:[0,0,1]
  v_pk_fma_f16 v191, v59, v59, s20 op_sel:[0,0,1]
  v_mfma_f32_16x16x32_f16 v[72:75], v[184:187], v[200:203], v[168:171]
  s_mov_b32 m0, s31
  v_mov_b32 v138, v118
  v_mov_b32 v142, v119
  v_mov_b32 v146, v120
  v_mov_b32 v139, v121
  v_mov_b32 v143, v122
  v_mov_b32 v147, v123
  v_mov_b32 v148, v124
  v_mov_b32 v152, v125
  v_mov_b32 v156, v126
  v_mov_b32 v149, v127
  v_mov_b32 v153, v128
  v_mov_b32 v157, v129
  v_mov_b32 v150, v130
  v_mov_b32 v154, v131
  v_mov_b32 v158, v132
  v_mov_b32 v151, v133
  v_mov_b32 v155, v134
  v_mov_b32 v159, v135
  v_pk_fma_f16 v188, v188, v56, s21 op_sel_hi:[1,1,0]
  v_pk_fma_f16 v189, v189, v57, s21 op_sel_hi:[1,1,0]
  v_mfma_f32_16x16x32_f16 v[76:79], v[184:187], v[204:207], v[172:175]
  s_cmp_eq_u32 s26, 1
  v_pk_fma_f16 v190, v190, v58, s21 op_sel_hi:[1,1,0]
  v_pk_fma_f16 v191, v191, v59, s21 op_sel_hi:[1,1,0]
  v_or3_b32 v12, v80, v81, v12
  v_or3_b32 v12, v82, v83, v12
  v_mfma_f32_16x16x32_bf16 v[64:67], v[136:139], v[240:243], v[64:67]
  s_cselect_b32 s35, 0x40000000, s23
  v_pk_fma_f16 v188, v188, v52, 0.5 op_sel_hi:[1,1,0] clamp
  v_pk_fma_f16 v189, v189, v53, 0.5 op_sel_hi:[1,1,0] clamp
  v_or3_b32 v12, v84, v85, v12
  v_or3_b32 v12, v86, v87, v12
  v_mfma_f32_16x16x32_bf16 v[68:71], v[136:139], v[32:35], v[68:71]
  s_waitcnt lgkmcnt(0)
  v_pk_fma_f16 v190, v190, v54, 0.5 op_sel_hi:[1,1,0] clamp
  v_pk_fma_f16 v191, v191, v55, 0.5 op_sel_hi:[1,1,0] clamp
  v_or3_b32 v12, v96, v97, v12
  v_or3_b32 v12, v98, v99, v12
  v_mfma_f32_16x16x32_f16 v[80:83], v[184:187], v[208:211], v[176:179]
  s_add_u32 s29, s29, s35
  v_pk_mul_f16 v188, v188, v52
  v_pk_mul_f16 v189, v189, v53
  v_or3_b32 v12, v100, v101, v12
  v_or3_b32 v12, v102, v103, v12
  v_mfma_f32_16x16x32_f16 v[84:87], v[184:187], v[212:215], v[180:183]
  s_nop 0
  v_pk_mul_f16 v190, v190, v54
  v_pk_mul_f16 v191, v191, v55
  v_subrev_u32 v14, 0x4100, v4
  v_add_u32 v4, 0x8200, v4
  v_mfma_f32_16x16x32_bf16 v[72:75], v[140:143], v[240:243], v[72:75]
  v_min_u32_e64 v4, v14, v4
  v_cvt_pk_f16_f32 v48, v16, v17
  v_mfma_f32_16x16x32_bf16 v[76:79], v[140:143], v[32:35], v[76:79]
  v_cvt_pk_f16_f32 v49, v18, v19
  v_cvt_pk_f16_f32 v50, v20, v21
  v_mfma_f32_16x16x32_f16 v[88:91], v[188:191], v[192:195], v[160:163]
  ds_read_b128 v[192:195], v1 offset:14336
  v_cvt_pk_f16_f32 v51, v22, v23
  v_mfma_f32_16x16x32_f16 v[92:95], v[188:191], v[196:199], v[164:167]
  ds_read_b128 v[196:199], v1 offset:15360
  v_cvt_pk_f16_f32 v52, v24, v25
  v_mfma_f32_16x16x32_bf16 v[80:83], v[144:147], v[240:243], v[80:83]
  v_cvt_pk_f16_f32 v53, v26, v27
  v_cvt_pk_f16_f32 v54, v28, v29
  v_mfma_f32_16x16x32_bf16 v[84:87], v[144:147], v[32:35], v[84:87]
  v_cvt_pk_f16_f32 v55, v30, v31
  v_pk_fma_f16 v56, v48, v48, s20 op_sel_hi:[1,1,0] neg_lo:[1,0,0] neg_hi:[1,0,0] clamp
  v_mfma_f32_16x16x32_f16 v[96:99], v[188:191], v[200:203], v[168:171]
  ds_read_b128 v[200:203], v1 offset:16384
  v_pk_fma_f16 v57, v49, v49, s20 op_sel_hi:[1,1,0] neg_lo:[1,0,0] neg_hi:[1,0,0] clamp
  v_mfma_f32_16x16x32_f16 v[100:103], v[188:191], v[204:207], v[172:175]
  buffer_load_dwordx4 v6, s[4:7], s52 offen lds
  buffer_load_dwordx4 v7, s[4:7], s52 offen offset:1024 lds
  buffer_load_dwordx4 v8, s[4:7], s52 offen offset:2048 lds
  buffer_load_dwordx4 v9, s[4:7], s52 offen offset:3072 lds
  v_mfma_f32_16x16x32_bf16 v[88:91], v[148:151], v[240:243], v[88:91]
  s_add_u32 m0, s14, 0x1c000
  ds_read_b128 v[204:207], v1 offset:17408
  v_pk_fma_f16 v58, v50, v50, s20 op_sel_hi:[1,1,0] neg_lo:[1,0,0] neg_hi:[1,0,0] clamp
  v_mfma_f32_16x16x32_bf16 v[92:95], v[148:151], v[32:35], v[92:95]
  v_pk_fma_f16 v59, v51, v51, s20 op_sel_hi:[1,1,0] neg_lo:[1,0,0] neg_hi:[1,0,0] clamp
  v_pk_fma_f16 v184, v56, v56, s20 op_sel:[0,0,1]
  v_mfma_f32_16x16x32_f16 v[104:107], v[188:191], v[208:211], v[176:179]
  ds_read_b128 v[208:211], v1 offset:18432
  v_pk_fma_f16 v185, v57, v57, s20 op_sel:[0,0,1]
  v_mfma_f32_16x16x32_f16 v[108:111], v[188:191], v[212:215], v[180:183]
  ds_read_b128 v[212:215], v1 offset:19456
  ds_read_b128 v[160:163], v3 offset:2400
  ds_read2_b64 v[176:179], v11 offset0:192 offset1:200
  v_mfma_f32_16x16x32_bf16 v[16:19], a[24:27], v[216:219], 0
  v_pk_fma_f16 v186, v58, v58, s20 op_sel:[0,0,1]
  v_pk_fma_f16 v187, v59, v59, s20 op_sel:[0,0,1]
  v_mfma_f32_16x16x32_bf16 v[24:27], a[24:27], v[220:223], 0
  v_pk_fma_f16 v184, v184, v56, s21 op_sel_hi:[1,1,0]
  v_pk_fma_f16 v185, v185, v57, s21 op_sel_hi:[1,1,0]
  v_mfma_f32_16x16x32_bf16 v[20:23], a[28:31], v[216:219], 0
  v_pk_fma_f16 v186, v186, v58, s21 op_sel_hi:[1,1,0]
  v_pk_fma_f16 v187, v187, v59, s21 op_sel_hi:[1,1,0]
  v_mfma_f32_16x16x32_bf16 v[28:31], a[28:31], v[220:223], 0
  buffer_load_dwordx4 v253, s[72:75], s55 offen lds
  buffer_load_dwordx4 v254, s[72:75], s55 offen offset:1024 lds
  buffer_load_dwordx4 v255, s[72:75], s55 offen offset:2048 lds
  v_mfma_f32_16x16x32_bf16 v[96:99], v[152:155], v[240:243], v[96:99]
  s_add_u32 m0, s14, 0x1cc00
  v_pk_fma_f16 v184, v184, v48, 0.5 op_sel_hi:[1,1,0] clamp
  v_pk_fma_f16 v185, v185, v49, 0.5 op_sel_hi:[1,1,0] clamp
  v_mfma_f32_16x16x32_bf16 v[100:103], v[152:155], v[32:35], v[100:103]
  v_pk_fma_f16 v186, v186, v50, 0.5 op_sel_hi:[1,1,0] clamp
  v_pk_fma_f16 v187, v187, v51, 0.5 op_sel_hi:[1,1,0] clamp
  v_mfma_f32_16x16x32_bf16 v[16:19], a[32:35], v[224:227], v[16:19]
  v_pk_mul_f16 v184, v184, v48
  v_pk_mul_f16 v185, v185, v49
  v_mfma_f32_16x16x32_bf16 v[24:27], a[32:35], v[228:231], v[24:27]
  v_pk_mul_f16 v186, v186, v50
  v_pk_mul_f16 v187, v187, v51
  v_mfma_f32_16x16x32_bf16 v[104:107], v[156:159], v[240:243], v[104:107]
  v_pk_fma_f16 v56, v52, v52, s20 op_sel_hi:[1,1,0] neg_lo:[1,0,0] neg_hi:[1,0,0] clamp
  v_pk_fma_f16 v57, v53, v53, s20 op_sel_hi:[1,1,0] neg_lo:[1,0,0] neg_hi:[1,0,0] clamp
  v_mfma_f32_16x16x32_bf16 v[108:111], v[156:159], v[32:35], v[108:111]
  v_pk_fma_f16 v58, v54, v54, s20 op_sel_hi:[1,1,0] neg_lo:[1,0,0] neg_hi:[1,0,0] clamp
  v_pk_fma_f16 v59, v55, v55, s20 op_sel_hi:[1,1,0] neg_lo:[1,0,0] neg_hi:[1,0,0] clamp
  v_mfma_f32_16x16x32_bf16 v[20:23], a[36:39], v[224:227], v[20:23]
  v_pk_fma_f16 v188, v56, v56, s20 op_sel:[0,0,1]
  v_pk_fma_f16 v189, v57, v57, s20 op_sel:[0,0,1]
  v_mfma_f32_16x16x32_bf16 v[28:31], a[36:39], v[228:231], v[28:31]
  buffer_load_dwordx4 v253, s[72:75], s56 offen lds
  buffer_load_dwordx4 v254, s[72:75], s56 offen offset:1024 lds
  buffer_load_dwordx4 v255, s[72:75], s56 offen offset:2048 lds
  v_mfma_f32_16x16x32_bf16 v[16:19], a[40:43], v[232:235], v[16:19]
  s_add_u32 s52, s52, s35
  ds_read_b128 v[32:35], v0 offset:12288
  ds_read_b128 v[36:39], v0 offset:15360
  ds_read_b128 v[40:43], v0 offset:13312
  v_mfma_f32_16x16x32_bf16 v[24:27], a[40:43], v[236:239], v[24:27]
  s_mov_b32 s32, s30
  ds_read_b128 v[44:47], v0 offset:16384
  ds_read_b128 v[60:63], v0 offset:14336
  v_pk_fma_f16 v190, v58, v58, s20 op_sel:[0,0,1]
  v_pk_fma_f16 v191, v59, v59, s20 op_sel:[0,0,1]
  v_mfma_f32_16x16x32_bf16 v[20:23], a[44:47], v[232:235], v[20:23]
  s_add_u32 s30, s33, 32
  v_pk_fma_f16 v188, v188, v56, s21 op_sel_hi:[1,1,0]
  v_pk_fma_f16 v189, v189, v57, s21 op_sel_hi:[1,1,0]
  v_mfma_f32_16x16x32_bf16 v[28:31], a[44:47], v[236:239], v[28:31]
  s_waitcnt lgkmcnt(5)
  v_pk_fma_f16 v190, v190, v58, s21 op_sel_hi:[1,1,0]
  v_pk_fma_f16 v191, v191, v59, s21 op_sel_hi:[1,1,0]
  v_mfma_f32_16x16x32_f16 v[64:67], v[184:187], v[192:195], v[64:67]
  s_mov_b32 s33, s31
  v_pk_fma_f16 v188, v188, v52, 0.5 op_sel_hi:[1,1,0] clamp
  v_pk_fma_f16 v189, v189, v53, 0.5 op_sel_hi:[1,1,0] clamp
  v_mfma_f32_16x16x32_f16 v[68:71], v[184:187], v[196:199], v[68:71]
  s_sub_u32 s31, s32, 32
  v_pk_fma_f16 v190, v190, v54, 0.5 op_sel_hi:[1,1,0] clamp
  v_pk_fma_f16 v191, v191, v55, 0.5 op_sel_hi:[1,1,0] clamp
  v_mfma_f32_16x16x32_f16 v[72:75], v[184:187], v[200:203], v[72:75]
  v_pk_mul_f16 v188, v188, v52
  v_pk_mul_f16 v189, v189, v53
  v_mfma_f32_16x16x32_f16 v[76:79], v[184:187], v[204:207], v[76:79]
  v_pk_mul_f16 v190, v190, v54
  v_pk_mul_f16 v191, v191, v55
  v_mfma_f32_16x16x32_f16 v[80:83], v[184:187], v[208:211], v[80:83]
  s_nop 0
  v_cvt_pk_f16_f32 v48, v16, v17
  v_cvt_pk_f16_f32 v49, v18, v19
  v_mfma_f32_16x16x32_f16 v[84:87], v[184:187], v[212:215], v[84:87]
  s_waitcnt vmcnt(14)
  ds_read_b128 a[216:219], v247
  ds_read_b128 a[220:223], v252
  ds_read_b128 a[224:227], v247 offset:64
  v_mfma_f32_16x16x32_f16 v[88:91], v[188:191], v[192:195], v[88:91]
  ds_read_b128 a[228:231], v252 offset:64
  ds_read_b128 a[232:235], v247 offset:128
  ds_read_b128 a[236:239], v252 offset:128
  v_mfma_f32_16x16x32_f16 v[92:95], v[188:191], v[196:199], v[92:95]
  ds_read_b128 v[192:195], v1 offset:20480
  ds_read_b128 v[196:199], v1 offset:21504
  v_mfma_f32_16x16x32_f16 v[96:99], v[188:191], v[200:203], v[96:99]
  ds_read_b128 v[200:203], v1 offset:22528
  v_cvt_pk_f16_f32 v50, v20, v21
  v_mfma_f32_16x16x32_f16 v[100:103], v[188:191], v[204:207], v[100:103]
  ds_read_b128 v[204:207], v1 offset:23552
  v_cvt_pk_f16_f32 v51, v22, v23
  v_mfma_f32_16x16x32_f16 v[104:107], v[188:191], v[208:211], v[104:107]
  ds_read_b128 v[208:211], v1 offset:24576
  v_cvt_pk_f16_f32 v52, v24, v25
  v_mfma_f32_16x16x32_f16 v[108:111], v[188:191], v[212:215], v[108:111]
  s_waitcnt lgkmcnt(10)
  ds_read_b128 v[212:215], v1 offset:25600
  v_cvt_pk_f16_f32 v53, v26, v27
  v_mfma_f32_32x32x16_bf16 v[112:127], a[216:219], a[192:195], 0
  s_waitcnt lgkmcnt(10)
  v_cvt_pk_f16_f32 v54, v28, v29
  v_cvt_pk_f16_f32 v55, v30, v31
  v_pk_fma_f16 v56, v48, v48, s20 op_sel_hi:[1,1,0] neg_lo:[1,0,0] neg_hi:[1,0,0] clamp
  v_pk_fma_f16 v57, v49, v49, s20 op_sel_hi:[1,1,0] neg_lo:[1,0,0] neg_hi:[1,0,0] clamp
  v_pk_fma_f16 v58, v50, v50, s20 op_sel_hi:[1,1,0] neg_lo:[1,0,0] neg_hi:[1,0,0] clamp
  v_pk_fma_f16 v59, v51, v51, s20 op_sel_hi:[1,1,0] neg_lo:[1,0,0] neg_hi:[1,0,0] clamp
  v_mfma_f32_32x32x16_bf16 v[112:127], a[220:223], a[196:199], v[112:127]
  s_nop 0
  s_waitcnt lgkmcnt(6)
  v_pk_fma_f16 v184, v56, v56, s20 op_sel:[0,0,1]
  v_pk_fma_f16 v185, v57, v57, s20 op_sel:[0,0,1]
  v_pk_fma_f16 v186, v58, v58, s20 op_sel:[0,0,1]
  v_pk_fma_f16 v187, v59, v59, s20 op_sel:[0,0,1]
  v_pk_fma_f16 v184, v184, v56, s21 op_sel_hi:[1,1,0]
  v_pk_fma_f16 v185, v185, v57, s21 op_sel_hi:[1,1,0]
  v_mfma_f32_32x32x16_bf16 v[128:143], a[224:227], a[200:203], 0
  v_pk_fma_f16 v186, v186, v58, s21 op_sel_hi:[1,1,0]
  v_pk_fma_f16 v187, v187, v59, s21 op_sel_hi:[1,1,0]
  v_pk_fma_f16 v184, v184, v48, 0.5 op_sel_hi:[1,1,0] clamp
  v_pk_fma_f16 v185, v185, v49, 0.5 op_sel_hi:[1,1,0] clamp
  v_pk_fma_f16 v186, v186, v50, 0.5 op_sel_hi:[1,1,0] clamp
  v_cvt_pk_f16_f32 v112, v112, v113
  v_mfma_f32_32x32x16_bf16 v[128:143], a[228:231], a[204:207], v[128:143]
  v_cvt_pk_f16_f32 v113, v114, v115
  v_cvt_pk_f16_f32 v114, v116, v117
  v_cvt_pk_f16_f32 v115, v118, v119
  v_pk_mul_f16 v112, v112, s21 op_sel:[0,1]
  v_pk_mul_f16 v113, v113, s21 op_sel:[0,1]
  v_pk_mul_f16 v114, v114, s21 op_sel:[0,1]
  v_mfma_f32_32x32x16_bf16 v[144:159], a[232:235], a[208:211], 0
  v_pk_mul_f16 v115, v115, s21 op_sel:[0,1]
  v_cvt_pk_f16_f32 v116, v120, v121
  v_cvt_pk_f16_f32 v117, v122, v123
  v_cvt_pk_f16_f32 v118, v124, v125
  v_cvt_pk_f16_f32 v119, v126, v127
  v_pk_mul_f16 v116, v116, s21 op_sel:[0,1]
  v_mfma_f32_32x32x16_bf16 v[144:159], a[236:239], a[212:215], v[144:159]
  v_pk_mul_f16 v117, v117, s21 op_sel:[0,1]
  v_pk_mul_f16 v118, v118, s21 op_sel:[0,1]
  v_pk_mul_f16 v119, v119, s21 op_sel:[0,1]
  v_or3_b32 v12, v112, v113, v12
  v_or3_b32 v12, v114, v115, v12
  v_or3_b32 v12, v116, v117, v12
  v_mfma_f32_16x16x32_bf16 v[16:19], a[48:51], v[216:219], 0
  ds_write_b128 v244, v[112:115]
  v_mfma_f32_16x16x32_bf16 v[24:27], a[48:51], v[220:223], 0
  v_or3_b32 v12, v118, v119, v12
  v_cvt_pk_f16_f32 v128, v128, v129
  v_cvt_pk_f16_f32 v129, v130, v131
  v_cvt_pk_f16_f32 v130, v132, v133
  v_mfma_f32_16x16x32_bf16 v[20:23], a[52:55], v[216:219], 0
  ds_write_b128 v244, v[116:119] offset:512
  v_mfma_f32_16x16x32_bf16 v[28:31], a[52:55], v[220:223], 0
  v_pk_fma_f16 v187, v187, v51, 0.5 op_sel_hi:[1,1,0] clamp
  v_cvt_pk_f16_f32 v131, v134, v135
  v_pk_mul_f16 v128, v128, s21 op_sel:[0,1]
  v_pk_mul_f16 v129, v129, s21 op_sel:[0,1]
  v_mfma_f32_16x16x32_bf16 v[16:19], a[56:59], v[224:227], v[16:19]
  v_pk_mul_f16 v184, v184, v48
  v_pk_mul_f16 v185, v185, v49
  v_pk_mul_f16 v130, v130, s21 op_sel:[0,1]
  v_pk_mul_f16 v131, v131, s21 op_sel:[0,1]
  v_mfma_f32_16x16x32_bf16 v[24:27], a[56:59], v[228:231], v[24:27]
  ds_write_b128 v245, v[128:131]
  v_pk_mul_f16 v186, v186, v50
  v_pk_mul_f16 v187, v187, v51
  v_cvt_pk_f16_f32 v132, v136, v137
  v_cvt_pk_f16_f32 v133, v138, v139
  v_mfma_f32_16x16x32_bf16 v[20:23], a[60:63], v[224:227], v[20:23]
  v_pk_fma_f16 v56, v52, v52, s20 op_sel_hi:[1,1,0] neg_lo:[1,0,0] neg_hi:[1,0,0] clamp
  v_pk_fma_f16 v57, v53, v53, s20 op_sel_hi:[1,1,0] neg_lo:[1,0,0] neg_hi:[1,0,0] clamp
  v_cvt_pk_f16_f32 v134, v140, v141
  v_cvt_pk_f16_f32 v135, v142, v143
  v_mfma_f32_16x16x32_bf16 v[28:31], a[60:63], v[228:231], v[28:31]
  v_pk_fma_f16 v58, v54, v54, s20 op_sel_hi:[1,1,0] neg_lo:[1,0,0] neg_hi:[1,0,0] clamp
  v_pk_fma_f16 v59, v55, v55, s20 op_sel_hi:[1,1,0] neg_lo:[1,0,0] neg_hi:[1,0,0] clamp
  v_pk_mul_f16 v132, v132, s21 op_sel:[0,1]
  v_pk_mul_f16 v133, v133, s21 op_sel:[0,1]
  v_mfma_f32_16x16x32_bf16 v[16:19], a[64:67], v[232:235], v[16:19]
  v_pk_fma_f16 v188, v56, v56, s20 op_sel:[0,0,1]
  v_pk_fma_f16 v189, v57, v57, s20 op_sel:[0,0,1]
  v_pk_mul_f16 v134, v134, s21 op_sel:[0,1]
  v_pk_mul_f16 v135, v135, s21 op_sel:[0,1]
  v_mfma_f32_16x16x32_bf16 v[24:27], a[64:67], v[236:239], v[24:27]
  ds_write_b128 v245, v[132:135] offset:512
  v_pk_fma_f16 v190, v58, v58, s20 op_sel:[0,0,1]
  v_pk_fma_f16 v191, v59, v59, s20 op_sel:[0,0,1]
  v_mfma_f32_16x16x32_bf16 v[20:23], a[68:71], v[232:235], v[20:23]
  v_pk_fma_f16 v188, v188, v56, s21 op_sel_hi:[1,1,0]
  v_pk_fma_f16 v189, v189, v57, s21 op_sel_hi:[1,1,0]
  v_or3_b32 v12, v128, v129, v12
  v_or3_b32 v12, v130, v131, v12
  v_mfma_f32_16x16x32_bf16 v[28:31], a[68:71], v[236:239], v[28:31]
  s_waitcnt lgkmcnt(4)
  v_pk_fma_f16 v190, v190, v58, s21 op_sel_hi:[1,1,0]
  v_pk_fma_f16 v191, v191, v59, s21 op_sel_hi:[1,1,0]
  v_or3_b32 v12, v132, v133, v12
  v_or3_b32 v12, v134, v135, v12
  v_mfma_f32_16x16x32_f16 v[64:67], v[184:187], v[192:195], v[64:67]
  s_nop 0
  v_pk_fma_f16 v188, v188, v52, 0.5 op_sel_hi:[1,1,0] clamp
  v_pk_fma_f16 v189, v189, v53, 0.5 op_sel_hi:[1,1,0] clamp
  v_cvt_pk_f16_f32 v144, v144, v145
  v_cvt_pk_f16_f32 v145, v146, v147
  v_mfma_f32_16x16x32_f16 v[68:71], v[184:187], v[196:199], v[68:71]
  v_pk_fma_f16 v190, v190, v54, 0.5 op_sel_hi:[1,1,0] clamp
  v_pk_fma_f16 v191, v191, v55, 0.5 op_sel_hi:[1,1,0] clamp
  v_cvt_pk_f16_f32 v146, v148, v149
  v_cvt_pk_f16_f32 v147, v150, v151
  v_mfma_f32_16x16x32_f16 v[72:75], v[184:187], v[200:203], v[72:75]
  v_pk_mul_f16 v188, v188, v52
  v_pk_mul_f16 v189, v189, v53
  v_pk_mul_f16 v144, v144, s21 op_sel:[0,1]
  v_pk_mul_f16 v145, v145, s21 op_sel:[0,1]
  v_mfma_f32_16x16x32_f16 v[76:79], v[184:187], v[204:207], v[76:79]
  v_pk_mul_f16 v190, v190, v54
  v_pk_mul_f16 v191, v191, v55
  v_pk_mul_f16 v146, v146, s21 op_sel:[0,1]
  v_pk_mul_f16 v147, v147, s21 op_sel:[0,1]
  v_mfma_f32_16x16x32_f16 v[80:83], v[184:187], v[208:211], v[80:83]
  ds_write_b128 v246, v[144:147]
  v_cvt_pk_f16_f32 v148, v152, v153
  v_cvt_pk_f16_f32 v149, v154, v155
  v_cvt_pk_f16_f32 v150, v156, v157
  v_cvt_pk_f16_f32 v151, v158, v159
  v_mfma_f32_16x16x32_f16 v[84:87], v[184:187], v[212:215], v[84:87]
  s_waitcnt vmcnt(0)
  ds_read_b128 a[216:219], v247 offset:24576
  ds_read_b128 a[220:223], v252 offset:24576
  ds_read_b128 a[224:227], v247 offset:24640
  v_pk_mul_f16 v148, v148, s21 op_sel:[0,1]
  v_mfma_f32_16x16x32_f16 v[88:91], v[188:191], v[192:195], v[88:91]
  s_nop 0
  ds_read_b128 a[228:231], v252 offset:24640
  ds_read_b128 a[232:235], v247 offset:24704
  ds_read_b128 a[236:239], v252 offset:24704
  v_pk_mul_f16 v149, v149, s21 op_sel:[0,1]
  v_mfma_f32_16x16x32_f16 v[92:95], v[188:191], v[196:199], v[92:95]
  v_pk_mul_f16 v150, v150, s21 op_sel:[0,1]
  v_pk_mul_f16 v151, v151, s21 op_sel:[0,1]
  v_or3_b32 v12, v144, v145, v12
  v_or3_b32 v12, v146, v147, v12
  v_mfma_f32_16x16x32_f16 v[96:99], v[188:191], v[200:203], v[96:99]
  s_nop 0
  ds_write_b128 v246, v[148:151] offset:512
  v_mfma_f32_16x16x32_f16 v[100:103], v[188:191], v[204:207], v[100:103]
  s_nop 0
  ds_read_b128 v[192:195], v1 offset:26624
  ds_read_b128 v[196:199], v1 offset:27648
  v_or3_b32 v12, v148, v149, v12
  v_or3_b32 v12, v150, v151, v12
  v_mfma_f32_16x16x32_f16 v[104:107], v[188:191], v[208:211], v[104:107]
  ds_read_b128 v[200:203], v1 offset:28672
  ds_read_b128 v[204:207], v1 offset:29696
  ds_read_b128 v[208:211], v1 offset:30720
  v_mfma_f32_16x16x32_f16 v[108:111], v[188:191], v[212:215], v[108:111]
  s_waitcnt lgkmcnt(11)
  ds_read_b128 v[212:215], v1 offset:31744
  v_cvt_pk_f16_f32 v48, v16, v17
  v_mfma_f32_32x32x16_bf16 v[112:127], a[216:219], a[192:195], 0
  s_waitcnt lgkmcnt(11)
  v_cvt_pk_f16_f32 v49, v18, v19
  v_cvt_pk_f16_f32 v50, v20, v21
  v_cvt_pk_f16_f32 v51, v22, v23
  v_cvt_pk_f16_f32 v52, v24, v25
  v_cvt_pk_f16_f32 v53, v26, v27
  v_cvt_pk_f16_f32 v54, v28, v29
  v_mfma_f32_32x32x16_bf16 v[112:127], a[220:223], a[196:199], v[112:127]
  s_nop 0
  s_waitcnt lgkmcnt(7)
  v_cvt_pk_f16_f32 v55, v30, v31
  v_pk_fma_f16 v56, v48, v48, s20 op_sel_hi:[1,1,0] neg_lo:[1,0,0] neg_hi:[1,0,0] clamp
  v_pk_fma_f16 v57, v49, v49, s20 op_sel_hi:[1,1,0] neg_lo:[1,0,0] neg_hi:[1,0,0] clamp
  v_pk_fma_f16 v58, v50, v50, s20 op_sel_hi:[1,1,0] neg_lo:[1,0,0] neg_hi:[1,0,0] clamp
  v_pk_fma_f16 v59, v51, v51, s20 op_sel_hi:[1,1,0] neg_lo:[1,0,0] neg_hi:[1,0,0] clamp
  v_pk_fma_f16 v184, v56, v56, s20 op_sel:[0,0,1]
  v_mfma_f32_32x32x16_bf16 v[128:143], a[224:227], a[200:203], 0
  v_pk_fma_f16 v185, v57, v57, s20 op_sel:[0,0,1]
  v_pk_fma_f16 v186, v58, v58, s20 op_sel:[0,0,1]
  v_pk_fma_f16 v187, v59, v59, s20 op_sel:[0,0,1]
  v_pk_fma_f16 v184, v184, v56, s21 op_sel_hi:[1,1,0]
  v_pk_fma_f16 v185, v185, v57, s21 op_sel_hi:[1,1,0]
  v_cvt_pk_f16_f32 v112, v112, v113
  v_mfma_f32_32x32x16_bf16 v[128:143], a[228:231], a[204:207], v[128:143]
  v_cvt_pk_f16_f32 v113, v114, v115
  v_cvt_pk_f16_f32 v114, v116, v117
  v_cvt_pk_f16_f32 v115, v118, v119
  v_pk_mul_f16 v112, v112, s21 op_sel:[0,1]
  v_pk_mul_f16 v113, v113, s21 op_sel:[0,1]
  v_pk_mul_f16 v114, v114, s21 op_sel:[0,1]
  v_mfma_f32_32x32x16_bf16 v[144:159], a[232:235], a[208:211], 0
  v_pk_mul_f16 v115, v115, s21 op_sel:[0,1]
  v_cvt_pk_f16_f32 v116, v120, v121
  v_cvt_pk_f16_f32 v117, v122, v123
  v_cvt_pk_f16_f32 v118, v124, v125
  v_cvt_pk_f16_f32 v119, v126, v127
  v_pk_mul_f16 v116, v116, s21 op_sel:[0,1]
  v_mfma_f32_32x32x16_bf16 v[144:159], a[236:239], a[212:215], v[144:159]
  ds_read_b128 a[192:195], v0
  ds_read_b128 a[196:199], v0 offset:3072
  ds_read_b128 a[200:203], v0 offset:1024
  v_pk_mul_f16 v117, v117, s21 op_sel:[0,1]
  v_pk_mul_f16 v118, v118, s21 op_sel:[0,1]
  v_pk_mul_f16 v119, v119, s21 op_sel:[0,1]
  v_mfma_f32_16x16x32_bf16 v[16:19], a[72:75], v[216:219], 0
  ds_read_b128 a[204:207], v0 offset:4096
  ds_read_b128 a[208:211], v0 offset:2048
  ds_read_b128 a[212:215], v0 offset:5120
  ds_write_b128 v244, v[112:115] offset:24576
  v_or3_b32 v12, v112, v113, v12
  v_mfma_f32_16x16x32_bf16 v[24:27], a[72:75], v[220:223], 0
  v_pk_fma_f16 v186, v186, v58, s21 op_sel_hi:[1,1,0]
  v_pk_fma_f16 v187, v187, v59, s21 op_sel_hi:[1,1,0]
  v_or3_b32 v12, v114, v115, v12
  v_or3_b32 v12, v116, v117, v12
  v_mfma_f32_16x16x32_bf16 v[20:23], a[76:79], v[216:219], 0
  ds_write_b128 v244, v[116:119] offset:25088
  v_pk_fma_f16 v184, v184, v48, 0.5 op_sel_hi:[1,1,0] clamp
  v_pk_fma_f16 v185, v185, v49, 0.5 op_sel_hi:[1,1,0] clamp
  v_or3_b32 v12, v118, v119, v12
  v_cvt_pk_f16_f32 v128, v128, v129
  v_mfma_f32_16x16x32_bf16 v[28:31], a[76:79], v[220:223], 0
  v_pk_fma_f16 v186, v186, v50, 0.5 op_sel_hi:[1,1,0] clamp
  v_pk_fma_f16 v187, v187, v51, 0.5 op_sel_hi:[1,1,0] clamp
  v_cvt_pk_f16_f32 v129, v130, v131
  v_cvt_pk_f16_f32 v130, v132, v133
  v_mfma_f32_16x16x32_bf16 v[16:19], a[80:83], v[224:227], v[16:19]
  v_pk_mul_f16 v184, v184, v48
  v_pk_mul_f16 v185, v185, v49
  v_cvt_pk_f16_f32 v131, v134, v135
  v_pk_mul_f16 v128, v128, s21 op_sel:[0,1]
  v_mfma_f32_16x16x32_bf16 v[24:27], a[80:83], v[228:231], v[24:27]
  v_pk_mul_f16 v186, v186, v50
  v_pk_mul_f16 v187, v187, v51
  v_pk_mul_f16 v129, v129, s21 op_sel:[0,1]
  v_pk_mul_f16 v130, v130, s21 op_sel:[0,1]
  v_mfma_f32_16x16x32_bf16 v[20:23], a[84:87], v[224:227], v[20:23]
  v_pk_fma_f16 v56, v52, v52, s20 op_sel_hi:[1,1,0] neg_lo:[1,0,0] neg_hi:[1,0,0] clamp
  v_pk_fma_f16 v57, v53, v53, s20 op_sel_hi:[1,1,0] neg_lo:[1,0,0] neg_hi:[1,0,0] clamp
  v_pk_mul_f16 v131, v131, s21 op_sel:[0,1]
  v_cvt_pk_f16_f32 v132, v136, v137
  v_mfma_f32_16x16x32_bf16 v[28:31], a[84:87], v[228:231], v[28:31]
  ds_write_b128 v245, v[128:131] offset:24576
  v_pk_fma_f16 v58, v54, v54, s20 op_sel_hi:[1,1,0] neg_lo:[1,0,0] neg_hi:[1,0,0] clamp
  v_pk_fma_f16 v59, v55, v55, s20 op_sel_hi:[1,1,0] neg_lo:[1,0,0] neg_hi:[1,0,0] clamp
  v_cvt_pk_f16_f32 v133, v138, v139
  v_cvt_pk_f16_f32 v134, v140, v141
  v_mfma_f32_16x16x32_bf16 v[16:19], a[88:91], v[232:235], v[16:19]
  v_pk_fma_f16 v188, v56, v56, s20 op_sel:[0,0,1]
  v_pk_fma_f16 v189, v57, v57, s20 op_sel:[0,0,1]
  v_cvt_pk_f16_f32 v135, v142, v143
  v_pk_mul_f16 v132, v132, s21 op_sel:[0,1]
  v_mfma_f32_16x16x32_bf16 v[24:27], a[88:91], v[236:239], v[24:27]
  v_pk_fma_f16 v190, v58, v58, s20 op_sel:[0,0,1]
  v_pk_fma_f16 v191, v59, v59, s20 op_sel:[0,0,1]
  v_pk_mul_f16 v133, v133, s21 op_sel:[0,1]
  v_pk_mul_f16 v134, v134, s21 op_sel:[0,1]
  v_mfma_f32_16x16x32_bf16 v[20:23], a[92:95], v[232:235], v[20:23]
  s_nop 0
  v_pk_fma_f16 v188, v188, v56, s21 op_sel_hi:[1,1,0]
  v_pk_fma_f16 v189, v189, v57, s21 op_sel_hi:[1,1,0]
  v_pk_mul_f16 v135, v135, s21 op_sel:[0,1]
  v_or3_b32 v12, v128, v129, v12
  v_mfma_f32_16x16x32_bf16 v[28:31], a[92:95], v[236:239], v[28:31]
  s_waitcnt lgkmcnt(3)
  ds_write_b128 v245, v[132:135] offset:25088
  v_pk_fma_f16 v190, v190, v58, s21 op_sel_hi:[1,1,0]
  v_pk_fma_f16 v191, v191, v59, s21 op_sel_hi:[1,1,0]
  v_or3_b32 v12, v130, v131, v12
  v_or3_b32 v12, v132, v133, v12
  v_mfma_f32_16x16x32_f16 v[64:67], v[184:187], v[192:195], v[64:67]
  v_pk_fma_f16 v188, v188, v52, 0.5 op_sel_hi:[1,1,0] clamp
  v_pk_fma_f16 v189, v189, v53, 0.5 op_sel_hi:[1,1,0] clamp
  v_or3_b32 v12, v134, v135, v12
  v_cvt_pk_f16_f32 v144, v144, v145
  v_mfma_f32_16x16x32_f16 v[68:71], v[184:187], v[196:199], v[68:71]
  s_nop 0
  buffer_load_dword v249, v248, s[4:7], s29 offen
  v_pk_fma_f16 v190, v190, v54, 0.5 op_sel_hi:[1,1,0] clamp
  v_pk_fma_f16 v191, v191, v55, 0.5 op_sel_hi:[1,1,0] clamp
  v_mfma_f32_16x16x32_f16 v[72:75], v[184:187], v[200:203], v[72:75]
  s_nop 0
  v_pk_mul_f16 v188, v188, v52
  v_pk_mul_f16 v189, v189, v53
  v_cvt_pk_f16_f32 v145, v146, v147
  v_cvt_pk_f16_f32 v146, v148, v149
  v_mfma_f32_16x16x32_f16 v[76:79], v[184:187], v[204:207], v[76:79]
  ds_read_b128 a[216:219], v0 offset:6144
  v_cvt_pk_f16_f32 v147, v150, v151
  v_pk_mul_f16 v144, v144, s21 op_sel:[0,1]
  v_pk_mul_f16 v145, v145, s21 op_sel:[0,1]
  v_pk_mul_f16 v146, v146, s21 op_sel:[0,1]
  v_pk_mul_f16 v147, v147, s21 op_sel:[0,1]
  v_cvt_pk_f16_f32 v148, v152, v153
  v_cvt_pk_f16_f32 v149, v154, v155
  v_cvt_pk_f16_f32 v150, v156, v157
  v_cvt_pk_f16_f32 v151, v158, v159
  v_pk_mul_f16 v148, v148, s21 op_sel:[0,1]
  v_pk_mul_f16 v149, v149, s21 op_sel:[0,1]
  v_pk_mul_f16 v150, v150, s21 op_sel:[0,1]
  v_pk_mul_f16 v151, v151, s21 op_sel:[0,1]
  v_or3_b32 v12, v144, v145, v12
  v_or3_b32 v12, v146, v147, v12
  v_or3_b32 v12, v148, v149, v12
  v_or3_b32 v12, v150, v151, v12
  v_pk_mul_f16 v190, v190, v54
  v_pk_mul_f16 v191, v191, v55
  v_mfma_f32_16x16x32_f16 v[80:83], v[184:187], v[208:211], v[80:83]
  ds_read_b128 a[220:223], v0 offset:9216
  ds_read_b128 a[224:227], v0 offset:7168
  ds_write_b128 v246, v[144:147] offset:24576
  v_cvt_pk_f16_f32 v48, v16, v17
  v_cvt_pk_f16_f32 v49, v18, v19
  v_mfma_f32_16x16x32_f16 v[84:87], v[184:187], v[212:215], v[84:87]
  v_and_b32 v13, 0x40004000, v12
  v_and_b32 v12, 0x30003000, v12
  v_cmp_ne_u32 vcc, 0, v13
  v_cvt_pk_f16_f32 v50, v20, v21
  v_cvt_pk_f16_f32 v51, v22, v23
  v_mfma_f32_16x16x32_f16 v[88:91], v[188:191], v[192:195], v[88:91]
  s_cmp_lg_u64 vcc, 0
  s_cselect_b32 s3, 1, s3
  ds_read_b128 a[228:231], v0 offset:10240
  ds_write_b128 v246, v[148:151] offset:25088
  v_cmp_ne_u32 vcc, 0, v12
  v_lshl_add_u32 v13, s27, 2, v2
  v_cvt_pk_f16_f32 v52, v24, v25
  v_cvt_pk_f16_f32 v53, v26, v27
  v_mfma_f32_16x16x32_f16 v[92:95], v[188:191], v[196:199], v[92:95]
  s_cmp_eq_u64 vcc, 0
  s_cselect_b32 s3, 1, s3
  ds_read_b128 a[232:235], v0 offset:8192
  v_mov_b32_e64 v12, s3
  v_cvt_pk_f16_f32 v54, v28, v29
  v_cvt_pk_f16_f32 v55, v30, v31
  v_mfma_f32_16x16x32_f16 v[96:99], v[188:191], v[200:203], v[96:99]
  ds_read_b128 a[236:239], v0 offset:11264
  ds_write_b32 v13, v12 offset:1536
  v_pk_fma_f16 v56, v48, v48, s20 op_sel_hi:[1,1,0] neg_lo:[1,0,0] neg_hi:[1,0,0] clamp
  v_pk_fma_f16 v57, v49, v49, s20 op_sel_hi:[1,1,0] neg_lo:[1,0,0] neg_hi:[1,0,0] clamp
  v_mfma_f32_16x16x32_f16 v[100:103], v[188:191], v[204:207], v[100:103]
  ds_read_b128 v[164:167], v4 offset:96
  ds_read_b128 v[168:171], v4 offset:288
  ds_read_b128 v[172:175], v4 offset:480
  ds_read_b128 v[244:247], v0 offset:17408
  v_pk_fma_f16 v58, v50, v50, s20 op_sel_hi:[1,1,0] neg_lo:[1,0,0] neg_hi:[1,0,0] clamp
  v_pk_fma_f16 v59, v51, v51, s20 op_sel_hi:[1,1,0] neg_lo:[1,0,0] neg_hi:[1,0,0] clamp
  v_mfma_f32_16x16x32_f16 v[104:107], v[188:191], v[208:211], v[104:107]
  v_pk_fma_f16 v184, v56, v56, s20 op_sel:[0,0,1]
  v_pk_fma_f16 v185, v57, v57, s20 op_sel:[0,0,1]
  v_lshlrev_b32 v252, 16, v240
  v_lshlrev_b32 v253, 16, v241
  v_mfma_f32_16x16x32_f16 v[108:111], v[188:191], v[212:215], v[108:111]
  s_waitcnt lgkmcnt(0)
  v_lshlrev_b32 v254, 16, v242
  v_lshlrev_b32_e64 v255, 16, v243
  v_pk_fma_f16 v186, v58, v58, s20 op_sel:[0,0,1]
  v_pk_fma_f16 v187, v59, v59, s20 op_sel:[0,0,1]
  s_barrier
  .p2align 6
L_loop:
  v_mfma_f32_16x16x32_bf16 v[16:19], a[96:99], v[216:219], 0
  s_add_u32 s28, s28, 0x60000
  ds_read_b128 v[192:195], v0 offset:24576
  ds_read_b128 v[196:199], v0 offset:25600
  ds_read_b128 v[200:203], v0 offset:26624
  v_mfma_f32_16x16x32_bf16 v[24:27], a[96:99], v[220:223], 0
  s_add_u32 s59, s59, 0x60000
  ds_read_b128 v[204:207], v0 offset:27648
  ds_read_b128 v[208:211], v0 offset:28672
  ds_read_b128 v[212:215], v0 offset:29696
  v_mfma_f32_16x16x32_bf16 v[20:23], a[100:103], v[216:219], 0
  s_add_u32 s57, s57, 0x60000
  v_pk_fma_f16 v184, v184, v56, s21 op_sel_hi:[1,1,0]
  v_pk_fma_f16 v185, v185, v57, s21 op_sel_hi:[1,1,0]
  v_mfma_f32_16x16x32_bf16 v[28:31], a[100:103], v[220:223], 0
  s_add_u32 s15, s15, 0x60000
  v_pk_fma_f16 v186, v186, v58, s21 op_sel_hi:[1,1,0]
  v_pk_fma_f16 v187, v187, v59, s21 op_sel_hi:[1,1,0]
  v_mfma_f32_16x16x32_bf16 v[136:139], v[160:163], v[164:167], 0
  s_mov_b32 m0, s30
  ds_read_b128 v[160:163], v3 offset:2800
  ds_read_b128 v[164:167], v4 offset:112
  v_mfma_f32_16x16x32_bf16 v[16:19], a[104:107], v[224:227], v[16:19]
  s_nop 0
  v_pk_fma_f16 v184, v184, v48, 0.5 op_sel_hi:[1,1,0] clamp
  v_pk_fma_f16 v185, v185, v49, 0.5 op_sel_hi:[1,1,0] clamp
  v_mfma_f32_16x16x32_bf16 v[24:27], a[104:107], v[228:231], v[24:27]
  v_pk_fma_f16 v186, v186, v50, 0.5 op_sel_hi:[1,1,0] clamp
  v_pk_fma_f16 v187, v187, v51, 0.5 op_sel_hi:[1,1,0] clamp
  v_smfmac_f32_16x16x64_bf16 v[136:139], v[176:179], v[168:175], v250
  ds_read_b128 v[168:171], v4 offset:304
  ds_read_b128 v[172:175], v4 offset:496
  ds_read2_b64 v[176:179], v11 offset0:224 offset1:232
  v_mfma_f32_16x16x32_bf16 v[20:23], a[108:111], v[224:227], v[20:23]
  v_pk_mul_f16 v184, v184, v48
  v_pk_mul_f16 v185, v185, v49
  v_mfma_f32_16x16x32_bf16 v[28:31], a[108:111], v[228:231], v[28:31]
  v_pk_mul_f16 v186, v186, v50
  v_pk_mul_f16 v187, v187, v51
  v_mfma_f32_16x16x32_bf16 v[16:19], a[112:115], v[232:235], v[16:19]
  v_pk_fma_f16 v56, v52, v52, s20 op_sel_hi:[1,1,0] neg_lo:[1,0,0] neg_hi:[1,0,0] clamp
  v_pk_fma_f16 v57, v53, v53, s20 op_sel_hi:[1,1,0] neg_lo:[1,0,0] neg_hi:[1,0,0] clamp
  v_mfma_f32_16x16x32_bf16 v[24:27], a[112:115], v[236:239], v[24:27]
  v_pk_fma_f16 v58, v54, v54, s20 op_sel_hi:[1,1,0] neg_lo:[1,0,0] neg_hi:[1,0,0] clamp
  v_pk_fma_f16 v59, v55, v55, s20 op_sel_hi:[1,1,0] neg_lo:[1,0,0] neg_hi:[1,0,0] clamp
  v_mfma_f32_16x16x32_bf16 v[20:23], a[116:119], v[232:235], v[20:23]
  v_pk_fma_f16 v188, v56, v56, s20 op_sel:[0,0,1]
  v_pk_fma_f16 v189, v57, v57, s20 op_sel:[0,0,1]
  v_mfma_f32_16x16x32_bf16 v[28:31], a[116:119], v[236:239], v[28:31]
  s_waitcnt lgkmcnt(3)
  v_pk_fma_f16 v190, v58, v58, s20 op_sel:[0,0,1]
  v_pk_fma_f16 v191, v59, v59, s20 op_sel:[0,0,1]
  v_mfma_f32_16x16x32_f16 v[64:67], v[184:187], v[192:195], v[64:67]
  s_nop 0
  v_pk_fma_f16 v188, v188, v56, s21 op_sel_hi:[1,1,0]
  v_pk_fma_f16 v189, v189, v57, s21 op_sel_hi:[1,1,0]
  v_mfma_f32_16x16x32_f16 v[68:71], v[184:187], v[196:199], v[68:71]
  v_pk_fma_f16 v190, v190, v58, s21 op_sel_hi:[1,1,0]
  v_pk_fma_f16 v191, v191, v59, s21 op_sel_hi:[1,1,0]
  v_mfma_f32_16x16x32_bf16 v[140:143], v[160:163], v[164:167], 0
  ds_read_b128 v[160:163], v3 offset:3200
  ds_read_b128 v[164:167], v4 offset:128
  v_pk_fma_f16 v188, v188, v52, 0.5 op_sel_hi:[1,1,0] clamp
  v_pk_fma_f16 v189, v189, v53, 0.5 op_sel_hi:[1,1,0] clamp
  v_mfma_f32_16x16x32_f16 v[72:75], v[184:187], v[200:203], v[72:75]
  v_pk_fma_f16 v190, v190, v54, 0.5 op_sel_hi:[1,1,0] clamp
  v_pk_fma_f16 v191, v191, v55, 0.5 op_sel_hi:[1,1,0] clamp
  v_mfma_f32_16x16x32_f16 v[76:79], v[184:187], v[204:207], v[76:79]
  s_waitcnt lgkmcnt(2)
  v_pk_mul_f16 v188, v188, v52
  v_pk_mul_f16 v189, v189, v53
  v_smfmac_f32_16x16x64_bf16 v[140:143], v[176:179], v[168:175], v250
  s_nop 0
  ds_read_b128 v[168:171], v4 offset:320
  ds_read_b128 v[172:175], v4 offset:512
  v_pk_mul_f16 v190, v190, v54
  v_pk_mul_f16 v191, v191, v55
  v_mfma_f32_16x16x32_f16 v[80:83], v[184:187], v[208:211], v[80:83]
  v_cvt_pk_f16_f32 v48, v16, v17
  v_cvt_pk_f16_f32 v49, v18, v19
  v_mfma_f32_16x16x32_f16 v[84:87], v[184:187], v[212:215], v[84:87]
  v_cvt_pk_f16_f32 v50, v20, v21
  v_cvt_pk_f16_f32 v51, v22, v23
  v_mfma_f32_16x16x32_f16 v[88:91], v[188:191], v[192:195], v[88:91]
  ds_read_b128 v[192:195], v0 offset:30720
  v_cvt_pk_f16_f32 v52, v24, v25
  v_mfma_f32_16x16x32_f16 v[92:95], v[188:191], v[196:199], v[92:95]
  ds_read_b128 v[196:199], v0 offset:31744
  v_cvt_pk_f16_f32 v53, v26, v27
  v_mfma_f32_16x16x32_f16 v[96:99], v[188:191], v[200:203], v[96:99]
  ds_read_b128 v[200:203], v0 offset:32768
  v_cvt_pk_f16_f32 v54, v28, v29
  v_mfma_f32_16x16x32_f16 v[100:103], v[188:191], v[204:207], v[100:103]
  ds_read_b128 v[204:207], v0 offset:33792
  v_cvt_pk_f16_f32 v55, v30, v31
  v_mfma_f32_16x16x32_f16 v[104:107], v[188:191], v[208:211], v[104:107]
  ds_read_b128 v[208:211], v0 offset:34816
  v_pk_fma_f16 v56, v48, v48, s20 op_sel_hi:[1,1,0] neg_lo:[1,0,0] neg_hi:[1,0,0] clamp
  v_mfma_f32_16x16x32_f16 v[108:111], v[188:191], v[212:215], v[108:111]
  s_waitcnt lgkmcnt(5)
  ds_read_b128 v[212:215], v0 offset:35840
  v_pk_fma_f16 v57, v49, v49, s20 op_sel_hi:[1,1,0] neg_lo:[1,0,0] neg_hi:[1,0,0] clamp
  v_mfma_f32_16x16x32_bf16 v[144:147], v[160:163], v[164:167], 0
  s_nop 0
  ds_read_b128 v[160:163], v3 offset:3600
  ds_read_b128 v[164:167], v4 offset:144
  v_mfma_f32_16x16x32_bf16 v[16:19], a[120:123], v[216:219], 0
  v_pk_fma_f16 v58, v50, v50, s20 op_sel_hi:[1,1,0] neg_lo:[1,0,0] neg_hi:[1,0,0] clamp
  v_pk_fma_f16 v59, v51, v51, s20 op_sel_hi:[1,1,0] neg_lo:[1,0,0] neg_hi:[1,0,0] clamp
  v_mfma_f32_16x16x32_bf16 v[24:27], a[120:123], v[220:223], 0
  v_pk_fma_f16 v184, v56, v56, s20 op_sel:[0,0,1]
  v_pk_fma_f16 v185, v57, v57, s20 op_sel:[0,0,1]
  v_smfmac_f32_16x16x64_bf16 v[144:147], a[240:243], v[168:175], v250
  ds_read_b128 v[168:171], v4 offset:336
  ds_read_b128 v[172:175], v4 offset:528
  v_pk_fma_f16 v186, v58, v58, s20 op_sel:[0,0,1]
  v_pk_fma_f16 v187, v59, v59, s20 op_sel:[0,0,1]
  v_mfma_f32_16x16x32_bf16 v[20:23], a[124:127], v[216:219], 0
  v_pk_fma_f16 v184, v184, v56, s21 op_sel_hi:[1,1,0]
  v_pk_fma_f16 v185, v185, v57, s21 op_sel_hi:[1,1,0]
  v_mfma_f32_16x16x32_bf16 v[28:31], a[124:127], v[220:223], 0
  v_pk_fma_f16 v186, v186, v58, s21 op_sel_hi:[1,1,0]
  v_pk_fma_f16 v187, v187, v59, s21 op_sel_hi:[1,1,0]
  v_mfma_f32_16x16x32_bf16 v[16:19], a[128:131], v[224:227], v[16:19]
  s_nop 0
  v_pk_fma_f16 v184, v184, v48, 0.5 op_sel_hi:[1,1,0] clamp
  v_pk_fma_f16 v185, v185, v49, 0.5 op_sel_hi:[1,1,0] clamp
  v_mfma_f32_16x16x32_bf16 v[24:27], a[128:131], v[228:231], v[24:27]
  s_nop 0
  v_pk_fma_f16 v186, v186, v50, 0.5 op_sel_hi:[1,1,0] clamp
  v_pk_fma_f16 v187, v187, v51, 0.5 op_sel_hi:[1,1,0] clamp
  v_mfma_f32_16x16x32_bf16 v[20:23], a[132:135], v[224:227], v[20:23]
  v_pk_mul_f16 v184, v184, v48
  v_pk_mul_f16 v185, v185, v49
  v_mfma_f32_16x16x32_bf16 v[28:31], a[132:135], v[228:231], v[28:31]
  v_pk_mul_f16 v186, v186, v50
  v_pk_mul_f16 v187, v187, v51
  v_mfma_f32_16x16x32_bf16 v[16:19], a[136:139], v[232:235], v[16:19]
  v_pk_fma_f16 v56, v52, v52, s20 op_sel_hi:[1,1,0] neg_lo:[1,0,0] neg_hi:[1,0,0] clamp
  v_pk_fma_f16 v57, v53, v53, s20 op_sel_hi:[1,1,0] neg_lo:[1,0,0] neg_hi:[1,0,0] clamp
  v_mfma_f32_16x16x32_bf16 v[24:27], a[136:139], v[236:239], v[24:27]
  s_waitcnt lgkmcnt(0)
  v_pk_fma_f16 v58, v54, v54, s20 op_sel_hi:[1,1,0] neg_lo:[1,0,0] neg_hi:[1,0,0] clamp
  v_pk_fma_f16 v59, v55, v55, s20 op_sel_hi:[1,1,0] neg_lo:[1,0,0] neg_hi:[1,0,0] clamp
  v_mfma_f32_16x16x32_bf16 v[148:151], v[160:163], v[164:167], 0
  s_nop 0
  ds_read_b128 v[160:163], v3 offset:4000
  ds_read_b128 v[164:167], v4 offset:160
  v_pk_fma_f16 v188, v56, v56, s20 op_sel:[0,0,1]
  v_pk_fma_f16 v189, v57, v57, s20 op_sel:[0,0,1]
  v_mfma_f32_16x16x32_bf16 v[20:23], a[140:143], v[232:235], v[20:23]
  v_pk_fma_f16 v190, v58, v58, s20 op_sel:[0,0,1]
  v_pk_fma_f16 v191, v59, v59, s20 op_sel:[0,0,1]
  v_mfma_f32_16x16x32_bf16 v[28:31], a[140:143], v[236:239], v[28:31]
  s_nop 0
  v_pk_fma_f16 v188, v188, v56, s21 op_sel_hi:[1,1,0]
  v_pk_fma_f16 v189, v189, v57, s21 op_sel_hi:[1,1,0]
  v_smfmac_f32_16x16x64_bf16 v[148:151], a[244:247], v[168:175], v250
  s_nop 0
  ds_read_b128 v[168:171], v4 offset:352
  ds_read_b128 v[172:175], v4 offset:544
  v_pk_fma_f16 v190, v190, v58, s21 op_sel_hi:[1,1,0]
  v_pk_fma_f16 v191, v191, v59, s21 op_sel_hi:[1,1,0]
  v_mfma_f32_16x16x32_f16 v[64:67], v[184:187], v[192:195], v[64:67]
  v_pk_fma_f16 v188, v188, v52, 0.5 op_sel_hi:[1,1,0] clamp
  v_pk_fma_f16 v189, v189, v53, 0.5 op_sel_hi:[1,1,0] clamp
  v_mfma_f32_16x16x32_f16 v[68:71], v[184:187], v[196:199], v[68:71]
  s_nop 0
  v_pk_fma_f16 v190, v190, v54, 0.5 op_sel_hi:[1,1,0] clamp
  v_pk_fma_f16 v191, v191, v55, 0.5 op_sel_hi:[1,1,0] clamp
  v_mfma_f32_16x16x32_f16 v[72:75], v[184:187], v[200:203], v[72:75]
  s_nop 0
  v_pk_mul_f16 v188, v188, v52
  v_pk_mul_f16 v189, v189, v53
  v_mfma_f32_16x16x32_f16 v[76:79], v[184:187], v[204:207], v[76:79]
  v_pk_mul_f16 v190, v190, v54
  v_pk_mul_f16 v191, v191, v55
  v_mfma_f32_16x16x32_f16 v[80:83], v[184:187], v[208:211], v[80:83]
  v_cvt_pk_f16_f32 v48, v16, v17
  v_cvt_pk_f16_f32 v49, v18, v19
  v_mfma_f32_16x16x32_f16 v[84:87], v[184:187], v[212:215], v[84:87]
  v_cvt_pk_f16_f32 v50, v20, v21
  v_cvt_pk_f16_f32 v51, v22, v23
  v_mfma_f32_16x16x32_f16 v[88:91], v[188:191], v[192:195], v[88:91]
  s_nop 0
  ds_read_b128 v[192:195], v0 offset:36864
  v_cvt_pk_f16_f32 v52, v24, v25
  v_mfma_f32_16x16x32_f16 v[92:95], v[188:191], v[196:199], v[92:95]
  s_waitcnt lgkmcnt(1)
  ds_read_b128 v[196:199], v0 offset:37888
  v_cvt_pk_f16_f32 v53, v26, v27
  v_mfma_f32_16x16x32_bf16 v[152:155], v[160:163], v[164:167], 0
  ds_read_b128 v[160:163], v3 offset:4400
  ds_read_b128 v[164:167], v4 offset:176
  v_mfma_f32_16x16x32_f16 v[96:99], v[188:191], v[200:203], v[96:99]
  ds_read_b128 v[200:203], v0 offset:38912
  v_cvt_pk_f16_f32 v54, v28, v29
  v_mfma_f32_16x16x32_f16 v[100:103], v[188:191], v[204:207], v[100:103]
  ds_read_b128 v[204:207], v0 offset:39936
  v_cvt_pk_f16_f32 v55, v30, v31
  v_smfmac_f32_16x16x64_bf16 v[152:155], a[248:251], v[168:175], v250
  ds_read_b128 v[168:171], v4 offset:368
  ds_read_b128 v[172:175], v4 offset:560
  v_mfma_f32_16x16x32_f16 v[104:107], v[188:191], v[208:211], v[104:107]
  ds_read_b128 v[208:211], v0 offset:40960
  v_pk_fma_f16 v56, v48, v48, s20 op_sel_hi:[1,1,0] neg_lo:[1,0,0] neg_hi:[1,0,0] clamp
  v_mfma_f32_16x16x32_f16 v[108:111], v[188:191], v[212:215], v[108:111]
  ds_read_b128 v[212:215], v0 offset:41984
  v_pk_fma_f16 v57, v49, v49, s20 op_sel_hi:[1,1,0] neg_lo:[1,0,0] neg_hi:[1,0,0] clamp
  v_mfma_f32_16x16x32_bf16 v[16:19], a[144:147], v[216:219], 0
  v_pk_fma_f16 v58, v50, v50, s20 op_sel_hi:[1,1,0] neg_lo:[1,0,0] neg_hi:[1,0,0] clamp
  v_pk_fma_f16 v59, v51, v51, s20 op_sel_hi:[1,1,0] neg_lo:[1,0,0] neg_hi:[1,0,0] clamp
  v_mfma_f32_16x16x32_bf16 v[24:27], a[144:147], v[220:223], 0
  v_pk_fma_f16 v184, v56, v56, s20 op_sel:[0,0,1]
  v_pk_fma_f16 v185, v57, v57, s20 op_sel:[0,0,1]
  v_mfma_f32_16x16x32_bf16 v[20:23], a[148:151], v[216:219], 0
  v_pk_fma_f16 v186, v58, v58, s20 op_sel:[0,0,1]
  v_pk_fma_f16 v187, v59, v59, s20 op_sel:[0,0,1]
  v_mfma_f32_16x16x32_bf16 v[28:31], a[148:151], v[220:223], 0
  v_pk_fma_f16 v184, v184, v56, s21 op_sel_hi:[1,1,0]
  v_pk_fma_f16 v185, v185, v57, s21 op_sel_hi:[1,1,0]
  v_mfma_f32_16x16x32_bf16 v[16:19], a[152:155], v[224:227], v[16:19]
  v_pk_fma_f16 v186, v186, v58, s21 op_sel_hi:[1,1,0]
  v_pk_fma_f16 v187, v187, v59, s21 op_sel_hi:[1,1,0]
  v_mfma_f32_16x16x32_bf16 v[24:27], a[152:155], v[228:231], v[24:27]
  s_waitcnt lgkmcnt(2)
  v_pk_fma_f16 v184, v184, v48, 0.5 op_sel_hi:[1,1,0] clamp
  v_pk_fma_f16 v185, v185, v49, 0.5 op_sel_hi:[1,1,0] clamp
  v_mfma_f32_16x16x32_bf16 v[156:159], v[160:163], v[164:167], 0
  s_nop 0
  ds_read_b128 v[160:163], v3
  ds_read_b128 v[164:167], v4
  v_mfma_f32_16x16x32_bf16 v[20:23], a[156:159], v[224:227], v[20:23]
  v_pk_fma_f16 v186, v186, v50, 0.5 op_sel_hi:[1,1,0] clamp
  v_pk_fma_f16 v187, v187, v51, 0.5 op_sel_hi:[1,1,0] clamp
  v_mfma_f32_16x16x32_bf16 v[28:31], a[156:159], v[228:231], v[28:31]
  v_pk_mul_f16 v184, v184, v48
  v_pk_mul_f16 v185, v185, v49
  v_smfmac_f32_16x16x64_bf16 v[156:159], a[252:255], v[168:175], v250
  ds_read_b128 v[168:171], v4 offset:192
  ds_read_b128 v[172:175], v4 offset:384
  v_pk_mul_f16 v186, v186, v50
  v_pk_mul_f16 v187, v187, v51
  v_mfma_f32_16x16x32_bf16 v[16:19], a[160:163], v[232:235], v[16:19]
  ds_read2_b64 v[176:179], v11 offset0:0 offset1:8
  v_pk_fma_f16 v56, v52, v52, s20 op_sel_hi:[1,1,0] neg_lo:[1,0,0] neg_hi:[1,0,0] clamp
  v_pk_fma_f16 v57, v53, v53, s20 op_sel_hi:[1,1,0] neg_lo:[1,0,0] neg_hi:[1,0,0] clamp
  v_mfma_f32_16x16x32_bf16 v[24:27], a[160:163], v[236:239], v[24:27]
  v_pk_fma_f16 v58, v54, v54, s20 op_sel_hi:[1,1,0] neg_lo:[1,0,0] neg_hi:[1,0,0] clamp
  v_pk_fma_f16 v59, v55, v55, s20 op_sel_hi:[1,1,0] neg_lo:[1,0,0] neg_hi:[1,0,0] clamp
  v_mfma_f32_16x16x32_bf16 v[20:23], a[164:167], v[232:235], v[20:23]
  v_pk_fma_f16 v188, v56, v56, s20 op_sel:[0,0,1]
  v_pk_fma_f16 v189, v57, v57, s20 op_sel:[0,0,1]
  v_mfma_f32_16x16x32_bf16 v[28:31], a[164:167], v[236:239], v[28:31]
  v_pk_fma_f16 v190, v58, v58, s20 op_sel:[0,0,1]
  v_pk_fma_f16 v191, v59, v59, s20 op_sel:[0,0,1]
  v_mfma_f32_16x16x32_f16 v[64:67], v[184:187], v[192:195], v[64:67]
  v_pk_fma_f16 v188, v188, v56, s21 op_sel_hi:[1,1,0]
  v_pk_fma_f16 v189, v189, v57, s21 op_sel_hi:[1,1,0]
  v_mfma_f32_16x16x32_f16 v[68:71], v[184:187], v[196:199], v[68:71]
  v_pk_fma_f16 v190, v190, v58, s21 op_sel_hi:[1,1,0]
  v_pk_fma_f16 v191, v191, v59, s21 op_sel_hi:[1,1,0]
  v_mfma_f32_16x16x32_f16 v[72:75], v[184:187], v[200:203], v[72:75]
  v_pk_fma_f16 v188, v188, v52, 0.5 op_sel_hi:[1,1,0] clamp
  v_pk_fma_f16 v189, v189, v53, 0.5 op_sel_hi:[1,1,0] clamp
  v_mfma_f32_16x16x32_f16 v[76:79], v[184:187], v[204:207], v[76:79]
  s_waitcnt lgkmcnt(1)
  v_pk_fma_f16 v190, v190, v54, 0.5 op_sel_hi:[1,1,0] clamp
  v_pk_fma_f16 v191, v191, v55, 0.5 op_sel_hi:[1,1,0] clamp
  v_mfma_f32_16x16x32_bf16 v[112:115], v[160:163], v[164:167], 0
  s_nop 0
  ds_read_b128 v[160:163], v3 offset:400
  ds_read_b128 v[164:167], v4 offset:16
  v_pk_mul_f16 v188, v188, v52
  v_pk_mul_f16 v189, v189, v53
  v_mfma_f32_16x16x32_f16 v[80:83], v[184:187], v[208:211], v[80:83]
  v_pk_mul_f16 v190, v190, v54
  v_pk_mul_f16 v191, v191, v55
  v_mfma_f32_16x16x32_f16 v[84:87], v[184:187], v[212:215], v[84:87]
  s_waitcnt lgkmcnt(2)
  v_cvt_pk_f16_f32 v48, v16, v17
  v_cvt_pk_f16_f32 v49, v18, v19
  v_smfmac_f32_16x16x64_bf16 v[112:115], v[176:179], v[168:175], v250
  s_nop 0
  ds_read_b128 v[168:171], v4 offset:208
  ds_read_b128 v[172:175], v4 offset:400
  ds_read2_b64 v[176:179], v11 offset0:32 offset1:40
  v_mfma_f32_16x16x32_f16 v[88:91], v[188:191], v[192:195], v[88:91]
  ds_read_b128 v[192:195], v0 offset:43008
  v_cvt_pk_f16_f32 v50, v20, v21
  v_mfma_f32_16x16x32_f16 v[92:95], v[188:191], v[196:199], v[92:95]
  ds_read_b128 v[196:199], v0 offset:44032
  v_cvt_pk_f16_f32 v51, v22, v23
  v_mfma_f32_16x16x32_f16 v[96:99], v[188:191], v[200:203], v[96:99]
  ds_read_b128 v[200:203], v0 offset:45056
  v_cvt_pk_f16_f32 v52, v24, v25
  v_mfma_f32_16x16x32_f16 v[100:103], v[188:191], v[204:207], v[100:103]
  ds_read_b128 v[204:207], v0 offset:46080
  v_cvt_pk_f16_f32 v53, v26, v27
  v_mfma_f32_16x16x32_f16 v[104:107], v[188:191], v[208:211], v[104:107]
  ds_read_b128 v[208:211], v0 offset:47104
  v_cvt_pk_f16_f32 v54, v28, v29
  v_mfma_f32_16x16x32_f16 v[108:111], v[188:191], v[212:215], v[108:111]
  ds_read_b128 v[212:215], v0 offset:48128
  v_cvt_pk_f16_f32 v55, v30, v31
  v_mfma_f32_16x16x32_bf16 v[16:19], a[168:171], v[216:219], 0
  v_pk_fma_f16 v56, v48, v48, s20 op_sel_hi:[1,1,0] neg_lo:[1,0,0] neg_hi:[1,0,0] clamp
  v_pk_fma_f16 v57, v49, v49, s20 op_sel_hi:[1,1,0] neg_lo:[1,0,0] neg_hi:[1,0,0] clamp
  v_mfma_f32_16x16x32_bf16 v[24:27], a[168:171], v[220:223], 0
  s_waitcnt lgkmcnt(6)
  v_pk_fma_f16 v58, v50, v50, s20 op_sel_hi:[1,1,0] neg_lo:[1,0,0] neg_hi:[1,0,0] clamp
  v_pk_fma_f16 v59, v51, v51, s20 op_sel_hi:[1,1,0] neg_lo:[1,0,0] neg_hi:[1,0,0] clamp
  v_mfma_f32_16x16x32_bf16 v[116:119], v[160:163], v[164:167], 0
  s_nop 0
  ds_read_b128 v[160:163], v3 offset:800
  ds_read_b128 v[164:167], v4 offset:32
  v_pk_fma_f16 v184, v56, v56, s20 op_sel:[0,0,1]
  v_pk_fma_f16 v185, v57, v57, s20 op_sel:[0,0,1]
  v_mfma_f32_16x16x32_bf16 v[20:23], a[172:175], v[216:219], 0
  v_pk_fma_f16 v186, v58, v58, s20 op_sel:[0,0,1]
  v_pk_fma_f16 v187, v59, v59, s20 op_sel:[0,0,1]
  v_mfma_f32_16x16x32_bf16 v[28:31], a[172:175], v[220:223], 0
  v_pk_fma_f16 v184, v184, v56, s21 op_sel_hi:[1,1,0]
  v_pk_fma_f16 v185, v185, v57, s21 op_sel_hi:[1,1,0]
  v_smfmac_f32_16x16x64_bf16 v[116:119], v[176:179], v[168:175], v250
  ds_read_b128 v[168:171], v4 offset:224
  ds_read_b128 v[172:175], v4 offset:416
  v_pk_fma_f16 v186, v186, v58, s21 op_sel_hi:[1,1,0]
  v_pk_fma_f16 v187, v187, v59, s21 op_sel_hi:[1,1,0]
  v_mfma_f32_16x16x32_bf16 v[16:19], a[176:179], v[224:227], v[16:19]
  ds_read2_b64 v[176:179], v11 offset0:64 offset1:72
  v_pk_fma_f16 v184, v184, v48, 0.5 op_sel_hi:[1,1,0] clamp
  v_pk_fma_f16 v185, v185, v49, 0.5 op_sel_hi:[1,1,0] clamp
  v_mfma_f32_16x16x32_bf16 v[24:27], a[176:179], v[228:231], v[24:27]
  v_pk_fma_f16 v186, v186, v50, 0.5 op_sel_hi:[1,1,0] clamp
  v_pk_fma_f16 v187, v187, v51, 0.5 op_sel_hi:[1,1,0] clamp
  v_mfma_f32_16x16x32_bf16 v[20:23], a[180:183], v[224:227], v[20:23]
  v_pk_mul_f16 v184, v184, v48
  v_pk_mul_f16 v185, v185, v49
  v_mfma_f32_16x16x32_bf16 v[28:31], a[180:183], v[228:231], v[28:31]
  v_pk_mul_f16 v186, v186, v50
  v_pk_mul_f16 v187, v187, v51
  v_mfma_f32_16x16x32_bf16 v[16:19], a[184:187], v[232:235], v[16:19]
  v_pk_fma_f16 v56, v52, v52, s20 op_sel_hi:[1,1,0] neg_lo:[1,0,0] neg_hi:[1,0,0] clamp
  v_pk_fma_f16 v57, v53, v53, s20 op_sel_hi:[1,1,0] neg_lo:[1,0,0] neg_hi:[1,0,0] clamp
  v_mfma_f32_16x16x32_bf16 v[24:27], a[184:187], v[236:239], v[24:27]
  v_pk_fma_f16 v58, v54, v54, s20 op_sel_hi:[1,1,0] neg_lo:[1,0,0] neg_hi:[1,0,0] clamp
  v_pk_fma_f16 v59, v55, v55, s20 op_sel_hi:[1,1,0] neg_lo:[1,0,0] neg_hi:[1,0,0] clamp
  v_mfma_f32_16x16x32_bf16 v[20:23], a[188:191], v[232:235], v[20:23]
  s_nop 0
  v_pk_fma_f16 v188, v56, v56, s20 op_sel:[0,0,1]
  v_pk_fma_f16 v189, v57, v57, s20 op_sel:[0,0,1]
  v_mfma_f32_16x16x32_bf16 v[28:31], a[188:191], v[236:239], v[28:31]
  s_waitcnt lgkmcnt(1)
  v_pk_fma_f16 v190, v58, v58, s20 op_sel:[0,0,1]
  v_pk_fma_f16 v191, v59, v59, s20 op_sel:[0,0,1]
  v_mfma_f32_16x16x32_bf16 v[120:123], v[160:163], v[164:167], 0
  ds_read_b128 v[160:163], v3 offset:1200
  ds_read_b128 v[164:167], v4 offset:48
  v_pk_fma_f16 v188, v188, v56, s21 op_sel_hi:[1,1,0]
  v_pk_fma_f16 v189, v189, v57, s21 op_sel_hi:[1,1,0]
  v_mfma_f32_16x16x32_f16 v[64:67], v[184:187], v[192:195], v[64:67]
  s_nop 0
  v_pk_fma_f16 v190, v190, v58, s21 op_sel_hi:[1,1,0]
  v_pk_fma_f16 v191, v191, v59, s21 op_sel_hi:[1,1,0]
  v_mfma_f32_16x16x32_f16 v[68:71], v[184:187], v[196:199], v[68:71]
  s_waitcnt lgkmcnt(2)
  v_pk_fma_f16 v188, v188, v52, 0.5 op_sel_hi:[1,1,0] clamp
  v_pk_fma_f16 v189, v189, v53, 0.5 op_sel_hi:[1,1,0] clamp
  v_smfmac_f32_16x16x64_bf16 v[120:123], v[176:179], v[168:175], v250
  ds_read_b128 v[168:171], v4 offset:240
  ds_read_b128 v[172:175], v4 offset:432
  v_pk_fma_f16 v190, v190, v54, 0.5 op_sel_hi:[1,1,0] clamp
  v_pk_fma_f16 v191, v191, v55, 0.5 op_sel_hi:[1,1,0] clamp
  v_mfma_f32_16x16x32_f16 v[72:75], v[184:187], v[200:203], v[72:75]
  ds_read2_b64 v[176:179], v11 offset0:96 offset1:104
  v_pk_mul_f16 v188, v188, v52
  v_pk_mul_f16 v189, v189, v53
  v_mfma_f32_16x16x32_f16 v[76:79], v[184:187], v[204:207], v[76:79]
  v_pk_mul_f16 v190, v190, v54
  v_pk_mul_f16 v191, v191, v55
  v_mfma_f32_16x16x32_f16 v[80:83], v[184:187], v[208:211], v[80:83]
  v_cvt_pk_f16_f32 v48, v16, v17
  v_cvt_pk_f16_f32 v49, v18, v19
  v_mfma_f32_16x16x32_f16 v[84:87], v[184:187], v[212:215], v[84:87]
  v_cvt_pk_f16_f32 v50, v20, v21
  v_cvt_pk_f16_f32 v51, v22, v23
  v_mfma_f32_16x16x32_f16 v[88:91], v[188:191], v[192:195], v[88:91]
  ds_read_b128 v[192:195], v0 offset:49152
  v_cvt_pk_f16_f32 v52, v24, v25
  v_mfma_f32_16x16x32_f16 v[92:95], v[188:191], v[196:199], v[92:95]
  ds_read_b128 v[196:199], v0 offset:50176
  v_cvt_pk_f16_f32 v53, v26, v27
  v_mfma_f32_16x16x32_f16 v[96:99], v[188:191], v[200:203], v[96:99]
  ds_read_b128 v[200:203], v0 offset:51200
  v_cvt_pk_f16_f32 v54, v28, v29
  v_mfma_f32_16x16x32_f16 v[100:103], v[188:191], v[204:207], v[100:103]
  s_waitcnt lgkmcnt(4)
  ds_read_b128 v[204:207], v0 offset:52224
  v_cvt_pk_f16_f32 v55, v30, v31
  v_mfma_f32_16x16x32_bf16 v[124:127], v[160:163], v[164:167], 0
  s_nop 0
  ds_read_b128 v[160:163], v3 offset:1600
  ds_read_b128 v[164:167], v4 offset:64
  v_mfma_f32_16x16x32_f16 v[104:107], v[188:191], v[208:211], v[104:107]
  ds_read_b128 v[208:211], v0 offset:53248
  v_pk_fma_f16 v56, v48, v48, s20 op_sel_hi:[1,1,0] neg_lo:[1,0,0] neg_hi:[1,0,0] clamp
  v_mfma_f32_16x16x32_f16 v[108:111], v[188:191], v[212:215], v[108:111]
  s_waitcnt lgkmcnt(7)
  ds_read_b128 v[212:215], v0 offset:54272
  v_pk_fma_f16 v57, v49, v49, s20 op_sel_hi:[1,1,0] neg_lo:[1,0,0] neg_hi:[1,0,0] clamp
  v_smfmac_f32_16x16x64_bf16 v[124:127], v[176:179], v[168:175], v250
  s_nop 0
  ds_read_b128 v[168:171], v4 offset:256
  ds_read_b128 v[172:175], v4 offset:448
  ds_read2_b64 v[176:179], v11 offset0:128 offset1:136
  v_mfma_f32_16x16x32_bf16 v[16:19], a[192:195], v[216:219], 0
  v_pk_fma_f16 v58, v50, v50, s20 op_sel_hi:[1,1,0] neg_lo:[1,0,0] neg_hi:[1,0,0] clamp
  v_pk_fma_f16 v59, v51, v51, s20 op_sel_hi:[1,1,0] neg_lo:[1,0,0] neg_hi:[1,0,0] clamp
  v_mfma_f32_16x16x32_bf16 v[24:27], a[192:195], v[220:223], 0
  v_pk_fma_f16 v184, v56, v56, s20 op_sel:[0,0,1]
  v_pk_fma_f16 v185, v57, v57, s20 op_sel:[0,0,1]
  v_mfma_f32_16x16x32_bf16 v[20:23], a[196:199], v[216:219], 0
  v_pk_fma_f16 v186, v58, v58, s20 op_sel:[0,0,1]
  v_pk_fma_f16 v187, v59, v59, s20 op_sel:[0,0,1]
  v_mfma_f32_16x16x32_bf16 v[28:31], a[196:199], v[220:223], 0
  v_pk_fma_f16 v184, v184, v56, s21 op_sel_hi:[1,1,0]
  v_pk_fma_f16 v185, v185, v57, s21 op_sel_hi:[1,1,0]
  v_mfma_f32_16x16x32_bf16 v[16:19], a[200:203], v[224:227], v[16:19]
  v_pk_fma_f16 v186, v186, v58, s21 op_sel_hi:[1,1,0]
  v_pk_fma_f16 v187, v187, v59, s21 op_sel_hi:[1,1,0]
  v_mfma_f32_16x16x32_bf16 v[24:27], a[200:203], v[228:231], v[24:27]
  v_pk_fma_f16 v184, v184, v48, 0.5 op_sel_hi:[1,1,0] clamp
  v_pk_fma_f16 v185, v185, v49, 0.5 op_sel_hi:[1,1,0] clamp
  v_mfma_f32_16x16x32_bf16 v[20:23], a[204:207], v[224:227], v[20:23]
  v_pk_fma_f16 v186, v186, v50, 0.5 op_sel_hi:[1,1,0] clamp
  v_pk_fma_f16 v187, v187, v51, 0.5 op_sel_hi:[1,1,0] clamp
  v_mfma_f32_16x16x32_bf16 v[28:31], a[204:207], v[228:231], v[28:31]
  s_waitcnt lgkmcnt(0)
  v_pk_mul_f16 v184, v184, v48
  v_pk_mul_f16 v185, v185, v49
  v_mfma_f32_16x16x32_bf16 v[128:131], v[160:163], v[164:167], 0
  s_nop 0
  ds_read_b128 v[160:163], v3 offset:2000
  ds_read_b128 v[164:167], v4 offset:80
  v_pk_mul_f16 v186, v186, v50
  v_pk_mul_f16 v187, v187, v51
  v_mfma_f32_16x16x32_bf16 v[16:19], a[208:211], v[232:235], v[16:19]
  v_pk_fma_f16 v56, v52, v52, s20 op_sel_hi:[1,1,0] neg_lo:[1,0,0] neg_hi:[1,0,0] clamp
  v_pk_fma_f16 v57, v53, v53, s20 op_sel_hi:[1,1,0] neg_lo:[1,0,0] neg_hi:[1,0,0] clamp
  v_mfma_f32_16x16x32_bf16 v[24:27], a[208:211], v[236:239], v[24:27]
  v_pk_fma_f16 v58, v54, v54, s20 op_sel_hi:[1,1,0] neg_lo:[1,0,0] neg_hi:[1,0,0] clamp
  v_pk_fma_f16 v59, v55, v55, s20 op_sel_hi:[1,1,0] neg_lo:[1,0,0] neg_hi:[1,0,0] clamp
  v_smfmac_f32_16x16x64_bf16 v[128:131], v[176:179], v[168:175], v250
  ds_read_b128 v[168:171], v4 offset:272
  ds_read_b128 v[172:175], v4 offset:464
  v_pk_fma_f16 v188, v56, v56, s20 op_sel:[0,0,1]
  v_pk_fma_f16 v189, v57, v57, s20 op_sel:[0,0,1]
  v_mfma_f32_16x16x32_bf16 v[20:23], a[212:215], v[232:235], v[20:23]
  ds_read2_b64 v[176:179], v11 offset0:160 offset1:168
  v_pk_fma_f16 v190, v58, v58, s20 op_sel:[0,0,1]
  v_pk_fma_f16 v191, v59, v59, s20 op_sel:[0,0,1]
  v_mfma_f32_16x16x32_bf16 v[28:31], a[212:215], v[236:239], v[28:31]
  v_pk_fma_f16 v188, v188, v56, s21 op_sel_hi:[1,1,0]
  v_pk_fma_f16 v189, v189, v57, s21 op_sel_hi:[1,1,0]
  v_mfma_f32_16x16x32_f16 v[64:67], v[184:187], v[192:195], v[64:67]
  v_pk_fma_f16 v190, v190, v58, s21 op_sel_hi:[1,1,0]
  v_pk_fma_f16 v191, v191, v59, s21 op_sel_hi:[1,1,0]
  v_mfma_f32_16x16x32_f16 v[68:71], v[184:187], v[196:199], v[68:71]
  v_pk_fma_f16 v188, v188, v52, 0.5 op_sel_hi:[1,1,0] clamp
  v_pk_fma_f16 v189, v189, v53, 0.5 op_sel_hi:[1,1,0] clamp
  v_mfma_f32_16x16x32_f16 v[72:75], v[184:187], v[200:203], v[72:75]
  v_pk_fma_f16 v190, v190, v54, 0.5 op_sel_hi:[1,1,0] clamp
  v_pk_fma_f16 v191, v191, v55, 0.5 op_sel_hi:[1,1,0] clamp
  v_mfma_f32_16x16x32_f16 v[76:79], v[184:187], v[204:207], v[76:79]
  v_pk_mul_f16 v188, v188, v52
  v_pk_mul_f16 v189, v189, v53
  v_mfma_f32_16x16x32_f16 v[80:83], v[184:187], v[208:211], v[80:83]
  s_nop 0
  v_pk_mul_f16 v190, v190, v54
  v_pk_mul_f16 v191, v191, v55
  v_mfma_f32_16x16x32_f16 v[84:87], v[184:187], v[212:215], v[84:87]
  s_waitcnt lgkmcnt(1)
  v_cvt_pk_f16_f32 v48, v16, v17
  v_cvt_pk_f16_f32 v49, v18, v19
  v_mfma_f32_16x16x32_bf16 v[132:135], v[160:163], v[164:167], 0
  ds_read_b128 v[160:163], v0 offset:18432
  ds_read_b128 v[164:167], v0 offset:21504
  v_mfma_f32_16x16x32_f16 v[88:91], v[188:191], v[192:195], v[88:91]
  ds_read_b128 v[192:195], v0 offset:55296
  v_cvt_pk_f16_f32 v50, v20, v21
  v_cvt_pk_f16_f32 v51, v22, v23
  v_mfma_f32_16x16x32_f16 v[92:95], v[188:191], v[196:199], v[92:95]
  s_waitcnt lgkmcnt(3)
  ds_read_b128 v[196:199], v0 offset:56320
  v_cvt_pk_f16_f32 v52, v24, v25
  v_cvt_pk_f16_f32 v53, v26, v27
  v_smfmac_f32_16x16x64_bf16 v[132:135], v[176:179], v[168:175], v250
  s_nop 0
  ds_read_b128 v[168:171], v0 offset:19456
  ds_read_b128 v[172:175], v0 offset:22528
  v_cvt_pk_f16_f32 v54, v28, v29
  v_cvt_pk_f16_f32 v55, v30, v31
  v_mfma_f32_16x16x32_f16 v[96:99], v[188:191], v[200:203], v[96:99]
  ds_read_b128 v[200:203], v0 offset:57344
  ds_read_b128 v[176:179], v0 offset:20480
  v_pk_fma_f16 v56, v48, v48, s20 op_sel_hi:[1,1,0] neg_lo:[1,0,0] neg_hi:[1,0,0] clamp
  v_pk_fma_f16 v57, v49, v49, s20 op_sel_hi:[1,1,0] neg_lo:[1,0,0] neg_hi:[1,0,0] clamp
  v_mfma_f32_16x16x32_f16 v[100:103], v[188:191], v[204:207], v[100:103]
  ds_read_b128 v[204:207], v0 offset:58368
  v_pk_fma_f16 v58, v50, v50, s20 op_sel_hi:[1,1,0] neg_lo:[1,0,0] neg_hi:[1,0,0] clamp
  v_pk_fma_f16 v59, v51, v51, s20 op_sel_hi:[1,1,0] neg_lo:[1,0,0] neg_hi:[1,0,0] clamp
  v_mfma_f32_16x16x32_f16 v[104:107], v[188:191], v[208:211], v[104:107]
  ds_read_b128 v[208:211], v0 offset:59392
  v_pk_fma_f16 v184, v56, v56, s20 op_sel:[0,0,1]
  v_pk_fma_f16 v185, v57, v57, s20 op_sel:[0,0,1]
  v_mfma_f32_16x16x32_f16 v[108:111], v[188:191], v[212:215], v[108:111]
  ds_read_b128 v[212:215], v0 offset:60416
  v_pk_fma_f16 v186, v58, v58, s20 op_sel:[0,0,1]
  v_pk_fma_f16 v187, v59, v59, s20 op_sel:[0,0,1]
  v_mfma_f32_16x16x32_bf16 v[16:19], a[216:219], v[216:219], 0
  v_pk_fma_f16 v184, v184, v56, s21 op_sel_hi:[1,1,0]
  v_pk_fma_f16 v185, v185, v57, s21 op_sel_hi:[1,1,0]
  v_mfma_f32_16x16x32_bf16 v[24:27], a[216:219], v[220:223], 0
  v_pk_fma_f16 v186, v186, v58, s21 op_sel_hi:[1,1,0]
  v_pk_fma_f16 v187, v187, v59, s21 op_sel_hi:[1,1,0]
  v_mul_f32 v14, v136, v136
  v_mul_f32 v15, v137, v137
  v_mul_f32 v182, v138, v138
  v_mul_f32 v183, v139, v139
  v_pk_add_f32 v[12:13], v[136:137], v[140:141]
  v_pk_fma_f32 v[14:15], v[140:141], v[140:141], v[14:15]
  v_pk_add_f32 v[180:181], v[138:139], v[142:143]
  v_pk_fma_f32 v[182:183], v[142:143], v[142:143], v[182:183]
  v_pk_add_f32 v[12:13], v[12:13], v[144:145]
  v_pk_fma_f32 v[14:15], v[144:145], v[144:145], v[14:15]
  v_pk_add_f32 v[180:181], v[180:181], v[146:147]
  v_pk_fma_f32 v[182:183], v[146:147], v[146:147], v[182:183]
  v_pk_add_f32 v[12:13], v[12:13], v[148:149]
  v_pk_fma_f32 v[14:15], v[148:149], v[148:149], v[14:15]
  v_pk_add_f32 v[180:181], v[180:181], v[150:151]
  v_pk_fma_f32 v[182:183], v[150:151], v[150:151], v[182:183]
  v_pk_add_f32 v[12:13], v[12:13], v[152:153]
  v_pk_fma_f32 v[14:15], v[152:153], v[152:153], v[14:15]
  v_pk_add_f32 v[180:181], v[180:181], v[154:155]
  v_pk_fma_f32 v[182:183], v[154:155], v[154:155], v[182:183]
  v_pk_add_f32 v[12:13], v[12:13], v[156:157]
  v_pk_fma_f32 v[14:15], v[156:157], v[156:157], v[14:15]
  v_pk_add_f32 v[180:181], v[180:181], v[158:159]
  v_pk_fma_f32 v[182:183], v[158:159], v[158:159], v[182:183]
  v_pk_add_f32 v[12:13], v[12:13], v[112:113]
  v_pk_fma_f32 v[14:15], v[112:113], v[112:113], v[14:15]
  v_pk_add_f32 v[180:181], v[180:181], v[114:115]
  v_pk_fma_f32 v[182:183], v[114:115], v[114:115], v[182:183]
  v_pk_add_f32 v[12:13], v[12:13], v[116:117]
  v_pk_fma_f32 v[14:15], v[116:117], v[116:117], v[14:15]
  v_pk_add_f32 v[180:181], v[180:181], v[118:119]
  v_pk_fma_f32 v[182:183], v[118:119], v[118:119], v[182:183]
  v_pk_add_f32 v[12:13], v[12:13], v[120:121]
  v_pk_fma_f32 v[14:15], v[120:121], v[120:121], v[14:15]
  v_pk_add_f32 v[180:181], v[180:181], v[122:123]
  v_pk_fma_f32 v[182:183], v[122:123], v[122:123], v[182:183]
  v_pk_add_f32 v[12:13], v[12:13], v[124:125]
  v_pk_fma_f32 v[14:15], v[124:125], v[124:125], v[14:15]
  v_pk_add_f32 v[180:181], v[180:181], v[126:127]
  v_pk_fma_f32 v[182:183], v[126:127], v[126:127], v[182:183]
  v_pk_add_f32 v[12:13], v[12:13], v[128:129]
  v_pk_fma_f32 v[14:15], v[128:129], v[128:129], v[14:15]
  v_pk_add_f32 v[180:181], v[180:181], v[130:131]
  v_pk_fma_f32 v[182:183], v[130:131], v[130:131], v[182:183]
  v_pk_add_f32 v[12:13], v[12:13], v[132:133]
  v_pk_fma_f32 v[14:15], v[132:133], v[132:133], v[14:15]
  v_pk_add_f32 v[180:181], v[180:181], v[134:135]
  v_pk_fma_f32 v[182:183], v[134:135], v[134:135], v[182:183]
  v_mfma_f32_16x16x32_bf16 v[20:23], a[220:223], v[216:219], 0
  v_pk_fma_f16 v184, v184, v48, 0.5 op_sel_hi:[1,1,0] clamp
  v_pk_fma_f16 v185, v185, v49, 0.5 op_sel_hi:[1,1,0] clamp
  v_add_f32 v12, v12, v13
  v_add_f32 v14, v14, v15
  v_mfma_f32_16x16x32_bf16 v[28:31], a[220:223], v[220:223], 0
  v_pk_fma_f16 v186, v186, v50, 0.5 op_sel_hi:[1,1,0] clamp
  v_pk_fma_f16 v187, v187, v51, 0.5 op_sel_hi:[1,1,0] clamp
  v_add_f32 v180, v180, v181
  v_add_f32 v182, v182, v183
  v_mfma_f32_16x16x32_bf16 v[16:19], a[224:227], v[224:227], v[16:19]
  v_pk_mul_f16 v184, v184, v48
  v_pk_mul_f16 v185, v185, v49
  v_permlane32_swap_b32_e64 v12, v14
  v_mfma_f32_16x16x32_bf16 v[24:27], a[224:227], v[228:231], v[24:27]
  v_pk_mul_f16 v186, v186, v50
  v_pk_mul_f16 v187, v187, v51
  v_permlane32_swap_b32_e64 v180, v182
  v_mfma_f32_16x16x32_bf16 v[20:23], a[228:231], v[224:227], v[20:23]
  v_pk_fma_f16 v56, v52, v52, s20 op_sel_hi:[1,1,0] neg_lo:[1,0,0] neg_hi:[1,0,0] clamp
  v_pk_fma_f16 v57, v53, v53, s20 op_sel_hi:[1,1,0] neg_lo:[1,0,0] neg_hi:[1,0,0] clamp
  v_add_f32 v12, v12, v14
  v_add_f32 v180, v180, v182
  v_mfma_f32_16x16x32_bf16 v[28:31], a[228:231], v[228:231], v[28:31]
  v_pk_fma_f16 v58, v54, v54, s20 op_sel_hi:[1,1,0] neg_lo:[1,0,0] neg_hi:[1,0,0] clamp
  v_pk_fma_f16 v59, v55, v55, s20 op_sel_hi:[1,1,0] neg_lo:[1,0,0] neg_hi:[1,0,0] clamp
  v_permlane16_swap_b32_e64 v12, v180
  v_mfma_f32_16x16x32_bf16 v[16:19], a[232:235], v[232:235], v[16:19]
  v_pk_fma_f16 v188, v56, v56, s20 op_sel:[0,0,1]
  v_pk_fma_f16 v189, v57, v57, s20 op_sel:[0,0,1]
  v_add_f32 v12, v12, v180
  v_mov_b32 v14, v12
  v_mfma_f32_16x16x32_bf16 v[24:27], a[232:235], v[236:239], v[24:27]
  v_pk_fma_f16 v190, v58, v58, s20 op_sel:[0,0,1]
  v_pk_fma_f16 v191, v59, v59, s20 op_sel:[0,0,1]
  v_permlane32_swap_b32_e64 v12, v14
  v_mfma_f32_16x16x32_bf16 v[20:23], a[236:239], v[232:235], v[20:23]
  v_pk_fma_f16 v188, v188, v56, s21 op_sel_hi:[1,1,0]
  v_pk_fma_f16 v189, v189, v57, s21 op_sel_hi:[1,1,0]
  v_mul_f32_e64 v12, s24, v12
  v_mul_f32 v13, s24, v14
  v_mfma_f32_16x16x32_bf16 v[28:31], a[236:239], v[236:239], v[28:31]
  s_waitcnt lgkmcnt(0)
  v_pk_fma_f16 v190, v190, v58, s21 op_sel_hi:[1,1,0]
  v_pk_fma_f16 v191, v191, v59, s21 op_sel_hi:[1,1,0]
  v_fma_f32 v13, -v12, v12, v13
  v_max_f32_e64 v13, 0, v13
  v_mfma_f32_16x16x32_f16 v[64:67], v[184:187], v[192:195], v[64:67]
  v_pk_fma_f16 v188, v188, v52, 0.5 op_sel_hi:[1,1,0] clamp
  v_pk_fma_f16 v189, v189, v53, 0.5 op_sel_hi:[1,1,0] clamp
  v_add_f32_e64 v13, s25, v13
  v_mfma_f32_16x16x32_f16 v[68:71], v[184:187], v[196:199], v[68:71]
  v_pk_fma_f16 v190, v190, v54, 0.5 op_sel_hi:[1,1,0] clamp
  v_pk_fma_f16 v191, v191, v55, 0.5 op_sel_hi:[1,1,0] clamp
  v_rsq_f32_e64 v13, v13
  v_mfma_f32_16x16x32_f16 v[72:75], v[184:187], v[200:203], v[72:75]
  v_pk_mul_f16 v188, v188, v52
  v_pk_mul_f16 v189, v189, v53
  v_mul_f32_e64 v14, s22, v13
  v_mul_f32_e64 v12, -v12, v14
  v_mfma_f32_16x16x32_f16 v[76:79], v[184:187], v[204:207], v[76:79]
  v_pk_mul_f16 v190, v190, v54
  v_pk_mul_f16 v191, v191, v55
  v_mov_b32_e64 v182, v14
  v_mov_b32_e64 v180, v12
  v_mfma_f32_16x16x32_f16 v[80:83], v[184:187], v[208:211], v[80:83]
  v_cvt_pk_f16_f32 v48, v16, v17
  v_cvt_pk_f16_f32 v49, v18, v19
  v_permlane16_swap_b32_e64 v14, v182
  v_mfma_f32_16x16x32_f16 v[84:87], v[184:187], v[212:215], v[84:87]
  v_cvt_pk_f16_f32 v50, v20, v21
  v_cvt_pk_f16_f32 v51, v22, v23
  v_permlane16_swap_b32_e64 v12, v180
  v_mfma_f32_16x16x32_f16 v[88:91], v[188:191], v[192:195], v[88:91]
  ds_read_b128 v[192:195], v0 offset:61440
  v_cvt_pk_f16_f32 v52, v24, v25
  v_cvt_pk_f16_f32 v53, v26, v27
  v_mfma_f32_16x16x32_f16 v[92:95], v[188:191], v[196:199], v[92:95]
  ds_read_b128 v[196:199], v0 offset:62464
  v_cvt_pk_f16_f32 v54, v28, v29
  v_cvt_pk_f16_f32 v55, v30, v31
  v_mfma_f32_16x16x32_f16 v[96:99], v[188:191], v[200:203], v[96:99]
  ds_read_b128 v[200:203], v0 offset:63488
  v_pk_fma_f16 v56, v48, v48, s20 op_sel_hi:[1,1,0] neg_lo:[1,0,0] neg_hi:[1,0,0] clamp
  v_pk_fma_f16 v57, v49, v49, s20 op_sel_hi:[1,1,0] neg_lo:[1,0,0] neg_hi:[1,0,0] clamp
  v_mfma_f32_16x16x32_f16 v[100:103], v[188:191], v[204:207], v[100:103]
  ds_read_b128 v[204:207], v0 offset:64512
  v_pk_fma_f16 v58, v50, v50, s20 op_sel_hi:[1,1,0] neg_lo:[1,0,0] neg_hi:[1,0,0] clamp
  v_pk_fma_f16 v59, v51, v51, s20 op_sel_hi:[1,1,0] neg_lo:[1,0,0] neg_hi:[1,0,0] clamp
  v_mfma_f32_16x16x32_f16 v[104:107], v[188:191], v[208:211], v[104:107]
  ds_read_b128 v[208:211], v1
  v_pk_fma_f16 v184, v56, v56, s20 op_sel:[0,0,1]
  v_pk_fma_f16 v185, v57, v57, s20 op_sel:[0,0,1]
  v_mfma_f32_16x16x32_f16 v[108:111], v[188:191], v[212:215], v[108:111]
  ds_read_b128 v[212:215], v1 offset:1024
  v_pk_fma_f16 v186, v58, v58, s20 op_sel:[0,0,1]
  v_pk_fma_f16 v187, v59, v59, s20 op_sel:[0,0,1]
  v_fma_f32 v112, v112, v14, v12
  v_fma_f32 v113, v113, v14, v12
  v_fma_f32 v114, v114, v182, v180
  v_fma_f32 v115, v115, v182, v180
  v_pk_fma_f32 v[116:117], v[116:117], v[14:15], v[12:13] op_sel_hi:[1,0,0]
  v_pk_fma_f32 v[118:119], v[118:119], v[182:183], v[180:181] op_sel_hi:[1,0,0]
  v_pk_fma_f32 v[120:121], v[120:121], v[14:15], v[12:13] op_sel_hi:[1,0,0]
  v_pk_fma_f32 v[122:123], v[122:123], v[182:183], v[180:181] op_sel_hi:[1,0,0]
  v_pk_fma_f32 v[124:125], v[124:125], v[14:15], v[12:13] op_sel_hi:[1,0,0]
  v_pk_fma_f32 v[126:127], v[126:127], v[182:183], v[180:181] op_sel_hi:[1,0,0]
  v_pk_fma_f32 v[128:129], v[128:129], v[14:15], v[12:13] op_sel_hi:[1,0,0]
  v_pk_fma_f32 v[130:131], v[130:131], v[182:183], v[180:181] op_sel_hi:[1,0,0]
  v_pk_fma_f32 v[132:133], v[132:133], v[14:15], v[12:13] op_sel_hi:[1,0,0]
  v_pk_fma_f32 v[134:135], v[134:135], v[182:183], v[180:181] op_sel_hi:[1,0,0]
  v_pk_fma_f32 v[136:137], v[136:137], v[14:15], v[12:13] op_sel_hi:[1,0,0]
  v_pk_fma_f32 v[138:139], v[138:139], v[182:183], v[180:181] op_sel_hi:[1,0,0]
  v_pk_fma_f32 v[140:141], v[140:141], v[14:15], v[12:13] op_sel_hi:[1,0,0]
  v_pk_fma_f32 v[142:143], v[142:143], v[182:183], v[180:181] op_sel_hi:[1,0,0]
  v_pk_fma_f32 v[144:145], v[144:145], v[14:15], v[12:13] op_sel_hi:[1,0,0]
  v_pk_fma_f32 v[146:147], v[146:147], v[182:183], v[180:181] op_sel_hi:[1,0,0]
  v_pk_fma_f32 v[148:149], v[148:149], v[14:15], v[12:13] op_sel_hi:[1,0,0]
  v_pk_fma_f32 v[150:151], v[150:151], v[182:183], v[180:181] op_sel_hi:[1,0,0]
  v_pk_fma_f32 v[152:153], v[152:153], v[14:15], v[12:13] op_sel_hi:[1,0,0]
  v_pk_fma_f32 v[154:155], v[154:155], v[182:183], v[180:181] op_sel_hi:[1,0,0]
  v_pk_fma_f32 v[156:157], v[156:157], v[14:15], v[12:13] op_sel_hi:[1,0,0]
  v_pk_fma_f32 v[158:159], v[158:159], v[182:183], v[180:181] op_sel_hi:[1,0,0]
  v_mfma_f32_16x16x32_bf16 v[16:19], v[32:35], v[216:219], 0
  v_pk_fma_f16 v184, v184, v56, s21 op_sel_hi:[1,1,0]
  v_pk_fma_f16 v185, v185, v57, s21 op_sel_hi:[1,1,0]
  v_cndmask_b32 v157, v157, v250, s[12:13]
  v_cndmask_b32 v159, v159, v250, s[12:13]
  v_mfma_f32_16x16x32_bf16 v[24:27], v[32:35], v[220:223], 0
  ds_read_b128 v[180:183], v0 offset:23552
  v_pk_fma_f16 v186, v186, v58, s21 op_sel_hi:[1,1,0]
  v_pk_fma_f16 v187, v187, v59, s21 op_sel_hi:[1,1,0]
  v_mfma_f32_16x16x32_bf16 v[20:23], v[36:39], v[216:219], 0
  v_pk_fma_f16 v184, v184, v48, 0.5 op_sel_hi:[1,1,0] clamp
  v_pk_fma_f16 v185, v185, v49, 0.5 op_sel_hi:[1,1,0] clamp
  v_mfma_f32_16x16x32_bf16 v[28:31], v[36:39], v[220:223], 0
  v_pk_fma_f16 v186, v186, v50, 0.5 op_sel_hi:[1,1,0] clamp
  v_pk_fma_f16 v187, v187, v51, 0.5 op_sel_hi:[1,1,0] clamp
  v_cvt_pk_bf16_f32 v216, v112, v113
  v_cvt_pk_bf16_f32 v217, v116, v117
  v_mfma_f32_16x16x32_bf16 v[16:19], v[40:43], v[224:227], v[16:19]
  v_pk_mul_f16 v184, v184, v48
  v_pk_mul_f16 v185, v185, v49
  v_cvt_pk_bf16_f32 v218, v120, v121
  v_cvt_pk_bf16_f32 v219, v124, v125
  v_mfma_f32_16x16x32_bf16 v[24:27], v[40:43], v[228:231], v[24:27]
  v_pk_mul_f16 v186, v186, v50
  v_pk_mul_f16 v187, v187, v51
  v_cvt_pk_bf16_f32 v220, v114, v115
  v_cvt_pk_bf16_f32 v221, v118, v119
  v_mfma_f32_16x16x32_bf16 v[20:23], v[44:47], v[224:227], v[20:23]
  v_pk_fma_f16 v56, v52, v52, s20 op_sel_hi:[1,1,0] neg_lo:[1,0,0] neg_hi:[1,0,0] clamp
  v_pk_fma_f16 v57, v53, v53, s20 op_sel_hi:[1,1,0] neg_lo:[1,0,0] neg_hi:[1,0,0] clamp
  v_cvt_pk_bf16_f32 v222, v122, v123
  v_cvt_pk_bf16_f32 v223, v126, v127
  v_mfma_f32_16x16x32_bf16 v[28:31], v[44:47], v[228:231], v[28:31]
  v_pk_fma_f16 v58, v54, v54, s20 op_sel_hi:[1,1,0] neg_lo:[1,0,0] neg_hi:[1,0,0] clamp
  v_pk_fma_f16 v59, v55, v55, s20 op_sel_hi:[1,1,0] neg_lo:[1,0,0] neg_hi:[1,0,0] clamp
  v_cvt_pk_bf16_f32 v224, v128, v129
  v_cvt_pk_bf16_f32 v225, v132, v133
  v_mfma_f32_16x16x32_bf16 v[16:19], v[60:63], v[232:235], v[16:19]
  v_pk_fma_f16 v188, v56, v56, s20 op_sel:[0,0,1]
  v_pk_fma_f16 v189, v57, v57, s20 op_sel:[0,0,1]
  v_cvt_pk_bf16_f32 v226, v136, v137
  v_cvt_pk_bf16_f32 v227, v140, v141
  v_mfma_f32_16x16x32_bf16 v[24:27], v[60:63], v[236:239], v[24:27]
  v_pk_fma_f16 v190, v58, v58, s20 op_sel:[0,0,1]
  v_pk_fma_f16 v191, v59, v59, s20 op_sel:[0,0,1]
  v_cvt_pk_bf16_f32 v228, v130, v131
  v_cvt_pk_bf16_f32 v229, v134, v135
  v_mfma_f32_16x16x32_bf16 v[20:23], v[244:247], v[232:235], v[20:23]
  s_nop 0
  v_pk_fma_f16 v188, v188, v56, s21 op_sel_hi:[1,1,0]
  v_pk_fma_f16 v189, v189, v57, s21 op_sel_hi:[1,1,0]
  v_cvt_pk_bf16_f32 v230, v138, v139
  v_cvt_pk_bf16_f32 v231, v142, v143
  v_mfma_f32_16x16x32_bf16 v[28:31], v[244:247], v[236:239], v[28:31]
  s_waitcnt lgkmcnt(0)
  v_pk_fma_f16 v190, v190, v58, s21 op_sel_hi:[1,1,0]
  v_pk_fma_f16 v191, v191, v59, s21 op_sel_hi:[1,1,0]
  v_cvt_pk_bf16_f32 v232, v144, v145
  v_cvt_pk_bf16_f32 v233, v148, v149
  v_mfma_f32_16x16x32_f16 v[64:67], v[184:187], v[192:195], v[64:67]
  v_pk_fma_f16 v188, v188, v52, 0.5 op_sel_hi:[1,1,0] clamp
  v_pk_fma_f16 v189, v189, v53, 0.5 op_sel_hi:[1,1,0] clamp
  v_cvt_pk_bf16_f32 v234, v152, v153
  v_cvt_pk_bf16_f32 v235, v156, v157
  v_mfma_f32_16x16x32_f16 v[68:71], v[184:187], v[196:199], v[68:71]
  v_pk_fma_f16 v190, v190, v54, 0.5 op_sel_hi:[1,1,0] clamp
  v_pk_fma_f16 v191, v191, v55, 0.5 op_sel_hi:[1,1,0] clamp
  v_cvt_pk_bf16_f32 v236, v146, v147
  v_cvt_pk_bf16_f32 v237, v150, v151
  v_mfma_f32_16x16x32_f16 v[72:75], v[184:187], v[200:203], v[72:75]
  v_pk_mul_f16 v188, v188, v52
  v_pk_mul_f16 v189, v189, v53
  v_cvt_pk_bf16_f32 v238, v154, v155
  v_cvt_pk_bf16_f32 v239, v158, v159
  v_mfma_f32_16x16x32_f16 v[76:79], v[184:187], v[204:207], v[76:79]
  v_pk_mul_f16 v190, v190, v54
  v_pk_mul_f16 v191, v191, v55
  v_mfma_f32_16x16x32_f16 v[80:83], v[184:187], v[208:211], v[80:83]
  v_cvt_pk_f16_f32 v48, v16, v17
  v_cvt_pk_f16_f32 v49, v18, v19
  v_mfma_f32_16x16x32_f16 v[84:87], v[184:187], v[212:215], v[84:87]
  v_cvt_pk_f16_f32 v50, v20, v21
  v_cvt_pk_f16_f32 v51, v22, v23
  v_mfma_f32_16x16x32_f16 v[88:91], v[188:191], v[192:195], v[88:91]
  ds_read_b128 v[192:195], v1 offset:2048
  v_cvt_pk_f16_f32 v52, v24, v25
  v_cvt_pk_f16_f32 v53, v26, v27
  v_mfma_f32_16x16x32_f16 v[92:95], v[188:191], v[196:199], v[92:95]
  ds_read_b128 v[196:199], v1 offset:3072
  v_cvt_pk_f16_f32 v54, v28, v29
  v_cvt_pk_f16_f32 v55, v30, v31
  v_mfma_f32_16x16x32_f16 v[96:99], v[188:191], v[200:203], v[96:99]
  ds_read_b128 v[200:203], v1 offset:4096
  v_pk_fma_f16 v56, v48, v48, s20 op_sel_hi:[1,1,0] neg_lo:[1,0,0] neg_hi:[1,0,0] clamp
  v_pk_fma_f16 v57, v49, v49, s20 op_sel_hi:[1,1,0] neg_lo:[1,0,0] neg_hi:[1,0,0] clamp
  v_mfma_f32_16x16x32_f16 v[100:103], v[188:191], v[204:207], v[100:103]
  ds_read_b128 v[204:207], v1 offset:5120
  v_pk_fma_f16 v58, v50, v50, s20 op_sel_hi:[1,1,0] neg_lo:[1,0,0] neg_hi:[1,0,0] clamp
  v_pk_fma_f16 v59, v51, v51, s20 op_sel_hi:[1,1,0] neg_lo:[1,0,0] neg_hi:[1,0,0] clamp
  v_mfma_f32_16x16x32_f16 v[104:107], v[188:191], v[208:211], v[104:107]
  ds_read_b128 v[208:211], v1 offset:6144
  v_pk_fma_f16 v184, v56, v56, s20 op_sel:[0,0,1]
  v_pk_fma_f16 v185, v57, v57, s20 op_sel:[0,0,1]
  v_mfma_f32_16x16x32_f16 v[108:111], v[188:191], v[212:215], v[108:111]
  ds_read_b128 v[212:215], v1 offset:7168
  ds_read2_b32 v[144:145], v5 offset0:0 offset1:3
  v_pk_fma_f16 v186, v58, v58, s20 op_sel:[0,0,1]
  v_pk_fma_f16 v187, v59, v59, s20 op_sel:[0,0,1]
  v_mfma_f32_16x16x32_bf16 v[16:19], v[160:163], v[216:219], 0
  v_pk_fma_f16 v184, v184, v56, s21 op_sel_hi:[1,1,0]
  v_pk_fma_f16 v185, v185, v57, s21 op_sel_hi:[1,1,0]
  v_mfma_f32_16x16x32_bf16 v[24:27], v[160:163], v[220:223], 0
  ds_read_b128 v[160:163], v2
  v_pk_fma_f16 v186, v186, v58, s21 op_sel_hi:[1,1,0]
  v_pk_fma_f16 v187, v187, v59, s21 op_sel_hi:[1,1,0]
  v_mfma_f32_16x16x32_bf16 v[20:23], v[164:167], v[216:219], 0
  v_pk_fma_f16 v184, v184, v48, 0.5 op_sel_hi:[1,1,0] clamp
  v_pk_fma_f16 v185, v185, v49, 0.5 op_sel_hi:[1,1,0] clamp
  v_mfma_f32_16x16x32_bf16 v[28:31], v[164:167], v[220:223], 0
  ds_read_b128 v[164:167], v2 offset:256
  ds_read2_b32 v[146:147], v5 offset0:6 offset1:9
  v_pk_fma_f16 v186, v186, v50, 0.5 op_sel_hi:[1,1,0] clamp
  v_pk_fma_f16 v187, v187, v51, 0.5 op_sel_hi:[1,1,0] clamp
  v_mfma_f32_16x16x32_bf16 v[16:19], v[168:171], v[224:227], v[16:19]
  v_pk_mul_f16 v184, v184, v48
  v_pk_mul_f16 v185, v185, v49
  v_mfma_f32_16x16x32_bf16 v[24:27], v[168:171], v[228:231], v[24:27]
  ds_read_b128 v[168:171], v2 offset:512
  v_pk_mul_f16 v186, v186, v50
  v_pk_mul_f16 v187, v187, v51
  v_mfma_f32_16x16x32_bf16 v[20:23], v[172:175], v[224:227], v[20:23]
  ds_read2_b32 v[148:149], v5 offset0:1 offset1:4
  v_pk_fma_f16 v56, v52, v52, s20 op_sel_hi:[1,1,0] neg_lo:[1,0,0] neg_hi:[1,0,0] clamp
  v_pk_fma_f16 v57, v53, v53, s20 op_sel_hi:[1,1,0] neg_lo:[1,0,0] neg_hi:[1,0,0] clamp
  v_mfma_f32_16x16x32_bf16 v[28:31], v[172:175], v[228:231], v[28:31]
  ds_read_b128 v[172:175], v2 offset:768
  v_pk_fma_f16 v58, v54, v54, s20 op_sel_hi:[1,1,0] neg_lo:[1,0,0] neg_hi:[1,0,0] clamp
  v_pk_fma_f16 v59, v55, v55, s20 op_sel_hi:[1,1,0] neg_lo:[1,0,0] neg_hi:[1,0,0] clamp
  v_mfma_f32_16x16x32_bf16 v[16:19], v[176:179], v[232:235], v[16:19]
  v_pk_fma_f16 v188, v56, v56, s20 op_sel:[0,0,1]
  v_pk_fma_f16 v189, v57, v57, s20 op_sel:[0,0,1]
  v_mfma_f32_16x16x32_bf16 v[24:27], v[176:179], v[236:239], v[24:27]
  ds_read_b128 v[176:179], v2 offset:1024
  ds_read2_b32 v[150:151], v5 offset0:7 offset1:10
  v_pk_fma_f16 v190, v58, v58, s20 op_sel:[0,0,1]
  v_pk_fma_f16 v191, v59, v59, s20 op_sel:[0,0,1]
  v_mfma_f32_16x16x32_bf16 v[20:23], v[180:183], v[232:235], v[20:23]
  s_nop 0
  v_pk_fma_f16 v188, v188, v56, s21 op_sel_hi:[1,1,0]
  v_pk_fma_f16 v189, v189, v57, s21 op_sel_hi:[1,1,0]
  v_mfma_f32_16x16x32_bf16 v[28:31], v[180:183], v[236:239], v[28:31]
  s_waitcnt lgkmcnt(5)
  ds_read_b128 v[180:183], v2 offset:1280
  v_pk_fma_f16 v190, v190, v58, s21 op_sel_hi:[1,1,0]
  v_pk_fma_f16 v191, v191, v59, s21 op_sel_hi:[1,1,0]
  v_mfma_f32_16x16x32_f16 v[64:67], v[184:187], v[192:195], v[64:67]
  ds_read2_b32 v[152:153], v5 offset0:2 offset1:5
  v_pk_fma_f16 v188, v188, v52, 0.5 op_sel_hi:[1,1,0] clamp
  v_pk_fma_f16 v189, v189, v53, 0.5 op_sel_hi:[1,1,0] clamp
  v_mfma_f32_16x16x32_f16 v[68:71], v[184:187], v[196:199], v[68:71]
  v_pk_fma_f16 v190, v190, v54, 0.5 op_sel_hi:[1,1,0] clamp
  v_pk_fma_f16 v191, v191, v55, 0.5 op_sel_hi:[1,1,0] clamp
  v_mfma_f32_16x16x32_f16 v[72:75], v[184:187], v[200:203], v[72:75]
  v_pk_mul_f16 v188, v188, v52
  v_pk_mul_f16 v189, v189, v53
  v_mfma_f32_16x16x32_f16 v[76:79], v[184:187], v[204:207], v[76:79]
  v_pk_mul_f16 v190, v190, v54
  v_pk_mul_f16 v191, v191, v55
  v_cvt_pk_bf16_f32 v112, v64, v68
  v_cvt_pk_bf16_f32 v116, v65, v69
  v_mfma_f32_16x16x32_f16 v[80:83], v[184:187], v[208:211], v[80:83]
  ds_read2_b32 v[154:155], v5 offset0:8 offset1:11
  v_cvt_pk_bf16_f32 v120, v66, v70
  v_cvt_pk_bf16_f32 v124, v67, v71
  v_mfma_f32_16x16x32_f16 v[84:87], v[184:187], v[212:215], v[84:87]
  v_cvt_pk_bf16_f32 v113, v72, v76
  v_cvt_pk_bf16_f32 v117, v73, v77
  v_cvt_pk_bf16_f32 v121, v74, v78
  v_cvt_pk_bf16_f32 v125, v75, v79
  v_mfma_f32_16x16x32_f16 v[88:91], v[188:191], v[192:195], v[88:91]
  ds_read_b128 v[192:195], v1 offset:8192
  ds_read2_b32 v[156:157], v251 offset0:0 offset1:3
  v_mfma_f32_16x16x32_f16 v[92:95], v[188:191], v[196:199], v[92:95]
  ds_read_b128 v[196:199], v1 offset:9216
  v_cvt_pk_bf16_f32 v114, v80, v84
  v_cvt_pk_bf16_f32 v118, v81, v85
  v_cvt_pk_bf16_f32 v122, v82, v86
  v_mfma_f32_16x16x32_f16 v[96:99], v[188:191], v[200:203], v[96:99]
  ds_read_b128 v[200:203], v1 offset:10240
  v_cvt_pk_f16_f32 v48, v16, v17
  v_cvt_pk_f16_f32 v49, v18, v19
  v_cvt_pk_bf16_f32 v126, v83, v87
  v_mfma_f32_16x16x32_f16 v[100:103], v[188:191], v[204:207], v[100:103]
  ds_read_b128 v[204:207], v1 offset:11264
  v_cvt_pk_f16_f32 v50, v20, v21
  v_cvt_pk_f16_f32 v51, v22, v23
  v_cvt_pk_bf16_f32 v128, v88, v92
  v_mfma_f32_16x16x32_f16 v[104:107], v[188:191], v[208:211], v[104:107]
  ds_read_b128 v[208:211], v1 offset:12288
  v_cvt_pk_f16_f32 v52, v24, v25
  v_cvt_pk_f16_f32 v53, v26, v27
  v_cvt_pk_bf16_f32 v132, v89, v93
  v_mfma_f32_16x16x32_f16 v[108:111], v[188:191], v[212:215], v[108:111]
  ds_read_b128 v[212:215], v1 offset:13312
  v_cvt_pk_f16_f32 v54, v28, v29
  v_cvt_pk_f16_f32 v55, v30, v31
  v_cvt_pk_bf16_f32 v136, v90, v94
  v_mfma_f32_16x16x32_bf16 v[16:19], a[0:3], v[216:219], 0
  ds_read2_b32 v[158:159], v251 offset0:6 offset1:9
  v_pk_fma_f16 v56, v48, v48, s20 op_sel_hi:[1,1,0] neg_lo:[1,0,0] neg_hi:[1,0,0] clamp
  v_pk_fma_f16 v57, v49, v49, s20 op_sel_hi:[1,1,0] neg_lo:[1,0,0] neg_hi:[1,0,0] clamp
  v_cvt_pk_bf16_f32 v140, v91, v95
  v_mfma_f32_16x16x32_bf16 v[24:27], a[0:3], v[220:223], 0
  v_pk_fma_f16 v58, v50, v50, s20 op_sel_hi:[1,1,0] neg_lo:[1,0,0] neg_hi:[1,0,0] clamp
  v_pk_fma_f16 v59, v51, v51, s20 op_sel_hi:[1,1,0] neg_lo:[1,0,0] neg_hi:[1,0,0] clamp
  v_cvt_pk_bf16_f32 v129, v96, v100
  v_cvt_pk_bf16_f32 v133, v97, v101
  v_mfma_f32_16x16x32_bf16 v[20:23], a[4:7], v[216:219], 0
  v_pk_fma_f16 v184, v56, v56, s20 op_sel:[0,0,1]
  v_pk_fma_f16 v185, v57, v57, s20 op_sel:[0,0,1]
  v_cvt_pk_bf16_f32 v137, v98, v102
  v_cvt_pk_bf16_f32 v141, v99, v103
  v_mfma_f32_16x16x32_bf16 v[28:31], a[4:7], v[220:223], 0
  v_pk_fma_f16 v186, v58, v58, s20 op_sel:[0,0,1]
  v_pk_fma_f16 v187, v59, v59, s20 op_sel:[0,0,1]
  v_cvt_pk_bf16_f32 v130, v104, v108
  v_cvt_pk_bf16_f32 v134, v105, v109
  v_mfma_f32_16x16x32_bf16 v[16:19], a[8:11], v[224:227], v[16:19]
  v_pk_fma_f16 v184, v184, v56, s21 op_sel_hi:[1,1,0]
  v_pk_fma_f16 v185, v185, v57, s21 op_sel_hi:[1,1,0]
  v_cvt_pk_bf16_f32 v138, v106, v110
  v_cvt_pk_bf16_f32 v142, v107, v111
  v_mfma_f32_16x16x32_bf16 v[24:27], a[8:11], v[228:231], v[24:27]
  buffer_store_dwordx3 v[112:114], v10, s[8:11], s28 offen sc1 nt
  v_pk_fma_f16 v186, v186, v58, s21 op_sel_hi:[1,1,0]
  v_pk_fma_f16 v187, v187, v59, s21 op_sel_hi:[1,1,0]
  v_mfma_f32_16x16x32_bf16 v[20:23], a[12:15], v[224:227], v[20:23]
  v_pk_fma_f16 v184, v184, v48, 0.5 op_sel_hi:[1,1,0] clamp
  v_pk_fma_f16 v185, v185, v49, 0.5 op_sel_hi:[1,1,0] clamp
  v_mfma_f32_16x16x32_bf16 v[28:31], a[12:15], v[228:231], v[28:31]
  v_pk_fma_f16 v186, v186, v50, 0.5 op_sel_hi:[1,1,0] clamp
  v_pk_fma_f16 v187, v187, v51, 0.5 op_sel_hi:[1,1,0] clamp
  v_mfma_f32_16x16x32_bf16 v[16:19], a[16:19], v[232:235], v[16:19]
  v_pk_mul_f16 v184, v184, v48
  v_pk_mul_f16 v185, v185, v49
  v_mfma_f32_16x16x32_bf16 v[24:27], a[16:19], v[236:239], v[24:27]
  buffer_store_dwordx3 v[116:118], v10, s[8:11], s28 offen offset:384 sc1 nt
  v_pk_mul_f16 v186, v186, v50
  v_pk_mul_f16 v187, v187, v51
  v_mfma_f32_16x16x32_bf16 v[20:23], a[20:23], v[232:235], v[20:23]
  v_pk_fma_f16 v56, v52, v52, s20 op_sel_hi:[1,1,0] neg_lo:[1,0,0] neg_hi:[1,0,0] clamp
  v_pk_fma_f16 v57, v53, v53, s20 op_sel_hi:[1,1,0] neg_lo:[1,0,0] neg_hi:[1,0,0] clamp
  v_mfma_f32_16x16x32_bf16 v[28:31], a[20:23], v[236:239], v[28:31]
  s_waitcnt lgkmcnt(0)
  v_pk_fma_f16 v58, v54, v54, s20 op_sel_hi:[1,1,0] neg_lo:[1,0,0] neg_hi:[1,0,0] clamp
  v_pk_fma_f16 v59, v55, v55, s20 op_sel_hi:[1,1,0] neg_lo:[1,0,0] neg_hi:[1,0,0] clamp
  v_mfma_f32_16x16x32_f16 v[64:67], v[184:187], v[192:195], v[160:163]
  s_nop 0
  v_pk_fma_f16 v188, v56, v56, s20 op_sel:[0,0,1]
  v_pk_fma_f16 v189, v57, v57, s20 op_sel:[0,0,1]
  v_mfma_f32_16x16x32_f16 v[68:71], v[184:187], v[196:199], v[164:167]
  v_pk_fma_f16 v190, v58, v58, s20 op_sel:[0,0,1]
  v_pk_fma_f16 v191, v59, v59, s20 op_sel:[0,0,1]
  v_mfma_f32_16x16x32_f16 v[72:75], v[184:187], v[200:203], v[168:171]
  v_pk_fma_f16 v188, v188, v56, s21 op_sel_hi:[1,1,0]
  v_pk_fma_f16 v189, v189, v57, s21 op_sel_hi:[1,1,0]
  v_mfma_f32_16x16x32_f16 v[76:79], v[184:187], v[204:207], v[172:175]
  v_pk_fma_f16 v190, v190, v58, s21 op_sel_hi:[1,1,0]
  v_pk_fma_f16 v191, v191, v59, s21 op_sel_hi:[1,1,0]
  v_mfma_f32_16x16x32_bf16 v[64:67], v[144:147], v[240:243], v[64:67]
  v_pk_fma_f16 v188, v188, v52, 0.5 op_sel_hi:[1,1,0] clamp
  v_pk_fma_f16 v189, v189, v53, 0.5 op_sel_hi:[1,1,0] clamp
  v_mfma_f32_16x16x32_bf16 v[68:71], v[144:147], v[252:255], v[68:71]
  ds_read2_b32 v[144:145], v251 offset0:1 offset1:4
  v_pk_fma_f16 v190, v190, v54, 0.5 op_sel_hi:[1,1,0] clamp
  v_pk_fma_f16 v191, v191, v55, 0.5 op_sel_hi:[1,1,0] clamp
  v_mfma_f32_16x16x32_f16 v[80:83], v[184:187], v[208:211], v[176:179]
  v_pk_mul_f16 v188, v188, v52
  v_pk_mul_f16 v189, v189, v53
  v_mfma_f32_16x16x32_f16 v[84:87], v[184:187], v[212:215], v[180:183]
  v_pk_mul_f16 v190, v190, v54
  v_pk_mul_f16 v191, v191, v55
  v_mfma_f32_16x16x32_bf16 v[72:75], v[148:151], v[240:243], v[72:75]
  ds_read2_b32 v[146:147], v251 offset0:7 offset1:10
  v_cvt_pk_f16_f32 v48, v16, v17
  v_mfma_f32_16x16x32_bf16 v[76:79], v[148:151], v[252:255], v[76:79]
  ds_read2_b32 v[148:149], v251 offset0:2 offset1:5
  v_cvt_pk_f16_f32 v49, v18, v19
  v_mfma_f32_16x16x32_f16 v[88:91], v[188:191], v[192:195], v[160:163]
  ds_read_b128 v[192:195], v1 offset:14336
  v_cvt_pk_f16_f32 v50, v20, v21
  v_mfma_f32_16x16x32_f16 v[92:95], v[188:191], v[196:199], v[164:167]
  ds_read_b128 v[196:199], v1 offset:15360
  v_cvt_pk_f16_f32 v51, v22, v23
  v_mfma_f32_16x16x32_bf16 v[80:83], v[152:155], v[240:243], v[80:83]
  ds_read2_b32 v[150:151], v251 offset0:8 offset1:11
  v_subrev_u32 v14, 0x4100, v5
  v_add_u32 v5, 0x8200, v5
  v_min_u32_e64 v5, v14, v5
  v_mfma_f32_16x16x32_bf16 v[84:87], v[152:155], v[252:255], v[84:87]
  v_subrev_u32 v14, 0x4100, v251
  v_add_u32 v251, 0x8200, v251
  v_min_u32_e64 v251, v14, v251
  v_subrev_u32 v14, 0x4100, v4
  v_mfma_f32_16x16x32_f16 v[96:99], v[188:191], v[200:203], v[168:171]
  ds_read_b128 v[200:203], v1 offset:16384
  v_add_u32 v4, 0x8200, v4
  v_min_u32_e64 v4, v14, v4
  v_mfma_f32_16x16x32_f16 v[100:103], v[188:191], v[204:207], v[172:175]
  ds_read_b128 v[204:207], v1 offset:17408
  v_cvt_pk_f16_f32 v52, v24, v25
  v_mfma_f32_16x16x32_bf16 v[88:91], v[156:159], v[240:243], v[88:91]
  v_cvt_pk_f16_f32 v53, v26, v27
  v_cvt_pk_f16_f32 v54, v28, v29
  v_mfma_f32_16x16x32_bf16 v[92:95], v[156:159], v[252:255], v[92:95]
  v_cvt_pk_f16_f32 v55, v30, v31
  v_pk_fma_f16 v56, v48, v48, s20 op_sel_hi:[1,1,0] neg_lo:[1,0,0] neg_hi:[1,0,0] clamp
  v_mfma_f32_16x16x32_f16 v[104:107], v[188:191], v[208:211], v[176:179]
  ds_read_b128 v[208:211], v1 offset:18432
  v_pk_fma_f16 v57, v49, v49, s20 op_sel_hi:[1,1,0] neg_lo:[1,0,0] neg_hi:[1,0,0] clamp
  v_mfma_f32_16x16x32_f16 v[108:111], v[188:191], v[212:215], v[180:183]
  ds_read_b128 v[212:215], v1 offset:19456
  ds_read_b128 v[160:163], v3 offset:2400
  ds_read2_b64 v[176:179], v11 offset0:192 offset1:200
  v_mfma_f32_16x16x32_bf16 v[16:19], a[24:27], v[216:219], 0
  v_pk_fma_f16 v58, v50, v50, s20 op_sel_hi:[1,1,0] neg_lo:[1,0,0] neg_hi:[1,0,0] clamp
  v_pk_fma_f16 v59, v51, v51, s20 op_sel_hi:[1,1,0] neg_lo:[1,0,0] neg_hi:[1,0,0] clamp
  v_mfma_f32_16x16x32_bf16 v[24:27], a[24:27], v[220:223], 0
  buffer_store_dwordx3 v[120:122], v10, s[8:11], s57 offen sc1 nt
  v_mfma_f32_16x16x32_bf16 v[20:23], a[28:31], v[216:219], 0
  v_pk_fma_f16 v184, v56, v56, s20 op_sel:[0,0,1]
  v_pk_fma_f16 v185, v57, v57, s20 op_sel:[0,0,1]
  v_mfma_f32_16x16x32_bf16 v[28:31], a[28:31], v[220:223], 0
  s_waitcnt lgkmcnt(4)
  v_pk_fma_f16 v186, v58, v58, s20 op_sel:[0,0,1]
  v_pk_fma_f16 v187, v59, v59, s20 op_sel:[0,0,1]
  v_mfma_f32_16x16x32_bf16 v[96:99], v[144:147], v[240:243], v[96:99]
  s_nop 0
  v_pk_fma_f16 v184, v184, v56, s21 op_sel_hi:[1,1,0]
  v_pk_fma_f16 v185, v185, v57, s21 op_sel_hi:[1,1,0]
  v_mfma_f32_16x16x32_bf16 v[100:103], v[144:147], v[252:255], v[100:103]
  v_pk_fma_f16 v186, v186, v58, s21 op_sel_hi:[1,1,0]
  v_pk_fma_f16 v187, v187, v59, s21 op_sel_hi:[1,1,0]
  v_mfma_f32_16x16x32_bf16 v[16:19], a[32:35], v[224:227], v[16:19]
  v_pk_fma_f16 v184, v184, v48, 0.5 op_sel_hi:[1,1,0] clamp
  v_pk_fma_f16 v185, v185, v49, 0.5 op_sel_hi:[1,1,0] clamp
  v_mfma_f32_16x16x32_bf16 v[24:27], a[32:35], v[228:231], v[24:27]
  v_pk_fma_f16 v186, v186, v50, 0.5 op_sel_hi:[1,1,0] clamp
  v_pk_fma_f16 v187, v187, v51, 0.5 op_sel_hi:[1,1,0] clamp
  v_mfma_f32_16x16x32_bf16 v[104:107], v[148:151], v[240:243], v[104:107]
  s_nop 0
  v_pk_mul_f16 v184, v184, v48
  v_pk_mul_f16 v185, v185, v49
  v_mfma_f32_16x16x32_bf16 v[108:111], v[148:151], v[252:255], v[108:111]
  s_nop 0
  v_pk_mul_f16 v186, v186, v50
  v_pk_mul_f16 v187, v187, v51
  v_mfma_f32_16x16x32_bf16 v[20:23], a[36:39], v[224:227], v[20:23]
  v_pk_fma_f16 v56, v52, v52, s20 op_sel_hi:[1,1,0] neg_lo:[1,0,0] neg_hi:[1,0,0] clamp
  v_pk_fma_f16 v57, v53, v53, s20 op_sel_hi:[1,1,0] neg_lo:[1,0,0] neg_hi:[1,0,0] clamp
  v_mfma_f32_16x16x32_bf16 v[28:31], a[36:39], v[228:231], v[28:31]
  buffer_store_dwordx3 v[124:126], v10, s[8:11], s57 offen offset:384 sc1 nt
  v_pk_fma_f16 v58, v54, v54, s20 op_sel_hi:[1,1,0] neg_lo:[1,0,0] neg_hi:[1,0,0] clamp
  v_pk_fma_f16 v59, v55, v55, s20 op_sel_hi:[1,1,0] neg_lo:[1,0,0] neg_hi:[1,0,0] clamp
  v_mfma_f32_16x16x32_bf16 v[16:19], a[40:43], v[232:235], v[16:19]
  v_pk_fma_f16 v188, v56, v56, s20 op_sel:[0,0,1]
  v_pk_fma_f16 v189, v57, v57, s20 op_sel:[0,0,1]
  v_mfma_f32_16x16x32_bf16 v[24:27], a[40:43], v[236:239], v[24:27]
  buffer_load_dwordx4 v6, s[4:7], s29 offen lds
  buffer_load_dwordx4 v7, s[4:7], s29 offen offset:1024 lds
  buffer_load_dwordx4 v8, s[4:7], s29 offen offset:2048 lds
  buffer_load_dwordx4 v9, s[4:7], s29 offen offset:3072 lds
  v_pk_fma_f16 v190, v58, v58, s20 op_sel:[0,0,1]
  v_pk_fma_f16 v191, v59, v59, s20 op_sel:[0,0,1]
  v_mfma_f32_16x16x32_bf16 v[20:23], a[44:47], v[232:235], v[20:23]
  s_mov_b32 m0, s31
  v_pk_fma_f16 v188, v188, v56, s21 op_sel_hi:[1,1,0]
  v_pk_fma_f16 v189, v189, v57, s21 op_sel_hi:[1,1,0]
  v_mfma_f32_16x16x32_bf16 v[28:31], a[44:47], v[236:239], v[28:31]
  s_cmp_eq_u32 s26, 1
  v_pk_fma_f16 v190, v190, v58, s21 op_sel_hi:[1,1,0]
  v_pk_fma_f16 v191, v191, v59, s21 op_sel_hi:[1,1,0]
  v_mfma_f32_16x16x32_f16 v[64:67], v[184:187], v[192:195], v[64:67]
  s_cselect_b32 s35, 0x40000000, s23
  v_pk_fma_f16 v188, v188, v52, 0.5 op_sel_hi:[1,1,0] clamp
  v_pk_fma_f16 v189, v189, v53, 0.5 op_sel_hi:[1,1,0] clamp
  v_mfma_f32_16x16x32_f16 v[68:71], v[184:187], v[196:199], v[68:71]
  s_add_u32 s29, s29, s35
  v_pk_fma_f16 v190, v190, v54, 0.5 op_sel_hi:[1,1,0] clamp
  v_pk_fma_f16 v191, v191, v55, 0.5 op_sel_hi:[1,1,0] clamp
  v_mfma_f32_16x16x32_f16 v[72:75], v[184:187], v[200:203], v[72:75]
  v_pk_mul_f16 v188, v188, v52
  v_pk_mul_f16 v189, v189, v53
  v_mfma_f32_16x16x32_f16 v[76:79], v[184:187], v[204:207], v[76:79]
  s_waitcnt lgkmcnt(0)
  buffer_load_dwordx4 v6, s[4:7], s52 offen lds
  buffer_load_dwordx4 v7, s[4:7], s52 offen offset:1024 lds
  buffer_load_dwordx4 v8, s[4:7], s52 offen offset:2048 lds
  buffer_load_dwordx4 v9, s[4:7], s52 offen offset:3072 lds
  v_pk_mul_f16 v190, v190, v54
  v_pk_mul_f16 v191, v191, v55
  v_mfma_f32_16x16x32_f16 v[80:83], v[184:187], v[208:211], v[80:83]
  s_add_u32 s52, s52, s35
  v_cvt_pk_f16_f32 v48, v16, v17
  v_cvt_pk_f16_f32 v49, v18, v19
  v_mfma_f32_16x16x32_f16 v[84:87], v[184:187], v[212:215], v[84:87]
  s_mov_b32 s32, s30
  v_cvt_pk_f16_f32 v50, v20, v21
  v_cvt_pk_f16_f32 v51, v22, v23
  v_mfma_f32_16x16x32_f16 v[88:91], v[188:191], v[192:195], v[88:91]
  s_add_u32 s30, s33, 32
  ds_read_b128 v[192:195], v1 offset:20480
  v_cvt_pk_f16_f32 v52, v24, v25
  v_cvt_pk_f16_f32 v53, v26, v27
  v_mfma_f32_16x16x32_f16 v[92:95], v[188:191], v[196:199], v[92:95]
  s_mov_b32 s33, s31
  ds_read_b128 v[196:199], v1 offset:21504
  v_cvt_pk_f16_f32 v54, v28, v29
  v_cvt_pk_f16_f32 v55, v30, v31
  v_mfma_f32_16x16x32_f16 v[96:99], v[188:191], v[200:203], v[96:99]
  s_sub_u32 s31, s32, 32
  ds_read_b128 v[200:203], v1 offset:22528
  v_pk_fma_f16 v56, v48, v48, s20 op_sel_hi:[1,1,0] neg_lo:[1,0,0] neg_hi:[1,0,0] clamp
  v_pk_fma_f16 v57, v49, v49, s20 op_sel_hi:[1,1,0] neg_lo:[1,0,0] neg_hi:[1,0,0] clamp
  v_mfma_f32_16x16x32_f16 v[100:103], v[188:191], v[204:207], v[100:103]
  buffer_store_dwordx3 v[128:130], v10, s[8:11], s59 offen sc1 nt
  v_pk_fma_f16 v58, v50, v50, s20 op_sel_hi:[1,1,0] neg_lo:[1,0,0] neg_hi:[1,0,0] clamp
  v_pk_fma_f16 v59, v51, v51, s20 op_sel_hi:[1,1,0] neg_lo:[1,0,0] neg_hi:[1,0,0] clamp
  v_mfma_f32_16x16x32_f16 v[104:107], v[188:191], v[208:211], v[104:107]
  ds_read_b128 v[204:207], v1 offset:23552
  ds_read_b128 v[208:211], v1 offset:24576
  v_pk_fma_f16 v184, v56, v56, s20 op_sel:[0,0,1]
  v_pk_fma_f16 v185, v57, v57, s20 op_sel:[0,0,1]
  v_mfma_f32_16x16x32_f16 v[108:111], v[188:191], v[212:215], v[108:111]
  ds_read_b128 v[212:215], v1 offset:25600
  v_pk_fma_f16 v186, v58, v58, s20 op_sel:[0,0,1]
  v_pk_fma_f16 v187, v59, v59, s20 op_sel:[0,0,1]
  v_mfma_f32_16x16x32_bf16 v[16:19], a[48:51], v[216:219], 0
  v_pk_fma_f16 v184, v184, v56, s21 op_sel_hi:[1,1,0]
  v_pk_fma_f16 v185, v185, v57, s21 op_sel_hi:[1,1,0]
  v_mfma_f32_16x16x32_bf16 v[24:27], a[48:51], v[220:223], 0
  v_pk_fma_f16 v186, v186, v58, s21 op_sel_hi:[1,1,0]
  v_pk_fma_f16 v187, v187, v59, s21 op_sel_hi:[1,1,0]
  v_mfma_f32_16x16x32_bf16 v[20:23], a[52:55], v[216:219], 0
  v_pk_fma_f16 v184, v184, v48, 0.5 op_sel_hi:[1,1,0] clamp
  v_pk_fma_f16 v185, v185, v49, 0.5 op_sel_hi:[1,1,0] clamp
  v_mfma_f32_16x16x32_bf16 v[28:31], a[52:55], v[220:223], 0
  v_pk_fma_f16 v186, v186, v50, 0.5 op_sel_hi:[1,1,0] clamp
  v_pk_fma_f16 v187, v187, v51, 0.5 op_sel_hi:[1,1,0] clamp
  v_mfma_f32_16x16x32_bf16 v[16:19], a[56:59], v[224:227], v[16:19]
  v_pk_mul_f16 v184, v184, v48
  v_pk_mul_f16 v185, v185, v49
  v_mfma_f32_16x16x32_bf16 v[24:27], a[56:59], v[228:231], v[24:27]
  buffer_store_dwordx3 v[132:134], v10, s[8:11], s59 offen offset:384 sc1 nt
  v_pk_mul_f16 v186, v186, v50
  v_pk_mul_f16 v187, v187, v51
  v_mfma_f32_16x16x32_bf16 v[20:23], a[60:63], v[224:227], v[20:23]
  v_pk_fma_f16 v56, v52, v52, s20 op_sel_hi:[1,1,0] neg_lo:[1,0,0] neg_hi:[1,0,0] clamp
  v_pk_fma_f16 v57, v53, v53, s20 op_sel_hi:[1,1,0] neg_lo:[1,0,0] neg_hi:[1,0,0] clamp
  v_mfma_f32_16x16x32_bf16 v[28:31], a[60:63], v[228:231], v[28:31]
  v_pk_fma_f16 v58, v54, v54, s20 op_sel_hi:[1,1,0] neg_lo:[1,0,0] neg_hi:[1,0,0] clamp
  v_pk_fma_f16 v59, v55, v55, s20 op_sel_hi:[1,1,0] neg_lo:[1,0,0] neg_hi:[1,0,0] clamp
  v_mfma_f32_16x16x32_bf16 v[16:19], a[64:67], v[232:235], v[16:19]
  v_pk_fma_f16 v188, v56, v56, s20 op_sel:[0,0,1]
  v_pk_fma_f16 v189, v57, v57, s20 op_sel:[0,0,1]
  v_mfma_f32_16x16x32_bf16 v[24:27], a[64:67], v[236:239], v[24:27]
  v_pk_fma_f16 v190, v58, v58, s20 op_sel:[0,0,1]
  v_pk_fma_f16 v191, v59, v59, s20 op_sel:[0,0,1]
  v_mfma_f32_16x16x32_bf16 v[20:23], a[68:71], v[232:235], v[20:23]
  v_pk_fma_f16 v188, v188, v56, s21 op_sel_hi:[1,1,0]
  v_pk_fma_f16 v189, v189, v57, s21 op_sel_hi:[1,1,0]
  v_mfma_f32_16x16x32_bf16 v[28:31], a[68:71], v[236:239], v[28:31]
  s_waitcnt lgkmcnt(0)
  v_pk_fma_f16 v190, v190, v58, s21 op_sel_hi:[1,1,0]
  v_pk_fma_f16 v191, v191, v59, s21 op_sel_hi:[1,1,0]
  v_mfma_f32_16x16x32_f16 v[64:67], v[184:187], v[192:195], v[64:67]
  s_nop 0
  v_pk_fma_f16 v188, v188, v52, 0.5 op_sel_hi:[1,1,0] clamp
  v_pk_fma_f16 v189, v189, v53, 0.5 op_sel_hi:[1,1,0] clamp
  v_mfma_f32_16x16x32_f16 v[68:71], v[184:187], v[196:199], v[68:71]
  buffer_store_dwordx3 v[136:138], v10, s[8:11], s15 offen sc1 nt
  v_pk_fma_f16 v190, v190, v54, 0.5 op_sel_hi:[1,1,0] clamp
  v_pk_fma_f16 v191, v191, v55, 0.5 op_sel_hi:[1,1,0] clamp
  v_mfma_f32_16x16x32_f16 v[72:75], v[184:187], v[200:203], v[72:75]
  v_pk_mul_f16 v188, v188, v52
  v_pk_mul_f16 v189, v189, v53
  v_mfma_f32_16x16x32_f16 v[76:79], v[184:187], v[204:207], v[76:79]
  v_pk_mul_f16 v190, v190, v54
  v_pk_mul_f16 v191, v191, v55
  v_mfma_f32_16x16x32_f16 v[80:83], v[184:187], v[208:211], v[80:83]
  v_cvt_pk_f16_f32 v48, v16, v17
  v_cvt_pk_f16_f32 v49, v18, v19
  v_mfma_f32_16x16x32_f16 v[84:87], v[184:187], v[212:215], v[84:87]
  s_nop 0
  v_cvt_pk_f16_f32 v50, v20, v21
  v_cvt_pk_f16_f32 v51, v22, v23
  v_mfma_f32_16x16x32_f16 v[88:91], v[188:191], v[192:195], v[88:91]
  s_nop 0
  ds_read_b128 v[192:195], v1 offset:26624
  v_cvt_pk_f16_f32 v52, v24, v25
  v_cvt_pk_f16_f32 v53, v26, v27
  v_mfma_f32_16x16x32_f16 v[92:95], v[188:191], v[196:199], v[92:95]
  ds_read_b128 v[196:199], v1 offset:27648
  v_cvt_pk_f16_f32 v54, v28, v29
  v_cvt_pk_f16_f32 v55, v30, v31
  v_mfma_f32_16x16x32_f16 v[96:99], v[188:191], v[200:203], v[96:99]
  ds_read_b128 v[200:203], v1 offset:28672
  v_pk_fma_f16 v56, v48, v48, s20 op_sel_hi:[1,1,0] neg_lo:[1,0,0] neg_hi:[1,0,0] clamp
  v_pk_fma_f16 v57, v49, v49, s20 op_sel_hi:[1,1,0] neg_lo:[1,0,0] neg_hi:[1,0,0] clamp
  v_mfma_f32_16x16x32_f16 v[100:103], v[188:191], v[204:207], v[100:103]
  buffer_store_dwordx3 v[140:142], v10, s[8:11], s15 offen offset:384 sc1 nt
  v_pk_fma_f16 v58, v50, v50, s20 op_sel_hi:[1,1,0] neg_lo:[1,0,0] neg_hi:[1,0,0] clamp
  v_pk_fma_f16 v59, v51, v51, s20 op_sel_hi:[1,1,0] neg_lo:[1,0,0] neg_hi:[1,0,0] clamp
  v_mfma_f32_16x16x32_f16 v[104:107], v[188:191], v[208:211], v[104:107]
  ds_read_b128 v[204:207], v1 offset:29696
  ds_read_b128 v[208:211], v1 offset:30720
  v_pk_fma_f16 v184, v56, v56, s20 op_sel:[0,0,1]
  v_pk_fma_f16 v185, v57, v57, s20 op_sel:[0,0,1]
  v_mfma_f32_16x16x32_f16 v[108:111], v[188:191], v[212:215], v[108:111]
  ds_read_b128 v[212:215], v1 offset:31744
  v_pk_fma_f16 v186, v58, v58, s20 op_sel:[0,0,1]
  v_pk_fma_f16 v187, v59, v59, s20 op_sel:[0,0,1]
  v_mfma_f32_16x16x32_bf16 v[16:19], a[72:75], v[216:219], 0
  v_pk_fma_f16 v184, v184, v56, s21 op_sel_hi:[1,1,0]
  v_pk_fma_f16 v185, v185, v57, s21 op_sel_hi:[1,1,0]
  v_mfma_f32_16x16x32_bf16 v[24:27], a[72:75], v[220:223], 0
  s_nop 0
  v_pk_fma_f16 v186, v186, v58, s21 op_sel_hi:[1,1,0]
  v_pk_fma_f16 v187, v187, v59, s21 op_sel_hi:[1,1,0]
  v_mfma_f32_16x16x32_bf16 v[20:23], a[76:79], v[216:219], 0
  s_nop 0
  v_pk_fma_f16 v184, v184, v48, 0.5 op_sel_hi:[1,1,0] clamp
  v_pk_fma_f16 v185, v185, v49, 0.5 op_sel_hi:[1,1,0] clamp
  v_mfma_f32_16x16x32_bf16 v[28:31], a[76:79], v[220:223], 0
  v_pk_fma_f16 v186, v186, v50, 0.5 op_sel_hi:[1,1,0] clamp
  v_pk_fma_f16 v187, v187, v51, 0.5 op_sel_hi:[1,1,0] clamp
  v_mfma_f32_16x16x32_bf16 v[16:19], a[80:83], v[224:227], v[16:19]
  v_pk_mul_f16 v184, v184, v48
  v_pk_mul_f16 v185, v185, v49
  v_mfma_f32_16x16x32_bf16 v[24:27], a[80:83], v[228:231], v[24:27]
  v_pk_mul_f16 v186, v186, v50
  v_pk_mul_f16 v187, v187, v51
  v_mfma_f32_16x16x32_bf16 v[20:23], a[84:87], v[224:227], v[20:23]
  v_pk_fma_f16 v56, v52, v52, s20 op_sel_hi:[1,1,0] neg_lo:[1,0,0] neg_hi:[1,0,0] clamp
  v_pk_fma_f16 v57, v53, v53, s20 op_sel_hi:[1,1,0] neg_lo:[1,0,0] neg_hi:[1,0,0] clamp
  v_mfma_f32_16x16x32_bf16 v[28:31], a[84:87], v[228:231], v[28:31]
  v_pk_fma_f16 v58, v54, v54, s20 op_sel_hi:[1,1,0] neg_lo:[1,0,0] neg_hi:[1,0,0] clamp
  v_pk_fma_f16 v59, v55, v55, s20 op_sel_hi:[1,1,0] neg_lo:[1,0,0] neg_hi:[1,0,0] clamp
  v_mfma_f32_16x16x32_bf16 v[16:19], a[88:91], v[232:235], v[16:19]
  v_pk_fma_f16 v188, v56, v56, s20 op_sel:[0,0,1]
  v_pk_fma_f16 v189, v57, v57, s20 op_sel:[0,0,1]
  v_mfma_f32_16x16x32_bf16 v[24:27], a[88:91], v[236:239], v[24:27]
  v_pk_fma_f16 v190, v58, v58, s20 op_sel:[0,0,1]
  v_pk_fma_f16 v191, v59, v59, s20 op_sel:[0,0,1]
  v_mfma_f32_16x16x32_bf16 v[20:23], a[92:95], v[232:235], v[20:23]
  s_nop 0
  v_pk_fma_f16 v188, v188, v56, s21 op_sel_hi:[1,1,0]
  v_pk_fma_f16 v189, v189, v57, s21 op_sel_hi:[1,1,0]
  v_mfma_f32_16x16x32_bf16 v[28:31], a[92:95], v[236:239], v[28:31]
  s_waitcnt lgkmcnt(0)
  v_pk_fma_f16 v190, v190, v58, s21 op_sel_hi:[1,1,0]
  v_pk_fma_f16 v191, v191, v59, s21 op_sel_hi:[1,1,0]
  v_mfma_f32_16x16x32_f16 v[64:67], v[184:187], v[192:195], v[64:67]
  v_pk_fma_f16 v188, v188, v52, 0.5 op_sel_hi:[1,1,0] clamp
  v_pk_fma_f16 v189, v189, v53, 0.5 op_sel_hi:[1,1,0] clamp
  v_mfma_f32_16x16x32_f16 v[68:71], v[184:187], v[196:199], v[68:71]
  buffer_load_dword v249, v248, s[4:7], s29 offen
  v_pk_fma_f16 v190, v190, v54, 0.5 op_sel_hi:[1,1,0] clamp
  v_pk_fma_f16 v191, v191, v55, 0.5 op_sel_hi:[1,1,0] clamp
  v_mfma_f32_16x16x32_f16 v[72:75], v[184:187], v[200:203], v[72:75]
  v_pk_mul_f16 v188, v188, v52
  v_pk_mul_f16 v189, v189, v53
  v_mfma_f32_16x16x32_f16 v[76:79], v[184:187], v[204:207], v[76:79]
  v_pk_mul_f16 v190, v190, v54
  v_pk_mul_f16 v191, v191, v55
  v_mfma_f32_16x16x32_f16 v[80:83], v[184:187], v[208:211], v[80:83]
  s_nop 0
  v_cvt_pk_f16_f32 v48, v16, v17
  v_cvt_pk_f16_f32 v49, v18, v19
  v_mfma_f32_16x16x32_f16 v[84:87], v[184:187], v[212:215], v[84:87]
  s_waitcnt vmcnt(5)
  ds_read_b128 v[164:167], v4 offset:96
  ds_read_b128 v[168:171], v4 offset:288
  v_cvt_pk_f16_f32 v50, v20, v21
  v_cvt_pk_f16_f32 v51, v22, v23
  v_mfma_f32_16x16x32_f16 v[88:91], v[188:191], v[192:195], v[88:91]
  ds_read_b128 v[172:175], v4 offset:480
  v_cvt_pk_f16_f32 v52, v24, v25
  v_cvt_pk_f16_f32 v53, v26, v27
  v_mfma_f32_16x16x32_f16 v[92:95], v[188:191], v[196:199], v[92:95]
  v_cvt_pk_f16_f32 v54, v28, v29
  v_cvt_pk_f16_f32 v55, v30, v31
  v_mfma_f32_16x16x32_f16 v[96:99], v[188:191], v[200:203], v[96:99]
  s_sub_u32 s26, s26, 1
  v_pk_fma_f16 v56, v48, v48, s20 op_sel_hi:[1,1,0] neg_lo:[1,0,0] neg_hi:[1,0,0] clamp
  v_pk_fma_f16 v57, v49, v49, s20 op_sel_hi:[1,1,0] neg_lo:[1,0,0] neg_hi:[1,0,0] clamp
  v_mfma_f32_16x16x32_f16 v[100:103], v[188:191], v[204:207], v[100:103]
  s_nop 0
  v_pk_fma_f16 v58, v50, v50, s20 op_sel_hi:[1,1,0] neg_lo:[1,0,0] neg_hi:[1,0,0] clamp
  v_pk_fma_f16 v59, v51, v51, s20 op_sel_hi:[1,1,0] neg_lo:[1,0,0] neg_hi:[1,0,0] clamp
  v_mfma_f32_16x16x32_f16 v[104:107], v[188:191], v[208:211], v[104:107]
  v_pk_fma_f16 v184, v56, v56, s20 op_sel:[0,0,1]
  v_pk_fma_f16 v185, v57, v57, s20 op_sel:[0,0,1]
  v_mfma_f32_16x16x32_f16 v[108:111], v[188:191], v[212:215], v[108:111]
  s_waitcnt lgkmcnt(0)
  v_pk_fma_f16 v186, v58, v58, s20 op_sel:[0,0,1]
  v_pk_fma_f16 v187, v59, v59, s20 op_sel:[0,0,1]
  s_cbranch_scc0 L_loop
  v_mfma_f32_16x16x32_bf16 v[16:19], a[96:99], v[216:219], 0
  s_add_u32 s28, s28, 0x60000
  v_pk_fma_f16 v184, v184, v56, s21 op_sel_hi:[1,1,0]
  v_pk_fma_f16 v185, v185, v57, s21 op_sel_hi:[1,1,0]
  v_pk_fma_f16 v186, v186, v58, s21 op_sel_hi:[1,1,0]
  v_pk_fma_f16 v187, v187, v59, s21 op_sel_hi:[1,1,0]
  v_pk_fma_f16 v184, v184, v48, 0.5 op_sel_hi:[1,1,0] clamp
  v_pk_fma_f16 v185, v185, v49, 0.5 op_sel_hi:[1,1,0] clamp
  v_pk_fma_f16 v186, v186, v50, 0.5 op_sel_hi:[1,1,0] clamp
  v_pk_fma_f16 v187, v187, v51, 0.5 op_sel_hi:[1,1,0] clamp
  v_pk_mul_f16 v184, v184, v48
  v_pk_mul_f16 v185, v185, v49
  v_pk_mul_f16 v186, v186, v50
  v_pk_mul_f16 v187, v187, v51
  v_mfma_f32_16x16x32_bf16 v[24:27], a[96:99], v[220:223], 0
  s_add_u32 s59, s59, 0x60000
  ds_read_b128 v[192:195], v0 offset:24576
  ds_read_b128 v[196:199], v0 offset:25600
  v_pk_fma_f16 v56, v52, v52, s20 op_sel_hi:[1,1,0] neg_lo:[1,0,0] neg_hi:[1,0,0] clamp
  v_pk_fma_f16 v57, v53, v53, s20 op_sel_hi:[1,1,0] neg_lo:[1,0,0] neg_hi:[1,0,0] clamp
  v_mfma_f32_16x16x32_bf16 v[20:23], a[100:103], v[216:219], 0
  s_add_u32 s57, s57, 0x60000
  ds_read_b128 v[200:203], v0 offset:26624
  ds_read_b128 v[204:207], v0 offset:27648
  v_pk_fma_f16 v58, v54, v54, s20 op_sel_hi:[1,1,0] neg_lo:[1,0,0] neg_hi:[1,0,0] clamp
  v_pk_fma_f16 v59, v55, v55, s20 op_sel_hi:[1,1,0] neg_lo:[1,0,0] neg_hi:[1,0,0] clamp
  v_mfma_f32_16x16x32_bf16 v[28:31], a[100:103], v[220:223], 0
  s_add_u32 s15, s15, 0x60000
  ds_read_b128 v[208:211], v0 offset:28672
  ds_read_b128 v[212:215], v0 offset:29696
  v_pk_fma_f16 v188, v56, v56, s20 op_sel:[0,0,1]
  v_pk_fma_f16 v189, v57, v57, s20 op_sel:[0,0,1]
  v_mfma_f32_16x16x32_bf16 v[16:19], a[104:107], v[224:227], v[16:19]
  v_pk_fma_f16 v190, v58, v58, s20 op_sel:[0,0,1]
  v_pk_fma_f16 v191, v59, v59, s20 op_sel:[0,0,1]
  v_mfma_f32_16x16x32_bf16 v[24:27], a[104:107], v[228:231], v[24:27]
  v_pk_fma_f16 v188, v188, v56, s21 op_sel_hi:[1,1,0]
  v_pk_fma_f16 v189, v189, v57, s21 op_sel_hi:[1,1,0]
  v_mfma_f32_16x16x32_bf16 v[20:23], a[108:111], v[224:227], v[20:23]
  s_nop 0
  v_pk_fma_f16 v190, v190, v58, s21 op_sel_hi:[1,1,0]
  v_pk_fma_f16 v191, v191, v59, s21 op_sel_hi:[1,1,0]
  v_mfma_f32_16x16x32_bf16 v[28:31], a[108:111], v[228:231], v[28:31]
  s_nop 0
  v_pk_fma_f16 v188, v188, v52, 0.5 op_sel_hi:[1,1,0] clamp
  v_pk_fma_f16 v189, v189, v53, 0.5 op_sel_hi:[1,1,0] clamp
  v_mfma_f32_16x16x32_bf16 v[16:19], a[112:115], v[232:235], v[16:19]
  v_pk_fma_f16 v190, v190, v54, 0.5 op_sel_hi:[1,1,0] clamp
  v_pk_fma_f16 v191, v191, v55, 0.5 op_sel_hi:[1,1,0] clamp
  v_mfma_f32_16x16x32_bf16 v[24:27], a[112:115], v[236:239], v[24:27]
  v_pk_mul_f16 v188, v188, v52
  v_pk_mul_f16 v189, v189, v53
  v_mfma_f32_16x16x32_bf16 v[20:23], a[116:119], v[232:235], v[20:23]
  v_pk_mul_f16 v190, v190, v54
  v_pk_mul_f16 v191, v191, v55
  v_mfma_f32_16x16x32_bf16 v[28:31], a[116:119], v[236:239], v[28:31]
  s_waitcnt lgkmcnt(0)
  v_cvt_pk_f16_f32 v48, v16, v17
  v_cvt_pk_f16_f32 v49, v18, v19
  v_mfma_f32_16x16x32_f16 v[64:67], v[184:187], v[192:195], v[64:67]
  s_nop 0
  v_cvt_pk_f16_f32 v50, v20, v21
  v_cvt_pk_f16_f32 v51, v22, v23
  v_mfma_f32_16x16x32_f16 v[68:71], v[184:187], v[196:199], v[68:71]
  v_cvt_pk_f16_f32 v52, v24, v25
  v_cvt_pk_f16_f32 v53, v26, v27
  v_mfma_f32_16x16x32_f16 v[72:75], v[184:187], v[200:203], v[72:75]
  v_cvt_pk_f16_f32 v54, v28, v29
  v_cvt_pk_f16_f32 v55, v30, v31
  v_mfma_f32_16x16x32_f16 v[76:79], v[184:187], v[204:207], v[76:79]
  v_pk_fma_f16 v56, v48, v48, s20 op_sel_hi:[1,1,0] neg_lo:[1,0,0] neg_hi:[1,0,0] clamp
  v_pk_fma_f16 v57, v49, v49, s20 op_sel_hi:[1,1,0] neg_lo:[1,0,0] neg_hi:[1,0,0] clamp
  v_mfma_f32_16x16x32_f16 v[80:83], v[184:187], v[208:211], v[80:83]
  v_pk_fma_f16 v58, v50, v50, s20 op_sel_hi:[1,1,0] neg_lo:[1,0,0] neg_hi:[1,0,0] clamp
  v_pk_fma_f16 v59, v51, v51, s20 op_sel_hi:[1,1,0] neg_lo:[1,0,0] neg_hi:[1,0,0] clamp
  v_mfma_f32_16x16x32_f16 v[84:87], v[184:187], v[212:215], v[84:87]
  v_pk_fma_f16 v184, v56, v56, s20 op_sel:[0,0,1]
  v_pk_fma_f16 v185, v57, v57, s20 op_sel:[0,0,1]
  v_mfma_f32_16x16x32_f16 v[88:91], v[188:191], v[192:195], v[88:91]
  ds_read_b128 v[192:195], v0 offset:30720
  v_pk_fma_f16 v186, v58, v58, s20 op_sel:[0,0,1]
  v_pk_fma_f16 v187, v59, v59, s20 op_sel:[0,0,1]
  v_mfma_f32_16x16x32_f16 v[92:95], v[188:191], v[196:199], v[92:95]
  ds_read_b128 v[196:199], v0 offset:31744
  v_pk_fma_f16 v184, v184, v56, s21 op_sel_hi:[1,1,0]
  v_pk_fma_f16 v185, v185, v57, s21 op_sel_hi:[1,1,0]
  v_mfma_f32_16x16x32_f16 v[96:99], v[188:191], v[200:203], v[96:99]
  ds_read_b128 v[200:203], v0 offset:32768
  v_pk_fma_f16 v186, v186, v58, s21 op_sel_hi:[1,1,0]
  v_pk_fma_f16 v187, v187, v59, s21 op_sel_hi:[1,1,0]
  v_mfma_f32_16x16x32_f16 v[100:103], v[188:191], v[204:207], v[100:103]
  ds_read_b128 v[204:207], v0 offset:33792
  v_pk_fma_f16 v184, v184, v48, 0.5 op_sel_hi:[1,1,0] clamp
  v_pk_fma_f16 v185, v185, v49, 0.5 op_sel_hi:[1,1,0] clamp
  v_mfma_f32_16x16x32_f16 v[104:107], v[188:191], v[208:211], v[104:107]
  ds_read_b128 v[208:211], v0 offset:34816
  v_pk_fma_f16 v186, v186, v50, 0.5 op_sel_hi:[1,1,0] clamp
  v_pk_fma_f16 v187, v187, v51, 0.5 op_sel_hi:[1,1,0] clamp
  v_mfma_f32_16x16x32_f16 v[108:111], v[188:191], v[212:215], v[108:111]
  ds_read_b128 v[212:215], v0 offset:35840
  v_pk_mul_f16 v184, v184, v48
  v_pk_mul_f16 v185, v185, v49
  v_mfma_f32_16x16x32_bf16 v[16:19], a[120:123], v[216:219], 0
  v_pk_mul_f16 v186, v186, v50
  v_pk_mul_f16 v187, v187, v51
  v_mfma_f32_16x16x32_bf16 v[24:27], a[120:123], v[220:223], 0
  ds_read_b128 v[12:15], v2 offset:1536
  v_pk_fma_f16 v56, v52, v52, s20 op_sel_hi:[1,1,0] neg_lo:[1,0,0] neg_hi:[1,0,0] clamp
  v_pk_fma_f16 v57, v53, v53, s20 op_sel_hi:[1,1,0] neg_lo:[1,0,0] neg_hi:[1,0,0] clamp
  v_mfma_f32_16x16x32_bf16 v[20:23], a[124:127], v[216:219], 0
  v_pk_fma_f16 v58, v54, v54, s20 op_sel_hi:[1,1,0] neg_lo:[1,0,0] neg_hi:[1,0,0] clamp
  v_pk_fma_f16 v59, v55, v55, s20 op_sel_hi:[1,1,0] neg_lo:[1,0,0] neg_hi:[1,0,0] clamp
  v_mfma_f32_16x16x32_bf16 v[28:31], a[124:127], v[220:223], 0
  v_pk_fma_f16 v188, v56, v56, s20 op_sel:[0,0,1]
  v_pk_fma_f16 v189, v57, v57, s20 op_sel:[0,0,1]
  v_mfma_f32_16x16x32_bf16 v[16:19], a[128:131], v[224:227], v[16:19]
  v_pk_fma_f16 v190, v58, v58, s20 op_sel:[0,0,1]
  v_pk_fma_f16 v191, v59, v59, s20 op_sel:[0,0,1]
  v_mfma_f32_16x16x32_bf16 v[24:27], a[128:131], v[228:231], v[24:27]
  s_waitcnt lgkmcnt(0)
  v_or3_b32 v12, v12, v13, v14
  v_or_b32_e64 v12, v12, v15
  v_cmp_ne_u32 vcc, 0, v12
  v_pk_fma_f16 v188, v188, v56, s21 op_sel_hi:[1,1,0]
  v_pk_fma_f16 v189, v189, v57, s21 op_sel_hi:[1,1,0]
  v_mfma_f32_16x16x32_bf16 v[20:23], a[132:135], v[224:227], v[20:23]
  s_cbranch_vccnz L_slow
  v_pk_fma_f16 v190, v190, v58, s21 op_sel_hi:[1,1,0]
  v_pk_fma_f16 v191, v191, v59, s21 op_sel_hi:[1,1,0]
  v_mfma_f32_16x16x32_bf16 v[28:31], a[132:135], v[228:231], v[28:31]
  s_nop 0
  v_pk_fma_f16 v188, v188, v52, 0.5 op_sel_hi:[1,1,0] clamp
  v_pk_fma_f16 v189, v189, v53, 0.5 op_sel_hi:[1,1,0] clamp
  v_mfma_f32_16x16x32_bf16 v[16:19], a[136:139], v[232:235], v[16:19]
  v_pk_fma_f16 v190, v190, v54, 0.5 op_sel_hi:[1,1,0] clamp
  v_pk_fma_f16 v191, v191, v55, 0.5 op_sel_hi:[1,1,0] clamp
  v_mfma_f32_16x16x32_bf16 v[24:27], a[136:139], v[236:239], v[24:27]
  v_pk_mul_f16 v188, v188, v52
  v_pk_mul_f16 v189, v189, v53
  v_mfma_f32_16x16x32_bf16 v[20:23], a[140:143], v[232:235], v[20:23]
  v_pk_mul_f16 v190, v190, v54
  v_pk_mul_f16 v191, v191, v55
  v_mfma_f32_16x16x32_bf16 v[28:31], a[140:143], v[236:239], v[28:31]
  s_nop 0
  v_cvt_pk_f16_f32 v48, v16, v17
  v_cvt_pk_f16_f32 v49, v18, v19
  v_mfma_f32_16x16x32_f16 v[64:67], v[184:187], v[192:195], v[64:67]
  s_nop 1
  v_cvt_pk_f16_f32 v50, v20, v21
  v_cvt_pk_f16_f32 v51, v22, v23
  v_mfma_f32_16x16x32_f16 v[68:71], v[184:187], v[196:199], v[68:71]
  v_cvt_pk_f16_f32 v52, v24, v25
  v_cvt_pk_f16_f32 v53, v26, v27
  v_mfma_f32_16x16x32_f16 v[72:75], v[184:187], v[200:203], v[72:75]
  v_cvt_pk_f16_f32 v54, v28, v29
  v_cvt_pk_f16_f32 v55, v30, v31
  v_mfma_f32_16x16x32_f16 v[76:79], v[184:187], v[204:207], v[76:79]
  v_pk_fma_f16 v56, v48, v48, s20 op_sel_hi:[1,1,0] neg_lo:[1,0,0] neg_hi:[1,0,0] clamp
  v_pk_fma_f16 v57, v49, v49, s20 op_sel_hi:[1,1,0] neg_lo:[1,0,0] neg_hi:[1,0,0] clamp
  v_mfma_f32_16x16x32_f16 v[80:83], v[184:187], v[208:211], v[80:83]
  s_nop 0
  v_pk_fma_f16 v58, v50, v50, s20 op_sel_hi:[1,1,0] neg_lo:[1,0,0] neg_hi:[1,0,0] clamp
  v_pk_fma_f16 v59, v51, v51, s20 op_sel_hi:[1,1,0] neg_lo:[1,0,0] neg_hi:[1,0,0] clamp
  v_mfma_f32_16x16x32_f16 v[84:87], v[184:187], v[212:215], v[84:87]
  s_nop 0
  v_pk_fma_f16 v184, v56, v56, s20 op_sel:[0,0,1]
  v_pk_fma_f16 v185, v57, v57, s20 op_sel:[0,0,1]
  v_mfma_f32_16x16x32_f16 v[88:91], v[188:191], v[192:195], v[88:91]
  ds_read_b128 v[192:195], v0 offset:36864
  v_pk_fma_f16 v186, v58, v58, s20 op_sel:[0,0,1]
  v_pk_fma_f16 v187, v59, v59, s20 op_sel:[0,0,1]
  v_mfma_f32_16x16x32_f16 v[92:95], v[188:191], v[196:199], v[92:95]
  ds_read_b128 v[196:199], v0 offset:37888
  v_pk_fma_f16 v184, v184, v56, s21 op_sel_hi:[1,1,0]
  v_pk_fma_f16 v185, v185, v57, s21 op_sel_hi:[1,1,0]
  v_mfma_f32_16x16x32_f16 v[96:99], v[188:191], v[200:203], v[96:99]
  ds_read_b128 v[200:203], v0 offset:38912
  v_pk_fma_f16 v186, v186, v58, s21 op_sel_hi:[1,1,0]
  v_pk_fma_f16 v187, v187, v59, s21 op_sel_hi:[1,1,0]
  v_mfma_f32_16x16x32_f16 v[100:103], v[188:191], v[204:207], v[100:103]
  ds_read_b128 v[204:207], v0 offset:39936
  v_pk_fma_f16 v184, v184, v48, 0.5 op_sel_hi:[1,1,0] clamp
  v_pk_fma_f16 v185, v185, v49, 0.5 op_sel_hi:[1,1,0] clamp
  v_mfma_f32_16x16x32_f16 v[104:107], v[188:191], v[208:211], v[104:107]
  ds_read_b128 v[208:211], v0 offset:40960
  v_pk_fma_f16 v186, v186, v50, 0.5 op_sel_hi:[1,1,0] clamp
  v_pk_fma_f16 v187, v187, v51, 0.5 op_sel_hi:[1,1,0] clamp
  v_mfma_f32_16x16x32_f16 v[108:111], v[188:191], v[212:215], v[108:111]
  ds_read_b128 v[212:215], v0 offset:41984
  v_pk_mul_f16 v184, v184, v48
  v_pk_mul_f16 v185, v185, v49
  v_mfma_f32_16x16x32_bf16 v[16:19], a[144:147], v[216:219], 0
  v_pk_mul_f16 v186, v186, v50
  v_pk_mul_f16 v187, v187, v51
  v_mfma_f32_16x16x32_bf16 v[24:27], a[144:147], v[220:223], 0
  v_pk_fma_f16 v56, v52, v52, s20 op_sel_hi:[1,1,0] neg_lo:[1,0,0] neg_hi:[1,0,0] clamp
  v_pk_fma_f16 v57, v53, v53, s20 op_sel_hi:[1,1,0] neg_lo:[1,0,0] neg_hi:[1,0,0] clamp
  v_mfma_f32_16x16x32_bf16 v[20:23], a[148:151], v[216:219], 0
  v_pk_fma_f16 v58, v54, v54, s20 op_sel_hi:[1,1,0] neg_lo:[1,0,0] neg_hi:[1,0,0] clamp
  v_pk_fma_f16 v59, v55, v55, s20 op_sel_hi:[1,1,0] neg_lo:[1,0,0] neg_hi:[1,0,0] clamp
  v_mfma_f32_16x16x32_bf16 v[28:31], a[148:151], v[220:223], 0
  v_pk_fma_f16 v188, v56, v56, s20 op_sel:[0,0,1]
  v_pk_fma_f16 v189, v57, v57, s20 op_sel:[0,0,1]
  v_mfma_f32_16x16x32_bf16 v[16:19], a[152:155], v[224:227], v[16:19]
  v_pk_fma_f16 v190, v58, v58, s20 op_sel:[0,0,1]
  v_pk_fma_f16 v191, v59, v59, s20 op_sel:[0,0,1]
  v_mfma_f32_16x16x32_bf16 v[24:27], a[152:155], v[228:231], v[24:27]
  v_pk_fma_f16 v188, v188, v56, s21 op_sel_hi:[1,1,0]
  v_pk_fma_f16 v189, v189, v57, s21 op_sel_hi:[1,1,0]
  v_mfma_f32_16x16x32_bf16 v[20:23], a[156:159], v[224:227], v[20:23]
  v_pk_fma_f16 v190, v190, v58, s21 op_sel_hi:[1,1,0]
  v_pk_fma_f16 v191, v191, v59, s21 op_sel_hi:[1,1,0]
  v_mfma_f32_16x16x32_bf16 v[28:31], a[156:159], v[228:231], v[28:31]
  v_pk_fma_f16 v188, v188, v52, 0.5 op_sel_hi:[1,1,0] clamp
  v_pk_fma_f16 v189, v189, v53, 0.5 op_sel_hi:[1,1,0] clamp
  v_mfma_f32_16x16x32_bf16 v[16:19], a[160:163], v[232:235], v[16:19]
  v_pk_fma_f16 v190, v190, v54, 0.5 op_sel_hi:[1,1,0] clamp
  v_pk_fma_f16 v191, v191, v55, 0.5 op_sel_hi:[1,1,0] clamp
  v_mfma_f32_16x16x32_bf16 v[24:27], a[160:163], v[236:239], v[24:27]
  v_pk_mul_f16 v188, v188, v52
  v_pk_mul_f16 v189, v189, v53
  v_mfma_f32_16x16x32_bf16 v[20:23], a[164:167], v[232:235], v[20:23]
  v_pk_mul_f16 v190, v190, v54
  v_pk_mul_f16 v191, v191, v55
  v_mfma_f32_16x16x32_bf16 v[28:31], a[164:167], v[236:239], v[28:31]
  s_waitcnt lgkmcnt(0)
  v_cvt_pk_f16_f32 v48, v16, v17
  v_cvt_pk_f16_f32 v49, v18, v19
  v_mfma_f32_16x16x32_f16 v[64:67], v[184:187], v[192:195], v[64:67]
  s_nop 0
  v_cvt_pk_f16_f32 v50, v20, v21
  v_cvt_pk_f16_f32 v51, v22, v23
  v_mfma_f32_16x16x32_f16 v[68:71], v[184:187], v[196:199], v[68:71]
  v_cvt_pk_f16_f32 v52, v24, v25
  v_cvt_pk_f16_f32 v53, v26, v27
  v_mfma_f32_16x16x32_f16 v[72:75], v[184:187], v[200:203], v[72:75]
  v_cvt_pk_f16_f32 v54, v28, v29
  v_cvt_pk_f16_f32 v55, v30, v31
  v_mfma_f32_16x16x32_f16 v[76:79], v[184:187], v[204:207], v[76:79]
  v_pk_fma_f16 v56, v48, v48, s20 op_sel_hi:[1,1,0] neg_lo:[1,0,0] neg_hi:[1,0,0] clamp
  v_pk_fma_f16 v57, v49, v49, s20 op_sel_hi:[1,1,0] neg_lo:[1,0,0] neg_hi:[1,0,0] clamp
  v_mfma_f32_16x16x32_f16 v[80:83], v[184:187], v[208:211], v[80:83]
  s_nop 0
  v_pk_fma_f16 v58, v50, v50, s20 op_sel_hi:[1,1,0] neg_lo:[1,0,0] neg_hi:[1,0,0] clamp
  v_pk_fma_f16 v59, v51, v51, s20 op_sel_hi:[1,1,0] neg_lo:[1,0,0] neg_hi:[1,0,0] clamp
  v_mfma_f32_16x16x32_f16 v[84:87], v[184:187], v[212:215], v[84:87]
  s_nop 0
  v_pk_fma_f16 v184, v56, v56, s20 op_sel:[0,0,1]
  v_pk_fma_f16 v185, v57, v57, s20 op_sel:[0,0,1]
  v_mfma_f32_16x16x32_f16 v[88:91], v[188:191], v[192:195], v[88:91]
  ds_read_b128 v[192:195], v0 offset:43008
  v_pk_fma_f16 v186, v58, v58, s20 op_sel:[0,0,1]
  v_pk_fma_f16 v187, v59, v59, s20 op_sel:[0,0,1]
  v_mfma_f32_16x16x32_f16 v[92:95], v[188:191], v[196:199], v[92:95]
  ds_read_b128 v[196:199], v0 offset:44032
  v_pk_fma_f16 v184, v184, v56, s21 op_sel_hi:[1,1,0]
  v_pk_fma_f16 v185, v185, v57, s21 op_sel_hi:[1,1,0]
  v_mfma_f32_16x16x32_f16 v[96:99], v[188:191], v[200:203], v[96:99]
  ds_read_b128 v[200:203], v0 offset:45056
  v_pk_fma_f16 v186, v186, v58, s21 op_sel_hi:[1,1,0]
  v_pk_fma_f16 v187, v187, v59, s21 op_sel_hi:[1,1,0]
  v_mfma_f32_16x16x32_f16 v[100:103], v[188:191], v[204:207], v[100:103]
  ds_read_b128 v[204:207], v0 offset:46080
  v_pk_fma_f16 v184, v184, v48, 0.5 op_sel_hi:[1,1,0] clamp
  v_pk_fma_f16 v185, v185, v49, 0.5 op_sel_hi:[1,1,0] clamp
  v_mfma_f32_16x16x32_f16 v[104:107], v[188:191], v[208:211], v[104:107]
  ds_read_b128 v[208:211], v0 offset:47104
  v_pk_fma_f16 v186, v186, v50, 0.5 op_sel_hi:[1,1,0] clamp
  v_pk_fma_f16 v187, v187, v51, 0.5 op_sel_hi:[1,1,0] clamp
  v_mfma_f32_16x16x32_f16 v[108:111], v[188:191], v[212:215], v[108:111]
  ds_read_b128 v[212:215], v0 offset:48128
  v_pk_mul_f16 v184, v184, v48
  v_pk_mul_f16 v185, v185, v49
  v_mfma_f32_16x16x32_bf16 v[16:19], a[168:171], v[216:219], 0
  v_pk_mul_f16 v186, v186, v50
  v_pk_mul_f16 v187, v187, v51
  v_mfma_f32_16x16x32_bf16 v[24:27], a[168:171], v[220:223], 0
  v_pk_fma_f16 v56, v52, v52, s20 op_sel_hi:[1,1,0] neg_lo:[1,0,0] neg_hi:[1,0,0] clamp
  v_pk_fma_f16 v57, v53, v53, s20 op_sel_hi:[1,1,0] neg_lo:[1,0,0] neg_hi:[1,0,0] clamp
  v_mfma_f32_16x16x32_bf16 v[20:23], a[172:175], v[216:219], 0
  v_pk_fma_f16 v58, v54, v54, s20 op_sel_hi:[1,1,0] neg_lo:[1,0,0] neg_hi:[1,0,0] clamp
  v_pk_fma_f16 v59, v55, v55, s20 op_sel_hi:[1,1,0] neg_lo:[1,0,0] neg_hi:[1,0,0] clamp
  v_mfma_f32_16x16x32_bf16 v[28:31], a[172:175], v[220:223], 0
  v_pk_fma_f16 v188, v56, v56, s20 op_sel:[0,0,1]
  v_pk_fma_f16 v189, v57, v57, s20 op_sel:[0,0,1]
  v_mfma_f32_16x16x32_bf16 v[16:19], a[176:179], v[224:227], v[16:19]
  v_pk_fma_f16 v190, v58, v58, s20 op_sel:[0,0,1]
  v_pk_fma_f16 v191, v59, v59, s20 op_sel:[0,0,1]
  v_mfma_f32_16x16x32_bf16 v[24:27], a[176:179], v[228:231], v[24:27]
  v_pk_fma_f16 v188, v188, v56, s21 op_sel_hi:[1,1,0]
  v_pk_fma_f16 v189, v189, v57, s21 op_sel_hi:[1,1,0]
  v_mfma_f32_16x16x32_bf16 v[20:23], a[180:183], v[224:227], v[20:23]
  v_pk_fma_f16 v190, v190, v58, s21 op_sel_hi:[1,1,0]
  v_pk_fma_f16 v191, v191, v59, s21 op_sel_hi:[1,1,0]
  v_mfma_f32_16x16x32_bf16 v[28:31], a[180:183], v[228:231], v[28:31]
  v_pk_fma_f16 v188, v188, v52, 0.5 op_sel_hi:[1,1,0] clamp
  v_pk_fma_f16 v189, v189, v53, 0.5 op_sel_hi:[1,1,0] clamp
  v_mfma_f32_16x16x32_bf16 v[16:19], a[184:187], v[232:235], v[16:19]
  v_pk_fma_f16 v190, v190, v54, 0.5 op_sel_hi:[1,1,0] clamp
  v_pk_fma_f16 v191, v191, v55, 0.5 op_sel_hi:[1,1,0] clamp
  v_mfma_f32_16x16x32_bf16 v[24:27], a[184:187], v[236:239], v[24:27]
  v_pk_mul_f16 v188, v188, v52
  v_pk_mul_f16 v189, v189, v53
  v_mfma_f32_16x16x32_bf16 v[20:23], a[188:191], v[232:235], v[20:23]
  v_pk_mul_f16 v190, v190, v54
  v_pk_mul_f16 v191, v191, v55
  v_mfma_f32_16x16x32_bf16 v[28:31], a[188:191], v[236:239], v[28:31]
  s_waitcnt lgkmcnt(0)
  v_cvt_pk_f16_f32 v48, v16, v17
  v_cvt_pk_f16_f32 v49, v18, v19
  v_mfma_f32_16x16x32_f16 v[64:67], v[184:187], v[192:195], v[64:67]
  s_nop 0
  v_cvt_pk_f16_f32 v50, v20, v21
  v_cvt_pk_f16_f32 v51, v22, v23
  v_mfma_f32_16x16x32_f16 v[68:71], v[184:187], v[196:199], v[68:71]
  v_cvt_pk_f16_f32 v52, v24, v25
  v_cvt_pk_f16_f32 v53, v26, v27
  v_mfma_f32_16x16x32_f16 v[72:75], v[184:187], v[200:203], v[72:75]
  v_cvt_pk_f16_f32 v54, v28, v29
  v_cvt_pk_f16_f32 v55, v30, v31
  v_mfma_f32_16x16x32_f16 v[76:79], v[184:187], v[204:207], v[76:79]
  v_pk_fma_f16 v56, v48, v48, s20 op_sel_hi:[1,1,0] neg_lo:[1,0,0] neg_hi:[1,0,0] clamp
  v_pk_fma_f16 v57, v49, v49, s20 op_sel_hi:[1,1,0] neg_lo:[1,0,0] neg_hi:[1,0,0] clamp
  v_mfma_f32_16x16x32_f16 v[80:83], v[184:187], v[208:211], v[80:83]
  s_nop 0
  v_pk_fma_f16 v58, v50, v50, s20 op_sel_hi:[1,1,0] neg_lo:[1,0,0] neg_hi:[1,0,0] clamp
  v_pk_fma_f16 v59, v51, v51, s20 op_sel_hi:[1,1,0] neg_lo:[1,0,0] neg_hi:[1,0,0] clamp
  v_mfma_f32_16x16x32_f16 v[84:87], v[184:187], v[212:215], v[84:87]
  s_nop 0
  v_pk_fma_f16 v184, v56, v56, s20 op_sel:[0,0,1]
  v_pk_fma_f16 v185, v57, v57, s20 op_sel:[0,0,1]
  v_mfma_f32_16x16x32_f16 v[88:91], v[188:191], v[192:195], v[88:91]
  ds_read_b128 v[192:195], v0 offset:49152
  v_pk_fma_f16 v186, v58, v58, s20 op_sel:[0,0,1]
  v_pk_fma_f16 v187, v59, v59, s20 op_sel:[0,0,1]
  v_mfma_f32_16x16x32_f16 v[92:95], v[188:191], v[196:199], v[92:95]
  ds_read_b128 v[196:199], v0 offset:50176
  v_pk_fma_f16 v184, v184, v56, s21 op_sel_hi:[1,1,0]
  v_pk_fma_f16 v185, v185, v57, s21 op_sel_hi:[1,1,0]
  v_mfma_f32_16x16x32_f16 v[96:99], v[188:191], v[200:203], v[96:99]
  ds_read_b128 v[200:203], v0 offset:51200
  v_pk_fma_f16 v186, v186, v58, s21 op_sel_hi:[1,1,0]
  v_pk_fma_f16 v187, v187, v59, s21 op_sel_hi:[1,1,0]
  v_mfma_f32_16x16x32_f16 v[100:103], v[188:191], v[204:207], v[100:103]
  ds_read_b128 v[204:207], v0 offset:52224
  v_pk_fma_f16 v184, v184, v48, 0.5 op_sel_hi:[1,1,0] clamp
  v_pk_fma_f16 v185, v185, v49, 0.5 op_sel_hi:[1,1,0] clamp
  v_mfma_f32_16x16x32_f16 v[104:107], v[188:191], v[208:211], v[104:107]
  ds_read_b128 v[208:211], v0 offset:53248
  v_pk_fma_f16 v186, v186, v50, 0.5 op_sel_hi:[1,1,0] clamp
  v_pk_fma_f16 v187, v187, v51, 0.5 op_sel_hi:[1,1,0] clamp
  v_mfma_f32_16x16x32_f16 v[108:111], v[188:191], v[212:215], v[108:111]
  ds_read_b128 v[212:215], v0 offset:54272
  v_pk_mul_f16 v184, v184, v48
  v_pk_mul_f16 v185, v185, v49
  v_mfma_f32_16x16x32_bf16 v[16:19], a[192:195], v[216:219], 0
  v_pk_mul_f16 v186, v186, v50
  v_pk_mul_f16 v187, v187, v51
  v_mfma_f32_16x16x32_bf16 v[24:27], a[192:195], v[220:223], 0
  v_pk_fma_f16 v56, v52, v52, s20 op_sel_hi:[1,1,0] neg_lo:[1,0,0] neg_hi:[1,0,0] clamp
  v_pk_fma_f16 v57, v53, v53, s20 op_sel_hi:[1,1,0] neg_lo:[1,0,0] neg_hi:[1,0,0] clamp
  v_mfma_f32_16x16x32_bf16 v[20:23], a[196:199], v[216:219], 0
  v_pk_fma_f16 v58, v54, v54, s20 op_sel_hi:[1,1,0] neg_lo:[1,0,0] neg_hi:[1,0,0] clamp
  v_pk_fma_f16 v59, v55, v55, s20 op_sel_hi:[1,1,0] neg_lo:[1,0,0] neg_hi:[1,0,0] clamp
  v_mfma_f32_16x16x32_bf16 v[28:31], a[196:199], v[220:223], 0
  v_pk_fma_f16 v188, v56, v56, s20 op_sel:[0,0,1]
  v_pk_fma_f16 v189, v57, v57, s20 op_sel:[0,0,1]
  v_mfma_f32_16x16x32_bf16 v[16:19], a[200:203], v[224:227], v[16:19]
  v_pk_fma_f16 v190, v58, v58, s20 op_sel:[0,0,1]
  v_pk_fma_f16 v191, v59, v59, s20 op_sel:[0,0,1]
  v_mfma_f32_16x16x32_bf16 v[24:27], a[200:203], v[228:231], v[24:27]
  v_pk_fma_f16 v188, v188, v56, s21 op_sel_hi:[1,1,0]
  v_pk_fma_f16 v189, v189, v57, s21 op_sel_hi:[1,1,0]
  v_mfma_f32_16x16x32_bf16 v[20:23], a[204:207], v[224:227], v[20:23]
  v_pk_fma_f16 v190, v190, v58, s21 op_sel_hi:[1,1,0]
  v_pk_fma_f16 v191, v191, v59, s21 op_sel_hi:[1,1,0]
  v_mfma_f32_16x16x32_bf16 v[28:31], a[204:207], v[228:231], v[28:31]
  v_pk_fma_f16 v188, v188, v52, 0.5 op_sel_hi:[1,1,0] clamp
  v_pk_fma_f16 v189, v189, v53, 0.5 op_sel_hi:[1,1,0] clamp
  v_mfma_f32_16x16x32_bf16 v[16:19], a[208:211], v[232:235], v[16:19]
  v_pk_fma_f16 v190, v190, v54, 0.5 op_sel_hi:[1,1,0] clamp
  v_pk_fma_f16 v191, v191, v55, 0.5 op_sel_hi:[1,1,0] clamp
  v_mfma_f32_16x16x32_bf16 v[24:27], a[208:211], v[236:239], v[24:27]
  v_pk_mul_f16 v188, v188, v52
  v_pk_mul_f16 v189, v189, v53
  v_mfma_f32_16x16x32_bf16 v[20:23], a[212:215], v[232:235], v[20:23]
  v_pk_mul_f16 v190, v190, v54
  v_pk_mul_f16 v191, v191, v55
  v_mfma_f32_16x16x32_bf16 v[28:31], a[212:215], v[236:239], v[28:31]
  s_waitcnt lgkmcnt(0)
  v_cvt_pk_f16_f32 v48, v16, v17
  v_cvt_pk_f16_f32 v49, v18, v19
  v_mfma_f32_16x16x32_f16 v[64:67], v[184:187], v[192:195], v[64:67]
  s_nop 0
  v_cvt_pk_f16_f32 v50, v20, v21
  v_cvt_pk_f16_f32 v51, v22, v23
  v_mfma_f32_16x16x32_f16 v[68:71], v[184:187], v[196:199], v[68:71]
  v_cvt_pk_f16_f32 v52, v24, v25
  v_cvt_pk_f16_f32 v53, v26, v27
  v_mfma_f32_16x16x32_f16 v[72:75], v[184:187], v[200:203], v[72:75]
  v_cvt_pk_f16_f32 v54, v28, v29
  v_cvt_pk_f16_f32 v55, v30, v31
  v_mfma_f32_16x16x32_f16 v[76:79], v[184:187], v[204:207], v[76:79]
  v_pk_fma_f16 v56, v48, v48, s20 op_sel_hi:[1,1,0] neg_lo:[1,0,0] neg_hi:[1,0,0] clamp
  v_pk_fma_f16 v57, v49, v49, s20 op_sel_hi:[1,1,0] neg_lo:[1,0,0] neg_hi:[1,0,0] clamp
  v_mfma_f32_16x16x32_f16 v[80:83], v[184:187], v[208:211], v[80:83]
  s_nop 0
  v_pk_fma_f16 v58, v50, v50, s20 op_sel_hi:[1,1,0] neg_lo:[1,0,0] neg_hi:[1,0,0] clamp
  v_pk_fma_f16 v59, v51, v51, s20 op_sel_hi:[1,1,0] neg_lo:[1,0,0] neg_hi:[1,0,0] clamp
  v_mfma_f32_16x16x32_f16 v[84:87], v[184:187], v[212:215], v[84:87]
  s_nop 0
  v_pk_fma_f16 v184, v56, v56, s20 op_sel:[0,0,1]
  v_pk_fma_f16 v185, v57, v57, s20 op_sel:[0,0,1]
  v_mfma_f32_16x16x32_f16 v[88:91], v[188:191], v[192:195], v[88:91]
  ds_read_b128 v[192:195], v0 offset:55296
  v_pk_fma_f16 v186, v58, v58, s20 op_sel:[0,0,1]
  v_pk_fma_f16 v187, v59, v59, s20 op_sel:[0,0,1]
  v_mfma_f32_16x16x32_f16 v[92:95], v[188:191], v[196:199], v[92:95]
  ds_read_b128 v[196:199], v0 offset:56320
  v_pk_fma_f16 v184, v184, v56, s21 op_sel_hi:[1,1,0]
  v_pk_fma_f16 v185, v185, v57, s21 op_sel_hi:[1,1,0]
  v_mfma_f32_16x16x32_f16 v[96:99], v[188:191], v[200:203], v[96:99]
  ds_read_b128 v[200:203], v0 offset:57344
  v_pk_fma_f16 v186, v186, v58, s21 op_sel_hi:[1,1,0]
  v_pk_fma_f16 v187, v187, v59, s21 op_sel_hi:[1,1,0]
  v_mfma_f32_16x16x32_f16 v[100:103], v[188:191], v[204:207], v[100:103]
  ds_read_b128 v[204:207], v0 offset:58368
  v_pk_fma_f16 v184, v184, v48, 0.5 op_sel_hi:[1,1,0] clamp
  v_pk_fma_f16 v185, v185, v49, 0.5 op_sel_hi:[1,1,0] clamp
  v_mfma_f32_16x16x32_f16 v[104:107], v[188:191], v[208:211], v[104:107]
  ds_read_b128 v[208:211], v0 offset:59392
  v_pk_fma_f16 v186, v186, v50, 0.5 op_sel_hi:[1,1,0] clamp
  v_pk_fma_f16 v187, v187, v51, 0.5 op_sel_hi:[1,1,0] clamp
  v_mfma_f32_16x16x32_f16 v[108:111], v[188:191], v[212:215], v[108:111]
  ds_read_b128 v[212:215], v0 offset:60416
  v_pk_mul_f16 v184, v184, v48
  v_pk_mul_f16 v185, v185, v49
  v_mfma_f32_16x16x32_bf16 v[16:19], a[216:219], v[216:219], 0
  v_pk_mul_f16 v186, v186, v50
  v_pk_mul_f16 v187, v187, v51
  v_mfma_f32_16x16x32_bf16 v[24:27], a[216:219], v[220:223], 0
  v_pk_fma_f16 v56, v52, v52, s20 op_sel_hi:[1,1,0] neg_lo:[1,0,0] neg_hi:[1,0,0] clamp
  v_pk_fma_f16 v57, v53, v53, s20 op_sel_hi:[1,1,0] neg_lo:[1,0,0] neg_hi:[1,0,0] clamp
  v_mfma_f32_16x16x32_bf16 v[20:23], a[220:223], v[216:219], 0
  v_pk_fma_f16 v58, v54, v54, s20 op_sel_hi:[1,1,0] neg_lo:[1,0,0] neg_hi:[1,0,0] clamp
  v_pk_fma_f16 v59, v55, v55, s20 op_sel_hi:[1,1,0] neg_lo:[1,0,0] neg_hi:[1,0,0] clamp
  v_mfma_f32_16x16x32_bf16 v[28:31], a[220:223], v[220:223], 0
  v_pk_fma_f16 v188, v56, v56, s20 op_sel:[0,0,1]
  v_pk_fma_f16 v189, v57, v57, s20 op_sel:[0,0,1]
  v_mfma_f32_16x16x32_bf16 v[16:19], a[224:227], v[224:227], v[16:19]
  v_pk_fma_f16 v190, v58, v58, s20 op_sel:[0,0,1]
  v_pk_fma_f16 v191, v59, v59, s20 op_sel:[0,0,1]
  v_mfma_f32_16x16x32_bf16 v[24:27], a[224:227], v[228:231], v[24:27]
  v_pk_fma_f16 v188, v188, v56, s21 op_sel_hi:[1,1,0]
  v_pk_fma_f16 v189, v189, v57, s21 op_sel_hi:[1,1,0]
  v_mfma_f32_16x16x32_bf16 v[20:23], a[228:231], v[224:227], v[20:23]
  v_pk_fma_f16 v190, v190, v58, s21 op_sel_hi:[1,1,0]
  v_pk_fma_f16 v191, v191, v59, s21 op_sel_hi:[1,1,0]
  v_mfma_f32_16x16x32_bf16 v[28:31], a[228:231], v[228:231], v[28:31]
  v_pk_fma_f16 v188, v188, v52, 0.5 op_sel_hi:[1,1,0] clamp
  v_pk_fma_f16 v189, v189, v53, 0.5 op_sel_hi:[1,1,0] clamp
  v_mfma_f32_16x16x32_bf16 v[16:19], a[232:235], v[232:235], v[16:19]
  v_pk_fma_f16 v190, v190, v54, 0.5 op_sel_hi:[1,1,0] clamp
  v_pk_fma_f16 v191, v191, v55, 0.5 op_sel_hi:[1,1,0] clamp
  v_mfma_f32_16x16x32_bf16 v[24:27], a[232:235], v[236:239], v[24:27]
  v_pk_mul_f16 v188, v188, v52
  v_pk_mul_f16 v189, v189, v53
  v_mfma_f32_16x16x32_bf16 v[20:23], a[236:239], v[232:235], v[20:23]
  v_pk_mul_f16 v190, v190, v54
  v_pk_mul_f16 v191, v191, v55
  v_mfma_f32_16x16x32_bf16 v[28:31], a[236:239], v[236:239], v[28:31]
  s_waitcnt lgkmcnt(0)
  v_cvt_pk_f16_f32 v48, v16, v17
  v_cvt_pk_f16_f32 v49, v18, v19
  v_mfma_f32_16x16x32_f16 v[64:67], v[184:187], v[192:195], v[64:67]
  s_nop 0
  v_cvt_pk_f16_f32 v50, v20, v21
  v_cvt_pk_f16_f32 v51, v22, v23
  v_mfma_f32_16x16x32_f16 v[68:71], v[184:187], v[196:199], v[68:71]
  v_cvt_pk_f16_f32 v52, v24, v25
  v_cvt_pk_f16_f32 v53, v26, v27
  v_mfma_f32_16x16x32_f16 v[72:75], v[184:187], v[200:203], v[72:75]
  v_cvt_pk_f16_f32 v54, v28, v29
  v_cvt_pk_f16_f32 v55, v30, v31
  v_mfma_f32_16x16x32_f16 v[76:79], v[184:187], v[204:207], v[76:79]
  v_pk_fma_f16 v56, v48, v48, s20 op_sel_hi:[1,1,0] neg_lo:[1,0,0] neg_hi:[1,0,0] clamp
  v_pk_fma_f16 v57, v49, v49, s20 op_sel_hi:[1,1,0] neg_lo:[1,0,0] neg_hi:[1,0,0] clamp
  v_mfma_f32_16x16x32_f16 v[80:83], v[184:187], v[208:211], v[80:83]
  s_nop 0
  v_pk_fma_f16 v58, v50, v50, s20 op_sel_hi:[1,1,0] neg_lo:[1,0,0] neg_hi:[1,0,0] clamp
  v_pk_fma_f16 v59, v51, v51, s20 op_sel_hi:[1,1,0] neg_lo:[1,0,0] neg_hi:[1,0,0] clamp
  v_mfma_f32_16x16x32_f16 v[84:87], v[184:187], v[212:215], v[84:87]
  s_nop 0
  v_pk_fma_f16 v184, v56, v56, s20 op_sel:[0,0,1]
  v_pk_fma_f16 v185, v57, v57, s20 op_sel:[0,0,1]
  v_mfma_f32_16x16x32_f16 v[88:91], v[188:191], v[192:195], v[88:91]
  ds_read_b128 v[192:195], v0 offset:61440
  v_pk_fma_f16 v186, v58, v58, s20 op_sel:[0,0,1]
  v_pk_fma_f16 v187, v59, v59, s20 op_sel:[0,0,1]
  v_mfma_f32_16x16x32_f16 v[92:95], v[188:191], v[196:199], v[92:95]
  ds_read_b128 v[196:199], v0 offset:62464
  v_pk_fma_f16 v184, v184, v56, s21 op_sel_hi:[1,1,0]
  v_pk_fma_f16 v185, v185, v57, s21 op_sel_hi:[1,1,0]
  v_mfma_f32_16x16x32_f16 v[96:99], v[188:191], v[200:203], v[96:99]
  ds_read_b128 v[200:203], v0 offset:63488
  v_pk_fma_f16 v186, v186, v58, s21 op_sel_hi:[1,1,0]
  v_pk_fma_f16 v187, v187, v59, s21 op_sel_hi:[1,1,0]
  v_mfma_f32_16x16x32_f16 v[100:103], v[188:191], v[204:207], v[100:103]
  ds_read_b128 v[204:207], v0 offset:64512
  v_pk_fma_f16 v184, v184, v48, 0.5 op_sel_hi:[1,1,0] clamp
  v_pk_fma_f16 v185, v185, v49, 0.5 op_sel_hi:[1,1,0] clamp
  v_mfma_f32_16x16x32_f16 v[104:107], v[188:191], v[208:211], v[104:107]
  ds_read_b128 v[208:211], v1
  v_pk_fma_f16 v186, v186, v50, 0.5 op_sel_hi:[1,1,0] clamp
  v_pk_fma_f16 v187, v187, v51, 0.5 op_sel_hi:[1,1,0] clamp
  v_mfma_f32_16x16x32_f16 v[108:111], v[188:191], v[212:215], v[108:111]
  ds_read_b128 v[212:215], v1 offset:1024
  v_pk_mul_f16 v184, v184, v48
  v_pk_mul_f16 v185, v185, v49
  v_mfma_f32_16x16x32_bf16 v[16:19], v[32:35], v[216:219], 0
  v_pk_mul_f16 v186, v186, v50
  v_pk_mul_f16 v187, v187, v51
  v_mfma_f32_16x16x32_bf16 v[24:27], v[32:35], v[220:223], 0
  v_pk_fma_f16 v56, v52, v52, s20 op_sel_hi:[1,1,0] neg_lo:[1,0,0] neg_hi:[1,0,0] clamp
  v_pk_fma_f16 v57, v53, v53, s20 op_sel_hi:[1,1,0] neg_lo:[1,0,0] neg_hi:[1,0,0] clamp
  v_mfma_f32_16x16x32_bf16 v[20:23], v[36:39], v[216:219], 0
  v_pk_fma_f16 v58, v54, v54, s20 op_sel_hi:[1,1,0] neg_lo:[1,0,0] neg_hi:[1,0,0] clamp
  v_pk_fma_f16 v59, v55, v55, s20 op_sel_hi:[1,1,0] neg_lo:[1,0,0] neg_hi:[1,0,0] clamp
  v_mfma_f32_16x16x32_bf16 v[28:31], v[36:39], v[220:223], 0
  v_pk_fma_f16 v188, v56, v56, s20 op_sel:[0,0,1]
  v_pk_fma_f16 v189, v57, v57, s20 op_sel:[0,0,1]
  v_mfma_f32_16x16x32_bf16 v[16:19], v[40:43], v[224:227], v[16:19]
  v_pk_fma_f16 v190, v58, v58, s20 op_sel:[0,0,1]
  v_pk_fma_f16 v191, v59, v59, s20 op_sel:[0,0,1]
  v_mfma_f32_16x16x32_bf16 v[24:27], v[40:43], v[228:231], v[24:27]
  v_pk_fma_f16 v188, v188, v56, s21 op_sel_hi:[1,1,0]
  v_pk_fma_f16 v189, v189, v57, s21 op_sel_hi:[1,1,0]
  v_mfma_f32_16x16x32_bf16 v[20:23], v[44:47], v[224:227], v[20:23]
  v_pk_fma_f16 v190, v190, v58, s21 op_sel_hi:[1,1,0]
  v_pk_fma_f16 v191, v191, v59, s21 op_sel_hi:[1,1,0]
  v_mfma_f32_16x16x32_bf16 v[28:31], v[44:47], v[228:231], v[28:31]
  v_pk_fma_f16 v188, v188, v52, 0.5 op_sel_hi:[1,1,0] clamp
  v_pk_fma_f16 v189, v189, v53, 0.5 op_sel_hi:[1,1,0] clamp
  v_mfma_f32_16x16x32_bf16 v[16:19], v[60:63], v[232:235], v[16:19]
  v_pk_fma_f16 v190, v190, v54, 0.5 op_sel_hi:[1,1,0] clamp
  v_pk_fma_f16 v191, v191, v55, 0.5 op_sel_hi:[1,1,0] clamp
  v_mfma_f32_16x16x32_bf16 v[24:27], v[60:63], v[236:239], v[24:27]
  v_pk_mul_f16 v188, v188, v52
  v_pk_mul_f16 v189, v189, v53
  v_mfma_f32_16x16x32_bf16 v[20:23], v[244:247], v[232:235], v[20:23]
  v_pk_mul_f16 v190, v190, v54
  v_pk_mul_f16 v191, v191, v55
  v_mfma_f32_16x16x32_bf16 v[28:31], v[244:247], v[236:239], v[28:31]
  s_waitcnt lgkmcnt(0)
  v_cvt_pk_f16_f32 v48, v16, v17
  v_cvt_pk_f16_f32 v49, v18, v19
  v_mfma_f32_16x16x32_f16 v[64:67], v[184:187], v[192:195], v[64:67]
  s_nop 0
  v_cvt_pk_f16_f32 v50, v20, v21
  v_cvt_pk_f16_f32 v51, v22, v23
  v_mfma_f32_16x16x32_f16 v[68:71], v[184:187], v[196:199], v[68:71]
  v_cvt_pk_f16_f32 v52, v24, v25
  v_cvt_pk_f16_f32 v53, v26, v27
  v_mfma_f32_16x16x32_f16 v[72:75], v[184:187], v[200:203], v[72:75]
  v_cvt_pk_f16_f32 v54, v28, v29
  v_cvt_pk_f16_f32 v55, v30, v31
  v_mfma_f32_16x16x32_f16 v[76:79], v[184:187], v[204:207], v[76:79]
  v_pk_fma_f16 v56, v48, v48, s20 op_sel_hi:[1,1,0] neg_lo:[1,0,0] neg_hi:[1,0,0] clamp
  v_pk_fma_f16 v57, v49, v49, s20 op_sel_hi:[1,1,0] neg_lo:[1,0,0] neg_hi:[1,0,0] clamp
  v_mfma_f32_16x16x32_f16 v[80:83], v[184:187], v[208:211], v[80:83]
  v_pk_fma_f16 v58, v50, v50, s20 op_sel_hi:[1,1,0] neg_lo:[1,0,0] neg_hi:[1,0,0] clamp
  v_pk_fma_f16 v59, v51, v51, s20 op_sel_hi:[1,1,0] neg_lo:[1,0,0] neg_hi:[1,0,0] clamp
  v_mfma_f32_16x16x32_f16 v[84:87], v[184:187], v[212:215], v[84:87]
  v_pk_fma_f16 v184, v56, v56, s20 op_sel:[0,0,1]
  v_pk_fma_f16 v185, v57, v57, s20 op_sel:[0,0,1]
  v_pk_fma_f16 v186, v58, v58, s20 op_sel:[0,0,1]
  v_pk_fma_f16 v187, v59, v59, s20 op_sel:[0,0,1]
  v_pk_fma_f16 v184, v184, v56, s21 op_sel_hi:[1,1,0]
  v_pk_fma_f16 v185, v185, v57, s21 op_sel_hi:[1,1,0]
  v_pk_fma_f16 v186, v186, v58, s21 op_sel_hi:[1,1,0]
  v_pk_fma_f16 v187, v187, v59, s21 op_sel_hi:[1,1,0]
  v_pk_fma_f16 v184, v184, v48, 0.5 op_sel_hi:[1,1,0] clamp
  v_pk_fma_f16 v185, v185, v49, 0.5 op_sel_hi:[1,1,0] clamp
  v_mfma_f32_16x16x32_f16 v[88:91], v[188:191], v[192:195], v[88:91]
  ds_read_b128 v[192:195], v1 offset:2048
  v_pk_fma_f16 v186, v186, v50, 0.5 op_sel_hi:[1,1,0] clamp
  v_pk_fma_f16 v187, v187, v51, 0.5 op_sel_hi:[1,1,0] clamp
  v_mfma_f32_16x16x32_f16 v[92:95], v[188:191], v[196:199], v[92:95]
  ds_read_b128 v[196:199], v1 offset:3072
  v_pk_mul_f16 v184, v184, v48
  v_pk_mul_f16 v185, v185, v49
  v_mfma_f32_16x16x32_f16 v[96:99], v[188:191], v[200:203], v[96:99]
  ds_read_b128 v[200:203], v1 offset:4096
  v_pk_mul_f16 v186, v186, v50
  v_pk_mul_f16 v187, v187, v51
  v_mfma_f32_16x16x32_f16 v[100:103], v[188:191], v[204:207], v[100:103]
  ds_read_b128 v[204:207], v1 offset:5120
  v_pk_fma_f16 v56, v52, v52, s20 op_sel_hi:[1,1,0] neg_lo:[1,0,0] neg_hi:[1,0,0] clamp
  v_pk_fma_f16 v57, v53, v53, s20 op_sel_hi:[1,1,0] neg_lo:[1,0,0] neg_hi:[1,0,0] clamp
  v_mfma_f32_16x16x32_f16 v[104:107], v[188:191], v[208:211], v[104:107]
  s_nop 0
  ds_read_b128 v[208:211], v1 offset:6144
  v_pk_fma_f16 v58, v54, v54, s20 op_sel_hi:[1,1,0] neg_lo:[1,0,0] neg_hi:[1,0,0] clamp
  v_pk_fma_f16 v59, v55, v55, s20 op_sel_hi:[1,1,0] neg_lo:[1,0,0] neg_hi:[1,0,0] clamp
  v_mfma_f32_16x16x32_f16 v[108:111], v[188:191], v[212:215], v[108:111]
  s_waitcnt lgkmcnt(4)
  ds_read_b128 v[212:215], v1 offset:7168
  v_pk_fma_f16 v188, v56, v56, s20 op_sel:[0,0,1]
  v_pk_fma_f16 v189, v57, v57, s20 op_sel:[0,0,1]
  v_pk_fma_f16 v190, v58, v58, s20 op_sel:[0,0,1]
  v_pk_fma_f16 v191, v59, v59, s20 op_sel:[0,0,1]
  v_pk_fma_f16 v188, v188, v56, s21 op_sel_hi:[1,1,0]
  v_pk_fma_f16 v189, v189, v57, s21 op_sel_hi:[1,1,0]
  v_pk_fma_f16 v190, v190, v58, s21 op_sel_hi:[1,1,0]
  v_pk_fma_f16 v191, v191, v59, s21 op_sel_hi:[1,1,0]
  v_mfma_f32_16x16x32_f16 v[64:67], v[184:187], v[192:195], v[64:67]
  s_waitcnt lgkmcnt(4)
  v_pk_fma_f16 v188, v188, v52, 0.5 op_sel_hi:[1,1,0] clamp
  v_pk_fma_f16 v189, v189, v53, 0.5 op_sel_hi:[1,1,0] clamp
  v_mfma_f32_16x16x32_f16 v[68:71], v[184:187], v[196:199], v[68:71]
  s_waitcnt lgkmcnt(3)
  v_pk_fma_f16 v190, v190, v54, 0.5 op_sel_hi:[1,1,0] clamp
  v_pk_fma_f16 v191, v191, v55, 0.5 op_sel_hi:[1,1,0] clamp
  v_mfma_f32_16x16x32_f16 v[72:75], v[184:187], v[200:203], v[72:75]
  s_waitcnt lgkmcnt(2)
  v_pk_mul_f16 v188, v188, v52
  v_pk_mul_f16 v189, v189, v53
  v_mfma_f32_16x16x32_f16 v[76:79], v[184:187], v[204:207], v[76:79]
  s_waitcnt lgkmcnt(1)
  v_pk_mul_f16 v190, v190, v54
  v_pk_mul_f16 v191, v191, v55
  v_cvt_pk_bf16_f32 v112, v64, v68
  v_cvt_pk_bf16_f32 v116, v65, v69
  v_mfma_f32_16x16x32_f16 v[80:83], v[184:187], v[208:211], v[80:83]
  s_waitcnt lgkmcnt(0)
  v_cvt_pk_bf16_f32 v120, v66, v70
  v_cvt_pk_bf16_f32 v124, v67, v71
  v_mfma_f32_16x16x32_f16 v[84:87], v[184:187], v[212:215], v[84:87]
  s_nop 0
  v_cvt_pk_bf16_f32 v113, v72, v76
  v_cvt_pk_bf16_f32 v117, v73, v77
  v_cvt_pk_bf16_f32 v121, v74, v78
  v_cvt_pk_bf16_f32 v125, v75, v79
  v_mfma_f32_16x16x32_f16 v[88:91], v[188:191], v[192:195], v[88:91]
  s_nop 0
  v_mfma_f32_16x16x32_f16 v[92:95], v[188:191], v[196:199], v[92:95]
  s_nop 1
  v_cvt_pk_bf16_f32 v114, v80, v84
  v_cvt_pk_bf16_f32 v118, v81, v85
  v_cvt_pk_bf16_f32 v122, v82, v86
  v_mfma_f32_16x16x32_f16 v[96:99], v[188:191], v[200:203], v[96:99]
  v_cvt_pk_bf16_f32 v126, v83, v87
  s_nop 0
  v_mfma_f32_16x16x32_f16 v[100:103], v[188:191], v[204:207], v[100:103]
  s_nop 0
  v_cvt_pk_bf16_f32 v128, v88, v92
  v_cvt_pk_bf16_f32 v132, v89, v93
  v_cvt_pk_bf16_f32 v136, v90, v94
  v_cvt_pk_bf16_f32 v140, v91, v95
  v_mfma_f32_16x16x32_f16 v[104:107], v[188:191], v[208:211], v[104:107]
  s_nop 0
  s_nop 0
  v_mfma_f32_16x16x32_f16 v[108:111], v[188:191], v[212:215], v[108:111]
  buffer_store_dwordx3 v[112:114], v10, s[8:11], s28 offen sc1 nt
  v_cvt_pk_bf16_f32 v129, v96, v100
  buffer_store_dwordx3 v[116:118], v10, s[8:11], s28 offen offset:384 sc1 nt
  v_cvt_pk_bf16_f32 v133, v97, v101
  buffer_store_dwordx3 v[120:122], v10, s[8:11], s57 offen sc1 nt
  v_cvt_pk_bf16_f32 v137, v98, v102
  buffer_store_dwordx3 v[124:126], v10, s[8:11], s57 offen offset:384 sc1 nt
  v_cvt_pk_bf16_f32 v141, v99, v103
  v_cvt_pk_bf16_f32 v130, v104, v108
  v_cvt_pk_bf16_f32 v134, v105, v109
  buffer_store_dwordx3 v[128:130], v10, s[8:11], s59 offen sc1 nt
  v_cvt_pk_bf16_f32 v138, v106, v110
  buffer_store_dwordx3 v[132:134], v10, s[8:11], s59 offen offset:384 sc1 nt
  v_cvt_pk_bf16_f32 v142, v107, v111
  buffer_store_dwordx3 v[136:138], v10, s[8:11], s15 offen sc1 nt
  buffer_store_dwordx3 v[140:142], v10, s[8:11], s15 offen offset:384 sc1 nt
L_end:
  s_endpgm
L_cend:
L_slow:
  s_waitcnt vmcnt(0) lgkmcnt(0)
  s_nop 15
  s_nop 15
  s_barrier
  v_mbcnt_lo_u32_b32 v0, -1, 0
  v_mbcnt_hi_u32_b32 v0, -1, v0
  v_lshl_add_u32 v0, s27, 6, v0
  s_nop 4
  .p2align 7
  s_cmp_ge_u32 s2, 0x100
  s_cbranch_scc1 S_end
  s_nop 0
  s_load_dwordx2 s[4:5], s[0:1], 0
  s_load_dwordx2 s[60:61], s[0:1], 8
  s_load_dwordx2 s[64:65], s[0:1], 16
  s_load_dwordx2 s[68:69], s[0:1], 24
  s_load_dwordx2 s[72:73], s[0:1], 32
  s_load_dwordx2 s[76:77], s[0:1], 40
  s_load_dwordx2 s[80:81], s[0:1], 48
  s_load_dwordx2 s[8:9], s[0:1], 56
  s_getpc_b64 s[40:41]
S_pc:
  s_lshl_b32 s32, s2, 9
  s_and_b32 s32, s32, 0xf000
  v_lshl_add_u32 v249, v0, 4, s32
  v_lshrrev_b32_e64 v112, 6, v0
  v_min_u32 v249, S_end-S_pc-12, v249
  v_and_b32 v113, 63, v0
  global_load_dwordx4 v[108:111], v249, s[40:41]
  v_readfirstlane_b32 s27, v112
  s_mov_b32 s62, 0x6c0
  s_mov_b32 s63, 0x20000
  s_mov_b32 s82, 0xc0
  s_mov_b32 s83, 0x20000
  s_mov_b32 s78, 0xc0
  s_mov_b32 s79, 0x20000
  s_mov_b32 s66, 0x12000
  s_mov_b32 s67, 0x20000
  s_mov_b32 s74, 0x12000
  s_mov_b32 s75, 0x20000
  v_bfe_u32 v114, v113, 3, 1
  v_bfe_u32 v115, v113, 4, 1
  v_bfe_u32 v116, v113, 2, 1
  v_and_b32 v117, 3, v113
  v_lshlrev_b32 v118, 4, v113
  s_min_u32 s44, s27, 2
  s_lshl_b32 s45, s44, 6
  s_mul_i32 s46, s44, 0x240
  v_lshlrev_b32 v119, 1, v113
  v_and_b32 v120, 31, v113
  v_lshlrev_b32_e64 v121, 1, v120
  v_lshlrev_b32_e64 v122, 4, v115
  v_lshl_add_u32 v122, v116, 3, v122
  v_lshl_add_u32 v122, v114, 2, v122
  v_add_u32_e64 v122, v122, v117
  v_lshlrev_b32_e64 v123, 1, v122
  s_lshr_b32 s35, s2, 3
  s_lshl_b32 s35, s35, 2
  s_add_u32 s35, s35, s27
  s_sub_u32 s55, s35, 0x48
  s_min_u32 s35, s35, s55
  s_lshl_b32 s47, s35, 10
  s_and_b32 s54, s2, 6
  s_lshl_b32 s54, s54, 1
  s_lshr_b32 s32, s2, 6
  s_add_u32 s54, s54, s32
  s_mul_i32 s59, s54, 0x300000
  s_and_b32 s53, s2, 1
  s_lshl_b32 s53, s53, 8
  s_and_b32 s32, s2, 56
  s_lshl_b32 s32, s32, 2
  s_add_u32 s53, s53, s32
  s_lshl_b32 s32, s27, 3
  s_add_u32 s53, s53, s32
  s_mul_i32 s3, s53, 0xc0
  s_add_u32 s3, s3, 0xf40
  s_mov_b32 s6, 0x3000000
  s_mov_b32 s7, 0x20000
  s_cmp_eq_u32 s53, 0
  s_cselect_b32 s35, 12, 0
  s_sub_u32 s55, 0x78, s35
  s_cmp_eq_u32 s53, 0x1f8
  s_cselect_b32 s55, 0x6c, s55
  s_mul_i32 s15, s27, 0x1040
  s_add_u32 s48, s59, 0x17000
  s_add_u32 s49, s59, 0x47000
  s_waitcnt lgkmcnt(0)
  v_add_u32 v124, 64, v113
  buffer_load_dwordx4 v[108:111], v118, s[64:67], s47 offen
  v_subrev_u32 v127, 57, v113
  v_cmp_le_u32 vcc, 57, v113
  buffer_load_dwordx4 v[108:111], v118, s[72:75], s47 offen
  v_add_u32_e64 v125, 7, v113
  v_add_u32 v126, 0x47, v113
  buffer_load_ushort v129, v119, s[60:63], s46 offen
  v_mov_b32 v199, 0x17c00
  v_cndmask_b32_e64 v124, v124, v127, vcc
  buffer_load_ushort v130, v119, s[60:63], s46 offen offset:128
  v_mov_b32 v127, 0xfffffc00
  v_cndmask_b32_e64 v199, v127, v199, vcc
  v_add_u32_e64 v198, s3, v118
  buffer_load_ushort v131, v119, s[60:63], s46 offen offset:256
  v_lshl_add_u32 v199, v124, 4, v199
  v_add_u32_e64 v199, s3, v199
  buffer_load_ushort v132, v119, s[60:63], s46 offen offset:384
  v_add_u32 v200, 0x17870, v198
  v_add_u32 v201, 0x17870, v198
  buffer_load_ushort v133, v121, s[60:63], s46 offen offset:512
  v_mov_b32 v128, 0x80000000
  v_subrev_u32_e64 v6, s35, v113
  buffer_load_ushort v137, v123, s[80:83], s45 offen
  v_cmp_gt_u32 s[36:37], s55, v6
  v_subrev_u32_e64 v7, s35, v124
  v_cmp_gt_u32 s[38:39], s55, v7
  buffer_load_ushort v138, v123, s[76:79], s45 offen
  v_subrev_u32_e64 v8, s35, v125
  v_cmp_gt_u32 s[40:41], s55, v8
  buffer_load_ushort v134, v123, s[80:83], 0 offen
  v_subrev_u32_e64 v9, s35, v126
  v_cmp_gt_u32 s[42:43], s55, v9
  buffer_load_ushort v135, v123, s[80:83], 0 offen offset:64
  v_cndmask_b32 v6, v128, v198, s[36:37]
  v_cndmask_b32 v7, v128, v199, s[38:39]
  buffer_load_ushort v136, v123, s[80:83], 0 offen offset:128
  v_cndmask_b32 v8, v128, v200, s[40:41]
  v_cndmask_b32 v9, v128, v201, s[42:43]
  s_add_u32 m0, s15, 0x4120
  s_nop 0
  buffer_load_dwordx4 v6, s[4:7], s48 offen lds
  buffer_load_dwordx4 v7, s[4:7], s48 offen offset:1024 lds
  buffer_load_dwordx4 v8, s[4:7], s48 offen offset:2048 lds
  buffer_load_dwordx4 v9, s[4:7], s48 offen offset:3072 lds
  s_sub_u32 s56, s59, 0x19000
  v_add_u32 v198, s56, v6
  s_add_u32 s56, s56, 0x400
  v_add_u32_e64 v199, s56, v7
  s_add_u32 s56, s56, 0x400
  v_add_u32_e64 v200, s56, v8
  s_add_u32 s56, s56, 0x400
  v_add_u32 v201, s56, v9
  v_lshrrev_b32 v139, 5, v113
  v_lshlrev_b32_e64 v202, 4, v117
  v_lshl_add_u32 v202, v139, 6, v202
  v_bfe_u32 v124, v113, 3, 2
  v_lshl_add_u32 v124, v116, 2, v124
  v_cmp_eq_u32 vcc, 7, v124
  v_mul_u32_u24 v203, 0x300, v124
  v_add_u32 v203, v203, v202
  v_cndmask_b32_e64 v204, v128, v202, vcc
  s_mov_b32 s70, 0x300
  s_mov_b32 s71, 0x20000
  s_mov_b32 s10, 0x3000000
  s_mov_b32 s11, 0x20000
  s_and_b32 s36, s27, 2
  s_add_u32 s37, s27, 1
  s_lshr_b32 s37, s37, 1
  s_and_b32 s38, s37, 1
  s_cmp_eq_u32 s27, 1
  s_cselect_b32 s39, 0, 3
  s_cselect_b32 s51, 0x1000, 0
  s_lshl_b32 s32, s36, 8
  s_lshl_b32 s33, s37, 8
  s_add_u32 s43, s32, 0x11d00
  s_add_u32 s50, s33, 0x11d00
  s_add_u32 s51, s51, s33
  s_mul_i32 s40, s38, 0x6000
  s_add_u32 s40, s40, s32
  s_mul_i32 s41, s38, 0x1800
  s_add_u32 s41, s41, s32
  s_add_u32 s41, s41, 0x3000
  s_mul_i32 s42, s39, 0x3000
  s_add_u32 s42, s42, s33
  s_mul_i32 s32, s36, 0x6000
  s_lshl_b32 s33, s38, 11
  s_add_u32 s33, s33, s32
  s_add_u32 s33, s33, 0x10000
  v_add_u32_e64 v195, s33, v118
  s_lshl_b32 s33, s38, 3
  s_add_u32 s33, s33, s32
  s_add_u32 s33, s33, 0x10400
  v_add_u32_e64 v196, s33, v118
  s_mul_i32 s32, s37, 0x6000
  s_lshl_b32 s33, s39, 10
  s_add_u32 s33, s33, s32
  s_add_u32 s33, s33, 0x10000
  v_add_u32 v197, s33, v118
  v_add_u32 v125, 16, v113
  v_lshrrev_b32_e64 v125, 6, v125
  buffer_load_dwordx4 a[72:75], v202, s[64:67], s43 offen
  v_lshlrev_b32 v125, 4, v125
  v_xor_b32 v254, v125, v118
  v_lshl_add_u32 v125, v139, 4, 16
  v_xor_b32_e64 v255, v125, v118
  v_mul_u32_u24 v125, 0x1200, v139
  v_add_u32_e64 v255, v125, v255
  v_add_u32 v125, 0xb0, v113
  v_lshrrev_b32 v125, 6, v125
  v_lshlrev_b32 v125, 4, v125
  v_xor_b32_e64 v194, v125, v118
  v_add_u32 v194, 0x1200, v194
  s_mul_i32 s14, s27, 0x1800
  s_add_u32 s32, s27, 3
  s_and_b32 s32, s32, 3
  s_mul_i32 s32, s32, 0x600
  s_cmp_eq_u32 s27, 0
  s_cselect_b32 s57, 0, 3
  s_cselect_b32 s53, 3, 6
  s_cselect_b32 s55, 6, 0
  s_lshl_b32 s57, s57, 13
  s_add_u32 s57, s57, s32
  s_add_u32 s58, s57, 0x3000
  s_lshl_b32 s53, s53, 13
  s_add_u32 s53, s53, s32
  s_add_u32 s54, s53, 0x3000
  s_lshl_b32 s55, s55, 13
  s_add_u32 s55, s55, s32
  s_add_u32 s56, s55, 0x3000
  v_and_b32_e64 v145, 7, v113
  buffer_load_dwordx4 a[76:79], v202, s[64:67], s43 offen offset:128
  v_lshrrev_b32 v146, 4, v113
  v_lshlrev_b32 v147, 4, v139
  v_and_b32 v141, 1, v113
  v_lshlrev_b32 v141, 4, v141
  v_mov_b32 v127, 0xffff
  v_lshlrev_b32_e64 v127, v141, v127
  v_bfe_u32 v125, v113, 1, 2
  buffer_load_dwordx4 a[80:83], v202, s[64:67], s50 offen
  v_lshlrev_b32 v125, v125, 1
  v_bfe_i32 v56, v125, 0, 1
  v_mov_b32 v60, 0
  v_and_b32 v56, v56, v127
  v_bfe_i32 v57, v125, 1, 1
  v_mov_b32 v61, 0
  v_and_b32 v57, v57, v127
  v_bfe_i32 v58, v125, 2, 1
  v_mov_b32 v62, 0
  v_and_b32 v58, v58, v127
  v_bfe_i32 v59, v125, 3, 1
  v_mov_b32 v63, 0
  v_and_b32 v59, v59, v127
  v_min_u32_e64 v125, 35, v113
  v_mul_u32_u24 v125, 0x190, v125
  ds_write_b128 v125, v[60:63] offset:50304
  s_lshl_b32 s32, s44, 7
  v_lshrrev_b32 v142, 3, v113
  buffer_load_dwordx4 a[84:87], v202, s[64:67], s50 offen offset:128
  v_mul_u32_u24 v142, 0x190, v142
  v_lshl_add_u32 v142, v145, 4, v142
  v_add_u32 v142, s32, v142
  v_lshrrev_b32 v143, 3, v120
  v_mul_u32_u24 v143, 0x190, v143
  v_lshl_add_u32 v143, v145, 4, v143
  v_add_u32_e64 v143, s32, v143
  v_lshl_add_u32 v144, v120, 2, s32
  v_sub_u32_e64 v125, v146, v116
  v_lshl_add_u32 v126, v114, 2, v117
  v_lshl_add_u32 v126, v125, 3, v126
  v_min_u32 v126, 24, v126
  v_lshlrev_b32 v126, 4, v126
  v_add_u32 v3, 0xc300, v126
  v_lshlrev_b32_e64 v148, 2, v115
  v_lshl_add_u32 v148, v114, 1, v148
  v_bfe_u32 v126, v113, 1, 1
  buffer_load_dwordx4 a[88:91], v204, s[68:71], s51 offen
  v_add_u32 v148, v148, v126
  v_xor_b32 v126, v116, v139
  v_lshl_add_u32 v148, v126, 3, v148
  v_lshlrev_b32 v148, v148, 1
  v_mov_b32 v126, 0x3f80
  v_lshlrev_b32_e64 v126, v141, v126
  v_mov_b32 v125, 0xbf80
  v_lshlrev_b32_e64 v125, v141, v125
  v_bfe_i32 v160, v148, 0, 1
  v_and_b32 v240, v160, v126
  v_and_b32 v184, v160, v125
  v_bfe_i32 v161, v148, 1, 1
  v_and_b32 v241, v161, v126
  v_and_b32 v185, v161, v125
  v_bfe_i32 v162, v148, 2, 1
  v_and_b32 v242, v162, v126
  v_and_b32 v186, v162, v125
  v_bfe_i32 v163, v148, 3, 1
  buffer_load_dwordx4 a[92:95], v204, s[68:71], s51 offen offset:128
  v_and_b32 v243, v163, v126
  v_and_b32 v187, v163, v125
  v_bfe_i32 v164, v148, 4, 1
  v_and_b32 v244, v164, v126
  v_and_b32 v188, v164, v125
  v_bfe_i32 v165, v148, 5, 1
  v_and_b32 v245, v165, v126
  v_and_b32 v189, v165, v125
  v_bfe_i32 v166, v148, 6, 1
  v_and_b32 v246, v166, v126
  v_and_b32 v190, v166, v125
  v_bfe_i32 v167, v148, 7, 1
  v_and_b32 v247, v167, v126
  v_and_b32 v191, v167, v125
  s_mov_b32 s22, 0x3eeff558
  s_mov_b32 s24, 0x3c2aaaab
  s_mov_b32 s25, 0x3727c5ac
  s_mov_b32 s20, 0x409d30fc
  s_mov_b32 s21, 0x409d30fc
  s_mov_b32 s23, 0x3eeff558
  s_mov_b32 s12, 0
  s_mov_b32 s13, -1
  s_add_u32 s29, s59, 0x77000
  s_add_u32 s52, s59, 0xa7000
  v_mul_u32_u24 v149, 0xc0, v145
  buffer_load_dwordx4 a[0:3], v203, s[64:67], s40 offen
  v_add_u32_e64 v127, s15, v149
  v_lshl_add_u32 v150, v114, 1, v146
  v_lshrrev_b32_e64 v125, 1, v150
  v_mul_u32_u24 v140, 0x4100, v125
  v_and_b32_e64 v125, 1, v125
  v_lshl_add_u32 v140, v125, 5, v140
  v_and_b32_e64 v125, 1, v150
  v_mul_u32_u24 v125, 0x790, v125
  v_add3_u32 v4, v140, v125, v127
  v_lshl_add_u32 v151, v114, 1, v115
  buffer_load_dwordx4 a[4:7], v203, s[64:67], s40 offen offset:128
  s_add_u32 s40, s40, 0x1800
  v_add_u32_e64 v150, 1, v151
  v_add_u32 v127, 0xc0, v127
  v_add_u32_e64 v127, v127, v147
  v_lshrrev_b32_e64 v125, 1, v150
  v_mul_u32_u24 v140, 0x4100, v125
  v_and_b32_e64 v125, 1, v125
  v_lshl_add_u32 v140, v125, 5, v140
  v_and_b32_e64 v125, 1, v150
  v_mul_u32_u24 v125, 0x790, v125
  v_add3_u32 v5, v140, v125, v127
  v_mul_u32_u24 v125, 0x18000, v151
  v_add3_u32 v10, v125, v147, v149
  s_sub_u32 s32, s3, 0xf40
  v_add_u32_e64 v10, s32, v10
  v_add_u32 v2, 0xfb40, v147
  v_add_u32 v0, 0x10000, v118
  v_add_u32 v1, 0x20000, v118
  v_and_b32_e64 v125, 15, v113
  buffer_load_dwordx4 a[8:11], v203, s[64:67], s40 offen
  v_lshlrev_b32 v125, 7, v125
  v_mul_u32_u24 v126, 0x18000, v146
  s_sub_u32 s32, s3, 64
  v_add3_u32 v248, v125, v126, s32
  v_mov_b32 v250, 0x3ef00000
  s_add_u32 s32, s14, 0x16000
  v_add_u32_e64 v253, s32, v118
  v_bfe_u32 v125, v122, 2, 2
  v_xor_b32_e64 v125, v125, v139
  v_lshl_add_u32 v125, v125, 4, s32
  v_mul_u32_u24 v126, 0xc0, v122
  v_add_u32_e64 v251, v125, v126
  v_xor_b32_e64 v252, 32, v251
  s_add_u32 s30, s15, 32
  s_add_u32 s31, s15, 0x4100
  s_mov_b32 s34, s59
  s_mov_b32 s28, 0x80000000
  s_add_u32 s33, s15, 0x8200
  buffer_load_dwordx4 a[12:15], v203, s[64:67], s40 offen offset:128
  buffer_load_dwordx4 a[16:19], v203, s[64:67], s41 offen
  buffer_load_dwordx4 a[20:23], v203, s[64:67], s41 offen offset:128
  s_waitcnt vmcnt(25)
  v_lshl_or_b32 v129, v129, 16, v129
  v_and_b32 v16, v56, v129
  v_and_b32 v17, v57, v129
  v_and_b32 v18, v58, v129
  v_and_b32_e64 v19, v59, v129
  ds_write_b128 v142, v[16:19] offset:49920
  s_waitcnt vmcnt(24)
  v_lshl_or_b32 v130, v130, 16, v130
  v_and_b32 v20, v56, v130
  v_and_b32 v21, v57, v130
  v_and_b32 v22, v58, v130
  v_and_b32 v23, v59, v130
  ds_write_b128 v142, v[20:23] offset:53120
  s_waitcnt vmcnt(23)
  v_lshl_or_b32 v131, v131, 16, v131
  v_and_b32 v24, v56, v131
  v_and_b32 v25, v57, v131
  v_and_b32 v26, v58, v131
  v_and_b32 v27, v59, v131
  ds_write_b128 v142, v[24:27] offset:56320
  s_waitcnt vmcnt(22)
  v_lshl_or_b32 v132, v132, 16, v132
  v_and_b32 v28, v56, v132
  v_and_b32 v29, v57, v132
  v_and_b32 v30, v58, v132
  v_and_b32 v31, v59, v132
  ds_write_b128 v142, v[28:31] offset:59520
  s_waitcnt vmcnt(21)
  v_lshl_or_b32 v133, v133, 16, v133
  v_and_b32 v16, v56, v133
  v_and_b32 v17, v57, v133
  v_and_b32 v18, v58, v133
  v_and_b32 v19, v59, v133
  ds_write_b128 v143, v[16:19] offset:62720
  s_waitcnt vmcnt(20)
  v_lshlrev_b32 v137, 16, v137
  s_waitcnt vmcnt(19)
  v_lshlrev_b32 v138, 16, v138
  v_mul_f32 v138, v137, v138
  s_waitcnt vmcnt(18)
  v_lshlrev_b32 v134, v141, v134
  s_waitcnt vmcnt(17)
  v_lshlrev_b32 v135, v141, v135
  s_waitcnt vmcnt(16)
  v_lshlrev_b32_e64 v136, v141, v136
  ds_write_b32 v144, v138 offset:64320
  s_waitcnt lgkmcnt(0)
  s_barrier
  ds_read_b128 a[96:99], v3
  ds_read_b128 a[100:103], v3 offset:4800
  ds_read_b128 a[104:107], v3 offset:9600
  ds_read_b128 a[108:111], v3 offset:400
  ds_read_b128 a[112:115], v3 offset:5200
  ds_read_b128 a[116:119], v3 offset:10000
  v_and_b32 v125, v160, v134
  v_and_b32 v126, v161, v134
  v_and_b32_e64 v127, v162, v134
  buffer_load_dwordx4 a[24:27], v203, s[64:67], s42 offen
  v_and_b32_e64 v140, v163, v134
  v_accvgpr_write_b32 a192, v125
  v_accvgpr_write_b32 a193, v126
  v_accvgpr_write_b32 a194, v127
  v_accvgpr_write_b32 a195, v140
  ds_read_b128 a[120:123], v3 offset:800
  ds_read_b128 a[124:127], v3 offset:5600
  ds_read_b128 a[128:131], v3 offset:10400
  ds_read_b128 a[132:135], v3 offset:1200
  ds_read_b128 a[136:139], v3 offset:6000
  ds_read_b128 a[140:143], v3 offset:10800
  buffer_load_dwordx4 a[28:31], v203, s[64:67], s42 offen offset:128
  s_add_u32 s42, s42, 0x1800
  v_and_b32 v125, v164, v134
  v_and_b32 v126, v165, v134
  v_and_b32 v127, v166, v134
  v_and_b32 v140, v167, v134
  v_accvgpr_write_b32 a196, v125
  v_accvgpr_write_b32 a197, v126
  v_accvgpr_write_b32 a198, v127
  v_accvgpr_write_b32 a199, v140
  ds_read_b128 a[144:147], v3 offset:1600
  ds_read_b128 a[148:151], v3 offset:6400
  buffer_load_dwordx4 a[32:35], v203, s[64:67], s42 offen
  ds_read_b128 a[152:155], v3 offset:11200
  ds_read_b128 a[156:159], v3 offset:2000
  ds_read_b128 a[160:163], v3 offset:6800
  ds_read_b128 a[164:167], v3 offset:11600
  v_and_b32 v125, v160, v135
  v_and_b32 v126, v161, v135
  v_and_b32 v127, v162, v135
  v_and_b32 v140, v163, v135
  v_accvgpr_write_b32 a200, v125
  v_accvgpr_write_b32 a201, v126
  v_accvgpr_write_b32 a202, v127
  buffer_load_dwordx4 a[36:39], v203, s[64:67], s42 offen offset:128
  s_add_u32 s42, s42, 0x1800
  v_accvgpr_write_b32 a203, v140
  ds_read_b128 a[240:243], v3 offset:2400
  ds_read_b128 a[244:247], v3 offset:7200
  ds_read_b128 a[248:251], v3 offset:12000
  ds_read_b128 a[168:171], v3 offset:2800
  ds_read_b128 a[172:175], v3 offset:7600
  ds_read_b128 a[176:179], v3 offset:12400
  v_and_b32 v125, v164, v135
  v_and_b32 v126, v165, v135
  v_and_b32 v127, v166, v135
  v_and_b32 v140, v167, v135
  buffer_load_dwordx4 a[40:43], v203, s[64:67], s42 offen
  v_accvgpr_write_b32 a204, v125
  v_accvgpr_write_b32 a205, v126
  v_accvgpr_write_b32 a206, v127
  v_accvgpr_write_b32 a207, v140
  ds_read_b128 a[252:255], v3 offset:3200
  ds_read_b128 a[180:183], v3 offset:8000
  ds_read_b128 a[184:187], v3 offset:12800
  ds_read_b128 a[188:191], v3 offset:3600
  ds_read_b128 a[216:219], v3 offset:8400
  ds_read_b128 a[220:223], v3 offset:13200
  buffer_load_dwordx4 a[44:47], v203, s[64:67], s42 offen offset:128
  s_add_u32 s42, s42, 0x1800
  v_and_b32 v125, v160, v136
  v_and_b32 v126, v161, v136
  v_and_b32 v127, v162, v136
  v_and_b32 v140, v163, v136
  v_accvgpr_write_b32 a208, v125
  v_accvgpr_write_b32 a209, v126
  v_accvgpr_write_b32 a210, v127
  v_accvgpr_write_b32 a211, v140
  ds_read_b128 a[224:227], v3 offset:4000
  ds_read_b128 a[228:231], v3 offset:8800
  ds_read_b128 a[232:235], v3 offset:13600
  buffer_load_dwordx4 a[48:51], v203, s[64:67], s42 offen
  ds_read_b128 a[236:239], v3 offset:4400
  ds_read_b128 v[208:211], v3 offset:9200
  ds_read_b128 v[212:215], v3 offset:14000
  v_and_b32 v125, v164, v136
  v_and_b32 v126, v165, v136
  v_and_b32 v127, v166, v136
  v_and_b32 v140, v167, v136
  v_accvgpr_write_b32 a212, v125
  v_accvgpr_write_b32 a213, v126
  v_accvgpr_write_b32 a214, v127
  buffer_load_dwordx4 a[52:55], v203, s[64:67], s42 offen offset:128
  s_add_u32 s42, s42, 0x1800
  v_accvgpr_write_b32 a215, v140
  s_waitcnt vmcnt(19)
  v_mfma_f32_32x32x16_bf16 v[16:31], a[72:75], v[184:187], 0
  buffer_load_dwordx4 a[56:59], v203, s[64:67], s42 offen
  s_waitcnt vmcnt(19)
  v_mfma_f32_32x32x16_bf16 v[16:31], a[76:79], v[188:191], v[16:31]
  s_waitcnt vmcnt(18)
  v_mfma_f32_32x32x16_bf16 v[32:47], a[80:83], v[184:187], 0
  s_nop 0
  buffer_load_dwordx4 a[60:63], v203, s[64:67], s42 offen offset:128
  s_add_u32 s42, s42, 0x1800
  s_waitcnt vmcnt(15)
  v_mfma_f32_32x32x16_bf16 v[48:63], a[0:3], v[240:243], v[16:31]
  s_nop 0
  buffer_load_dwordx4 a[64:67], v203, s[64:67], s42 offen
  v_mfma_f32_32x32x16_bf16 v[32:47], a[84:87], v[188:191], v[32:47]
  s_waitcnt vmcnt(15)
  v_mfma_f32_32x32x16_bf16 v[48:63], a[4:7], v[244:247], v[48:63]
  buffer_load_dwordx4 a[68:71], v203, s[64:67], s42 offen offset:128
  s_waitcnt vmcnt(15)
  v_mfma_f32_32x32x16_bf16 v[216:231], a[8:11], v[240:243], v[16:31]
  s_add_u32 m0, s15, 0x8200
  s_nop 0
  buffer_load_dwordx4 v6, s[4:7], s49 offen lds
  s_waitcnt vmcnt(15)
  v_mfma_f32_32x32x16_bf16 v[216:231], a[12:15], v[244:247], v[216:231]
  buffer_load_dwordx4 v7, s[4:7], s49 offen offset:1024 lds
  s_nop 2
  v_cvt_pk_bf16_f32 v64, v48, v52
  v_cvt_pk_bf16_f32 v65, v56, v60
  v_cvt_pk_bf16_f32 v68, v49, v53
  v_cvt_pk_bf16_f32 v69, v57, v61
  s_waitcnt vmcnt(15)
  v_mfma_f32_32x32x16_bf16 v[96:111], a[16:19], v[240:243], v[16:31]
  buffer_load_dwordx4 v8, s[4:7], s49 offen offset:2048 lds
  v_cvt_pk_bf16_f32 v72, v50, v54
  v_cvt_pk_bf16_f32 v73, v58, v62
  v_cvt_pk_bf16_f32 v76, v51, v55
  v_cvt_pk_bf16_f32 v77, v59, v63
  s_waitcnt vmcnt(15)
  v_mfma_f32_32x32x16_bf16 v[96:111], a[20:23], v[244:247], v[96:111]
  buffer_load_dwordx4 v9, s[4:7], s49 offen offset:3072 lds
  v_cvt_pk_bf16_f32 v66, v216, v220
  v_cvt_pk_bf16_f32 v67, v224, v228
  v_cvt_pk_bf16_f32 v70, v217, v221
  v_cvt_pk_bf16_f32 v71, v225, v229
  ds_write_b128 v195, v[64:67]
  s_waitcnt vmcnt(15)
  v_mfma_f32_32x32x16_bf16 v[48:63], a[24:27], v[240:243], v[32:47]
  s_add_u32 m0, s15, 0
  s_nop 0
  buffer_load_dwordx4 v198, s[4:7], 0 offen lds
  ds_write_b128 v195, v[68:71] offset:6144
  v_cvt_pk_bf16_f32 v74, v218, v222
  v_cvt_pk_bf16_f32 v75, v226, v230
  v_cvt_pk_bf16_f32 v78, v219, v223
  v_cvt_pk_bf16_f32 v79, v227, v231
  s_waitcnt vmcnt(15)
  v_mfma_f32_32x32x16_bf16 v[48:63], a[28:31], v[244:247], v[48:63]
  s_add_u32 m0, s15, 0x400
  s_nop 0
  buffer_load_dwordx4 v199, s[4:7], 0 offen lds
  ds_write_b128 v195, v[72:75] offset:12288
  v_cvt_pk_bf16_f32 v80, v96, v100
  v_cvt_pk_bf16_f32 v81, v104, v108
  v_cvt_pk_bf16_f32 v84, v97, v101
  v_cvt_pk_bf16_f32 v85, v105, v109
  s_waitcnt vmcnt(15)
  v_mfma_f32_32x32x16_bf16 v[216:231], a[32:35], v[240:243], v[32:47]
  s_add_u32 m0, s15, 0x800
  s_nop 0
  buffer_load_dwordx4 v200, s[4:7], 0 offen lds
  ds_write_b128 v195, v[76:79] offset:18432
  v_cvt_pk_bf16_f32 v88, v98, v102
  v_cvt_pk_bf16_f32 v89, v106, v110
  v_cvt_pk_bf16_f32 v92, v99, v103
  v_cvt_pk_bf16_f32 v93, v107, v111
  s_waitcnt vmcnt(15)
  v_mfma_f32_32x32x16_bf16 v[216:231], a[36:39], v[244:247], v[216:231]
  s_add_u32 m0, s15, 0xc00
  s_nop 0
  buffer_load_dwordx4 v201, s[4:7], 0 offen lds
  ds_write_b64 v196, v[80:81]
  ds_write_b64 v196, v[84:85] offset:6144
  v_cvt_pk_bf16_f32 v64, v48, v52
  v_cvt_pk_bf16_f32 v65, v56, v60
  v_cvt_pk_bf16_f32 v68, v49, v53
  v_cvt_pk_bf16_f32 v69, v57, v61
  s_waitcnt vmcnt(15)
  v_mfma_f32_32x32x16_bf16 v[96:111], a[40:43], v[240:243], v[32:47]
  s_add_u32 m0, s14, 0x22000
  s_nop 0
  buffer_load_dwordx4 v254, s[72:75], s57 offen lds
  ds_write_b64 v196, v[88:89] offset:12288
  ds_write_b64 v196, v[92:93] offset:18432
  v_cvt_pk_bf16_f32 v72, v50, v54
  v_cvt_pk_bf16_f32 v73, v58, v62
  v_cvt_pk_bf16_f32 v76, v51, v55
  v_cvt_pk_bf16_f32 v77, v59, v63
  s_waitcnt vmcnt(15)
  v_mfma_f32_32x32x16_bf16 v[96:111], a[44:47], v[244:247], v[96:111]
  s_nop 0
  buffer_load_dwordx4 v255, s[72:75], s57 offen offset:1024 lds
  v_cvt_pk_bf16_f32 v66, v216, v220
  v_cvt_pk_bf16_f32 v67, v224, v228
  v_cvt_pk_bf16_f32 v70, v217, v221
  v_cvt_pk_bf16_f32 v71, v225, v229
  ds_write_b128 v197, v[64:67]
  s_waitcnt vmcnt(15)
  v_mfma_f32_32x32x16_bf16 v[48:63], a[48:51], v[240:243], v[32:47]
  s_nop 0
  buffer_load_dwordx4 v194, s[72:75], s57 offen offset:2048 lds
  ds_write_b128 v197, v[68:71] offset:6144
  v_cvt_pk_bf16_f32 v74, v218, v222
  v_cvt_pk_bf16_f32 v75, v226, v230
  v_cvt_pk_bf16_f32 v78, v219, v223
  v_cvt_pk_bf16_f32 v79, v227, v231
  s_waitcnt vmcnt(15)
  v_mfma_f32_32x32x16_bf16 v[48:63], a[52:55], v[244:247], v[48:63]
  s_add_u32 m0, s14, 0x22c00
  s_nop 0
  buffer_load_dwordx4 v254, s[72:75], s58 offen lds
  ds_write_b128 v197, v[72:75] offset:12288
  v_cvt_pk_bf16_f32 v80, v96, v100
  v_cvt_pk_bf16_f32 v81, v104, v108
  v_cvt_pk_bf16_f32 v84, v97, v101
  v_cvt_pk_bf16_f32 v85, v105, v109
  s_waitcnt vmcnt(15)
  v_mfma_f32_32x32x16_bf16 v[216:231], a[56:59], v[240:243], v[32:47]
  s_nop 0
  buffer_load_dwordx4 v255, s[72:75], s58 offen offset:1024 lds
  ds_write_b128 v197, v[76:79] offset:18432
  v_cvt_pk_bf16_f32 v88, v98, v102
  v_cvt_pk_bf16_f32 v89, v106, v110
  v_cvt_pk_bf16_f32 v92, v99, v103
  v_cvt_pk_bf16_f32 v93, v107, v111
  v_mfma_f32_32x32x16_bf16 v[96:111], a[88:91], v[240:243], v[32:47]
  s_waitcnt vmcnt(15)
  v_mfma_f32_32x32x16_bf16 v[216:231], a[60:63], v[244:247], v[216:231]
  s_nop 0
  buffer_load_dwordx4 v194, s[72:75], s58 offen offset:2048 lds
  v_cvt_pk_bf16_f32 v82, v48, v52
  v_cvt_pk_bf16_f32 v83, v56, v60
  v_cvt_pk_bf16_f32 v86, v49, v53
  v_cvt_pk_bf16_f32 v87, v57, v61
  ds_write_b128 v197, v[80:83] offset:1024
  v_mfma_f32_32x32x16_bf16 v[96:111], a[92:95], v[244:247], v[96:111]
  s_waitcnt vmcnt(15)
  v_mfma_f32_32x32x16_bf16 v[96:111], a[64:67], v[240:243], v[96:111]
  s_nop 0
  ds_write_b128 v197, v[84:87] offset:7168
  v_cvt_pk_bf16_f32 v90, v50, v54
  v_cvt_pk_bf16_f32 v91, v58, v62
  v_cvt_pk_bf16_f32 v94, v51, v55
  v_cvt_pk_bf16_f32 v95, v59, v63
  s_waitcnt vmcnt(14)
  v_mfma_f32_32x32x16_bf16 v[96:111], a[68:71], v[244:247], v[96:111]
  s_nop 0
  ds_write_b128 v197, v[88:91] offset:13312
  v_cvt_pk_bf16_f32 v64, v216, v220
  v_cvt_pk_bf16_f32 v65, v224, v228
  v_cvt_pk_bf16_f32 v68, v217, v221
  v_cvt_pk_bf16_f32 v69, v225, v229
  ds_write_b128 v197, v[92:95] offset:19456
  v_cvt_pk_bf16_f32 v72, v218, v222
  v_cvt_pk_bf16_f32 v73, v226, v230
  v_cvt_pk_bf16_f32 v76, v219, v223
  v_cvt_pk_bf16_f32 v77, v227, v231
  s_nop 1
  s_nop 0
  v_cvt_pk_bf16_f32 v66, v96, v100
  v_cvt_pk_bf16_f32 v67, v104, v108
  v_cvt_pk_bf16_f32 v70, v97, v101
  v_cvt_pk_bf16_f32 v71, v105, v109
  ds_write_b128 v197, v[64:67] offset:2048
  ds_write_b128 v197, v[68:71] offset:8192
  v_cvt_pk_bf16_f32 v74, v98, v102
  v_cvt_pk_bf16_f32 v75, v106, v110
  v_cvt_pk_bf16_f32 v78, v99, v103
  v_cvt_pk_bf16_f32 v79, v107, v111
  ds_write_b128 v197, v[72:75] offset:14336
  ds_write_b128 v197, v[76:79] offset:20480
  s_waitcnt lgkmcnt(0)
  s_barrier
  ds_read_b128 a[0:3], v0 offset:24576
  ds_read_b128 a[4:7], v0 offset:25600
  ds_read_b128 a[8:11], v0 offset:26624
  ds_read_b128 a[12:15], v0 offset:27648
  ds_read_b128 a[16:19], v0 offset:28672
  ds_read_b128 a[20:23], v0 offset:29696
  ds_read_b128 a[24:27], v0 offset:30720
  ds_read_b128 a[28:31], v0 offset:31744
  ds_read_b128 a[32:35], v0 offset:32768
  ds_read_b128 a[36:39], v0 offset:33792
  ds_read_b128 a[40:43], v0 offset:34816
  ds_read_b128 a[44:47], v0 offset:35840
  ds_read_b128 a[48:51], v0 offset:36864
  ds_read_b128 a[52:55], v0 offset:37888
  ds_read_b128 a[56:59], v0 offset:38912
  ds_read_b128 a[60:63], v0 offset:39936
  ds_read_b128 a[64:67], v0 offset:40960
  ds_read_b128 a[68:71], v0 offset:41984
  ds_read_b128 a[72:75], v0 offset:43008
  ds_read_b128 a[76:79], v0 offset:44032
  ds_read_b128 a[80:83], v0 offset:45056
  ds_read_b128 a[84:87], v0 offset:46080
  ds_read_b128 a[88:91], v0 offset:47104
  ds_read_b128 a[92:95], v0 offset:48128
  s_waitcnt vmcnt(6)
  s_nop 0
  ds_read_b128 v[216:219], v4
  ds_read_b128 v[220:223], v4 offset:16
  ds_read_b128 v[224:227], v4 offset:192
  ds_read_b128 v[228:231], v4 offset:208
  ds_read_b128 v[232:235], v4 offset:384
  ds_read_b128 v[236:239], v4 offset:400
  ds_read_b128 v[160:163], v4 offset:32
  ds_read_b128 v[164:167], v4 offset:48
  ds_read_b128 v[168:171], v4 offset:224
  ds_read_b128 v[172:175], v4 offset:240
  ds_read_b128 v[176:179], v4 offset:416
  s_waitcnt lgkmcnt(10)
  v_mfma_f32_16x16x32_bf16 v[112:115], a[96:99], v[216:219], 0
  s_waitcnt lgkmcnt(9)
  ds_read_b128 v[180:183], v4 offset:432
  v_mfma_f32_16x16x32_bf16 v[116:119], a[108:111], v[220:223], 0
  s_waitcnt lgkmcnt(9)
  ds_read_b128 v[216:219], v4 offset:64
  v_mfma_f32_16x16x32_bf16 v[112:115], a[100:103], v[224:227], v[112:115]
  s_waitcnt lgkmcnt(9)
  ds_read_b128 v[220:223], v4 offset:80
  v_mfma_f32_16x16x32_bf16 v[116:119], a[112:115], v[228:231], v[116:119]
  s_waitcnt lgkmcnt(9)
  ds_read_b128 v[224:227], v4 offset:256
  v_mfma_f32_16x16x32_bf16 v[112:115], a[104:107], v[232:235], v[112:115]
  s_waitcnt lgkmcnt(9)
  ds_read_b128 v[228:231], v4 offset:272
  v_mfma_f32_16x16x32_bf16 v[116:119], a[116:119], v[236:239], v[116:119]
  s_waitcnt lgkmcnt(9)
  ds_read_b128 v[232:235], v4 offset:448
  v_mfma_f32_16x16x32_bf16 v[120:123], a[120:123], v[160:163], 0
  s_waitcnt lgkmcnt(9)
  ds_read_b128 v[236:239], v4 offset:464
  v_mfma_f32_16x16x32_bf16 v[124:127], a[132:135], v[164:167], 0
  s_waitcnt lgkmcnt(9)
  ds_read_b128 v[160:163], v4 offset:96
  v_mfma_f32_16x16x32_bf16 v[120:123], a[124:127], v[168:171], v[120:123]
  s_waitcnt lgkmcnt(9)
  ds_read_b128 v[164:167], v4 offset:112
  v_mfma_f32_16x16x32_bf16 v[124:127], a[136:139], v[172:175], v[124:127]
  s_waitcnt lgkmcnt(9)
  ds_read_b128 v[168:171], v4 offset:288
  v_mfma_f32_16x16x32_bf16 v[120:123], a[128:131], v[176:179], v[120:123]
  s_waitcnt lgkmcnt(9)
  ds_read_b128 v[172:175], v4 offset:304
  v_mfma_f32_16x16x32_bf16 v[124:127], a[140:143], v[180:183], v[124:127]
  s_waitcnt lgkmcnt(9)
  ds_read_b128 v[176:179], v4 offset:480
  v_mfma_f32_16x16x32_bf16 v[128:131], a[144:147], v[216:219], 0
  s_waitcnt lgkmcnt(9)
  ds_read_b128 v[180:183], v4 offset:496
  v_mfma_f32_16x16x32_bf16 v[132:135], a[156:159], v[220:223], 0
  s_waitcnt lgkmcnt(9)
  ds_read_b128 v[216:219], v4 offset:128
  v_mfma_f32_16x16x32_bf16 v[128:131], a[148:151], v[224:227], v[128:131]
  s_waitcnt lgkmcnt(9)
  ds_read_b128 v[220:223], v4 offset:144
  v_mfma_f32_16x16x32_bf16 v[132:135], a[160:163], v[228:231], v[132:135]
  s_waitcnt lgkmcnt(9)
  ds_read_b128 v[224:227], v4 offset:320
  v_mfma_f32_16x16x32_bf16 v[128:131], a[152:155], v[232:235], v[128:131]
  s_waitcnt lgkmcnt(9)
  ds_read_b128 v[228:231], v4 offset:336
  v_mfma_f32_16x16x32_bf16 v[132:135], a[164:167], v[236:239], v[132:135]
  s_waitcnt lgkmcnt(9)
  ds_read_b128 v[232:235], v4 offset:512
  v_mfma_f32_16x16x32_bf16 v[136:139], a[240:243], v[160:163], 0
  s_waitcnt lgkmcnt(9)
  ds_read_b128 v[236:239], v4 offset:528
  v_mfma_f32_16x16x32_bf16 v[140:143], a[168:171], v[164:167], 0
  s_waitcnt lgkmcnt(9)
  ds_read_b128 v[160:163], v4 offset:160
  v_mfma_f32_16x16x32_bf16 v[136:139], a[244:247], v[168:171], v[136:139]
  s_waitcnt lgkmcnt(9)
  ds_read_b128 v[164:167], v4 offset:176
  v_mfma_f32_16x16x32_bf16 v[140:143], a[172:175], v[172:175], v[140:143]
  s_waitcnt lgkmcnt(9)
  ds_read_b128 v[168:171], v4 offset:352
  v_mfma_f32_16x16x32_bf16 v[136:139], a[248:251], v[176:179], v[136:139]
  s_waitcnt lgkmcnt(9)
  ds_read_b128 v[172:175], v4 offset:368
  v_mfma_f32_16x16x32_bf16 v[140:143], a[176:179], v[180:183], v[140:143]
  s_waitcnt lgkmcnt(9)
  ds_read_b128 v[176:179], v4 offset:544
  v_mfma_f32_16x16x32_bf16 v[144:147], a[252:255], v[216:219], 0
  s_waitcnt lgkmcnt(9)
  ds_read_b128 v[180:183], v4 offset:560
  v_mfma_f32_16x16x32_bf16 v[148:151], a[188:191], v[220:223], 0
  s_waitcnt lgkmcnt(9)
  v_mfma_f32_16x16x32_bf16 v[144:147], a[180:183], v[224:227], v[144:147]
  s_waitcnt lgkmcnt(8)
  v_mfma_f32_16x16x32_bf16 v[148:151], a[216:219], v[228:231], v[148:151]
  s_waitcnt lgkmcnt(7)
  v_mfma_f32_16x16x32_bf16 v[144:147], a[184:187], v[232:235], v[144:147]
  s_waitcnt lgkmcnt(6)
  v_mfma_f32_16x16x32_bf16 v[148:151], a[220:223], v[236:239], v[148:151]
  s_waitcnt lgkmcnt(5)
  v_mfma_f32_16x16x32_bf16 v[152:155], a[224:227], v[160:163], 0
  s_waitcnt lgkmcnt(4)
  v_mfma_f32_16x16x32_bf16 v[156:159], a[236:239], v[164:167], 0
  s_waitcnt lgkmcnt(3)
  v_mfma_f32_16x16x32_bf16 v[152:155], a[228:231], v[168:171], v[152:155]
  s_waitcnt lgkmcnt(2)
  v_mfma_f32_16x16x32_bf16 v[156:159], v[208:211], v[172:175], v[156:159]
  s_waitcnt lgkmcnt(1)
  v_mfma_f32_16x16x32_bf16 v[152:155], a[232:235], v[176:179], v[152:155]
  s_waitcnt lgkmcnt(0)
  v_mfma_f32_16x16x32_bf16 v[156:159], v[212:215], v[180:183], v[156:159]
  buffer_load_dword v249, v248, s[4:7], s29 offen
  v_pk_add_f32 v[12:13], v[112:113], v[114:115]
  v_pk_mul_f32 v[14:15], v[112:113], v[112:113]
  v_pk_fma_f32 v[14:15], v[114:115], v[114:115], v[14:15]
  v_pk_add_f32 v[12:13], v[12:13], v[116:117]
  v_pk_fma_f32 v[14:15], v[116:117], v[116:117], v[14:15]
  v_pk_add_f32 v[12:13], v[12:13], v[118:119]
  v_pk_fma_f32 v[14:15], v[118:119], v[118:119], v[14:15]
  v_pk_add_f32 v[12:13], v[12:13], v[120:121]
  v_pk_fma_f32 v[14:15], v[120:121], v[120:121], v[14:15]
  v_pk_add_f32 v[12:13], v[12:13], v[122:123]
  v_pk_fma_f32 v[14:15], v[122:123], v[122:123], v[14:15]
  v_pk_add_f32 v[12:13], v[12:13], v[124:125]
  ds_read_b128 v[216:219], v0 offset:18432
  ds_read_b128 v[220:223], v0 offset:19456
  ds_read_b128 v[224:227], v0 offset:20480
  ds_read_b128 v[228:231], v0 offset:21504
  v_pk_fma_f32 v[14:15], v[124:125], v[124:125], v[14:15]
  v_pk_add_f32 v[12:13], v[12:13], v[126:127]
  v_pk_fma_f32 v[14:15], v[126:127], v[126:127], v[14:15]
  v_pk_add_f32 v[12:13], v[12:13], v[128:129]
  v_pk_fma_f32 v[14:15], v[128:129], v[128:129], v[14:15]
  v_pk_add_f32 v[12:13], v[12:13], v[130:131]
  v_pk_fma_f32 v[14:15], v[130:131], v[130:131], v[14:15]
  v_pk_add_f32 v[12:13], v[12:13], v[132:133]
  v_pk_fma_f32 v[14:15], v[132:133], v[132:133], v[14:15]
  v_pk_add_f32 v[12:13], v[12:13], v[134:135]
  v_pk_fma_f32 v[14:15], v[134:135], v[134:135], v[14:15]
  v_pk_add_f32 v[12:13], v[12:13], v[136:137]
  ds_read_b128 v[232:235], v0 offset:22528
  ds_read_b128 v[236:239], v0 offset:23552
  ds_read_b128 a[96:99], v0 offset:49152
  ds_read_b128 a[100:103], v0 offset:50176
  v_pk_fma_f32 v[14:15], v[136:137], v[136:137], v[14:15]
  v_pk_add_f32 v[12:13], v[12:13], v[138:139]
  v_pk_fma_f32 v[14:15], v[138:139], v[138:139], v[14:15]
  v_pk_add_f32 v[12:13], v[12:13], v[140:141]
  v_pk_fma_f32 v[14:15], v[140:141], v[140:141], v[14:15]
  v_pk_add_f32 v[12:13], v[12:13], v[142:143]
  v_pk_fma_f32 v[14:15], v[142:143], v[142:143], v[14:15]
  v_pk_add_f32 v[12:13], v[12:13], v[144:145]
  v_pk_fma_f32 v[14:15], v[144:145], v[144:145], v[14:15]
  v_pk_add_f32 v[12:13], v[12:13], v[146:147]
  v_pk_fma_f32 v[14:15], v[146:147], v[146:147], v[14:15]
  v_pk_add_f32 v[12:13], v[12:13], v[148:149]
  ds_read_b128 a[104:107], v0 offset:51200
  ds_read_b128 a[108:111], v0 offset:52224
  ds_read_b128 a[112:115], v0 offset:53248
  ds_read_b128 a[116:119], v0 offset:54272
  v_pk_fma_f32 v[14:15], v[148:149], v[148:149], v[14:15]
  v_pk_add_f32 v[12:13], v[12:13], v[150:151]
  v_pk_fma_f32 v[14:15], v[150:151], v[150:151], v[14:15]
  v_pk_add_f32 v[12:13], v[12:13], v[152:153]
  v_pk_fma_f32 v[14:15], v[152:153], v[152:153], v[14:15]
  v_pk_add_f32 v[12:13], v[12:13], v[154:155]
  v_pk_fma_f32 v[14:15], v[154:155], v[154:155], v[14:15]
  v_pk_add_f32 v[12:13], v[12:13], v[156:157]
  v_pk_fma_f32 v[14:15], v[156:157], v[156:157], v[14:15]
  v_pk_add_f32 v[12:13], v[12:13], v[158:159]
  v_pk_fma_f32 v[14:15], v[158:159], v[158:159], v[14:15]
  v_add_f32_e64 v12, v12, v13
  ds_read_b128 a[120:123], v0 offset:55296
  ds_read_b128 a[124:127], v0 offset:56320
  ds_read_b128 a[128:131], v0 offset:57344
  ds_read_b128 a[132:135], v0 offset:58368
  v_add_f32 v14, v14, v15
  s_nop 1
  v_permlane32_swap_b32 v12, v14
  v_add_f32 v12, v12, v14
  v_mov_b32 v14, v12
  s_nop 1
  v_permlane32_swap_b32 v12, v14
  v_mul_f32 v12, s24, v12
  v_mul_f32 v13, s24, v14
  v_fma_f32 v13, -v12, v12, v13
  v_max_f32 v13, 0, v13
  v_add_f32 v13, s25, v13
  v_rsq_f32 v13, v13
  s_nop 0
  v_mul_f32 v14, s22, v13
  ds_read_b128 a[136:139], v0 offset:59392
  ds_read_b128 a[140:143], v0 offset:60416
  ds_read_b128 a[144:147], v0 offset:61440
  ds_read_b128 a[148:151], v0 offset:62464
  v_mul_f32_e64 v12, -v12, v14
  v_pk_fma_f32 v[112:113], v[112:113], v[14:15], v[12:13] op_sel_hi:[1,0,0]
  v_pk_fma_f32 v[114:115], v[114:115], v[14:15], v[12:13] op_sel_hi:[1,0,0]
  v_pk_fma_f32 v[116:117], v[116:117], v[14:15], v[12:13] op_sel_hi:[1,0,0]
  v_pk_fma_f32 v[118:119], v[118:119], v[14:15], v[12:13] op_sel_hi:[1,0,0]
  v_pk_fma_f32 v[120:121], v[120:121], v[14:15], v[12:13] op_sel_hi:[1,0,0]
  v_pk_fma_f32 v[122:123], v[122:123], v[14:15], v[12:13] op_sel_hi:[1,0,0]
  v_pk_fma_f32 v[124:125], v[124:125], v[14:15], v[12:13] op_sel_hi:[1,0,0]
  v_pk_fma_f32 v[126:127], v[126:127], v[14:15], v[12:13] op_sel_hi:[1,0,0]
  v_pk_fma_f32 v[128:129], v[128:129], v[14:15], v[12:13] op_sel_hi:[1,0,0]
  v_pk_fma_f32 v[130:131], v[130:131], v[14:15], v[12:13] op_sel_hi:[1,0,0]
  v_pk_fma_f32 v[132:133], v[132:133], v[14:15], v[12:13] op_sel_hi:[1,0,0]
  ds_read_b128 a[152:155], v0 offset:63488
  ds_read_b128 a[156:159], v0 offset:64512
  ds_read_b128 a[160:163], v1
  ds_read_b128 a[164:167], v1 offset:1024
  v_pk_fma_f32 v[134:135], v[134:135], v[14:15], v[12:13] op_sel_hi:[1,0,0]
  v_pk_fma_f32 v[136:137], v[136:137], v[14:15], v[12:13] op_sel_hi:[1,0,0]
  v_pk_fma_f32 v[138:139], v[138:139], v[14:15], v[12:13] op_sel_hi:[1,0,0]
  v_pk_fma_f32 v[140:141], v[140:141], v[14:15], v[12:13] op_sel_hi:[1,0,0]
  v_pk_fma_f32 v[142:143], v[142:143], v[14:15], v[12:13] op_sel_hi:[1,0,0]
  v_pk_fma_f32 v[144:145], v[144:145], v[14:15], v[12:13] op_sel_hi:[1,0,0]
  v_pk_fma_f32 v[146:147], v[146:147], v[14:15], v[12:13] op_sel_hi:[1,0,0]
  v_pk_fma_f32 v[148:149], v[148:149], v[14:15], v[12:13] op_sel_hi:[1,0,0]
  v_pk_fma_f32 v[150:151], v[150:151], v[14:15], v[12:13] op_sel_hi:[1,0,0]
  v_pk_fma_f32 v[152:153], v[152:153], v[14:15], v[12:13] op_sel_hi:[1,0,0]
  v_pk_fma_f32 v[154:155], v[154:155], v[14:15], v[12:13] op_sel_hi:[1,0,0]
  v_pk_fma_f32 v[156:157], v[156:157], v[14:15], v[12:13] op_sel_hi:[1,0,0]
  ds_read_b128 a[168:171], v1 offset:2048
  ds_read_b128 a[172:175], v1 offset:3072
  ds_read_b128 a[176:179], v1 offset:4096
  ds_read_b128 a[180:183], v1 offset:5120
  v_pk_fma_f32 v[158:159], v[158:159], v[14:15], v[12:13] op_sel_hi:[1,0,0]
  v_cndmask_b32 v159, v159, v250, s[12:13]
  v_cvt_pk_bf16_f32 v160, v112, v113
  v_cvt_pk_bf16_f32 v161, v114, v115
  v_cvt_pk_bf16_f32 v162, v116, v117
  v_cvt_pk_bf16_f32 v163, v118, v119
  v_cvt_pk_bf16_f32 v164, v120, v121
  v_cvt_pk_bf16_f32 v165, v122, v123
  v_cvt_pk_bf16_f32 v166, v124, v125
  v_cvt_pk_bf16_f32 v167, v126, v127
  v_cvt_pk_bf16_f32 v168, v128, v129
  v_cvt_pk_bf16_f32 v169, v130, v131
  ds_read_b128 a[184:187], v1 offset:6144
  ds_read_b128 a[188:191], v1 offset:7168
  v_cvt_pk_bf16_f32 v170, v132, v133
  v_cvt_pk_bf16_f32 v171, v134, v135
  v_cvt_pk_bf16_f32 v172, v136, v137
  v_cvt_pk_bf16_f32 v173, v138, v139
  v_cvt_pk_bf16_f32 v174, v140, v141
  v_cvt_pk_bf16_f32 v175, v142, v143
  v_cvt_pk_bf16_f32 v176, v144, v145
  v_cvt_pk_bf16_f32 v177, v146, v147
  v_cvt_pk_bf16_f32 v178, v148, v149
  v_cvt_pk_bf16_f32 v179, v150, v151
  v_cvt_pk_bf16_f32 v180, v152, v153
  v_cvt_pk_bf16_f32 v181, v154, v155
  v_cvt_pk_bf16_f32 v182, v156, v157
  v_cvt_pk_bf16_f32 v183, v158, v159
  s_waitcnt lgkmcnt(15)
  v_mfma_f32_32x32x16_bf16 v[16:31], v[216:219], v[160:163], 0
  s_nop 0
  ds_read_b128 v[136:139], v5
  ds_read_b128 v[140:143], v5 offset:32
  ds_read_b128 v[144:147], v5 offset:64
  v_mfma_f32_32x32x16_bf16 v[16:31], v[220:223], v[164:167], v[16:31]
  ds_read_b128 v[148:151], v5 offset:96
  ds_read_b128 v[152:155], v5 offset:128
  ds_read_b128 v[156:159], v5 offset:160
  v_mfma_f32_32x32x16_bf16 v[16:31], v[224:227], v[168:171], v[16:31]
  s_waitcnt vmcnt(1)
  ds_read_b128 a[216:219], v251 offset:49152
  ds_read_b128 a[220:223], v252 offset:49152
  v_mfma_f32_32x32x16_bf16 v[16:31], v[228:231], v[172:175], v[16:31]
  s_nop 0
  ds_read_b128 a[224:227], v251 offset:49216
  ds_read_b128 a[228:231], v252 offset:49216
  ds_read_b128 a[232:235], v251 offset:49280
  v_mfma_f32_32x32x16_bf16 v[16:31], v[232:235], v[176:179], v[16:31]
  s_nop 0
  ds_read_b128 a[236:239], v252 offset:49280
  v_mfma_f32_32x32x16_bf16 v[16:31], v[236:239], v[180:183], v[16:31]
  s_nop 11
  v_pk_fma_f32 v[48:49], v[16:17], v[16:17], s[20:21] neg_lo:[1,0,1] neg_hi:[1,0,1]
  v_pk_fma_f32 v[50:51], v[18:19], v[18:19], s[20:21] neg_lo:[1,0,1] neg_hi:[1,0,1]
  v_pk_fma_f32 v[52:53], v[20:21], v[20:21], s[20:21] neg_lo:[1,0,1] neg_hi:[1,0,1]
  v_pk_fma_f32 v[54:55], v[22:23], v[22:23], s[20:21] neg_lo:[1,0,1] neg_hi:[1,0,1]
  v_pk_fma_f32 v[56:57], v[24:25], v[24:25], s[20:21] neg_lo:[1,0,1] neg_hi:[1,0,1]
  v_pk_fma_f32 v[58:59], v[26:27], v[26:27], s[20:21] neg_lo:[1,0,1] neg_hi:[1,0,1]
  v_pk_fma_f32 v[60:61], v[28:29], v[28:29], s[20:21] neg_lo:[1,0,1] neg_hi:[1,0,1]
  v_pk_fma_f32 v[62:63], v[30:31], v[30:31], s[20:21] neg_lo:[1,0,1] neg_hi:[1,0,1]
  v_pk_mul_f32 v[48:49], v[16:17], v[48:49]
  v_pk_mul_f32 v[50:51], v[18:19], v[50:51]
  v_pk_mul_f32 v[52:53], v[20:21], v[52:53]
  v_pk_mul_f32 v[54:55], v[22:23], v[54:55]
  v_pk_mul_f32 v[56:57], v[24:25], v[56:57]
  v_pk_mul_f32 v[58:59], v[26:27], v[58:59]
  v_pk_mul_f32 v[60:61], v[28:29], v[60:61]
  v_pk_mul_f32 v[62:63], v[30:31], v[62:63]
  s_waitcnt lgkmcnt(5)
  v_mfma_f32_32x32x16_bf16 v[64:79], a[216:219], a[192:195], 0
  s_mov_b32 m0, s30
  v_exp_f32 v48, v48
  v_exp_f32 v49, v49
  v_exp_f32 v50, v50
  v_exp_f32 v51, v51
  v_exp_f32 v52, v52
  s_waitcnt lgkmcnt(4)
  v_mfma_f32_32x32x16_bf16 v[64:79], a[220:223], a[196:199], v[64:79]
  buffer_load_dwordx4 v6, s[4:7], s29 offen lds
  v_exp_f32 v53, v53
  s_waitcnt lgkmcnt(3)
  v_mfma_f32_32x32x16_bf16 v[80:95], a[224:227], a[200:203], 0
  buffer_load_dwordx4 v7, s[4:7], s29 offen offset:1024 lds
  s_waitcnt lgkmcnt(2)
  v_mfma_f32_32x32x16_bf16 v[80:95], a[228:231], a[204:207], v[80:95]
  buffer_load_dwordx4 v8, s[4:7], s29 offen offset:2048 lds
  s_nop 3
  v_cvt_pk_bf16_f32 v64, v64, v65
  v_cvt_pk_bf16_f32 v65, v66, v67
  v_cvt_pk_bf16_f32 v66, v68, v69
  v_cvt_pk_bf16_f32 v67, v70, v71
  ds_write_b128 v253, v[64:67] offset:49152
  v_exp_f32 v54, v54
  v_exp_f32 v55, v55
  v_cvt_pk_bf16_f32 v68, v72, v73
  v_cvt_pk_bf16_f32 v69, v74, v75
  v_cvt_pk_bf16_f32 v70, v76, v77
  s_waitcnt lgkmcnt(2)
  v_mfma_f32_32x32x16_bf16 v[96:111], a[232:235], a[208:211], 0
  s_nop 0
  buffer_load_dwordx4 v9, s[4:7], s29 offen offset:3072 lds
  v_cvt_pk_bf16_f32 v71, v78, v79
  v_exp_f32_e64 v56, v56
  v_exp_f32 v57, v57
  ds_write_b128 v253, v[68:71] offset:52224
  s_waitcnt lgkmcnt(2)
  v_mfma_f32_32x32x16_bf16 v[96:111], a[236:239], a[212:215], v[96:111]
  v_cvt_pk_bf16_f32 v80, v80, v81
  v_cvt_pk_bf16_f32 v81, v82, v83
  v_cvt_pk_bf16_f32 v82, v84, v85
  v_cvt_pk_bf16_f32 v83, v86, v87
  v_exp_f32 v58, v58
  v_exp_f32 v59, v59
  ds_write_b128 v253, v[80:83] offset:50176
  v_cvt_pk_bf16_f32 v84, v88, v89
  v_cvt_pk_bf16_f32 v85, v90, v91
  v_cvt_pk_bf16_f32 v86, v92, v93
  v_cvt_pk_bf16_f32 v87, v94, v95
  v_exp_f32 v60, v60
  v_exp_f32 v61, v61
  ds_write_b128 v253, v[84:87] offset:53248
  v_cvt_pk_bf16_f32 v96, v96, v97
  v_cvt_pk_bf16_f32 v97, v98, v99
  v_cvt_pk_bf16_f32 v98, v100, v101
  v_cvt_pk_bf16_f32 v99, v102, v103
  v_exp_f32 v62, v62
  v_exp_f32 v63, v63
  v_cvt_pk_bf16_f32 v100, v104, v105
  v_cvt_pk_bf16_f32 v101, v106, v107
  v_cvt_pk_bf16_f32 v102, v108, v109
  v_cvt_pk_bf16_f32 v103, v110, v111
  ds_write_b128 v253, v[96:99] offset:51200
  v_pk_fma_f32 v[48:49], v[48:49], s[22:23], s[22:23]
  v_pk_fma_f32 v[50:51], v[50:51], s[22:23], s[22:23]
  v_pk_fma_f32 v[52:53], v[52:53], s[22:23], s[22:23]
  v_pk_fma_f32 v[54:55], v[54:55], s[22:23], s[22:23]
  v_pk_fma_f32 v[56:57], v[56:57], s[22:23], s[22:23]
  v_pk_fma_f32 v[58:59], v[58:59], s[22:23], s[22:23]
  v_pk_fma_f32 v[60:61], v[60:61], s[22:23], s[22:23]
  v_pk_fma_f32 v[62:63], v[62:63], s[22:23], s[22:23]
  ds_write_b128 v253, v[100:103] offset:54272
  s_waitcnt lgkmcnt(0)
  s_barrier
  v_mfma_f32_32x32x16_bf16 v[32:47], a[0:3], v[160:163], 0
  ds_read_b128 v[64:67], v2
  ds_read_b128 v[68:71], v2 offset:32
  ds_read_b128 v[72:75], v2 offset:64
  s_add_u32 m0, s14, 0x16000
  v_rcp_f32_e64 v48, v48
  v_mfma_f32_32x32x16_bf16 v[32:47], a[4:7], v[164:167], v[32:47]
  ds_read_b128 v[76:79], v2 offset:96
  ds_read_b128 v[80:83], v2 offset:128
  ds_read_b128 v[84:87], v2 offset:160
  buffer_load_dwordx4 v254, s[72:75], s53 offen lds
  v_rcp_f32_e64 v49, v49
  v_mfma_f32_32x32x16_bf16 v[32:47], a[8:11], v[168:171], v[32:47]
  ds_read_b128 v[88:91], v2 offset:192
  ds_read_b128 v[92:95], v2 offset:224
  ds_read_b128 v[96:99], v2 offset:256
  buffer_load_dwordx4 v255, s[72:75], s53 offen offset:1024 lds
  v_rcp_f32_e64 v50, v50
  v_mfma_f32_32x32x16_bf16 v[32:47], a[12:15], v[172:175], v[32:47]
  ds_read_b128 v[100:103], v2 offset:288
  ds_read_b128 v[104:107], v2 offset:320
  ds_read_b128 v[108:111], v2 offset:352
  v_rcp_f32_e64 v51, v51
  v_mfma_f32_32x32x16_bf16 v[32:47], a[16:19], v[176:179], v[32:47]
  buffer_load_dwordx4 v194, s[72:75], s53 offen offset:2048 lds
  s_add_u32 m0, s14, 0x16c00
  v_rcp_f32 v52, v52
  v_rcp_f32 v53, v53
  v_mfma_f32_32x32x16_bf16 v[32:47], a[20:23], v[180:183], v[32:47]
  s_waitcnt lgkmcnt(0)
  buffer_load_dwordx4 v254, s[72:75], s54 offen lds
  v_rcp_f32 v54, v54
  v_rcp_f32_e64 v55, v55
  v_mfma_f32_32x32x16_bf16 v[64:79], v[240:243], v[136:139], v[64:79]
  v_mov_b32 v112, v194
  v_rcp_f32 v56, v56
  v_rcp_f32_e64 v57, v57
  v_mfma_f32_32x32x16_bf16 v[64:79], v[244:247], v[140:143], v[64:79]
  buffer_load_dwordx4 v255, s[72:75], s54 offen offset:1024 lds
  v_rcp_f32 v58, v58
  v_rcp_f32 v59, v59
  v_mfma_f32_32x32x16_bf16 v[80:95], v[240:243], v[144:147], v[80:95]
  buffer_load_dwordx4 v194, s[72:75], s54 offen offset:2048 lds
  v_rcp_f32_e64 v60, v60
  v_rcp_f32_e64 v61, v61
  v_mfma_f32_32x32x16_bf16 v[80:95], v[244:247], v[148:151], v[80:95]
  ds_read_b128 v[192:195], v1 offset:8192
  ds_read_b128 v[196:199], v1 offset:9216
  v_rcp_f32_e64 v62, v62
  v_rcp_f32_e64 v63, v63
  v_mfma_f32_32x32x16_bf16 v[96:111], v[240:243], v[152:155], v[96:111]
  s_nop 0
  ds_read_b128 v[200:203], v1 offset:10240
  ds_read_b128 v[204:207], v1 offset:11264
  v_mfma_f32_32x32x16_bf16 v[96:111], v[244:247], v[156:159], v[96:111]
  s_waitcnt lgkmcnt(0)
  ds_read_b128 v[208:211], v1 offset:12288
  ds_read_b128 v[212:215], v1 offset:13312
  v_pk_mul_f32 v[16:17], v[16:17], v[48:49]
  v_pk_mul_f32 v[18:19], v[18:19], v[50:51]
  v_pk_mul_f32 v[20:21], v[20:21], v[52:53]
  v_pk_mul_f32 v[22:23], v[22:23], v[54:55]
  v_pk_mul_f32 v[24:25], v[24:25], v[56:57]
  v_pk_mul_f32 v[26:27], v[26:27], v[58:59]
  v_pk_mul_f32 v[28:29], v[28:29], v[60:61]
  v_pk_mul_f32 v[30:31], v[30:31], v[62:63]
  v_pk_fma_f32 v[48:49], v[32:33], v[32:33], s[20:21] neg_lo:[1,0,1] neg_hi:[1,0,1]
  v_pk_fma_f32 v[50:51], v[34:35], v[34:35], s[20:21] neg_lo:[1,0,1] neg_hi:[1,0,1]
  v_pk_fma_f32 v[52:53], v[36:37], v[36:37], s[20:21] neg_lo:[1,0,1] neg_hi:[1,0,1]
  v_pk_fma_f32 v[54:55], v[38:39], v[38:39], s[20:21] neg_lo:[1,0,1] neg_hi:[1,0,1]
  v_pk_fma_f32 v[56:57], v[40:41], v[40:41], s[20:21] neg_lo:[1,0,1] neg_hi:[1,0,1]
  v_pk_fma_f32 v[58:59], v[42:43], v[42:43], s[20:21] neg_lo:[1,0,1] neg_hi:[1,0,1]
  v_pk_fma_f32 v[60:61], v[44:45], v[44:45], s[20:21] neg_lo:[1,0,1] neg_hi:[1,0,1]
  v_pk_fma_f32 v[62:63], v[46:47], v[46:47], s[20:21] neg_lo:[1,0,1] neg_hi:[1,0,1]
  v_pk_mul_f32 v[48:49], v[32:33], v[48:49]
  v_pk_mul_f32 v[50:51], v[34:35], v[50:51]
  v_pk_mul_f32 v[52:53], v[36:37], v[52:53]
  v_pk_mul_f32 v[54:55], v[38:39], v[54:55]
  v_pk_mul_f32 v[56:57], v[40:41], v[56:57]
  v_cvt_pk_bf16_f32 v184, v16, v17
  v_cvt_pk_bf16_f32 v185, v18, v19
  v_cvt_pk_bf16_f32 v186, v20, v21
  v_cvt_pk_bf16_f32 v187, v22, v23
  v_pk_mul_f32 v[58:59], v[42:43], v[58:59]
  v_pk_mul_f32 v[60:61], v[44:45], v[60:61]
  v_pk_mul_f32 v[62:63], v[46:47], v[62:63]
  v_mfma_f32_32x32x16_bf16 v[64:79], v[192:195], v[184:187], v[64:79]
  s_mov_b32 m0, s31
  v_cvt_pk_bf16_f32 v188, v24, v25
  v_cvt_pk_bf16_f32 v189, v26, v27
  v_cvt_pk_bf16_f32 v190, v28, v29
  v_cvt_pk_bf16_f32 v191, v30, v31
  v_exp_f32 v48, v48
  v_mfma_f32_32x32x16_bf16 v[80:95], v[196:199], v[184:187], v[80:95]
  buffer_load_dwordx4 v6, s[4:7], s52 offen lds
  v_exp_f32 v49, v49
  v_exp_f32 v50, v50
  v_exp_f32_e64 v51, v51
  v_mfma_f32_32x32x16_bf16 v[96:111], v[200:203], v[184:187], v[96:111]
  buffer_load_dwordx4 v7, s[4:7], s52 offen offset:1024 lds
  v_exp_f32 v52, v52
  v_exp_f32 v53, v53
  v_mfma_f32_32x32x16_bf16 v[64:79], v[204:207], v[188:191], v[64:79]
  buffer_load_dwordx4 v8, s[4:7], s52 offen offset:2048 lds
  v_exp_f32 v54, v54
  v_exp_f32 v55, v55
  v_exp_f32 v56, v56
  s_waitcnt lgkmcnt(1)
  v_mfma_f32_32x32x16_bf16 v[80:95], v[208:211], v[188:191], v[80:95]
  buffer_load_dwordx4 v9, s[4:7], s52 offen offset:3072 lds
  v_exp_f32 v57, v57
  v_exp_f32 v58, v58
  s_waitcnt lgkmcnt(0)
  v_mfma_f32_32x32x16_bf16 v[96:111], v[212:215], v[188:191], v[96:111]
  v_exp_f32 v59, v59
  v_exp_f32 v60, v60
  v_exp_f32 v61, v61
  v_exp_f32 v62, v62
  v_exp_f32 v63, v63
  v_pk_fma_f32 v[48:49], v[48:49], s[22:23], s[22:23]
  v_pk_fma_f32 v[50:51], v[50:51], s[22:23], s[22:23]
  v_pk_fma_f32 v[52:53], v[52:53], s[22:23], s[22:23]
  v_pk_fma_f32 v[54:55], v[54:55], s[22:23], s[22:23]
  v_pk_fma_f32 v[56:57], v[56:57], s[22:23], s[22:23]
  v_pk_fma_f32 v[58:59], v[58:59], s[22:23], s[22:23]
  v_pk_fma_f32 v[60:61], v[60:61], s[22:23], s[22:23]
  v_pk_fma_f32 v[62:63], v[62:63], s[22:23], s[22:23]
  v_mfma_f32_32x32x16_bf16 v[16:31], a[24:27], v[160:163], 0
  ds_read_b128 v[192:195], v1 offset:14336
  ds_read_b128 v[196:199], v1 offset:15360
  s_add_u32 m0, s14, 0x1c000
  v_rcp_f32 v48, v48
  v_rcp_f32 v49, v49
  v_mfma_f32_32x32x16_bf16 v[16:31], a[28:31], v[164:167], v[16:31]
  ds_read_b128 v[200:203], v1 offset:16384
  ds_read_b128 v[204:207], v1 offset:17408
  buffer_load_dwordx4 v254, s[72:75], s55 offen lds
  v_rcp_f32 v50, v50
  v_rcp_f32 v51, v51
  v_mfma_f32_32x32x16_bf16 v[16:31], a[32:35], v[168:171], v[16:31]
  ds_read_b128 v[208:211], v1 offset:18432
  ds_read_b128 v[212:215], v1 offset:19456
  v_rcp_f32 v52, v52
  v_rcp_f32 v53, v53
  v_mfma_f32_32x32x16_bf16 v[16:31], a[36:39], v[172:175], v[16:31]
  buffer_load_dwordx4 v255, s[72:75], s55 offen offset:1024 lds
  v_rcp_f32 v54, v54
  v_rcp_f32 v55, v55
  v_rcp_f32_e64 v56, v56
  v_mfma_f32_32x32x16_bf16 v[16:31], a[40:43], v[176:179], v[16:31]
  v_rcp_f32 v57, v57
  v_rcp_f32 v58, v58
  v_rcp_f32 v59, v59
  v_mfma_f32_32x32x16_bf16 v[16:31], a[44:47], v[180:183], v[16:31]
  s_waitcnt lgkmcnt(0)
  buffer_load_dwordx4 v112, s[72:75], s55 offen offset:2048 lds
  v_rcp_f32 v60, v60
  v_rcp_f32 v61, v61
  v_rcp_f32 v62, v62
  v_rcp_f32 v63, v63
  v_pk_mul_f32 v[32:33], v[32:33], v[48:49]
  v_pk_mul_f32 v[34:35], v[34:35], v[50:51]
  v_pk_mul_f32 v[36:37], v[36:37], v[52:53]
  v_pk_mul_f32 v[38:39], v[38:39], v[54:55]
  v_pk_mul_f32 v[40:41], v[40:41], v[56:57]
  v_pk_mul_f32 v[42:43], v[42:43], v[58:59]
  v_pk_mul_f32 v[44:45], v[44:45], v[60:61]
  v_pk_mul_f32 v[46:47], v[46:47], v[62:63]
  v_pk_fma_f32 v[48:49], v[16:17], v[16:17], s[20:21] neg_lo:[1,0,1] neg_hi:[1,0,1]
  v_pk_fma_f32 v[50:51], v[18:19], v[18:19], s[20:21] neg_lo:[1,0,1] neg_hi:[1,0,1]
  v_pk_fma_f32 v[52:53], v[20:21], v[20:21], s[20:21] neg_lo:[1,0,1] neg_hi:[1,0,1]
  v_pk_fma_f32 v[54:55], v[22:23], v[22:23], s[20:21] neg_lo:[1,0,1] neg_hi:[1,0,1]
  v_pk_fma_f32 v[56:57], v[24:25], v[24:25], s[20:21] neg_lo:[1,0,1] neg_hi:[1,0,1]
  v_pk_fma_f32 v[58:59], v[26:27], v[26:27], s[20:21] neg_lo:[1,0,1] neg_hi:[1,0,1]
  v_pk_fma_f32 v[60:61], v[28:29], v[28:29], s[20:21] neg_lo:[1,0,1] neg_hi:[1,0,1]
  v_pk_fma_f32 v[62:63], v[30:31], v[30:31], s[20:21] neg_lo:[1,0,1] neg_hi:[1,0,1]
  v_pk_mul_f32 v[48:49], v[16:17], v[48:49]
  v_pk_mul_f32 v[50:51], v[18:19], v[50:51]
  v_pk_mul_f32 v[52:53], v[20:21], v[52:53]
  v_pk_mul_f32 v[54:55], v[22:23], v[54:55]
  v_pk_mul_f32 v[56:57], v[24:25], v[56:57]
  v_cvt_pk_bf16_f32 v184, v32, v33
  v_cvt_pk_bf16_f32 v185, v34, v35
  v_cvt_pk_bf16_f32 v186, v36, v37
  v_cvt_pk_bf16_f32 v187, v38, v39
  v_pk_mul_f32 v[58:59], v[26:27], v[58:59]
  v_pk_mul_f32 v[60:61], v[28:29], v[60:61]
  v_pk_mul_f32 v[62:63], v[30:31], v[62:63]
  v_mfma_f32_32x32x16_bf16 v[64:79], v[192:195], v[184:187], v[64:79]
  s_add_u32 m0, s14, 0x1cc00
  v_cvt_pk_bf16_f32 v188, v40, v41
  v_cvt_pk_bf16_f32 v189, v42, v43
  v_cvt_pk_bf16_f32 v190, v44, v45
  v_cvt_pk_bf16_f32 v191, v46, v47
  v_exp_f32_e64 v48, v48
  v_mfma_f32_32x32x16_bf16 v[80:95], v[196:199], v[184:187], v[80:95]
  buffer_load_dwordx4 v254, s[72:75], s56 offen lds
  v_exp_f32 v49, v49
  v_exp_f32 v50, v50
  v_exp_f32 v51, v51
  v_mfma_f32_32x32x16_bf16 v[96:111], v[200:203], v[184:187], v[96:111]
  s_waitcnt vmcnt(8)
  ds_read_b128 a[216:219], v251
  ds_read_b128 a[220:223], v252
  ds_read_b128 a[224:227], v251 offset:64
  v_exp_f32 v52, v52
  v_exp_f32 v53, v53
  v_mfma_f32_32x32x16_bf16 v[64:79], v[204:207], v[188:191], v[64:79]
  ds_read_b128 a[228:231], v252 offset:64
  ds_read_b128 a[232:235], v251 offset:128
  ds_read_b128 a[236:239], v252 offset:128
  buffer_load_dwordx4 v255, s[72:75], s56 offen offset:1024 lds
  v_subrev_u32 v11, 0x4100, v5
  v_exp_f32_e64 v54, v54
  v_mfma_f32_32x32x16_bf16 v[80:95], v[208:211], v[188:191], v[80:95]
  v_exp_f32 v55, v55
  v_exp_f32 v56, v56
  v_exp_f32_e64 v57, v57
  v_exp_f32 v58, v58
  v_mfma_f32_32x32x16_bf16 v[96:111], v[212:215], v[188:191], v[96:111]
  s_waitcnt lgkmcnt(0)
  buffer_load_dwordx4 v112, s[72:75], s56 offen offset:2048 lds
  v_add_u32 v5, 0x8200, v5
  v_exp_f32 v59, v59
  v_exp_f32 v60, v60
  v_exp_f32 v61, v61
  v_exp_f32 v62, v62
  v_exp_f32 v63, v63
  v_min_u32 v5, v11, v5
  v_pk_fma_f32 v[48:49], v[48:49], s[22:23], s[22:23]
  v_pk_fma_f32 v[50:51], v[50:51], s[22:23], s[22:23]
  v_pk_fma_f32 v[52:53], v[52:53], s[22:23], s[22:23]
  v_pk_fma_f32 v[54:55], v[54:55], s[22:23], s[22:23]
  v_pk_fma_f32 v[56:57], v[56:57], s[22:23], s[22:23]
  v_pk_fma_f32 v[58:59], v[58:59], s[22:23], s[22:23]
  v_pk_fma_f32 v[60:61], v[60:61], s[22:23], s[22:23]
  v_pk_fma_f32 v[62:63], v[62:63], s[22:23], s[22:23]
  v_mfma_f32_32x32x16_bf16 v[112:127], a[216:219], a[192:195], 0
  ds_read_b128 v[192:195], v1 offset:20480
  ds_read_b128 v[196:199], v1 offset:21504
  v_rcp_f32 v48, v48
  v_rcp_f32 v49, v49
  v_mfma_f32_32x32x16_bf16 v[112:127], a[220:223], a[196:199], v[112:127]
  ds_read_b128 v[200:203], v1 offset:22528
  ds_read_b128 v[204:207], v1 offset:23552
  v_rcp_f32 v50, v50
  v_rcp_f32 v51, v51
  v_mfma_f32_32x32x16_bf16 v[128:143], a[224:227], a[200:203], 0
  ds_read_b128 v[208:211], v1 offset:24576
  ds_read_b128 v[212:215], v1 offset:25600
  v_rcp_f32_e64 v52, v52
  v_rcp_f32 v53, v53
  v_mfma_f32_32x32x16_bf16 v[128:143], a[228:231], a[204:207], v[128:143]
  s_nop 1
  v_cvt_pk_bf16_f32 v112, v112, v113
  v_cvt_pk_bf16_f32 v113, v114, v115
  v_cvt_pk_bf16_f32 v114, v116, v117
  v_cvt_pk_bf16_f32 v115, v118, v119
  v_rcp_f32_e64 v54, v54
  v_mfma_f32_32x32x16_bf16 v[144:159], a[232:235], a[208:211], 0
  ds_write_b128 v253, v[112:115]
  v_cvt_pk_bf16_f32 v116, v120, v121
  v_cvt_pk_bf16_f32 v117, v122, v123
  v_cvt_pk_bf16_f32 v118, v124, v125
  v_cvt_pk_bf16_f32 v119, v126, v127
  v_mfma_f32_32x32x16_bf16 v[144:159], a[236:239], a[212:215], v[144:159]
  ds_write_b128 v253, v[116:119] offset:3072
  v_cvt_pk_bf16_f32 v128, v128, v129
  v_cvt_pk_bf16_f32 v129, v130, v131
  v_cvt_pk_bf16_f32 v130, v132, v133
  v_cvt_pk_bf16_f32 v131, v134, v135
  v_mfma_f32_32x32x16_bf16 v[32:47], a[48:51], v[160:163], 0
  ds_write_b128 v253, v[128:131] offset:1024
  v_cvt_pk_bf16_f32 v132, v136, v137
  v_cvt_pk_bf16_f32 v133, v138, v139
  v_cvt_pk_bf16_f32 v134, v140, v141
  v_cvt_pk_bf16_f32 v135, v142, v143
  v_mfma_f32_32x32x16_bf16 v[32:47], a[52:55], v[164:167], v[32:47]
  ds_write_b128 v253, v[132:135] offset:4096
  v_cvt_pk_bf16_f32 v144, v144, v145
  v_cvt_pk_bf16_f32 v145, v146, v147
  v_cvt_pk_bf16_f32 v146, v148, v149
  v_cvt_pk_bf16_f32 v147, v150, v151
  v_mfma_f32_32x32x16_bf16 v[32:47], a[56:59], v[168:171], v[32:47]
  ds_write_b128 v253, v[144:147] offset:2048
  v_cvt_pk_bf16_f32 v148, v152, v153
  v_cvt_pk_bf16_f32 v149, v154, v155
  v_cvt_pk_bf16_f32 v150, v156, v157
  v_cvt_pk_bf16_f32 v151, v158, v159
  v_mfma_f32_32x32x16_bf16 v[32:47], a[60:63], v[172:175], v[32:47]
  ds_write_b128 v253, v[148:151] offset:5120
  v_rcp_f32 v55, v55
  v_rcp_f32 v56, v56
  v_mfma_f32_32x32x16_bf16 v[32:47], a[64:67], v[176:179], v[32:47]
  v_rcp_f32 v57, v57
  v_rcp_f32 v58, v58
  v_rcp_f32_e64 v59, v59
  v_mfma_f32_32x32x16_bf16 v[32:47], a[68:71], v[180:183], v[32:47]
  s_waitcnt lgkmcnt(6)
  v_rcp_f32 v60, v60
  v_rcp_f32 v61, v61
  v_rcp_f32 v62, v62
  v_rcp_f32_e64 v63, v63
  v_pk_mul_f32 v[16:17], v[16:17], v[48:49]
  v_pk_mul_f32 v[18:19], v[18:19], v[50:51]
  v_pk_mul_f32 v[20:21], v[20:21], v[52:53]
  v_pk_mul_f32 v[22:23], v[22:23], v[54:55]
  v_pk_mul_f32 v[24:25], v[24:25], v[56:57]
  v_pk_mul_f32 v[26:27], v[26:27], v[58:59]
  v_pk_mul_f32 v[28:29], v[28:29], v[60:61]
  v_pk_mul_f32 v[30:31], v[30:31], v[62:63]
  v_pk_fma_f32 v[48:49], v[32:33], v[32:33], s[20:21] neg_lo:[1,0,1] neg_hi:[1,0,1]
  v_pk_fma_f32 v[50:51], v[34:35], v[34:35], s[20:21] neg_lo:[1,0,1] neg_hi:[1,0,1]
  v_pk_fma_f32 v[52:53], v[36:37], v[36:37], s[20:21] neg_lo:[1,0,1] neg_hi:[1,0,1]
  v_pk_fma_f32 v[54:55], v[38:39], v[38:39], s[20:21] neg_lo:[1,0,1] neg_hi:[1,0,1]
  v_pk_fma_f32 v[56:57], v[40:41], v[40:41], s[20:21] neg_lo:[1,0,1] neg_hi:[1,0,1]
  v_pk_fma_f32 v[58:59], v[42:43], v[42:43], s[20:21] neg_lo:[1,0,1] neg_hi:[1,0,1]
  v_pk_fma_f32 v[60:61], v[44:45], v[44:45], s[20:21] neg_lo:[1,0,1] neg_hi:[1,0,1]
  v_pk_fma_f32 v[62:63], v[46:47], v[46:47], s[20:21] neg_lo:[1,0,1] neg_hi:[1,0,1]
  v_pk_mul_f32 v[48:49], v[32:33], v[48:49]
  v_pk_mul_f32 v[50:51], v[34:35], v[50:51]
  v_pk_mul_f32 v[52:53], v[36:37], v[52:53]
  v_pk_mul_f32 v[54:55], v[38:39], v[54:55]
  v_pk_mul_f32 v[56:57], v[40:41], v[56:57]
  v_cvt_pk_bf16_f32 v184, v16, v17
  v_cvt_pk_bf16_f32 v185, v18, v19
  v_cvt_pk_bf16_f32 v186, v20, v21
  v_cvt_pk_bf16_f32 v187, v22, v23
  v_pk_mul_f32 v[58:59], v[42:43], v[58:59]
  v_pk_mul_f32 v[60:61], v[44:45], v[60:61]
  v_pk_mul_f32 v[62:63], v[46:47], v[62:63]
  v_mfma_f32_32x32x16_bf16 v[64:79], v[192:195], v[184:187], v[64:79]
  s_add_u32 s29, s29, 0x60000
  v_cvt_pk_bf16_f32 v188, v24, v25
  v_cvt_pk_bf16_f32 v189, v26, v27
  v_cvt_pk_bf16_f32 v190, v28, v29
  v_cvt_pk_bf16_f32 v191, v30, v31
  v_exp_f32_e64 v48, v48
  v_mfma_f32_32x32x16_bf16 v[80:95], v[196:199], v[184:187], v[80:95]
  s_add_u32 s52, s52, 0x60000
  v_exp_f32 v49, v49
  v_exp_f32 v50, v50
  v_exp_f32_e64 v51, v51
  v_mfma_f32_32x32x16_bf16 v[96:111], v[200:203], v[184:187], v[96:111]
  s_mov_b32 s32, s30
  s_waitcnt vmcnt(0)
  ds_read_b128 a[216:219], v251 offset:24576
  ds_read_b128 a[220:223], v252 offset:24576
  ds_read_b128 a[224:227], v251 offset:24640
  v_exp_f32_e64 v52, v52
  v_exp_f32 v53, v53
  v_mfma_f32_32x32x16_bf16 v[64:79], v[204:207], v[188:191], v[64:79]
  s_add_u32 s30, s33, 32
  ds_read_b128 a[228:231], v252 offset:24640
  ds_read_b128 a[232:235], v251 offset:24704
  ds_read_b128 a[236:239], v252 offset:24704
  v_subrev_u32 v11, 0x4100, v4
  v_exp_f32_e64 v54, v54
  v_mfma_f32_32x32x16_bf16 v[80:95], v[208:211], v[188:191], v[80:95]
  s_sub_u32 s33, s31, 0
  v_exp_f32 v55, v55
  v_exp_f32 v56, v56
  v_exp_f32 v57, v57
  v_exp_f32 v58, v58
  v_mfma_f32_32x32x16_bf16 v[96:111], v[212:215], v[188:191], v[96:111]
  s_waitcnt lgkmcnt(0)
  v_add_u32 v4, 0x8200, v4
  v_exp_f32 v59, v59
  v_exp_f32 v60, v60
  v_exp_f32 v61, v61
  v_exp_f32 v62, v62
  v_exp_f32 v63, v63
  v_min_u32 v4, v11, v4
  v_pk_fma_f32 v[48:49], v[48:49], s[22:23], s[22:23]
  v_pk_fma_f32 v[50:51], v[50:51], s[22:23], s[22:23]
  v_pk_fma_f32 v[52:53], v[52:53], s[22:23], s[22:23]
  v_pk_fma_f32 v[54:55], v[54:55], s[22:23], s[22:23]
  v_pk_fma_f32 v[56:57], v[56:57], s[22:23], s[22:23]
  v_pk_fma_f32 v[58:59], v[58:59], s[22:23], s[22:23]
  v_pk_fma_f32 v[60:61], v[60:61], s[22:23], s[22:23]
  v_pk_fma_f32 v[62:63], v[62:63], s[22:23], s[22:23]
  v_mfma_f32_32x32x16_bf16 v[112:127], a[216:219], a[192:195], 0
  ds_read_b128 v[192:195], v1 offset:26624
  ds_read_b128 v[196:199], v1 offset:27648
  v_rcp_f32 v48, v48
  v_rcp_f32 v49, v49
  v_mfma_f32_32x32x16_bf16 v[112:127], a[220:223], a[196:199], v[112:127]
  ds_read_b128 v[200:203], v1 offset:28672
  ds_read_b128 v[204:207], v1 offset:29696
  v_rcp_f32 v50, v50
  v_rcp_f32 v51, v51
  v_mfma_f32_32x32x16_bf16 v[128:143], a[224:227], a[200:203], 0
  ds_read_b128 v[208:211], v1 offset:30720
  ds_read_b128 v[212:215], v1 offset:31744
  v_rcp_f32_e64 v52, v52
  v_rcp_f32 v53, v53
  v_mfma_f32_32x32x16_bf16 v[128:143], a[228:231], a[204:207], v[128:143]
  s_nop 1
  v_cvt_pk_bf16_f32 v112, v112, v113
  v_cvt_pk_bf16_f32 v113, v114, v115
  v_cvt_pk_bf16_f32 v114, v116, v117
  v_cvt_pk_bf16_f32 v115, v118, v119
  v_rcp_f32_e64 v54, v54
  v_mfma_f32_32x32x16_bf16 v[144:159], a[232:235], a[208:211], 0
  ds_write_b128 v253, v[112:115] offset:24576
  v_cvt_pk_bf16_f32 v116, v120, v121
  v_cvt_pk_bf16_f32 v117, v122, v123
  v_cvt_pk_bf16_f32 v118, v124, v125
  v_cvt_pk_bf16_f32 v119, v126, v127
  v_mfma_f32_32x32x16_bf16 v[144:159], a[236:239], a[212:215], v[144:159]
  ds_write_b128 v253, v[116:119] offset:27648
  v_cvt_pk_bf16_f32 v128, v128, v129
  v_cvt_pk_bf16_f32 v129, v130, v131
  v_cvt_pk_bf16_f32 v130, v132, v133
  v_cvt_pk_bf16_f32 v131, v134, v135
  v_mfma_f32_32x32x16_bf16 v[16:31], a[72:75], v[160:163], 0
  ds_write_b128 v253, v[128:131] offset:25600
  v_cvt_pk_bf16_f32 v132, v136, v137
  v_cvt_pk_bf16_f32 v133, v138, v139
  v_cvt_pk_bf16_f32 v134, v140, v141
  v_cvt_pk_bf16_f32 v135, v142, v143
  v_mfma_f32_32x32x16_bf16 v[16:31], a[76:79], v[164:167], v[16:31]
  ds_write_b128 v253, v[132:135] offset:28672
  v_cvt_pk_bf16_f32 v144, v144, v145
  v_cvt_pk_bf16_f32 v145, v146, v147
  v_cvt_pk_bf16_f32 v146, v148, v149
  v_cvt_pk_bf16_f32 v147, v150, v151
  v_mfma_f32_32x32x16_bf16 v[16:31], a[80:83], v[168:171], v[16:31]
  ds_write_b128 v253, v[144:147] offset:26624
  v_cvt_pk_bf16_f32 v148, v152, v153
  v_cvt_pk_bf16_f32 v149, v154, v155
  v_cvt_pk_bf16_f32 v150, v156, v157
  v_cvt_pk_bf16_f32 v151, v158, v159
  v_mfma_f32_32x32x16_bf16 v[16:31], a[84:87], v[172:175], v[16:31]
  ds_write_b128 v253, v[148:151] offset:29696
  buffer_load_dword v249, v248, s[4:7], s29 offen
  v_rcp_f32_e64 v55, v55
  v_mfma_f32_32x32x16_bf16 v[16:31], a[88:91], v[176:179], v[16:31]
  v_rcp_f32 v56, v56
  v_rcp_f32 v57, v57
  v_rcp_f32_e64 v58, v58
  v_mfma_f32_32x32x16_bf16 v[16:31], a[92:95], v[180:183], v[16:31]
  s_waitcnt lgkmcnt(6)
  v_rcp_f32 v59, v59
  v_rcp_f32 v60, v60
  v_rcp_f32 v61, v61
  v_rcp_f32 v62, v62
  v_rcp_f32 v63, v63
  v_pk_mul_f32 v[32:33], v[32:33], v[48:49]
  v_pk_mul_f32 v[34:35], v[34:35], v[50:51]
  v_pk_mul_f32 v[36:37], v[36:37], v[52:53]
  v_pk_mul_f32 v[38:39], v[38:39], v[54:55]
  v_pk_mul_f32 v[40:41], v[40:41], v[56:57]
  v_pk_mul_f32 v[42:43], v[42:43], v[58:59]
  v_pk_mul_f32 v[44:45], v[44:45], v[60:61]
  v_pk_mul_f32 v[46:47], v[46:47], v[62:63]
  v_pk_fma_f32 v[48:49], v[16:17], v[16:17], s[20:21] neg_lo:[1,0,1] neg_hi:[1,0,1]
  v_pk_fma_f32 v[50:51], v[18:19], v[18:19], s[20:21] neg_lo:[1,0,1] neg_hi:[1,0,1]
  v_pk_fma_f32 v[52:53], v[20:21], v[20:21], s[20:21] neg_lo:[1,0,1] neg_hi:[1,0,1]
  v_pk_fma_f32 v[54:55], v[22:23], v[22:23], s[20:21] neg_lo:[1,0,1] neg_hi:[1,0,1]
  v_pk_fma_f32 v[56:57], v[24:25], v[24:25], s[20:21] neg_lo:[1,0,1] neg_hi:[1,0,1]
  v_pk_fma_f32 v[58:59], v[26:27], v[26:27], s[20:21] neg_lo:[1,0,1] neg_hi:[1,0,1]
  v_pk_fma_f32 v[60:61], v[28:29], v[28:29], s[20:21] neg_lo:[1,0,1] neg_hi:[1,0,1]
  v_pk_fma_f32 v[62:63], v[30:31], v[30:31], s[20:21] neg_lo:[1,0,1] neg_hi:[1,0,1]
  v_pk_mul_f32 v[48:49], v[16:17], v[48:49]
  v_pk_mul_f32 v[50:51], v[18:19], v[50:51]
  v_pk_mul_f32 v[52:53], v[20:21], v[52:53]
  v_pk_mul_f32 v[54:55], v[22:23], v[54:55]
  v_pk_mul_f32 v[56:57], v[24:25], v[56:57]
  v_cvt_pk_bf16_f32 v184, v32, v33
  v_cvt_pk_bf16_f32 v185, v34, v35
  v_cvt_pk_bf16_f32 v186, v36, v37
  v_cvt_pk_bf16_f32 v187, v38, v39
  v_pk_mul_f32 v[58:59], v[26:27], v[58:59]
  v_pk_mul_f32 v[60:61], v[28:29], v[60:61]
  v_pk_mul_f32 v[62:63], v[30:31], v[62:63]
  v_mfma_f32_32x32x16_bf16 v[64:79], v[192:195], v[184:187], v[64:79]
  ds_read_b128 v[220:223], v4 offset:96
  v_cvt_pk_bf16_f32 v188, v40, v41
  v_cvt_pk_bf16_f32 v189, v42, v43
  v_cvt_pk_bf16_f32 v190, v44, v45
  v_cvt_pk_bf16_f32 v191, v46, v47
  v_mfma_f32_32x32x16_bf16 v[80:95], v[196:199], v[184:187], v[80:95]
  ds_read_b128 v[228:231], v4 offset:288
  v_exp_f32 v48, v48
  v_exp_f32 v49, v49
  v_exp_f32_e64 v50, v50
  v_mfma_f32_32x32x16_bf16 v[96:111], v[200:203], v[184:187], v[96:111]
  ds_read_b128 v[236:239], v4 offset:480
  v_exp_f32 v51, v51
  v_exp_f32 v52, v52
  v_mfma_f32_32x32x16_bf16 v[64:79], v[204:207], v[188:191], v[64:79]
  v_exp_f32 v53, v53
  v_exp_f32 v54, v54
  v_exp_f32_e64 v55, v55
  v_mfma_f32_32x32x16_bf16 v[80:95], v[208:211], v[188:191], v[80:95]
  v_exp_f32 v56, v56
  v_exp_f32 v57, v57
  v_exp_f32_e64 v58, v58
  v_mfma_f32_32x32x16_bf16 v[96:111], v[212:215], v[188:191], v[96:111]
  s_waitcnt lgkmcnt(0)
  v_exp_f32 v59, v59
  v_exp_f32 v60, v60
  v_exp_f32 v61, v61
  v_exp_f32_e64 v62, v62
  v_exp_f32_e64 v63, v63
  v_pk_fma_f32 v[48:49], v[48:49], s[22:23], s[22:23]
  v_pk_fma_f32 v[50:51], v[50:51], s[22:23], s[22:23]
  v_pk_fma_f32 v[52:53], v[52:53], s[22:23], s[22:23]
  v_pk_fma_f32 v[54:55], v[54:55], s[22:23], s[22:23]
  v_pk_fma_f32 v[56:57], v[56:57], s[22:23], s[22:23]
  v_pk_fma_f32 v[58:59], v[58:59], s[22:23], s[22:23]
  v_pk_fma_f32 v[60:61], v[60:61], s[22:23], s[22:23]
  v_pk_fma_f32 v[62:63], v[62:63], s[22:23], s[22:23]
  s_barrier
  v_mfma_f32_32x32x16_bf16 v[32:47], a[96:99], v[160:163], 0
  ds_read_b128 v[192:195], v0 offset:24576
  ds_read_b128 v[196:199], v0 offset:25600
  v_rcp_f32 v48, v48
  v_rcp_f32_e64 v49, v49
  v_mfma_f32_16x16x32_bf16 v[136:139], a[240:243], v[220:223], 0
  ds_read_b128 v[216:219], v3 offset:2800
  ds_read_b128 v[220:223], v4 offset:112
  v_mfma_f32_32x32x16_bf16 v[32:47], a[100:103], v[164:167], v[32:47]
  ds_read_b128 v[200:203], v0 offset:26624
  ds_read_b128 v[204:207], v0 offset:27648
  v_rcp_f32 v50, v50
  v_rcp_f32 v51, v51
  v_mfma_f32_16x16x32_bf16 v[136:139], a[244:247], v[228:231], v[136:139]
  ds_read_b128 v[224:227], v3 offset:7600
  ds_read_b128 v[228:231], v4 offset:304
  v_mfma_f32_32x32x16_bf16 v[32:47], a[104:107], v[168:171], v[32:47]
  ds_read_b128 v[208:211], v0 offset:28672
  ds_read_b128 v[212:215], v0 offset:29696
  v_rcp_f32 v52, v52
  v_rcp_f32 v53, v53
  v_mfma_f32_16x16x32_bf16 v[136:139], a[248:251], v[236:239], v[136:139]
  ds_read_b128 v[232:235], v3 offset:12400
  ds_read_b128 v[236:239], v4 offset:496
  v_mfma_f32_32x32x16_bf16 v[32:47], a[108:111], v[172:175], v[32:47]
  v_rcp_f32 v54, v54
  v_rcp_f32 v55, v55
  v_rcp_f32_e64 v56, v56
  v_mfma_f32_32x32x16_bf16 v[32:47], a[112:115], v[176:179], v[32:47]
  v_rcp_f32 v57, v57
  v_rcp_f32 v58, v58
  v_rcp_f32_e64 v59, v59
  v_mfma_f32_32x32x16_bf16 v[32:47], a[116:119], v[180:183], v[32:47]
  s_waitcnt lgkmcnt(0)
  v_rcp_f32 v60, v60
  v_rcp_f32 v61, v61
  v_rcp_f32 v62, v62
  v_rcp_f32_e64 v63, v63
  v_pk_mul_f32 v[16:17], v[16:17], v[48:49]
  v_pk_mul_f32 v[18:19], v[18:19], v[50:51]
  v_pk_mul_f32 v[20:21], v[20:21], v[52:53]
  v_pk_mul_f32 v[22:23], v[22:23], v[54:55]
  v_pk_mul_f32 v[24:25], v[24:25], v[56:57]
  v_pk_mul_f32 v[26:27], v[26:27], v[58:59]
  v_pk_mul_f32 v[28:29], v[28:29], v[60:61]
  v_pk_mul_f32 v[30:31], v[30:31], v[62:63]
  v_pk_add_f32 v[12:13], v[136:137], v[138:139]
  v_pk_mul_f32 v[14:15], v[136:137], v[136:137]
  v_pk_fma_f32 v[14:15], v[138:139], v[138:139], v[14:15]
  v_pk_fma_f32 v[48:49], v[32:33], v[32:33], s[20:21] neg_lo:[1,0,1] neg_hi:[1,0,1]
  v_pk_fma_f32 v[50:51], v[34:35], v[34:35], s[20:21] neg_lo:[1,0,1] neg_hi:[1,0,1]
  v_pk_fma_f32 v[52:53], v[36:37], v[36:37], s[20:21] neg_lo:[1,0,1] neg_hi:[1,0,1]
  v_pk_fma_f32 v[54:55], v[38:39], v[38:39], s[20:21] neg_lo:[1,0,1] neg_hi:[1,0,1]
  v_pk_fma_f32 v[56:57], v[40:41], v[40:41], s[20:21] neg_lo:[1,0,1] neg_hi:[1,0,1]
  v_pk_fma_f32 v[58:59], v[42:43], v[42:43], s[20:21] neg_lo:[1,0,1] neg_hi:[1,0,1]
  v_pk_fma_f32 v[60:61], v[44:45], v[44:45], s[20:21] neg_lo:[1,0,1] neg_hi:[1,0,1]
  v_pk_fma_f32 v[62:63], v[46:47], v[46:47], s[20:21] neg_lo:[1,0,1] neg_hi:[1,0,1]
  v_pk_mul_f32 v[48:49], v[32:33], v[48:49]
  v_pk_mul_f32 v[50:51], v[34:35], v[50:51]
  v_pk_mul_f32 v[52:53], v[36:37], v[52:53]
  v_pk_mul_f32 v[54:55], v[38:39], v[54:55]
  v_pk_mul_f32 v[56:57], v[40:41], v[56:57]
  v_pk_mul_f32 v[58:59], v[42:43], v[58:59]
  v_pk_mul_f32 v[60:61], v[44:45], v[60:61]
  v_pk_mul_f32 v[62:63], v[46:47], v[62:63]
  v_mfma_f32_16x16x32_bf16 v[140:143], v[216:219], v[220:223], 0
  v_cvt_pk_bf16_f32 v184, v16, v17
  v_cvt_pk_bf16_f32 v185, v18, v19
  v_mfma_f32_16x16x32_bf16 v[140:143], v[224:227], v[228:231], v[140:143]
  v_cvt_pk_bf16_f32 v186, v20, v21
  v_cvt_pk_bf16_f32 v187, v22, v23
  v_mfma_f32_16x16x32_bf16 v[140:143], v[232:235], v[236:239], v[140:143]
  ds_read_b128 v[220:223], v4 offset:128
  v_mfma_f32_32x32x16_bf16 v[64:79], v[192:195], v[184:187], v[64:79]
  ds_read_b128 v[224:227], v3 offset:8000
  ds_read_b128 v[228:231], v4 offset:320
  v_cvt_pk_bf16_f32 v188, v24, v25
  v_cvt_pk_bf16_f32 v189, v26, v27
  v_cvt_pk_bf16_f32 v190, v28, v29
  v_cvt_pk_bf16_f32 v191, v30, v31
  v_mfma_f32_32x32x16_bf16 v[80:95], v[196:199], v[184:187], v[80:95]
  ds_read_b128 v[232:235], v3 offset:12800
  ds_read_b128 v[236:239], v4 offset:512
  v_exp_f32 v48, v48
  v_exp_f32 v49, v49
  v_mfma_f32_32x32x16_bf16 v[96:111], v[200:203], v[184:187], v[96:111]
  s_sub_u32 s31, s32, 32
  v_exp_f32 v50, v50
  v_exp_f32 v51, v51
  v_exp_f32 v52, v52
  v_mfma_f32_32x32x16_bf16 v[64:79], v[204:207], v[188:191], v[64:79]
  v_exp_f32 v53, v53
  v_exp_f32 v54, v54
  v_exp_f32_e64 v55, v55
  v_mfma_f32_32x32x16_bf16 v[80:95], v[208:211], v[188:191], v[80:95]
  v_exp_f32 v56, v56
  v_exp_f32 v57, v57
  v_exp_f32_e64 v58, v58
  v_mfma_f32_32x32x16_bf16 v[96:111], v[212:215], v[188:191], v[96:111]
  s_waitcnt lgkmcnt(0)
  v_exp_f32 v59, v59
  v_exp_f32 v60, v60
  v_exp_f32 v61, v61
  v_exp_f32 v62, v62
  v_exp_f32 v63, v63
  v_pk_add_f32 v[12:13], v[12:13], v[140:141]
  v_pk_fma_f32 v[14:15], v[140:141], v[140:141], v[14:15]
  v_pk_add_f32 v[12:13], v[12:13], v[142:143]
  v_pk_fma_f32 v[14:15], v[142:143], v[142:143], v[14:15]
  v_pk_fma_f32 v[48:49], v[48:49], s[22:23], s[22:23]
  v_pk_fma_f32 v[50:51], v[50:51], s[22:23], s[22:23]
  v_pk_fma_f32 v[52:53], v[52:53], s[22:23], s[22:23]
  v_pk_fma_f32 v[54:55], v[54:55], s[22:23], s[22:23]
  v_pk_fma_f32 v[56:57], v[56:57], s[22:23], s[22:23]
  v_pk_fma_f32 v[58:59], v[58:59], s[22:23], s[22:23]
  v_pk_fma_f32 v[60:61], v[60:61], s[22:23], s[22:23]
  v_pk_fma_f32 v[62:63], v[62:63], s[22:23], s[22:23]
  v_mfma_f32_32x32x16_bf16 v[16:31], a[120:123], v[160:163], 0
  ds_read_b128 v[192:195], v0 offset:30720
  ds_read_b128 v[196:199], v0 offset:31744
  v_rcp_f32 v48, v48
  v_rcp_f32 v49, v49
  v_mfma_f32_16x16x32_bf16 v[144:147], a[252:255], v[220:223], 0
  ds_read_b128 v[216:219], v3 offset:3600
  ds_read_b128 v[220:223], v4 offset:144
  v_mfma_f32_32x32x16_bf16 v[16:31], a[124:127], v[164:167], v[16:31]
  ds_read_b128 v[200:203], v0 offset:32768
  ds_read_b128 v[204:207], v0 offset:33792
  v_rcp_f32 v50, v50
  v_rcp_f32 v51, v51
  v_mfma_f32_16x16x32_bf16 v[144:147], v[224:227], v[228:231], v[144:147]
  ds_read_b128 v[224:227], v3 offset:8400
  ds_read_b128 v[228:231], v4 offset:336
  v_mfma_f32_32x32x16_bf16 v[16:31], a[128:131], v[168:171], v[16:31]
  ds_read_b128 v[208:211], v0 offset:34816
  ds_read_b128 v[212:215], v0 offset:35840
  v_rcp_f32 v52, v52
  v_rcp_f32 v53, v53
  v_mfma_f32_16x16x32_bf16 v[144:147], v[232:235], v[236:239], v[144:147]
  ds_read_b128 v[232:235], v3 offset:13200
  ds_read_b128 v[236:239], v4 offset:528
  v_mfma_f32_32x32x16_bf16 v[16:31], a[132:135], v[172:175], v[16:31]
  v_rcp_f32 v54, v54
  v_rcp_f32 v55, v55
  v_rcp_f32_e64 v56, v56
  v_mfma_f32_32x32x16_bf16 v[16:31], a[136:139], v[176:179], v[16:31]
  ds_read_b128 a[192:195], v0
  ds_read_b128 a[196:199], v0 offset:1024
  ds_read_b128 a[200:203], v0 offset:2048
  v_rcp_f32 v57, v57
  v_rcp_f32 v58, v58
  v_mfma_f32_32x32x16_bf16 v[16:31], a[140:143], v[180:183], v[16:31]
  s_waitcnt lgkmcnt(3)
  v_rcp_f32 v59, v59
  v_rcp_f32 v60, v60
  v_rcp_f32 v61, v61
  v_rcp_f32 v62, v62
  v_rcp_f32 v63, v63
  v_pk_mul_f32 v[32:33], v[32:33], v[48:49]
  v_pk_mul_f32 v[34:35], v[34:35], v[50:51]
  v_pk_mul_f32 v[36:37], v[36:37], v[52:53]
  v_pk_mul_f32 v[38:39], v[38:39], v[54:55]
  v_pk_mul_f32 v[40:41], v[40:41], v[56:57]
  v_pk_mul_f32 v[42:43], v[42:43], v[58:59]
  v_pk_mul_f32 v[44:45], v[44:45], v[60:61]
  v_pk_mul_f32 v[46:47], v[46:47], v[62:63]
  v_pk_add_f32 v[12:13], v[12:13], v[144:145]
  v_pk_fma_f32 v[14:15], v[144:145], v[144:145], v[14:15]
  v_pk_add_f32 v[12:13], v[12:13], v[146:147]
  v_pk_fma_f32 v[14:15], v[146:147], v[146:147], v[14:15]
  v_pk_fma_f32 v[48:49], v[16:17], v[16:17], s[20:21] neg_lo:[1,0,1] neg_hi:[1,0,1]
  v_pk_fma_f32 v[50:51], v[18:19], v[18:19], s[20:21] neg_lo:[1,0,1] neg_hi:[1,0,1]
  v_pk_fma_f32 v[52:53], v[20:21], v[20:21], s[20:21] neg_lo:[1,0,1] neg_hi:[1,0,1]
  v_pk_fma_f32 v[54:55], v[22:23], v[22:23], s[20:21] neg_lo:[1,0,1] neg_hi:[1,0,1]
  v_pk_fma_f32 v[56:57], v[24:25], v[24:25], s[20:21] neg_lo:[1,0,1] neg_hi:[1,0,1]
  v_pk_fma_f32 v[58:59], v[26:27], v[26:27], s[20:21] neg_lo:[1,0,1] neg_hi:[1,0,1]
  v_pk_fma_f32 v[60:61], v[28:29], v[28:29], s[20:21] neg_lo:[1,0,1] neg_hi:[1,0,1]
  v_pk_fma_f32 v[62:63], v[30:31], v[30:31], s[20:21] neg_lo:[1,0,1] neg_hi:[1,0,1]
  v_pk_mul_f32 v[48:49], v[16:17], v[48:49]
  v_pk_mul_f32 v[50:51], v[18:19], v[50:51]
  v_pk_mul_f32 v[52:53], v[20:21], v[52:53]
  v_pk_mul_f32 v[54:55], v[22:23], v[54:55]
  v_pk_mul_f32 v[56:57], v[24:25], v[56:57]
  v_pk_mul_f32 v[58:59], v[26:27], v[58:59]
  v_pk_mul_f32 v[60:61], v[28:29], v[60:61]
  v_pk_mul_f32 v[62:63], v[30:31], v[62:63]
  v_mfma_f32_16x16x32_bf16 v[148:151], v[216:219], v[220:223], 0
  v_cvt_pk_bf16_f32 v184, v32, v33
  v_cvt_pk_bf16_f32 v185, v34, v35
  v_mfma_f32_16x16x32_bf16 v[148:151], v[224:227], v[228:231], v[148:151]
  v_cvt_pk_bf16_f32 v186, v36, v37
  v_cvt_pk_bf16_f32 v187, v38, v39
  v_mfma_f32_16x16x32_bf16 v[148:151], v[232:235], v[236:239], v[148:151]
  ds_read_b128 v[216:219], v3 offset:4000
  ds_read_b128 v[220:223], v4 offset:160
  v_mfma_f32_32x32x16_bf16 v[64:79], v[192:195], v[184:187], v[64:79]
  ds_read_b128 v[224:227], v3 offset:8800
  ds_read_b128 v[228:231], v4 offset:352
  v_cvt_pk_bf16_f32 v188, v40, v41
  v_cvt_pk_bf16_f32 v189, v42, v43
  v_cvt_pk_bf16_f32 v190, v44, v45
  v_cvt_pk_bf16_f32 v191, v46, v47
  v_mfma_f32_32x32x16_bf16 v[80:95], v[196:199], v[184:187], v[80:95]
  ds_read_b128 v[232:235], v3 offset:13600
  ds_read_b128 v[236:239], v4 offset:544
  v_exp_f32 v48, v48
  v_exp_f32 v49, v49
  v_mfma_f32_32x32x16_bf16 v[96:111], v[200:203], v[184:187], v[96:111]
  v_exp_f32 v50, v50
  v_exp_f32 v51, v51
  v_exp_f32_e64 v52, v52
  v_mfma_f32_32x32x16_bf16 v[64:79], v[204:207], v[188:191], v[64:79]
  v_exp_f32 v53, v53
  v_exp_f32 v54, v54
  v_exp_f32_e64 v55, v55
  v_mfma_f32_32x32x16_bf16 v[80:95], v[208:211], v[188:191], v[80:95]
  ds_read_b128 a[204:207], v0 offset:3072
  ds_read_b128 a[208:211], v0 offset:4096
  ds_read_b128 a[212:215], v0 offset:5120
  v_exp_f32 v56, v56
  v_exp_f32 v57, v57
  v_mfma_f32_32x32x16_bf16 v[96:111], v[212:215], v[188:191], v[96:111]
  s_waitcnt lgkmcnt(3)
  v_exp_f32 v58, v58
  v_exp_f32 v59, v59
  v_exp_f32 v60, v60
  v_exp_f32 v61, v61
  v_exp_f32 v62, v62
  v_exp_f32_e64 v63, v63
  v_pk_add_f32 v[12:13], v[12:13], v[148:149]
  v_pk_fma_f32 v[14:15], v[148:149], v[148:149], v[14:15]
  v_pk_add_f32 v[12:13], v[12:13], v[150:151]
  v_pk_fma_f32 v[14:15], v[150:151], v[150:151], v[14:15]
  v_pk_fma_f32 v[48:49], v[48:49], s[22:23], s[22:23]
  v_pk_fma_f32 v[50:51], v[50:51], s[22:23], s[22:23]
  v_pk_fma_f32 v[52:53], v[52:53], s[22:23], s[22:23]
  v_pk_fma_f32 v[54:55], v[54:55], s[22:23], s[22:23]
  v_pk_fma_f32 v[56:57], v[56:57], s[22:23], s[22:23]
  v_pk_fma_f32 v[58:59], v[58:59], s[22:23], s[22:23]
  v_pk_fma_f32 v[60:61], v[60:61], s[22:23], s[22:23]
  v_pk_fma_f32 v[62:63], v[62:63], s[22:23], s[22:23]
  v_mfma_f32_32x32x16_bf16 v[32:47], a[144:147], v[160:163], 0
  ds_read_b128 v[192:195], v0 offset:36864
  ds_read_b128 v[196:199], v0 offset:37888
  v_rcp_f32 v48, v48
  v_rcp_f32 v49, v49
  v_mfma_f32_16x16x32_bf16 v[152:155], v[216:219], v[220:223], 0
  ds_read_b128 v[216:219], v3 offset:4400
  ds_read_b128 v[220:223], v4 offset:176
  v_mfma_f32_32x32x16_bf16 v[32:47], a[148:151], v[164:167], v[32:47]
  ds_read_b128 v[200:203], v0 offset:38912
  ds_read_b128 v[204:207], v0 offset:39936
  v_rcp_f32 v50, v50
  v_rcp_f32 v51, v51
  v_mfma_f32_16x16x32_bf16 v[152:155], v[224:227], v[228:231], v[152:155]
  ds_read_b128 v[224:227], v3 offset:9200
  ds_read_b128 v[228:231], v4 offset:368
  v_mfma_f32_32x32x16_bf16 v[32:47], a[152:155], v[168:171], v[32:47]
  ds_read_b128 v[208:211], v0 offset:40960
  ds_read_b128 v[212:215], v0 offset:41984
  v_rcp_f32 v52, v52
  v_rcp_f32 v53, v53
  v_mfma_f32_16x16x32_bf16 v[152:155], v[232:235], v[236:239], v[152:155]
  ds_read_b128 v[232:235], v3 offset:14000
  ds_read_b128 v[236:239], v4 offset:560
  v_mfma_f32_32x32x16_bf16 v[32:47], a[156:159], v[172:175], v[32:47]
  v_rcp_f32 v54, v54
  v_rcp_f32 v55, v55
  v_rcp_f32_e64 v56, v56
  v_mfma_f32_32x32x16_bf16 v[32:47], a[160:163], v[176:179], v[32:47]
  ds_read_b128 a[216:219], v0 offset:6144
  ds_read_b128 a[220:223], v0 offset:7168
  ds_read_b128 a[224:227], v0 offset:8192
  v_rcp_f32 v57, v57
  v_rcp_f32 v58, v58
  v_mfma_f32_32x32x16_bf16 v[32:47], a[164:167], v[180:183], v[32:47]
  s_waitcnt lgkmcnt(3)
  v_rcp_f32 v59, v59
  v_rcp_f32 v60, v60
  v_rcp_f32 v61, v61
  v_rcp_f32 v62, v62
  v_rcp_f32 v63, v63
  v_pk_mul_f32 v[16:17], v[16:17], v[48:49]
  v_pk_mul_f32 v[18:19], v[18:19], v[50:51]
  v_pk_mul_f32 v[20:21], v[20:21], v[52:53]
  v_pk_mul_f32 v[22:23], v[22:23], v[54:55]
  v_pk_mul_f32 v[24:25], v[24:25], v[56:57]
  v_pk_mul_f32 v[26:27], v[26:27], v[58:59]
  v_pk_mul_f32 v[28:29], v[28:29], v[60:61]
  v_pk_mul_f32 v[30:31], v[30:31], v[62:63]
  v_pk_add_f32 v[12:13], v[12:13], v[152:153]
  v_pk_fma_f32 v[14:15], v[152:153], v[152:153], v[14:15]
  v_pk_add_f32 v[12:13], v[12:13], v[154:155]
  v_pk_fma_f32 v[14:15], v[154:155], v[154:155], v[14:15]
  v_pk_fma_f32 v[48:49], v[32:33], v[32:33], s[20:21] neg_lo:[1,0,1] neg_hi:[1,0,1]
  v_pk_fma_f32 v[50:51], v[34:35], v[34:35], s[20:21] neg_lo:[1,0,1] neg_hi:[1,0,1]
  v_pk_fma_f32 v[52:53], v[36:37], v[36:37], s[20:21] neg_lo:[1,0,1] neg_hi:[1,0,1]
  v_pk_fma_f32 v[54:55], v[38:39], v[38:39], s[20:21] neg_lo:[1,0,1] neg_hi:[1,0,1]
  v_pk_fma_f32 v[56:57], v[40:41], v[40:41], s[20:21] neg_lo:[1,0,1] neg_hi:[1,0,1]
  v_pk_fma_f32 v[58:59], v[42:43], v[42:43], s[20:21] neg_lo:[1,0,1] neg_hi:[1,0,1]
  v_pk_fma_f32 v[60:61], v[44:45], v[44:45], s[20:21] neg_lo:[1,0,1] neg_hi:[1,0,1]
  v_pk_fma_f32 v[62:63], v[46:47], v[46:47], s[20:21] neg_lo:[1,0,1] neg_hi:[1,0,1]
  v_pk_mul_f32 v[48:49], v[32:33], v[48:49]
  v_pk_mul_f32 v[50:51], v[34:35], v[50:51]
  v_pk_mul_f32 v[52:53], v[36:37], v[52:53]
  v_pk_mul_f32 v[54:55], v[38:39], v[54:55]
  v_pk_mul_f32 v[56:57], v[40:41], v[56:57]
  v_pk_mul_f32 v[58:59], v[42:43], v[58:59]
  v_pk_mul_f32 v[60:61], v[44:45], v[60:61]
  v_pk_mul_f32 v[62:63], v[46:47], v[62:63]
  v_mfma_f32_16x16x32_bf16 v[156:159], v[216:219], v[220:223], 0
  v_cvt_pk_bf16_f32 v184, v16, v17
  v_cvt_pk_bf16_f32 v185, v18, v19
  v_mfma_f32_16x16x32_bf16 v[156:159], v[224:227], v[228:231], v[156:159]
  v_cvt_pk_bf16_f32 v186, v20, v21
  v_cvt_pk_bf16_f32 v187, v22, v23
  v_mfma_f32_16x16x32_bf16 v[156:159], v[232:235], v[236:239], v[156:159]
  ds_read_b128 v[216:219], v3
  ds_read_b128 v[220:223], v4
  v_mfma_f32_32x32x16_bf16 v[64:79], v[192:195], v[184:187], v[64:79]
  ds_read_b128 v[224:227], v3 offset:4800
  ds_read_b128 v[228:231], v4 offset:192
  v_cvt_pk_bf16_f32 v188, v24, v25
  v_cvt_pk_bf16_f32 v189, v26, v27
  v_cvt_pk_bf16_f32 v190, v28, v29
  v_cvt_pk_bf16_f32 v191, v30, v31
  v_mfma_f32_32x32x16_bf16 v[80:95], v[196:199], v[184:187], v[80:95]
  ds_read_b128 v[232:235], v3 offset:9600
  ds_read_b128 v[236:239], v4 offset:384
  v_exp_f32 v48, v48
  v_exp_f32 v49, v49
  v_mfma_f32_32x32x16_bf16 v[96:111], v[200:203], v[184:187], v[96:111]
  v_exp_f32 v50, v50
  v_exp_f32 v51, v51
  v_exp_f32_e64 v52, v52
  v_mfma_f32_32x32x16_bf16 v[64:79], v[204:207], v[188:191], v[64:79]
  v_exp_f32 v53, v53
  v_exp_f32 v54, v54
  v_exp_f32_e64 v55, v55
  v_mfma_f32_32x32x16_bf16 v[80:95], v[208:211], v[188:191], v[80:95]
  ds_read_b128 a[228:231], v0 offset:9216
  ds_read_b128 a[232:235], v0 offset:10240
  ds_read_b128 a[236:239], v0 offset:11264
  v_exp_f32 v56, v56
  v_exp_f32 v57, v57
  v_mfma_f32_32x32x16_bf16 v[96:111], v[212:215], v[188:191], v[96:111]
  s_waitcnt lgkmcnt(3)
  v_exp_f32 v58, v58
  v_exp_f32 v59, v59
  v_exp_f32 v60, v60
  v_exp_f32 v61, v61
  v_exp_f32 v62, v62
  v_exp_f32_e64 v63, v63
  v_pk_add_f32 v[12:13], v[12:13], v[156:157]
  v_pk_fma_f32 v[14:15], v[156:157], v[156:157], v[14:15]
  v_pk_add_f32 v[12:13], v[12:13], v[158:159]
  v_pk_fma_f32 v[14:15], v[158:159], v[158:159], v[14:15]
  v_pk_fma_f32 v[48:49], v[48:49], s[22:23], s[22:23]
  v_pk_fma_f32 v[50:51], v[50:51], s[22:23], s[22:23]
  v_pk_fma_f32 v[52:53], v[52:53], s[22:23], s[22:23]
  v_pk_fma_f32 v[54:55], v[54:55], s[22:23], s[22:23]
  v_pk_fma_f32 v[56:57], v[56:57], s[22:23], s[22:23]
  v_pk_fma_f32 v[58:59], v[58:59], s[22:23], s[22:23]
  v_pk_fma_f32 v[60:61], v[60:61], s[22:23], s[22:23]
  v_pk_fma_f32 v[62:63], v[62:63], s[22:23], s[22:23]
  v_mfma_f32_32x32x16_bf16 v[16:31], a[168:171], v[160:163], 0
  ds_read_b128 v[192:195], v0 offset:43008
  ds_read_b128 v[196:199], v0 offset:44032
  v_rcp_f32 v48, v48
  v_rcp_f32 v49, v49
  v_mfma_f32_16x16x32_bf16 v[112:115], v[216:219], v[220:223], 0
  ds_read_b128 v[216:219], v3 offset:400
  ds_read_b128 v[220:223], v4 offset:16
  v_mfma_f32_32x32x16_bf16 v[16:31], a[172:175], v[164:167], v[16:31]
  ds_read_b128 v[200:203], v0 offset:45056
  ds_read_b128 v[204:207], v0 offset:46080
  v_rcp_f32 v50, v50
  v_rcp_f32 v51, v51
  v_mfma_f32_16x16x32_bf16 v[112:115], v[224:227], v[228:231], v[112:115]
  ds_read_b128 v[224:227], v3 offset:5200
  ds_read_b128 v[228:231], v4 offset:208
  v_mfma_f32_32x32x16_bf16 v[16:31], a[176:179], v[168:171], v[16:31]
  ds_read_b128 v[208:211], v0 offset:47104
  ds_read_b128 v[212:215], v0 offset:48128
  v_rcp_f32 v52, v52
  v_rcp_f32 v53, v53
  v_mfma_f32_16x16x32_bf16 v[112:115], v[232:235], v[236:239], v[112:115]
  ds_read_b128 v[232:235], v3 offset:10000
  ds_read_b128 v[236:239], v4 offset:400
  v_mfma_f32_32x32x16_bf16 v[16:31], a[180:183], v[172:175], v[16:31]
  v_rcp_f32 v54, v54
  v_rcp_f32 v55, v55
  v_rcp_f32_e64 v56, v56
  v_mfma_f32_32x32x16_bf16 v[16:31], a[184:187], v[176:179], v[16:31]
  v_rcp_f32 v57, v57
  v_rcp_f32 v58, v58
  v_rcp_f32_e64 v59, v59
  v_mfma_f32_32x32x16_bf16 v[16:31], a[188:191], v[180:183], v[16:31]
  s_waitcnt lgkmcnt(0)
  v_rcp_f32 v60, v60
  v_rcp_f32 v61, v61
  v_rcp_f32 v62, v62
  v_rcp_f32_e64 v63, v63
  v_pk_mul_f32 v[32:33], v[32:33], v[48:49]
  v_pk_mul_f32 v[34:35], v[34:35], v[50:51]
  v_pk_mul_f32 v[36:37], v[36:37], v[52:53]
  v_pk_mul_f32 v[38:39], v[38:39], v[54:55]
  v_pk_mul_f32 v[40:41], v[40:41], v[56:57]
  v_pk_mul_f32 v[42:43], v[42:43], v[58:59]
  v_pk_mul_f32 v[44:45], v[44:45], v[60:61]
  v_pk_mul_f32 v[46:47], v[46:47], v[62:63]
  v_pk_add_f32 v[12:13], v[12:13], v[112:113]
  v_pk_fma_f32 v[14:15], v[112:113], v[112:113], v[14:15]
  v_pk_add_f32 v[12:13], v[12:13], v[114:115]
  v_pk_fma_f32 v[14:15], v[114:115], v[114:115], v[14:15]
  v_pk_fma_f32 v[48:49], v[16:17], v[16:17], s[20:21] neg_lo:[1,0,1] neg_hi:[1,0,1]
  v_pk_fma_f32 v[50:51], v[18:19], v[18:19], s[20:21] neg_lo:[1,0,1] neg_hi:[1,0,1]
  v_pk_fma_f32 v[52:53], v[20:21], v[20:21], s[20:21] neg_lo:[1,0,1] neg_hi:[1,0,1]
  v_pk_fma_f32 v[54:55], v[22:23], v[22:23], s[20:21] neg_lo:[1,0,1] neg_hi:[1,0,1]
  v_pk_fma_f32 v[56:57], v[24:25], v[24:25], s[20:21] neg_lo:[1,0,1] neg_hi:[1,0,1]
  v_pk_fma_f32 v[58:59], v[26:27], v[26:27], s[20:21] neg_lo:[1,0,1] neg_hi:[1,0,1]
  v_pk_fma_f32 v[60:61], v[28:29], v[28:29], s[20:21] neg_lo:[1,0,1] neg_hi:[1,0,1]
  v_pk_fma_f32 v[62:63], v[30:31], v[30:31], s[20:21] neg_lo:[1,0,1] neg_hi:[1,0,1]
  v_pk_mul_f32 v[48:49], v[16:17], v[48:49]
  v_pk_mul_f32 v[50:51], v[18:19], v[50:51]
  v_pk_mul_f32 v[52:53], v[20:21], v[52:53]
  v_pk_mul_f32 v[54:55], v[22:23], v[54:55]
  v_pk_mul_f32 v[56:57], v[24:25], v[56:57]
  v_pk_mul_f32 v[58:59], v[26:27], v[58:59]
  v_pk_mul_f32 v[60:61], v[28:29], v[60:61]
  v_pk_mul_f32 v[62:63], v[30:31], v[62:63]
  v_mfma_f32_16x16x32_bf16 v[116:119], v[216:219], v[220:223], 0
  v_cvt_pk_bf16_f32 v184, v32, v33
  v_cvt_pk_bf16_f32 v185, v34, v35
  v_mfma_f32_16x16x32_bf16 v[116:119], v[224:227], v[228:231], v[116:119]
  v_cvt_pk_bf16_f32 v186, v36, v37
  v_cvt_pk_bf16_f32 v187, v38, v39
  v_mfma_f32_16x16x32_bf16 v[116:119], v[232:235], v[236:239], v[116:119]
  ds_read_b128 v[216:219], v3 offset:800
  ds_read_b128 v[220:223], v4 offset:32
  v_mfma_f32_32x32x16_bf16 v[64:79], v[192:195], v[184:187], v[64:79]
  ds_read_b128 v[224:227], v3 offset:5600
  ds_read_b128 v[228:231], v4 offset:224
  v_cvt_pk_bf16_f32 v188, v40, v41
  v_cvt_pk_bf16_f32 v189, v42, v43
  v_cvt_pk_bf16_f32 v190, v44, v45
  v_cvt_pk_bf16_f32 v191, v46, v47
  v_mfma_f32_32x32x16_bf16 v[80:95], v[196:199], v[184:187], v[80:95]
  ds_read_b128 v[232:235], v3 offset:10400
  ds_read_b128 v[236:239], v4 offset:416
  v_exp_f32 v48, v48
  v_exp_f32 v49, v49
  v_mfma_f32_32x32x16_bf16 v[96:111], v[200:203], v[184:187], v[96:111]
  v_exp_f32 v50, v50
  v_exp_f32 v51, v51
  v_exp_f32_e64 v52, v52
  v_mfma_f32_32x32x16_bf16 v[64:79], v[204:207], v[188:191], v[64:79]
  v_exp_f32 v53, v53
  v_exp_f32 v54, v54
  v_exp_f32_e64 v55, v55
  v_mfma_f32_32x32x16_bf16 v[80:95], v[208:211], v[188:191], v[80:95]
  v_exp_f32 v56, v56
  v_exp_f32 v57, v57
  v_exp_f32_e64 v58, v58
  v_mfma_f32_32x32x16_bf16 v[96:111], v[212:215], v[188:191], v[96:111]
  s_waitcnt lgkmcnt(0)
  v_exp_f32 v59, v59
  v_exp_f32 v60, v60
  v_exp_f32 v61, v61
  v_exp_f32 v62, v62
  v_exp_f32 v63, v63
  v_pk_add_f32 v[12:13], v[12:13], v[116:117]
  v_pk_fma_f32 v[14:15], v[116:117], v[116:117], v[14:15]
  v_pk_add_f32 v[12:13], v[12:13], v[118:119]
  v_pk_fma_f32 v[14:15], v[118:119], v[118:119], v[14:15]
  v_pk_fma_f32 v[48:49], v[48:49], s[22:23], s[22:23]
  v_pk_fma_f32 v[50:51], v[50:51], s[22:23], s[22:23]
  v_pk_fma_f32 v[52:53], v[52:53], s[22:23], s[22:23]
  v_pk_fma_f32 v[54:55], v[54:55], s[22:23], s[22:23]
  v_pk_fma_f32 v[56:57], v[56:57], s[22:23], s[22:23]
  v_pk_fma_f32 v[58:59], v[58:59], s[22:23], s[22:23]
  v_pk_fma_f32 v[60:61], v[60:61], s[22:23], s[22:23]
  v_pk_fma_f32 v[62:63], v[62:63], s[22:23], s[22:23]
  v_mfma_f32_32x32x16_bf16 v[32:47], a[192:195], v[160:163], 0
  ds_read_b128 v[192:195], v0 offset:49152
  ds_read_b128 v[196:199], v0 offset:50176
  v_rcp_f32 v48, v48
  v_rcp_f32 v49, v49
  v_mfma_f32_16x16x32_bf16 v[120:123], v[216:219], v[220:223], 0
  ds_read_b128 v[216:219], v3 offset:1200
  ds_read_b128 v[220:223], v4 offset:48
  v_mfma_f32_32x32x16_bf16 v[32:47], a[196:199], v[164:167], v[32:47]
  ds_read_b128 v[200:203], v0 offset:51200
  ds_read_b128 v[204:207], v0 offset:52224
  v_rcp_f32 v50, v50
  v_rcp_f32 v51, v51
  v_mfma_f32_16x16x32_bf16 v[120:123], v[224:227], v[228:231], v[120:123]
  ds_read_b128 v[224:227], v3 offset:6000
  ds_read_b128 v[228:231], v4 offset:240
  v_mfma_f32_32x32x16_bf16 v[32:47], a[200:203], v[168:171], v[32:47]
  ds_read_b128 v[208:211], v0 offset:53248
  ds_read_b128 v[212:215], v0 offset:54272
  v_rcp_f32 v52, v52
  v_rcp_f32 v53, v53
  v_mfma_f32_16x16x32_bf16 v[120:123], v[232:235], v[236:239], v[120:123]
  ds_read_b128 v[232:235], v3 offset:10800
  ds_read_b128 v[236:239], v4 offset:432
  v_mfma_f32_32x32x16_bf16 v[32:47], a[204:207], v[172:175], v[32:47]
  v_rcp_f32 v54, v54
  v_rcp_f32 v55, v55
  v_rcp_f32_e64 v56, v56
  v_mfma_f32_32x32x16_bf16 v[32:47], a[208:211], v[176:179], v[32:47]
  v_rcp_f32 v57, v57
  v_rcp_f32 v58, v58
  v_rcp_f32_e64 v59, v59
  v_mfma_f32_32x32x16_bf16 v[32:47], a[212:215], v[180:183], v[32:47]
  s_waitcnt lgkmcnt(0)
  v_rcp_f32 v60, v60
  v_rcp_f32 v61, v61
  v_rcp_f32 v62, v62
  v_rcp_f32_e64 v63, v63
  v_pk_mul_f32 v[16:17], v[16:17], v[48:49]
  v_pk_mul_f32 v[18:19], v[18:19], v[50:51]
  v_pk_mul_f32 v[20:21], v[20:21], v[52:53]
  v_pk_mul_f32 v[22:23], v[22:23], v[54:55]
  v_pk_mul_f32 v[24:25], v[24:25], v[56:57]
  v_pk_mul_f32 v[26:27], v[26:27], v[58:59]
  v_pk_mul_f32 v[28:29], v[28:29], v[60:61]
  v_pk_mul_f32 v[30:31], v[30:31], v[62:63]
  v_pk_add_f32 v[12:13], v[12:13], v[120:121]
  v_pk_fma_f32 v[14:15], v[120:121], v[120:121], v[14:15]
  v_pk_add_f32 v[12:13], v[12:13], v[122:123]
  v_pk_fma_f32 v[14:15], v[122:123], v[122:123], v[14:15]
  v_pk_fma_f32 v[48:49], v[32:33], v[32:33], s[20:21] neg_lo:[1,0,1] neg_hi:[1,0,1]
  v_pk_fma_f32 v[50:51], v[34:35], v[34:35], s[20:21] neg_lo:[1,0,1] neg_hi:[1,0,1]
  v_pk_fma_f32 v[52:53], v[36:37], v[36:37], s[20:21] neg_lo:[1,0,1] neg_hi:[1,0,1]
  v_pk_fma_f32 v[54:55], v[38:39], v[38:39], s[20:21] neg_lo:[1,0,1] neg_hi:[1,0,1]
  v_pk_fma_f32 v[56:57], v[40:41], v[40:41], s[20:21] neg_lo:[1,0,1] neg_hi:[1,0,1]
  v_pk_fma_f32 v[58:59], v[42:43], v[42:43], s[20:21] neg_lo:[1,0,1] neg_hi:[1,0,1]
  v_pk_fma_f32 v[60:61], v[44:45], v[44:45], s[20:21] neg_lo:[1,0,1] neg_hi:[1,0,1]
  v_pk_fma_f32 v[62:63], v[46:47], v[46:47], s[20:21] neg_lo:[1,0,1] neg_hi:[1,0,1]
  v_pk_mul_f32 v[48:49], v[32:33], v[48:49]
  v_pk_mul_f32 v[50:51], v[34:35], v[50:51]
  v_pk_mul_f32 v[52:53], v[36:37], v[52:53]
  v_pk_mul_f32 v[54:55], v[38:39], v[54:55]
  v_pk_mul_f32 v[56:57], v[40:41], v[56:57]
  v_pk_mul_f32 v[58:59], v[42:43], v[58:59]
  v_pk_mul_f32 v[60:61], v[44:45], v[60:61]
  v_pk_mul_f32 v[62:63], v[46:47], v[62:63]
  v_mfma_f32_16x16x32_bf16 v[124:127], v[216:219], v[220:223], 0
  v_cvt_pk_bf16_f32 v184, v16, v17
  v_cvt_pk_bf16_f32 v185, v18, v19
  v_mfma_f32_16x16x32_bf16 v[124:127], v[224:227], v[228:231], v[124:127]
  v_cvt_pk_bf16_f32 v186, v20, v21
  v_cvt_pk_bf16_f32 v187, v22, v23
  v_mfma_f32_16x16x32_bf16 v[124:127], v[232:235], v[236:239], v[124:127]
  ds_read_b128 v[216:219], v3 offset:1600
  ds_read_b128 v[220:223], v4 offset:64
  v_mfma_f32_32x32x16_bf16 v[64:79], v[192:195], v[184:187], v[64:79]
  ds_read_b128 v[224:227], v3 offset:6400
  ds_read_b128 v[228:231], v4 offset:256
  v_cvt_pk_bf16_f32 v188, v24, v25
  v_cvt_pk_bf16_f32 v189, v26, v27
  v_cvt_pk_bf16_f32 v190, v28, v29
  v_cvt_pk_bf16_f32 v191, v30, v31
  v_mfma_f32_32x32x16_bf16 v[80:95], v[196:199], v[184:187], v[80:95]
  ds_read_b128 v[232:235], v3 offset:11200
  ds_read_b128 v[236:239], v4 offset:448
  v_exp_f32 v48, v48
  v_exp_f32 v49, v49
  v_mfma_f32_32x32x16_bf16 v[96:111], v[200:203], v[184:187], v[96:111]
  v_exp_f32 v50, v50
  v_exp_f32 v51, v51
  v_exp_f32_e64 v52, v52
  v_mfma_f32_32x32x16_bf16 v[64:79], v[204:207], v[188:191], v[64:79]
  v_exp_f32 v53, v53
  v_exp_f32 v54, v54
  v_exp_f32_e64 v55, v55
  v_mfma_f32_32x32x16_bf16 v[80:95], v[208:211], v[188:191], v[80:95]
  v_exp_f32 v56, v56
  v_exp_f32 v57, v57
  v_exp_f32_e64 v58, v58
  v_mfma_f32_32x32x16_bf16 v[96:111], v[212:215], v[188:191], v[96:111]
  s_waitcnt lgkmcnt(0)
  v_exp_f32 v59, v59
  v_exp_f32 v60, v60
  v_exp_f32 v61, v61
  v_exp_f32 v62, v62
  v_exp_f32 v63, v63
  v_pk_add_f32 v[12:13], v[12:13], v[124:125]
  v_pk_fma_f32 v[14:15], v[124:125], v[124:125], v[14:15]
  v_pk_add_f32 v[12:13], v[12:13], v[126:127]
  v_pk_fma_f32 v[14:15], v[126:127], v[126:127], v[14:15]
  v_pk_fma_f32 v[48:49], v[48:49], s[22:23], s[22:23]
  v_pk_fma_f32 v[50:51], v[50:51], s[22:23], s[22:23]
  v_pk_fma_f32 v[52:53], v[52:53], s[22:23], s[22:23]
  v_pk_fma_f32 v[54:55], v[54:55], s[22:23], s[22:23]
  v_pk_fma_f32 v[56:57], v[56:57], s[22:23], s[22:23]
  v_pk_fma_f32 v[58:59], v[58:59], s[22:23], s[22:23]
  v_pk_fma_f32 v[60:61], v[60:61], s[22:23], s[22:23]
  v_pk_fma_f32 v[62:63], v[62:63], s[22:23], s[22:23]
  v_mfma_f32_32x32x16_bf16 v[16:31], a[216:219], v[160:163], 0
  ds_read_b128 v[192:195], v0 offset:55296
  ds_read_b128 v[196:199], v0 offset:56320
  v_rcp_f32 v48, v48
  v_rcp_f32 v49, v49
  v_mfma_f32_16x16x32_bf16 v[128:131], v[216:219], v[220:223], 0
  ds_read_b128 v[216:219], v3 offset:2000
  ds_read_b128 v[220:223], v4 offset:80
  v_mfma_f32_32x32x16_bf16 v[16:31], a[220:223], v[164:167], v[16:31]
  ds_read_b128 v[200:203], v0 offset:57344
  ds_read_b128 v[204:207], v0 offset:58368
  v_rcp_f32 v50, v50
  v_rcp_f32 v51, v51
  v_mfma_f32_16x16x32_bf16 v[128:131], v[224:227], v[228:231], v[128:131]
  ds_read_b128 v[224:227], v3 offset:6800
  ds_read_b128 v[228:231], v4 offset:272
  v_mfma_f32_32x32x16_bf16 v[16:31], a[224:227], v[168:171], v[16:31]
  ds_read_b128 v[208:211], v0 offset:59392
  ds_read_b128 v[212:215], v0 offset:60416
  v_rcp_f32 v52, v52
  v_rcp_f32 v53, v53
  v_mfma_f32_16x16x32_bf16 v[128:131], v[232:235], v[236:239], v[128:131]
  ds_read_b128 v[232:235], v3 offset:11600
  ds_read_b128 v[236:239], v4 offset:464
  v_mfma_f32_32x32x16_bf16 v[16:31], a[228:231], v[172:175], v[16:31]
  v_rcp_f32 v54, v54
  v_rcp_f32 v55, v55
  v_rcp_f32_e64 v56, v56
  v_mfma_f32_32x32x16_bf16 v[16:31], a[232:235], v[176:179], v[16:31]
  v_rcp_f32 v57, v57
  v_rcp_f32 v58, v58
  v_rcp_f32_e64 v59, v59
  v_mfma_f32_32x32x16_bf16 v[16:31], a[236:239], v[180:183], v[16:31]
  s_waitcnt lgkmcnt(0)
  v_rcp_f32 v60, v60
  v_rcp_f32 v61, v61
  v_rcp_f32 v62, v62
  v_rcp_f32_e64 v63, v63
  v_pk_mul_f32 v[32:33], v[32:33], v[48:49]
  v_pk_mul_f32 v[34:35], v[34:35], v[50:51]
  v_pk_mul_f32 v[36:37], v[36:37], v[52:53]
  v_pk_mul_f32 v[38:39], v[38:39], v[54:55]
  v_pk_mul_f32 v[40:41], v[40:41], v[56:57]
  v_pk_mul_f32 v[42:43], v[42:43], v[58:59]
  v_pk_mul_f32 v[44:45], v[44:45], v[60:61]
  v_pk_mul_f32 v[46:47], v[46:47], v[62:63]
  v_pk_add_f32 v[12:13], v[12:13], v[128:129]
  v_pk_fma_f32 v[14:15], v[128:129], v[128:129], v[14:15]
  v_pk_add_f32 v[12:13], v[12:13], v[130:131]
  v_pk_fma_f32 v[14:15], v[130:131], v[130:131], v[14:15]
  v_pk_fma_f32 v[48:49], v[16:17], v[16:17], s[20:21] neg_lo:[1,0,1] neg_hi:[1,0,1]
  v_pk_fma_f32 v[50:51], v[18:19], v[18:19], s[20:21] neg_lo:[1,0,1] neg_hi:[1,0,1]
  v_pk_fma_f32 v[52:53], v[20:21], v[20:21], s[20:21] neg_lo:[1,0,1] neg_hi:[1,0,1]
  v_pk_fma_f32 v[54:55], v[22:23], v[22:23], s[20:21] neg_lo:[1,0,1] neg_hi:[1,0,1]
  v_pk_fma_f32 v[56:57], v[24:25], v[24:25], s[20:21] neg_lo:[1,0,1] neg_hi:[1,0,1]
  v_pk_fma_f32 v[58:59], v[26:27], v[26:27], s[20:21] neg_lo:[1,0,1] neg_hi:[1,0,1]
  v_pk_fma_f32 v[60:61], v[28:29], v[28:29], s[20:21] neg_lo:[1,0,1] neg_hi:[1,0,1]
  v_pk_fma_f32 v[62:63], v[30:31], v[30:31], s[20:21] neg_lo:[1,0,1] neg_hi:[1,0,1]
  v_pk_mul_f32 v[48:49], v[16:17], v[48:49]
  v_pk_mul_f32 v[50:51], v[18:19], v[50:51]
  v_pk_mul_f32 v[52:53], v[20:21], v[52:53]
  v_pk_mul_f32 v[54:55], v[22:23], v[54:55]
  v_pk_mul_f32 v[56:57], v[24:25], v[56:57]
  v_pk_mul_f32 v[58:59], v[26:27], v[58:59]
  v_pk_mul_f32 v[60:61], v[28:29], v[60:61]
  v_pk_mul_f32 v[62:63], v[30:31], v[62:63]
  v_mfma_f32_16x16x32_bf16 v[132:135], v[216:219], v[220:223], 0
  v_cvt_pk_bf16_f32 v184, v32, v33
  v_cvt_pk_bf16_f32 v185, v34, v35
  v_mfma_f32_16x16x32_bf16 v[132:135], v[224:227], v[228:231], v[132:135]
  v_cvt_pk_bf16_f32 v186, v36, v37
  v_cvt_pk_bf16_f32 v187, v38, v39
  v_mfma_f32_16x16x32_bf16 v[132:135], v[232:235], v[236:239], v[132:135]
  ds_read_b128 v[216:219], v0 offset:12288
  ds_read_b128 v[220:223], v0 offset:13312
  v_mfma_f32_32x32x16_bf16 v[64:79], v[192:195], v[184:187], v[64:79]
  ds_read_b128 v[224:227], v0 offset:14336
  ds_read_b128 v[228:231], v0 offset:15360
  v_cvt_pk_bf16_f32 v188, v40, v41
  v_cvt_pk_bf16_f32 v189, v42, v43
  v_cvt_pk_bf16_f32 v190, v44, v45
  v_cvt_pk_bf16_f32 v191, v46, v47
  v_mfma_f32_32x32x16_bf16 v[80:95], v[196:199], v[184:187], v[80:95]
  ds_read_b128 v[232:235], v0 offset:16384
  ds_read_b128 v[236:239], v0 offset:17408
  v_exp_f32 v48, v48
  v_exp_f32 v49, v49
  v_mfma_f32_32x32x16_bf16 v[96:111], v[200:203], v[184:187], v[96:111]
  v_exp_f32 v50, v50
  v_exp_f32 v51, v51
  v_exp_f32_e64 v52, v52
  v_mfma_f32_32x32x16_bf16 v[64:79], v[204:207], v[188:191], v[64:79]
  s_mov_b32 s28, s34
  v_exp_f32 v53, v53
  v_exp_f32 v54, v54
  v_exp_f32 v55, v55
  v_mfma_f32_32x32x16_bf16 v[80:95], v[208:211], v[188:191], v[80:95]
  s_add_u32 s34, s34, 0x60000
  v_exp_f32 v56, v56
  v_exp_f32 v57, v57
  v_exp_f32_e64 v58, v58
  v_mfma_f32_32x32x16_bf16 v[96:111], v[212:215], v[188:191], v[96:111]
  s_waitcnt lgkmcnt(0)
  v_exp_f32 v59, v59
  v_exp_f32 v60, v60
  v_exp_f32 v61, v61
  v_exp_f32 v62, v62
  v_exp_f32 v63, v63
  v_pk_add_f32 v[12:13], v[12:13], v[132:133]
  v_pk_fma_f32 v[14:15], v[132:133], v[132:133], v[14:15]
  v_pk_add_f32 v[12:13], v[12:13], v[134:135]
  v_pk_fma_f32 v[14:15], v[134:135], v[134:135], v[14:15]
  v_pk_fma_f32 v[48:49], v[48:49], s[22:23], s[22:23]
  v_pk_fma_f32 v[50:51], v[50:51], s[22:23], s[22:23]
  v_pk_fma_f32 v[52:53], v[52:53], s[22:23], s[22:23]
  v_pk_fma_f32 v[54:55], v[54:55], s[22:23], s[22:23]
  v_pk_fma_f32 v[56:57], v[56:57], s[22:23], s[22:23]
  v_pk_fma_f32 v[58:59], v[58:59], s[22:23], s[22:23]
  v_pk_fma_f32 v[60:61], v[60:61], s[22:23], s[22:23]
  v_pk_fma_f32 v[62:63], v[62:63], s[22:23], s[22:23]
  v_mfma_f32_32x32x16_bf16 v[32:47], v[216:219], v[160:163], 0
  ds_read_b128 v[192:195], v0 offset:61440
  ds_read_b128 v[196:199], v0 offset:62464
  v_rcp_f32 v48, v48
  v_rcp_f32 v49, v49
  v_add_f32_e64 v12, v12, v13
  v_mfma_f32_32x32x16_bf16 v[32:47], v[220:223], v[164:167], v[32:47]
  ds_read_b128 v[200:203], v0 offset:63488
  ds_read_b128 v[204:207], v0 offset:64512
  v_rcp_f32 v50, v50
  v_add_f32 v14, v14, v15
  v_rcp_f32_e64 v51, v51
  v_mfma_f32_32x32x16_bf16 v[32:47], v[224:227], v[168:171], v[32:47]
  ds_read_b128 v[208:211], v1
  ds_read_b128 v[212:215], v1 offset:1024
  v_permlane32_swap_b32 v12, v14
  v_rcp_f32 v52, v52
  v_add_f32 v12, v12, v14
  v_rcp_f32 v53, v53
  v_mfma_f32_32x32x16_bf16 v[32:47], v[228:231], v[172:175], v[32:47]
  v_mov_b32 v14, v12
  v_rcp_f32 v54, v54
  s_nop 0
  v_permlane32_swap_b32 v12, v14
  v_rcp_f32 v55, v55
  v_mul_f32 v12, s24, v12
  v_mfma_f32_32x32x16_bf16 v[32:47], v[232:235], v[176:179], v[32:47]
  v_rcp_f32 v56, v56
  v_rcp_f32 v57, v57
  v_mul_f32 v13, s24, v14
  v_rcp_f32 v58, v58
  v_fma_f32 v13, -v12, v12, v13
  v_mfma_f32_32x32x16_bf16 v[32:47], v[236:239], v[180:183], v[32:47]
  s_waitcnt lgkmcnt(0)
  v_rcp_f32 v59, v59
  v_max_f32 v13, 0, v13
  v_rcp_f32 v60, v60
  v_add_f32 v13, s25, v13
  v_rcp_f32 v61, v61
  v_rsq_f32 v13, v13
  v_rcp_f32 v62, v62
  v_mul_f32 v14, s22, v13
  v_rcp_f32 v63, v63
  v_mul_f32_e64 v12, -v12, v14
  v_pk_mul_f32 v[16:17], v[16:17], v[48:49]
  v_pk_mul_f32 v[18:19], v[18:19], v[50:51]
  v_pk_mul_f32 v[20:21], v[20:21], v[52:53]
  v_pk_mul_f32 v[22:23], v[22:23], v[54:55]
  v_pk_mul_f32 v[24:25], v[24:25], v[56:57]
  v_pk_mul_f32 v[26:27], v[26:27], v[58:59]
  v_pk_mul_f32 v[28:29], v[28:29], v[60:61]
  v_pk_mul_f32 v[30:31], v[30:31], v[62:63]
  v_pk_fma_f32 v[112:113], v[112:113], v[14:15], v[12:13] op_sel_hi:[1,0,0]
  v_pk_fma_f32 v[114:115], v[114:115], v[14:15], v[12:13] op_sel_hi:[1,0,0]
  v_pk_fma_f32 v[116:117], v[116:117], v[14:15], v[12:13] op_sel_hi:[1,0,0]
  v_pk_fma_f32 v[118:119], v[118:119], v[14:15], v[12:13] op_sel_hi:[1,0,0]
  v_pk_fma_f32 v[120:121], v[120:121], v[14:15], v[12:13] op_sel_hi:[1,0,0]
  v_pk_fma_f32 v[122:123], v[122:123], v[14:15], v[12:13] op_sel_hi:[1,0,0]
  v_pk_fma_f32 v[124:125], v[124:125], v[14:15], v[12:13] op_sel_hi:[1,0,0]
  v_pk_fma_f32 v[126:127], v[126:127], v[14:15], v[12:13] op_sel_hi:[1,0,0]
  v_pk_fma_f32 v[128:129], v[128:129], v[14:15], v[12:13] op_sel_hi:[1,0,0]
  v_pk_fma_f32 v[130:131], v[130:131], v[14:15], v[12:13] op_sel_hi:[1,0,0]
  v_pk_fma_f32 v[132:133], v[132:133], v[14:15], v[12:13] op_sel_hi:[1,0,0]
  v_pk_fma_f32 v[134:135], v[134:135], v[14:15], v[12:13] op_sel_hi:[1,0,0]
  v_pk_fma_f32 v[136:137], v[136:137], v[14:15], v[12:13] op_sel_hi:[1,0,0]
  v_pk_fma_f32 v[138:139], v[138:139], v[14:15], v[12:13] op_sel_hi:[1,0,0]
  v_pk_fma_f32 v[140:141], v[140:141], v[14:15], v[12:13] op_sel_hi:[1,0,0]
  v_pk_fma_f32 v[142:143], v[142:143], v[14:15], v[12:13] op_sel_hi:[1,0,0]
  v_pk_fma_f32 v[144:145], v[144:145], v[14:15], v[12:13] op_sel_hi:[1,0,0]
  v_pk_fma_f32 v[146:147], v[146:147], v[14:15], v[12:13] op_sel_hi:[1,0,0]
  v_pk_fma_f32 v[148:149], v[148:149], v[14:15], v[12:13] op_sel_hi:[1,0,0]
  v_pk_fma_f32 v[150:151], v[150:151], v[14:15], v[12:13] op_sel_hi:[1,0,0]
  v_pk_fma_f32 v[152:153], v[152:153], v[14:15], v[12:13] op_sel_hi:[1,0,0]
  v_pk_fma_f32 v[154:155], v[154:155], v[14:15], v[12:13] op_sel_hi:[1,0,0]
  v_pk_fma_f32 v[156:157], v[156:157], v[14:15], v[12:13] op_sel_hi:[1,0,0]
  v_pk_fma_f32 v[158:159], v[158:159], v[14:15], v[12:13] op_sel_hi:[1,0,0]
  v_pk_fma_f32 v[48:49], v[32:33], v[32:33], s[20:21] neg_lo:[1,0,1] neg_hi:[1,0,1]
  v_pk_fma_f32 v[50:51], v[34:35], v[34:35], s[20:21] neg_lo:[1,0,1] neg_hi:[1,0,1]
  v_pk_fma_f32 v[52:53], v[36:37], v[36:37], s[20:21] neg_lo:[1,0,1] neg_hi:[1,0,1]
  v_pk_fma_f32 v[54:55], v[38:39], v[38:39], s[20:21] neg_lo:[1,0,1] neg_hi:[1,0,1]
  v_pk_fma_f32 v[56:57], v[40:41], v[40:41], s[20:21] neg_lo:[1,0,1] neg_hi:[1,0,1]
  v_pk_fma_f32 v[58:59], v[42:43], v[42:43], s[20:21] neg_lo:[1,0,1] neg_hi:[1,0,1]
  v_pk_fma_f32 v[60:61], v[44:45], v[44:45], s[20:21] neg_lo:[1,0,1] neg_hi:[1,0,1]
  v_pk_fma_f32 v[62:63], v[46:47], v[46:47], s[20:21] neg_lo:[1,0,1] neg_hi:[1,0,1]
  v_pk_mul_f32 v[48:49], v[32:33], v[48:49]
  v_pk_mul_f32 v[50:51], v[34:35], v[50:51]
  v_pk_mul_f32 v[52:53], v[36:37], v[52:53]
  v_pk_mul_f32 v[54:55], v[38:39], v[54:55]
  v_pk_mul_f32 v[56:57], v[40:41], v[56:57]
  v_cvt_pk_bf16_f32 v184, v16, v17
  v_cvt_pk_bf16_f32 v185, v18, v19
  v_cvt_pk_bf16_f32 v186, v20, v21
  v_cvt_pk_bf16_f32 v187, v22, v23
  v_pk_mul_f32 v[58:59], v[42:43], v[58:59]
  v_pk_mul_f32 v[60:61], v[44:45], v[60:61]
  v_pk_mul_f32 v[62:63], v[46:47], v[62:63]
  v_mfma_f32_32x32x16_bf16 v[64:79], v[192:195], v[184:187], v[64:79]
  ds_read_b128 v[216:219], v0 offset:18432
  ds_read_b128 v[220:223], v0 offset:19456
  v_cvt_pk_bf16_f32 v188, v24, v25
  v_cvt_pk_bf16_f32 v189, v26, v27
  v_cvt_pk_bf16_f32 v190, v28, v29
  v_cvt_pk_bf16_f32 v191, v30, v31
  v_exp_f32_e64 v48, v48
  v_cndmask_b32 v159, v159, v250, s[12:13]
  v_mfma_f32_32x32x16_bf16 v[80:95], v[196:199], v[184:187], v[80:95]
  ds_read_b128 v[224:227], v0 offset:20480
  ds_read_b128 v[228:231], v0 offset:21504
  v_exp_f32_e64 v49, v49
  v_cvt_pk_bf16_f32 v160, v112, v113
  v_cvt_pk_bf16_f32 v161, v114, v115
  v_exp_f32_e64 v50, v50
  v_cvt_pk_bf16_f32 v162, v116, v117
  v_mfma_f32_32x32x16_bf16 v[96:111], v[200:203], v[184:187], v[96:111]
  ds_read_b128 v[232:235], v0 offset:22528
  ds_read_b128 v[236:239], v0 offset:23552
  v_exp_f32_e64 v51, v51
  v_cvt_pk_bf16_f32 v163, v118, v119
  v_cvt_pk_bf16_f32 v164, v120, v121
  v_exp_f32_e64 v52, v52
  v_cvt_pk_bf16_f32 v165, v122, v123
  v_mfma_f32_32x32x16_bf16 v[64:79], v[204:207], v[188:191], v[64:79]
  v_exp_f32_e64 v53, v53
  v_cvt_pk_bf16_f32 v166, v124, v125
  v_cvt_pk_bf16_f32 v167, v126, v127
  v_exp_f32_e64 v54, v54
  v_cvt_pk_bf16_f32 v168, v128, v129
  v_exp_f32_e64 v55, v55
  v_cvt_pk_bf16_f32 v169, v130, v131
  v_cvt_pk_bf16_f32 v170, v132, v133
  v_mfma_f32_32x32x16_bf16 v[80:95], v[208:211], v[188:191], v[80:95]
  v_exp_f32_e64 v56, v56
  v_cvt_pk_bf16_f32 v171, v134, v135
  v_cvt_pk_bf16_f32 v172, v136, v137
  v_exp_f32_e64 v57, v57
  v_cvt_pk_bf16_f32 v173, v138, v139
  v_exp_f32_e64 v58, v58
  v_cvt_pk_bf16_f32 v174, v140, v141
  v_cvt_pk_bf16_f32 v175, v142, v143
  v_mfma_f32_32x32x16_bf16 v[96:111], v[212:215], v[188:191], v[96:111]
  s_waitcnt lgkmcnt(0)
  v_exp_f32 v59, v59
  v_cvt_pk_bf16_f32 v176, v144, v145
  v_exp_f32_e64 v60, v60
  v_cvt_pk_bf16_f32 v177, v146, v147
  v_cvt_pk_bf16_f32 v178, v148, v149
  v_exp_f32_e64 v61, v61
  v_cvt_pk_bf16_f32 v179, v150, v151
  v_exp_f32_e64 v62, v62
  v_cvt_pk_bf16_f32 v180, v152, v153
  v_cvt_pk_bf16_f32 v181, v154, v155
  v_exp_f32_e64 v63, v63
  v_cvt_pk_bf16_f32 v182, v156, v157
  v_cvt_pk_bf16_f32 v183, v158, v159
  v_pk_fma_f32 v[48:49], v[48:49], s[22:23], s[22:23]
  v_pk_fma_f32 v[50:51], v[50:51], s[22:23], s[22:23]
  v_pk_fma_f32 v[52:53], v[52:53], s[22:23], s[22:23]
  v_pk_fma_f32 v[54:55], v[54:55], s[22:23], s[22:23]
  v_pk_fma_f32 v[56:57], v[56:57], s[22:23], s[22:23]
  v_pk_fma_f32 v[58:59], v[58:59], s[22:23], s[22:23]
  v_pk_fma_f32 v[60:61], v[60:61], s[22:23], s[22:23]
  v_pk_fma_f32 v[62:63], v[62:63], s[22:23], s[22:23]
  s_mov_b32 s26, 6
  .p2align 6
  s_waitcnt vmcnt(0)
S_loop:
  v_mfma_f32_32x32x16_bf16 v[16:31], v[216:219], v[160:163], 0
  s_nop 0
  ds_read_b128 v[192:195], v1 offset:2048
  ds_read_b128 v[196:199], v1 offset:3072
  ds_read_b128 v[200:203], v1 offset:4096
  v_rcp_f32 v48, v48
  v_rcp_f32 v49, v49
  v_mfma_f32_32x32x16_bf16 v[16:31], v[220:223], v[164:167], v[16:31]
  ds_read_b128 v[204:207], v1 offset:5120
  ds_read_b128 v[208:211], v1 offset:6144
  ds_read_b128 v[212:215], v1 offset:7168
  v_rcp_f32 v50, v50
  v_rcp_f32 v51, v51
  v_mfma_f32_32x32x16_bf16 v[16:31], v[224:227], v[168:171], v[16:31]
  ds_read_b128 v[136:139], v5
  ds_read_b128 v[140:143], v5 offset:32
  ds_read_b128 v[144:147], v5 offset:64
  v_rcp_f32 v52, v52
  v_rcp_f32 v53, v53
  v_mfma_f32_32x32x16_bf16 v[16:31], v[228:231], v[172:175], v[16:31]
  ds_read_b128 v[148:151], v5 offset:96
  ds_read_b128 v[152:155], v5 offset:128
  ds_read_b128 v[156:159], v5 offset:160
  v_rcp_f32 v54, v54
  v_rcp_f32 v55, v55
  v_mfma_f32_32x32x16_bf16 v[16:31], v[232:235], v[176:179], v[16:31]
  v_rcp_f32 v56, v56
  v_rcp_f32 v57, v57
  v_rcp_f32_e64 v58, v58
  v_mfma_f32_32x32x16_bf16 v[16:31], v[236:239], v[180:183], v[16:31]
  s_waitcnt lgkmcnt(0)
  v_rcp_f32 v59, v59
  v_rcp_f32 v60, v60
  v_rcp_f32 v61, v61
  v_rcp_f32 v62, v62
  v_rcp_f32 v63, v63
  v_pk_mul_f32 v[32:33], v[32:33], v[48:49]
  v_pk_mul_f32 v[34:35], v[34:35], v[50:51]
  v_pk_mul_f32 v[36:37], v[36:37], v[52:53]
  v_pk_mul_f32 v[38:39], v[38:39], v[54:55]
  v_pk_mul_f32 v[40:41], v[40:41], v[56:57]
  v_pk_mul_f32 v[42:43], v[42:43], v[58:59]
  v_pk_mul_f32 v[44:45], v[44:45], v[60:61]
  v_pk_mul_f32 v[46:47], v[46:47], v[62:63]
  v_pk_fma_f32 v[48:49], v[16:17], v[16:17], s[20:21] neg_lo:[1,0,1] neg_hi:[1,0,1]
  v_pk_fma_f32 v[50:51], v[18:19], v[18:19], s[20:21] neg_lo:[1,0,1] neg_hi:[1,0,1]
  v_pk_fma_f32 v[52:53], v[20:21], v[20:21], s[20:21] neg_lo:[1,0,1] neg_hi:[1,0,1]
  v_pk_fma_f32 v[54:55], v[22:23], v[22:23], s[20:21] neg_lo:[1,0,1] neg_hi:[1,0,1]
  v_pk_fma_f32 v[56:57], v[24:25], v[24:25], s[20:21] neg_lo:[1,0,1] neg_hi:[1,0,1]
  v_pk_fma_f32 v[58:59], v[26:27], v[26:27], s[20:21] neg_lo:[1,0,1] neg_hi:[1,0,1]
  v_pk_fma_f32 v[60:61], v[28:29], v[28:29], s[20:21] neg_lo:[1,0,1] neg_hi:[1,0,1]
  v_pk_fma_f32 v[62:63], v[30:31], v[30:31], s[20:21] neg_lo:[1,0,1] neg_hi:[1,0,1]
  v_pk_mul_f32 v[48:49], v[16:17], v[48:49]
  v_pk_mul_f32 v[50:51], v[18:19], v[50:51]
  v_pk_mul_f32 v[52:53], v[20:21], v[52:53]
  v_pk_mul_f32 v[54:55], v[22:23], v[54:55]
  v_pk_mul_f32 v[56:57], v[24:25], v[56:57]
  v_cvt_pk_bf16_f32 v184, v32, v33
  v_cvt_pk_bf16_f32 v185, v34, v35
  v_cvt_pk_bf16_f32 v186, v36, v37
  v_cvt_pk_bf16_f32 v187, v38, v39
  v_pk_mul_f32 v[58:59], v[26:27], v[58:59]
  v_pk_mul_f32 v[60:61], v[28:29], v[60:61]
  v_pk_mul_f32 v[62:63], v[30:31], v[62:63]
  v_mfma_f32_32x32x16_bf16 v[64:79], v[192:195], v[184:187], v[64:79]
  s_mov_b32 m0, s30
  v_cvt_pk_bf16_f32 v188, v40, v41
  v_cvt_pk_bf16_f32 v189, v42, v43
  v_cvt_pk_bf16_f32 v190, v44, v45
  v_cvt_pk_bf16_f32 v191, v46, v47
  v_exp_f32 v48, v48
  v_mfma_f32_32x32x16_bf16 v[80:95], v[196:199], v[184:187], v[80:95]
  buffer_load_dwordx4 v6, s[4:7], s29 offen lds
  v_exp_f32 v49, v49
  v_exp_f32 v50, v50
  v_exp_f32_e64 v51, v51
  v_mfma_f32_32x32x16_bf16 v[96:111], v[200:203], v[184:187], v[96:111]
  buffer_load_dwordx4 v7, s[4:7], s29 offen offset:1024 lds
  v_exp_f32 v52, v52
  v_exp_f32 v53, v53
  v_mfma_f32_32x32x16_bf16 v[64:79], v[204:207], v[188:191], v[64:79]
  buffer_load_dwordx4 v8, s[4:7], s29 offen offset:2048 lds
  v_exp_f32 v54, v54
  v_exp_f32 v55, v55
  v_exp_f32_e64 v56, v56
  v_mfma_f32_32x32x16_bf16 v[80:95], v[208:211], v[188:191], v[80:95]
  buffer_load_dwordx4 v9, s[4:7], s29 offen offset:3072 lds
  v_exp_f32 v57, v57
  v_exp_f32 v58, v58
  v_mfma_f32_32x32x16_bf16 v[96:111], v[212:215], v[188:191], v[96:111]
  v_exp_f32 v59, v59
  v_exp_f32 v60, v60
  v_exp_f32 v61, v61
  v_exp_f32 v62, v62
  v_exp_f32_e64 v63, v63
  v_pk_fma_f32 v[48:49], v[48:49], s[22:23], s[22:23]
  v_pk_fma_f32 v[50:51], v[50:51], s[22:23], s[22:23]
  v_pk_fma_f32 v[52:53], v[52:53], s[22:23], s[22:23]
  v_pk_fma_f32 v[54:55], v[54:55], s[22:23], s[22:23]
  v_pk_fma_f32 v[56:57], v[56:57], s[22:23], s[22:23]
  v_pk_fma_f32 v[58:59], v[58:59], s[22:23], s[22:23]
  v_pk_fma_f32 v[60:61], v[60:61], s[22:23], s[22:23]
  v_pk_fma_f32 v[62:63], v[62:63], s[22:23], s[22:23]
  v_mfma_f32_32x32x16_bf16 v[32:47], a[0:3], v[160:163], 0
  v_cvt_pk_bf16_f32 v112, v64, v65
  v_cvt_pk_bf16_f32 v113, v66, v67
  v_cvt_pk_bf16_f32 v114, v68, v69
  v_cvt_pk_bf16_f32 v115, v70, v71
  v_cvt_pk_bf16_f32 v116, v72, v73
  v_cvt_pk_bf16_f32 v117, v74, v75
  v_mfma_f32_32x32x16_bf16 v[32:47], a[4:7], v[164:167], v[32:47]
  v_cvt_pk_bf16_f32 v118, v76, v77
  v_cvt_pk_bf16_f32 v119, v78, v79
  v_cvt_pk_bf16_f32 v120, v80, v81
  v_cvt_pk_bf16_f32 v121, v82, v83
  v_cvt_pk_bf16_f32 v122, v84, v85
  v_cvt_pk_bf16_f32 v123, v86, v87
  v_mfma_f32_32x32x16_bf16 v[32:47], a[8:11], v[168:171], v[32:47]
  ds_read_b128 v[64:67], v2
  ds_read_b128 v[68:71], v2 offset:32
  ds_read_b128 v[72:75], v2 offset:64
  ds_read_b128 v[76:79], v2 offset:96
  v_cvt_pk_bf16_f32 v124, v88, v89
  v_cvt_pk_bf16_f32 v125, v90, v91
  v_mfma_f32_32x32x16_bf16 v[32:47], a[12:15], v[172:175], v[32:47]
  ds_read_b128 v[192:195], v1 offset:8192
  ds_read_b128 v[196:199], v1 offset:9216
  v_cvt_pk_bf16_f32 v126, v92, v93
  v_cvt_pk_bf16_f32 v127, v94, v95
  v_cvt_pk_bf16_f32 v128, v96, v97
  v_cvt_pk_bf16_f32 v129, v98, v99
  v_mfma_f32_32x32x16_bf16 v[32:47], a[16:19], v[176:179], v[32:47]
  ds_read_b128 v[80:83], v2 offset:128
  ds_read_b128 v[84:87], v2 offset:160
  ds_read_b128 v[88:91], v2 offset:192
  ds_read_b128 v[92:95], v2 offset:224
  v_cvt_pk_bf16_f32 v130, v100, v101
  v_cvt_pk_bf16_f32 v131, v102, v103
  v_mfma_f32_32x32x16_bf16 v[32:47], a[20:23], v[180:183], v[32:47]
  s_waitcnt lgkmcnt(6)
  ds_read_b128 v[200:203], v1 offset:10240
  ds_read_b128 v[204:207], v1 offset:11264
  v_cvt_pk_bf16_f32 v132, v104, v105
  v_cvt_pk_bf16_f32 v133, v106, v107
  v_cvt_pk_bf16_f32 v134, v108, v109
  v_cvt_pk_bf16_f32 v135, v110, v111
  v_mfma_f32_32x32x16_bf16 v[64:79], v[240:243], v[136:139], v[64:79]
  s_nop 0
  ds_read_b128 v[96:99], v2 offset:256
  ds_read_b128 v[100:103], v2 offset:288
  ds_read_b128 v[104:107], v2 offset:320
  ds_read_b128 v[108:111], v2 offset:352
  v_rcp_f32 v48, v48
  v_mfma_f32_32x32x16_bf16 v[64:79], v[244:247], v[140:143], v[64:79]
  s_waitcnt lgkmcnt(6)
  ds_read_b128 v[208:211], v1 offset:12288
  ds_read_b128 v[212:215], v1 offset:13312
  v_rcp_f32 v49, v49
  v_rcp_f32 v50, v50
  v_mfma_f32_32x32x16_bf16 v[80:95], v[240:243], v[144:147], v[80:95]
  v_rcp_f32 v51, v51
  v_rcp_f32 v52, v52
  v_rcp_f32_e64 v53, v53
  v_mfma_f32_32x32x16_bf16 v[80:95], v[244:247], v[148:151], v[80:95]
  s_waitcnt lgkmcnt(2)
  v_rcp_f32 v54, v54
  v_rcp_f32 v55, v55
  v_rcp_f32 v56, v56
  v_mfma_f32_32x32x16_bf16 v[96:111], v[240:243], v[152:155], v[96:111]
  v_rcp_f32 v57, v57
  v_rcp_f32 v58, v58
  v_rcp_f32_e64 v59, v59
  v_mfma_f32_32x32x16_bf16 v[96:111], v[244:247], v[156:159], v[96:111]
  s_waitcnt lgkmcnt(0)
  v_rcp_f32 v60, v60
  v_rcp_f32 v61, v61
  v_rcp_f32 v62, v62
  v_rcp_f32_e64 v63, v63
  v_pk_mul_f32 v[16:17], v[16:17], v[48:49]
  v_pk_mul_f32 v[18:19], v[18:19], v[50:51]
  v_pk_mul_f32 v[20:21], v[20:21], v[52:53]
  v_pk_mul_f32 v[22:23], v[22:23], v[54:55]
  v_pk_mul_f32 v[24:25], v[24:25], v[56:57]
  v_pk_mul_f32 v[26:27], v[26:27], v[58:59]
  v_pk_mul_f32 v[28:29], v[28:29], v[60:61]
  v_pk_mul_f32 v[30:31], v[30:31], v[62:63]
  v_pk_fma_f32 v[48:49], v[32:33], v[32:33], s[20:21] neg_lo:[1,0,1] neg_hi:[1,0,1]
  v_pk_fma_f32 v[50:51], v[34:35], v[34:35], s[20:21] neg_lo:[1,0,1] neg_hi:[1,0,1]
  v_pk_fma_f32 v[52:53], v[36:37], v[36:37], s[20:21] neg_lo:[1,0,1] neg_hi:[1,0,1]
  v_pk_fma_f32 v[54:55], v[38:39], v[38:39], s[20:21] neg_lo:[1,0,1] neg_hi:[1,0,1]
  v_pk_fma_f32 v[56:57], v[40:41], v[40:41], s[20:21] neg_lo:[1,0,1] neg_hi:[1,0,1]
  v_pk_fma_f32 v[58:59], v[42:43], v[42:43], s[20:21] neg_lo:[1,0,1] neg_hi:[1,0,1]
  v_pk_fma_f32 v[60:61], v[44:45], v[44:45], s[20:21] neg_lo:[1,0,1] neg_hi:[1,0,1]
  v_pk_fma_f32 v[62:63], v[46:47], v[46:47], s[20:21] neg_lo:[1,0,1] neg_hi:[1,0,1]
  v_pk_mul_f32 v[48:49], v[32:33], v[48:49]
  v_pk_mul_f32 v[50:51], v[34:35], v[50:51]
  v_pk_mul_f32 v[52:53], v[36:37], v[52:53]
  v_pk_mul_f32 v[54:55], v[38:39], v[54:55]
  v_pk_mul_f32 v[56:57], v[40:41], v[56:57]
  v_cvt_pk_bf16_f32 v184, v16, v17
  v_cvt_pk_bf16_f32 v185, v18, v19
  v_cvt_pk_bf16_f32 v186, v20, v21
  v_cvt_pk_bf16_f32 v187, v22, v23
  v_pk_mul_f32 v[58:59], v[42:43], v[58:59]
  v_pk_mul_f32 v[60:61], v[44:45], v[60:61]
  v_pk_mul_f32 v[62:63], v[46:47], v[62:63]
  v_mfma_f32_32x32x16_bf16 v[64:79], v[192:195], v[184:187], v[64:79]
  s_mov_b32 m0, s31
  v_cvt_pk_bf16_f32 v188, v24, v25
  v_cvt_pk_bf16_f32 v189, v26, v27
  v_cvt_pk_bf16_f32 v190, v28, v29
  v_cvt_pk_bf16_f32 v191, v30, v31
  v_exp_f32 v48, v48
  v_mfma_f32_32x32x16_bf16 v[80:95], v[196:199], v[184:187], v[80:95]
  buffer_load_dwordx4 v6, s[4:7], s52 offen lds
  v_exp_f32 v49, v49
  v_exp_f32 v50, v50
  v_exp_f32_e64 v51, v51
  v_mfma_f32_32x32x16_bf16 v[96:111], v[200:203], v[184:187], v[96:111]
  buffer_load_dwordx4 v7, s[4:7], s52 offen offset:1024 lds
  v_exp_f32 v52, v52
  v_exp_f32 v53, v53
  v_mfma_f32_32x32x16_bf16 v[64:79], v[204:207], v[188:191], v[64:79]
  buffer_load_dwordx4 v8, s[4:7], s52 offen offset:2048 lds
  v_exp_f32 v54, v54
  v_exp_f32 v55, v55
  v_exp_f32_e64 v56, v56
  v_mfma_f32_32x32x16_bf16 v[80:95], v[208:211], v[188:191], v[80:95]
  buffer_load_dwordx4 v9, s[4:7], s52 offen offset:3072 lds
  v_exp_f32 v57, v57
  v_exp_f32 v58, v58
  v_mfma_f32_32x32x16_bf16 v[96:111], v[212:215], v[188:191], v[96:111]
  v_exp_f32 v59, v59
  v_exp_f32 v60, v60
  v_exp_f32 v61, v61
  v_exp_f32 v62, v62
  v_exp_f32_e64 v63, v63
  v_pk_fma_f32 v[48:49], v[48:49], s[22:23], s[22:23]
  v_pk_fma_f32 v[50:51], v[50:51], s[22:23], s[22:23]
  v_pk_fma_f32 v[52:53], v[52:53], s[22:23], s[22:23]
  v_pk_fma_f32 v[54:55], v[54:55], s[22:23], s[22:23]
  v_pk_fma_f32 v[56:57], v[56:57], s[22:23], s[22:23]
  v_pk_fma_f32 v[58:59], v[58:59], s[22:23], s[22:23]
  v_pk_fma_f32 v[60:61], v[60:61], s[22:23], s[22:23]
  v_pk_fma_f32 v[62:63], v[62:63], s[22:23], s[22:23]
  v_mfma_f32_32x32x16_bf16 v[16:31], a[24:27], v[160:163], 0
  ds_read_b128 v[192:195], v1 offset:14336
  ds_read_b128 v[196:199], v1 offset:15360
  v_rcp_f32 v48, v48
  v_rcp_f32 v49, v49
  v_mfma_f32_32x32x16_bf16 v[16:31], a[28:31], v[164:167], v[16:31]
  ds_read_b128 v[200:203], v1 offset:16384
  ds_read_b128 v[204:207], v1 offset:17408
  v_rcp_f32 v50, v50
  v_rcp_f32 v51, v51
  v_mfma_f32_32x32x16_bf16 v[16:31], a[32:35], v[168:171], v[16:31]
  ds_read_b128 v[208:211], v1 offset:18432
  ds_read_b128 v[212:215], v1 offset:19456
  v_rcp_f32 v52, v52
  v_rcp_f32 v53, v53
  v_mfma_f32_32x32x16_bf16 v[16:31], a[36:39], v[172:175], v[16:31]
  buffer_store_dwordx4 v[112:115], v10, s[8:11], s28 offen
  v_rcp_f32 v54, v54
  v_rcp_f32 v55, v55
  v_mfma_f32_32x32x16_bf16 v[16:31], a[40:43], v[176:179], v[16:31]
  v_rcp_f32 v56, v56
  v_rcp_f32 v57, v57
  v_rcp_f32_e64 v58, v58
  v_mfma_f32_32x32x16_bf16 v[16:31], a[44:47], v[180:183], v[16:31]
  s_waitcnt lgkmcnt(0)
  v_rcp_f32 v59, v59
  v_rcp_f32 v60, v60
  v_rcp_f32 v61, v61
  v_rcp_f32 v62, v62
  v_rcp_f32 v63, v63
  v_pk_mul_f32 v[32:33], v[32:33], v[48:49]
  v_pk_mul_f32 v[34:35], v[34:35], v[50:51]
  v_pk_mul_f32 v[36:37], v[36:37], v[52:53]
  v_pk_mul_f32 v[38:39], v[38:39], v[54:55]
  v_pk_mul_f32 v[40:41], v[40:41], v[56:57]
  v_pk_mul_f32 v[42:43], v[42:43], v[58:59]
  v_pk_mul_f32 v[44:45], v[44:45], v[60:61]
  v_pk_mul_f32 v[46:47], v[46:47], v[62:63]
  v_pk_fma_f32 v[48:49], v[16:17], v[16:17], s[20:21] neg_lo:[1,0,1] neg_hi:[1,0,1]
  v_pk_fma_f32 v[50:51], v[18:19], v[18:19], s[20:21] neg_lo:[1,0,1] neg_hi:[1,0,1]
  v_pk_fma_f32 v[52:53], v[20:21], v[20:21], s[20:21] neg_lo:[1,0,1] neg_hi:[1,0,1]
  v_pk_fma_f32 v[54:55], v[22:23], v[22:23], s[20:21] neg_lo:[1,0,1] neg_hi:[1,0,1]
  v_pk_fma_f32 v[56:57], v[24:25], v[24:25], s[20:21] neg_lo:[1,0,1] neg_hi:[1,0,1]
  v_pk_fma_f32 v[58:59], v[26:27], v[26:27], s[20:21] neg_lo:[1,0,1] neg_hi:[1,0,1]
  v_pk_fma_f32 v[60:61], v[28:29], v[28:29], s[20:21] neg_lo:[1,0,1] neg_hi:[1,0,1]
  v_pk_fma_f32 v[62:63], v[30:31], v[30:31], s[20:21] neg_lo:[1,0,1] neg_hi:[1,0,1]
  v_pk_mul_f32 v[48:49], v[16:17], v[48:49]
  v_pk_mul_f32 v[50:51], v[18:19], v[50:51]
  v_pk_mul_f32 v[52:53], v[20:21], v[52:53]
  v_pk_mul_f32 v[54:55], v[22:23], v[54:55]
  v_pk_mul_f32 v[56:57], v[24:25], v[56:57]
  v_cvt_pk_bf16_f32 v184, v32, v33
  v_cvt_pk_bf16_f32 v185, v34, v35
  v_cvt_pk_bf16_f32 v186, v36, v37
  v_cvt_pk_bf16_f32 v187, v38, v39
  v_pk_mul_f32 v[58:59], v[26:27], v[58:59]
  v_pk_mul_f32 v[60:61], v[28:29], v[60:61]
  v_pk_mul_f32 v[62:63], v[30:31], v[62:63]
  v_mfma_f32_32x32x16_bf16 v[64:79], v[192:195], v[184:187], v[64:79]
  v_cvt_pk_bf16_f32 v188, v40, v41
  v_cvt_pk_bf16_f32 v189, v42, v43
  v_cvt_pk_bf16_f32 v190, v44, v45
  v_cvt_pk_bf16_f32 v191, v46, v47
  v_exp_f32_e64 v48, v48
  v_mfma_f32_32x32x16_bf16 v[80:95], v[196:199], v[184:187], v[80:95]
  v_exp_f32 v49, v49
  v_exp_f32 v50, v50
  v_exp_f32_e64 v51, v51
  v_mfma_f32_32x32x16_bf16 v[96:111], v[200:203], v[184:187], v[96:111]
  v_exp_f32 v52, v52
  v_exp_f32 v53, v53
  v_subrev_u32 v11, 0x4100, v5
  v_mfma_f32_32x32x16_bf16 v[64:79], v[204:207], v[188:191], v[64:79]
  v_exp_f32 v54, v54
  v_exp_f32 v55, v55
  v_exp_f32_e64 v56, v56
  v_mfma_f32_32x32x16_bf16 v[80:95], v[208:211], v[188:191], v[80:95]
  v_exp_f32 v57, v57
  v_exp_f32 v58, v58
  v_add_u32 v5, 0x8200, v5
  v_exp_f32_e64 v59, v59
  v_mfma_f32_32x32x16_bf16 v[96:111], v[212:215], v[188:191], v[96:111]
  v_exp_f32 v60, v60
  v_exp_f32 v61, v61
  v_exp_f32 v62, v62
  v_exp_f32 v63, v63
  v_min_u32_e64 v5, v11, v5
  v_pk_fma_f32 v[48:49], v[48:49], s[22:23], s[22:23]
  v_pk_fma_f32 v[50:51], v[50:51], s[22:23], s[22:23]
  v_pk_fma_f32 v[52:53], v[52:53], s[22:23], s[22:23]
  v_pk_fma_f32 v[54:55], v[54:55], s[22:23], s[22:23]
  v_pk_fma_f32 v[56:57], v[56:57], s[22:23], s[22:23]
  v_pk_fma_f32 v[58:59], v[58:59], s[22:23], s[22:23]
  v_pk_fma_f32 v[60:61], v[60:61], s[22:23], s[22:23]
  v_pk_fma_f32 v[62:63], v[62:63], s[22:23], s[22:23]
  v_mfma_f32_32x32x16_bf16 v[32:47], a[48:51], v[160:163], 0
  ds_read_b128 v[192:195], v1 offset:20480
  ds_read_b128 v[196:199], v1 offset:21504
  v_rcp_f32 v48, v48
  v_rcp_f32 v49, v49
  v_mfma_f32_32x32x16_bf16 v[32:47], a[52:55], v[164:167], v[32:47]
  ds_read_b128 v[200:203], v1 offset:22528
  ds_read_b128 v[204:207], v1 offset:23552
  v_rcp_f32 v50, v50
  v_rcp_f32 v51, v51
  v_mfma_f32_32x32x16_bf16 v[32:47], a[56:59], v[168:171], v[32:47]
  ds_read_b128 v[208:211], v1 offset:24576
  ds_read_b128 v[212:215], v1 offset:25600
  v_rcp_f32 v52, v52
  v_rcp_f32 v53, v53
  v_mfma_f32_32x32x16_bf16 v[32:47], a[60:63], v[172:175], v[32:47]
  buffer_store_dwordx4 v[116:119], v10, s[8:11], s28 offen offset:32
  v_rcp_f32 v54, v54
  v_rcp_f32 v55, v55
  v_mfma_f32_32x32x16_bf16 v[32:47], a[64:67], v[176:179], v[32:47]
  v_rcp_f32 v56, v56
  v_rcp_f32 v57, v57
  v_rcp_f32_e64 v58, v58
  v_mfma_f32_32x32x16_bf16 v[32:47], a[68:71], v[180:183], v[32:47]
  s_waitcnt lgkmcnt(0)
  v_rcp_f32 v59, v59
  v_rcp_f32 v60, v60
  v_rcp_f32 v61, v61
  v_rcp_f32 v62, v62
  v_rcp_f32 v63, v63
  v_pk_mul_f32 v[16:17], v[16:17], v[48:49]
  v_pk_mul_f32 v[18:19], v[18:19], v[50:51]
  v_pk_mul_f32 v[20:21], v[20:21], v[52:53]
  v_pk_mul_f32 v[22:23], v[22:23], v[54:55]
  v_pk_mul_f32 v[24:25], v[24:25], v[56:57]
  v_pk_mul_f32 v[26:27], v[26:27], v[58:59]
  v_pk_mul_f32 v[28:29], v[28:29], v[60:61]
  v_pk_mul_f32 v[30:31], v[30:31], v[62:63]
  v_pk_fma_f32 v[48:49], v[32:33], v[32:33], s[20:21] neg_lo:[1,0,1] neg_hi:[1,0,1]
  v_pk_fma_f32 v[50:51], v[34:35], v[34:35], s[20:21] neg_lo:[1,0,1] neg_hi:[1,0,1]
  v_pk_fma_f32 v[52:53], v[36:37], v[36:37], s[20:21] neg_lo:[1,0,1] neg_hi:[1,0,1]
  v_pk_fma_f32 v[54:55], v[38:39], v[38:39], s[20:21] neg_lo:[1,0,1] neg_hi:[1,0,1]
  v_pk_fma_f32 v[56:57], v[40:41], v[40:41], s[20:21] neg_lo:[1,0,1] neg_hi:[1,0,1]
  v_pk_fma_f32 v[58:59], v[42:43], v[42:43], s[20:21] neg_lo:[1,0,1] neg_hi:[1,0,1]
  v_pk_fma_f32 v[60:61], v[44:45], v[44:45], s[20:21] neg_lo:[1,0,1] neg_hi:[1,0,1]
  v_pk_fma_f32 v[62:63], v[46:47], v[46:47], s[20:21] neg_lo:[1,0,1] neg_hi:[1,0,1]
  v_pk_mul_f32 v[48:49], v[32:33], v[48:49]
  v_pk_mul_f32 v[50:51], v[34:35], v[50:51]
  v_pk_mul_f32 v[52:53], v[36:37], v[52:53]
  v_pk_mul_f32 v[54:55], v[38:39], v[54:55]
  v_pk_mul_f32 v[56:57], v[40:41], v[56:57]
  v_cvt_pk_bf16_f32 v184, v16, v17
  v_cvt_pk_bf16_f32 v185, v18, v19
  v_cvt_pk_bf16_f32 v186, v20, v21
  v_cvt_pk_bf16_f32 v187, v22, v23
  v_pk_mul_f32 v[58:59], v[42:43], v[58:59]
  v_pk_mul_f32 v[60:61], v[44:45], v[60:61]
  v_pk_mul_f32 v[62:63], v[46:47], v[62:63]
  v_mfma_f32_32x32x16_bf16 v[64:79], v[192:195], v[184:187], v[64:79]
  s_add_u32 s29, s29, 0x60000
  v_cvt_pk_bf16_f32 v188, v24, v25
  v_cvt_pk_bf16_f32 v189, v26, v27
  v_cvt_pk_bf16_f32 v190, v28, v29
  v_cvt_pk_bf16_f32 v191, v30, v31
  v_exp_f32_e64 v48, v48
  v_mfma_f32_32x32x16_bf16 v[80:95], v[196:199], v[184:187], v[80:95]
  s_add_u32 s52, s52, 0x60000
  v_exp_f32 v49, v49
  v_exp_f32 v50, v50
  v_exp_f32_e64 v51, v51
  v_mfma_f32_32x32x16_bf16 v[96:111], v[200:203], v[184:187], v[96:111]
  s_mov_b32 s32, s30
  v_exp_f32 v52, v52
  v_exp_f32_e64 v53, v53
  v_subrev_u32 v11, 0x4100, v4
  v_mfma_f32_32x32x16_bf16 v[64:79], v[204:207], v[188:191], v[64:79]
  s_add_u32 s30, s33, 32
  v_exp_f32 v54, v54
  v_exp_f32 v55, v55
  v_exp_f32 v56, v56
  v_mfma_f32_32x32x16_bf16 v[80:95], v[208:211], v[188:191], v[80:95]
  s_sub_u32 s33, s31, 0
  v_exp_f32 v57, v57
  v_exp_f32_e64 v58, v58
  v_add_u32 v4, 0x8200, v4
  v_exp_f32_e64 v59, v59
  v_mfma_f32_32x32x16_bf16 v[96:111], v[212:215], v[188:191], v[96:111]
  v_exp_f32 v60, v60
  v_exp_f32 v61, v61
  v_exp_f32 v62, v62
  v_exp_f32 v63, v63
  v_min_u32_e64 v4, v11, v4
  v_pk_fma_f32 v[48:49], v[48:49], s[22:23], s[22:23]
  v_pk_fma_f32 v[50:51], v[50:51], s[22:23], s[22:23]
  v_pk_fma_f32 v[52:53], v[52:53], s[22:23], s[22:23]
  v_pk_fma_f32 v[54:55], v[54:55], s[22:23], s[22:23]
  v_pk_fma_f32 v[56:57], v[56:57], s[22:23], s[22:23]
  v_pk_fma_f32 v[58:59], v[58:59], s[22:23], s[22:23]
  v_pk_fma_f32 v[60:61], v[60:61], s[22:23], s[22:23]
  v_pk_fma_f32 v[62:63], v[62:63], s[22:23], s[22:23]
  v_mfma_f32_32x32x16_bf16 v[16:31], a[72:75], v[160:163], 0
  ds_read_b128 v[192:195], v1 offset:26624
  ds_read_b128 v[196:199], v1 offset:27648
  v_rcp_f32 v48, v48
  v_rcp_f32 v49, v49
  v_mfma_f32_32x32x16_bf16 v[16:31], a[76:79], v[164:167], v[16:31]
  ds_read_b128 v[200:203], v1 offset:28672
  ds_read_b128 v[204:207], v1 offset:29696
  v_rcp_f32 v50, v50
  v_rcp_f32 v51, v51
  v_mfma_f32_32x32x16_bf16 v[16:31], a[80:83], v[168:171], v[16:31]
  ds_read_b128 v[208:211], v1 offset:30720
  ds_read_b128 v[212:215], v1 offset:31744
  v_rcp_f32 v52, v52
  v_rcp_f32 v53, v53
  v_mfma_f32_32x32x16_bf16 v[16:31], a[84:87], v[172:175], v[16:31]
  buffer_load_dword v249, v248, s[4:7], s29 offen
  v_rcp_f32 v54, v54
  v_rcp_f32 v55, v55
  v_mfma_f32_32x32x16_bf16 v[16:31], a[88:91], v[176:179], v[16:31]
  v_rcp_f32 v56, v56
  v_rcp_f32 v57, v57
  v_rcp_f32_e64 v58, v58
  v_mfma_f32_32x32x16_bf16 v[16:31], a[92:95], v[180:183], v[16:31]
  s_waitcnt lgkmcnt(0)
  v_rcp_f32 v59, v59
  v_rcp_f32 v60, v60
  v_rcp_f32 v61, v61
  v_rcp_f32_e64 v62, v62
  v_rcp_f32_e64 v63, v63
  v_pk_mul_f32 v[32:33], v[32:33], v[48:49]
  v_pk_mul_f32 v[34:35], v[34:35], v[50:51]
  v_pk_mul_f32 v[36:37], v[36:37], v[52:53]
  v_pk_mul_f32 v[38:39], v[38:39], v[54:55]
  v_pk_mul_f32 v[40:41], v[40:41], v[56:57]
  v_pk_mul_f32 v[42:43], v[42:43], v[58:59]
  v_pk_mul_f32 v[44:45], v[44:45], v[60:61]
  v_pk_mul_f32 v[46:47], v[46:47], v[62:63]
  v_pk_fma_f32 v[48:49], v[16:17], v[16:17], s[20:21] neg_lo:[1,0,1] neg_hi:[1,0,1]
  v_pk_fma_f32 v[50:51], v[18:19], v[18:19], s[20:21] neg_lo:[1,0,1] neg_hi:[1,0,1]
  v_pk_fma_f32 v[52:53], v[20:21], v[20:21], s[20:21] neg_lo:[1,0,1] neg_hi:[1,0,1]
  v_pk_fma_f32 v[54:55], v[22:23], v[22:23], s[20:21] neg_lo:[1,0,1] neg_hi:[1,0,1]
  v_pk_fma_f32 v[56:57], v[24:25], v[24:25], s[20:21] neg_lo:[1,0,1] neg_hi:[1,0,1]
  v_pk_fma_f32 v[58:59], v[26:27], v[26:27], s[20:21] neg_lo:[1,0,1] neg_hi:[1,0,1]
  v_pk_fma_f32 v[60:61], v[28:29], v[28:29], s[20:21] neg_lo:[1,0,1] neg_hi:[1,0,1]
  v_pk_fma_f32 v[62:63], v[30:31], v[30:31], s[20:21] neg_lo:[1,0,1] neg_hi:[1,0,1]
  v_pk_mul_f32 v[48:49], v[16:17], v[48:49]
  v_pk_mul_f32 v[50:51], v[18:19], v[50:51]
  v_pk_mul_f32 v[52:53], v[20:21], v[52:53]
  v_pk_mul_f32 v[54:55], v[22:23], v[54:55]
  v_pk_mul_f32 v[56:57], v[24:25], v[56:57]
  v_cvt_pk_bf16_f32 v184, v32, v33
  v_cvt_pk_bf16_f32 v185, v34, v35
  v_cvt_pk_bf16_f32 v186, v36, v37
  v_cvt_pk_bf16_f32 v187, v38, v39
  v_pk_mul_f32 v[58:59], v[26:27], v[58:59]
  v_pk_mul_f32 v[60:61], v[28:29], v[60:61]
  v_pk_mul_f32 v[62:63], v[30:31], v[62:63]
  v_mfma_f32_32x32x16_bf16 v[64:79], v[192:195], v[184:187], v[64:79]
  s_waitcnt vmcnt(3)
  ds_read_b128 v[220:223], v4 offset:96
  v_cvt_pk_bf16_f32 v188, v40, v41
  v_cvt_pk_bf16_f32 v189, v42, v43
  v_cvt_pk_bf16_f32 v190, v44, v45
  v_cvt_pk_bf16_f32 v191, v46, v47
  v_mfma_f32_32x32x16_bf16 v[80:95], v[196:199], v[184:187], v[80:95]
  ds_read_b128 v[228:231], v4 offset:288
  v_exp_f32 v48, v48
  v_exp_f32 v49, v49
  v_exp_f32 v50, v50
  v_mfma_f32_32x32x16_bf16 v[96:111], v[200:203], v[184:187], v[96:111]
  ds_read_b128 v[236:239], v4 offset:480
  v_exp_f32 v51, v51
  v_exp_f32 v52, v52
  v_mfma_f32_32x32x16_bf16 v[64:79], v[204:207], v[188:191], v[64:79]
  v_exp_f32 v53, v53
  v_exp_f32 v54, v54
  v_exp_f32_e64 v55, v55
  v_mfma_f32_32x32x16_bf16 v[80:95], v[208:211], v[188:191], v[80:95]
  v_exp_f32 v56, v56
  v_exp_f32 v57, v57
  v_exp_f32_e64 v58, v58
  v_mfma_f32_32x32x16_bf16 v[96:111], v[212:215], v[188:191], v[96:111]
  s_waitcnt lgkmcnt(0)
  v_exp_f32 v59, v59
  v_exp_f32 v60, v60
  v_exp_f32 v61, v61
  v_exp_f32 v62, v62
  v_exp_f32 v63, v63
  v_pk_fma_f32 v[48:49], v[48:49], s[22:23], s[22:23]
  v_pk_fma_f32 v[50:51], v[50:51], s[22:23], s[22:23]
  v_pk_fma_f32 v[52:53], v[52:53], s[22:23], s[22:23]
  v_pk_fma_f32 v[54:55], v[54:55], s[22:23], s[22:23]
  v_pk_fma_f32 v[56:57], v[56:57], s[22:23], s[22:23]
  v_pk_fma_f32 v[58:59], v[58:59], s[22:23], s[22:23]
  v_pk_fma_f32 v[60:61], v[60:61], s[22:23], s[22:23]
  v_pk_fma_f32 v[62:63], v[62:63], s[22:23], s[22:23]
  v_mfma_f32_32x32x16_bf16 v[32:47], a[96:99], v[160:163], 0
  ds_read_b128 v[192:195], v0 offset:24576
  ds_read_b128 v[196:199], v0 offset:25600
  v_rcp_f32 v48, v48
  v_rcp_f32 v49, v49
  v_mfma_f32_16x16x32_bf16 v[136:139], a[240:243], v[220:223], 0
  ds_read_b128 v[216:219], v3 offset:2800
  ds_read_b128 v[220:223], v4 offset:112
  v_mfma_f32_32x32x16_bf16 v[32:47], a[100:103], v[164:167], v[32:47]
  ds_read_b128 v[200:203], v0 offset:26624
  ds_read_b128 v[204:207], v0 offset:27648
  v_rcp_f32 v50, v50
  v_rcp_f32 v51, v51
  v_mfma_f32_16x16x32_bf16 v[136:139], a[244:247], v[228:231], v[136:139]
  ds_read_b128 v[224:227], v3 offset:7600
  ds_read_b128 v[228:231], v4 offset:304
  v_mfma_f32_32x32x16_bf16 v[32:47], a[104:107], v[168:171], v[32:47]
  ds_read_b128 v[208:211], v0 offset:28672
  ds_read_b128 v[212:215], v0 offset:29696
  v_rcp_f32 v52, v52
  v_rcp_f32 v53, v53
  v_mfma_f32_16x16x32_bf16 v[136:139], a[248:251], v[236:239], v[136:139]
  ds_read_b128 v[232:235], v3 offset:12400
  ds_read_b128 v[236:239], v4 offset:496
  v_mfma_f32_32x32x16_bf16 v[32:47], a[108:111], v[172:175], v[32:47]
  buffer_store_dwordx4 v[120:123], v10, s[8:11], s28 offen offset:64
  v_rcp_f32 v54, v54
  v_rcp_f32 v55, v55
  v_mfma_f32_32x32x16_bf16 v[32:47], a[112:115], v[176:179], v[32:47]
  v_rcp_f32 v56, v56
  v_rcp_f32 v57, v57
  v_rcp_f32_e64 v58, v58
  v_mfma_f32_32x32x16_bf16 v[32:47], a[116:119], v[180:183], v[32:47]
  s_waitcnt lgkmcnt(0)
  v_rcp_f32 v59, v59
  v_rcp_f32 v60, v60
  v_rcp_f32 v61, v61
  v_rcp_f32 v62, v62
  v_rcp_f32 v63, v63
  v_pk_mul_f32 v[16:17], v[16:17], v[48:49]
  v_pk_mul_f32 v[18:19], v[18:19], v[50:51]
  v_pk_mul_f32 v[20:21], v[20:21], v[52:53]
  v_pk_mul_f32 v[22:23], v[22:23], v[54:55]
  v_pk_mul_f32 v[24:25], v[24:25], v[56:57]
  v_pk_mul_f32 v[26:27], v[26:27], v[58:59]
  v_pk_mul_f32 v[28:29], v[28:29], v[60:61]
  v_pk_mul_f32 v[30:31], v[30:31], v[62:63]
  v_pk_add_f32 v[12:13], v[136:137], v[138:139]
  v_pk_mul_f32 v[14:15], v[136:137], v[136:137]
  v_pk_fma_f32 v[14:15], v[138:139], v[138:139], v[14:15]
  v_pk_fma_f32 v[48:49], v[32:33], v[32:33], s[20:21] neg_lo:[1,0,1] neg_hi:[1,0,1]
  v_pk_fma_f32 v[50:51], v[34:35], v[34:35], s[20:21] neg_lo:[1,0,1] neg_hi:[1,0,1]
  v_pk_fma_f32 v[52:53], v[36:37], v[36:37], s[20:21] neg_lo:[1,0,1] neg_hi:[1,0,1]
  v_pk_fma_f32 v[54:55], v[38:39], v[38:39], s[20:21] neg_lo:[1,0,1] neg_hi:[1,0,1]
  v_pk_fma_f32 v[56:57], v[40:41], v[40:41], s[20:21] neg_lo:[1,0,1] neg_hi:[1,0,1]
  v_pk_fma_f32 v[58:59], v[42:43], v[42:43], s[20:21] neg_lo:[1,0,1] neg_hi:[1,0,1]
  v_pk_fma_f32 v[60:61], v[44:45], v[44:45], s[20:21] neg_lo:[1,0,1] neg_hi:[1,0,1]
  v_pk_fma_f32 v[62:63], v[46:47], v[46:47], s[20:21] neg_lo:[1,0,1] neg_hi:[1,0,1]
  v_pk_mul_f32 v[48:49], v[32:33], v[48:49]
  v_pk_mul_f32 v[50:51], v[34:35], v[50:51]
  v_pk_mul_f32 v[52:53], v[36:37], v[52:53]
  v_pk_mul_f32 v[54:55], v[38:39], v[54:55]
  v_pk_mul_f32 v[56:57], v[40:41], v[56:57]
  v_pk_mul_f32 v[58:59], v[42:43], v[58:59]
  v_pk_mul_f32 v[60:61], v[44:45], v[60:61]
  v_pk_mul_f32 v[62:63], v[46:47], v[62:63]
  v_mfma_f32_16x16x32_bf16 v[140:143], v[216:219], v[220:223], 0
  v_cvt_pk_bf16_f32 v184, v16, v17
  v_cvt_pk_bf16_f32 v185, v18, v19
  v_mfma_f32_16x16x32_bf16 v[140:143], v[224:227], v[228:231], v[140:143]
  v_cvt_pk_bf16_f32 v186, v20, v21
  v_cvt_pk_bf16_f32 v187, v22, v23
  v_mfma_f32_16x16x32_bf16 v[140:143], v[232:235], v[236:239], v[140:143]
  ds_read_b128 v[220:223], v4 offset:128
  v_mfma_f32_32x32x16_bf16 v[64:79], v[192:195], v[184:187], v[64:79]
  ds_read_b128 v[224:227], v3 offset:8000
  ds_read_b128 v[228:231], v4 offset:320
  v_cvt_pk_bf16_f32 v188, v24, v25
  v_cvt_pk_bf16_f32 v189, v26, v27
  v_cvt_pk_bf16_f32 v190, v28, v29
  v_cvt_pk_bf16_f32 v191, v30, v31
  v_mfma_f32_32x32x16_bf16 v[80:95], v[196:199], v[184:187], v[80:95]
  ds_read_b128 v[232:235], v3 offset:12800
  ds_read_b128 v[236:239], v4 offset:512
  v_exp_f32 v48, v48
  v_exp_f32 v49, v49
  v_mfma_f32_32x32x16_bf16 v[96:111], v[200:203], v[184:187], v[96:111]
  s_sub_u32 s31, s32, 32
  v_exp_f32 v50, v50
  v_exp_f32 v51, v51
  v_exp_f32 v52, v52
  v_mfma_f32_32x32x16_bf16 v[64:79], v[204:207], v[188:191], v[64:79]
  v_exp_f32 v53, v53
  v_exp_f32 v54, v54
  v_exp_f32_e64 v55, v55
  v_mfma_f32_32x32x16_bf16 v[80:95], v[208:211], v[188:191], v[80:95]
  v_exp_f32 v56, v56
  v_exp_f32 v57, v57
  v_exp_f32_e64 v58, v58
  v_mfma_f32_32x32x16_bf16 v[96:111], v[212:215], v[188:191], v[96:111]
  s_waitcnt lgkmcnt(0)
  v_exp_f32 v59, v59
  v_exp_f32 v60, v60
  v_exp_f32 v61, v61
  v_exp_f32 v62, v62
  v_exp_f32 v63, v63
  v_pk_add_f32 v[12:13], v[12:13], v[140:141]
  v_pk_fma_f32 v[14:15], v[140:141], v[140:141], v[14:15]
  v_pk_add_f32 v[12:13], v[12:13], v[142:143]
  v_pk_fma_f32 v[14:15], v[142:143], v[142:143], v[14:15]
  v_pk_fma_f32 v[48:49], v[48:49], s[22:23], s[22:23]
  v_pk_fma_f32 v[50:51], v[50:51], s[22:23], s[22:23]
  v_pk_fma_f32 v[52:53], v[52:53], s[22:23], s[22:23]
  v_pk_fma_f32 v[54:55], v[54:55], s[22:23], s[22:23]
  v_pk_fma_f32 v[56:57], v[56:57], s[22:23], s[22:23]
  v_pk_fma_f32 v[58:59], v[58:59], s[22:23], s[22:23]
  v_pk_fma_f32 v[60:61], v[60:61], s[22:23], s[22:23]
  v_pk_fma_f32 v[62:63], v[62:63], s[22:23], s[22:23]
  v_mfma_f32_32x32x16_bf16 v[16:31], a[120:123], v[160:163], 0
  ds_read_b128 v[192:195], v0 offset:30720
  ds_read_b128 v[196:199], v0 offset:31744
  v_rcp_f32 v48, v48
  v_rcp_f32 v49, v49
  v_mfma_f32_16x16x32_bf16 v[144:147], a[252:255], v[220:223], 0
  ds_read_b128 v[216:219], v3 offset:3600
  ds_read_b128 v[220:223], v4 offset:144
  v_mfma_f32_32x32x16_bf16 v[16:31], a[124:127], v[164:167], v[16:31]
  ds_read_b128 v[200:203], v0 offset:32768
  ds_read_b128 v[204:207], v0 offset:33792
  v_rcp_f32 v50, v50
  v_rcp_f32 v51, v51
  v_mfma_f32_16x16x32_bf16 v[144:147], v[224:227], v[228:231], v[144:147]
  ds_read_b128 v[224:227], v3 offset:8400
  ds_read_b128 v[228:231], v4 offset:336
  v_mfma_f32_32x32x16_bf16 v[16:31], a[128:131], v[168:171], v[16:31]
  ds_read_b128 v[208:211], v0 offset:34816
  ds_read_b128 v[212:215], v0 offset:35840
  v_rcp_f32 v52, v52
  v_rcp_f32 v53, v53
  v_mfma_f32_16x16x32_bf16 v[144:147], v[232:235], v[236:239], v[144:147]
  ds_read_b128 v[232:235], v3 offset:13200
  ds_read_b128 v[236:239], v4 offset:528
  v_mfma_f32_32x32x16_bf16 v[16:31], a[132:135], v[172:175], v[16:31]
  buffer_store_dwordx4 v[124:127], v10, s[8:11], s28 offen offset:96
  v_rcp_f32 v54, v54
  v_rcp_f32 v55, v55
  v_mfma_f32_32x32x16_bf16 v[16:31], a[136:139], v[176:179], v[16:31]
  v_rcp_f32 v56, v56
  v_rcp_f32 v57, v57
  v_rcp_f32_e64 v58, v58
  v_mfma_f32_32x32x16_bf16 v[16:31], a[140:143], v[180:183], v[16:31]
  s_waitcnt lgkmcnt(0)
  v_rcp_f32 v59, v59
  v_rcp_f32 v60, v60
  v_rcp_f32 v61, v61
  v_rcp_f32 v62, v62
  v_rcp_f32 v63, v63
  v_pk_mul_f32 v[32:33], v[32:33], v[48:49]
  v_pk_mul_f32 v[34:35], v[34:35], v[50:51]
  v_pk_mul_f32 v[36:37], v[36:37], v[52:53]
  v_pk_mul_f32 v[38:39], v[38:39], v[54:55]
  v_pk_mul_f32 v[40:41], v[40:41], v[56:57]
  v_pk_mul_f32 v[42:43], v[42:43], v[58:59]
  v_pk_mul_f32 v[44:45], v[44:45], v[60:61]
  v_pk_mul_f32 v[46:47], v[46:47], v[62:63]
  v_pk_add_f32 v[12:13], v[12:13], v[144:145]
  v_pk_fma_f32 v[14:15], v[144:145], v[144:145], v[14:15]
  v_pk_add_f32 v[12:13], v[12:13], v[146:147]
  v_pk_fma_f32 v[14:15], v[146:147], v[146:147], v[14:15]
  v_pk_fma_f32 v[48:49], v[16:17], v[16:17], s[20:21] neg_lo:[1,0,1] neg_hi:[1,0,1]
  v_pk_fma_f32 v[50:51], v[18:19], v[18:19], s[20:21] neg_lo:[1,0,1] neg_hi:[1,0,1]
  v_pk_fma_f32 v[52:53], v[20:21], v[20:21], s[20:21] neg_lo:[1,0,1] neg_hi:[1,0,1]
  v_pk_fma_f32 v[54:55], v[22:23], v[22:23], s[20:21] neg_lo:[1,0,1] neg_hi:[1,0,1]
  v_pk_fma_f32 v[56:57], v[24:25], v[24:25], s[20:21] neg_lo:[1,0,1] neg_hi:[1,0,1]
  v_pk_fma_f32 v[58:59], v[26:27], v[26:27], s[20:21] neg_lo:[1,0,1] neg_hi:[1,0,1]
  v_pk_fma_f32 v[60:61], v[28:29], v[28:29], s[20:21] neg_lo:[1,0,1] neg_hi:[1,0,1]
  v_pk_fma_f32 v[62:63], v[30:31], v[30:31], s[20:21] neg_lo:[1,0,1] neg_hi:[1,0,1]
  v_pk_mul_f32 v[48:49], v[16:17], v[48:49]
  v_pk_mul_f32 v[50:51], v[18:19], v[50:51]
  v_pk_mul_f32 v[52:53], v[20:21], v[52:53]
  v_pk_mul_f32 v[54:55], v[22:23], v[54:55]
  v_pk_mul_f32 v[56:57], v[24:25], v[56:57]
  v_pk_mul_f32 v[58:59], v[26:27], v[58:59]
  v_pk_mul_f32 v[60:61], v[28:29], v[60:61]
  v_pk_mul_f32 v[62:63], v[30:31], v[62:63]
  v_mfma_f32_16x16x32_bf16 v[148:151], v[216:219], v[220:223], 0
  v_cvt_pk_bf16_f32 v184, v32, v33
  v_cvt_pk_bf16_f32 v185, v34, v35
  v_mfma_f32_16x16x32_bf16 v[148:151], v[224:227], v[228:231], v[148:151]
  v_cvt_pk_bf16_f32 v186, v36, v37
  v_cvt_pk_bf16_f32 v187, v38, v39
  v_mfma_f32_16x16x32_bf16 v[148:151], v[232:235], v[236:239], v[148:151]
  ds_read_b128 v[216:219], v3 offset:4000
  ds_read_b128 v[220:223], v4 offset:160
  v_mfma_f32_32x32x16_bf16 v[64:79], v[192:195], v[184:187], v[64:79]
  ds_read_b128 v[224:227], v3 offset:8800
  ds_read_b128 v[228:231], v4 offset:352
  v_cvt_pk_bf16_f32 v188, v40, v41
  v_cvt_pk_bf16_f32 v189, v42, v43
  v_cvt_pk_bf16_f32 v190, v44, v45
  v_cvt_pk_bf16_f32 v191, v46, v47
  v_mfma_f32_32x32x16_bf16 v[80:95], v[196:199], v[184:187], v[80:95]
  ds_read_b128 v[232:235], v3 offset:13600
  ds_read_b128 v[236:239], v4 offset:544
  v_exp_f32 v48, v48
  v_exp_f32 v49, v49
  v_mfma_f32_32x32x16_bf16 v[96:111], v[200:203], v[184:187], v[96:111]
  v_exp_f32 v50, v50
  v_exp_f32 v51, v51
  v_exp_f32_e64 v52, v52
  v_mfma_f32_32x32x16_bf16 v[64:79], v[204:207], v[188:191], v[64:79]
  v_exp_f32 v53, v53
  v_exp_f32 v54, v54
  v_exp_f32_e64 v55, v55
  v_mfma_f32_32x32x16_bf16 v[80:95], v[208:211], v[188:191], v[80:95]
  v_exp_f32 v56, v56
  v_exp_f32 v57, v57
  v_exp_f32_e64 v58, v58
  v_mfma_f32_32x32x16_bf16 v[96:111], v[212:215], v[188:191], v[96:111]
  s_waitcnt lgkmcnt(0)
  v_exp_f32 v59, v59
  v_exp_f32 v60, v60
  v_exp_f32 v61, v61
  v_exp_f32 v62, v62
  v_exp_f32 v63, v63
  v_pk_add_f32 v[12:13], v[12:13], v[148:149]
  v_pk_fma_f32 v[14:15], v[148:149], v[148:149], v[14:15]
  v_pk_add_f32 v[12:13], v[12:13], v[150:151]
  v_pk_fma_f32 v[14:15], v[150:151], v[150:151], v[14:15]
  v_pk_fma_f32 v[48:49], v[48:49], s[22:23], s[22:23]
  v_pk_fma_f32 v[50:51], v[50:51], s[22:23], s[22:23]
  v_pk_fma_f32 v[52:53], v[52:53], s[22:23], s[22:23]
  v_pk_fma_f32 v[54:55], v[54:55], s[22:23], s[22:23]
  v_pk_fma_f32 v[56:57], v[56:57], s[22:23], s[22:23]
  v_pk_fma_f32 v[58:59], v[58:59], s[22:23], s[22:23]
  v_pk_fma_f32 v[60:61], v[60:61], s[22:23], s[22:23]
  v_pk_fma_f32 v[62:63], v[62:63], s[22:23], s[22:23]
  v_mfma_f32_32x32x16_bf16 v[32:47], a[144:147], v[160:163], 0
  ds_read_b128 v[192:195], v0 offset:36864
  ds_read_b128 v[196:199], v0 offset:37888
  v_rcp_f32 v48, v48
  v_rcp_f32 v49, v49
  v_mfma_f32_16x16x32_bf16 v[152:155], v[216:219], v[220:223], 0
  ds_read_b128 v[216:219], v3 offset:4400
  ds_read_b128 v[220:223], v4 offset:176
  v_mfma_f32_32x32x16_bf16 v[32:47], a[148:151], v[164:167], v[32:47]
  ds_read_b128 v[200:203], v0 offset:38912
  ds_read_b128 v[204:207], v0 offset:39936
  v_rcp_f32 v50, v50
  v_rcp_f32 v51, v51
  v_mfma_f32_16x16x32_bf16 v[152:155], v[224:227], v[228:231], v[152:155]
  ds_read_b128 v[224:227], v3 offset:9200
  ds_read_b128 v[228:231], v4 offset:368
  v_mfma_f32_32x32x16_bf16 v[32:47], a[152:155], v[168:171], v[32:47]
  ds_read_b128 v[208:211], v0 offset:40960
  ds_read_b128 v[212:215], v0 offset:41984
  v_rcp_f32 v52, v52
  v_rcp_f32 v53, v53
  v_mfma_f32_16x16x32_bf16 v[152:155], v[232:235], v[236:239], v[152:155]
  ds_read_b128 v[232:235], v3 offset:14000
  ds_read_b128 v[236:239], v4 offset:560
  v_mfma_f32_32x32x16_bf16 v[32:47], a[156:159], v[172:175], v[32:47]
  v_rcp_f32 v54, v54
  v_rcp_f32 v55, v55
  v_rcp_f32_e64 v56, v56
  v_mfma_f32_32x32x16_bf16 v[32:47], a[160:163], v[176:179], v[32:47]
  v_rcp_f32 v57, v57
  v_rcp_f32 v58, v58
  v_rcp_f32_e64 v59, v59
  v_mfma_f32_32x32x16_bf16 v[32:47], a[164:167], v[180:183], v[32:47]
  s_waitcnt lgkmcnt(0)
  v_rcp_f32 v60, v60
  v_rcp_f32 v61, v61
  v_rcp_f32 v62, v62
  v_rcp_f32_e64 v63, v63
  v_pk_mul_f32 v[16:17], v[16:17], v[48:49]
  v_pk_mul_f32 v[18:19], v[18:19], v[50:51]
  v_pk_mul_f32 v[20:21], v[20:21], v[52:53]
  v_pk_mul_f32 v[22:23], v[22:23], v[54:55]
  v_pk_mul_f32 v[24:25], v[24:25], v[56:57]
  v_pk_mul_f32 v[26:27], v[26:27], v[58:59]
  v_pk_mul_f32 v[28:29], v[28:29], v[60:61]
  v_pk_mul_f32 v[30:31], v[30:31], v[62:63]
  v_pk_add_f32 v[12:13], v[12:13], v[152:153]
  v_pk_fma_f32 v[14:15], v[152:153], v[152:153], v[14:15]
  v_pk_add_f32 v[12:13], v[12:13], v[154:155]
  v_pk_fma_f32 v[14:15], v[154:155], v[154:155], v[14:15]
  v_pk_fma_f32 v[48:49], v[32:33], v[32:33], s[20:21] neg_lo:[1,0,1] neg_hi:[1,0,1]
  v_pk_fma_f32 v[50:51], v[34:35], v[34:35], s[20:21] neg_lo:[1,0,1] neg_hi:[1,0,1]
  v_pk_fma_f32 v[52:53], v[36:37], v[36:37], s[20:21] neg_lo:[1,0,1] neg_hi:[1,0,1]
  v_pk_fma_f32 v[54:55], v[38:39], v[38:39], s[20:21] neg_lo:[1,0,1] neg_hi:[1,0,1]
  v_pk_fma_f32 v[56:57], v[40:41], v[40:41], s[20:21] neg_lo:[1,0,1] neg_hi:[1,0,1]
  v_pk_fma_f32 v[58:59], v[42:43], v[42:43], s[20:21] neg_lo:[1,0,1] neg_hi:[1,0,1]
  v_pk_fma_f32 v[60:61], v[44:45], v[44:45], s[20:21] neg_lo:[1,0,1] neg_hi:[1,0,1]
  v_pk_fma_f32 v[62:63], v[46:47], v[46:47], s[20:21] neg_lo:[1,0,1] neg_hi:[1,0,1]
  v_pk_mul_f32 v[48:49], v[32:33], v[48:49]
  v_pk_mul_f32 v[50:51], v[34:35], v[50:51]
  v_pk_mul_f32 v[52:53], v[36:37], v[52:53]
  v_pk_mul_f32 v[54:55], v[38:39], v[54:55]
  v_pk_mul_f32 v[56:57], v[40:41], v[56:57]
  v_pk_mul_f32 v[58:59], v[42:43], v[58:59]
  v_pk_mul_f32 v[60:61], v[44:45], v[60:61]
  v_pk_mul_f32 v[62:63], v[46:47], v[62:63]
  v_mfma_f32_16x16x32_bf16 v[156:159], v[216:219], v[220:223], 0
  v_cvt_pk_bf16_f32 v184, v16, v17
  v_cvt_pk_bf16_f32 v185, v18, v19
  v_mfma_f32_16x16x32_bf16 v[156:159], v[224:227], v[228:231], v[156:159]
  v_cvt_pk_bf16_f32 v186, v20, v21
  v_cvt_pk_bf16_f32 v187, v22, v23
  v_mfma_f32_16x16x32_bf16 v[156:159], v[232:235], v[236:239], v[156:159]
  ds_read_b128 v[216:219], v3
  ds_read_b128 v[220:223], v4
  v_mfma_f32_32x32x16_bf16 v[64:79], v[192:195], v[184:187], v[64:79]
  ds_read_b128 v[224:227], v3 offset:4800
  ds_read_b128 v[228:231], v4 offset:192
  v_cvt_pk_bf16_f32 v188, v24, v25
  v_cvt_pk_bf16_f32 v189, v26, v27
  v_cvt_pk_bf16_f32 v190, v28, v29
  v_cvt_pk_bf16_f32 v191, v30, v31
  v_mfma_f32_32x32x16_bf16 v[80:95], v[196:199], v[184:187], v[80:95]
  ds_read_b128 v[232:235], v3 offset:9600
  ds_read_b128 v[236:239], v4 offset:384
  v_exp_f32 v48, v48
  v_exp_f32 v49, v49
  v_mfma_f32_32x32x16_bf16 v[96:111], v[200:203], v[184:187], v[96:111]
  v_exp_f32 v50, v50
  v_exp_f32 v51, v51
  v_exp_f32_e64 v52, v52
  v_mfma_f32_32x32x16_bf16 v[64:79], v[204:207], v[188:191], v[64:79]
  v_exp_f32 v53, v53
  v_exp_f32 v54, v54
  v_exp_f32_e64 v55, v55
  v_mfma_f32_32x32x16_bf16 v[80:95], v[208:211], v[188:191], v[80:95]
  v_exp_f32 v56, v56
  v_exp_f32 v57, v57
  v_exp_f32_e64 v58, v58
  v_mfma_f32_32x32x16_bf16 v[96:111], v[212:215], v[188:191], v[96:111]
  s_waitcnt lgkmcnt(0)
  v_exp_f32 v59, v59
  v_exp_f32 v60, v60
  v_exp_f32 v61, v61
  v_exp_f32 v62, v62
  v_exp_f32 v63, v63
  v_pk_add_f32 v[12:13], v[12:13], v[156:157]
  v_pk_fma_f32 v[14:15], v[156:157], v[156:157], v[14:15]
  v_pk_add_f32 v[12:13], v[12:13], v[158:159]
  v_pk_fma_f32 v[14:15], v[158:159], v[158:159], v[14:15]
  v_pk_fma_f32 v[48:49], v[48:49], s[22:23], s[22:23]
  v_pk_fma_f32 v[50:51], v[50:51], s[22:23], s[22:23]
  v_pk_fma_f32 v[52:53], v[52:53], s[22:23], s[22:23]
  v_pk_fma_f32 v[54:55], v[54:55], s[22:23], s[22:23]
  v_pk_fma_f32 v[56:57], v[56:57], s[22:23], s[22:23]
  v_pk_fma_f32 v[58:59], v[58:59], s[22:23], s[22:23]
  v_pk_fma_f32 v[60:61], v[60:61], s[22:23], s[22:23]
  v_pk_fma_f32 v[62:63], v[62:63], s[22:23], s[22:23]
  v_mfma_f32_32x32x16_bf16 v[16:31], a[168:171], v[160:163], 0
  ds_read_b128 v[192:195], v0 offset:43008
  ds_read_b128 v[196:199], v0 offset:44032
  v_rcp_f32 v48, v48
  v_rcp_f32 v49, v49
  v_mfma_f32_16x16x32_bf16 v[112:115], v[216:219], v[220:223], 0
  ds_read_b128 v[216:219], v3 offset:400
  ds_read_b128 v[220:223], v4 offset:16
  v_mfma_f32_32x32x16_bf16 v[16:31], a[172:175], v[164:167], v[16:31]
  ds_read_b128 v[200:203], v0 offset:45056
  ds_read_b128 v[204:207], v0 offset:46080
  v_rcp_f32 v50, v50
  v_rcp_f32 v51, v51
  v_mfma_f32_16x16x32_bf16 v[112:115], v[224:227], v[228:231], v[112:115]
  ds_read_b128 v[224:227], v3 offset:5200
  ds_read_b128 v[228:231], v4 offset:208
  v_mfma_f32_32x32x16_bf16 v[16:31], a[176:179], v[168:171], v[16:31]
  ds_read_b128 v[208:211], v0 offset:47104
  ds_read_b128 v[212:215], v0 offset:48128
  v_rcp_f32 v52, v52
  v_rcp_f32 v53, v53
  v_mfma_f32_16x16x32_bf16 v[112:115], v[232:235], v[236:239], v[112:115]
  ds_read_b128 v[232:235], v3 offset:10000
  ds_read_b128 v[236:239], v4 offset:400
  v_mfma_f32_32x32x16_bf16 v[16:31], a[180:183], v[172:175], v[16:31]
  buffer_store_dwordx4 v[128:131], v10, s[8:11], s28 offen offset:128
  v_rcp_f32 v54, v54
  v_rcp_f32 v55, v55
  v_mfma_f32_32x32x16_bf16 v[16:31], a[184:187], v[176:179], v[16:31]
  v_rcp_f32 v56, v56
  v_rcp_f32 v57, v57
  v_rcp_f32_e64 v58, v58
  v_mfma_f32_32x32x16_bf16 v[16:31], a[188:191], v[180:183], v[16:31]
  s_waitcnt lgkmcnt(0)
  v_rcp_f32 v59, v59
  v_rcp_f32 v60, v60
  v_rcp_f32 v61, v61
  v_rcp_f32 v62, v62
  v_rcp_f32 v63, v63
  v_pk_mul_f32 v[32:33], v[32:33], v[48:49]
  v_pk_mul_f32 v[34:35], v[34:35], v[50:51]
  v_pk_mul_f32 v[36:37], v[36:37], v[52:53]
  v_pk_mul_f32 v[38:39], v[38:39], v[54:55]
  v_pk_mul_f32 v[40:41], v[40:41], v[56:57]
  v_pk_mul_f32 v[42:43], v[42:43], v[58:59]
  v_pk_mul_f32 v[44:45], v[44:45], v[60:61]
  v_pk_mul_f32 v[46:47], v[46:47], v[62:63]
  v_pk_add_f32 v[12:13], v[12:13], v[112:113]
  v_pk_fma_f32 v[14:15], v[112:113], v[112:113], v[14:15]
  v_pk_add_f32 v[12:13], v[12:13], v[114:115]
  v_pk_fma_f32 v[14:15], v[114:115], v[114:115], v[14:15]
  v_pk_fma_f32 v[48:49], v[16:17], v[16:17], s[20:21] neg_lo:[1,0,1] neg_hi:[1,0,1]
  v_pk_fma_f32 v[50:51], v[18:19], v[18:19], s[20:21] neg_lo:[1,0,1] neg_hi:[1,0,1]
  v_pk_fma_f32 v[52:53], v[20:21], v[20:21], s[20:21] neg_lo:[1,0,1] neg_hi:[1,0,1]
  v_pk_fma_f32 v[54:55], v[22:23], v[22:23], s[20:21] neg_lo:[1,0,1] neg_hi:[1,0,1]
  v_pk_fma_f32 v[56:57], v[24:25], v[24:25], s[20:21] neg_lo:[1,0,1] neg_hi:[1,0,1]
  v_pk_fma_f32 v[58:59], v[26:27], v[26:27], s[20:21] neg_lo:[1,0,1] neg_hi:[1,0,1]
  v_pk_fma_f32 v[60:61], v[28:29], v[28:29], s[20:21] neg_lo:[1,0,1] neg_hi:[1,0,1]
  v_pk_fma_f32 v[62:63], v[30:31], v[30:31], s[20:21] neg_lo:[1,0,1] neg_hi:[1,0,1]
  v_pk_mul_f32 v[48:49], v[16:17], v[48:49]
  v_pk_mul_f32 v[50:51], v[18:19], v[50:51]
  v_pk_mul_f32 v[52:53], v[20:21], v[52:53]
  v_pk_mul_f32 v[54:55], v[22:23], v[54:55]
  v_pk_mul_f32 v[56:57], v[24:25], v[56:57]
  v_pk_mul_f32 v[58:59], v[26:27], v[58:59]
  v_pk_mul_f32 v[60:61], v[28:29], v[60:61]
  v_pk_mul_f32 v[62:63], v[30:31], v[62:63]
  v_mfma_f32_16x16x32_bf16 v[116:119], v[216:219], v[220:223], 0
  v_cvt_pk_bf16_f32 v184, v32, v33
  v_cvt_pk_bf16_f32 v185, v34, v35
  v_mfma_f32_16x16x32_bf16 v[116:119], v[224:227], v[228:231], v[116:119]
  v_cvt_pk_bf16_f32 v186, v36, v37
  v_cvt_pk_bf16_f32 v187, v38, v39
  v_mfma_f32_16x16x32_bf16 v[116:119], v[232:235], v[236:239], v[116:119]
  ds_read_b128 v[216:219], v3 offset:800
  ds_read_b128 v[220:223], v4 offset:32
  v_mfma_f32_32x32x16_bf16 v[64:79], v[192:195], v[184:187], v[64:79]
  ds_read_b128 v[224:227], v3 offset:5600
  ds_read_b128 v[228:231], v4 offset:224
  v_cvt_pk_bf16_f32 v188, v40, v41
  v_cvt_pk_bf16_f32 v189, v42, v43
  v_cvt_pk_bf16_f32 v190, v44, v45
  v_cvt_pk_bf16_f32 v191, v46, v47
  v_mfma_f32_32x32x16_bf16 v[80:95], v[196:199], v[184:187], v[80:95]
  ds_read_b128 v[232:235], v3 offset:10400
  ds_read_b128 v[236:239], v4 offset:416
  v_exp_f32 v48, v48
  v_exp_f32 v49, v49
  v_mfma_f32_32x32x16_bf16 v[96:111], v[200:203], v[184:187], v[96:111]
  v_exp_f32 v50, v50
  v_exp_f32 v51, v51
  v_exp_f32_e64 v52, v52
  v_mfma_f32_32x32x16_bf16 v[64:79], v[204:207], v[188:191], v[64:79]
  v_exp_f32 v53, v53
  v_exp_f32 v54, v54
  v_exp_f32_e64 v55, v55
  v_mfma_f32_32x32x16_bf16 v[80:95], v[208:211], v[188:191], v[80:95]
  v_exp_f32 v56, v56
  v_exp_f32 v57, v57
  v_exp_f32_e64 v58, v58
  v_mfma_f32_32x32x16_bf16 v[96:111], v[212:215], v[188:191], v[96:111]
  s_waitcnt lgkmcnt(0)
  v_exp_f32 v59, v59
  v_exp_f32 v60, v60
  v_exp_f32 v61, v61
  v_exp_f32 v62, v62
  v_exp_f32 v63, v63
  v_pk_add_f32 v[12:13], v[12:13], v[116:117]
  v_pk_fma_f32 v[14:15], v[116:117], v[116:117], v[14:15]
  v_pk_add_f32 v[12:13], v[12:13], v[118:119]
  v_pk_fma_f32 v[14:15], v[118:119], v[118:119], v[14:15]
  v_pk_fma_f32 v[48:49], v[48:49], s[22:23], s[22:23]
  v_pk_fma_f32 v[50:51], v[50:51], s[22:23], s[22:23]
  v_pk_fma_f32 v[52:53], v[52:53], s[22:23], s[22:23]
  v_pk_fma_f32 v[54:55], v[54:55], s[22:23], s[22:23]
  v_pk_fma_f32 v[56:57], v[56:57], s[22:23], s[22:23]
  v_pk_fma_f32 v[58:59], v[58:59], s[22:23], s[22:23]
  v_pk_fma_f32 v[60:61], v[60:61], s[22:23], s[22:23]
  v_pk_fma_f32 v[62:63], v[62:63], s[22:23], s[22:23]
  v_mfma_f32_32x32x16_bf16 v[32:47], a[192:195], v[160:163], 0
  ds_read_b128 v[192:195], v0 offset:49152
  ds_read_b128 v[196:199], v0 offset:50176
  v_rcp_f32 v48, v48
  v_rcp_f32 v49, v49
  v_mfma_f32_16x16x32_bf16 v[120:123], v[216:219], v[220:223], 0
  ds_read_b128 v[216:219], v3 offset:1200
  ds_read_b128 v[220:223], v4 offset:48
  v_mfma_f32_32x32x16_bf16 v[32:47], a[196:199], v[164:167], v[32:47]
  ds_read_b128 v[200:203], v0 offset:51200
  ds_read_b128 v[204:207], v0 offset:52224
  v_rcp_f32 v50, v50
  v_rcp_f32 v51, v51
  v_mfma_f32_16x16x32_bf16 v[120:123], v[224:227], v[228:231], v[120:123]
  ds_read_b128 v[224:227], v3 offset:6000
  ds_read_b128 v[228:231], v4 offset:240
  v_mfma_f32_32x32x16_bf16 v[32:47], a[200:203], v[168:171], v[32:47]
  ds_read_b128 v[208:211], v0 offset:53248
  ds_read_b128 v[212:215], v0 offset:54272
  v_rcp_f32 v52, v52
  v_rcp_f32 v53, v53
  v_mfma_f32_16x16x32_bf16 v[120:123], v[232:235], v[236:239], v[120:123]
  ds_read_b128 v[232:235], v3 offset:10800
  ds_read_b128 v[236:239], v4 offset:432
  v_mfma_f32_32x32x16_bf16 v[32:47], a[204:207], v[172:175], v[32:47]
  buffer_store_dwordx4 v[132:135], v10, s[8:11], s28 offen offset:160
  v_rcp_f32 v54, v54
  v_rcp_f32 v55, v55
  v_mfma_f32_32x32x16_bf16 v[32:47], a[208:211], v[176:179], v[32:47]
  v_rcp_f32 v56, v56
  v_rcp_f32 v57, v57
  v_rcp_f32_e64 v58, v58
  v_mfma_f32_32x32x16_bf16 v[32:47], a[212:215], v[180:183], v[32:47]
  s_waitcnt lgkmcnt(0)
  v_rcp_f32 v59, v59
  v_rcp_f32 v60, v60
  v_rcp_f32 v61, v61
  v_rcp_f32 v62, v62
  v_rcp_f32 v63, v63
  v_pk_mul_f32 v[16:17], v[16:17], v[48:49]
  v_pk_mul_f32 v[18:19], v[18:19], v[50:51]
  v_pk_mul_f32 v[20:21], v[20:21], v[52:53]
  v_pk_mul_f32 v[22:23], v[22:23], v[54:55]
  v_pk_mul_f32 v[24:25], v[24:25], v[56:57]
  v_pk_mul_f32 v[26:27], v[26:27], v[58:59]
  v_pk_mul_f32 v[28:29], v[28:29], v[60:61]
  v_pk_mul_f32 v[30:31], v[30:31], v[62:63]
  v_pk_add_f32 v[12:13], v[12:13], v[120:121]
  v_pk_fma_f32 v[14:15], v[120:121], v[120:121], v[14:15]
  v_pk_add_f32 v[12:13], v[12:13], v[122:123]
  v_pk_fma_f32 v[14:15], v[122:123], v[122:123], v[14:15]
  v_pk_fma_f32 v[48:49], v[32:33], v[32:33], s[20:21] neg_lo:[1,0,1] neg_hi:[1,0,1]
  v_pk_fma_f32 v[50:51], v[34:35], v[34:35], s[20:21] neg_lo:[1,0,1] neg_hi:[1,0,1]
  v_pk_fma_f32 v[52:53], v[36:37], v[36:37], s[20:21] neg_lo:[1,0,1] neg_hi:[1,0,1]
  v_pk_fma_f32 v[54:55], v[38:39], v[38:39], s[20:21] neg_lo:[1,0,1] neg_hi:[1,0,1]
  v_pk_fma_f32 v[56:57], v[40:41], v[40:41], s[20:21] neg_lo:[1,0,1] neg_hi:[1,0,1]
  v_pk_fma_f32 v[58:59], v[42:43], v[42:43], s[20:21] neg_lo:[1,0,1] neg_hi:[1,0,1]
  v_pk_fma_f32 v[60:61], v[44:45], v[44:45], s[20:21] neg_lo:[1,0,1] neg_hi:[1,0,1]
  v_pk_fma_f32 v[62:63], v[46:47], v[46:47], s[20:21] neg_lo:[1,0,1] neg_hi:[1,0,1]
  v_pk_mul_f32 v[48:49], v[32:33], v[48:49]
  v_pk_mul_f32 v[50:51], v[34:35], v[50:51]
  v_pk_mul_f32 v[52:53], v[36:37], v[52:53]
  v_pk_mul_f32 v[54:55], v[38:39], v[54:55]
  v_pk_mul_f32 v[56:57], v[40:41], v[56:57]
  v_pk_mul_f32 v[58:59], v[42:43], v[58:59]
  v_pk_mul_f32 v[60:61], v[44:45], v[60:61]
  v_pk_mul_f32 v[62:63], v[46:47], v[62:63]
  v_mfma_f32_16x16x32_bf16 v[124:127], v[216:219], v[220:223], 0
  v_cvt_pk_bf16_f32 v184, v16, v17
  v_cvt_pk_bf16_f32 v185, v18, v19
  v_mfma_f32_16x16x32_bf16 v[124:127], v[224:227], v[228:231], v[124:127]
  v_cvt_pk_bf16_f32 v186, v20, v21
  v_cvt_pk_bf16_f32 v187, v22, v23
  v_mfma_f32_16x16x32_bf16 v[124:127], v[232:235], v[236:239], v[124:127]
  ds_read_b128 v[216:219], v3 offset:1600
  ds_read_b128 v[220:223], v4 offset:64
  v_mfma_f32_32x32x16_bf16 v[64:79], v[192:195], v[184:187], v[64:79]
  ds_read_b128 v[224:227], v3 offset:6400
  ds_read_b128 v[228:231], v4 offset:256
  v_cvt_pk_bf16_f32 v188, v24, v25
  v_cvt_pk_bf16_f32 v189, v26, v27
  v_cvt_pk_bf16_f32 v190, v28, v29
  v_cvt_pk_bf16_f32 v191, v30, v31
  v_mfma_f32_32x32x16_bf16 v[80:95], v[196:199], v[184:187], v[80:95]
  ds_read_b128 v[232:235], v3 offset:11200
  ds_read_b128 v[236:239], v4 offset:448
  v_exp_f32 v48, v48
  v_exp_f32 v49, v49
  v_mfma_f32_32x32x16_bf16 v[96:111], v[200:203], v[184:187], v[96:111]
  v_exp_f32 v50, v50
  v_exp_f32 v51, v51
  v_exp_f32_e64 v52, v52
  v_mfma_f32_32x32x16_bf16 v[64:79], v[204:207], v[188:191], v[64:79]
  v_exp_f32 v53, v53
  v_exp_f32 v54, v54
  v_exp_f32_e64 v55, v55
  v_mfma_f32_32x32x16_bf16 v[80:95], v[208:211], v[188:191], v[80:95]
  v_exp_f32 v56, v56
  v_exp_f32 v57, v57
  v_exp_f32_e64 v58, v58
  v_mfma_f32_32x32x16_bf16 v[96:111], v[212:215], v[188:191], v[96:111]
  s_waitcnt lgkmcnt(0)
  v_exp_f32 v59, v59
  v_exp_f32 v60, v60
  v_exp_f32 v61, v61
  v_exp_f32 v62, v62
  v_exp_f32 v63, v63
  v_pk_add_f32 v[12:13], v[12:13], v[124:125]
  v_pk_fma_f32 v[14:15], v[124:125], v[124:125], v[14:15]
  v_pk_add_f32 v[12:13], v[12:13], v[126:127]
  v_pk_fma_f32 v[14:15], v[126:127], v[126:127], v[14:15]
  v_pk_fma_f32 v[48:49], v[48:49], s[22:23], s[22:23]
  v_pk_fma_f32 v[50:51], v[50:51], s[22:23], s[22:23]
  v_pk_fma_f32 v[52:53], v[52:53], s[22:23], s[22:23]
  v_pk_fma_f32 v[54:55], v[54:55], s[22:23], s[22:23]
  v_pk_fma_f32 v[56:57], v[56:57], s[22:23], s[22:23]
  v_pk_fma_f32 v[58:59], v[58:59], s[22:23], s[22:23]
  v_pk_fma_f32 v[60:61], v[60:61], s[22:23], s[22:23]
  v_pk_fma_f32 v[62:63], v[62:63], s[22:23], s[22:23]
  v_mfma_f32_32x32x16_bf16 v[16:31], a[216:219], v[160:163], 0
  ds_read_b128 v[192:195], v0 offset:55296
  ds_read_b128 v[196:199], v0 offset:56320
  v_rcp_f32 v48, v48
  v_rcp_f32 v49, v49
  v_mfma_f32_16x16x32_bf16 v[128:131], v[216:219], v[220:223], 0
  ds_read_b128 v[216:219], v3 offset:2000
  ds_read_b128 v[220:223], v4 offset:80
  v_mfma_f32_32x32x16_bf16 v[16:31], a[220:223], v[164:167], v[16:31]
  ds_read_b128 v[200:203], v0 offset:57344
  ds_read_b128 v[204:207], v0 offset:58368
  v_rcp_f32 v50, v50
  v_rcp_f32 v51, v51
  v_mfma_f32_16x16x32_bf16 v[128:131], v[224:227], v[228:231], v[128:131]
  ds_read_b128 v[224:227], v3 offset:6800
  ds_read_b128 v[228:231], v4 offset:272
  v_mfma_f32_32x32x16_bf16 v[16:31], a[224:227], v[168:171], v[16:31]
  ds_read_b128 v[208:211], v0 offset:59392
  ds_read_b128 v[212:215], v0 offset:60416
  v_rcp_f32 v52, v52
  v_rcp_f32 v53, v53
  v_mfma_f32_16x16x32_bf16 v[128:131], v[232:235], v[236:239], v[128:131]
  ds_read_b128 v[232:235], v3 offset:11600
  ds_read_b128 v[236:239], v4 offset:464
  v_mfma_f32_32x32x16_bf16 v[16:31], a[228:231], v[172:175], v[16:31]
  v_rcp_f32 v54, v54
  v_rcp_f32 v55, v55
  v_rcp_f32_e64 v56, v56
  v_mfma_f32_32x32x16_bf16 v[16:31], a[232:235], v[176:179], v[16:31]
  v_rcp_f32 v57, v57
  v_rcp_f32 v58, v58
  v_rcp_f32_e64 v59, v59
  v_mfma_f32_32x32x16_bf16 v[16:31], a[236:239], v[180:183], v[16:31]
  s_waitcnt lgkmcnt(0)
  v_rcp_f32 v60, v60
  v_rcp_f32 v61, v61
  v_rcp_f32 v62, v62
  v_rcp_f32_e64 v63, v63
  v_pk_mul_f32 v[32:33], v[32:33], v[48:49]
  v_pk_mul_f32 v[34:35], v[34:35], v[50:51]
  v_pk_mul_f32 v[36:37], v[36:37], v[52:53]
  v_pk_mul_f32 v[38:39], v[38:39], v[54:55]
  v_pk_mul_f32 v[40:41], v[40:41], v[56:57]
  v_pk_mul_f32 v[42:43], v[42:43], v[58:59]
  v_pk_mul_f32 v[44:45], v[44:45], v[60:61]
  v_pk_mul_f32 v[46:47], v[46:47], v[62:63]
  v_pk_add_f32 v[12:13], v[12:13], v[128:129]
  v_pk_fma_f32 v[14:15], v[128:129], v[128:129], v[14:15]
  v_pk_add_f32 v[12:13], v[12:13], v[130:131]
  v_pk_fma_f32 v[14:15], v[130:131], v[130:131], v[14:15]
  v_pk_fma_f32 v[48:49], v[16:17], v[16:17], s[20:21] neg_lo:[1,0,1] neg_hi:[1,0,1]
  v_pk_fma_f32 v[50:51], v[18:19], v[18:19], s[20:21] neg_lo:[1,0,1] neg_hi:[1,0,1]
  v_pk_fma_f32 v[52:53], v[20:21], v[20:21], s[20:21] neg_lo:[1,0,1] neg_hi:[1,0,1]
  v_pk_fma_f32 v[54:55], v[22:23], v[22:23], s[20:21] neg_lo:[1,0,1] neg_hi:[1,0,1]
  v_pk_fma_f32 v[56:57], v[24:25], v[24:25], s[20:21] neg_lo:[1,0,1] neg_hi:[1,0,1]
  v_pk_fma_f32 v[58:59], v[26:27], v[26:27], s[20:21] neg_lo:[1,0,1] neg_hi:[1,0,1]
  v_pk_fma_f32 v[60:61], v[28:29], v[28:29], s[20:21] neg_lo:[1,0,1] neg_hi:[1,0,1]
  v_pk_fma_f32 v[62:63], v[30:31], v[30:31], s[20:21] neg_lo:[1,0,1] neg_hi:[1,0,1]
  v_pk_mul_f32 v[48:49], v[16:17], v[48:49]
  v_pk_mul_f32 v[50:51], v[18:19], v[50:51]
  v_pk_mul_f32 v[52:53], v[20:21], v[52:53]
  v_pk_mul_f32 v[54:55], v[22:23], v[54:55]
  v_pk_mul_f32 v[56:57], v[24:25], v[56:57]
  v_pk_mul_f32 v[58:59], v[26:27], v[58:59]
  v_pk_mul_f32 v[60:61], v[28:29], v[60:61]
  v_pk_mul_f32 v[62:63], v[30:31], v[62:63]
  v_mfma_f32_16x16x32_bf16 v[132:135], v[216:219], v[220:223], 0
  v_cvt_pk_bf16_f32 v184, v32, v33
  v_cvt_pk_bf16_f32 v185, v34, v35
  v_mfma_f32_16x16x32_bf16 v[132:135], v[224:227], v[228:231], v[132:135]
  v_cvt_pk_bf16_f32 v186, v36, v37
  v_cvt_pk_bf16_f32 v187, v38, v39
  v_mfma_f32_16x16x32_bf16 v[132:135], v[232:235], v[236:239], v[132:135]
  ds_read_b128 v[216:219], v0 offset:12288
  ds_read_b128 v[220:223], v0 offset:13312
  v_mfma_f32_32x32x16_bf16 v[64:79], v[192:195], v[184:187], v[64:79]
  ds_read_b128 v[224:227], v0 offset:14336
  ds_read_b128 v[228:231], v0 offset:15360
  v_cvt_pk_bf16_f32 v188, v40, v41
  v_cvt_pk_bf16_f32 v189, v42, v43
  v_cvt_pk_bf16_f32 v190, v44, v45
  v_cvt_pk_bf16_f32 v191, v46, v47
  v_mfma_f32_32x32x16_bf16 v[80:95], v[196:199], v[184:187], v[80:95]
  ds_read_b128 v[232:235], v0 offset:16384
  ds_read_b128 v[236:239], v0 offset:17408
  v_exp_f32 v48, v48
  v_exp_f32 v49, v49
  v_mfma_f32_32x32x16_bf16 v[96:111], v[200:203], v[184:187], v[96:111]
  v_exp_f32 v50, v50
  v_exp_f32 v51, v51
  v_exp_f32_e64 v52, v52
  v_mfma_f32_32x32x16_bf16 v[64:79], v[204:207], v[188:191], v[64:79]
  s_mov_b32 s28, s34
  v_exp_f32 v53, v53
  v_exp_f32 v54, v54
  v_exp_f32 v55, v55
  v_mfma_f32_32x32x16_bf16 v[80:95], v[208:211], v[188:191], v[80:95]
  s_add_u32 s34, s34, 0x60000
  v_exp_f32 v56, v56
  v_exp_f32 v57, v57
  v_exp_f32_e64 v58, v58
  v_mfma_f32_32x32x16_bf16 v[96:111], v[212:215], v[188:191], v[96:111]
  s_waitcnt lgkmcnt(0)
  v_exp_f32 v59, v59
  v_exp_f32 v60, v60
  v_exp_f32 v61, v61
  v_exp_f32 v62, v62
  v_exp_f32 v63, v63
  v_pk_add_f32 v[12:13], v[12:13], v[132:133]
  v_pk_fma_f32 v[14:15], v[132:133], v[132:133], v[14:15]
  v_pk_add_f32 v[12:13], v[12:13], v[134:135]
  v_pk_fma_f32 v[14:15], v[134:135], v[134:135], v[14:15]
  v_pk_fma_f32 v[48:49], v[48:49], s[22:23], s[22:23]
  v_pk_fma_f32 v[50:51], v[50:51], s[22:23], s[22:23]
  v_pk_fma_f32 v[52:53], v[52:53], s[22:23], s[22:23]
  v_pk_fma_f32 v[54:55], v[54:55], s[22:23], s[22:23]
  v_pk_fma_f32 v[56:57], v[56:57], s[22:23], s[22:23]
  v_pk_fma_f32 v[58:59], v[58:59], s[22:23], s[22:23]
  v_pk_fma_f32 v[60:61], v[60:61], s[22:23], s[22:23]
  v_pk_fma_f32 v[62:63], v[62:63], s[22:23], s[22:23]
  v_mfma_f32_32x32x16_bf16 v[32:47], v[216:219], v[160:163], 0
  ds_read_b128 v[192:195], v0 offset:61440
  ds_read_b128 v[196:199], v0 offset:62464
  v_rcp_f32 v48, v48
  v_rcp_f32 v49, v49
  v_add_f32_e64 v12, v12, v13
  v_mfma_f32_32x32x16_bf16 v[32:47], v[220:223], v[164:167], v[32:47]
  ds_read_b128 v[200:203], v0 offset:63488
  ds_read_b128 v[204:207], v0 offset:64512
  v_rcp_f32 v50, v50
  v_add_f32 v14, v14, v15
  v_rcp_f32_e64 v51, v51
  v_mfma_f32_32x32x16_bf16 v[32:47], v[224:227], v[168:171], v[32:47]
  ds_read_b128 v[208:211], v1
  ds_read_b128 v[212:215], v1 offset:1024
  v_permlane32_swap_b32 v12, v14
  v_rcp_f32 v52, v52
  v_add_f32 v12, v12, v14
  v_rcp_f32 v53, v53
  v_mfma_f32_32x32x16_bf16 v[32:47], v[228:231], v[172:175], v[32:47]
  v_mov_b32 v14, v12
  v_rcp_f32 v54, v54
  s_nop 0
  v_permlane32_swap_b32 v12, v14
  v_rcp_f32 v55, v55
  v_mul_f32 v12, s24, v12
  v_mfma_f32_32x32x16_bf16 v[32:47], v[232:235], v[176:179], v[32:47]
  v_rcp_f32 v56, v56
  v_rcp_f32 v57, v57
  v_mul_f32 v13, s24, v14
  v_rcp_f32 v58, v58
  v_fma_f32 v13, -v12, v12, v13
  v_mfma_f32_32x32x16_bf16 v[32:47], v[236:239], v[180:183], v[32:47]
  s_waitcnt lgkmcnt(0)
  v_rcp_f32 v59, v59
  v_max_f32 v13, 0, v13
  v_rcp_f32 v60, v60
  v_add_f32 v13, s25, v13
  v_rcp_f32 v61, v61
  v_rsq_f32 v13, v13
  v_rcp_f32 v62, v62
  v_mul_f32 v14, s22, v13
  v_rcp_f32 v63, v63
  v_mul_f32_e64 v12, -v12, v14
  v_pk_mul_f32 v[16:17], v[16:17], v[48:49]
  v_pk_mul_f32 v[18:19], v[18:19], v[50:51]
  v_pk_mul_f32 v[20:21], v[20:21], v[52:53]
  v_pk_mul_f32 v[22:23], v[22:23], v[54:55]
  v_pk_mul_f32 v[24:25], v[24:25], v[56:57]
  v_pk_mul_f32 v[26:27], v[26:27], v[58:59]
  v_pk_mul_f32 v[28:29], v[28:29], v[60:61]
  v_pk_mul_f32 v[30:31], v[30:31], v[62:63]
  v_pk_fma_f32 v[112:113], v[112:113], v[14:15], v[12:13] op_sel_hi:[1,0,0]
  v_pk_fma_f32 v[114:115], v[114:115], v[14:15], v[12:13] op_sel_hi:[1,0,0]
  v_pk_fma_f32 v[116:117], v[116:117], v[14:15], v[12:13] op_sel_hi:[1,0,0]
  v_pk_fma_f32 v[118:119], v[118:119], v[14:15], v[12:13] op_sel_hi:[1,0,0]
  v_pk_fma_f32 v[120:121], v[120:121], v[14:15], v[12:13] op_sel_hi:[1,0,0]
  v_pk_fma_f32 v[122:123], v[122:123], v[14:15], v[12:13] op_sel_hi:[1,0,0]
  v_pk_fma_f32 v[124:125], v[124:125], v[14:15], v[12:13] op_sel_hi:[1,0,0]
  v_pk_fma_f32 v[126:127], v[126:127], v[14:15], v[12:13] op_sel_hi:[1,0,0]
  v_pk_fma_f32 v[128:129], v[128:129], v[14:15], v[12:13] op_sel_hi:[1,0,0]
  v_pk_fma_f32 v[130:131], v[130:131], v[14:15], v[12:13] op_sel_hi:[1,0,0]
  v_pk_fma_f32 v[132:133], v[132:133], v[14:15], v[12:13] op_sel_hi:[1,0,0]
  v_pk_fma_f32 v[134:135], v[134:135], v[14:15], v[12:13] op_sel_hi:[1,0,0]
  v_pk_fma_f32 v[136:137], v[136:137], v[14:15], v[12:13] op_sel_hi:[1,0,0]
  v_pk_fma_f32 v[138:139], v[138:139], v[14:15], v[12:13] op_sel_hi:[1,0,0]
  v_pk_fma_f32 v[140:141], v[140:141], v[14:15], v[12:13] op_sel_hi:[1,0,0]
  v_pk_fma_f32 v[142:143], v[142:143], v[14:15], v[12:13] op_sel_hi:[1,0,0]
  v_pk_fma_f32 v[144:145], v[144:145], v[14:15], v[12:13] op_sel_hi:[1,0,0]
  v_pk_fma_f32 v[146:147], v[146:147], v[14:15], v[12:13] op_sel_hi:[1,0,0]
  v_pk_fma_f32 v[148:149], v[148:149], v[14:15], v[12:13] op_sel_hi:[1,0,0]
  v_pk_fma_f32 v[150:151], v[150:151], v[14:15], v[12:13] op_sel_hi:[1,0,0]
  v_pk_fma_f32 v[152:153], v[152:153], v[14:15], v[12:13] op_sel_hi:[1,0,0]
  v_pk_fma_f32 v[154:155], v[154:155], v[14:15], v[12:13] op_sel_hi:[1,0,0]
  v_pk_fma_f32 v[156:157], v[156:157], v[14:15], v[12:13] op_sel_hi:[1,0,0]
  v_pk_fma_f32 v[158:159], v[158:159], v[14:15], v[12:13] op_sel_hi:[1,0,0]
  v_pk_fma_f32 v[48:49], v[32:33], v[32:33], s[20:21] neg_lo:[1,0,1] neg_hi:[1,0,1]
  v_pk_fma_f32 v[50:51], v[34:35], v[34:35], s[20:21] neg_lo:[1,0,1] neg_hi:[1,0,1]
  v_pk_fma_f32 v[52:53], v[36:37], v[36:37], s[20:21] neg_lo:[1,0,1] neg_hi:[1,0,1]
  v_pk_fma_f32 v[54:55], v[38:39], v[38:39], s[20:21] neg_lo:[1,0,1] neg_hi:[1,0,1]
  v_pk_fma_f32 v[56:57], v[40:41], v[40:41], s[20:21] neg_lo:[1,0,1] neg_hi:[1,0,1]
  v_pk_fma_f32 v[58:59], v[42:43], v[42:43], s[20:21] neg_lo:[1,0,1] neg_hi:[1,0,1]
  v_pk_fma_f32 v[60:61], v[44:45], v[44:45], s[20:21] neg_lo:[1,0,1] neg_hi:[1,0,1]
  v_pk_fma_f32 v[62:63], v[46:47], v[46:47], s[20:21] neg_lo:[1,0,1] neg_hi:[1,0,1]
  v_pk_mul_f32 v[48:49], v[32:33], v[48:49]
  v_pk_mul_f32 v[50:51], v[34:35], v[50:51]
  v_pk_mul_f32 v[52:53], v[36:37], v[52:53]
  v_pk_mul_f32 v[54:55], v[38:39], v[54:55]
  v_pk_mul_f32 v[56:57], v[40:41], v[56:57]
  v_cvt_pk_bf16_f32 v184, v16, v17
  v_cvt_pk_bf16_f32 v185, v18, v19
  v_cvt_pk_bf16_f32 v186, v20, v21
  v_cvt_pk_bf16_f32 v187, v22, v23
  v_pk_mul_f32 v[58:59], v[42:43], v[58:59]
  v_pk_mul_f32 v[60:61], v[44:45], v[60:61]
  v_pk_mul_f32 v[62:63], v[46:47], v[62:63]
  v_mfma_f32_32x32x16_bf16 v[64:79], v[192:195], v[184:187], v[64:79]
  ds_read_b128 v[216:219], v0 offset:18432
  ds_read_b128 v[220:223], v0 offset:19456
  v_cvt_pk_bf16_f32 v188, v24, v25
  v_cvt_pk_bf16_f32 v189, v26, v27
  v_cvt_pk_bf16_f32 v190, v28, v29
  v_cvt_pk_bf16_f32 v191, v30, v31
  v_exp_f32_e64 v48, v48
  v_cndmask_b32 v159, v159, v250, s[12:13]
  v_mfma_f32_32x32x16_bf16 v[80:95], v[196:199], v[184:187], v[80:95]
  ds_read_b128 v[224:227], v0 offset:20480
  ds_read_b128 v[228:231], v0 offset:21504
  v_exp_f32_e64 v49, v49
  v_cvt_pk_bf16_f32 v160, v112, v113
  v_cvt_pk_bf16_f32 v161, v114, v115
  v_exp_f32_e64 v50, v50
  v_cvt_pk_bf16_f32 v162, v116, v117
  v_mfma_f32_32x32x16_bf16 v[96:111], v[200:203], v[184:187], v[96:111]
  ds_read_b128 v[232:235], v0 offset:22528
  ds_read_b128 v[236:239], v0 offset:23552
  v_exp_f32_e64 v51, v51
  v_cvt_pk_bf16_f32 v163, v118, v119
  v_cvt_pk_bf16_f32 v164, v120, v121
  v_exp_f32_e64 v52, v52
  v_cvt_pk_bf16_f32 v165, v122, v123
  v_mfma_f32_32x32x16_bf16 v[64:79], v[204:207], v[188:191], v[64:79]
  v_exp_f32_e64 v53, v53
  v_cvt_pk_bf16_f32 v166, v124, v125
  v_cvt_pk_bf16_f32 v167, v126, v127
  v_exp_f32_e64 v54, v54
  v_cvt_pk_bf16_f32 v168, v128, v129
  v_exp_f32_e64 v55, v55
  v_cvt_pk_bf16_f32 v169, v130, v131
  v_cvt_pk_bf16_f32 v170, v132, v133
  v_mfma_f32_32x32x16_bf16 v[80:95], v[208:211], v[188:191], v[80:95]
  v_exp_f32_e64 v56, v56
  v_cvt_pk_bf16_f32 v171, v134, v135
  v_cvt_pk_bf16_f32 v172, v136, v137
  v_exp_f32_e64 v57, v57
  v_cvt_pk_bf16_f32 v173, v138, v139
  v_exp_f32_e64 v58, v58
  v_cvt_pk_bf16_f32 v174, v140, v141
  v_cvt_pk_bf16_f32 v175, v142, v143
  v_mfma_f32_32x32x16_bf16 v[96:111], v[212:215], v[188:191], v[96:111]
  s_waitcnt lgkmcnt(0)
  v_exp_f32 v59, v59
  v_cvt_pk_bf16_f32 v176, v144, v145
  v_exp_f32_e64 v60, v60
  v_cvt_pk_bf16_f32 v177, v146, v147
  v_cvt_pk_bf16_f32 v178, v148, v149
  v_exp_f32_e64 v61, v61
  v_cvt_pk_bf16_f32 v179, v150, v151
  v_exp_f32_e64 v62, v62
  v_cvt_pk_bf16_f32 v180, v152, v153
  v_cvt_pk_bf16_f32 v181, v154, v155
  v_exp_f32_e64 v63, v63
  v_cvt_pk_bf16_f32 v182, v156, v157
  v_cvt_pk_bf16_f32 v183, v158, v159
  v_pk_fma_f32 v[48:49], v[48:49], s[22:23], s[22:23]
  v_pk_fma_f32 v[50:51], v[50:51], s[22:23], s[22:23]
  v_pk_fma_f32 v[52:53], v[52:53], s[22:23], s[22:23]
  v_pk_fma_f32 v[54:55], v[54:55], s[22:23], s[22:23]
  v_pk_fma_f32 v[56:57], v[56:57], s[22:23], s[22:23]
  v_pk_fma_f32 v[58:59], v[58:59], s[22:23], s[22:23]
  v_pk_fma_f32 v[60:61], v[60:61], s[22:23], s[22:23]
  v_pk_fma_f32 v[62:63], v[62:63], s[22:23], s[22:23]
  s_sub_u32 s26, s26, 1
  s_cmp_lg_u32 s26, 0
  s_waitcnt vmcnt(4)
  s_cbranch_scc1 S_loop
  v_mfma_f32_32x32x16_bf16 v[16:31], v[216:219], v[160:163], 0
  ds_read_b128 v[192:195], v1 offset:2048
  ds_read_b128 v[196:199], v1 offset:3072
  ds_read_b128 v[200:203], v1 offset:4096
  v_rcp_f32 v48, v48
  v_rcp_f32 v49, v49
  v_mfma_f32_32x32x16_bf16 v[16:31], v[220:223], v[164:167], v[16:31]
  ds_read_b128 v[204:207], v1 offset:5120
  ds_read_b128 v[208:211], v1 offset:6144
  ds_read_b128 v[212:215], v1 offset:7168
  v_rcp_f32 v50, v50
  v_rcp_f32 v51, v51
  v_mfma_f32_32x32x16_bf16 v[16:31], v[224:227], v[168:171], v[16:31]
  ds_read_b128 v[136:139], v5
  ds_read_b128 v[140:143], v5 offset:32
  ds_read_b128 v[144:147], v5 offset:64
  v_rcp_f32 v52, v52
  v_rcp_f32 v53, v53
  v_mfma_f32_32x32x16_bf16 v[16:31], v[228:231], v[172:175], v[16:31]
  ds_read_b128 v[148:151], v5 offset:96
  ds_read_b128 v[152:155], v5 offset:128
  ds_read_b128 v[156:159], v5 offset:160
  v_rcp_f32 v54, v54
  v_rcp_f32 v55, v55
  v_mfma_f32_32x32x16_bf16 v[16:31], v[232:235], v[176:179], v[16:31]
  v_rcp_f32 v56, v56
  v_rcp_f32 v57, v57
  v_rcp_f32_e64 v58, v58
  v_mfma_f32_32x32x16_bf16 v[16:31], v[236:239], v[180:183], v[16:31]
  s_waitcnt lgkmcnt(0)
  v_rcp_f32 v59, v59
  v_rcp_f32 v60, v60
  v_rcp_f32 v61, v61
  v_rcp_f32 v62, v62
  v_rcp_f32 v63, v63
  v_pk_mul_f32 v[32:33], v[32:33], v[48:49]
  v_pk_mul_f32 v[34:35], v[34:35], v[50:51]
  v_pk_mul_f32 v[36:37], v[36:37], v[52:53]
  v_pk_mul_f32 v[38:39], v[38:39], v[54:55]
  v_pk_mul_f32 v[40:41], v[40:41], v[56:57]
  v_pk_mul_f32 v[42:43], v[42:43], v[58:59]
  v_pk_mul_f32 v[44:45], v[44:45], v[60:61]
  v_pk_mul_f32 v[46:47], v[46:47], v[62:63]
  v_pk_fma_f32 v[48:49], v[16:17], v[16:17], s[20:21] neg_lo:[1,0,1] neg_hi:[1,0,1]
  v_pk_fma_f32 v[50:51], v[18:19], v[18:19], s[20:21] neg_lo:[1,0,1] neg_hi:[1,0,1]
  v_pk_fma_f32 v[52:53], v[20:21], v[20:21], s[20:21] neg_lo:[1,0,1] neg_hi:[1,0,1]
  v_pk_fma_f32 v[54:55], v[22:23], v[22:23], s[20:21] neg_lo:[1,0,1] neg_hi:[1,0,1]
  v_pk_fma_f32 v[56:57], v[24:25], v[24:25], s[20:21] neg_lo:[1,0,1] neg_hi:[1,0,1]
  v_pk_fma_f32 v[58:59], v[26:27], v[26:27], s[20:21] neg_lo:[1,0,1] neg_hi:[1,0,1]
  v_pk_fma_f32 v[60:61], v[28:29], v[28:29], s[20:21] neg_lo:[1,0,1] neg_hi:[1,0,1]
  v_pk_fma_f32 v[62:63], v[30:31], v[30:31], s[20:21] neg_lo:[1,0,1] neg_hi:[1,0,1]
  v_pk_mul_f32 v[48:49], v[16:17], v[48:49]
  v_pk_mul_f32 v[50:51], v[18:19], v[50:51]
  v_pk_mul_f32 v[52:53], v[20:21], v[52:53]
  v_pk_mul_f32 v[54:55], v[22:23], v[54:55]
  v_pk_mul_f32 v[56:57], v[24:25], v[56:57]
  v_cvt_pk_bf16_f32 v184, v32, v33
  v_cvt_pk_bf16_f32 v185, v34, v35
  v_cvt_pk_bf16_f32 v186, v36, v37
  v_cvt_pk_bf16_f32 v187, v38, v39
  v_pk_mul_f32 v[58:59], v[26:27], v[58:59]
  v_pk_mul_f32 v[60:61], v[28:29], v[60:61]
  v_pk_mul_f32 v[62:63], v[30:31], v[62:63]
  v_mfma_f32_32x32x16_bf16 v[64:79], v[192:195], v[184:187], v[64:79]
  v_cvt_pk_bf16_f32 v188, v40, v41
  v_cvt_pk_bf16_f32 v189, v42, v43
  v_cvt_pk_bf16_f32 v190, v44, v45
  v_cvt_pk_bf16_f32 v191, v46, v47
  v_exp_f32_e64 v48, v48
  v_mfma_f32_32x32x16_bf16 v[80:95], v[196:199], v[184:187], v[80:95]
  v_exp_f32 v49, v49
  v_exp_f32 v50, v50
  v_exp_f32_e64 v51, v51
  v_mfma_f32_32x32x16_bf16 v[96:111], v[200:203], v[184:187], v[96:111]
  v_exp_f32 v52, v52
  v_exp_f32 v53, v53
  v_exp_f32_e64 v54, v54
  v_mfma_f32_32x32x16_bf16 v[64:79], v[204:207], v[188:191], v[64:79]
  v_exp_f32 v55, v55
  v_exp_f32 v56, v56
  v_exp_f32_e64 v57, v57
  v_mfma_f32_32x32x16_bf16 v[80:95], v[208:211], v[188:191], v[80:95]
  v_exp_f32_e64 v58, v58
  v_exp_f32_e64 v59, v59
  v_exp_f32_e64 v60, v60
  v_mfma_f32_32x32x16_bf16 v[96:111], v[212:215], v[188:191], v[96:111]
  v_exp_f32_e64 v61, v61
  v_exp_f32_e64 v62, v62
  v_exp_f32_e64 v63, v63
  v_pk_fma_f32 v[48:49], v[48:49], s[22:23], s[22:23]
  v_pk_fma_f32 v[50:51], v[50:51], s[22:23], s[22:23]
  v_pk_fma_f32 v[52:53], v[52:53], s[22:23], s[22:23]
  v_pk_fma_f32 v[54:55], v[54:55], s[22:23], s[22:23]
  v_pk_fma_f32 v[56:57], v[56:57], s[22:23], s[22:23]
  v_pk_fma_f32 v[58:59], v[58:59], s[22:23], s[22:23]
  v_pk_fma_f32 v[60:61], v[60:61], s[22:23], s[22:23]
  v_pk_fma_f32 v[62:63], v[62:63], s[22:23], s[22:23]
  v_mfma_f32_32x32x16_bf16 v[32:47], a[0:3], v[160:163], 0
  v_cvt_pk_bf16_f32 v112, v64, v65
  v_cvt_pk_bf16_f32 v113, v66, v67
  v_cvt_pk_bf16_f32 v114, v68, v69
  v_cvt_pk_bf16_f32 v115, v70, v71
  v_cvt_pk_bf16_f32 v116, v72, v73
  v_cvt_pk_bf16_f32 v117, v74, v75
  v_mfma_f32_32x32x16_bf16 v[32:47], a[4:7], v[164:167], v[32:47]
  v_cvt_pk_bf16_f32 v118, v76, v77
  v_cvt_pk_bf16_f32 v119, v78, v79
  v_cvt_pk_bf16_f32 v120, v80, v81
  v_cvt_pk_bf16_f32 v121, v82, v83
  v_cvt_pk_bf16_f32 v122, v84, v85
  v_cvt_pk_bf16_f32 v123, v86, v87
  v_mfma_f32_32x32x16_bf16 v[32:47], a[8:11], v[168:171], v[32:47]
  ds_read_b128 v[64:67], v2
  ds_read_b128 v[68:71], v2 offset:32
  ds_read_b128 v[72:75], v2 offset:64
  ds_read_b128 v[76:79], v2 offset:96
  v_cvt_pk_bf16_f32 v124, v88, v89
  v_cvt_pk_bf16_f32 v125, v90, v91
  v_mfma_f32_32x32x16_bf16 v[32:47], a[12:15], v[172:175], v[32:47]
  ds_read_b128 v[192:195], v1 offset:8192
  ds_read_b128 v[196:199], v1 offset:9216
  v_cvt_pk_bf16_f32 v126, v92, v93
  v_cvt_pk_bf16_f32 v127, v94, v95
  v_cvt_pk_bf16_f32 v128, v96, v97
  v_cvt_pk_bf16_f32 v129, v98, v99
  v_mfma_f32_32x32x16_bf16 v[32:47], a[16:19], v[176:179], v[32:47]
  ds_read_b128 v[80:83], v2 offset:128
  ds_read_b128 v[84:87], v2 offset:160
  ds_read_b128 v[88:91], v2 offset:192
  ds_read_b128 v[92:95], v2 offset:224
  v_cvt_pk_bf16_f32 v130, v100, v101
  v_cvt_pk_bf16_f32 v131, v102, v103
  v_mfma_f32_32x32x16_bf16 v[32:47], a[20:23], v[180:183], v[32:47]
  s_waitcnt lgkmcnt(6)
  ds_read_b128 v[200:203], v1 offset:10240
  ds_read_b128 v[204:207], v1 offset:11264
  v_cvt_pk_bf16_f32 v132, v104, v105
  v_cvt_pk_bf16_f32 v133, v106, v107
  v_cvt_pk_bf16_f32 v134, v108, v109
  v_cvt_pk_bf16_f32 v135, v110, v111
  v_mfma_f32_32x32x16_bf16 v[64:79], v[240:243], v[136:139], v[64:79]
  s_nop 0
  ds_read_b128 v[96:99], v2 offset:256
  ds_read_b128 v[100:103], v2 offset:288
  ds_read_b128 v[104:107], v2 offset:320
  ds_read_b128 v[108:111], v2 offset:352
  v_rcp_f32 v48, v48
  v_mfma_f32_32x32x16_bf16 v[64:79], v[244:247], v[140:143], v[64:79]
  s_waitcnt lgkmcnt(6)
  ds_read_b128 v[208:211], v1 offset:12288
  ds_read_b128 v[212:215], v1 offset:13312
  v_rcp_f32 v49, v49
  v_rcp_f32 v50, v50
  v_mfma_f32_32x32x16_bf16 v[80:95], v[240:243], v[144:147], v[80:95]
  v_rcp_f32 v51, v51
  v_rcp_f32 v52, v52
  v_rcp_f32_e64 v53, v53
  v_mfma_f32_32x32x16_bf16 v[80:95], v[244:247], v[148:151], v[80:95]
  s_waitcnt lgkmcnt(2)
  v_rcp_f32 v54, v54
  v_rcp_f32 v55, v55
  v_rcp_f32 v56, v56
  v_mfma_f32_32x32x16_bf16 v[96:111], v[240:243], v[152:155], v[96:111]
  v_rcp_f32 v57, v57
  v_rcp_f32 v58, v58
  v_rcp_f32_e64 v59, v59
  v_mfma_f32_32x32x16_bf16 v[96:111], v[244:247], v[156:159], v[96:111]
  s_waitcnt lgkmcnt(0)
  v_rcp_f32 v60, v60
  v_rcp_f32 v61, v61
  v_rcp_f32 v62, v62
  v_rcp_f32_e64 v63, v63
  v_pk_mul_f32 v[16:17], v[16:17], v[48:49]
  v_pk_mul_f32 v[18:19], v[18:19], v[50:51]
  v_pk_mul_f32 v[20:21], v[20:21], v[52:53]
  v_pk_mul_f32 v[22:23], v[22:23], v[54:55]
  v_pk_mul_f32 v[24:25], v[24:25], v[56:57]
  v_pk_mul_f32 v[26:27], v[26:27], v[58:59]
  v_pk_mul_f32 v[28:29], v[28:29], v[60:61]
  v_pk_mul_f32 v[30:31], v[30:31], v[62:63]
  v_pk_fma_f32 v[48:49], v[32:33], v[32:33], s[20:21] neg_lo:[1,0,1] neg_hi:[1,0,1]
  v_pk_fma_f32 v[50:51], v[34:35], v[34:35], s[20:21] neg_lo:[1,0,1] neg_hi:[1,0,1]
  v_pk_fma_f32 v[52:53], v[36:37], v[36:37], s[20:21] neg_lo:[1,0,1] neg_hi:[1,0,1]
  v_pk_fma_f32 v[54:55], v[38:39], v[38:39], s[20:21] neg_lo:[1,0,1] neg_hi:[1,0,1]
  v_pk_fma_f32 v[56:57], v[40:41], v[40:41], s[20:21] neg_lo:[1,0,1] neg_hi:[1,0,1]
  v_pk_fma_f32 v[58:59], v[42:43], v[42:43], s[20:21] neg_lo:[1,0,1] neg_hi:[1,0,1]
  v_pk_fma_f32 v[60:61], v[44:45], v[44:45], s[20:21] neg_lo:[1,0,1] neg_hi:[1,0,1]
  v_pk_fma_f32 v[62:63], v[46:47], v[46:47], s[20:21] neg_lo:[1,0,1] neg_hi:[1,0,1]
  v_pk_mul_f32 v[48:49], v[32:33], v[48:49]
  v_pk_mul_f32 v[50:51], v[34:35], v[50:51]
  v_pk_mul_f32 v[52:53], v[36:37], v[52:53]
  v_pk_mul_f32 v[54:55], v[38:39], v[54:55]
  v_pk_mul_f32 v[56:57], v[40:41], v[56:57]
  v_cvt_pk_bf16_f32 v184, v16, v17
  v_cvt_pk_bf16_f32 v185, v18, v19
  v_cvt_pk_bf16_f32 v186, v20, v21
  v_cvt_pk_bf16_f32 v187, v22, v23
  v_pk_mul_f32 v[58:59], v[42:43], v[58:59]
  v_pk_mul_f32 v[60:61], v[44:45], v[60:61]
  v_pk_mul_f32 v[62:63], v[46:47], v[62:63]
  v_mfma_f32_32x32x16_bf16 v[64:79], v[192:195], v[184:187], v[64:79]
  v_cvt_pk_bf16_f32 v188, v24, v25
  v_cvt_pk_bf16_f32 v189, v26, v27
  v_cvt_pk_bf16_f32 v190, v28, v29
  v_cvt_pk_bf16_f32 v191, v30, v31
  v_exp_f32_e64 v48, v48
  v_mfma_f32_32x32x16_bf16 v[80:95], v[196:199], v[184:187], v[80:95]
  v_exp_f32 v49, v49
  v_exp_f32 v50, v50
  v_exp_f32_e64 v51, v51
  v_mfma_f32_32x32x16_bf16 v[96:111], v[200:203], v[184:187], v[96:111]
  v_exp_f32 v52, v52
  v_exp_f32 v53, v53
  v_exp_f32_e64 v54, v54
  v_mfma_f32_32x32x16_bf16 v[64:79], v[204:207], v[188:191], v[64:79]
  v_exp_f32 v55, v55
  v_exp_f32 v56, v56
  v_exp_f32_e64 v57, v57
  v_mfma_f32_32x32x16_bf16 v[80:95], v[208:211], v[188:191], v[80:95]
  v_exp_f32 v58, v58
  v_exp_f32 v59, v59
  v_exp_f32_e64 v60, v60
  v_mfma_f32_32x32x16_bf16 v[96:111], v[212:215], v[188:191], v[96:111]
  v_exp_f32 v61, v61
  v_exp_f32 v62, v62
  v_exp_f32_e64 v63, v63
  v_pk_fma_f32 v[48:49], v[48:49], s[22:23], s[22:23]
  v_pk_fma_f32 v[50:51], v[50:51], s[22:23], s[22:23]
  v_pk_fma_f32 v[52:53], v[52:53], s[22:23], s[22:23]
  v_pk_fma_f32 v[54:55], v[54:55], s[22:23], s[22:23]
  v_pk_fma_f32 v[56:57], v[56:57], s[22:23], s[22:23]
  v_pk_fma_f32 v[58:59], v[58:59], s[22:23], s[22:23]
  v_pk_fma_f32 v[60:61], v[60:61], s[22:23], s[22:23]
  v_pk_fma_f32 v[62:63], v[62:63], s[22:23], s[22:23]
  v_mfma_f32_32x32x16_bf16 v[16:31], a[24:27], v[160:163], 0
  ds_read_b128 v[192:195], v1 offset:14336
  ds_read_b128 v[196:199], v1 offset:15360
  v_rcp_f32 v48, v48
  v_rcp_f32 v49, v49
  v_mfma_f32_32x32x16_bf16 v[16:31], a[28:31], v[164:167], v[16:31]
  ds_read_b128 v[200:203], v1 offset:16384
  ds_read_b128 v[204:207], v1 offset:17408
  v_rcp_f32 v50, v50
  v_rcp_f32 v51, v51
  v_mfma_f32_32x32x16_bf16 v[16:31], a[32:35], v[168:171], v[16:31]
  ds_read_b128 v[208:211], v1 offset:18432
  ds_read_b128 v[212:215], v1 offset:19456
  v_rcp_f32 v52, v52
  v_rcp_f32 v53, v53
  v_mfma_f32_32x32x16_bf16 v[16:31], a[36:39], v[172:175], v[16:31]
  buffer_store_dwordx4 v[112:115], v10, s[8:11], s28 offen
  v_rcp_f32 v54, v54
  v_rcp_f32 v55, v55
  v_mfma_f32_32x32x16_bf16 v[16:31], a[40:43], v[176:179], v[16:31]
  v_rcp_f32 v56, v56
  v_rcp_f32 v57, v57
  v_rcp_f32_e64 v58, v58
  v_mfma_f32_32x32x16_bf16 v[16:31], a[44:47], v[180:183], v[16:31]
  s_waitcnt lgkmcnt(0)
  v_rcp_f32 v59, v59
  v_rcp_f32 v60, v60
  v_rcp_f32 v61, v61
  v_rcp_f32 v62, v62
  v_rcp_f32 v63, v63
  v_pk_mul_f32 v[32:33], v[32:33], v[48:49]
  v_pk_mul_f32 v[34:35], v[34:35], v[50:51]
  v_pk_mul_f32 v[36:37], v[36:37], v[52:53]
  v_pk_mul_f32 v[38:39], v[38:39], v[54:55]
  v_pk_mul_f32 v[40:41], v[40:41], v[56:57]
  v_pk_mul_f32 v[42:43], v[42:43], v[58:59]
  v_pk_mul_f32 v[44:45], v[44:45], v[60:61]
  v_pk_mul_f32 v[46:47], v[46:47], v[62:63]
  v_pk_fma_f32 v[48:49], v[16:17], v[16:17], s[20:21] neg_lo:[1,0,1] neg_hi:[1,0,1]
  v_pk_fma_f32 v[50:51], v[18:19], v[18:19], s[20:21] neg_lo:[1,0,1] neg_hi:[1,0,1]
  v_pk_fma_f32 v[52:53], v[20:21], v[20:21], s[20:21] neg_lo:[1,0,1] neg_hi:[1,0,1]
  v_pk_fma_f32 v[54:55], v[22:23], v[22:23], s[20:21] neg_lo:[1,0,1] neg_hi:[1,0,1]
  v_pk_fma_f32 v[56:57], v[24:25], v[24:25], s[20:21] neg_lo:[1,0,1] neg_hi:[1,0,1]
  v_pk_fma_f32 v[58:59], v[26:27], v[26:27], s[20:21] neg_lo:[1,0,1] neg_hi:[1,0,1]
  v_pk_fma_f32 v[60:61], v[28:29], v[28:29], s[20:21] neg_lo:[1,0,1] neg_hi:[1,0,1]
  v_pk_fma_f32 v[62:63], v[30:31], v[30:31], s[20:21] neg_lo:[1,0,1] neg_hi:[1,0,1]
  v_pk_mul_f32 v[48:49], v[16:17], v[48:49]
  v_pk_mul_f32 v[50:51], v[18:19], v[50:51]
  v_pk_mul_f32 v[52:53], v[20:21], v[52:53]
  v_pk_mul_f32 v[54:55], v[22:23], v[54:55]
  v_pk_mul_f32 v[56:57], v[24:25], v[56:57]
  v_cvt_pk_bf16_f32 v184, v32, v33
  v_cvt_pk_bf16_f32 v185, v34, v35
  v_cvt_pk_bf16_f32 v186, v36, v37
  v_cvt_pk_bf16_f32 v187, v38, v39
  v_pk_mul_f32 v[58:59], v[26:27], v[58:59]
  v_pk_mul_f32 v[60:61], v[28:29], v[60:61]
  v_pk_mul_f32 v[62:63], v[30:31], v[62:63]
  v_mfma_f32_32x32x16_bf16 v[64:79], v[192:195], v[184:187], v[64:79]
  v_cvt_pk_bf16_f32 v188, v40, v41
  v_cvt_pk_bf16_f32 v189, v42, v43
  v_cvt_pk_bf16_f32 v190, v44, v45
  v_cvt_pk_bf16_f32 v191, v46, v47
  v_exp_f32_e64 v48, v48
  v_mfma_f32_32x32x16_bf16 v[80:95], v[196:199], v[184:187], v[80:95]
  v_exp_f32 v49, v49
  v_exp_f32 v50, v50
  v_exp_f32_e64 v51, v51
  v_mfma_f32_32x32x16_bf16 v[96:111], v[200:203], v[184:187], v[96:111]
  v_exp_f32 v52, v52
  v_exp_f32 v53, v53
  v_exp_f32_e64 v54, v54
  v_mfma_f32_32x32x16_bf16 v[64:79], v[204:207], v[188:191], v[64:79]
  v_exp_f32 v55, v55
  v_exp_f32 v56, v56
  v_exp_f32_e64 v57, v57
  v_mfma_f32_32x32x16_bf16 v[80:95], v[208:211], v[188:191], v[80:95]
  v_exp_f32 v58, v58
  v_exp_f32 v59, v59
  v_exp_f32_e64 v60, v60
  v_mfma_f32_32x32x16_bf16 v[96:111], v[212:215], v[188:191], v[96:111]
  v_exp_f32 v61, v61
  v_exp_f32 v62, v62
  v_exp_f32_e64 v63, v63
  v_pk_fma_f32 v[48:49], v[48:49], s[22:23], s[22:23]
  v_pk_fma_f32 v[50:51], v[50:51], s[22:23], s[22:23]
  v_pk_fma_f32 v[52:53], v[52:53], s[22:23], s[22:23]
  v_pk_fma_f32 v[54:55], v[54:55], s[22:23], s[22:23]
  v_pk_fma_f32 v[56:57], v[56:57], s[22:23], s[22:23]
  v_pk_fma_f32 v[58:59], v[58:59], s[22:23], s[22:23]
  v_pk_fma_f32 v[60:61], v[60:61], s[22:23], s[22:23]
  v_pk_fma_f32 v[62:63], v[62:63], s[22:23], s[22:23]
  v_mfma_f32_32x32x16_bf16 v[32:47], a[48:51], v[160:163], 0
  ds_read_b128 v[192:195], v1 offset:20480
  ds_read_b128 v[196:199], v1 offset:21504
  v_rcp_f32 v48, v48
  v_rcp_f32 v49, v49
  v_mfma_f32_32x32x16_bf16 v[32:47], a[52:55], v[164:167], v[32:47]
  ds_read_b128 v[200:203], v1 offset:22528
  ds_read_b128 v[204:207], v1 offset:23552
  v_rcp_f32 v50, v50
  v_rcp_f32 v51, v51
  v_mfma_f32_32x32x16_bf16 v[32:47], a[56:59], v[168:171], v[32:47]
  ds_read_b128 v[208:211], v1 offset:24576
  ds_read_b128 v[212:215], v1 offset:25600
  v_rcp_f32 v52, v52
  v_rcp_f32 v53, v53
  v_mfma_f32_32x32x16_bf16 v[32:47], a[60:63], v[172:175], v[32:47]
  buffer_store_dwordx4 v[116:119], v10, s[8:11], s28 offen offset:32
  v_rcp_f32 v54, v54
  v_rcp_f32 v55, v55
  v_mfma_f32_32x32x16_bf16 v[32:47], a[64:67], v[176:179], v[32:47]
  v_rcp_f32 v56, v56
  v_rcp_f32 v57, v57
  v_rcp_f32_e64 v58, v58
  v_mfma_f32_32x32x16_bf16 v[32:47], a[68:71], v[180:183], v[32:47]
  s_waitcnt lgkmcnt(0)
  v_rcp_f32 v59, v59
  v_rcp_f32 v60, v60
  v_rcp_f32 v61, v61
  v_rcp_f32 v62, v62
  v_rcp_f32 v63, v63
  v_pk_mul_f32 v[16:17], v[16:17], v[48:49]
  v_pk_mul_f32 v[18:19], v[18:19], v[50:51]
  v_pk_mul_f32 v[20:21], v[20:21], v[52:53]
  v_pk_mul_f32 v[22:23], v[22:23], v[54:55]
  v_pk_mul_f32 v[24:25], v[24:25], v[56:57]
  v_pk_mul_f32 v[26:27], v[26:27], v[58:59]
  v_pk_mul_f32 v[28:29], v[28:29], v[60:61]
  v_pk_mul_f32 v[30:31], v[30:31], v[62:63]
  v_pk_fma_f32 v[48:49], v[32:33], v[32:33], s[20:21] neg_lo:[1,0,1] neg_hi:[1,0,1]
  v_pk_fma_f32 v[50:51], v[34:35], v[34:35], s[20:21] neg_lo:[1,0,1] neg_hi:[1,0,1]
  v_pk_fma_f32 v[52:53], v[36:37], v[36:37], s[20:21] neg_lo:[1,0,1] neg_hi:[1,0,1]
  v_pk_fma_f32 v[54:55], v[38:39], v[38:39], s[20:21] neg_lo:[1,0,1] neg_hi:[1,0,1]
  v_pk_fma_f32 v[56:57], v[40:41], v[40:41], s[20:21] neg_lo:[1,0,1] neg_hi:[1,0,1]
  v_pk_fma_f32 v[58:59], v[42:43], v[42:43], s[20:21] neg_lo:[1,0,1] neg_hi:[1,0,1]
  v_pk_fma_f32 v[60:61], v[44:45], v[44:45], s[20:21] neg_lo:[1,0,1] neg_hi:[1,0,1]
  v_pk_fma_f32 v[62:63], v[46:47], v[46:47], s[20:21] neg_lo:[1,0,1] neg_hi:[1,0,1]
  v_pk_mul_f32 v[48:49], v[32:33], v[48:49]
  v_pk_mul_f32 v[50:51], v[34:35], v[50:51]
  v_pk_mul_f32 v[52:53], v[36:37], v[52:53]
  v_pk_mul_f32 v[54:55], v[38:39], v[54:55]
  v_pk_mul_f32 v[56:57], v[40:41], v[56:57]
  v_cvt_pk_bf16_f32 v184, v16, v17
  v_cvt_pk_bf16_f32 v185, v18, v19
  v_cvt_pk_bf16_f32 v186, v20, v21
  v_cvt_pk_bf16_f32 v187, v22, v23
  v_pk_mul_f32 v[58:59], v[42:43], v[58:59]
  v_pk_mul_f32 v[60:61], v[44:45], v[60:61]
  v_pk_mul_f32 v[62:63], v[46:47], v[62:63]
  v_mfma_f32_32x32x16_bf16 v[64:79], v[192:195], v[184:187], v[64:79]
  v_cvt_pk_bf16_f32 v188, v24, v25
  v_cvt_pk_bf16_f32 v189, v26, v27
  v_cvt_pk_bf16_f32 v190, v28, v29
  v_cvt_pk_bf16_f32 v191, v30, v31
  v_exp_f32_e64 v48, v48
  v_mfma_f32_32x32x16_bf16 v[80:95], v[196:199], v[184:187], v[80:95]
  v_exp_f32 v49, v49
  v_exp_f32 v50, v50
  v_exp_f32_e64 v51, v51
  v_mfma_f32_32x32x16_bf16 v[96:111], v[200:203], v[184:187], v[96:111]
  v_exp_f32 v52, v52
  v_exp_f32 v53, v53
  v_exp_f32_e64 v54, v54
  v_mfma_f32_32x32x16_bf16 v[64:79], v[204:207], v[188:191], v[64:79]
  v_exp_f32 v55, v55
  v_exp_f32 v56, v56
  v_exp_f32_e64 v57, v57
  v_mfma_f32_32x32x16_bf16 v[80:95], v[208:211], v[188:191], v[80:95]
  v_exp_f32 v58, v58
  v_exp_f32 v59, v59
  v_exp_f32_e64 v60, v60
  v_mfma_f32_32x32x16_bf16 v[96:111], v[212:215], v[188:191], v[96:111]
  v_exp_f32 v61, v61
  v_exp_f32 v62, v62
  v_exp_f32_e64 v63, v63
  v_pk_fma_f32 v[48:49], v[48:49], s[22:23], s[22:23]
  v_pk_fma_f32 v[50:51], v[50:51], s[22:23], s[22:23]
  v_pk_fma_f32 v[52:53], v[52:53], s[22:23], s[22:23]
  v_pk_fma_f32 v[54:55], v[54:55], s[22:23], s[22:23]
  v_pk_fma_f32 v[56:57], v[56:57], s[22:23], s[22:23]
  v_pk_fma_f32 v[58:59], v[58:59], s[22:23], s[22:23]
  v_pk_fma_f32 v[60:61], v[60:61], s[22:23], s[22:23]
  v_pk_fma_f32 v[62:63], v[62:63], s[22:23], s[22:23]
  v_mfma_f32_32x32x16_bf16 v[16:31], a[72:75], v[160:163], 0
  ds_read_b128 v[192:195], v1 offset:26624
  ds_read_b128 v[196:199], v1 offset:27648
  v_rcp_f32 v48, v48
  v_rcp_f32 v49, v49
  v_mfma_f32_32x32x16_bf16 v[16:31], a[76:79], v[164:167], v[16:31]
  ds_read_b128 v[200:203], v1 offset:28672
  ds_read_b128 v[204:207], v1 offset:29696
  v_rcp_f32 v50, v50
  v_rcp_f32 v51, v51
  v_mfma_f32_32x32x16_bf16 v[16:31], a[80:83], v[168:171], v[16:31]
  ds_read_b128 v[208:211], v1 offset:30720
  ds_read_b128 v[212:215], v1 offset:31744
  v_rcp_f32 v52, v52
  v_rcp_f32 v53, v53
  v_mfma_f32_32x32x16_bf16 v[16:31], a[84:87], v[172:175], v[16:31]
  v_rcp_f32 v54, v54
  v_rcp_f32 v55, v55
  v_rcp_f32_e64 v56, v56
  v_mfma_f32_32x32x16_bf16 v[16:31], a[88:91], v[176:179], v[16:31]
  v_rcp_f32 v57, v57
  v_rcp_f32 v58, v58
  v_rcp_f32_e64 v59, v59
  v_mfma_f32_32x32x16_bf16 v[16:31], a[92:95], v[180:183], v[16:31]
  s_waitcnt lgkmcnt(0)
  v_rcp_f32 v60, v60
  v_rcp_f32 v61, v61
  v_rcp_f32 v62, v62
  v_rcp_f32_e64 v63, v63
  v_pk_mul_f32 v[32:33], v[32:33], v[48:49]
  v_pk_mul_f32 v[34:35], v[34:35], v[50:51]
  v_pk_mul_f32 v[36:37], v[36:37], v[52:53]
  v_pk_mul_f32 v[38:39], v[38:39], v[54:55]
  v_pk_mul_f32 v[40:41], v[40:41], v[56:57]
  v_pk_mul_f32 v[42:43], v[42:43], v[58:59]
  v_pk_mul_f32 v[44:45], v[44:45], v[60:61]
  v_pk_mul_f32 v[46:47], v[46:47], v[62:63]
  v_pk_fma_f32 v[48:49], v[16:17], v[16:17], s[20:21] neg_lo:[1,0,1] neg_hi:[1,0,1]
  v_pk_fma_f32 v[50:51], v[18:19], v[18:19], s[20:21] neg_lo:[1,0,1] neg_hi:[1,0,1]
  v_pk_fma_f32 v[52:53], v[20:21], v[20:21], s[20:21] neg_lo:[1,0,1] neg_hi:[1,0,1]
  v_pk_fma_f32 v[54:55], v[22:23], v[22:23], s[20:21] neg_lo:[1,0,1] neg_hi:[1,0,1]
  v_pk_fma_f32 v[56:57], v[24:25], v[24:25], s[20:21] neg_lo:[1,0,1] neg_hi:[1,0,1]
  v_pk_fma_f32 v[58:59], v[26:27], v[26:27], s[20:21] neg_lo:[1,0,1] neg_hi:[1,0,1]
  v_pk_fma_f32 v[60:61], v[28:29], v[28:29], s[20:21] neg_lo:[1,0,1] neg_hi:[1,0,1]
  v_pk_fma_f32 v[62:63], v[30:31], v[30:31], s[20:21] neg_lo:[1,0,1] neg_hi:[1,0,1]
  v_pk_mul_f32 v[48:49], v[16:17], v[48:49]
  v_pk_mul_f32 v[50:51], v[18:19], v[50:51]
  v_pk_mul_f32 v[52:53], v[20:21], v[52:53]
  v_pk_mul_f32 v[54:55], v[22:23], v[54:55]
  v_pk_mul_f32 v[56:57], v[24:25], v[56:57]
  v_cvt_pk_bf16_f32 v184, v32, v33
  v_cvt_pk_bf16_f32 v185, v34, v35
  v_cvt_pk_bf16_f32 v186, v36, v37
  v_cvt_pk_bf16_f32 v187, v38, v39
  v_pk_mul_f32 v[58:59], v[26:27], v[58:59]
  v_pk_mul_f32 v[60:61], v[28:29], v[60:61]
  v_pk_mul_f32 v[62:63], v[30:31], v[62:63]
  v_mfma_f32_32x32x16_bf16 v[64:79], v[192:195], v[184:187], v[64:79]
  v_cvt_pk_bf16_f32 v188, v40, v41
  v_cvt_pk_bf16_f32 v189, v42, v43
  v_cvt_pk_bf16_f32 v190, v44, v45
  v_cvt_pk_bf16_f32 v191, v46, v47
  v_exp_f32_e64 v48, v48
  v_mfma_f32_32x32x16_bf16 v[80:95], v[196:199], v[184:187], v[80:95]
  v_exp_f32 v49, v49
  v_exp_f32 v50, v50
  v_exp_f32_e64 v51, v51
  v_mfma_f32_32x32x16_bf16 v[96:111], v[200:203], v[184:187], v[96:111]
  v_exp_f32 v52, v52
  v_exp_f32 v53, v53
  v_exp_f32_e64 v54, v54
  v_mfma_f32_32x32x16_bf16 v[64:79], v[204:207], v[188:191], v[64:79]
  v_exp_f32 v55, v55
  v_exp_f32 v56, v56
  v_exp_f32_e64 v57, v57
  v_mfma_f32_32x32x16_bf16 v[80:95], v[208:211], v[188:191], v[80:95]
  v_exp_f32 v58, v58
  v_exp_f32 v59, v59
  v_exp_f32_e64 v60, v60
  v_mfma_f32_32x32x16_bf16 v[96:111], v[212:215], v[188:191], v[96:111]
  v_exp_f32 v61, v61
  v_exp_f32 v62, v62
  v_exp_f32_e64 v63, v63
  v_pk_fma_f32 v[48:49], v[48:49], s[22:23], s[22:23]
  v_pk_fma_f32 v[50:51], v[50:51], s[22:23], s[22:23]
  v_pk_fma_f32 v[52:53], v[52:53], s[22:23], s[22:23]
  v_pk_fma_f32 v[54:55], v[54:55], s[22:23], s[22:23]
  v_pk_fma_f32 v[56:57], v[56:57], s[22:23], s[22:23]
  v_pk_fma_f32 v[58:59], v[58:59], s[22:23], s[22:23]
  v_pk_fma_f32 v[60:61], v[60:61], s[22:23], s[22:23]
  v_pk_fma_f32 v[62:63], v[62:63], s[22:23], s[22:23]
  v_mfma_f32_32x32x16_bf16 v[32:47], a[96:99], v[160:163], 0
  ds_read_b128 v[192:195], v0 offset:24576
  ds_read_b128 v[196:199], v0 offset:25600
  v_rcp_f32 v48, v48
  v_rcp_f32 v49, v49
  v_mfma_f32_32x32x16_bf16 v[32:47], a[100:103], v[164:167], v[32:47]
  ds_read_b128 v[200:203], v0 offset:26624
  ds_read_b128 v[204:207], v0 offset:27648
  v_rcp_f32 v50, v50
  v_rcp_f32 v51, v51
  v_mfma_f32_32x32x16_bf16 v[32:47], a[104:107], v[168:171], v[32:47]
  ds_read_b128 v[208:211], v0 offset:28672
  ds_read_b128 v[212:215], v0 offset:29696
  v_rcp_f32 v52, v52
  v_rcp_f32 v53, v53
  v_mfma_f32_32x32x16_bf16 v[32:47], a[108:111], v[172:175], v[32:47]
  buffer_store_dwordx4 v[120:123], v10, s[8:11], s28 offen offset:64
  v_rcp_f32 v54, v54
  v_rcp_f32 v55, v55
  v_mfma_f32_32x32x16_bf16 v[32:47], a[112:115], v[176:179], v[32:47]
  v_rcp_f32 v56, v56
  v_rcp_f32 v57, v57
  v_rcp_f32_e64 v58, v58
  v_mfma_f32_32x32x16_bf16 v[32:47], a[116:119], v[180:183], v[32:47]
  s_waitcnt lgkmcnt(0)
  v_rcp_f32 v59, v59
  v_rcp_f32 v60, v60
  v_rcp_f32 v61, v61
  v_rcp_f32 v62, v62
  v_rcp_f32 v63, v63
  v_pk_mul_f32 v[16:17], v[16:17], v[48:49]
  v_pk_mul_f32 v[18:19], v[18:19], v[50:51]
  v_pk_mul_f32 v[20:21], v[20:21], v[52:53]
  v_pk_mul_f32 v[22:23], v[22:23], v[54:55]
  v_pk_mul_f32 v[24:25], v[24:25], v[56:57]
  v_pk_mul_f32 v[26:27], v[26:27], v[58:59]
  v_pk_mul_f32 v[28:29], v[28:29], v[60:61]
  v_pk_mul_f32 v[30:31], v[30:31], v[62:63]
  v_pk_fma_f32 v[48:49], v[32:33], v[32:33], s[20:21] neg_lo:[1,0,1] neg_hi:[1,0,1]
  v_pk_fma_f32 v[50:51], v[34:35], v[34:35], s[20:21] neg_lo:[1,0,1] neg_hi:[1,0,1]
  v_pk_fma_f32 v[52:53], v[36:37], v[36:37], s[20:21] neg_lo:[1,0,1] neg_hi:[1,0,1]
  v_pk_fma_f32 v[54:55], v[38:39], v[38:39], s[20:21] neg_lo:[1,0,1] neg_hi:[1,0,1]
  v_pk_fma_f32 v[56:57], v[40:41], v[40:41], s[20:21] neg_lo:[1,0,1] neg_hi:[1,0,1]
  v_pk_fma_f32 v[58:59], v[42:43], v[42:43], s[20:21] neg_lo:[1,0,1] neg_hi:[1,0,1]
  v_pk_fma_f32 v[60:61], v[44:45], v[44:45], s[20:21] neg_lo:[1,0,1] neg_hi:[1,0,1]
  v_pk_fma_f32 v[62:63], v[46:47], v[46:47], s[20:21] neg_lo:[1,0,1] neg_hi:[1,0,1]
  v_pk_mul_f32 v[48:49], v[32:33], v[48:49]
  v_pk_mul_f32 v[50:51], v[34:35], v[50:51]
  v_pk_mul_f32 v[52:53], v[36:37], v[52:53]
  v_pk_mul_f32 v[54:55], v[38:39], v[54:55]
  v_pk_mul_f32 v[56:57], v[40:41], v[56:57]
  v_cvt_pk_bf16_f32 v184, v16, v17
  v_cvt_pk_bf16_f32 v185, v18, v19
  v_cvt_pk_bf16_f32 v186, v20, v21
  v_cvt_pk_bf16_f32 v187, v22, v23
  v_pk_mul_f32 v[58:59], v[42:43], v[58:59]
  v_pk_mul_f32 v[60:61], v[44:45], v[60:61]
  v_pk_mul_f32 v[62:63], v[46:47], v[62:63]
  v_mfma_f32_32x32x16_bf16 v[64:79], v[192:195], v[184:187], v[64:79]
  v_cvt_pk_bf16_f32 v188, v24, v25
  v_cvt_pk_bf16_f32 v189, v26, v27
  v_cvt_pk_bf16_f32 v190, v28, v29
  v_cvt_pk_bf16_f32 v191, v30, v31
  v_exp_f32_e64 v48, v48
  v_mfma_f32_32x32x16_bf16 v[80:95], v[196:199], v[184:187], v[80:95]
  v_exp_f32 v49, v49
  v_exp_f32 v50, v50
  v_exp_f32_e64 v51, v51
  v_mfma_f32_32x32x16_bf16 v[96:111], v[200:203], v[184:187], v[96:111]
  v_exp_f32 v52, v52
  v_exp_f32 v53, v53
  v_exp_f32_e64 v54, v54
  v_mfma_f32_32x32x16_bf16 v[64:79], v[204:207], v[188:191], v[64:79]
  v_exp_f32 v55, v55
  v_exp_f32 v56, v56
  v_exp_f32_e64 v57, v57
  v_mfma_f32_32x32x16_bf16 v[80:95], v[208:211], v[188:191], v[80:95]
  v_exp_f32 v58, v58
  v_exp_f32 v59, v59
  v_exp_f32_e64 v60, v60
  v_mfma_f32_32x32x16_bf16 v[96:111], v[212:215], v[188:191], v[96:111]
  v_exp_f32 v61, v61
  v_exp_f32 v62, v62
  v_exp_f32_e64 v63, v63
  v_pk_fma_f32 v[48:49], v[48:49], s[22:23], s[22:23]
  v_pk_fma_f32 v[50:51], v[50:51], s[22:23], s[22:23]
  v_pk_fma_f32 v[52:53], v[52:53], s[22:23], s[22:23]
  v_pk_fma_f32 v[54:55], v[54:55], s[22:23], s[22:23]
  v_pk_fma_f32 v[56:57], v[56:57], s[22:23], s[22:23]
  v_pk_fma_f32 v[58:59], v[58:59], s[22:23], s[22:23]
  v_pk_fma_f32 v[60:61], v[60:61], s[22:23], s[22:23]
  v_pk_fma_f32 v[62:63], v[62:63], s[22:23], s[22:23]
  v_mfma_f32_32x32x16_bf16 v[16:31], a[120:123], v[160:163], 0
  ds_read_b128 v[192:195], v0 offset:30720
  ds_read_b128 v[196:199], v0 offset:31744
  v_rcp_f32 v48, v48
  v_rcp_f32 v49, v49
  v_mfma_f32_32x32x16_bf16 v[16:31], a[124:127], v[164:167], v[16:31]
  ds_read_b128 v[200:203], v0 offset:32768
  ds_read_b128 v[204:207], v0 offset:33792
  v_rcp_f32 v50, v50
  v_rcp_f32 v51, v51
  v_mfma_f32_32x32x16_bf16 v[16:31], a[128:131], v[168:171], v[16:31]
  ds_read_b128 v[208:211], v0 offset:34816
  ds_read_b128 v[212:215], v0 offset:35840
  v_rcp_f32 v52, v52
  v_rcp_f32 v53, v53
  v_mfma_f32_32x32x16_bf16 v[16:31], a[132:135], v[172:175], v[16:31]
  buffer_store_dwordx4 v[124:127], v10, s[8:11], s28 offen offset:96
  v_rcp_f32 v54, v54
  v_rcp_f32 v55, v55
  v_mfma_f32_32x32x16_bf16 v[16:31], a[136:139], v[176:179], v[16:31]
  v_rcp_f32 v56, v56
  v_rcp_f32 v57, v57
  v_rcp_f32_e64 v58, v58
  v_mfma_f32_32x32x16_bf16 v[16:31], a[140:143], v[180:183], v[16:31]
  s_waitcnt lgkmcnt(0)
  v_rcp_f32 v59, v59
  v_rcp_f32 v60, v60
  v_rcp_f32 v61, v61
  v_rcp_f32 v62, v62
  v_rcp_f32 v63, v63
  v_pk_mul_f32 v[32:33], v[32:33], v[48:49]
  v_pk_mul_f32 v[34:35], v[34:35], v[50:51]
  v_pk_mul_f32 v[36:37], v[36:37], v[52:53]
  v_pk_mul_f32 v[38:39], v[38:39], v[54:55]
  v_pk_mul_f32 v[40:41], v[40:41], v[56:57]
  v_pk_mul_f32 v[42:43], v[42:43], v[58:59]
  v_pk_mul_f32 v[44:45], v[44:45], v[60:61]
  v_pk_mul_f32 v[46:47], v[46:47], v[62:63]
  v_pk_fma_f32 v[48:49], v[16:17], v[16:17], s[20:21] neg_lo:[1,0,1] neg_hi:[1,0,1]
  v_pk_fma_f32 v[50:51], v[18:19], v[18:19], s[20:21] neg_lo:[1,0,1] neg_hi:[1,0,1]
  v_pk_fma_f32 v[52:53], v[20:21], v[20:21], s[20:21] neg_lo:[1,0,1] neg_hi:[1,0,1]
  v_pk_fma_f32 v[54:55], v[22:23], v[22:23], s[20:21] neg_lo:[1,0,1] neg_hi:[1,0,1]
  v_pk_fma_f32 v[56:57], v[24:25], v[24:25], s[20:21] neg_lo:[1,0,1] neg_hi:[1,0,1]
  v_pk_fma_f32 v[58:59], v[26:27], v[26:27], s[20:21] neg_lo:[1,0,1] neg_hi:[1,0,1]
  v_pk_fma_f32 v[60:61], v[28:29], v[28:29], s[20:21] neg_lo:[1,0,1] neg_hi:[1,0,1]
  v_pk_fma_f32 v[62:63], v[30:31], v[30:31], s[20:21] neg_lo:[1,0,1] neg_hi:[1,0,1]
  v_pk_mul_f32 v[48:49], v[16:17], v[48:49]
  v_pk_mul_f32 v[50:51], v[18:19], v[50:51]
  v_pk_mul_f32 v[52:53], v[20:21], v[52:53]
  v_pk_mul_f32 v[54:55], v[22:23], v[54:55]
  v_pk_mul_f32 v[56:57], v[24:25], v[56:57]
  v_cvt_pk_bf16_f32 v184, v32, v33
  v_cvt_pk_bf16_f32 v185, v34, v35
  v_cvt_pk_bf16_f32 v186, v36, v37
  v_cvt_pk_bf16_f32 v187, v38, v39
  v_pk_mul_f32 v[58:59], v[26:27], v[58:59]
  v_pk_mul_f32 v[60:61], v[28:29], v[60:61]
  v_pk_mul_f32 v[62:63], v[30:31], v[62:63]
  v_mfma_f32_32x32x16_bf16 v[64:79], v[192:195], v[184:187], v[64:79]
  v_cvt_pk_bf16_f32 v188, v40, v41
  v_cvt_pk_bf16_f32 v189, v42, v43
  v_cvt_pk_bf16_f32 v190, v44, v45
  v_cvt_pk_bf16_f32 v191, v46, v47
  v_exp_f32_e64 v48, v48
  v_mfma_f32_32x32x16_bf16 v[80:95], v[196:199], v[184:187], v[80:95]
  v_exp_f32 v49, v49
  v_exp_f32 v50, v50
  v_exp_f32_e64 v51, v51
  v_mfma_f32_32x32x16_bf16 v[96:111], v[200:203], v[184:187], v[96:111]
  v_exp_f32 v52, v52
  v_exp_f32 v53, v53
  v_exp_f32_e64 v54, v54
  v_mfma_f32_32x32x16_bf16 v[64:79], v[204:207], v[188:191], v[64:79]
  v_exp_f32 v55, v55
  v_exp_f32 v56, v56
  v_exp_f32_e64 v57, v57
  v_mfma_f32_32x32x16_bf16 v[80:95], v[208:211], v[188:191], v[80:95]
  v_exp_f32 v58, v58
  v_exp_f32 v59, v59
  v_exp_f32_e64 v60, v60
  v_mfma_f32_32x32x16_bf16 v[96:111], v[212:215], v[188:191], v[96:111]
  v_exp_f32 v61, v61
  v_exp_f32 v62, v62
  v_exp_f32_e64 v63, v63
  v_pk_fma_f32 v[48:49], v[48:49], s[22:23], s[22:23]
  v_pk_fma_f32 v[50:51], v[50:51], s[22:23], s[22:23]
  v_pk_fma_f32 v[52:53], v[52:53], s[22:23], s[22:23]
  v_pk_fma_f32 v[54:55], v[54:55], s[22:23], s[22:23]
  v_pk_fma_f32 v[56:57], v[56:57], s[22:23], s[22:23]
  v_pk_fma_f32 v[58:59], v[58:59], s[22:23], s[22:23]
  v_pk_fma_f32 v[60:61], v[60:61], s[22:23], s[22:23]
  v_pk_fma_f32 v[62:63], v[62:63], s[22:23], s[22:23]
  v_mfma_f32_32x32x16_bf16 v[32:47], a[144:147], v[160:163], 0
  ds_read_b128 v[192:195], v0 offset:36864
  ds_read_b128 v[196:199], v0 offset:37888
  v_rcp_f32 v48, v48
  v_rcp_f32 v49, v49
  v_mfma_f32_32x32x16_bf16 v[32:47], a[148:151], v[164:167], v[32:47]
  ds_read_b128 v[200:203], v0 offset:38912
  ds_read_b128 v[204:207], v0 offset:39936
  v_rcp_f32 v50, v50
  v_rcp_f32 v51, v51
  v_mfma_f32_32x32x16_bf16 v[32:47], a[152:155], v[168:171], v[32:47]
  ds_read_b128 v[208:211], v0 offset:40960
  ds_read_b128 v[212:215], v0 offset:41984
  v_rcp_f32 v52, v52
  v_rcp_f32 v53, v53
  v_mfma_f32_32x32x16_bf16 v[32:47], a[156:159], v[172:175], v[32:47]
  v_rcp_f32 v54, v54
  v_rcp_f32 v55, v55
  v_rcp_f32_e64 v56, v56
  v_mfma_f32_32x32x16_bf16 v[32:47], a[160:163], v[176:179], v[32:47]
  v_rcp_f32 v57, v57
  v_rcp_f32 v58, v58
  v_rcp_f32_e64 v59, v59
  v_mfma_f32_32x32x16_bf16 v[32:47], a[164:167], v[180:183], v[32:47]
  s_waitcnt lgkmcnt(0)
  v_rcp_f32 v60, v60
  v_rcp_f32 v61, v61
  v_rcp_f32 v62, v62
  v_rcp_f32_e64 v63, v63
  v_pk_mul_f32 v[16:17], v[16:17], v[48:49]
  v_pk_mul_f32 v[18:19], v[18:19], v[50:51]
  v_pk_mul_f32 v[20:21], v[20:21], v[52:53]
  v_pk_mul_f32 v[22:23], v[22:23], v[54:55]
  v_pk_mul_f32 v[24:25], v[24:25], v[56:57]
  v_pk_mul_f32 v[26:27], v[26:27], v[58:59]
  v_pk_mul_f32 v[28:29], v[28:29], v[60:61]
  v_pk_mul_f32 v[30:31], v[30:31], v[62:63]
  v_pk_fma_f32 v[48:49], v[32:33], v[32:33], s[20:21] neg_lo:[1,0,1] neg_hi:[1,0,1]
  v_pk_fma_f32 v[50:51], v[34:35], v[34:35], s[20:21] neg_lo:[1,0,1] neg_hi:[1,0,1]
  v_pk_fma_f32 v[52:53], v[36:37], v[36:37], s[20:21] neg_lo:[1,0,1] neg_hi:[1,0,1]
  v_pk_fma_f32 v[54:55], v[38:39], v[38:39], s[20:21] neg_lo:[1,0,1] neg_hi:[1,0,1]
  v_pk_fma_f32 v[56:57], v[40:41], v[40:41], s[20:21] neg_lo:[1,0,1] neg_hi:[1,0,1]
  v_pk_fma_f32 v[58:59], v[42:43], v[42:43], s[20:21] neg_lo:[1,0,1] neg_hi:[1,0,1]
  v_pk_fma_f32 v[60:61], v[44:45], v[44:45], s[20:21] neg_lo:[1,0,1] neg_hi:[1,0,1]
  v_pk_fma_f32 v[62:63], v[46:47], v[46:47], s[20:21] neg_lo:[1,0,1] neg_hi:[1,0,1]
  v_pk_mul_f32 v[48:49], v[32:33], v[48:49]
  v_pk_mul_f32 v[50:51], v[34:35], v[50:51]
  v_pk_mul_f32 v[52:53], v[36:37], v[52:53]
  v_pk_mul_f32 v[54:55], v[38:39], v[54:55]
  v_pk_mul_f32 v[56:57], v[40:41], v[56:57]
  v_cvt_pk_bf16_f32 v184, v16, v17
  v_cvt_pk_bf16_f32 v185, v18, v19
  v_cvt_pk_bf16_f32 v186, v20, v21
  v_cvt_pk_bf16_f32 v187, v22, v23
  v_pk_mul_f32 v[58:59], v[42:43], v[58:59]
  v_pk_mul_f32 v[60:61], v[44:45], v[60:61]
  v_pk_mul_f32 v[62:63], v[46:47], v[62:63]
  v_mfma_f32_32x32x16_bf16 v[64:79], v[192:195], v[184:187], v[64:79]
  v_cvt_pk_bf16_f32 v188, v24, v25
  v_cvt_pk_bf16_f32 v189, v26, v27
  v_cvt_pk_bf16_f32 v190, v28, v29
  v_cvt_pk_bf16_f32 v191, v30, v31
  v_exp_f32_e64 v48, v48
  v_mfma_f32_32x32x16_bf16 v[80:95], v[196:199], v[184:187], v[80:95]
  v_exp_f32 v49, v49
  v_exp_f32 v50, v50
  v_exp_f32_e64 v51, v51
  v_mfma_f32_32x32x16_bf16 v[96:111], v[200:203], v[184:187], v[96:111]
  v_exp_f32 v52, v52
  v_exp_f32 v53, v53
  v_exp_f32_e64 v54, v54
  v_mfma_f32_32x32x16_bf16 v[64:79], v[204:207], v[188:191], v[64:79]
  v_exp_f32 v55, v55
  v_exp_f32 v56, v56
  v_exp_f32_e64 v57, v57
  v_mfma_f32_32x32x16_bf16 v[80:95], v[208:211], v[188:191], v[80:95]
  v_exp_f32 v58, v58
  v_exp_f32 v59, v59
  v_exp_f32_e64 v60, v60
  v_mfma_f32_32x32x16_bf16 v[96:111], v[212:215], v[188:191], v[96:111]
  v_exp_f32 v61, v61
  v_exp_f32 v62, v62
  v_exp_f32_e64 v63, v63
  v_pk_fma_f32 v[48:49], v[48:49], s[22:23], s[22:23]
  v_pk_fma_f32 v[50:51], v[50:51], s[22:23], s[22:23]
  v_pk_fma_f32 v[52:53], v[52:53], s[22:23], s[22:23]
  v_pk_fma_f32 v[54:55], v[54:55], s[22:23], s[22:23]
  v_pk_fma_f32 v[56:57], v[56:57], s[22:23], s[22:23]
  v_pk_fma_f32 v[58:59], v[58:59], s[22:23], s[22:23]
  v_pk_fma_f32 v[60:61], v[60:61], s[22:23], s[22:23]
  v_pk_fma_f32 v[62:63], v[62:63], s[22:23], s[22:23]
  v_mfma_f32_32x32x16_bf16 v[16:31], a[168:171], v[160:163], 0
  ds_read_b128 v[192:195], v0 offset:43008
  ds_read_b128 v[196:199], v0 offset:44032
  v_rcp_f32 v48, v48
  v_rcp_f32 v49, v49
  v_mfma_f32_32x32x16_bf16 v[16:31], a[172:175], v[164:167], v[16:31]
  ds_read_b128 v[200:203], v0 offset:45056
  ds_read_b128 v[204:207], v0 offset:46080
  v_rcp_f32 v50, v50
  v_rcp_f32 v51, v51
  v_mfma_f32_32x32x16_bf16 v[16:31], a[176:179], v[168:171], v[16:31]
  ds_read_b128 v[208:211], v0 offset:47104
  ds_read_b128 v[212:215], v0 offset:48128
  v_rcp_f32 v52, v52
  v_rcp_f32 v53, v53
  v_mfma_f32_32x32x16_bf16 v[16:31], a[180:183], v[172:175], v[16:31]
  buffer_store_dwordx4 v[128:131], v10, s[8:11], s28 offen offset:128
  v_rcp_f32 v54, v54
  v_rcp_f32 v55, v55
  v_mfma_f32_32x32x16_bf16 v[16:31], a[184:187], v[176:179], v[16:31]
  v_rcp_f32 v56, v56
  v_rcp_f32 v57, v57
  v_rcp_f32_e64 v58, v58
  v_mfma_f32_32x32x16_bf16 v[16:31], a[188:191], v[180:183], v[16:31]
  s_waitcnt lgkmcnt(0)
  v_rcp_f32 v59, v59
  v_rcp_f32 v60, v60
  v_rcp_f32 v61, v61
  v_rcp_f32 v62, v62
  v_rcp_f32 v63, v63
  v_pk_mul_f32 v[32:33], v[32:33], v[48:49]
  v_pk_mul_f32 v[34:35], v[34:35], v[50:51]
  v_pk_mul_f32 v[36:37], v[36:37], v[52:53]
  v_pk_mul_f32 v[38:39], v[38:39], v[54:55]
  v_pk_mul_f32 v[40:41], v[40:41], v[56:57]
  v_pk_mul_f32 v[42:43], v[42:43], v[58:59]
  v_pk_mul_f32 v[44:45], v[44:45], v[60:61]
  v_pk_mul_f32 v[46:47], v[46:47], v[62:63]
  v_pk_fma_f32 v[48:49], v[16:17], v[16:17], s[20:21] neg_lo:[1,0,1] neg_hi:[1,0,1]
  v_pk_fma_f32 v[50:51], v[18:19], v[18:19], s[20:21] neg_lo:[1,0,1] neg_hi:[1,0,1]
  v_pk_fma_f32 v[52:53], v[20:21], v[20:21], s[20:21] neg_lo:[1,0,1] neg_hi:[1,0,1]
  v_pk_fma_f32 v[54:55], v[22:23], v[22:23], s[20:21] neg_lo:[1,0,1] neg_hi:[1,0,1]
  v_pk_fma_f32 v[56:57], v[24:25], v[24:25], s[20:21] neg_lo:[1,0,1] neg_hi:[1,0,1]
  v_pk_fma_f32 v[58:59], v[26:27], v[26:27], s[20:21] neg_lo:[1,0,1] neg_hi:[1,0,1]
  v_pk_fma_f32 v[60:61], v[28:29], v[28:29], s[20:21] neg_lo:[1,0,1] neg_hi:[1,0,1]
  v_pk_fma_f32 v[62:63], v[30:31], v[30:31], s[20:21] neg_lo:[1,0,1] neg_hi:[1,0,1]
  v_pk_mul_f32 v[48:49], v[16:17], v[48:49]
  v_pk_mul_f32 v[50:51], v[18:19], v[50:51]
  v_pk_mul_f32 v[52:53], v[20:21], v[52:53]
  v_pk_mul_f32 v[54:55], v[22:23], v[54:55]
  v_pk_mul_f32 v[56:57], v[24:25], v[56:57]
  v_cvt_pk_bf16_f32 v184, v32, v33
  v_cvt_pk_bf16_f32 v185, v34, v35
  v_cvt_pk_bf16_f32 v186, v36, v37
  v_cvt_pk_bf16_f32 v187, v38, v39
  v_pk_mul_f32 v[58:59], v[26:27], v[58:59]
  v_pk_mul_f32 v[60:61], v[28:29], v[60:61]
  v_pk_mul_f32 v[62:63], v[30:31], v[62:63]
  v_mfma_f32_32x32x16_bf16 v[64:79], v[192:195], v[184:187], v[64:79]
  v_cvt_pk_bf16_f32 v188, v40, v41
  v_cvt_pk_bf16_f32 v189, v42, v43
  v_cvt_pk_bf16_f32 v190, v44, v45
  v_cvt_pk_bf16_f32 v191, v46, v47
  v_exp_f32_e64 v48, v48
  v_mfma_f32_32x32x16_bf16 v[80:95], v[196:199], v[184:187], v[80:95]
  v_exp_f32 v49, v49
  v_exp_f32 v50, v50
  v_exp_f32_e64 v51, v51
  v_mfma_f32_32x32x16_bf16 v[96:111], v[200:203], v[184:187], v[96:111]
  v_exp_f32 v52, v52
  v_exp_f32 v53, v53
  v_exp_f32_e64 v54, v54
  v_mfma_f32_32x32x16_bf16 v[64:79], v[204:207], v[188:191], v[64:79]
  v_exp_f32 v55, v55
  v_exp_f32 v56, v56
  v_exp_f32_e64 v57, v57
  v_mfma_f32_32x32x16_bf16 v[80:95], v[208:211], v[188:191], v[80:95]
  v_exp_f32 v58, v58
  v_exp_f32 v59, v59
  v_exp_f32_e64 v60, v60
  v_mfma_f32_32x32x16_bf16 v[96:111], v[212:215], v[188:191], v[96:111]
  v_exp_f32 v61, v61
  v_exp_f32 v62, v62
  v_exp_f32_e64 v63, v63
  v_pk_fma_f32 v[48:49], v[48:49], s[22:23], s[22:23]
  v_pk_fma_f32 v[50:51], v[50:51], s[22:23], s[22:23]
  v_pk_fma_f32 v[52:53], v[52:53], s[22:23], s[22:23]
  v_pk_fma_f32 v[54:55], v[54:55], s[22:23], s[22:23]
  v_pk_fma_f32 v[56:57], v[56:57], s[22:23], s[22:23]
  v_pk_fma_f32 v[58:59], v[58:59], s[22:23], s[22:23]
  v_pk_fma_f32 v[60:61], v[60:61], s[22:23], s[22:23]
  v_pk_fma_f32 v[62:63], v[62:63], s[22:23], s[22:23]
  v_mfma_f32_32x32x16_bf16 v[32:47], a[192:195], v[160:163], 0
  ds_read_b128 v[192:195], v0 offset:49152
  ds_read_b128 v[196:199], v0 offset:50176
  v_rcp_f32 v48, v48
  v_rcp_f32 v49, v49
  v_mfma_f32_32x32x16_bf16 v[32:47], a[196:199], v[164:167], v[32:47]
  ds_read_b128 v[200:203], v0 offset:51200
  ds_read_b128 v[204:207], v0 offset:52224
  v_rcp_f32 v50, v50
  v_rcp_f32 v51, v51
  v_mfma_f32_32x32x16_bf16 v[32:47], a[200:203], v[168:171], v[32:47]
  ds_read_b128 v[208:211], v0 offset:53248
  ds_read_b128 v[212:215], v0 offset:54272
  v_rcp_f32 v52, v52
  v_rcp_f32 v53, v53
  v_mfma_f32_32x32x16_bf16 v[32:47], a[204:207], v[172:175], v[32:47]
  buffer_store_dwordx4 v[132:135], v10, s[8:11], s28 offen offset:160
  v_rcp_f32 v54, v54
  v_rcp_f32 v55, v55
  v_mfma_f32_32x32x16_bf16 v[32:47], a[208:211], v[176:179], v[32:47]
  v_rcp_f32 v56, v56
  v_rcp_f32 v57, v57
  v_rcp_f32_e64 v58, v58
  v_mfma_f32_32x32x16_bf16 v[32:47], a[212:215], v[180:183], v[32:47]
  s_waitcnt lgkmcnt(0)
  v_rcp_f32 v59, v59
  v_rcp_f32 v60, v60
  v_rcp_f32 v61, v61
  v_rcp_f32 v62, v62
  v_rcp_f32 v63, v63
  v_pk_mul_f32 v[16:17], v[16:17], v[48:49]
  v_pk_mul_f32 v[18:19], v[18:19], v[50:51]
  v_pk_mul_f32 v[20:21], v[20:21], v[52:53]
  v_pk_mul_f32 v[22:23], v[22:23], v[54:55]
  v_pk_mul_f32 v[24:25], v[24:25], v[56:57]
  v_pk_mul_f32 v[26:27], v[26:27], v[58:59]
  v_pk_mul_f32 v[28:29], v[28:29], v[60:61]
  v_pk_mul_f32 v[30:31], v[30:31], v[62:63]
  v_pk_fma_f32 v[48:49], v[32:33], v[32:33], s[20:21] neg_lo:[1,0,1] neg_hi:[1,0,1]
  v_pk_fma_f32 v[50:51], v[34:35], v[34:35], s[20:21] neg_lo:[1,0,1] neg_hi:[1,0,1]
  v_pk_fma_f32 v[52:53], v[36:37], v[36:37], s[20:21] neg_lo:[1,0,1] neg_hi:[1,0,1]
  v_pk_fma_f32 v[54:55], v[38:39], v[38:39], s[20:21] neg_lo:[1,0,1] neg_hi:[1,0,1]
  v_pk_fma_f32 v[56:57], v[40:41], v[40:41], s[20:21] neg_lo:[1,0,1] neg_hi:[1,0,1]
  v_pk_fma_f32 v[58:59], v[42:43], v[42:43], s[20:21] neg_lo:[1,0,1] neg_hi:[1,0,1]
  v_pk_fma_f32 v[60:61], v[44:45], v[44:45], s[20:21] neg_lo:[1,0,1] neg_hi:[1,0,1]
  v_pk_fma_f32 v[62:63], v[46:47], v[46:47], s[20:21] neg_lo:[1,0,1] neg_hi:[1,0,1]
  v_pk_mul_f32 v[48:49], v[32:33], v[48:49]
  v_pk_mul_f32 v[50:51], v[34:35], v[50:51]
  v_pk_mul_f32 v[52:53], v[36:37], v[52:53]
  v_pk_mul_f32 v[54:55], v[38:39], v[54:55]
  v_pk_mul_f32 v[56:57], v[40:41], v[56:57]
  v_cvt_pk_bf16_f32 v184, v16, v17
  v_cvt_pk_bf16_f32 v185, v18, v19
  v_cvt_pk_bf16_f32 v186, v20, v21
  v_cvt_pk_bf16_f32 v187, v22, v23
  v_pk_mul_f32 v[58:59], v[42:43], v[58:59]
  v_pk_mul_f32 v[60:61], v[44:45], v[60:61]
  v_pk_mul_f32 v[62:63], v[46:47], v[62:63]
  v_mfma_f32_32x32x16_bf16 v[64:79], v[192:195], v[184:187], v[64:79]
  v_cvt_pk_bf16_f32 v188, v24, v25
  v_cvt_pk_bf16_f32 v189, v26, v27
  v_cvt_pk_bf16_f32 v190, v28, v29
  v_cvt_pk_bf16_f32 v191, v30, v31
  v_exp_f32_e64 v48, v48
  v_mfma_f32_32x32x16_bf16 v[80:95], v[196:199], v[184:187], v[80:95]
  v_exp_f32 v49, v49
  v_exp_f32 v50, v50
  v_exp_f32_e64 v51, v51
  v_mfma_f32_32x32x16_bf16 v[96:111], v[200:203], v[184:187], v[96:111]
  v_exp_f32 v52, v52
  v_exp_f32 v53, v53
  v_exp_f32_e64 v54, v54
  v_mfma_f32_32x32x16_bf16 v[64:79], v[204:207], v[188:191], v[64:79]
  v_exp_f32 v55, v55
  v_exp_f32 v56, v56
  v_exp_f32_e64 v57, v57
  v_mfma_f32_32x32x16_bf16 v[80:95], v[208:211], v[188:191], v[80:95]
  v_exp_f32 v58, v58
  v_exp_f32 v59, v59
  v_exp_f32_e64 v60, v60
  v_mfma_f32_32x32x16_bf16 v[96:111], v[212:215], v[188:191], v[96:111]
  v_exp_f32 v61, v61
  v_exp_f32 v62, v62
  v_exp_f32_e64 v63, v63
  v_pk_fma_f32 v[48:49], v[48:49], s[22:23], s[22:23]
  v_pk_fma_f32 v[50:51], v[50:51], s[22:23], s[22:23]
  v_pk_fma_f32 v[52:53], v[52:53], s[22:23], s[22:23]
  v_pk_fma_f32 v[54:55], v[54:55], s[22:23], s[22:23]
  v_pk_fma_f32 v[56:57], v[56:57], s[22:23], s[22:23]
  v_pk_fma_f32 v[58:59], v[58:59], s[22:23], s[22:23]
  v_pk_fma_f32 v[60:61], v[60:61], s[22:23], s[22:23]
  v_pk_fma_f32 v[62:63], v[62:63], s[22:23], s[22:23]
  v_mfma_f32_32x32x16_bf16 v[16:31], a[216:219], v[160:163], 0
  ds_read_b128 v[192:195], v0 offset:55296
  ds_read_b128 v[196:199], v0 offset:56320
  v_rcp_f32 v48, v48
  v_rcp_f32 v49, v49
  v_mfma_f32_32x32x16_bf16 v[16:31], a[220:223], v[164:167], v[16:31]
  ds_read_b128 v[200:203], v0 offset:57344
  ds_read_b128 v[204:207], v0 offset:58368
  v_rcp_f32 v50, v50
  v_rcp_f32 v51, v51
  v_mfma_f32_32x32x16_bf16 v[16:31], a[224:227], v[168:171], v[16:31]
  ds_read_b128 v[208:211], v0 offset:59392
  ds_read_b128 v[212:215], v0 offset:60416
  v_rcp_f32 v52, v52
  v_rcp_f32 v53, v53
  v_mfma_f32_32x32x16_bf16 v[16:31], a[228:231], v[172:175], v[16:31]
  v_rcp_f32 v54, v54
  v_rcp_f32 v55, v55
  v_rcp_f32_e64 v56, v56
  v_mfma_f32_32x32x16_bf16 v[16:31], a[232:235], v[176:179], v[16:31]
  v_rcp_f32 v57, v57
  v_rcp_f32 v58, v58
  v_rcp_f32_e64 v59, v59
  v_mfma_f32_32x32x16_bf16 v[16:31], a[236:239], v[180:183], v[16:31]
  s_waitcnt lgkmcnt(0)
  v_rcp_f32 v60, v60
  v_rcp_f32 v61, v61
  v_rcp_f32 v62, v62
  v_rcp_f32_e64 v63, v63
  v_pk_mul_f32 v[32:33], v[32:33], v[48:49]
  v_pk_mul_f32 v[34:35], v[34:35], v[50:51]
  v_pk_mul_f32 v[36:37], v[36:37], v[52:53]
  v_pk_mul_f32 v[38:39], v[38:39], v[54:55]
  v_pk_mul_f32 v[40:41], v[40:41], v[56:57]
  v_pk_mul_f32 v[42:43], v[42:43], v[58:59]
  v_pk_mul_f32 v[44:45], v[44:45], v[60:61]
  v_pk_mul_f32 v[46:47], v[46:47], v[62:63]
  v_pk_fma_f32 v[48:49], v[16:17], v[16:17], s[20:21] neg_lo:[1,0,1] neg_hi:[1,0,1]
  v_pk_fma_f32 v[50:51], v[18:19], v[18:19], s[20:21] neg_lo:[1,0,1] neg_hi:[1,0,1]
  v_pk_fma_f32 v[52:53], v[20:21], v[20:21], s[20:21] neg_lo:[1,0,1] neg_hi:[1,0,1]
  v_pk_fma_f32 v[54:55], v[22:23], v[22:23], s[20:21] neg_lo:[1,0,1] neg_hi:[1,0,1]
  v_pk_fma_f32 v[56:57], v[24:25], v[24:25], s[20:21] neg_lo:[1,0,1] neg_hi:[1,0,1]
  v_pk_fma_f32 v[58:59], v[26:27], v[26:27], s[20:21] neg_lo:[1,0,1] neg_hi:[1,0,1]
  v_pk_fma_f32 v[60:61], v[28:29], v[28:29], s[20:21] neg_lo:[1,0,1] neg_hi:[1,0,1]
  v_pk_fma_f32 v[62:63], v[30:31], v[30:31], s[20:21] neg_lo:[1,0,1] neg_hi:[1,0,1]
  v_pk_mul_f32 v[48:49], v[16:17], v[48:49]
  v_pk_mul_f32 v[50:51], v[18:19], v[50:51]
  v_pk_mul_f32 v[52:53], v[20:21], v[52:53]
  v_pk_mul_f32 v[54:55], v[22:23], v[54:55]
  v_pk_mul_f32 v[56:57], v[24:25], v[56:57]
  v_cvt_pk_bf16_f32 v184, v32, v33
  v_cvt_pk_bf16_f32 v185, v34, v35
  v_cvt_pk_bf16_f32 v186, v36, v37
  v_cvt_pk_bf16_f32 v187, v38, v39
  v_pk_mul_f32 v[58:59], v[26:27], v[58:59]
  v_pk_mul_f32 v[60:61], v[28:29], v[60:61]
  v_pk_mul_f32 v[62:63], v[30:31], v[62:63]
  v_mfma_f32_32x32x16_bf16 v[64:79], v[192:195], v[184:187], v[64:79]
  ds_read_b128 v[216:219], v0 offset:12288
  ds_read_b128 v[220:223], v0 offset:13312
  v_cvt_pk_bf16_f32 v188, v40, v41
  v_cvt_pk_bf16_f32 v189, v42, v43
  v_cvt_pk_bf16_f32 v190, v44, v45
  v_cvt_pk_bf16_f32 v191, v46, v47
  v_mfma_f32_32x32x16_bf16 v[80:95], v[196:199], v[184:187], v[80:95]
  ds_read_b128 v[224:227], v0 offset:14336
  ds_read_b128 v[228:231], v0 offset:15360
  v_exp_f32 v48, v48
  v_exp_f32 v49, v49
  v_mfma_f32_32x32x16_bf16 v[96:111], v[200:203], v[184:187], v[96:111]
  ds_read_b128 v[232:235], v0 offset:16384
  ds_read_b128 v[236:239], v0 offset:17408
  v_exp_f32 v50, v50
  v_exp_f32 v51, v51
  v_mfma_f32_32x32x16_bf16 v[64:79], v[204:207], v[188:191], v[64:79]
  s_mov_b32 s28, s34
  v_exp_f32 v52, v52
  v_exp_f32 v53, v53
  v_exp_f32 v54, v54
  v_mfma_f32_32x32x16_bf16 v[80:95], v[208:211], v[188:191], v[80:95]
  s_add_u32 s34, s34, 0x60000
  v_exp_f32 v55, v55
  v_exp_f32 v56, v56
  v_exp_f32_e64 v57, v57
  v_mfma_f32_32x32x16_bf16 v[96:111], v[212:215], v[188:191], v[96:111]
  s_waitcnt lgkmcnt(0)
  v_exp_f32 v58, v58
  v_exp_f32 v59, v59
  v_exp_f32 v60, v60
  v_exp_f32 v61, v61
  v_exp_f32 v62, v62
  v_exp_f32_e64 v63, v63
  v_pk_fma_f32 v[48:49], v[48:49], s[22:23], s[22:23]
  v_pk_fma_f32 v[50:51], v[50:51], s[22:23], s[22:23]
  v_pk_fma_f32 v[52:53], v[52:53], s[22:23], s[22:23]
  v_pk_fma_f32 v[54:55], v[54:55], s[22:23], s[22:23]
  v_pk_fma_f32 v[56:57], v[56:57], s[22:23], s[22:23]
  v_pk_fma_f32 v[58:59], v[58:59], s[22:23], s[22:23]
  v_pk_fma_f32 v[60:61], v[60:61], s[22:23], s[22:23]
  v_pk_fma_f32 v[62:63], v[62:63], s[22:23], s[22:23]
  v_mfma_f32_32x32x16_bf16 v[32:47], v[216:219], v[160:163], 0
  ds_read_b128 v[192:195], v0 offset:61440
  ds_read_b128 v[196:199], v0 offset:62464
  v_rcp_f32 v48, v48
  v_rcp_f32 v49, v49
  v_mfma_f32_32x32x16_bf16 v[32:47], v[220:223], v[164:167], v[32:47]
  ds_read_b128 v[200:203], v0 offset:63488
  ds_read_b128 v[204:207], v0 offset:64512
  v_rcp_f32 v50, v50
  v_rcp_f32 v51, v51
  v_mfma_f32_32x32x16_bf16 v[32:47], v[224:227], v[168:171], v[32:47]
  ds_read_b128 v[208:211], v1
  ds_read_b128 v[212:215], v1 offset:1024
  v_rcp_f32 v52, v52
  v_rcp_f32 v53, v53
  v_mfma_f32_32x32x16_bf16 v[32:47], v[228:231], v[172:175], v[32:47]
  v_rcp_f32 v54, v54
  v_rcp_f32 v55, v55
  v_rcp_f32_e64 v56, v56
  v_mfma_f32_32x32x16_bf16 v[32:47], v[232:235], v[176:179], v[32:47]
  v_rcp_f32 v57, v57
  v_rcp_f32 v58, v58
  v_rcp_f32_e64 v59, v59
  v_mfma_f32_32x32x16_bf16 v[32:47], v[236:239], v[180:183], v[32:47]
  s_waitcnt lgkmcnt(0)
  v_rcp_f32 v60, v60
  v_rcp_f32 v61, v61
  v_rcp_f32 v62, v62
  v_rcp_f32_e64 v63, v63
  v_pk_mul_f32 v[16:17], v[16:17], v[48:49]
  v_pk_mul_f32 v[18:19], v[18:19], v[50:51]
  v_pk_mul_f32 v[20:21], v[20:21], v[52:53]
  v_pk_mul_f32 v[22:23], v[22:23], v[54:55]
  v_pk_mul_f32 v[24:25], v[24:25], v[56:57]
  v_pk_mul_f32 v[26:27], v[26:27], v[58:59]
  v_pk_mul_f32 v[28:29], v[28:29], v[60:61]
  v_pk_mul_f32 v[30:31], v[30:31], v[62:63]
  v_pk_fma_f32 v[48:49], v[32:33], v[32:33], s[20:21] neg_lo:[1,0,1] neg_hi:[1,0,1]
  v_pk_fma_f32 v[50:51], v[34:35], v[34:35], s[20:21] neg_lo:[1,0,1] neg_hi:[1,0,1]
  v_pk_fma_f32 v[52:53], v[36:37], v[36:37], s[20:21] neg_lo:[1,0,1] neg_hi:[1,0,1]
  v_pk_fma_f32 v[54:55], v[38:39], v[38:39], s[20:21] neg_lo:[1,0,1] neg_hi:[1,0,1]
  v_pk_fma_f32 v[56:57], v[40:41], v[40:41], s[20:21] neg_lo:[1,0,1] neg_hi:[1,0,1]
  v_pk_fma_f32 v[58:59], v[42:43], v[42:43], s[20:21] neg_lo:[1,0,1] neg_hi:[1,0,1]
  v_pk_fma_f32 v[60:61], v[44:45], v[44:45], s[20:21] neg_lo:[1,0,1] neg_hi:[1,0,1]
  v_pk_fma_f32 v[62:63], v[46:47], v[46:47], s[20:21] neg_lo:[1,0,1] neg_hi:[1,0,1]
  v_pk_mul_f32 v[48:49], v[32:33], v[48:49]
  v_pk_mul_f32 v[50:51], v[34:35], v[50:51]
  v_pk_mul_f32 v[52:53], v[36:37], v[52:53]
  v_pk_mul_f32 v[54:55], v[38:39], v[54:55]
  v_pk_mul_f32 v[56:57], v[40:41], v[56:57]
  v_cvt_pk_bf16_f32 v184, v16, v17
  v_cvt_pk_bf16_f32 v185, v18, v19
  v_cvt_pk_bf16_f32 v186, v20, v21
  v_cvt_pk_bf16_f32 v187, v22, v23
  v_pk_mul_f32 v[58:59], v[42:43], v[58:59]
  v_pk_mul_f32 v[60:61], v[44:45], v[60:61]
  v_pk_mul_f32 v[62:63], v[46:47], v[62:63]
  v_mfma_f32_32x32x16_bf16 v[64:79], v[192:195], v[184:187], v[64:79]
  v_cvt_pk_bf16_f32 v188, v24, v25
  v_cvt_pk_bf16_f32 v189, v26, v27
  v_cvt_pk_bf16_f32 v190, v28, v29
  v_cvt_pk_bf16_f32 v191, v30, v31
  v_exp_f32_e64 v48, v48
  v_mfma_f32_32x32x16_bf16 v[80:95], v[196:199], v[184:187], v[80:95]
  v_exp_f32 v49, v49
  v_exp_f32 v50, v50
  v_exp_f32_e64 v51, v51
  v_mfma_f32_32x32x16_bf16 v[96:111], v[200:203], v[184:187], v[96:111]
  v_exp_f32 v52, v52
  v_exp_f32 v53, v53
  v_exp_f32_e64 v54, v54
  v_mfma_f32_32x32x16_bf16 v[64:79], v[204:207], v[188:191], v[64:79]
  v_exp_f32 v55, v55
  v_exp_f32 v56, v56
  v_exp_f32_e64 v57, v57
  v_mfma_f32_32x32x16_bf16 v[80:95], v[208:211], v[188:191], v[80:95]
  v_exp_f32 v58, v58
  v_exp_f32 v59, v59
  v_exp_f32_e64 v60, v60
  v_mfma_f32_32x32x16_bf16 v[96:111], v[212:215], v[188:191], v[96:111]
  v_exp_f32 v61, v61
  v_exp_f32 v62, v62
  v_exp_f32_e64 v63, v63
  v_pk_fma_f32 v[48:49], v[48:49], s[22:23], s[22:23]
  v_pk_fma_f32 v[50:51], v[50:51], s[22:23], s[22:23]
  v_pk_fma_f32 v[52:53], v[52:53], s[22:23], s[22:23]
  v_pk_fma_f32 v[54:55], v[54:55], s[22:23], s[22:23]
  v_pk_fma_f32 v[56:57], v[56:57], s[22:23], s[22:23]
  v_pk_fma_f32 v[58:59], v[58:59], s[22:23], s[22:23]
  v_pk_fma_f32 v[60:61], v[60:61], s[22:23], s[22:23]
  v_pk_fma_f32 v[62:63], v[62:63], s[22:23], s[22:23]
  ds_read_b128 v[192:195], v1 offset:2048
  ds_read_b128 v[196:199], v1 offset:3072
  ds_read_b128 v[200:203], v1 offset:4096
  ds_read_b128 v[204:207], v1 offset:5120
  ds_read_b128 v[208:211], v1 offset:6144
  ds_read_b128 v[212:215], v1 offset:7168
  v_rcp_f32 v48, v48
  v_rcp_f32 v49, v49
  v_rcp_f32 v50, v50
  v_rcp_f32 v51, v51
  v_rcp_f32 v52, v52
  v_rcp_f32 v53, v53
  v_rcp_f32 v54, v54
  v_rcp_f32 v55, v55
  v_rcp_f32 v56, v56
  v_rcp_f32 v57, v57
  v_rcp_f32 v58, v58
  v_rcp_f32 v59, v59
  v_rcp_f32 v60, v60
  v_rcp_f32 v61, v61
  v_rcp_f32 v62, v62
  v_rcp_f32 v63, v63
  v_pk_mul_f32 v[32:33], v[32:33], v[48:49]
  v_pk_mul_f32 v[34:35], v[34:35], v[50:51]
  v_pk_mul_f32 v[36:37], v[36:37], v[52:53]
  v_pk_mul_f32 v[38:39], v[38:39], v[54:55]
  v_pk_mul_f32 v[40:41], v[40:41], v[56:57]
  v_pk_mul_f32 v[42:43], v[42:43], v[58:59]
  v_pk_mul_f32 v[44:45], v[44:45], v[60:61]
  v_pk_mul_f32 v[46:47], v[46:47], v[62:63]
  v_cvt_pk_bf16_f32 v184, v32, v33
  v_cvt_pk_bf16_f32 v185, v34, v35
  v_cvt_pk_bf16_f32 v186, v36, v37
  v_cvt_pk_bf16_f32 v187, v38, v39
  v_cvt_pk_bf16_f32 v188, v40, v41
  v_cvt_pk_bf16_f32 v189, v42, v43
  v_cvt_pk_bf16_f32 v190, v44, v45
  v_cvt_pk_bf16_f32 v191, v46, v47
  s_waitcnt lgkmcnt(5)
  v_mfma_f32_32x32x16_bf16 v[64:79], v[192:195], v[184:187], v[64:79]
  s_waitcnt lgkmcnt(2)
  v_mfma_f32_32x32x16_bf16 v[64:79], v[204:207], v[188:191], v[64:79]
  v_mfma_f32_32x32x16_bf16 v[80:95], v[196:199], v[184:187], v[80:95]
  s_waitcnt lgkmcnt(1)
  v_mfma_f32_32x32x16_bf16 v[80:95], v[208:211], v[188:191], v[80:95]
  s_nop 0
  v_mfma_f32_32x32x16_bf16 v[96:111], v[200:203], v[184:187], v[96:111]
  s_waitcnt lgkmcnt(0)
  v_mfma_f32_32x32x16_bf16 v[96:111], v[212:215], v[188:191], v[96:111]
  s_nop 5
  v_cvt_pk_bf16_f32 v112, v64, v65
  v_cvt_pk_bf16_f32 v113, v66, v67
  v_cvt_pk_bf16_f32 v114, v68, v69
  v_cvt_pk_bf16_f32 v115, v70, v71
  buffer_store_dwordx4 v[112:115], v10, s[8:11], s28 offen
  v_cvt_pk_bf16_f32 v116, v72, v73
  v_cvt_pk_bf16_f32 v117, v74, v75
  v_cvt_pk_bf16_f32 v118, v76, v77
  v_cvt_pk_bf16_f32 v119, v78, v79
  buffer_store_dwordx4 v[116:119], v10, s[8:11], s28 offen offset:32
  v_cvt_pk_bf16_f32 v120, v80, v81
  v_cvt_pk_bf16_f32 v121, v82, v83
  v_cvt_pk_bf16_f32 v122, v84, v85
  v_cvt_pk_bf16_f32 v123, v86, v87
  buffer_store_dwordx4 v[120:123], v10, s[8:11], s28 offen offset:64
  v_cvt_pk_bf16_f32 v124, v88, v89
  v_cvt_pk_bf16_f32 v125, v90, v91
  v_cvt_pk_bf16_f32 v126, v92, v93
  v_cvt_pk_bf16_f32 v127, v94, v95
  buffer_store_dwordx4 v[124:127], v10, s[8:11], s28 offen offset:96
  v_cvt_pk_bf16_f32 v128, v96, v97
  v_cvt_pk_bf16_f32 v129, v98, v99
  v_cvt_pk_bf16_f32 v130, v100, v101
  v_cvt_pk_bf16_f32 v131, v102, v103
  buffer_store_dwordx4 v[128:131], v10, s[8:11], s28 offen offset:128
  v_cvt_pk_bf16_f32 v132, v104, v105
  v_cvt_pk_bf16_f32 v133, v106, v107
  v_cvt_pk_bf16_f32 v134, v108, v109
  v_cvt_pk_bf16_f32 v135, v110, v111
  buffer_store_dwordx4 v[132:135], v10, s[8:11], s28 offen offset:160
S_end:
  s_endpgm
.section .rodata,"a"
.p2align 6
.amdhsa_kernel standalone__modern_conv_block_convnext__vision_kernel
  .amdhsa_next_free_vgpr 512
  .amdhsa_next_free_sgpr 102
  .amdhsa_accum_offset 256
  .amdhsa_group_segment_fixed_size 0
  .amdhsa_kernarg_size 80
  .amdhsa_user_sgpr_count 2
  .amdhsa_user_sgpr_kernarg_segment_ptr 1
  .amdhsa_system_sgpr_workgroup_id_x 1
.end_amdhsa_kernel
```
